```python
import torch

def _softmax(x, axis=-1):
    return torch.softmax(x, dim=axis)
def _gelu(x):
    return torch.nn.functional.gelu(x, approximate="tanh")
def _silu(x):
    return torch.nn.functional.silu(x)
def _sigmoid(x):
    return torch.sigmoid(x)
def _layernorm(x, axis=-1, eps=1e-5):
    m = x.mean(dim=axis, keepdim=True)
    v = x.var(dim=axis, keepdim=True, unbiased=False)
    return (x - m) / torch.sqrt(v + eps)
def _scatter_add(tgt, idx, src, axis=0):
    return tgt.clone().index_add_(axis, idx, src)
def _segment_sum(src, seg, n):
    out = torch.zeros((n,) + src.shape[1:], dtype=src.dtype)
    return out.index_add_(0, seg, src)
def _pad(x, pw):
    flat = tuple(v for pair in reversed(pw) for v in pair)
    return torch.nn.functional.pad(x, flat)

kernel_name = 'standalone__edge_featured_mpnn_gatedgcn__graph'

def setup_inputs():

    _w = (lambda a: (lambda t: t.to(torch.bfloat16) if t.is_floating_point() else t)(torch.as_tensor(a)))
    N, deg, D, De = 50000, 16, 64, max(16, 1)
    E = N * deg
    return {
        "x": _w((lambda *s: torch.randn(*s, dtype=torch.bfloat16) * 0.4)(N, D)),
        "e_attr": _w((lambda *s: torch.randn(*s, dtype=torch.bfloat16) * 0.8)(E, De)),
        "src": _w((lambda lo, hi, *s: torch.randint(lo, hi, s))(0, N, E).to(torch.int64)),
        "dst": _w((lambda lo, hi, *s: torch.randint(lo, hi, s))(0, N, E).to(torch.int64)),
        "w_a": _w((lambda *s: torch.randn(*s, dtype=torch.bfloat16) * 0.8)(D, D)),
        "w_b": _w((lambda *s: torch.randn(*s, dtype=torch.bfloat16) * 0.4)(D, D)),
        "w_c": _w((lambda *s: torch.randn(*s, dtype=torch.bfloat16) * 0.8)(De, D)),
        "w_u": _w((lambda *s: torch.randn(*s, dtype=torch.bfloat16) * 0.05)(D, D)),
        "w_v": _w((lambda *s: torch.randn(*s, dtype=torch.bfloat16) * 0.05)(D, D)),
    }

def reference(x, e_attr, src, dst, w_a, w_b, w_c, w_u, w_v):
    N, D = x.shape
    hv = x @ w_v
    g = x[dst] @ w_a + x[src] @ w_b + e_attr @ w_c
    eta = _sigmoid(g)
    denom = _segment_sum(eta, dst, N) + 1e-6
    eta_n = eta / denom[dst]
    agg = _segment_sum(eta_n * hv[src], dst, N)
    z = x @ w_u + agg
    relu_z = torch.where(z > 0, z, 0 * z)
    return x + relu_z
```

```asm
; @launch grid=(256,1,1) block=(512,1,1) lds=159360
.amdgcn_target "amdgcn-amd-amdhsa--gfx950"
.text
.globl standalone__edge_featured_mpnn_gatedgcn__graph_kernel
.p2align 8
.type standalone__edge_featured_mpnn_gatedgcn__graph_kernel,@function
standalone__edge_featured_mpnn_gatedgcn__graph_kernel:
    s_cmp_ge_u32 s2, 256
    s_cbranch_scc1 L_END
    s_load_dwordx16 s[16:31], s[0:1], 0
    s_load_dwordx8 s[32:39], s[0:1], 64
    s_getpc_b64 s[64:65]
L_PC:
    v_lshlrev_b32 v188, 7, v0
    v_min_u32 v188, L_LAST-L_PC, v188
    v_cmp_gt_u32 vcc, 0xc0, v0
    s_cbranch_vccz L_NOCPF
    global_load_dword v251, v188, s[64:65]
L_NOCPF:
    v_mov_b32 v255, v0
    v_lshrrev_b32 v188, 6, v0
    v_and_b32 v253, 63, v0
    v_readfirstlane_b32 s3, v188
    v_lshlrev_b32 v232, 4, v0
    v_lshlrev_b32 v190, 3, v0
    v_lshlrev_b32 v191, 2, v0
    v_mov_b32 v184, 0x10000
    v_and_b32 v192, 0x3fc, v191
    ds_write_b32 v192, v184 offset:5120
    s_mul_i32 s10, s2, 12512
    s_sub_u32 s11, 3200000, s10
    s_min_u32 s11, s11, 12512
    s_and_b32 s5, s2, 7
    s_lshr_b32 s4, s2, 3
    s_lshl_b32 s5, s5, 5
    s_add_u32 s5, s5, s4
    s_mul_i32 s9, s5, 196
    s_lshl_b32 s12, s3, 5
    s_add_u32 s9, s9, s12
    v_lshrrev_b32 v193, 3, v253
    v_lshl_add_u32 v193, v193, 2, s9
    v_and_b32 v243, 7, v253
    v_lshlrev_b32 v243, 4, v243
    v_lshl_add_u32 v234, v193, 7, v243
    s_lshl_b32 s101, s3, 10
    s_add_u32 s101, s101, 116736
    s_movk_i32 s8, 0x2000
    s_movk_i32 s9, 0x3000
    s_waitcnt lgkmcnt(0)
    s_load_dword s6, s[38:39], 0
    s_add_u32 s56, s22, s10
    s_addc_u32 s57, s23, 0
    s_mov_b32 s58, s11
    s_mov_b32 s59, 0x20000
    s_add_u32 s60, s20, s10
    s_addc_u32 s61, s21, 0
    s_mov_b32 s62, s11
    s_mov_b32 s63, 0x20000
    buffer_load_dwordx4 v[96:99], v232, s[56:59], 0 offen nt
    buffer_load_dwordx4 v[104:107], v232, s[60:63], 0 offen nt
    buffer_load_dwordx2 v[100:101], v190, s[56:59], s8 offen nt
    buffer_load_dwordx2 v[108:109], v190, s[60:63], s8 offen nt
    s_cmp_lg_u32 s3, 0
    s_cbranch_scc1 L_NO7
    buffer_load_dword v102, v191, s[56:59], s9 offen nt
    buffer_load_dword v110, v191, s[60:63], s9 offen nt
L_NO7:
    s_barrier
    s_mov_b32 s44, s18
    s_or_b32 s45, s19, 0x200000
    s_mov_b32 s46, 800000
    s_mov_b32 s47, 0x20000
    s_mov_b32 s48, s34
    s_mov_b32 s49, s35
    s_mov_b32 s50, 6400000
    s_mov_b32 s51, 0x20000
    s_mov_b32 s40, s16
    s_mov_b32 s41, s17
    s_mov_b32 s42, 6400000
    s_mov_b32 s43, 0x20000
    s_mov_b32 s52, s38
    s_mov_b32 s53, s39
    s_mov_b32 s54, 23068672
    s_mov_b32 s55, 0x20000
    s_lshl_b32 s12, s2, 7
    s_add_u32 s12, s12, 65536
    s_add_u32 s56, s38, s12
    s_addc_u32 s57, s39, 0
    s_mov_b32 s58, 12599296
    s_mov_b32 s59, 0x20000
    s_mov_b32 s64, 85599
    s_mov_b32 s65, 4294967100
    s_mov_b32 s66, 42944
    s_mov_b32 s67, 0x60000000
    s_mov_b32 s68, 32896
    v_add_u32 v136, 0, v191
    v_add_u32 v137, 1, v191
    v_add_u32 v138, 2, v191
    v_add_u32 v139, 3, v191
    v_lshrrev_b32 v140, 1, v191
    v_add_u32 v140, 0x800, v140
    v_add_u32 v141, 1, v140
    v_add_u32 v142, 0xc00, v255
    s_lshr_b32 s11, s11, 2
    v_cmp_gt_u32 s[70:71], s11, v140
    v_cmp_gt_u32 s[72:73], s11, v142
    s_and_b32 s10, s3, 3
    s_lshr_b32 s4, s3, 2
    s_lshl1_add_u32 s4, s10, s4
    s_xor_b32 s4, s4, 1
    s_mul_i32 s10, s4, 49
    s_sub_i32 s10, s10, 7
    s_ashr_i32 s10, s10, 1
    s_max_i32 s7, s10, 0
    s_mul_i32 s13, s4, 4224
    s_add_u32 s13, s13, 82944
    s_lshl_b32 s14, s4, 10
    s_add_u32 s14, s14, 5120
    s_mul_i32 s12, s4, 2304
    s_add_u32 s12, s12, 46080
    s_movk_i32 s15, 128
    v_bfe_u32 v194, v255, 4, 4
    v_and_b32 v195, 7, v255
    v_cmp_eq_u32 vcc, v194, v195
    v_and_b32 v194, 8, v255
    v_lshlrev_b32 v194, 1, v194
    v_mov_b32 v196, 0x3f80
    v_lshlrev_b32 v196, v194, v196
    v_cndmask_b32 v196, 0, v196, vcc
    ds_write_b32 v192, v196 offset:0
    v_mov_b64 v[196:197], 0
    ds_write_b64 v190, v[196:197] offset:1024
    v_add_u32 v194, 158336, v192
    ds_write_b32 v194, v196
    v_cmp_eq_u32 s[74:75], 0, v195
    v_lshrrev_b32 v223, 3, v255
    v_mad_u32_u24 v220, v223, s68, v243
    v_mul_u32_u24 v224, 160, v223
    v_add_u32 v221, v224, v243
    v_add_u32 v221, 46080, v221
    v_and_b32 v222, 4, v255
    v_lshl_add_u32 v222, v222, 2, v221
    v_bfe_u32 v194, v255, 5, 1
    v_bfe_u32 v196, v255, 6, 1
    v_sub_u32 v194, v194, v196
    v_mul_i32_i24 v194, 640, v194
    v_add_u32 v224, v224, v194
    v_lshl_add_u32 v224, v195, 2, v224
    v_add_u32 v224, 13312, v224
    v_lshlrev_b32 v223, 2, v223
    v_lshlrev_b32 v185, 4, v253
    v_and_b32 v241, 1, v253
    v_lshlrev_b32 v241, 4, v241
    v_mov_b32 v242, 0xdddd
    v_and_b32 v245, 16, v253
    v_and_b32 v194, 3, v253
    v_lshlrev_b32 v246, 3, v194
    v_bfe_u32 v196, v253, 2, 2
    v_and_b32 v197, 48, v253
    v_lshl_add_u32 v198, v196, 7, v197
    v_mul_u32_u24 v244, 1056, v194
    v_add3_u32 v244, v244, v198, s13
    v_bfe_u32 v197, v253, 2, 3
    v_lshrrev_b32 v196, 5, v253
    v_lshl_add_u32 v197, v196, 4, v197
    v_mul_u32_u24 v225, 160, v197
    v_add_u32 v225, v225, v246
    v_lshrrev_b32 v194, 3, v253
    v_lshl_add_u32 v247, v194, 4, s12
    s_add_u32 s10, s12, 18432
    v_lshrrev_b32 v194, 1, v253
    v_lshl_add_u32 v248, v194, 2, s10
    s_add_u32 s10, s10, 2
    v_and_b32 v194, 48, v253
    v_lshl_add_u32 v250, v194, 1, s10
    v_and_b32 v194, 12, v253
    v_add_u32 v250, v250, v194
    v_lshrrev_b32 v194, 5, v253
    v_mul_u32_u24 v249, 18432, v194
    v_and_b32 v194, 15, v253
    v_lshl_add_u32 v249, v194, 2, v249
    s_add_u32 s10, s12, 2
    v_add_u32 v249, s10, v249
    s_movk_i32 s69, 11520
    s_waitcnt lgkmcnt(0)
    s_waitcnt vmcnt(3)
    v_mul_u32_u24 v112, s64, v96
    v_mul_u32_u24 v113, s64, v97
    v_mul_u32_u24 v114, s64, v98
    v_mul_u32_u24 v115, s64, v99
    v_lshrrev_b32 v112, 24, v112
    v_lshrrev_b32 v113, 24, v113
    v_lshrrev_b32 v114, 24, v114
    v_lshrrev_b32 v115, 24, v115
    v_lshlrev_b32 v120, 2, v112
    ds_add_rtn_u32 v128, v120, v184 offset:5120
    v_lshlrev_b32 v121, 2, v113
    ds_add_rtn_u32 v129, v121, v184 offset:5120
    v_lshlrev_b32 v122, 2, v114
    ds_add_rtn_u32 v130, v122, v184 offset:5120
    v_lshlrev_b32 v123, 2, v115
    ds_add_rtn_u32 v131, v123, v184 offset:5120
    s_waitcnt vmcnt(1)
    s_mov_b64 exec, s[70:71]
    v_mul_u32_u24 v116, s64, v100
    v_mul_u32_u24 v117, s64, v101
    v_lshrrev_b32 v116, 24, v116
    v_lshrrev_b32 v117, 24, v117
    v_lshlrev_b32 v124, 2, v116
    ds_add_rtn_u32 v132, v124, v184 offset:5120
    v_lshlrev_b32 v125, 2, v117
    ds_add_rtn_u32 v133, v125, v184 offset:5120
    s_mov_b64 exec, -1
    s_waitcnt vmcnt(0)
    v_mad_i32_i24 v96, v112, s65, v96
    v_mul_u32_u24 v194, s66, v104
    v_lshl_or_b32 v104, v96, 21, v104
    v_and_or_b32 v104, v194, s67, v104
    v_mad_u32_u24 v112, v112, 40, s69
    v_mad_i32_i24 v97, v113, s65, v97
    v_mul_u32_u24 v194, s66, v105
    v_lshl_or_b32 v105, v97, 21, v105
    v_and_or_b32 v105, v194, s67, v105
    v_mad_u32_u24 v113, v113, 40, s69
    v_mad_i32_i24 v98, v114, s65, v98
    v_mul_u32_u24 v194, s66, v106
    v_lshl_or_b32 v106, v98, 21, v106
    v_and_or_b32 v106, v194, s67, v106
    v_mad_u32_u24 v114, v114, 40, s69
    v_mad_i32_i24 v99, v115, s65, v99
    v_mul_u32_u24 v194, s66, v107
    v_lshl_or_b32 v107, v99, 21, v107
    v_and_or_b32 v107, v194, s67, v107
    v_mad_u32_u24 v115, v115, 40, s69
    v_mad_i32_i24 v100, v116, s65, v100
    v_mul_u32_u24 v194, s66, v108
    v_lshl_or_b32 v108, v100, 21, v108
    v_and_or_b32 v108, v194, s67, v108
    v_mad_u32_u24 v116, v116, 40, s69
    v_mad_i32_i24 v101, v117, s65, v101
    v_mul_u32_u24 v194, s66, v109
    v_lshl_or_b32 v109, v101, 21, v109
    v_and_or_b32 v109, v194, s67, v109
    v_mad_u32_u24 v117, v117, 40, s69
    s_waitcnt lgkmcnt(5)
    v_lshrrev_b32 v128, 16, v128
    v_mul_u32_u24 v96, 33, v128
    v_bfe_u32 v96, v96, 3, 5
    v_add_lshl_u32 v96, v96, v112, 1
    v_lshlrev_b32 v194, 1, v96
    v_cmpx_gt_u32 vcc, 32, v128
    ds_write_b16 v96, v136 offset:64000
    ds_write_b32 v194, v104 offset:0
    s_mov_b64 exec, -1
    s_waitcnt lgkmcnt(6)
    v_lshrrev_b32 v129, 16, v129
    v_mul_u32_u24 v97, 33, v129
    v_bfe_u32 v97, v97, 3, 5
    v_add_lshl_u32 v97, v97, v113, 1
    v_lshlrev_b32 v194, 1, v97
    v_cmpx_gt_u32 vcc, 32, v129
    ds_write_b16 v97, v137 offset:64000
    ds_write_b32 v194, v105 offset:0
    s_mov_b64 exec, -1
    s_waitcnt lgkmcnt(7)
    v_lshrrev_b32 v130, 16, v130
    v_mul_u32_u24 v98, 33, v130
    v_bfe_u32 v98, v98, 3, 5
    v_add_lshl_u32 v98, v98, v114, 1
    v_lshlrev_b32 v194, 1, v98
    v_cmpx_gt_u32 vcc, 32, v130
    ds_write_b16 v98, v138 offset:64000
    ds_write_b32 v194, v106 offset:0
    s_mov_b64 exec, -1
    s_waitcnt lgkmcnt(8)
    v_lshrrev_b32 v131, 16, v131
    v_mul_u32_u24 v99, 33, v131
    v_bfe_u32 v99, v99, 3, 5
    v_add_lshl_u32 v99, v99, v115, 1
    v_lshlrev_b32 v194, 1, v99
    v_cmpx_gt_u32 vcc, 32, v131
    ds_write_b16 v99, v139 offset:64000
    ds_write_b32 v194, v107 offset:0
    s_mov_b64 exec, s[70:71]
    s_waitcnt lgkmcnt(9)
    v_lshrrev_b32 v132, 16, v132
    v_mul_u32_u24 v100, 33, v132
    v_bfe_u32 v100, v100, 3, 5
    v_add_lshl_u32 v100, v100, v116, 1
    v_lshlrev_b32 v194, 1, v100
    v_cmpx_gt_u32 vcc, 32, v132
    ds_write_b16 v100, v140 offset:64000
    ds_write_b32 v194, v108 offset:0
    s_mov_b64 exec, s[70:71]
    s_waitcnt lgkmcnt(10)
    v_lshrrev_b32 v133, 16, v133
    v_mul_u32_u24 v101, 33, v133
    v_bfe_u32 v101, v101, 3, 5
    v_add_lshl_u32 v101, v101, v117, 1
    v_lshlrev_b32 v194, 1, v101
    v_cmpx_gt_u32 vcc, 32, v133
    ds_write_b16 v101, v141 offset:64000
    ds_write_b32 v194, v109 offset:0
    s_mov_b64 exec, -1
    s_cmp_lg_u32 s3, 0
    s_cbranch_scc1 L_B1
    s_mov_b64 exec, s[72:73]
    v_mul_u32_u24 v118, s64, v102
    v_lshrrev_b32 v118, 24, v118
    v_lshlrev_b32 v126, 2, v118
    ds_add_rtn_u32 v134, v126, v184 offset:5120
    v_mad_i32_i24 v102, v118, s65, v102
    v_mul_u32_u24 v194, s66, v110
    v_lshl_or_b32 v110, v102, 21, v110
    v_and_or_b32 v110, v194, s67, v110
    v_mad_u32_u24 v118, v118, 40, s69
    s_waitcnt lgkmcnt(0)
    v_lshrrev_b32 v134, 16, v134
    v_mul_u32_u24 v102, 33, v134
    v_bfe_u32 v102, v102, 3, 5
    v_add_lshl_u32 v102, v102, v118, 1
    v_lshlrev_b32 v194, 1, v102
    v_cmpx_gt_u32 vcc, 32, v134
    ds_write_b16 v102, v142 offset:64000
    ds_write_b32 v194, v110 offset:0
    s_mov_b64 exec, -1
L_B1:
    s_cmp_ge_u32 s3, 2
    s_cbranch_scc1 L_NOC
    global_load_dwordx4 v[176:179], v232, s[28:29]
L_NOC:
    global_load_dwordx4 v[160:163], v232, s[26:27]
    global_load_dwordx4 v[164:167], v232, s[32:33]
    global_load_dwordx4 v[168:171], v232, s[24:25]
    s_add_u32 s6, s6, 0xb5c179b9
    s_and_b32 s76, s6, 0x801f0000
    s_bfe_u32 s77, s6, 0x40010
    s_mul_i32 s77, s77, 0x10001000
    s_and_b32 s78, s6, 0xf000ffff
    v_mov_b32 v186, s76
    v_mov_b32 v187, s77
    v_mov_b32 v236, 0x801f0000
    v_cndmask_b32 v236, v236, -1, s[74:75]
    s_mov_b32 s64, 0x801f0000
    s_mov_b32 s66, 0xf000f000
    s_waitcnt lgkmcnt(0)
    s_barrier
    ds_read_b128 v[192:195], v185 offset:5120
    ds_read_b32 v228, v223 offset:5120
    ds_read_b128 v[204:207], v221 offset:0
    ds_read_b32 v229, v223 offset:5376
    ds_read_b128 v[208:211], v221 offset:10240
    ds_read_b32 v230, v223 offset:5632
    ds_read_b128 v[212:215], v221 offset:20480
    ds_read_b32 v231, v223 offset:5888
    ds_read_b128 v[216:219], v221 offset:30720
    ds_read_b128 v[196:199], v222 offset:40960
    ds_read_b128 v[200:203], v222 offset:51200
    s_mov_b32 s80, 2105344
    s_mov_b32 s81, 4210688
    s_mov_b32 s82, 6316032
    s_mov_b32 s83, 8421376
    s_mov_b32 s84, 10526720
    s_waitcnt lgkmcnt(10)
    v_max3_u32 v188, v192, v193, v194
    v_max_u32 v188, v188, v195
    v_cmp_lt_u32 vcc, 2097152, v188
    s_cbranch_vccnz L_POVF
L_POUT:
    s_waitcnt lgkmcnt(8)
    v_or_b32 v228, s78, v228
    v_cndmask_b32 v228, v186, v228, s[74:75]
    v_bfi_b32 v205, s64, v186, v205
    v_bfi_b32 v206, s64, v186, v206
    v_bfi_b32 v207, s64, v186, v207
    v_bfi_b32 v204, v236, v228, v204
    buffer_store_dwordx4 v[204:207], v220, s[56:59], 0 offen sc1
    s_waitcnt lgkmcnt(6)
    v_or_b32 v229, s78, v229
    v_cndmask_b32 v229, v186, v229, s[74:75]
    v_bfi_b32 v209, s64, v186, v209
    v_bfi_b32 v210, s64, v186, v210
    v_bfi_b32 v211, s64, v186, v211
    v_bfi_b32 v208, v236, v229, v208
    buffer_store_dwordx4 v[208:211], v220, s[56:59], s80 offen sc1
    s_waitcnt lgkmcnt(4)
    v_or_b32 v230, s78, v230
    v_cndmask_b32 v230, v186, v230, s[74:75]
    v_bfi_b32 v213, s64, v186, v213
    v_bfi_b32 v214, s64, v186, v214
    v_bfi_b32 v215, s64, v186, v215
    v_bfi_b32 v212, v236, v230, v212
    buffer_store_dwordx4 v[212:215], v220, s[56:59], s81 offen sc1
    s_waitcnt lgkmcnt(2)
    v_or_b32 v231, s78, v231
    v_cndmask_b32 v231, v186, v231, s[74:75]
    v_bfi_b32 v217, s64, v186, v217
    v_bfi_b32 v218, s64, v186, v218
    v_bfi_b32 v219, s64, v186, v219
    v_bfi_b32 v216, v236, v231, v216
    buffer_store_dwordx4 v[216:219], v220, s[56:59], s82 offen sc1
    s_waitcnt lgkmcnt(1)
    v_bfi_b32 v196, s66, v187, v196
    v_bfi_b32 v197, s66, v187, v197
    v_bfi_b32 v198, s66, v187, v198
    v_bfi_b32 v199, s66, v187, v199
    buffer_store_dwordx4 v[196:199], v220, s[56:59], s83 offen sc1
    s_waitcnt lgkmcnt(0)
    v_bfi_b32 v200, s66, v187, v200
    v_bfi_b32 v201, s66, v187, v201
    v_bfi_b32 v202, s66, v187, v202
    v_bfi_b32 v203, s66, v187, v203
    buffer_store_dwordx4 v[200:203], v220, s[56:59], s84 offen sc1
    s_mov_b32 s10, 0xbfb8aa3b
    s_mov_b32 s11, s10
    s_mov_b32 s64, 0x05040100
    s_mov_b32 s66, 0x07060302
    s_waitcnt vmcnt(6)
    v_perm_b32 v112, v170, v168, s64
    v_perm_b32 v113, v170, v168, s66
    v_perm_b32 v114, v171, v169, s64
    v_perm_b32 v115, v171, v169, s66
    v_add_u32 v116, 20480, v224
    ds_write2_b32 v116, v112, v113 offset0:0 offset1:8
    ds_write2_b32 v116, v114, v115 offset0:16 offset1:24
    v_lshlrev_b32 v96, 16, v160
    v_and_b32 v97, 0xffff0000, v160
    v_lshlrev_b32 v98, 16, v161
    v_and_b32 v99, 0xffff0000, v161
    v_lshlrev_b32 v100, 16, v162
    v_and_b32 v101, 0xffff0000, v162
    v_lshlrev_b32 v102, 16, v163
    v_and_b32 v103, 0xffff0000, v163
    v_pk_mul_f32 v[96:97], v[96:97], s[10:11]
    v_pk_mul_f32 v[98:99], v[98:99], s[10:11]
    v_pk_mul_f32 v[100:101], v[100:101], s[10:11]
    v_pk_mul_f32 v[102:103], v[102:103], s[10:11]
    v_cvt_pk_bf16_f32 v104, v96, v100
    v_cvt_pk_bf16_f32 v105, v97, v101
    v_cvt_pk_bf16_f32 v106, v98, v102
    v_cvt_pk_bf16_f32 v107, v99, v103
    ds_write2_b32 v224, v104, v105 offset0:0 offset1:8
    ds_write2_b32 v224, v106, v107 offset0:16 offset1:24
    v_perm_b32 v120, v166, v164, s64
    v_perm_b32 v121, v166, v164, s66
    v_perm_b32 v122, v167, v165, s64
    v_perm_b32 v123, v167, v165, s66
    v_add_u32 v124, 10240, v224
    ds_write2_b32 v124, v120, v121 offset0:0 offset1:8
    ds_write2_b32 v124, v122, v123 offset0:16 offset1:24
    s_cmp_ge_u32 s3, 2
    s_cbranch_scc1 L_NOWC
    v_lshlrev_b32 v96, 16, v176
    v_and_b32 v97, 0xffff0000, v176
    v_lshlrev_b32 v98, 16, v177
    v_and_b32 v99, 0xffff0000, v177
    v_lshlrev_b32 v100, 16, v178
    v_and_b32 v101, 0xffff0000, v178
    v_lshlrev_b32 v102, 16, v179
    v_and_b32 v103, 0xffff0000, v179
    v_pk_mul_f32 v[96:97], v[96:97], s[10:11]
    v_pk_mul_f32 v[98:99], v[98:99], s[10:11]
    v_pk_mul_f32 v[100:101], v[100:101], s[10:11]
    v_pk_mul_f32 v[102:103], v[102:103], s[10:11]
    v_cvt_pk_bf16_f32 v104, v96, v100
    v_cvt_pk_bf16_f32 v105, v97, v101
    v_cvt_pk_bf16_f32 v106, v98, v102
    v_cvt_pk_bf16_f32 v107, v99, v103
    v_add_u32 v108, 140416, v224
    ds_write2_b32 v108, v104, v105 offset0:0 offset1:8
    ds_write2_b32 v108, v106, v107 offset0:16 offset1:24
L_NOWC:
    s_mul_i32 s34, s5, 32896
    s_add_u32 s34, s34, 65536
    s_add_u32 s56, s38, s34
    s_addc_u32 s57, s39, 0
    s_mov_b32 s58, 32768
    s_mov_b32 s59, 0x20000
    s_lshr_b32 s34, s5, 1
    s_mul_i32 s34, s34, 32896
    s_and_b32 s35, s5, 1
    s_lshl_b32 s35, s35, 6
    s_add_u32 s34, s34, s35
    s_add_u32 s34, s34, 8486912
    s_add_u32 s60, s38, s34
    s_addc_u32 s61, s39, 0
    s_mov_b32 s62, 32704
    s_mov_b32 s63, 0x20000
    v_lshrrev_b32 v233, 1, v243
    v_lshl_add_u32 v233, v223, 5, v233
    s_movk_i32 s26, 8192
    s_movk_i32 s27, 16384
    s_movk_i32 s28, 24576
    s_waitcnt lgkmcnt(0)
    s_barrier
    global_load_dwordx4 v[92:95], v232, s[30:31]
    s_cmp_eq_u32 s3, 7
    s_cbranch_scc1 L_NOO4
    s_cmp_eq_u32 s3, 6
    s_cselect_b32 exec_hi, 0, -1
    s_add_u32 m0, s101, 0
    s_nop 0
    buffer_load_dwordx4 v234, s[40:43], 0 offen offset:0 lds
    s_add_u32 m0, s101, 6560
    s_nop 0
    buffer_load_dwordx4 v234, s[40:43], 0 offen offset:128 lds
    s_add_u32 m0, s101, 13120
    s_nop 0
    buffer_load_dwordx4 v234, s[40:43], 0 offen offset:256 lds
    s_add_u32 m0, s101, 19680
    s_nop 0
    buffer_load_dwordx4 v234, s[40:43], 0 offen offset:384 lds
    s_mov_b32 exec_hi, -1
L_NOO4:
    v_add_u32 v225, 13312, v225
    ds_read_b64_tr_b16 v[96:97], v225 offset:20480
    ds_read_b64_tr_b16 v[98:99], v225 offset:21760
    ds_read_b64_tr_b16 v[100:101], v225 offset:25600
    ds_read_b64_tr_b16 v[102:103], v225 offset:26880
    ds_read_b64_tr_b16 v[104:105], v225 offset:20512
    ds_read_b64_tr_b16 v[106:107], v225 offset:21792
    ds_read_b64_tr_b16 v[108:109], v225 offset:25632
    ds_read_b64_tr_b16 v[110:111], v225 offset:26912
    ds_read_b64_tr_b16 v[112:113], v225 offset:20544
    ds_read_b64_tr_b16 v[114:115], v225 offset:21824
    ds_read_b64_tr_b16 v[116:117], v225 offset:25664
    ds_read_b64_tr_b16 v[118:119], v225 offset:26944
    ds_read_b64_tr_b16 v[120:121], v225 offset:20576
    ds_read_b64_tr_b16 v[122:123], v225 offset:21856
    v_and_b32 v88, 7, v253
    s_lshl_b32 s10, s14, 16
    v_lshl_add_u32 v80, v88, 23, s10
    v_add_u32 v81, 0x200000, v80
    v_add_u32 v82, 0x400000, v80
    v_add_u32 v83, 0x600000, v80
    v_mov_b32 v84, 0x20fffff
    v_mov_b32 v85, 0x20fffff
    v_mov_b32 v86, 0x20fffff
    v_mov_b32 v87, 0x20fffff
    v_lshl_add_u32 v88, v253, 4, s12
    ds_write_b128 v88, v[80:83] offset:0
    ds_write_b128 v88, v[84:87] offset:18432
    ds_write_b128 v88, v[80:83] offset:1024
    ds_write_b128 v88, v[84:87] offset:19456
    ds_write_b128 v88, v[80:83] offset:1280
    ds_write_b128 v88, v[84:87] offset:19712
    ds_read_b64_tr_b16 v[124:125], v225 offset:25696
    ds_read_b64_tr_b16 v[126:127], v225 offset:26976
    ds_read_b64_tr_b16 v[0:1], v225 offset:0
    ds_read_b64_tr_b16 v[2:3], v225 offset:1280
    ds_read_b64_tr_b16 v[4:5], v225 offset:5120
    ds_read_b64_tr_b16 v[6:7], v225 offset:6400
    ds_read_b64_tr_b16 v[8:9], v225 offset:32
    ds_read_b64_tr_b16 v[10:11], v225 offset:1312
    ds_read_b64_tr_b16 v[12:13], v225 offset:5152
    ds_read_b64_tr_b16 v[14:15], v225 offset:6432
    ds_read_b64_tr_b16 v[16:17], v225 offset:64
    ds_read_b64_tr_b16 v[18:19], v225 offset:1344
    ds_read_b64_tr_b16 v[20:21], v225 offset:5184
    ds_read_b64_tr_b16 v[22:23], v225 offset:6464
    ds_read_b64_tr_b16 v[24:25], v225 offset:96
    ds_read_b64_tr_b16 v[26:27], v225 offset:1376
    ds_read_b64_tr_b16 v[28:29], v225 offset:5216
    ds_read_b64_tr_b16 v[30:31], v225 offset:6496
    v_subrev_u32 v194, s13, v244
    s_movk_i32 s34, 704
    v_mad_u32_u24 v194, v246, s34, v194
    v_add_u32 v194, s101, v194
    v_and_b32 v192, 15, v253
    v_mul_u32_u24 v192, 152, v192
    v_lshrrev_b32 v193, 4, v253
    v_lshl_add_u32 v192, v193, 3, v192
    s_mul_i32 s34, s3, 4864
    s_add_u32 s34, s34, 82944
    v_add_u32 v192, s34, v192
    v_lshrrev_b32 v176, 4, v243
    v_lshrrev_b32 v190, 2, v223
    v_mul_u32_u24 v156, 3128, v190
    v_add_u32 v157, 200192, v156
    v_add_u32 v158, 400384, v156
    v_add_u32 v159, 600576, v156
    s_mov_b32 s98, 0xa0a0a0a
    s_mov_b32 s99, 0xa0a0a0a
    v_mov_b32 v191, 0xfffff
    v_cndmask_b32 v177, 0, v191, s[98:99]
    v_and_b32 v178, -32, v232
    v_add_u32 v178, 13312, v178
    v_mov_b32 v184, 4
    v_and_b32 v179, 31, v253
    v_add_u32 v179, s7, v179
    v_lshlrev_b32 v181, 2, v179
    v_lshrrev_b32 v191, 5, v253
    v_lshl_add_u32 v180, v191, 11, v181
    v_add_u32 v181, 156288, v181
    v_mov_b32 v237, s78
    v_cndmask_b32 v237, v186, v237, s[74:75]
    v_mov_b32 v191, 0xf000ffff
    v_cndmask_b32 v236, v236, v191, s[74:75]
    s_not_b64 s[32:33], s[74:75]
    s_waitcnt lgkmcnt(4)
    ds_read_b64_tr_b16 v[32:33], v225 offset:10240
    ds_read_b64_tr_b16 v[34:35], v225 offset:11520
    ds_read_b64_tr_b16 v[36:37], v225 offset:15360
    ds_read_b64_tr_b16 v[38:39], v225 offset:16640
    ds_read_b64_tr_b16 v[40:41], v225 offset:10272
    ds_read_b64_tr_b16 v[42:43], v225 offset:11552
    ds_read_b64_tr_b16 v[44:45], v225 offset:15392
    ds_read_b64_tr_b16 v[46:47], v225 offset:16672
    ds_read_b64_tr_b16 v[48:49], v225 offset:10304
    ds_read_b64_tr_b16 v[50:51], v225 offset:11584
    ds_read_b64_tr_b16 v[52:53], v225 offset:15424
    ds_read_b64_tr_b16 v[54:55], v225 offset:16704
    ds_read_b64_tr_b16 v[56:57], v225 offset:10336
    ds_read_b64_tr_b16 v[58:59], v225 offset:11616
    ds_read_b64_tr_b16 v[60:61], v225 offset:15456
    ds_read_b64_tr_b16 v[62:63], v225 offset:16736
    s_movk_i32 s18, 0xfff0
    s_and_b32 s18, s18, 0xffff
    s_movk_i32 s20, 39
    s_mov_b32 s21, 0
    s_mov_b32 s100, 0
    s_mov_b32 s16, 0x801f0000
    s_mov_b32 s17, 0xf000f000
    s_mul_i32 s10, s4, 49
    s_sub_i32 s22, s10, 7
    s_ashr_i32 s22, s22, 1
    s_add_i32 s23, s10, 8
    s_ashr_i32 s23, s23, 1
    s_add_i32 s24, s10, 42
    s_ashr_i32 s24, s24, 1
    s_add_i32 s25, s22, 32
    s_cmp_eq_u32 s4, 7
    s_cselect_b32 s24, 196, s24
    s_cselect_b32 s25, 196, s25
    s_waitcnt vmcnt(0)
    ds_read_b128 v[160:163], v194 offset:0
    ds_read_b128 v[164:167], v194 offset:64
    ds_read_b128 v[168:171], v194 offset:512
    ds_read_b128 v[172:175], v194 offset:576
    v_perm_b32 v80, v94, v92, s64
    v_perm_b32 v81, v94, v92, s66
    v_perm_b32 v82, v95, v93, s64
    v_perm_b32 v83, v95, v93, s66
    v_add_u32 v84, 130176, v224
    ds_write2_b32 v84, v80, v81 offset0:0 offset1:8
    ds_write2_b32 v84, v82, v83 offset0:16 offset1:24
    s_mov_b32 s10, 0xbfb8aa3b
    s_mov_b32 s11, s10
    s_cmp_eq_u32 s3, 7
    s_cbranch_scc1 L_NOA
    s_waitcnt lgkmcnt(2)
    v_mfma_f32_16x16x32_bf16 v[204:207], v[96:99], v[160:163], 0
    v_mfma_f32_16x16x32_bf16 v[208:211], v[104:107], v[160:163], 0
    v_mfma_f32_16x16x32_bf16 v[212:215], v[112:115], v[160:163], 0
    v_mfma_f32_16x16x32_bf16 v[216:219], v[120:123], v[160:163], 0
    v_mfma_f32_16x16x32_bf16 v[204:207], v[100:103], v[164:167], v[204:207]
    v_mfma_f32_16x16x32_bf16 v[208:211], v[108:111], v[164:167], v[208:211]
    v_mfma_f32_16x16x32_bf16 v[212:215], v[116:119], v[164:167], v[212:215]
    v_mfma_f32_16x16x32_bf16 v[216:219], v[124:127], v[164:167], v[216:219]
    v_mfma_f32_16x16x32_bf16 v[64:67], v[96:99], v[168:171], 0
    v_mfma_f32_16x16x32_bf16 v[68:71], v[104:107], v[168:171], 0
    v_mfma_f32_16x16x32_bf16 v[72:75], v[112:115], v[168:171], 0
    v_mfma_f32_16x16x32_bf16 v[76:79], v[120:123], v[168:171], 0
    v_mfma_f32_16x16x32_bf16 v[64:67], v[100:103], v[172:175], v[64:67]
    v_mfma_f32_16x16x32_bf16 v[68:71], v[108:111], v[172:175], v[68:71]
    v_mfma_f32_16x16x32_bf16 v[72:75], v[116:119], v[172:175], v[72:75]
    v_mfma_f32_16x16x32_bf16 v[76:79], v[124:127], v[172:175], v[76:79]
    v_pk_mul_f32 v[204:205], v[204:205], s[10:11]
    v_pk_mul_f32 v[206:207], v[206:207], s[10:11]
    v_pk_mul_f32 v[208:209], v[208:209], s[10:11]
    v_pk_mul_f32 v[210:211], v[210:211], s[10:11]
    v_pk_mul_f32 v[212:213], v[212:213], s[10:11]
    v_pk_mul_f32 v[214:215], v[214:215], s[10:11]
    v_pk_mul_f32 v[216:217], v[216:217], s[10:11]
    v_pk_mul_f32 v[218:219], v[218:219], s[10:11]
    v_cvt_pk_bf16_f32 v204, v204, v205
    v_cvt_pk_bf16_f32 v205, v206, v207
    v_cvt_pk_bf16_f32 v206, v208, v209
    v_cvt_pk_bf16_f32 v207, v210, v211
    v_cvt_pk_bf16_f32 v208, v212, v213
    v_cvt_pk_bf16_f32 v209, v214, v215
    v_cvt_pk_bf16_f32 v210, v216, v217
    v_cvt_pk_bf16_f32 v211, v218, v219
    ds_write_b64 v192, v[204:205] offset:0
    ds_write_b64 v192, v[206:207] offset:32
    ds_write_b64 v192, v[208:209] offset:64
    ds_write_b64 v192, v[210:211] offset:96
    s_cmp_eq_u32 s3, 6
    s_cbranch_scc1 L_NOA
    v_pk_mul_f32 v[64:65], v[64:65], s[10:11]
    v_pk_mul_f32 v[66:67], v[66:67], s[10:11]
    v_pk_mul_f32 v[68:69], v[68:69], s[10:11]
    v_pk_mul_f32 v[70:71], v[70:71], s[10:11]
    v_pk_mul_f32 v[72:73], v[72:73], s[10:11]
    v_pk_mul_f32 v[74:75], v[74:75], s[10:11]
    v_pk_mul_f32 v[76:77], v[76:77], s[10:11]
    v_pk_mul_f32 v[78:79], v[78:79], s[10:11]
    v_cvt_pk_bf16_f32 v64, v64, v65
    v_cvt_pk_bf16_f32 v65, v66, v67
    v_cvt_pk_bf16_f32 v66, v68, v69
    v_cvt_pk_bf16_f32 v67, v70, v71
    v_cvt_pk_bf16_f32 v68, v72, v73
    v_cvt_pk_bf16_f32 v69, v74, v75
    v_cvt_pk_bf16_f32 v70, v76, v77
    v_cvt_pk_bf16_f32 v71, v78, v79
    ds_write_b64 v192, v[64:65] offset:2432
    ds_write_b64 v192, v[66:67] offset:2464
    ds_write_b64 v192, v[68:69] offset:2496
    ds_write_b64 v192, v[70:71] offset:2528
L_NOA:
    buffer_load_dwordx4 v[128:131], v232, s[56:59], 0 offen sc1
    buffer_load_dwordx2 v[144:145], v233, s[60:63], 0 offen sc1
    buffer_load_dwordx4 v[132:135], v232, s[56:59], s26 offen sc1
    buffer_load_dwordx2 v[146:147], v233, s[60:63], s26 offen sc1
    buffer_load_dwordx4 v[136:139], v232, s[56:59], s27 offen sc1
    buffer_load_dwordx2 v[148:149], v233, s[60:63], s27 offen sc1
    buffer_load_dwordx4 v[140:143], v232, s[56:59], s28 offen sc1
    buffer_load_dwordx2 v[150:151], v233, s[60:63], s28 offen sc1
    s_waitcnt vmcnt(6)
    v_xor_b32 v128, v128, v237
    v_xor_b32 v129, v129, v186
    v_xor_b32 v130, v130, v186
    v_xor_b32 v131, v131, v186
    v_xor_b32 v144, v144, v187
    v_xor_b32 v145, v145, v187
    v_or3_b32 v188, v129, v130, v131
    v_or_b32 v189, v144, v145
    v_and_b32 v190, v128, v236
    v_and_or_b32 v190, v188, s16, v190
    v_and_or_b32 v190, v189, s17, v190
    v_cmp_ne_u32 s[64:65], 0, v190
    s_waitcnt vmcnt(4)
    v_xor_b32 v132, v132, v237
    v_xor_b32 v133, v133, v186
    v_xor_b32 v134, v134, v186
    v_xor_b32 v135, v135, v186
    v_xor_b32 v146, v146, v187
    v_xor_b32 v147, v147, v187
    v_or3_b32 v188, v133, v134, v135
    v_or_b32 v189, v146, v147
    v_and_b32 v190, v132, v236
    v_and_or_b32 v190, v188, s16, v190
    v_and_or_b32 v190, v189, s17, v190
    v_cmp_ne_u32 s[66:67], 0, v190
    s_waitcnt vmcnt(2)
    v_xor_b32 v136, v136, v237
    v_xor_b32 v137, v137, v186
    v_xor_b32 v138, v138, v186
    v_xor_b32 v139, v139, v186
    v_xor_b32 v148, v148, v187
    v_xor_b32 v149, v149, v187
    v_or3_b32 v188, v137, v138, v139
    v_or_b32 v189, v148, v149
    v_and_b32 v190, v136, v236
    v_and_or_b32 v190, v188, s16, v190
    v_and_or_b32 v190, v189, s17, v190
    v_cmp_ne_u32 s[68:69], 0, v190
    s_waitcnt vmcnt(0)
    v_xor_b32 v140, v140, v237
    v_xor_b32 v141, v141, v186
    v_xor_b32 v142, v142, v186
    v_xor_b32 v143, v143, v186
    v_xor_b32 v150, v150, v187
    v_xor_b32 v151, v151, v187
    v_or3_b32 v188, v141, v142, v143
    v_or_b32 v189, v150, v151
    v_and_b32 v190, v140, v236
    v_and_or_b32 v190, v188, s16, v190
    v_and_or_b32 v190, v189, s17, v190
    v_cmp_ne_u32 s[70:71], 0, v190
L_POLL:
    s_or_b64 s[10:11], s[64:65], s[66:67]
    s_or_b64 s[10:11], s[10:11], s[68:69]
    s_or_b64 s[10:11], s[10:11], s[70:71]
    s_cbranch_scc1 L_RETRY
    v_mov_b32_dpp v152, v128 row_newbcast:0 row_mask:0xf bank_mask:0x3
    v_mov_b32_dpp v152, v128 row_newbcast:8 row_mask:0xf bank_mask:0xc
    v_lshrrev_b32 v96, 19, v128
    v_lshrrev_b32 v97, 19, v129
    v_lshrrev_b32 v98, 19, v130
    v_sub_u32_sdwa v188, v152, v176 dst_sel:DWORD dst_unused:UNUSED_PAD src0_sel:WORD_1 src1_sel:DWORD
    v_cmp_lt_i32 s[64:65], 0, v188
    v_cmp_lt_i32 s[66:67], 8, v188
    v_cmp_lt_i32 s[68:69], 16, v188
    v_cmp_lt_i32 s[70:71], 24, v188
    s_and_b64 s[64:65], s[64:65], s[32:33]
    s_mov_b64 exec, s[64:65]
    ds_add_rtn_u32 v112, v96, v184 offset:1024
    s_mov_b64 exec, s[66:67]
    ds_add_rtn_u32 v113, v97, v184 offset:1024
    s_mov_b64 exec, s[68:69]
    ds_add_rtn_u32 v114, v98, v184 offset:1024
    s_mov_b64 exec, -1
    v_mov_b32_dpp v153, v132 row_newbcast:0 row_mask:0xf bank_mask:0x3
    v_mov_b32_dpp v153, v132 row_newbcast:8 row_mask:0xf bank_mask:0xc
    v_lshrrev_b32 v100, 19, v132
    v_lshrrev_b32 v101, 19, v133
    v_lshrrev_b32 v102, 19, v134
    v_sub_u32_sdwa v188, v153, v176 dst_sel:DWORD dst_unused:UNUSED_PAD src0_sel:WORD_1 src1_sel:DWORD
    v_cmp_lt_i32 s[72:73], 0, v188
    v_cmp_lt_i32 s[74:75], 8, v188
    v_cmp_lt_i32 s[76:77], 16, v188
    v_cmp_lt_i32 s[78:79], 24, v188
    s_and_b64 s[72:73], s[72:73], s[32:33]
    s_mov_b64 exec, s[72:73]
    ds_add_rtn_u32 v116, v100, v184 offset:1024
    s_mov_b64 exec, s[74:75]
    ds_add_rtn_u32 v117, v101, v184 offset:1024
    s_mov_b64 exec, s[76:77]
    ds_add_rtn_u32 v118, v102, v184 offset:1024
    s_mov_b64 exec, -1
    v_mov_b32_dpp v154, v136 row_newbcast:0 row_mask:0xf bank_mask:0x3
    v_mov_b32_dpp v154, v136 row_newbcast:8 row_mask:0xf bank_mask:0xc
    v_lshrrev_b32 v104, 19, v136
    v_lshrrev_b32 v105, 19, v137
    v_lshrrev_b32 v106, 19, v138
    v_sub_u32_sdwa v188, v154, v176 dst_sel:DWORD dst_unused:UNUSED_PAD src0_sel:WORD_1 src1_sel:DWORD
    v_cmp_lt_i32 s[80:81], 0, v188
    v_cmp_lt_i32 s[82:83], 8, v188
    v_cmp_lt_i32 s[84:85], 16, v188
    v_cmp_lt_i32 s[86:87], 24, v188
    s_and_b64 s[80:81], s[80:81], s[32:33]
    s_mov_b64 exec, s[80:81]
    ds_add_rtn_u32 v120, v104, v184 offset:1024
    s_mov_b64 exec, s[82:83]
    ds_add_rtn_u32 v121, v105, v184 offset:1024
    s_mov_b64 exec, s[84:85]
    ds_add_rtn_u32 v122, v106, v184 offset:1024
    s_mov_b64 exec, -1
    v_mov_b32_dpp v155, v140 row_newbcast:0 row_mask:0xf bank_mask:0x3
    v_mov_b32_dpp v155, v140 row_newbcast:8 row_mask:0xf bank_mask:0xc
    v_lshrrev_b32 v108, 19, v140
    v_lshrrev_b32 v109, 19, v141
    v_lshrrev_b32 v110, 19, v142
    v_sub_u32_sdwa v188, v155, v176 dst_sel:DWORD dst_unused:UNUSED_PAD src0_sel:WORD_1 src1_sel:DWORD
    v_cmp_lt_i32 s[88:89], 0, v188
    v_cmp_lt_i32 s[90:91], 8, v188
    v_cmp_lt_i32 s[92:93], 16, v188
    v_cmp_lt_i32 s[94:95], 24, v188
    s_and_b64 s[88:89], s[88:89], s[32:33]
    s_mov_b64 exec, s[88:89]
    ds_add_rtn_u32 v124, v108, v184 offset:1024
    s_mov_b64 exec, s[90:91]
    ds_add_rtn_u32 v125, v109, v184 offset:1024
    s_mov_b64 exec, s[92:93]
    ds_add_rtn_u32 v126, v110, v184 offset:1024
    s_mov_b64 exec, -1
    s_or_b64 s[96:97], s[70:71], s[78:79]
    s_or_b64 s[96:97], s[96:97], s[86:87]
    s_or_b64 s[96:97], s[96:97], s[94:95]
    s_cbranch_scc1 L_J3A
L_J3AR:
    s_mov_b32 s16, 0x1e00000
    v_add_u32_sdwa v204, v144, v156 dst_sel:DWORD dst_unused:UNUSED_PAD src0_sel:WORD_0 src1_sel:DWORD
    v_add_u32_sdwa v205, v144, v156 dst_sel:DWORD dst_unused:UNUSED_PAD src0_sel:WORD_1 src1_sel:DWORD
    v_add_u32_sdwa v206, v145, v156 dst_sel:DWORD dst_unused:UNUSED_PAD src0_sel:WORD_0 src1_sel:DWORD
    v_and_or_b32 v204, v128, s16, v204
    v_and_or_b32 v205, v129, s16, v205
    v_and_or_b32 v206, v130, s16, v206
    s_waitcnt lgkmcnt(0)
    s_barrier
    ds_read_b128 v[160:163], v185 offset:1024
    ds_read_b128 v[164:167], v185 offset:2048
    ds_read_b128 v[168:171], v185 offset:3072
    ds_read_b128 v[172:175], v185 offset:4096
    ds_read_u16 v198, v180 offset:1024
    ds_read_u16 v201, v180 offset:2048
    v_mov_b32_dpp v240, v144 quad_perm:[1,1,3,3] row_mask:0xf bank_mask:0xf
    s_lshl_b32 m0, s3, 10
    s_and_b64 vcc, s[64:65], s[98:99]
    v_add_u32_sdwa v240, v240, v156 dst_sel:DWORD dst_unused:UNUSED_PAD src0_sel:WORD_0 src1_sel:DWORD
    s_add_u32 m0, m0, 13312
    s_lshr_b64 exec, vcc, 1
    s_or_b64 exec, exec, vcc
    buffer_load_dwordx4 v[240:241], s[44:47], 0 idxen offen lds
    s_mov_b64 exec, -1
    s_cmp_lg_u32 s2, 0
    s_cbranch_scc1 L_NOK
    v_mov_b32 v199, s6
    v_mov_b32 v200, 0
    buffer_store_dword v199, v200, s[52:55], 0 offen sc1
L_NOK:
    s_waitcnt lgkmcnt(0)
    v_add_u32_sdwa v188, v160, v164 dst_sel:DWORD dst_unused:UNUSED_PAD src0_sel:WORD_0 src1_sel:WORD_0
    v_add_u32_sdwa v192, v168, v172 dst_sel:DWORD dst_unused:UNUSED_PAD src0_sel:WORD_0 src1_sel:WORD_0
    v_add_u32_sdwa v189, v161, v165 dst_sel:DWORD dst_unused:UNUSED_PAD src0_sel:WORD_0 src1_sel:WORD_0
    v_add_u32_sdwa v193, v169, v173 dst_sel:DWORD dst_unused:UNUSED_PAD src0_sel:WORD_0 src1_sel:WORD_0
    v_add_u32_sdwa v190, v162, v166 dst_sel:DWORD dst_unused:UNUSED_PAD src0_sel:WORD_0 src1_sel:WORD_0
    v_add_u32_sdwa v194, v170, v174 dst_sel:DWORD dst_unused:UNUSED_PAD src0_sel:WORD_0 src1_sel:WORD_0
    v_add_u32_sdwa v191, v163, v167 dst_sel:DWORD dst_unused:UNUSED_PAD src0_sel:WORD_0 src1_sel:WORD_0
    v_add_u32_sdwa v195, v171, v175 dst_sel:DWORD dst_unused:UNUSED_PAD src0_sel:WORD_0 src1_sel:WORD_0
    v_add_u32 v188, v188, v192
    v_add_u32 v189, v189, v193
    v_add_u32 v190, v190, v194
    v_add_u32 v191, v191, v195
    v_lshl_or_b32 v198, v201, 16, v198
    v_add_u32 v193, v188, v189
    v_add_u32 v194, v193, v190
    v_add_u32 v195, v194, v191
    v_mov_b32 v196, v195
    v_add_u32 v189, v188, v193
    v_add_u32 v190, v193, v194
    v_add_u32_dpp v196, v196, v196 row_shr:1 row_mask:0xf bank_mask:0xf bound_ctrl:0
    v_add_u32 v191, v194, v195
    v_or_b32 v204, v204, v177
    v_add_u32_dpp v196, v196, v196 row_shr:2 row_mask:0xf bank_mask:0xf bound_ctrl:0
    v_add_u32_sdwa v208, v146, v157 dst_sel:DWORD dst_unused:UNUSED_PAD src0_sel:WORD_0 src1_sel:DWORD
    v_add_u32_sdwa v209, v146, v157 dst_sel:DWORD dst_unused:UNUSED_PAD src0_sel:WORD_1 src1_sel:DWORD
    v_add_u32_dpp v196, v196, v196 row_shr:4 row_mask:0xf bank_mask:0xf bound_ctrl:0
    v_add_u32_sdwa v210, v147, v157 dst_sel:DWORD dst_unused:UNUSED_PAD src0_sel:WORD_0 src1_sel:DWORD
    v_and_or_b32 v208, v132, s16, v208
    v_add_u32_dpp v196, v196, v196 row_shr:8 row_mask:0xf bank_mask:0xf bound_ctrl:0
    v_and_or_b32 v209, v133, s16, v209
    v_and_or_b32 v210, v134, s16, v210
    v_add_u32_dpp v196, v196, v196 row_bcast:15 row_mask:0xa bank_mask:0xf
    v_or_b32 v208, v208, v177
    v_add_u32_sdwa v212, v148, v158 dst_sel:DWORD dst_unused:UNUSED_PAD src0_sel:WORD_0 src1_sel:DWORD
    v_add_u32_dpp v196, v196, v196 row_bcast:31 row_mask:0xc bank_mask:0xf
    v_mov_b32_dpp v240, v146 quad_perm:[1,1,3,3] row_mask:0xf bank_mask:0xf
    s_lshl_b32 m0, s3, 10
    s_and_b64 vcc, s[72:73], s[98:99]
    v_add_u32_sdwa v240, v240, v157 dst_sel:DWORD dst_unused:UNUSED_PAD src0_sel:WORD_0 src1_sel:DWORD
    s_add_u32 m0, m0, 21504
    s_lshr_b64 exec, vcc, 1
    s_or_b64 exec, exec, vcc
    buffer_load_dwordx4 v[240:241], s[44:47], 0 idxen offen lds
    s_mov_b64 exec, -1
    v_sub_u32 v192, v196, v195
    v_readlane_b32 s10, v196, 63
    v_lshl_add_u32 v188, v192, 1, v188
    v_lshl_add_u32 v189, v192, 1, v189
    v_lshl_add_u32 v190, v192, 1, v190
    v_lshl_add_u32 v191, v192, 1, v191
    s_lshr_b32 s11, s10, 5
    s_add_u32 s11, s11, 16
    s_and_b32 s11, s11, -32
    s_sub_i32 s11, s11, 16
    s_lshl_b32 s11, s11, 3
    s_lshr_b32 s10, s10, 1
    s_lshr_b32 s8, s4, 1
    s_mul_i32 s8, s8, s10
    s_add_i32 s11, s11, s8
    s_add_i32 s10, s10, s8
    s_bitcmp1_b32 s4, 0
    s_cselect_b32 s31, s11, s8
    s_cselect_b32 s10, s10, s11
    s_mov_b32 s8, 0
    s_mov_b32 s9, 0
    v_cmp_gt_i32 vcc, s31, v188
    v_cmp_gt_i32 s[34:35], s10, v188
    s_bcnt1_i32_b64 s11, vcc
    s_add_u32 s8, s8, s11
    s_bcnt1_i32_b64 s11, s[34:35]
    s_add_u32 s9, s9, s11
    v_cmp_gt_i32 vcc, s31, v189
    v_cmp_gt_i32 s[34:35], s10, v189
    s_bcnt1_i32_b64 s11, vcc
    s_add_u32 s8, s8, s11
    s_bcnt1_i32_b64 s11, s[34:35]
    s_add_u32 s9, s9, s11
    v_cmp_gt_i32 vcc, s31, v190
    v_cmp_gt_i32 s[34:35], s10, v190
    s_bcnt1_i32_b64 s11, vcc
    s_add_u32 s8, s8, s11
    s_bcnt1_i32_b64 s11, s[34:35]
    s_add_u32 s9, s9, s11
    v_cmp_gt_i32 vcc, s31, v191
    v_cmp_gt_i32 s[34:35], s10, v191
    s_bcnt1_i32_b64 s11, vcc
    s_add_u32 s8, s8, s11
    s_bcnt1_i32_b64 s11, s[34:35]
    s_add_u32 s9, s9, s11
    s_max_i32 s8, s8, s22
    s_min_i32 s8, s8, s23
    s_max_i32 s9, s9, s24
    s_min_i32 s9, s9, s25
    v_cmp_le_u32 vcc, s8, v179
    v_cmp_gt_u32 s[10:11], s9, v179
    s_mov_b32 s19, 2
    s_and_b64 s[32:33], vcc, s[10:11]
    v_cndmask_b32 v198, 0, v198, s[32:33]
    v_mov_b32 v196, v198
    s_add_u32 s10, s8, 16
    s_sub_i32 s11, s9, 16
    v_cmp_gt_i32 s[22:23], s10, v179
    v_cmp_gt_i32 s[24:25], s11, v179
    v_add_u32_dpp v196, v196, v196 row_shr:1 row_mask:0xf bank_mask:0xf bound_ctrl:0
    v_add_u32_sdwa v213, v148, v158 dst_sel:DWORD dst_unused:UNUSED_PAD src0_sel:WORD_1 src1_sel:DWORD
    v_add_u32_sdwa v214, v149, v158 dst_sel:DWORD dst_unused:UNUSED_PAD src0_sel:WORD_0 src1_sel:DWORD
    v_add_u32_dpp v196, v196, v196 row_shr:2 row_mask:0xf bank_mask:0xf bound_ctrl:0
    v_and_or_b32 v212, v136, s16, v212
    v_and_or_b32 v213, v137, s16, v213
    v_add_u32_dpp v196, v196, v196 row_shr:4 row_mask:0xf bank_mask:0xf bound_ctrl:0
    v_and_or_b32 v214, v138, s16, v214
    v_or_b32 v212, v212, v177
    v_add_u32_dpp v196, v196, v196 row_shr:8 row_mask:0xf bank_mask:0xf bound_ctrl:0
    v_add_u32_sdwa v216, v150, v159 dst_sel:DWORD dst_unused:UNUSED_PAD src0_sel:WORD_0 src1_sel:DWORD
    v_add_u32_sdwa v217, v150, v159 dst_sel:DWORD dst_unused:UNUSED_PAD src0_sel:WORD_1 src1_sel:DWORD
    v_add_u32_dpp v196, v196, v196 row_bcast:15 row_mask:0xa bank_mask:0xf
    v_add_u32_sdwa v218, v151, v159 dst_sel:DWORD dst_unused:UNUSED_PAD src0_sel:WORD_0 src1_sel:DWORD
    v_and_or_b32 v216, v140, s16, v216
    v_and_or_b32 v217, v141, s16, v217
    v_and_or_b32 v218, v142, s16, v218
    v_or_b32 v216, v216, v177
    v_mov_b32_dpp v240, v148 quad_perm:[1,1,3,3] row_mask:0xf bank_mask:0xf
    s_lshl_b32 m0, s3, 10
    s_and_b64 vcc, s[80:81], s[98:99]
    v_add_u32_sdwa v240, v240, v158 dst_sel:DWORD dst_unused:UNUSED_PAD src0_sel:WORD_0 src1_sel:DWORD
    s_add_u32 m0, m0, 29696
    s_lshr_b64 exec, vcc, 1
    s_or_b64 exec, exec, vcc
    buffer_load_dwordx4 v[240:241], s[44:47], 0 idxen offen lds
    s_mov_b64 exec, -1
    v_sub_u32 v188, v196, v198
    v_add_u32_sdwa v190, v196, v196 dst_sel:DWORD dst_unused:UNUSED_PAD src0_sel:WORD_0 src1_sel:WORD_1
    v_add_u32_sdwa v189, v188, v188 dst_sel:DWORD dst_unused:UNUSED_PAD src0_sel:WORD_0 src1_sel:WORD_1
    v_add_u32_sdwa v191, v198, v198 dst_sel:DWORD dst_unused:UNUSED_PAD src0_sel:WORD_0 src1_sel:WORD_1
    v_readlane_b32 s27, v196, 31
    v_readlane_b32 s28, v196, 63
    v_permlane32_swap_b32 v189, v190
    s_nop 0
    v_add_u32 v189, v189, v190
    s_mov_b32 exec_hi, 0
    v_readlane_b32 s31, v189, 63
    v_add_u32 v189, v189, v191
    s_mov_b32 exec_hi, -1
    v_sub_u32_sdwa v191, v189, v198 dst_sel:DWORD dst_unused:UNUSED_PAD src0_sel:DWORD src1_sel:WORD_1
    s_add_u32 s10, s31, 255
    s_lshr_b32 s10, s10, 8
    s_lshl_b32 s10, s10, 7
    v_cmp_ge_u32 s[34:35], s10, v191
    v_cmp_ge_u32 s[36:37], s10, v189
    s_and_b64 s[34:35], s[34:35], s[22:23]
    s_and_b64 s[36:37], s[36:37], s[22:23]
    s_or_b64 s[34:35], s[34:35], s[24:25]
    s_or_b64 s[36:37], s[36:37], s[24:25]
    s_bcnt1_i32_b32 s24, s34
    s_add_u32 s10, s24, 63
    v_readlane_b32 s22, v196, s10
    s_cmp_eq_u32 s24, 0
    s_cselect_b32 s22, 0, s22
    s_and_b32 s22, s22, 0xffff
    s_bcnt1_i32_b32 s26, s36
    s_add_u32 s10, s26, 63
    v_readlane_b32 s23, v196, s10
    s_cmp_eq_u32 s26, 0
    s_cselect_b32 s23, 0, s23
    s_lshr_b32 s23, s23, 16
    s_bcnt1_i32_b32 s17, s35
    s_add_u32 s10, s17, 31
    v_readlane_b32 s29, v196, s10
    s_cmp_eq_u32 s17, 0
    s_cselect_b32 s29, 0, s29
    s_and_b32 s29, s29, 0xffff
    s_bcnt1_i32_b32 s25, s37
    s_add_u32 s10, s25, 31
    v_readlane_b32 s30, v196, s10
    s_cmp_eq_u32 s25, 0
    s_cselect_b32 s30, 0, s30
    s_lshr_b32 s30, s30, 16
    s_add_u32 s23, s23, s22
    s_add_u32 s29, s29, s23
    s_add_u32 s30, s30, s29
    s_sub_u32 s16, s12, 46080
    s_pack_ll_b32_b16 s16, s16, s16
    v_add_u32 v188, s16, v188
    s_and_b32 s10, s27, 0xffff
    s_lshr_b32 s11, s27, 16
    s_add_u32 s11, s11, s10
    s_and_b32 s28, s28, 0xffff
    s_add_u32 s28, s28, s11
    s_sub_u32 s27, 1152, s22
    s_sub_u32 s10, s10, s23
    s_sub_u32 s11, s11, s29
    s_sub_u32 s28, s28, s30
    s_add_u32 s10, s10, 1152
    s_add_u32 s11, s11, 1152
    s_add_u32 s28, s28, 1152
    s_lshl_b32 s10, s10, 16
    s_lshl_b32 s28, s28, 16
    s_lshl_b32 s22, s22, 16
    s_lshl_b32 s29, s29, 16
    s_mov_b32 exec_hi, 0
    s_not_b32 exec_lo, s34
    v_add_u32 v188, s27, v188
    s_mov_b32 exec_lo, s36
    v_add_u32 v188, s22, v188
    s_not_b32 exec_lo, s36
    v_add_u32 v188, s10, v188
    s_mov_b32 exec_lo, 0
    s_mov_b32 exec_hi, s35
    v_add_u32 v188, s23, v188
    s_not_b32 exec_hi, s35
    v_add_u32 v188, s11, v188
    s_mov_b32 exec_hi, s37
    v_add_u32 v188, s29, v188
    s_not_b32 exec_hi, s37
    v_add_u32 v188, s28, v188
    s_mov_b64 exec, s[32:33]
    ds_write_b16 v180, v188 offset:1026
    ds_write_b16_d16_hi v180, v188 offset:2050
    s_lshl_b32 s10, s4, 3
    v_cndmask_b32 v189, 4, 0, s[34:35]
    s_mov_b32 exec_hi, 0
    v_add_u32 v189, s10, v189
    ds_write_b32 v181, v189
    s_mov_b64 exec, -1
    v_mov_b32_dpp v240, v150 quad_perm:[1,1,3,3] row_mask:0xf bank_mask:0xf
    s_lshl_b32 m0, s3, 10
    s_and_b64 vcc, s[88:89], s[98:99]
    v_add_u32_sdwa v240, v240, v159 dst_sel:DWORD dst_unused:UNUSED_PAD src0_sel:WORD_0 src1_sel:DWORD
    s_add_u32 m0, m0, 37888
    s_lshr_b64 exec, vcc, 1
    s_or_b64 exec, exec, vcc
    buffer_load_dwordx4 v[240:241], s[44:47], 0 idxen offen lds
    s_mov_b64 exec, -1
    s_sub_u32 s31, s31, s30
    v_mov_b32 v197, 640
    s_max_u32 s10, s31, s30
    s_cmp_le_u32 s10, 1152
    s_cbranch_scc1 L_LFIT
    ds_write_b32 v197, v184
L_LFIT:
    s_add_u32 s10, s30, 127
    s_lshr_b32 s10, s10, 7
    s_lshl1_add_u32 s10, s10, -1
    s_add_u32 s11, s31, 127
    s_lshr_b32 s11, s11, 6
    s_and_b32 s11, s11, -2
    s_max_i32 s17, s10, s11
    s_add_u32 s24, s24, s7
    s_add_u32 s25, s25, s7
    s_min_u32 s24, s24, s9
    s_min_u32 s25, s25, s9
    s_min_u32 s22, s8, 192
    s_min_u32 s23, s25, 192
    s_cmp_lt_u32 s25, s24
    s_and_b32 s10, s25, 15
    s_cmp_lt_u32 s25, s24
    s_cselect_b32 s25, s10, 16
    v_and_b32 v192, 16, v253
    v_lshrrev_b32 v192, 1, v192
    v_bfe_u32 v193, v253, 2, 2
    v_add_u32 v192, v192, v193
    s_movk_i32 s10, 152
    v_add_u32 v193, 82944, v246
    s_sub_u32 s11, 0, s22
    v_add_u32 v199, s11, v192
    v_and_b32 v199, 15, v199
    v_add_u32 v199, s22, v199
    v_mad_u32_u24 v199, v199, s10, v193
    s_sub_u32 s11, 4, s22
    v_add_u32 v200, s11, v192
    v_and_b32 v200, 15, v200
    v_add_u32 v200, s22, v200
    v_mad_u32_u24 v200, v200, s10, v193
    s_sub_u32 s11, 0, s23
    v_add_u32 v201, s11, v192
    v_and_b32 v201, 15, v201
    v_add_u32 v201, s23, v201
    v_mad_u32_u24 v201, v201, s10, v193
    s_sub_u32 s11, 4, s23
    v_add_u32 v194, s11, v192
    v_and_b32 v194, 15, v194
    v_add_u32 v194, s23, v194
    v_mad_u32_u24 v194, v194, s10, v193
    s_mov_b32 exec_hi, 0
    v_add_u32 v199, 140416, v225
    v_add_u32 v200, 141696, v225
    v_add_u32 v201, 140416, v225
    v_add_u32 v194, 141696, v225
    s_mov_b32 exec_hi, -1
    s_waitcnt lgkmcnt(0)
    s_barrier
    ds_read_b64 v[202:203], v197
    s_mov_b64 exec, s[64:65]
    ds_read_u16 v96, v96 offset:1026
    s_mov_b64 exec, s[66:67]
    ds_read_u16 v97, v97 offset:1026
    s_mov_b64 exec, s[68:69]
    ds_read_u16 v98, v98 offset:1026
    s_mov_b64 exec, s[72:73]
    ds_read_u16 v100, v100 offset:1026
    s_mov_b64 exec, s[74:75]
    ds_read_u16 v101, v101 offset:1026
    s_mov_b64 exec, s[76:77]
    ds_read_u16 v102, v102 offset:1026
    s_mov_b64 exec, s[80:81]
    ds_read_u16 v104, v104 offset:1026
    s_mov_b64 exec, s[82:83]
    ds_read_u16 v105, v105 offset:1026
    s_mov_b64 exec, s[84:85]
    ds_read_u16 v106, v106 offset:1026
    s_mov_b64 exec, s[88:89]
    ds_read_u16 v108, v108 offset:1026
    s_mov_b64 exec, s[90:91]
    ds_read_u16 v109, v109 offset:1026
    s_mov_b64 exec, s[92:93]
    ds_read_u16 v110, v110 offset:1026
    s_mov_b64 exec, -1
    s_waitcnt lgkmcnt(12)
    v_cmp_ne_u32 vcc, 0, v202
    v_readfirstlane_b32 s19, v203
    s_cbranch_vccnz L_OVF
    s_waitcnt lgkmcnt(0)
    s_mov_b64 exec, s[64:65]
    v_add_u32 v96, v96, v112
    ds_write_b16 v96, v128 offset:46080
    ds_write_b32 v96, v204 offset:64512
    s_and_b64 exec, exec, s[98:99]
    ds_write_b16 v96, v178 offset:46082
    s_mov_b64 exec, s[66:67]
    v_add_u32 v97, v97, v113
    ds_write_b16 v97, v129 offset:46080
    ds_write_b32 v97, v205 offset:64512
    s_mov_b64 exec, s[68:69]
    v_add_u32 v98, v98, v114
    ds_write_b16 v98, v130 offset:46080
    ds_write_b32 v98, v206 offset:64512
    s_mov_b64 exec, -1
    v_add_u32 v178, 0x2000, v178
    ds_read_b64_tr_b16 v[64:65], v199 offset:0
    ds_read_b64_tr_b16 v[66:67], v200 offset:0
    ds_read_b64_tr_b16 v[68:69], v199 offset:32
    ds_read_b64_tr_b16 v[70:71], v200 offset:32
    s_mov_b64 exec, s[72:73]
    v_add_u32 v100, v100, v116
    ds_write_b16 v100, v132 offset:46080
    ds_write_b32 v100, v208 offset:64512
    s_and_b64 exec, exec, s[98:99]
    ds_write_b16 v100, v178 offset:46082
    s_mov_b64 exec, s[74:75]
    v_add_u32 v101, v101, v117
    ds_write_b16 v101, v133 offset:46080
    ds_write_b32 v101, v209 offset:64512
    s_mov_b64 exec, s[76:77]
    v_add_u32 v102, v102, v118
    ds_write_b16 v102, v134 offset:46080
    ds_write_b32 v102, v210 offset:64512
    s_mov_b64 exec, -1
    v_add_u32 v178, 0x2000, v178
    ds_read_b64_tr_b16 v[72:73], v199 offset:64
    ds_read_b64_tr_b16 v[74:75], v200 offset:64
    ds_read_b64_tr_b16 v[76:77], v199 offset:96
    ds_read_b64_tr_b16 v[78:79], v200 offset:96
    s_mov_b64 exec, s[80:81]
    v_add_u32 v104, v104, v120
    ds_write_b16 v104, v136 offset:46080
    ds_write_b32 v104, v212 offset:64512
    s_and_b64 exec, exec, s[98:99]
    ds_write_b16 v104, v178 offset:46082
    s_mov_b64 exec, s[82:83]
    v_add_u32 v105, v105, v121
    ds_write_b16 v105, v137 offset:46080
    ds_write_b32 v105, v213 offset:64512
    s_mov_b64 exec, s[84:85]
    v_add_u32 v106, v106, v122
    ds_write_b16 v106, v138 offset:46080
    ds_write_b32 v106, v214 offset:64512
    s_mov_b64 exec, -1
    v_add_u32 v178, 0x2000, v178
    ds_read_b64_tr_b16 v[80:81], v201 offset:0
    ds_read_b64_tr_b16 v[82:83], v194 offset:0
    ds_read_b64_tr_b16 v[84:85], v201 offset:32
    ds_read_b64_tr_b16 v[86:87], v194 offset:32
    s_mov_b64 exec, s[88:89]
    v_add_u32 v108, v108, v124
    ds_write_b16 v108, v140 offset:46080
    ds_write_b32 v108, v216 offset:64512
    s_and_b64 exec, exec, s[98:99]
    ds_write_b16 v108, v178 offset:46082
    s_mov_b64 exec, s[90:91]
    v_add_u32 v109, v109, v125
    ds_write_b16 v109, v141 offset:46080
    ds_write_b32 v109, v217 offset:64512
    s_mov_b64 exec, s[92:93]
    v_add_u32 v110, v110, v126
    ds_write_b16 v110, v142 offset:46080
    ds_write_b32 v110, v218 offset:64512
    s_mov_b64 exec, -1
    ds_read_b64_tr_b16 v[88:89], v201 offset:64
    ds_read_b64_tr_b16 v[90:91], v194 offset:64
    ds_read_b64_tr_b16 v[92:93], v201 offset:96
    ds_read_b64_tr_b16 v[94:95], v194 offset:96
    s_cmp_lg_u64 s[96:97], 0
    s_cbranch_scc1 L_J3B
L_J3BR:
    s_waitcnt vmcnt(0) lgkmcnt(0)
    s_barrier
    s_mov_b32 s10, 0x358637bd
    ds_read_b128 v[236:239], v247
    ds_read_b32 v240, v248
    v_lshrrev_b32 v188, 2, v253
    v_and_b32 v188, 12, v188
    v_subrev_u32 v188, s25, v188
    s_waitcnt lgkmcnt(0)
    s_add_u32 m0, s13, 0
    v_mad_u32_u16 v236, v236, s15, v243
    buffer_load_dwordx4 v236, s[40:43], 0 offen lds
    s_add_u32 m0, s13, 1056
    v_mad_u32_u16 v237, v237, s15, v243
    buffer_load_dwordx4 v237, s[40:43], 0 offen lds
    s_add_u32 m0, s13, 2112
    v_mad_u32_u16 v238, v238, s15, v243
    buffer_load_dwordx4 v238, s[40:43], 0 offen lds
    s_add_u32 m0, s13, 3168
    v_mad_u32_u16 v239, v239, s15, v243
    buffer_load_dwordx4 v239, s[40:43], 0 offen lds
    s_mov_b32 m0, s14
    v_and_b32 v240, 0xfffff, v240
    buffer_load_dwordx4 v[240:241], s[44:47], 0 idxen offen lds
    s_mov_b32 s11, s10
    v_mov_b32 v189, s10
    v_mov_b64 v[96:97], s[10:11]
    v_mov_b64 v[98:99], s[10:11]
    v_mov_b64 v[100:101], s[10:11]
    v_mov_b64 v[102:103], s[10:11]
    v_mov_b64 v[104:105], s[10:11]
    v_mov_b64 v[106:107], s[10:11]
    v_mov_b64 v[108:109], s[10:11]
    v_mov_b64 v[110:111], s[10:11]
    v_cmp_ne_u32 vcc, 0, v188
    v_mov_b64 v[112:113], 0
    v_mov_b64 v[114:115], 0
    v_cndmask_b32 v128, 0, v189, vcc
    v_cmp_ne_u32 vcc, -1, v188
    v_mov_b64 v[116:117], 0
    v_mov_b64 v[118:119], 0
    v_cndmask_b32 v129, 0, v189, vcc
    v_cmp_ne_u32 vcc, -2, v188
    v_mov_b64 v[120:121], 0
    v_mov_b64 v[122:123], 0
    v_cndmask_b32 v130, 0, v189, vcc
    v_cmp_ne_u32 vcc, -3, v188
    v_mov_b64 v[124:125], 0
    v_mov_b64 v[126:127], 0
    v_cndmask_b32 v131, 0, v189, vcc
    v_mov_b64 v[144:145], 0
    v_mov_b64 v[146:147], 0
    v_mov_b64 v[148:149], 0
    v_mov_b64 v[150:151], 0
    v_mov_b64 v[152:153], 0
    v_mov_b64 v[154:155], 0
    v_mov_b64 v[156:157], 0
    v_mov_b64 v[158:159], 0
    v_mov_b64 v[132:133], v[128:129]
    v_mov_b64 v[134:135], v[130:131]
    v_mov_b64 v[136:137], v[128:129]
    v_mov_b64 v[138:139], v[130:131]
    v_mov_b64 v[140:141], v[128:129]
    v_mov_b64 v[142:143], v[130:131]
    s_mov_b32 s26, -1
    s_mov_b64 s[32:33], 0
    s_mov_b32 s28, 0
    s_mov_b32 s29, 0
L_GO:
    ds_read_u16 v251, v249 offset:0
    ds_read_u16 v252, v249 offset:64
    ds_read_b128 v[236:239], v247 offset:1152
    ds_read_b32 v240, v248 offset:1152
    s_lshr_b32 s10, s4, 1
    s_lshl_b32 s10, s10, 8
    s_add_u32 s10, s10, 158336
    v_lshl_add_u32 v255, v253, 2, s10
    s_bitcmp1_b32 s4, 0
    s_cselect_b32 s101, -1, 1
    s_mul_i32 s10, s101, s17
    v_mov_b32 v253, s10
    ds_add_u32 v255, v253
    s_sub_i32 s10, 0, s101
    v_mov_b32 v253, s10
    v_mov_b64 v[204:205], 0
    v_mov_b64 v[206:207], 0
    v_mov_b64 v[208:209], 0
    v_mov_b64 v[210:211], 0
    v_mov_b64 v[212:213], 0
    v_mov_b64 v[214:215], 0
    v_mov_b64 v[216:217], 0
    v_mov_b64 v[218:219], 0
    v_mov_b64 v[220:221], 0
    v_mov_b64 v[222:223], 0
    v_mov_b64 v[224:225], 0
    v_mov_b64 v[226:227], 0
    v_mov_b64 v[228:229], 0
    v_mov_b64 v[230:231], 0
    v_mov_b64 v[232:233], 0
    v_mov_b64 v[234:235], 0
    v_mov_b64 v[184:185], 0
    v_mov_b64 v[186:187], 0
    s_waitcnt lgkmcnt(0)
    v_and_or_b32 v251, v251, s18, v245
    v_and_or_b32 v252, v252, s18, v245
    s_waitcnt vmcnt(0)
    ds_read_b128 v[176:179], v251
    ds_read_b128 v[180:183], v252
    ds_read_b128 v[160:163], v244 offset:0
    ds_read_b128 v[168:171], v244 offset:512
    ds_read_b128 v[164:167], v244 offset:64
    ds_read_b128 v[172:175], v244 offset:576
    s_cmp_lt_i32 s17, 1
    s_cbranch_scc1 L_DONE
    s_waitcnt lgkmcnt(4)
    v_mfma_f32_16x16x32_bf16 v[188:191], v[176:179], v[64:67], 0
    v_mfma_f32_16x16x32_bf16 v[196:199], v[176:179], v[68:71], 0
    v_mfma_f32_16x16x32_bf16 v[192:195], v[180:183], v[64:67], 0
    v_mfma_f32_16x16x32_bf16 v[200:203], v[180:183], v[68:71], 0
    s_waitcnt lgkmcnt(0)
    v_mfma_f32_16x16x32_bf16 v[188:191], v[160:163], v[0:3], v[188:191]
    v_mfma_f32_16x16x32_bf16 v[196:199], v[160:163], v[8:11], v[196:199]
    v_mfma_f32_16x16x32_bf16 v[192:195], v[168:171], v[0:3], v[192:195]
    v_mfma_f32_16x16x32_bf16 v[200:203], v[168:171], v[8:11], v[200:203]
    v_mfma_f32_16x16x32_bf16 v[188:191], v[164:167], v[4:7], v[188:191]
    v_mfma_f32_16x16x32_bf16 v[196:199], v[164:167], v[12:15], v[196:199]
    v_mfma_f32_16x16x32_bf16 v[192:195], v[172:175], v[4:7], v[192:195]
    v_mfma_f32_16x16x32_bf16 v[200:203], v[172:175], v[12:15], v[200:203]
    s_add_u32 m0, s13, 0
    v_mad_u32_u16 v236, v236, s15, v243
    buffer_load_dwordx4 v236, s[40:43], 0 offen lds
    s_add_u32 m0, s13, 1056
    v_mad_u32_u16 v237, v237, s15, v243
    buffer_load_dwordx4 v237, s[40:43], 0 offen lds
    s_add_u32 m0, s13, 2112
    v_mad_u32_u16 v238, v238, s15, v243
    buffer_load_dwordx4 v238, s[40:43], 0 offen lds
    s_add_u32 m0, s13, 3168
    v_mad_u32_u16 v239, v239, s15, v243
    buffer_load_dwordx4 v239, s[40:43], 0 offen lds
    s_mov_b32 m0, s14
    v_and_b32 v240, 0xfffff, v240
    buffer_load_dwordx4 v[240:241], s[44:47], 0 idxen offen lds
    s_mov_b32 s16, 1
.p2align 6
L_LOOP1:
    s_setprio 1
    v_smfmac_f32_16x16x64_bf16 v[152:155], v[184:187], v[204:211], v242
    ds_read_u16 v236, v250 offset:0
    ds_read_u16 v237, v250 offset:16
    ds_add_rtn_u32 v238, v255, v253
    v_exp_f32 v188, v188
    v_smfmac_f32_16x16x64_bf16 v[156:159], v[184:187], v[212:219], v242
    v_exp_f32 v189, v189
    v_mfma_f32_16x16x32_bf16 v[204:207], v[160:163], v[32:35], 0
    v_exp_f32 v190, v190
    v_mfma_f32_16x16x32_bf16 v[212:215], v[160:163], v[40:43], 0
    v_exp_f32 v191, v191
    v_mfma_f32_16x16x32_bf16 v[208:211], v[168:171], v[32:35], 0
    v_exp_f32 v192, v192
    v_mfma_f32_16x16x32_bf16 v[216:219], v[168:171], v[40:43], 0
    v_exp_f32 v193, v193
    v_mfma_f32_16x16x32_bf16 v[204:207], v[164:167], v[36:39], v[204:207]
    v_exp_f32 v194, v194
    v_mfma_f32_16x16x32_bf16 v[212:215], v[164:167], v[44:47], v[212:215]
    v_exp_f32 v195, v195
    v_mfma_f32_16x16x32_bf16 v[208:211], v[172:175], v[36:39], v[208:211]
    s_waitcnt lgkmcnt(0)
    v_and_or_b32 v236, v236, s18, v246
    v_and_or_b32 v237, v237, s18, v246
    v_readfirstlane_b32 s96, v238
    v_exp_f32 v196, v196
    v_mfma_f32_16x16x32_bf16 v[216:219], v[172:175], v[44:47], v[216:219]
    v_exp_f32 v197, v197
    v_smfmac_f32_16x16x64_bf16 v[136:139], v[184:187], v[220:227], v242
    v_exp_f32 v198, v198
    s_setprio 3
    v_smfmac_f32_16x16x64_bf16 v[140:143], v[184:187], v[228:235], v242
    v_exp_f32 v199, v199
    v_exp_f32 v200, v200
    v_exp_f32 v201, v201
    v_exp_f32 v202, v202
    v_exp_f32 v203, v203
    v_pk_add_f32 v[188:189], v[188:189], 1.0 op_sel_hi:[1,0]
    v_pk_add_f32 v[190:191], v[190:191], 1.0 op_sel_hi:[1,0]
    v_pk_add_f32 v[192:193], v[192:193], 1.0 op_sel_hi:[1,0]
    v_pk_add_f32 v[194:195], v[194:195], 1.0 op_sel_hi:[1,0]
    v_pk_add_f32 v[196:197], v[196:197], 1.0 op_sel_hi:[1,0]
    v_pk_add_f32 v[198:199], v[198:199], 1.0 op_sel_hi:[1,0]
    v_pk_add_f32 v[200:201], v[200:201], 1.0 op_sel_hi:[1,0]
    v_pk_add_f32 v[202:203], v[202:203], 1.0 op_sel_hi:[1,0]
    s_setprio 1
    v_mfma_f32_16x16x32_bf16 v[220:223], v[176:179], v[72:75], 0
    ds_read_b64_tr_b16 v[184:185], v236
    ds_read_b64_tr_b16 v[186:187], v237
    ds_read_u16 v251, v249 offset:1152
    ds_read_u16 v252, v249 offset:1216
    v_rcp_f32 v188, v188
    v_mfma_f32_16x16x32_bf16 v[228:231], v[176:179], v[76:79], 0
    s_mul_i32 s96, s96, s101
    v_rcp_f32 v189, v189
    v_mfma_f32_16x16x32_bf16 v[224:227], v[180:183], v[72:75], 0
    v_rcp_f32 v190, v190
    v_mfma_f32_16x16x32_bf16 v[232:235], v[180:183], v[76:79], 0
    v_rcp_f32 v191, v191
    v_mfma_f32_16x16x32_bf16 v[220:223], v[160:163], v[16:19], v[220:223]
    v_rcp_f32 v192, v192
    v_mfma_f32_16x16x32_bf16 v[228:231], v[160:163], v[24:27], v[228:231]
    v_rcp_f32 v193, v193
    v_mfma_f32_16x16x32_bf16 v[224:227], v[168:171], v[16:19], v[224:227]
    s_waitcnt lgkmcnt(0)
    v_and_or_b32 v251, v251, s18, v245
    v_and_or_b32 v252, v252, s18, v245
    ds_read_b128 v[236:239], v247 offset:128
    ds_read_b32 v240, v248 offset:128
    s_add_u32 s16, s16, 1
    v_rcp_f32 v194, v194
    v_mfma_f32_16x16x32_bf16 v[232:235], v[168:171], v[24:27], v[232:235]
    v_rcp_f32 v195, v195
    v_mfma_f32_16x16x32_bf16 v[220:223], v[164:167], v[20:23], v[220:223]
    v_rcp_f32 v196, v196
    v_mfma_f32_16x16x32_bf16 v[228:231], v[164:167], v[28:31], v[228:231]
    v_rcp_f32 v197, v197
    v_mfma_f32_16x16x32_bf16 v[224:227], v[172:175], v[20:23], v[224:227]
    v_rcp_f32 v198, v198
    s_setprio 3
    v_mfma_f32_16x16x32_bf16 v[232:235], v[172:175], v[28:31], v[232:235]
    v_rcp_f32 v199, v199
    v_rcp_f32 v200, v200
    v_rcp_f32 v201, v201
    v_rcp_f32 v202, v202
    v_rcp_f32 v203, v203
    v_pk_mul_f32 v[204:205], v[188:189], v[204:205]
    v_pk_mul_f32 v[206:207], v[190:191], v[206:207]
    v_pk_mul_f32 v[208:209], v[192:193], v[208:209]
    v_pk_mul_f32 v[210:211], v[194:195], v[210:211]
    v_pk_mul_f32 v[212:213], v[196:197], v[212:213]
    v_pk_mul_f32 v[214:215], v[198:199], v[214:215]
    v_pk_mul_f32 v[216:217], v[200:201], v[216:217]
    v_pk_mul_f32 v[218:219], v[202:203], v[218:219]
    s_cmp_ge_i32 s96, 1
    s_cbranch_scc0 L_PB00
L_PB01:
    s_setprio 1
    v_smfmac_f32_16x16x64_bf16 v[112:115], v[184:187], v[204:211], v242
    v_exp_f32 v220, v220
    v_smfmac_f32_16x16x64_bf16 v[116:119], v[184:187], v[212:219], v242
    v_exp_f32 v221, v221
    s_waitcnt vmcnt(0)
    ds_read_b128 v[176:179], v251
    ds_read_b128 v[180:183], v252
    v_mfma_f32_16x16x32_bf16 v[204:207], v[160:163], v[48:51], 0
    v_exp_f32 v222, v222
    v_mfma_f32_16x16x32_bf16 v[212:215], v[160:163], v[56:59], 0
    ds_read_b128 v[160:163], v244 offset:0
    v_exp_f32 v223, v223
    v_mfma_f32_16x16x32_bf16 v[208:211], v[168:171], v[48:51], 0
    v_exp_f32 v224, v224
    v_mfma_f32_16x16x32_bf16 v[216:219], v[168:171], v[56:59], 0
    ds_read_b128 v[168:171], v244 offset:512
    v_exp_f32 v225, v225
    v_mfma_f32_16x16x32_bf16 v[204:207], v[164:167], v[52:55], v[204:207]
    v_exp_f32 v226, v226
    v_mfma_f32_16x16x32_bf16 v[212:215], v[164:167], v[60:63], v[212:215]
    ds_read_b128 v[164:167], v244 offset:64
    v_exp_f32 v227, v227
    v_mfma_f32_16x16x32_bf16 v[208:211], v[172:175], v[52:55], v[208:211]
    v_exp_f32 v228, v228
    v_mfma_f32_16x16x32_bf16 v[216:219], v[172:175], v[60:63], v[216:219]
    ds_read_b128 v[172:175], v244 offset:576
    v_exp_f32 v229, v229
    v_smfmac_f32_16x16x64_bf16 v[96:99], v[184:187], v[188:195], v242
    v_exp_f32 v230, v230
    s_setprio 3
    v_smfmac_f32_16x16x64_bf16 v[100:103], v[184:187], v[196:203], v242
    v_exp_f32 v231, v231
    v_exp_f32 v232, v232
    v_exp_f32 v233, v233
    v_exp_f32 v234, v234
    v_exp_f32 v235, v235
    v_pk_add_f32 v[220:221], v[220:221], 1.0 op_sel_hi:[1,0]
    v_pk_add_f32 v[222:223], v[222:223], 1.0 op_sel_hi:[1,0]
    v_pk_add_f32 v[224:225], v[224:225], 1.0 op_sel_hi:[1,0]
    v_pk_add_f32 v[226:227], v[226:227], 1.0 op_sel_hi:[1,0]
    v_pk_add_f32 v[228:229], v[228:229], 1.0 op_sel_hi:[1,0]
    v_pk_add_f32 v[230:231], v[230:231], 1.0 op_sel_hi:[1,0]
    v_pk_add_f32 v[232:233], v[232:233], 1.0 op_sel_hi:[1,0]
    v_pk_add_f32 v[234:235], v[234:235], 1.0 op_sel_hi:[1,0]
    s_setprio 1
    s_waitcnt lgkmcnt(4)
    v_mfma_f32_16x16x32_bf16 v[188:191], v[176:179], v[80:83], 0
    v_rcp_f32 v220, v220
    v_mfma_f32_16x16x32_bf16 v[196:199], v[176:179], v[84:87], 0
    v_rcp_f32 v221, v221
    v_mfma_f32_16x16x32_bf16 v[192:195], v[180:183], v[80:83], 0
    v_rcp_f32 v222, v222
    v_mfma_f32_16x16x32_bf16 v[200:203], v[180:183], v[84:87], 0
    v_rcp_f32 v223, v223
    s_waitcnt lgkmcnt(3)
    v_mfma_f32_16x16x32_bf16 v[188:191], v[160:163], v[0:3], v[188:191]
    v_rcp_f32 v224, v224
    v_mfma_f32_16x16x32_bf16 v[196:199], v[160:163], v[8:11], v[196:199]
    v_rcp_f32 v225, v225
    s_waitcnt lgkmcnt(2)
    v_mfma_f32_16x16x32_bf16 v[192:195], v[168:171], v[0:3], v[192:195]
    v_rcp_f32 v226, v226
    v_mfma_f32_16x16x32_bf16 v[200:203], v[168:171], v[8:11], v[200:203]
    v_rcp_f32 v227, v227
    s_waitcnt lgkmcnt(1)
    v_mfma_f32_16x16x32_bf16 v[188:191], v[164:167], v[4:7], v[188:191]
    v_rcp_f32 v228, v228
    v_mfma_f32_16x16x32_bf16 v[196:199], v[164:167], v[12:15], v[196:199]
    v_rcp_f32 v229, v229
    s_waitcnt lgkmcnt(0)
    v_mfma_f32_16x16x32_bf16 v[192:195], v[172:175], v[4:7], v[192:195]
    s_cmp_lt_u32 s16, s17
    s_cbranch_scc0 L_ND01
    s_add_u32 m0, s13, 0
    v_mad_u32_u16 v236, v236, s15, v243
    buffer_load_dwordx4 v236, s[40:43], 0 offen lds
    s_add_u32 m0, s13, 1056
    v_mad_u32_u16 v237, v237, s15, v243
    buffer_load_dwordx4 v237, s[40:43], 0 offen lds
    s_add_u32 m0, s13, 2112
    v_mad_u32_u16 v238, v238, s15, v243
    buffer_load_dwordx4 v238, s[40:43], 0 offen lds
    s_add_u32 m0, s13, 3168
    v_mad_u32_u16 v239, v239, s15, v243
    buffer_load_dwordx4 v239, s[40:43], 0 offen lds
    s_mov_b32 m0, s14
    v_and_b32 v240, 0xfffff, v240
    buffer_load_dwordx4 v[240:241], s[44:47], 0 idxen offen lds
L_ND01:
    v_rcp_f32 v230, v230
    s_setprio 3
    v_mfma_f32_16x16x32_bf16 v[200:203], v[172:175], v[12:15], v[200:203]
    v_rcp_f32 v231, v231
    v_rcp_f32 v232, v232
    v_rcp_f32 v233, v233
    v_rcp_f32 v234, v234
    v_rcp_f32 v235, v235
    v_pk_mul_f32 v[204:205], v[220:221], v[204:205]
    v_pk_mul_f32 v[206:207], v[222:223], v[206:207]
    v_pk_mul_f32 v[208:209], v[224:225], v[208:209]
    v_pk_mul_f32 v[210:211], v[226:227], v[210:211]
    v_pk_mul_f32 v[212:213], v[228:229], v[212:213]
    v_pk_mul_f32 v[214:215], v[230:231], v[214:215]
    v_pk_mul_f32 v[216:217], v[232:233], v[216:217]
    v_pk_mul_f32 v[218:219], v[234:235], v[218:219]
    s_cmp_gt_u32 s16, s17
    s_cbranch_scc1 L_TAIL0
    s_setprio 1
    v_smfmac_f32_16x16x64_bf16 v[120:123], v[184:187], v[204:211], v242
    ds_read_u16 v236, v250 offset:1152
    ds_read_u16 v237, v250 offset:1168
    ds_add_rtn_u32 v238, v255, v253
    v_exp_f32 v188, v188
    v_smfmac_f32_16x16x64_bf16 v[124:127], v[184:187], v[212:219], v242
    v_exp_f32 v189, v189
    v_mfma_f32_16x16x32_bf16 v[204:207], v[160:163], v[32:35], 0
    v_exp_f32 v190, v190
    v_mfma_f32_16x16x32_bf16 v[212:215], v[160:163], v[40:43], 0
    v_exp_f32 v191, v191
    v_mfma_f32_16x16x32_bf16 v[208:211], v[168:171], v[32:35], 0
    v_exp_f32 v192, v192
    v_mfma_f32_16x16x32_bf16 v[216:219], v[168:171], v[40:43], 0
    v_exp_f32 v193, v193
    v_mfma_f32_16x16x32_bf16 v[204:207], v[164:167], v[36:39], v[204:207]
    v_exp_f32 v194, v194
    v_mfma_f32_16x16x32_bf16 v[212:215], v[164:167], v[44:47], v[212:215]
    v_exp_f32 v195, v195
    v_mfma_f32_16x16x32_bf16 v[208:211], v[172:175], v[36:39], v[208:211]
    s_waitcnt lgkmcnt(0)
    v_and_or_b32 v236, v236, s18, v246
    v_and_or_b32 v237, v237, s18, v246
    v_readfirstlane_b32 s96, v238
    v_exp_f32 v196, v196
    v_mfma_f32_16x16x32_bf16 v[216:219], v[172:175], v[44:47], v[216:219]
    v_exp_f32 v197, v197
    v_smfmac_f32_16x16x64_bf16 v[104:107], v[184:187], v[220:227], v242
    v_exp_f32 v198, v198
    s_setprio 3
    v_smfmac_f32_16x16x64_bf16 v[108:111], v[184:187], v[228:235], v242
    v_exp_f32 v199, v199
    v_exp_f32 v200, v200
    v_exp_f32 v201, v201
    v_exp_f32 v202, v202
    v_exp_f32 v203, v203
    v_pk_add_f32 v[188:189], v[188:189], 1.0 op_sel_hi:[1,0]
    v_pk_add_f32 v[190:191], v[190:191], 1.0 op_sel_hi:[1,0]
    v_pk_add_f32 v[192:193], v[192:193], 1.0 op_sel_hi:[1,0]
    v_pk_add_f32 v[194:195], v[194:195], 1.0 op_sel_hi:[1,0]
    v_pk_add_f32 v[196:197], v[196:197], 1.0 op_sel_hi:[1,0]
    v_pk_add_f32 v[198:199], v[198:199], 1.0 op_sel_hi:[1,0]
    v_pk_add_f32 v[200:201], v[200:201], 1.0 op_sel_hi:[1,0]
    v_pk_add_f32 v[202:203], v[202:203], 1.0 op_sel_hi:[1,0]
    s_setprio 1
    v_mfma_f32_16x16x32_bf16 v[220:223], v[176:179], v[88:91], 0
    ds_read_b64_tr_b16 v[184:185], v236
    ds_read_b64_tr_b16 v[186:187], v237
    ds_read_u16 v251, v249 offset:128
    ds_read_u16 v252, v249 offset:192
    v_rcp_f32 v188, v188
    v_mfma_f32_16x16x32_bf16 v[228:231], v[176:179], v[92:95], 0
    s_mul_i32 s96, s96, s101
    v_rcp_f32 v189, v189
    v_mfma_f32_16x16x32_bf16 v[224:227], v[180:183], v[88:91], 0
    v_rcp_f32 v190, v190
    v_mfma_f32_16x16x32_bf16 v[232:235], v[180:183], v[92:95], 0
    v_rcp_f32 v191, v191
    v_mfma_f32_16x16x32_bf16 v[220:223], v[160:163], v[16:19], v[220:223]
    v_rcp_f32 v192, v192
    v_mfma_f32_16x16x32_bf16 v[228:231], v[160:163], v[24:27], v[228:231]
    v_rcp_f32 v193, v193
    v_mfma_f32_16x16x32_bf16 v[224:227], v[168:171], v[16:19], v[224:227]
    s_waitcnt lgkmcnt(0)
    v_and_or_b32 v251, v251, s18, v245
    v_and_or_b32 v252, v252, s18, v245
    ds_read_b128 v[236:239], v247 offset:1280
    ds_read_b32 v240, v248 offset:1280
    s_add_u32 s16, s16, 1
    v_rcp_f32 v194, v194
    v_mfma_f32_16x16x32_bf16 v[232:235], v[168:171], v[24:27], v[232:235]
    v_add_u32 v247, 0x80, v247
    v_add_u32 v248, 0x80, v248
    v_add_u32 v249, 0x80, v249
    v_add_u32 v250, 0x80, v250
    v_rcp_f32 v195, v195
    v_mfma_f32_16x16x32_bf16 v[220:223], v[164:167], v[20:23], v[220:223]
    v_rcp_f32 v196, v196
    v_mfma_f32_16x16x32_bf16 v[228:231], v[164:167], v[28:31], v[228:231]
    v_rcp_f32 v197, v197
    v_mfma_f32_16x16x32_bf16 v[224:227], v[172:175], v[20:23], v[224:227]
    v_rcp_f32 v198, v198
    s_setprio 3
    v_mfma_f32_16x16x32_bf16 v[232:235], v[172:175], v[28:31], v[232:235]
    v_rcp_f32 v199, v199
    v_rcp_f32 v200, v200
    v_rcp_f32 v201, v201
    v_rcp_f32 v202, v202
    v_rcp_f32 v203, v203
    v_pk_mul_f32 v[204:205], v[188:189], v[204:205]
    v_pk_mul_f32 v[206:207], v[190:191], v[206:207]
    v_pk_mul_f32 v[208:209], v[192:193], v[208:209]
    v_pk_mul_f32 v[210:211], v[194:195], v[210:211]
    v_pk_mul_f32 v[212:213], v[196:197], v[212:213]
    v_pk_mul_f32 v[214:215], v[198:199], v[214:215]
    v_pk_mul_f32 v[216:217], v[200:201], v[216:217]
    v_pk_mul_f32 v[218:219], v[202:203], v[218:219]
    s_cmp_ge_i32 s96, 1
    s_cbranch_scc0 L_PB10
L_PB11:
    s_setprio 1
    v_smfmac_f32_16x16x64_bf16 v[144:147], v[184:187], v[204:211], v242
    v_exp_f32 v220, v220
    v_smfmac_f32_16x16x64_bf16 v[148:151], v[184:187], v[212:219], v242
    v_exp_f32 v221, v221
    s_waitcnt vmcnt(0)
    ds_read_b128 v[176:179], v251
    ds_read_b128 v[180:183], v252
    v_mfma_f32_16x16x32_bf16 v[204:207], v[160:163], v[48:51], 0
    v_exp_f32 v222, v222
    v_mfma_f32_16x16x32_bf16 v[212:215], v[160:163], v[56:59], 0
    ds_read_b128 v[160:163], v244 offset:0
    v_exp_f32 v223, v223
    v_mfma_f32_16x16x32_bf16 v[208:211], v[168:171], v[48:51], 0
    v_exp_f32 v224, v224
    v_mfma_f32_16x16x32_bf16 v[216:219], v[168:171], v[56:59], 0
    ds_read_b128 v[168:171], v244 offset:512
    v_exp_f32 v225, v225
    v_mfma_f32_16x16x32_bf16 v[204:207], v[164:167], v[52:55], v[204:207]
    v_exp_f32 v226, v226
    v_mfma_f32_16x16x32_bf16 v[212:215], v[164:167], v[60:63], v[212:215]
    ds_read_b128 v[164:167], v244 offset:64
    v_exp_f32 v227, v227
    v_mfma_f32_16x16x32_bf16 v[208:211], v[172:175], v[52:55], v[208:211]
    v_exp_f32 v228, v228
    v_mfma_f32_16x16x32_bf16 v[216:219], v[172:175], v[60:63], v[216:219]
    ds_read_b128 v[172:175], v244 offset:576
    v_exp_f32 v229, v229
    v_smfmac_f32_16x16x64_bf16 v[128:131], v[184:187], v[188:195], v242
    v_exp_f32 v230, v230
    s_setprio 3
    v_smfmac_f32_16x16x64_bf16 v[132:135], v[184:187], v[196:203], v242
    v_exp_f32 v231, v231
    v_exp_f32 v232, v232
    v_exp_f32 v233, v233
    v_exp_f32 v234, v234
    v_exp_f32 v235, v235
    v_pk_add_f32 v[220:221], v[220:221], 1.0 op_sel_hi:[1,0]
    v_pk_add_f32 v[222:223], v[222:223], 1.0 op_sel_hi:[1,0]
    v_pk_add_f32 v[224:225], v[224:225], 1.0 op_sel_hi:[1,0]
    v_pk_add_f32 v[226:227], v[226:227], 1.0 op_sel_hi:[1,0]
    v_pk_add_f32 v[228:229], v[228:229], 1.0 op_sel_hi:[1,0]
    v_pk_add_f32 v[230:231], v[230:231], 1.0 op_sel_hi:[1,0]
    v_pk_add_f32 v[232:233], v[232:233], 1.0 op_sel_hi:[1,0]
    v_pk_add_f32 v[234:235], v[234:235], 1.0 op_sel_hi:[1,0]
    s_setprio 1
    s_waitcnt lgkmcnt(4)
    v_mfma_f32_16x16x32_bf16 v[188:191], v[176:179], v[64:67], 0
    v_rcp_f32 v220, v220
    v_mfma_f32_16x16x32_bf16 v[196:199], v[176:179], v[68:71], 0
    v_rcp_f32 v221, v221
    v_mfma_f32_16x16x32_bf16 v[192:195], v[180:183], v[64:67], 0
    v_rcp_f32 v222, v222
    v_mfma_f32_16x16x32_bf16 v[200:203], v[180:183], v[68:71], 0
    v_rcp_f32 v223, v223
    s_waitcnt lgkmcnt(3)
    v_mfma_f32_16x16x32_bf16 v[188:191], v[160:163], v[0:3], v[188:191]
    v_rcp_f32 v224, v224
    v_mfma_f32_16x16x32_bf16 v[196:199], v[160:163], v[8:11], v[196:199]
    v_rcp_f32 v225, v225
    s_waitcnt lgkmcnt(2)
    v_mfma_f32_16x16x32_bf16 v[192:195], v[168:171], v[0:3], v[192:195]
    v_rcp_f32 v226, v226
    v_mfma_f32_16x16x32_bf16 v[200:203], v[168:171], v[8:11], v[200:203]
    v_rcp_f32 v227, v227
    s_waitcnt lgkmcnt(1)
    v_mfma_f32_16x16x32_bf16 v[188:191], v[164:167], v[4:7], v[188:191]
    v_rcp_f32 v228, v228
    v_mfma_f32_16x16x32_bf16 v[196:199], v[164:167], v[12:15], v[196:199]
    v_rcp_f32 v229, v229
    s_waitcnt lgkmcnt(0)
    v_mfma_f32_16x16x32_bf16 v[192:195], v[172:175], v[4:7], v[192:195]
    s_cmp_lt_u32 s16, s17
    s_cbranch_scc0 L_ND11
    s_add_u32 m0, s13, 0
    v_mad_u32_u16 v236, v236, s15, v243
    buffer_load_dwordx4 v236, s[40:43], 0 offen lds
    s_add_u32 m0, s13, 1056
    v_mad_u32_u16 v237, v237, s15, v243
    buffer_load_dwordx4 v237, s[40:43], 0 offen lds
    s_add_u32 m0, s13, 2112
    v_mad_u32_u16 v238, v238, s15, v243
    buffer_load_dwordx4 v238, s[40:43], 0 offen lds
    s_add_u32 m0, s13, 3168
    v_mad_u32_u16 v239, v239, s15, v243
    buffer_load_dwordx4 v239, s[40:43], 0 offen lds
    s_mov_b32 m0, s14
    v_and_b32 v240, 0xfffff, v240
    buffer_load_dwordx4 v[240:241], s[44:47], 0 idxen offen lds
L_ND11:
    v_rcp_f32 v230, v230
    s_setprio 3
    v_mfma_f32_16x16x32_bf16 v[200:203], v[172:175], v[12:15], v[200:203]
    v_rcp_f32 v231, v231
    v_rcp_f32 v232, v232
    v_rcp_f32 v233, v233
    v_rcp_f32 v234, v234
    v_rcp_f32 v235, v235
    v_pk_mul_f32 v[204:205], v[220:221], v[204:205]
    v_pk_mul_f32 v[206:207], v[222:223], v[206:207]
    v_pk_mul_f32 v[208:209], v[224:225], v[208:209]
    v_pk_mul_f32 v[210:211], v[226:227], v[210:211]
    v_pk_mul_f32 v[212:213], v[228:229], v[212:213]
    v_pk_mul_f32 v[214:215], v[230:231], v[214:215]
    v_pk_mul_f32 v[216:217], v[232:233], v[216:217]
    v_pk_mul_f32 v[218:219], v[234:235], v[218:219]
    s_cmp_le_u32 s16, s17
    s_cbranch_scc1 L_LOOP1
    s_branch L_TAIL1
.p2align 6
L_LOOP0:
    s_setprio 0
    v_smfmac_f32_16x16x64_bf16 v[152:155], v[184:187], v[204:211], v242
    ds_read_u16 v236, v250 offset:0
    ds_read_u16 v237, v250 offset:16
    ds_add_rtn_u32 v238, v255, v253
    v_exp_f32 v188, v188
    v_smfmac_f32_16x16x64_bf16 v[156:159], v[184:187], v[212:219], v242
    v_exp_f32 v189, v189
    v_mfma_f32_16x16x32_bf16 v[204:207], v[160:163], v[32:35], 0
    v_exp_f32 v190, v190
    v_mfma_f32_16x16x32_bf16 v[212:215], v[160:163], v[40:43], 0
    v_exp_f32 v191, v191
    v_mfma_f32_16x16x32_bf16 v[208:211], v[168:171], v[32:35], 0
    v_exp_f32 v192, v192
    v_mfma_f32_16x16x32_bf16 v[216:219], v[168:171], v[40:43], 0
    v_exp_f32 v193, v193
    v_mfma_f32_16x16x32_bf16 v[204:207], v[164:167], v[36:39], v[204:207]
    v_exp_f32 v194, v194
    v_mfma_f32_16x16x32_bf16 v[212:215], v[164:167], v[44:47], v[212:215]
    v_exp_f32 v195, v195
    v_mfma_f32_16x16x32_bf16 v[208:211], v[172:175], v[36:39], v[208:211]
    s_waitcnt lgkmcnt(0)
    v_and_or_b32 v236, v236, s18, v246
    v_and_or_b32 v237, v237, s18, v246
    v_readfirstlane_b32 s96, v238
    v_exp_f32 v196, v196
    v_mfma_f32_16x16x32_bf16 v[216:219], v[172:175], v[44:47], v[216:219]
    v_exp_f32 v197, v197
    v_smfmac_f32_16x16x64_bf16 v[136:139], v[184:187], v[220:227], v242
    v_exp_f32 v198, v198
    s_setprio 3
    v_smfmac_f32_16x16x64_bf16 v[140:143], v[184:187], v[228:235], v242
    v_exp_f32 v199, v199
    v_exp_f32 v200, v200
    v_exp_f32 v201, v201
    v_exp_f32 v202, v202
    v_exp_f32 v203, v203
    v_pk_add_f32 v[188:189], v[188:189], 1.0 op_sel_hi:[1,0]
    v_pk_add_f32 v[190:191], v[190:191], 1.0 op_sel_hi:[1,0]
    v_pk_add_f32 v[192:193], v[192:193], 1.0 op_sel_hi:[1,0]
    v_pk_add_f32 v[194:195], v[194:195], 1.0 op_sel_hi:[1,0]
    v_pk_add_f32 v[196:197], v[196:197], 1.0 op_sel_hi:[1,0]
    v_pk_add_f32 v[198:199], v[198:199], 1.0 op_sel_hi:[1,0]
    v_pk_add_f32 v[200:201], v[200:201], 1.0 op_sel_hi:[1,0]
    v_pk_add_f32 v[202:203], v[202:203], 1.0 op_sel_hi:[1,0]
    s_setprio 0
    v_mfma_f32_16x16x32_bf16 v[220:223], v[176:179], v[72:75], 0
    ds_read_b64_tr_b16 v[184:185], v236
    ds_read_b64_tr_b16 v[186:187], v237
    ds_read_u16 v251, v249 offset:1152
    ds_read_u16 v252, v249 offset:1216
    v_rcp_f32 v188, v188
    v_mfma_f32_16x16x32_bf16 v[228:231], v[176:179], v[76:79], 0
    s_mul_i32 s96, s96, s101
    v_rcp_f32 v189, v189
    v_mfma_f32_16x16x32_bf16 v[224:227], v[180:183], v[72:75], 0
    v_rcp_f32 v190, v190
    v_mfma_f32_16x16x32_bf16 v[232:235], v[180:183], v[76:79], 0
    v_rcp_f32 v191, v191
    v_mfma_f32_16x16x32_bf16 v[220:223], v[160:163], v[16:19], v[220:223]
    v_rcp_f32 v192, v192
    v_mfma_f32_16x16x32_bf16 v[228:231], v[160:163], v[24:27], v[228:231]
    v_rcp_f32 v193, v193
    v_mfma_f32_16x16x32_bf16 v[224:227], v[168:171], v[16:19], v[224:227]
    s_waitcnt lgkmcnt(0)
    v_and_or_b32 v251, v251, s18, v245
    v_and_or_b32 v252, v252, s18, v245
    ds_read_b128 v[236:239], v247 offset:128
    ds_read_b32 v240, v248 offset:128
    s_add_u32 s16, s16, 1
    v_rcp_f32 v194, v194
    v_mfma_f32_16x16x32_bf16 v[232:235], v[168:171], v[24:27], v[232:235]
    v_rcp_f32 v195, v195
    v_mfma_f32_16x16x32_bf16 v[220:223], v[164:167], v[20:23], v[220:223]
    v_rcp_f32 v196, v196
    v_mfma_f32_16x16x32_bf16 v[228:231], v[164:167], v[28:31], v[228:231]
    v_rcp_f32 v197, v197
    v_mfma_f32_16x16x32_bf16 v[224:227], v[172:175], v[20:23], v[224:227]
    v_rcp_f32 v198, v198
    s_setprio 3
    v_mfma_f32_16x16x32_bf16 v[232:235], v[172:175], v[28:31], v[232:235]
    v_rcp_f32 v199, v199
    v_rcp_f32 v200, v200
    v_rcp_f32 v201, v201
    v_rcp_f32 v202, v202
    v_rcp_f32 v203, v203
    v_pk_mul_f32 v[204:205], v[188:189], v[204:205]
    v_pk_mul_f32 v[206:207], v[190:191], v[206:207]
    v_pk_mul_f32 v[208:209], v[192:193], v[208:209]
    v_pk_mul_f32 v[210:211], v[194:195], v[210:211]
    v_pk_mul_f32 v[212:213], v[196:197], v[212:213]
    v_pk_mul_f32 v[214:215], v[198:199], v[214:215]
    v_pk_mul_f32 v[216:217], v[200:201], v[216:217]
    v_pk_mul_f32 v[218:219], v[202:203], v[218:219]
    s_cmp_ge_i32 s96, 1
    s_cbranch_scc1 L_PB01
L_PB00:
    s_setprio 0
    v_smfmac_f32_16x16x64_bf16 v[112:115], v[184:187], v[204:211], v242
    v_exp_f32 v220, v220
    v_smfmac_f32_16x16x64_bf16 v[116:119], v[184:187], v[212:219], v242
    v_exp_f32 v221, v221
    s_waitcnt vmcnt(0)
    ds_read_b128 v[176:179], v251
    ds_read_b128 v[180:183], v252
    v_mfma_f32_16x16x32_bf16 v[204:207], v[160:163], v[48:51], 0
    v_exp_f32 v222, v222
    v_mfma_f32_16x16x32_bf16 v[212:215], v[160:163], v[56:59], 0
    ds_read_b128 v[160:163], v244 offset:0
    v_exp_f32 v223, v223
    v_mfma_f32_16x16x32_bf16 v[208:211], v[168:171], v[48:51], 0
    v_exp_f32 v224, v224
    v_mfma_f32_16x16x32_bf16 v[216:219], v[168:171], v[56:59], 0
    ds_read_b128 v[168:171], v244 offset:512
    v_exp_f32 v225, v225
    v_mfma_f32_16x16x32_bf16 v[204:207], v[164:167], v[52:55], v[204:207]
    v_exp_f32 v226, v226
    v_mfma_f32_16x16x32_bf16 v[212:215], v[164:167], v[60:63], v[212:215]
    ds_read_b128 v[164:167], v244 offset:64
    v_exp_f32 v227, v227
    v_mfma_f32_16x16x32_bf16 v[208:211], v[172:175], v[52:55], v[208:211]
    v_exp_f32 v228, v228
    v_mfma_f32_16x16x32_bf16 v[216:219], v[172:175], v[60:63], v[216:219]
    ds_read_b128 v[172:175], v244 offset:576
    v_exp_f32 v229, v229
    v_smfmac_f32_16x16x64_bf16 v[96:99], v[184:187], v[188:195], v242
    v_exp_f32 v230, v230
    s_setprio 3
    v_smfmac_f32_16x16x64_bf16 v[100:103], v[184:187], v[196:203], v242
    v_exp_f32 v231, v231
    v_exp_f32 v232, v232
    v_exp_f32 v233, v233
    v_exp_f32 v234, v234
    v_exp_f32 v235, v235
    v_pk_add_f32 v[220:221], v[220:221], 1.0 op_sel_hi:[1,0]
    v_pk_add_f32 v[222:223], v[222:223], 1.0 op_sel_hi:[1,0]
    v_pk_add_f32 v[224:225], v[224:225], 1.0 op_sel_hi:[1,0]
    v_pk_add_f32 v[226:227], v[226:227], 1.0 op_sel_hi:[1,0]
    v_pk_add_f32 v[228:229], v[228:229], 1.0 op_sel_hi:[1,0]
    v_pk_add_f32 v[230:231], v[230:231], 1.0 op_sel_hi:[1,0]
    v_pk_add_f32 v[232:233], v[232:233], 1.0 op_sel_hi:[1,0]
    v_pk_add_f32 v[234:235], v[234:235], 1.0 op_sel_hi:[1,0]
    s_setprio 0
    s_waitcnt lgkmcnt(4)
    v_mfma_f32_16x16x32_bf16 v[188:191], v[176:179], v[80:83], 0
    v_rcp_f32 v220, v220
    v_mfma_f32_16x16x32_bf16 v[196:199], v[176:179], v[84:87], 0
    v_rcp_f32 v221, v221
    v_mfma_f32_16x16x32_bf16 v[192:195], v[180:183], v[80:83], 0
    v_rcp_f32 v222, v222
    v_mfma_f32_16x16x32_bf16 v[200:203], v[180:183], v[84:87], 0
    v_rcp_f32 v223, v223
    s_waitcnt lgkmcnt(3)
    v_mfma_f32_16x16x32_bf16 v[188:191], v[160:163], v[0:3], v[188:191]
    v_rcp_f32 v224, v224
    v_mfma_f32_16x16x32_bf16 v[196:199], v[160:163], v[8:11], v[196:199]
    v_rcp_f32 v225, v225
    s_waitcnt lgkmcnt(2)
    v_mfma_f32_16x16x32_bf16 v[192:195], v[168:171], v[0:3], v[192:195]
    v_rcp_f32 v226, v226
    v_mfma_f32_16x16x32_bf16 v[200:203], v[168:171], v[8:11], v[200:203]
    v_rcp_f32 v227, v227
    s_waitcnt lgkmcnt(1)
    v_mfma_f32_16x16x32_bf16 v[188:191], v[164:167], v[4:7], v[188:191]
    v_rcp_f32 v228, v228
    v_mfma_f32_16x16x32_bf16 v[196:199], v[164:167], v[12:15], v[196:199]
    v_rcp_f32 v229, v229
    s_waitcnt lgkmcnt(0)
    v_mfma_f32_16x16x32_bf16 v[192:195], v[172:175], v[4:7], v[192:195]
    s_cmp_lt_u32 s16, s17
    s_cbranch_scc0 L_ND00
    s_add_u32 m0, s13, 0
    v_mad_u32_u16 v236, v236, s15, v243
    buffer_load_dwordx4 v236, s[40:43], 0 offen lds
    s_add_u32 m0, s13, 1056
    v_mad_u32_u16 v237, v237, s15, v243
    buffer_load_dwordx4 v237, s[40:43], 0 offen lds
    s_add_u32 m0, s13, 2112
    v_mad_u32_u16 v238, v238, s15, v243
    buffer_load_dwordx4 v238, s[40:43], 0 offen lds
    s_add_u32 m0, s13, 3168
    v_mad_u32_u16 v239, v239, s15, v243
    buffer_load_dwordx4 v239, s[40:43], 0 offen lds
    s_mov_b32 m0, s14
    v_and_b32 v240, 0xfffff, v240
    buffer_load_dwordx4 v[240:241], s[44:47], 0 idxen offen lds
L_ND00:
    v_rcp_f32 v230, v230
    s_setprio 3
    v_mfma_f32_16x16x32_bf16 v[200:203], v[172:175], v[12:15], v[200:203]
    v_rcp_f32 v231, v231
    v_rcp_f32 v232, v232
    v_rcp_f32 v233, v233
    v_rcp_f32 v234, v234
    v_rcp_f32 v235, v235
    v_pk_mul_f32 v[204:205], v[220:221], v[204:205]
    v_pk_mul_f32 v[206:207], v[222:223], v[206:207]
    v_pk_mul_f32 v[208:209], v[224:225], v[208:209]
    v_pk_mul_f32 v[210:211], v[226:227], v[210:211]
    v_pk_mul_f32 v[212:213], v[228:229], v[212:213]
    v_pk_mul_f32 v[214:215], v[230:231], v[214:215]
    v_pk_mul_f32 v[216:217], v[232:233], v[216:217]
    v_pk_mul_f32 v[218:219], v[234:235], v[218:219]
    s_cmp_gt_u32 s16, s17
    s_cbranch_scc1 L_TAIL0
    s_setprio 0
    v_smfmac_f32_16x16x64_bf16 v[120:123], v[184:187], v[204:211], v242
    ds_read_u16 v236, v250 offset:1152
    ds_read_u16 v237, v250 offset:1168
    ds_add_rtn_u32 v238, v255, v253
    v_exp_f32 v188, v188
    v_smfmac_f32_16x16x64_bf16 v[124:127], v[184:187], v[212:219], v242
    v_exp_f32 v189, v189
    v_mfma_f32_16x16x32_bf16 v[204:207], v[160:163], v[32:35], 0
    v_exp_f32 v190, v190
    v_mfma_f32_16x16x32_bf16 v[212:215], v[160:163], v[40:43], 0
    v_exp_f32 v191, v191
    v_mfma_f32_16x16x32_bf16 v[208:211], v[168:171], v[32:35], 0
    v_exp_f32 v192, v192
    v_mfma_f32_16x16x32_bf16 v[216:219], v[168:171], v[40:43], 0
    v_exp_f32 v193, v193
    v_mfma_f32_16x16x32_bf16 v[204:207], v[164:167], v[36:39], v[204:207]
    v_exp_f32 v194, v194
    v_mfma_f32_16x16x32_bf16 v[212:215], v[164:167], v[44:47], v[212:215]
    v_exp_f32 v195, v195
    v_mfma_f32_16x16x32_bf16 v[208:211], v[172:175], v[36:39], v[208:211]
    s_waitcnt lgkmcnt(0)
    v_and_or_b32 v236, v236, s18, v246
    v_and_or_b32 v237, v237, s18, v246
    v_readfirstlane_b32 s96, v238
    v_exp_f32 v196, v196
    v_mfma_f32_16x16x32_bf16 v[216:219], v[172:175], v[44:47], v[216:219]
    v_exp_f32 v197, v197
    v_smfmac_f32_16x16x64_bf16 v[104:107], v[184:187], v[220:227], v242
    v_exp_f32 v198, v198
    s_setprio 3
    v_smfmac_f32_16x16x64_bf16 v[108:111], v[184:187], v[228:235], v242
    v_exp_f32 v199, v199
    v_exp_f32 v200, v200
    v_exp_f32 v201, v201
    v_exp_f32 v202, v202
    v_exp_f32 v203, v203
    v_pk_add_f32 v[188:189], v[188:189], 1.0 op_sel_hi:[1,0]
    v_pk_add_f32 v[190:191], v[190:191], 1.0 op_sel_hi:[1,0]
    v_pk_add_f32 v[192:193], v[192:193], 1.0 op_sel_hi:[1,0]
    v_pk_add_f32 v[194:195], v[194:195], 1.0 op_sel_hi:[1,0]
    v_pk_add_f32 v[196:197], v[196:197], 1.0 op_sel_hi:[1,0]
    v_pk_add_f32 v[198:199], v[198:199], 1.0 op_sel_hi:[1,0]
    v_pk_add_f32 v[200:201], v[200:201], 1.0 op_sel_hi:[1,0]
    v_pk_add_f32 v[202:203], v[202:203], 1.0 op_sel_hi:[1,0]
    s_setprio 0
    v_mfma_f32_16x16x32_bf16 v[220:223], v[176:179], v[88:91], 0
    ds_read_b64_tr_b16 v[184:185], v236
    ds_read_b64_tr_b16 v[186:187], v237
    ds_read_u16 v251, v249 offset:128
    ds_read_u16 v252, v249 offset:192
    v_rcp_f32 v188, v188
    v_mfma_f32_16x16x32_bf16 v[228:231], v[176:179], v[92:95], 0
    s_mul_i32 s96, s96, s101
    v_rcp_f32 v189, v189
    v_mfma_f32_16x16x32_bf16 v[224:227], v[180:183], v[88:91], 0
    v_rcp_f32 v190, v190
    v_mfma_f32_16x16x32_bf16 v[232:235], v[180:183], v[92:95], 0
    v_rcp_f32 v191, v191
    v_mfma_f32_16x16x32_bf16 v[220:223], v[160:163], v[16:19], v[220:223]
    v_rcp_f32 v192, v192
    v_mfma_f32_16x16x32_bf16 v[228:231], v[160:163], v[24:27], v[228:231]
    v_rcp_f32 v193, v193
    v_mfma_f32_16x16x32_bf16 v[224:227], v[168:171], v[16:19], v[224:227]
    s_waitcnt lgkmcnt(0)
    v_and_or_b32 v251, v251, s18, v245
    v_and_or_b32 v252, v252, s18, v245
    ds_read_b128 v[236:239], v247 offset:1280
    ds_read_b32 v240, v248 offset:1280
    s_add_u32 s16, s16, 1
    v_rcp_f32 v194, v194
    v_mfma_f32_16x16x32_bf16 v[232:235], v[168:171], v[24:27], v[232:235]
    v_add_u32 v247, 0x80, v247
    v_add_u32 v248, 0x80, v248
    v_add_u32 v249, 0x80, v249
    v_add_u32 v250, 0x80, v250
    v_rcp_f32 v195, v195
    v_mfma_f32_16x16x32_bf16 v[220:223], v[164:167], v[20:23], v[220:223]
    v_rcp_f32 v196, v196
    v_mfma_f32_16x16x32_bf16 v[228:231], v[164:167], v[28:31], v[228:231]
    v_rcp_f32 v197, v197
    v_mfma_f32_16x16x32_bf16 v[224:227], v[172:175], v[20:23], v[224:227]
    v_rcp_f32 v198, v198
    s_setprio 3
    v_mfma_f32_16x16x32_bf16 v[232:235], v[172:175], v[28:31], v[232:235]
    v_rcp_f32 v199, v199
    v_rcp_f32 v200, v200
    v_rcp_f32 v201, v201
    v_rcp_f32 v202, v202
    v_rcp_f32 v203, v203
    v_pk_mul_f32 v[204:205], v[188:189], v[204:205]
    v_pk_mul_f32 v[206:207], v[190:191], v[206:207]
    v_pk_mul_f32 v[208:209], v[192:193], v[208:209]
    v_pk_mul_f32 v[210:211], v[194:195], v[210:211]
    v_pk_mul_f32 v[212:213], v[196:197], v[212:213]
    v_pk_mul_f32 v[214:215], v[198:199], v[214:215]
    v_pk_mul_f32 v[216:217], v[200:201], v[216:217]
    v_pk_mul_f32 v[218:219], v[202:203], v[218:219]
    s_cmp_ge_i32 s96, 1
    s_cbranch_scc1 L_PB11
L_PB10:
    s_setprio 0
    v_smfmac_f32_16x16x64_bf16 v[144:147], v[184:187], v[204:211], v242
    v_exp_f32 v220, v220
    v_smfmac_f32_16x16x64_bf16 v[148:151], v[184:187], v[212:219], v242
    v_exp_f32 v221, v221
    s_waitcnt vmcnt(0)
    ds_read_b128 v[176:179], v251
    ds_read_b128 v[180:183], v252
    v_mfma_f32_16x16x32_bf16 v[204:207], v[160:163], v[48:51], 0
    v_exp_f32 v222, v222
    v_mfma_f32_16x16x32_bf16 v[212:215], v[160:163], v[56:59], 0
    ds_read_b128 v[160:163], v244 offset:0
    v_exp_f32 v223, v223
    v_mfma_f32_16x16x32_bf16 v[208:211], v[168:171], v[48:51], 0
    v_exp_f32 v224, v224
    v_mfma_f32_16x16x32_bf16 v[216:219], v[168:171], v[56:59], 0
    ds_read_b128 v[168:171], v244 offset:512
    v_exp_f32 v225, v225
    v_mfma_f32_16x16x32_bf16 v[204:207], v[164:167], v[52:55], v[204:207]
    v_exp_f32 v226, v226
    v_mfma_f32_16x16x32_bf16 v[212:215], v[164:167], v[60:63], v[212:215]
    ds_read_b128 v[164:167], v244 offset:64
    v_exp_f32 v227, v227
    v_mfma_f32_16x16x32_bf16 v[208:211], v[172:175], v[52:55], v[208:211]
    v_exp_f32 v228, v228
    v_mfma_f32_16x16x32_bf16 v[216:219], v[172:175], v[60:63], v[216:219]
    ds_read_b128 v[172:175], v244 offset:576
    v_exp_f32 v229, v229
    v_smfmac_f32_16x16x64_bf16 v[128:131], v[184:187], v[188:195], v242
    v_exp_f32 v230, v230
    s_setprio 3
    v_smfmac_f32_16x16x64_bf16 v[132:135], v[184:187], v[196:203], v242
    v_exp_f32 v231, v231
    v_exp_f32 v232, v232
    v_exp_f32 v233, v233
    v_exp_f32 v234, v234
    v_exp_f32 v235, v235
    v_pk_add_f32 v[220:221], v[220:221], 1.0 op_sel_hi:[1,0]
    v_pk_add_f32 v[222:223], v[222:223], 1.0 op_sel_hi:[1,0]
    v_pk_add_f32 v[224:225], v[224:225], 1.0 op_sel_hi:[1,0]
    v_pk_add_f32 v[226:227], v[226:227], 1.0 op_sel_hi:[1,0]
    v_pk_add_f32 v[228:229], v[228:229], 1.0 op_sel_hi:[1,0]
    v_pk_add_f32 v[230:231], v[230:231], 1.0 op_sel_hi:[1,0]
    v_pk_add_f32 v[232:233], v[232:233], 1.0 op_sel_hi:[1,0]
    v_pk_add_f32 v[234:235], v[234:235], 1.0 op_sel_hi:[1,0]
    s_setprio 0
    s_waitcnt lgkmcnt(4)
    v_mfma_f32_16x16x32_bf16 v[188:191], v[176:179], v[64:67], 0
    v_rcp_f32 v220, v220
    v_mfma_f32_16x16x32_bf16 v[196:199], v[176:179], v[68:71], 0
    v_rcp_f32 v221, v221
    v_mfma_f32_16x16x32_bf16 v[192:195], v[180:183], v[64:67], 0
    v_rcp_f32 v222, v222
    v_mfma_f32_16x16x32_bf16 v[200:203], v[180:183], v[68:71], 0
    v_rcp_f32 v223, v223
    s_waitcnt lgkmcnt(3)
    v_mfma_f32_16x16x32_bf16 v[188:191], v[160:163], v[0:3], v[188:191]
    v_rcp_f32 v224, v224
    v_mfma_f32_16x16x32_bf16 v[196:199], v[160:163], v[8:11], v[196:199]
    v_rcp_f32 v225, v225
    s_waitcnt lgkmcnt(2)
    v_mfma_f32_16x16x32_bf16 v[192:195], v[168:171], v[0:3], v[192:195]
    v_rcp_f32 v226, v226
    v_mfma_f32_16x16x32_bf16 v[200:203], v[168:171], v[8:11], v[200:203]
    v_rcp_f32 v227, v227
    s_waitcnt lgkmcnt(1)
    v_mfma_f32_16x16x32_bf16 v[188:191], v[164:167], v[4:7], v[188:191]
    v_rcp_f32 v228, v228
    v_mfma_f32_16x16x32_bf16 v[196:199], v[164:167], v[12:15], v[196:199]
    v_rcp_f32 v229, v229
    s_waitcnt lgkmcnt(0)
    v_mfma_f32_16x16x32_bf16 v[192:195], v[172:175], v[4:7], v[192:195]
    s_cmp_lt_u32 s16, s17
    s_cbranch_scc0 L_ND10
    s_add_u32 m0, s13, 0
    v_mad_u32_u16 v236, v236, s15, v243
    buffer_load_dwordx4 v236, s[40:43], 0 offen lds
    s_add_u32 m0, s13, 1056
    v_mad_u32_u16 v237, v237, s15, v243
    buffer_load_dwordx4 v237, s[40:43], 0 offen lds
    s_add_u32 m0, s13, 2112
    v_mad_u32_u16 v238, v238, s15, v243
    buffer_load_dwordx4 v238, s[40:43], 0 offen lds
    s_add_u32 m0, s13, 3168
    v_mad_u32_u16 v239, v239, s15, v243
    buffer_load_dwordx4 v239, s[40:43], 0 offen lds
    s_mov_b32 m0, s14
    v_and_b32 v240, 0xfffff, v240
    buffer_load_dwordx4 v[240:241], s[44:47], 0 idxen offen lds
L_ND10:
    v_rcp_f32 v230, v230
    s_setprio 3
    v_mfma_f32_16x16x32_bf16 v[200:203], v[172:175], v[12:15], v[200:203]
    v_rcp_f32 v231, v231
    v_rcp_f32 v232, v232
    v_rcp_f32 v233, v233
    v_rcp_f32 v234, v234
    v_rcp_f32 v235, v235
    v_pk_mul_f32 v[204:205], v[220:221], v[204:205]
    v_pk_mul_f32 v[206:207], v[222:223], v[206:207]
    v_pk_mul_f32 v[208:209], v[224:225], v[208:209]
    v_pk_mul_f32 v[210:211], v[226:227], v[210:211]
    v_pk_mul_f32 v[212:213], v[228:229], v[212:213]
    v_pk_mul_f32 v[214:215], v[230:231], v[214:215]
    v_pk_mul_f32 v[216:217], v[232:233], v[216:217]
    v_pk_mul_f32 v[218:219], v[234:235], v[218:219]
    s_cmp_le_u32 s16, s17
    s_cbranch_scc1 L_LOOP0
L_TAIL1:
    v_smfmac_f32_16x16x64_bf16 v[152:155], v[184:187], v[204:211], v242
    v_smfmac_f32_16x16x64_bf16 v[156:159], v[184:187], v[212:219], v242
    v_smfmac_f32_16x16x64_bf16 v[136:139], v[184:187], v[220:227], v242
    v_smfmac_f32_16x16x64_bf16 v[140:143], v[184:187], v[228:235], v242
    s_branch L_DONE
L_TAIL0:
    v_smfmac_f32_16x16x64_bf16 v[120:123], v[184:187], v[204:211], v242
    v_smfmac_f32_16x16x64_bf16 v[124:127], v[184:187], v[212:219], v242
    v_smfmac_f32_16x16x64_bf16 v[104:107], v[184:187], v[220:227], v242
    v_smfmac_f32_16x16x64_bf16 v[108:111], v[184:187], v[228:235], v242
L_DONE:
    v_mbcnt_lo_u32_b32 v253, -1, 0
    v_mbcnt_hi_u32_b32 v253, -1, v253
    s_cmp_lg_u32 s19, 0
    s_cbranch_scc1 L_SLOW
L_EPI:
    s_setprio 3
    v_bfe_u32 v65, v253, 2, 3
    v_lshrrev_b32 v66, 5, v253
    v_lshl_add_u32 v65, v66, 4, v65
    v_mul_u32_u24 v65, 160, v65
    s_mov_b32 s10, 143488
    v_add3_u32 v65, v65, v246, s10
    v_and_b32 v64, 48, v253
    v_and_b32 v67, 15, v253
    v_lshlrev_b32 v68, 3, v67
    v_lshlrev_b32 v70, 3, v64
    s_movk_i32 s10, 832
    v_mad_u32_u24 v64, v246, s10, v64
    s_waitcnt lgkmcnt(0)
    s_lshl_b32 s22, s22, 5
    s_add_u32 s10, s22, 116736
    v_add_u32 v69, s10, v68
    s_sub_u32 s11, 0, s22
    v_add_u32 v80, s11, v70
    v_and_b32 v80, 0x1ff, v80
    v_add_u32 v72, v80, v69
    ds_read_b64 v[32:33], v72 offset:0
    s_sub_u32 s11, 32, s22
    v_add_u32 v81, s11, v70
    v_and_b32 v81, 0x1ff, v81
    v_add_u32 v72, v81, v69
    ds_read_b64 v[34:35], v72 offset:6656
    s_sub_u32 s11, 64, s22
    v_add_u32 v82, s11, v70
    v_and_b32 v82, 0x1ff, v82
    v_add_u32 v72, v82, v69
    ds_read_b64 v[36:37], v72 offset:13312
    s_sub_u32 s11, 96, s22
    v_add_u32 v83, s11, v70
    v_and_b32 v83, 0x1ff, v83
    v_add_u32 v72, v83, v69
    ds_read_b64 v[38:39], v72 offset:19968
    s_sub_u32 s11, 0, s22
    v_lshl_add_u32 v72, v68, 2, s11
    v_and_b32 v72, 0x1ff, v72
    v_add3_u32 v72, v72, v64, s10
    ds_read_b128 v[160:163], v72 offset:0
    ds_read_b128 v[164:167], v72 offset:64
    ds_read_b64_tr_b16 v[0:1], v65 offset:0
    ds_read_b64_tr_b16 v[2:3], v65 offset:1280
    ds_read_b64_tr_b16 v[8:9], v65 offset:32
    ds_read_b64_tr_b16 v[10:11], v65 offset:1312
    ds_read_b64_tr_b16 v[16:17], v65 offset:64
    ds_read_b64_tr_b16 v[18:19], v65 offset:1344
    ds_read_b64_tr_b16 v[24:25], v65 offset:96
    ds_read_b64_tr_b16 v[26:27], v65 offset:1376
    s_lshl_b32 s23, s23, 5
    s_add_u32 s10, s23, 116736
    v_add_u32 v69, s10, v68
    s_sub_u32 s11, 0, s23
    v_add_u32 v84, s11, v70
    v_and_b32 v84, 0x1ff, v84
    v_add_u32 v72, v84, v69
    ds_read_b64 v[40:41], v72 offset:0
    s_sub_u32 s11, 32, s23
    v_add_u32 v85, s11, v70
    v_and_b32 v85, 0x1ff, v85
    v_add_u32 v72, v85, v69
    ds_read_b64 v[42:43], v72 offset:6656
    s_sub_u32 s11, 64, s23
    v_add_u32 v86, s11, v70
    v_and_b32 v86, 0x1ff, v86
    v_add_u32 v72, v86, v69
    ds_read_b64 v[44:45], v72 offset:13312
    s_sub_u32 s11, 96, s23
    v_add_u32 v87, s11, v70
    v_and_b32 v87, 0x1ff, v87
    v_add_u32 v72, v87, v69
    ds_read_b64 v[46:47], v72 offset:19968
    s_sub_u32 s11, 0, s23
    v_lshl_add_u32 v72, v68, 2, s11
    v_and_b32 v72, 0x1ff, v72
    v_add3_u32 v72, v72, v64, s10
    ds_read_b128 v[168:171], v72 offset:0
    ds_read_b128 v[172:175], v72 offset:64
    ds_read_b64_tr_b16 v[4:5], v65 offset:5120
    ds_read_b64_tr_b16 v[6:7], v65 offset:6400
    ds_read_b64_tr_b16 v[12:13], v65 offset:5152
    ds_read_b64_tr_b16 v[14:15], v65 offset:6432
    ds_read_b64_tr_b16 v[20:21], v65 offset:5184
    ds_read_b64_tr_b16 v[22:23], v65 offset:6464
    ds_read_b64_tr_b16 v[28:29], v65 offset:5216
    ds_read_b64_tr_b16 v[30:31], v65 offset:6496
    s_lshl_b32 s10, s25, 5
    v_subrev_u32 v70, s10, v70
    v_cmpx_eq_u32 vcc, 0x0, v70
    s_cbranch_execz L_NS0
    v_add_f32 v96, v96, v128
    v_add_f32 v100, v100, v132
    v_add_f32 v104, v104, v136
    v_add_f32 v108, v108, v140
    v_add_f32 v112, v112, v144
    v_add_f32 v116, v116, v148
    v_add_f32 v120, v120, v152
    v_add_f32 v124, v124, v156
L_NS0:
    s_mov_b64 exec, -1
    v_cmpx_eq_u32 vcc, 0xffffffe0, v70
    s_cbranch_execz L_NS1
    v_add_f32 v97, v97, v129
    v_add_f32 v101, v101, v133
    v_add_f32 v105, v105, v137
    v_add_f32 v109, v109, v141
    v_add_f32 v113, v113, v145
    v_add_f32 v117, v117, v149
    v_add_f32 v121, v121, v153
    v_add_f32 v125, v125, v157
L_NS1:
    s_mov_b64 exec, -1
    v_cmpx_eq_u32 vcc, 0xffffffc0, v70
    s_cbranch_execz L_NS2
    v_add_f32 v98, v98, v130
    v_add_f32 v102, v102, v134
    v_add_f32 v106, v106, v138
    v_add_f32 v110, v110, v142
    v_add_f32 v114, v114, v146
    v_add_f32 v118, v118, v150
    v_add_f32 v122, v122, v154
    v_add_f32 v126, v126, v158
L_NS2:
    s_mov_b64 exec, -1
    v_cmpx_eq_u32 vcc, 0xffffffa0, v70
    s_cbranch_execz L_NS3
    v_add_f32 v99, v99, v131
    v_add_f32 v103, v103, v135
    v_add_f32 v107, v107, v139
    v_add_f32 v111, v111, v143
    v_add_f32 v115, v115, v147
    v_add_f32 v119, v119, v151
    v_add_f32 v123, v123, v155
    v_add_f32 v127, v127, v159
L_NS3:
    s_mov_b64 exec, -1
    s_mul_i32 s10, s5, 196
    s_add_u32 s34, s10, s8
    s_min_u32 s34, s34, 50000
    s_lshl_b32 s34, s34, 7
    s_add_u32 s35, s10, s24
    s_min_u32 s35, s35, 50000
    s_lshl_b32 s35, s35, 7
    s_add_u32 s36, s10, s9
    s_min_u32 s36, s36, 50000
    s_lshl_b32 s36, s36, 7
    s_add_u32 s56, s48, s35
    s_addc_u32 s57, s49, 0
    s_sub_u32 s58, s36, s35
    s_add_u32 s48, s48, s34
    s_addc_u32 s49, s49, 0
    s_sub_u32 s50, s35, s34
    s_lshl_b32 s10, s8, 5
    s_sub_u32 s10, s22, s10
    s_lshl_b32 s10, s10, 2
    v_add_u32 v74, s10, v68
    s_lshl_b32 s10, s24, 5
    s_sub_u32 s10, s23, s10
    s_lshl_b32 s10, s10, 2
    v_add_u32 v75, s10, v68
    v_rcp_f32 v128, v128
    v_rcp_f32 v129, v129
    v_rcp_f32 v130, v130
    v_rcp_f32 v131, v131
    v_rcp_f32 v132, v132
    v_rcp_f32 v133, v133
    v_rcp_f32 v134, v134
    v_rcp_f32 v135, v135
    v_rcp_f32 v136, v136
    v_rcp_f32 v137, v137
    v_rcp_f32 v138, v138
    v_rcp_f32 v139, v139
    v_rcp_f32 v140, v140
    v_rcp_f32 v141, v141
    v_rcp_f32 v142, v142
    v_rcp_f32 v143, v143
    v_rcp_f32 v96, v96
    v_rcp_f32 v97, v97
    v_rcp_f32 v98, v98
    v_rcp_f32 v99, v99
    v_rcp_f32 v100, v100
    v_rcp_f32 v101, v101
    v_rcp_f32 v102, v102
    v_rcp_f32 v103, v103
    v_rcp_f32 v104, v104
    v_rcp_f32 v105, v105
    v_rcp_f32 v106, v106
    v_rcp_f32 v107, v107
    v_rcp_f32 v108, v108
    v_rcp_f32 v109, v109
    v_rcp_f32 v110, v110
    v_rcp_f32 v111, v111
    s_waitcnt lgkmcnt(8)
    v_lshlrev_b32 v188, 16, v32
    v_and_b32 v192, 0xffff0000, v32
    v_lshlrev_b32 v196, 16, v33
    v_and_b32 v200, 0xffff0000, v33
    v_lshlrev_b32 v189, 16, v34
    v_and_b32 v193, 0xffff0000, v34
    v_lshlrev_b32 v197, 16, v35
    v_and_b32 v201, 0xffff0000, v35
    v_lshlrev_b32 v190, 16, v36
    v_and_b32 v194, 0xffff0000, v36
    v_lshlrev_b32 v198, 16, v37
    v_and_b32 v202, 0xffff0000, v37
    v_lshlrev_b32 v191, 16, v38
    v_and_b32 v195, 0xffff0000, v38
    v_lshlrev_b32 v199, 16, v39
    v_and_b32 v203, 0xffff0000, v39
    v_lshlrev_b32 v204, 16, v40
    v_and_b32 v208, 0xffff0000, v40
    v_lshlrev_b32 v212, 16, v41
    v_and_b32 v216, 0xffff0000, v41
    v_lshlrev_b32 v205, 16, v42
    v_and_b32 v209, 0xffff0000, v42
    v_lshlrev_b32 v213, 16, v43
    v_and_b32 v217, 0xffff0000, v43
    v_lshlrev_b32 v206, 16, v44
    v_and_b32 v210, 0xffff0000, v44
    v_lshlrev_b32 v214, 16, v45
    v_and_b32 v218, 0xffff0000, v45
    v_lshlrev_b32 v207, 16, v46
    v_and_b32 v211, 0xffff0000, v46
    v_lshlrev_b32 v215, 16, v47
    v_and_b32 v219, 0xffff0000, v47
    v_pk_fma_f32 v[112:113], v[112:113], v[96:97], v[188:189]
    v_pk_fma_f32 v[114:115], v[114:115], v[98:99], v[190:191]
    v_pk_fma_f32 v[116:117], v[116:117], v[100:101], v[192:193]
    v_pk_fma_f32 v[118:119], v[118:119], v[102:103], v[194:195]
    v_pk_fma_f32 v[120:121], v[120:121], v[104:105], v[196:197]
    v_pk_fma_f32 v[122:123], v[122:123], v[106:107], v[198:199]
    v_pk_fma_f32 v[124:125], v[124:125], v[108:109], v[200:201]
    v_pk_fma_f32 v[126:127], v[126:127], v[110:111], v[202:203]
    v_pk_fma_f32 v[144:145], v[144:145], v[128:129], v[204:205]
    v_pk_fma_f32 v[146:147], v[146:147], v[130:131], v[206:207]
    v_pk_fma_f32 v[148:149], v[148:149], v[132:133], v[208:209]
    v_pk_fma_f32 v[150:151], v[150:151], v[134:135], v[210:211]
    v_pk_fma_f32 v[152:153], v[152:153], v[136:137], v[212:213]
    v_pk_fma_f32 v[154:155], v[154:155], v[138:139], v[214:215]
    v_pk_fma_f32 v[156:157], v[156:157], v[140:141], v[216:217]
    v_pk_fma_f32 v[158:159], v[158:159], v[142:143], v[218:219]
    s_waitcnt lgkmcnt(0)
    v_mfma_f32_16x16x32_bf16 v[112:115], v[160:163], v[0:3], v[112:115]
    v_lshl_add_u32 v80, v80, 2, v74
    v_mfma_f32_16x16x32_bf16 v[116:119], v[160:163], v[8:11], v[116:119]
    v_lshl_add_u32 v81, v81, 2, v74
    v_mfma_f32_16x16x32_bf16 v[120:123], v[160:163], v[16:19], v[120:123]
    v_lshl_add_u32 v82, v82, 2, v74
    v_mfma_f32_16x16x32_bf16 v[124:127], v[160:163], v[24:27], v[124:127]
    v_lshl_add_u32 v83, v83, 2, v74
    v_mfma_f32_16x16x32_bf16 v[112:115], v[164:167], v[4:7], v[112:115]
    v_lshl_add_u32 v84, v84, 2, v75
    v_mfma_f32_16x16x32_bf16 v[116:119], v[164:167], v[12:15], v[116:119]
    v_lshl_add_u32 v85, v85, 2, v75
    v_mfma_f32_16x16x32_bf16 v[120:123], v[164:167], v[20:23], v[120:123]
    v_lshl_add_u32 v86, v86, 2, v75
    v_mfma_f32_16x16x32_bf16 v[124:127], v[164:167], v[28:31], v[124:127]
    v_lshl_add_u32 v87, v87, 2, v75
    v_mfma_f32_16x16x32_bf16 v[144:147], v[168:171], v[0:3], v[144:147]
    v_mfma_f32_16x16x32_bf16 v[148:151], v[168:171], v[8:11], v[148:151]
    v_mfma_f32_16x16x32_bf16 v[152:155], v[168:171], v[16:19], v[152:155]
    v_mfma_f32_16x16x32_bf16 v[156:159], v[168:171], v[24:27], v[156:159]
    v_mfma_f32_16x16x32_bf16 v[144:147], v[172:175], v[4:7], v[144:147]
    v_mfma_f32_16x16x32_bf16 v[148:151], v[172:175], v[12:15], v[148:151]
    v_mfma_f32_16x16x32_bf16 v[152:155], v[172:175], v[20:23], v[152:155]
    v_mfma_f32_16x16x32_bf16 v[156:159], v[172:175], v[28:31], v[156:159]
    v_max_f32 v112, v112, v188
    v_max_f32 v116, v116, v192
    v_max_f32 v120, v120, v196
    v_max_f32 v124, v124, v200
    v_cvt_pk_bf16_f32 v96, v112, v116
    v_cvt_pk_bf16_f32 v97, v120, v124
    buffer_store_dwordx2 v[96:97], v80, s[48:51], 0 offen sc1
    v_max_f32 v113, v113, v189
    v_max_f32 v117, v117, v193
    v_max_f32 v121, v121, v197
    v_max_f32 v125, v125, v201
    v_cvt_pk_bf16_f32 v98, v113, v117
    v_cvt_pk_bf16_f32 v99, v121, v125
    buffer_store_dwordx2 v[98:99], v81, s[48:51], 0 offen sc1
    v_max_f32 v114, v114, v190
    v_max_f32 v118, v118, v194
    v_max_f32 v122, v122, v198
    v_max_f32 v126, v126, v202
    v_cvt_pk_bf16_f32 v100, v114, v118
    v_cvt_pk_bf16_f32 v101, v122, v126
    buffer_store_dwordx2 v[100:101], v82, s[48:51], 0 offen sc1
    v_max_f32 v115, v115, v191
    v_max_f32 v119, v119, v195
    v_max_f32 v123, v123, v199
    v_max_f32 v127, v127, v203
    v_cvt_pk_bf16_f32 v102, v115, v119
    v_cvt_pk_bf16_f32 v103, v123, v127
    buffer_store_dwordx2 v[102:103], v83, s[48:51], 0 offen sc1
    v_max_f32 v144, v144, v204
    v_max_f32 v148, v148, v208
    v_max_f32 v152, v152, v212
    v_max_f32 v156, v156, v216
    v_cvt_pk_bf16_f32 v128, v144, v148
    v_cvt_pk_bf16_f32 v129, v152, v156
    buffer_store_dwordx2 v[128:129], v84, s[56:59], 0 offen sc1
    v_max_f32 v145, v145, v205
    v_max_f32 v149, v149, v209
    v_max_f32 v153, v153, v213
    v_max_f32 v157, v157, v217
    v_cvt_pk_bf16_f32 v130, v145, v149
    v_cvt_pk_bf16_f32 v131, v153, v157
    buffer_store_dwordx2 v[130:131], v85, s[56:59], 0 offen sc1
    v_max_f32 v146, v146, v206
    v_max_f32 v150, v150, v210
    v_max_f32 v154, v154, v214
    v_max_f32 v158, v158, v218
    v_cvt_pk_bf16_f32 v132, v146, v150
    v_cvt_pk_bf16_f32 v133, v154, v158
    buffer_store_dwordx2 v[132:133], v86, s[56:59], 0 offen sc1
    v_max_f32 v147, v147, v207
    v_max_f32 v151, v151, v211
    v_max_f32 v155, v155, v215
    v_max_f32 v159, v159, v219
    v_cvt_pk_bf16_f32 v134, v147, v151
    v_cvt_pk_bf16_f32 v135, v155, v159
    buffer_store_dwordx2 v[134:135], v87, s[56:59], 0 offen sc1
L_END:
    s_endpgm
L_RETRY:
    s_add_u32 s100, s100, 1
    s_cmp_gt_u32 s100, 200000
    s_cbranch_scc1 L_END
    s_sleep 1
    s_cmp_eq_u64 s[64:65], 0
    s_cbranch_scc1 L_RT0
    buffer_load_dwordx4 v[128:131], v232, s[56:59], 0 offen sc1
    buffer_load_dwordx2 v[144:145], v233, s[60:63], 0 offen sc1
L_RT0:
    s_cmp_eq_u64 s[66:67], 0
    s_cbranch_scc1 L_RT1
    buffer_load_dwordx4 v[132:135], v232, s[56:59], s26 offen sc1
    buffer_load_dwordx2 v[146:147], v233, s[60:63], s26 offen sc1
L_RT1:
    s_cmp_eq_u64 s[68:69], 0
    s_cbranch_scc1 L_RT2
    buffer_load_dwordx4 v[136:139], v232, s[56:59], s27 offen sc1
    buffer_load_dwordx2 v[148:149], v233, s[60:63], s27 offen sc1
L_RT2:
    s_cmp_eq_u64 s[70:71], 0
    s_cbranch_scc1 L_RT3
    buffer_load_dwordx4 v[140:143], v232, s[56:59], s28 offen sc1
    buffer_load_dwordx2 v[150:151], v233, s[60:63], s28 offen sc1
L_RT3:
    s_waitcnt vmcnt(0)
    s_cmp_eq_u64 s[64:65], 0
    s_cbranch_scc1 L_RC0
    v_xor_b32 v128, v128, v237
    v_xor_b32 v129, v129, v186
    v_xor_b32 v130, v130, v186
    v_xor_b32 v131, v131, v186
    v_xor_b32 v144, v144, v187
    v_xor_b32 v145, v145, v187
    v_or3_b32 v188, v129, v130, v131
    v_or_b32 v189, v144, v145
    v_and_b32 v190, v128, v236
    v_and_or_b32 v190, v188, s16, v190
    v_and_or_b32 v190, v189, s17, v190
    v_cmp_ne_u32 s[64:65], 0, v190
L_RC0:
    s_cmp_eq_u64 s[66:67], 0
    s_cbranch_scc1 L_RC1
    v_xor_b32 v132, v132, v237
    v_xor_b32 v133, v133, v186
    v_xor_b32 v134, v134, v186
    v_xor_b32 v135, v135, v186
    v_xor_b32 v146, v146, v187
    v_xor_b32 v147, v147, v187
    v_or3_b32 v188, v133, v134, v135
    v_or_b32 v189, v146, v147
    v_and_b32 v190, v132, v236
    v_and_or_b32 v190, v188, s16, v190
    v_and_or_b32 v190, v189, s17, v190
    v_cmp_ne_u32 s[66:67], 0, v190
L_RC1:
    s_cmp_eq_u64 s[68:69], 0
    s_cbranch_scc1 L_RC2
    v_xor_b32 v136, v136, v237
    v_xor_b32 v137, v137, v186
    v_xor_b32 v138, v138, v186
    v_xor_b32 v139, v139, v186
    v_xor_b32 v148, v148, v187
    v_xor_b32 v149, v149, v187
    v_or3_b32 v188, v137, v138, v139
    v_or_b32 v189, v148, v149
    v_and_b32 v190, v136, v236
    v_and_or_b32 v190, v188, s16, v190
    v_and_or_b32 v190, v189, s17, v190
    v_cmp_ne_u32 s[68:69], 0, v190
L_RC2:
    s_cmp_eq_u64 s[70:71], 0
    s_cbranch_scc1 L_RC3
    v_xor_b32 v140, v140, v237
    v_xor_b32 v141, v141, v186
    v_xor_b32 v142, v142, v186
    v_xor_b32 v143, v143, v186
    v_xor_b32 v150, v150, v187
    v_xor_b32 v151, v151, v187
    v_or3_b32 v188, v141, v142, v143
    v_or_b32 v189, v150, v151
    v_and_b32 v190, v140, v236
    v_and_or_b32 v190, v188, s16, v190
    v_and_or_b32 v190, v189, s17, v190
    v_cmp_ne_u32 s[70:71], 0, v190
L_RC3:
    s_branch L_POLL
L_J3A:
    s_mov_b32 s16, 0x1e00000
    s_waitcnt lgkmcnt(0)
    v_lshrrev_b32 v99, 19, v131
    v_add_u32_sdwa v207, v145, v156 dst_sel:DWORD dst_unused:UNUSED_PAD src0_sel:WORD_1 src1_sel:DWORD
    v_and_or_b32 v207, v131, s16, v207
    s_mov_b64 exec, s[70:71]
    ds_add_rtn_u32 v115, v99, v184 offset:1024
    s_mov_b64 exec, -1
    v_lshrrev_b32 v103, 19, v135
    v_add_u32_sdwa v211, v147, v157 dst_sel:DWORD dst_unused:UNUSED_PAD src0_sel:WORD_1 src1_sel:DWORD
    v_and_or_b32 v211, v135, s16, v211
    s_mov_b64 exec, s[78:79]
    ds_add_rtn_u32 v119, v103, v184 offset:1024
    s_mov_b64 exec, -1
    v_lshrrev_b32 v107, 19, v139
    v_add_u32_sdwa v215, v149, v158 dst_sel:DWORD dst_unused:UNUSED_PAD src0_sel:WORD_1 src1_sel:DWORD
    v_and_or_b32 v215, v139, s16, v215
    s_mov_b64 exec, s[86:87]
    ds_add_rtn_u32 v123, v107, v184 offset:1024
    s_mov_b64 exec, -1
    v_lshrrev_b32 v111, 19, v143
    v_add_u32_sdwa v219, v151, v159 dst_sel:DWORD dst_unused:UNUSED_PAD src0_sel:WORD_1 src1_sel:DWORD
    v_and_or_b32 v219, v143, s16, v219
    s_mov_b64 exec, s[94:95]
    ds_add_rtn_u32 v127, v111, v184 offset:1024
    s_mov_b64 exec, -1
    v_max3_u32 v188, v152, v153, v154
    v_max_u32 v188, v188, v155
    v_cmp_lt_u32 vcc, 2097152, v188
    s_cbranch_vccz L_J3AR
    s_mov_b32 s21, 1
    v_cmp_lt_u32 vcc, 2621440, v188
    s_cbranch_vccz L_XT0
    v_mov_b32 v189, 640
    ds_write_b32 v189, v184 offset:4
L_XT0:
    v_add_u32 v182, 32, v176
    v_mov_b32 v189, 0x1ffffff0
    v_mov_b32_dpp v220, v144 row_newbcast:0 row_mask:0xf bank_mask:0x3
    v_mov_b32_dpp v220, v144 row_newbcast:8 row_mask:0xf bank_mask:0xc
    v_lshrrev_b32 v183, 16, v152
    v_cmp_lt_u32 vcc, v182, v183
    v_and_b32 v220, 0xffff, v220
    v_add3_u32 v220, v220, v156, v182
    v_cndmask_b32 v220, v189, v220, vcc
    v_lshlrev_b32 v228, 2, v220
    v_lshlrev_b32 v232, 1, v220
    s_mov_b32 s10, 16777212
    s_mov_b32 s11, 20971518
    buffer_load_dword v228, v228, s[52:55], s10 offen sc1
    buffer_load_ushort v232, v232, s[52:55], s11 offen sc1
    v_mov_b32_dpp v221, v146 row_newbcast:0 row_mask:0xf bank_mask:0x3
    v_mov_b32_dpp v221, v146 row_newbcast:8 row_mask:0xf bank_mask:0xc
    v_lshrrev_b32 v183, 16, v153
    v_cmp_lt_u32 vcc, v182, v183
    v_and_b32 v221, 0xffff, v221
    v_add3_u32 v221, v221, v157, v182
    v_cndmask_b32 v221, v189, v221, vcc
    v_lshlrev_b32 v229, 2, v221
    v_lshlrev_b32 v233, 1, v221
    s_mov_b32 s10, 16777212
    s_mov_b32 s11, 20971518
    buffer_load_dword v229, v229, s[52:55], s10 offen sc1
    buffer_load_ushort v233, v233, s[52:55], s11 offen sc1
    v_mov_b32_dpp v222, v148 row_newbcast:0 row_mask:0xf bank_mask:0x3
    v_mov_b32_dpp v222, v148 row_newbcast:8 row_mask:0xf bank_mask:0xc
    v_lshrrev_b32 v183, 16, v154
    v_cmp_lt_u32 vcc, v182, v183
    v_and_b32 v222, 0xffff, v222
    v_add3_u32 v222, v222, v158, v182
    v_cndmask_b32 v222, v189, v222, vcc
    v_lshlrev_b32 v230, 2, v222
    v_lshlrev_b32 v234, 1, v222
    s_mov_b32 s10, 16777212
    s_mov_b32 s11, 20971518
    buffer_load_dword v230, v230, s[52:55], s10 offen sc1
    buffer_load_ushort v234, v234, s[52:55], s11 offen sc1
    v_mov_b32_dpp v223, v150 row_newbcast:0 row_mask:0xf bank_mask:0x3
    v_mov_b32_dpp v223, v150 row_newbcast:8 row_mask:0xf bank_mask:0xc
    v_lshrrev_b32 v183, 16, v155
    v_cmp_lt_u32 vcc, v182, v183
    v_and_b32 v223, 0xffff, v223
    v_add3_u32 v223, v223, v159, v182
    v_cndmask_b32 v223, v189, v223, vcc
    v_lshlrev_b32 v231, 2, v223
    v_lshlrev_b32 v235, 1, v223
    s_mov_b32 s10, 16777212
    s_mov_b32 s11, 20971518
    buffer_load_dword v231, v231, s[52:55], s10 offen sc1
    buffer_load_ushort v235, v235, s[52:55], s11 offen sc1
    s_waitcnt vmcnt(0)
    v_lshrrev_b32 v183, 16, v152
    v_cmp_lt_u32 vcc, v182, v183
    v_lshrrev_b32 v220, 19, v228
    v_add_u32 v232, v232, v156
    v_and_or_b32 v232, v228, s16, v232
    s_mov_b64 exec, vcc
    ds_add_rtn_u32 v236, v220, v184 offset:1024
    s_mov_b64 exec, -1
    v_lshrrev_b32 v183, 16, v153
    v_cmp_lt_u32 vcc, v182, v183
    v_lshrrev_b32 v221, 19, v229
    v_add_u32 v233, v233, v157
    v_and_or_b32 v233, v229, s16, v233
    s_mov_b64 exec, vcc
    ds_add_rtn_u32 v237, v221, v184 offset:1024
    s_mov_b64 exec, -1
    v_lshrrev_b32 v183, 16, v154
    v_cmp_lt_u32 vcc, v182, v183
    v_lshrrev_b32 v222, 19, v230
    v_add_u32 v234, v234, v158
    v_and_or_b32 v234, v230, s16, v234
    s_mov_b64 exec, vcc
    ds_add_rtn_u32 v238, v222, v184 offset:1024
    s_mov_b64 exec, -1
    v_lshrrev_b32 v183, 16, v155
    v_cmp_lt_u32 vcc, v182, v183
    v_lshrrev_b32 v223, 19, v231
    v_add_u32 v235, v235, v159
    v_and_or_b32 v235, v231, s16, v235
    s_mov_b64 exec, vcc
    ds_add_rtn_u32 v239, v223, v184 offset:1024
    s_mov_b64 exec, -1
    s_branch L_J3AR
L_J3B:
    s_waitcnt lgkmcnt(0)
    s_mov_b64 exec, s[70:71]
    ds_read_u16 v99, v99 offset:1026
    s_mov_b64 exec, s[78:79]
    ds_read_u16 v103, v103 offset:1026
    s_mov_b64 exec, s[86:87]
    ds_read_u16 v107, v107 offset:1026
    s_mov_b64 exec, s[94:95]
    ds_read_u16 v111, v111 offset:1026
    s_waitcnt lgkmcnt(0)
    s_mov_b64 exec, s[70:71]
    v_add_u32 v99, v99, v115
    ds_write_b16 v99, v131 offset:46080
    ds_write_b32 v99, v207 offset:64512
    s_mov_b64 exec, s[78:79]
    v_add_u32 v103, v103, v119
    ds_write_b16 v103, v135 offset:46080
    ds_write_b32 v103, v211 offset:64512
    s_mov_b64 exec, s[86:87]
    v_add_u32 v107, v107, v123
    ds_write_b16 v107, v139 offset:46080
    ds_write_b32 v107, v215 offset:64512
    s_mov_b64 exec, s[94:95]
    v_add_u32 v111, v111, v127
    ds_write_b16 v111, v143 offset:46080
    ds_write_b32 v111, v219 offset:64512
    s_mov_b64 exec, -1
    s_cmp_eq_u32 s21, 0
    s_cbranch_scc1 L_J3BR
    ds_read_u16 v220, v220 offset:1026
    ds_read_u16 v221, v221 offset:1026
    ds_read_u16 v222, v222 offset:1026
    ds_read_u16 v223, v223 offset:1026
    s_waitcnt lgkmcnt(0)
    v_lshrrev_b32 v183, 16, v152
    v_cmp_lt_u32 vcc, v182, v183
    v_add_u32 v220, v220, v236
    s_mov_b64 exec, vcc
    ds_write_b16 v220, v228 offset:46080
    ds_write_b32 v220, v232 offset:64512
    s_mov_b64 exec, -1
    v_lshrrev_b32 v183, 16, v153
    v_cmp_lt_u32 vcc, v182, v183
    v_add_u32 v221, v221, v237
    s_mov_b64 exec, vcc
    ds_write_b16 v221, v229 offset:46080
    ds_write_b32 v221, v233 offset:64512
    s_mov_b64 exec, -1
    v_lshrrev_b32 v183, 16, v154
    v_cmp_lt_u32 vcc, v182, v183
    v_add_u32 v222, v222, v238
    s_mov_b64 exec, vcc
    ds_write_b16 v222, v230 offset:46080
    ds_write_b32 v222, v234 offset:64512
    s_mov_b64 exec, -1
    v_lshrrev_b32 v183, 16, v155
    v_cmp_lt_u32 vcc, v182, v183
    v_add_u32 v223, v223, v239
    s_mov_b64 exec, vcc
    ds_write_b16 v223, v231 offset:46080
    ds_write_b32 v223, v235 offset:64512
    s_mov_b64 exec, -1
    s_branch L_J3BR
L_OVF:
    s_mov_b32 s20, 0
    s_mov_b32 s17, 0
    s_mov_b32 s19, 4
    s_waitcnt lgkmcnt(0)
    ds_read_b64_tr_b16 v[64:65], v199 offset:0
    ds_read_b64_tr_b16 v[66:67], v200 offset:0
    ds_read_b64_tr_b16 v[68:69], v199 offset:32
    ds_read_b64_tr_b16 v[70:71], v200 offset:32
    ds_read_b64_tr_b16 v[72:73], v199 offset:64
    ds_read_b64_tr_b16 v[74:75], v200 offset:64
    ds_read_b64_tr_b16 v[76:77], v199 offset:96
    ds_read_b64_tr_b16 v[78:79], v200 offset:96
    s_waitcnt lgkmcnt(0)
    ds_read_b64_tr_b16 v[80:81], v201 offset:0
    ds_read_b64_tr_b16 v[82:83], v194 offset:0
    ds_read_b64_tr_b16 v[84:85], v201 offset:32
    ds_read_b64_tr_b16 v[86:87], v194 offset:32
    ds_read_b64_tr_b16 v[88:89], v201 offset:64
    ds_read_b64_tr_b16 v[90:91], v194 offset:64
    ds_read_b64_tr_b16 v[92:93], v201 offset:96
    ds_read_b64_tr_b16 v[94:95], v194 offset:96
    s_waitcnt lgkmcnt(0)
    s_branch L_J3BR
L_POVF:
    v_lshrrev_b32 v64, 16, v192
    v_subrev_u32 v64, 1, v64
    v_lshrrev_b32 v65, 16, v193
    v_subrev_u32 v65, 1, v65
    v_lshrrev_b32 v66, 16, v194
    v_subrev_u32 v66, 1, v66
    v_lshrrev_b32 v67, 16, v195
    v_subrev_u32 v67, 1, v67
    v_add_u32 v69, v64, v65
    v_add_u32 v70, v69, v66
    v_add_u32 v71, v70, v67
    v_mov_b32 v72, v71
    s_nop 1
    v_add_u32_dpp v72, v72, v72 row_shr:1 row_mask:0xf bank_mask:0xf bound_ctrl:0
    s_nop 1
    v_add_u32_dpp v72, v72, v72 row_shr:2 row_mask:0xf bank_mask:0xf bound_ctrl:0
    s_nop 1
    v_add_u32_dpp v72, v72, v72 row_shr:4 row_mask:0xf bank_mask:0xf bound_ctrl:0
    s_nop 1
    v_add_u32_dpp v72, v72, v72 row_shr:8 row_mask:0xf bank_mask:0xf bound_ctrl:0
    s_nop 1
    v_add_u32_dpp v72, v72, v72 row_bcast:15 row_mask:0xa bank_mask:0xf
    s_nop 1
    v_add_u32_dpp v72, v72, v72 row_bcast:31 row_mask:0xc bank_mask:0xf
    s_nop 0
    v_sub_u32 v68, v72, v71
    v_add_u32 v71, v68, v70
    v_add_u32 v70, v68, v69
    v_add_u32 v69, v68, v64
    v_mul_u32_u24 v72, 320, v253
    v_add_u32 v72, 87040, v72
    s_waitcnt lgkmcnt(0)
    ds_write_b16 v72, v68 offset:0
    ds_write_b16 v72, v69 offset:80
    ds_write_b16 v72, v70 offset:160
    ds_write_b16 v72, v71 offset:240
    ds_read_b128 v[196:199], v222 offset:40960
    ds_read_b128 v[200:203], v222 offset:51200
    s_mul_i32 s10, s2, 3128
    s_cmp_eq_u32 s3, 0
    s_cselect_b64 s[72:73], s[72:73], 0
    v_lshlrev_b32 v64, 1, v112
    v_and_b32 v64, 0x1fffe, v64
    ds_read_u16 v64, v64 offset:64000
    v_lshlrev_b32 v65, 1, v113
    v_and_b32 v65, 0x1fffe, v65
    ds_read_u16 v65, v65 offset:64000
    v_lshlrev_b32 v66, 1, v114
    v_and_b32 v66, 0x1fffe, v66
    ds_read_u16 v66, v66 offset:64000
    v_lshlrev_b32 v67, 1, v115
    v_and_b32 v67, 0x1fffe, v67
    ds_read_u16 v67, v67 offset:64000
    v_lshlrev_b32 v68, 1, v116
    v_and_b32 v68, 0x1fffe, v68
    ds_read_u16 v68, v68 offset:64000
    v_lshlrev_b32 v69, 1, v117
    v_and_b32 v69, 0x1fffe, v69
    ds_read_u16 v69, v69 offset:64000
    v_lshlrev_b32 v70, 1, v118
    v_and_b32 v70, 0x1fffe, v70
    ds_read_u16 v70, v70 offset:64000
    s_waitcnt lgkmcnt(0)
    s_mov_b32 s34, 16777212
    s_mov_b32 s35, 20971518
    v_add3_u32 v64, v64, v128, s10
    v_cmp_le_u32 vcc, 32, v128
    v_lshlrev_b32 v72, 2, v64
    v_lshlrev_b32 v64, 1, v64
    s_and_b64 exec, vcc, -1
    s_cbranch_execz L_PO0
    buffer_store_short v136, v64, s[52:55], s35 offen sc1
    buffer_store_dword v104, v72, s[52:55], s34 offen sc1
L_PO0:
    s_mov_b64 exec, -1
    v_add3_u32 v65, v65, v129, s10
    v_cmp_le_u32 vcc, 32, v129
    v_lshlrev_b32 v73, 2, v65
    v_lshlrev_b32 v65, 1, v65
    s_and_b64 exec, vcc, -1
    s_cbranch_execz L_PO1
    buffer_store_short v137, v65, s[52:55], s35 offen sc1
    buffer_store_dword v105, v73, s[52:55], s34 offen sc1
L_PO1:
    s_mov_b64 exec, -1
    v_add3_u32 v66, v66, v130, s10
    v_cmp_le_u32 vcc, 32, v130
    v_lshlrev_b32 v74, 2, v66
    v_lshlrev_b32 v66, 1, v66
    s_and_b64 exec, vcc, -1
    s_cbranch_execz L_PO2
    buffer_store_short v138, v66, s[52:55], s35 offen sc1
    buffer_store_dword v106, v74, s[52:55], s34 offen sc1
L_PO2:
    s_mov_b64 exec, -1
    v_add3_u32 v67, v67, v131, s10
    v_cmp_le_u32 vcc, 32, v131
    v_lshlrev_b32 v75, 2, v67
    v_lshlrev_b32 v67, 1, v67
    s_and_b64 exec, vcc, -1
    s_cbranch_execz L_PO3
    buffer_store_short v139, v67, s[52:55], s35 offen sc1
    buffer_store_dword v107, v75, s[52:55], s34 offen sc1
L_PO3:
    s_mov_b64 exec, -1
    v_add3_u32 v68, v68, v132, s10
    v_cmp_le_u32 vcc, 32, v132
    v_lshlrev_b32 v76, 2, v68
    v_lshlrev_b32 v68, 1, v68
    s_and_b64 exec, vcc, s[70:71]
    s_cbranch_execz L_PO4
    buffer_store_short v140, v68, s[52:55], s35 offen sc1
    buffer_store_dword v108, v76, s[52:55], s34 offen sc1
L_PO4:
    s_mov_b64 exec, -1
    v_add3_u32 v69, v69, v133, s10
    v_cmp_le_u32 vcc, 32, v133
    v_lshlrev_b32 v77, 2, v69
    v_lshlrev_b32 v69, 1, v69
    s_and_b64 exec, vcc, s[70:71]
    s_cbranch_execz L_PO5
    buffer_store_short v141, v69, s[52:55], s35 offen sc1
    buffer_store_dword v109, v77, s[52:55], s34 offen sc1
L_PO5:
    s_mov_b64 exec, -1
    v_add3_u32 v70, v70, v134, s10
    v_cmp_le_u32 vcc, 32, v134
    v_lshlrev_b32 v78, 2, v70
    v_lshlrev_b32 v70, 1, v70
    s_and_b64 exec, vcc, s[72:73]
    s_cbranch_execz L_PO6
    buffer_store_short v142, v70, s[52:55], s35 offen sc1
    buffer_store_dword v110, v78, s[52:55], s34 offen sc1
L_PO6:
    s_mov_b64 exec, -1
    s_waitcnt vmcnt(0) lgkmcnt(0)
    s_barrier
    s_branch L_POUT
L_SLOW:
    s_setprio 0
    s_lshl_b32 s10, s3, 6
    v_add_u32 v255, s10, v253
    s_cmp_lg_u32 s19, 4
    s_cbranch_scc1 L_SL1
    s_mov_b32 s19, 1
    v_and_b32 v188, 0xff, v255
    v_lshlrev_b32 v189, 7, v188
    buffer_load_dword v190, v189, s[56:59], 0 offen sc1
    buffer_load_ushort v191, v189, s[60:63], 0 offen sc1
    v_lshlrev_b32 v188, 2, v188
    v_add_u32 v188, 157312, v188
    s_waitcnt vmcnt(0)
    v_and_b32 v190, 0xfff0000, v190
    v_and_b32 v191, 0xfff, v191
    v_or_b32 v190, v190, v191
    v_subrev_u32 v190, 0x10000, v190
    ds_write_b32 v188, v190
    s_waitcnt lgkmcnt(0)
    s_barrier
L_SL1:
    s_add_u32 s28, s28, 288
    s_cmp_lt_u32 s28, s29
    s_cbranch_scc1 L_BATCH
L_FIND:
    s_cmp_lg_u64 s[32:33], 0
    s_cbranch_scc1 L_GOT
    s_add_u32 s26, s26, 1
    s_cmp_ge_u32 s26, 4
    s_cbranch_scc1 L_EPI
    s_lshl_b32 s10, s26, 8
    s_add_u32 s10, s10, 157312
    v_lshl_add_u32 v188, v253, 2, s10
    ds_read_u16 v188, v188 offset:2
    s_waitcnt lgkmcnt(0)
    v_cmp_lt_u32 s[32:33], s20, v188
    s_nop 3
    s_branch L_FIND
L_GOT:
    s_ff1_i32_b64 s10, s[32:33]
    s_bitset0_b64 s[32:33], s10
    s_lshl_b32 s11, s26, 6
    s_add_u32 s27, s10, s11
    s_lshl_b32 s10, s27, 2
    s_add_u32 s10, s10, 157312
    v_mov_b32 v188, s10
    ds_read_b32 v188, v188
    s_waitcnt lgkmcnt(0)
    v_readfirstlane_b32 s10, v188
    s_nop 3
    s_lshr_b32 s29, s10, 16
    s_and_b32 s30, s10, 0xffff
    s_mov_b32 s28, s20
L_BATCH:
    s_waitcnt vmcnt(0)
    s_barrier
    v_and_b32 v200, 7, v253
    s_lshl_b32 s10, s14, 16
    v_lshl_add_u32 v192, v200, 23, s10
    v_add_u32 v193, 0x200000, v192
    v_add_u32 v194, 0x400000, v192
    v_add_u32 v195, 0x600000, v192
    v_mov_b32 v196, 0x20fffff
    v_mov_b32 v197, 0x20fffff
    v_mov_b32 v198, 0x20fffff
    v_mov_b32 v199, 0x20fffff
    v_lshl_add_u32 v200, v253, 4, s12
    ds_write_b128 v200, v[192:195] offset:0
    ds_write_b128 v200, v[196:199] offset:18432
    ds_write_b128 v200, v[192:195] offset:1024
    ds_write_b128 v200, v[196:199] offset:19456
    ds_write_b128 v200, v[192:195] offset:1280
    ds_write_b128 v200, v[196:199] offset:19712
    v_and_b32 v188, 15, v253
    v_mul_u32_u24 v189, 1152, v188
    v_lshlrev_b32 v188, 2, v188
    ds_write_b32 v188, v189 offset:576
    v_add_u32 v188, s28, v255
    v_add_u32 v190, 1, v188
    v_mul_u32_u24 v190, 33, v190
    v_bfe_u32 v190, v190, 3, 5
    s_mul_i32 s36, s27, 3128
    s_add_u32 s11, s36, s30
    v_cmp_gt_u32 vcc, 31, v188
    s_lshl_b32 s34, s11, 2
    s_add_u32 s34, s34, 16777216
    v_lshl_add_u32 v189, v188, 2, s34
    s_mul_i32 s10, s5, 32896
    s_lshl_b32 s35, s27, 7
    s_add_u32 s35, s35, 65536
    s_add_u32 s10, s10, s35
    v_lshl_add_u32 v191, v190, 2, s10
    v_cndmask_b32 v189, v189, v191, vcc
    s_lshr_b32 s10, s5, 1
    s_add_u32 s10, s10, 256
    s_mul_i32 s10, s10, 32896
    s_add_u32 s10, s10, s35
    s_and_b32 s34, s5, 1
    s_lshl_b32 s34, s34, 6
    s_add_u32 s10, s10, s34
    v_lshl_add_u32 v190, v190, 1, s10
    s_lshl_b32 s34, s11, 1
    s_add_u32 s34, s34, 20971520
    v_lshl_add_u32 v191, v188, 1, s34
    v_cndmask_b32 v191, v191, v190, vcc
    s_add_u32 s10, s28, 288
    s_min_u32 s10, s10, s29
    v_cmp_gt_u32 vcc, s10, v188
    v_mov_b32 v190, 0x7ffffff0
    s_mov_b32 s16, 0x1e00000
    v_cndmask_b32 v189, v190, v189, vcc
    v_cndmask_b32 v191, v190, v191, vcc
    buffer_load_dword v189, v189, s[52:55], 0 offen sc1
    buffer_load_ushort v191, v191, s[52:55], 0 offen sc1
    s_waitcnt lgkmcnt(0)
    s_barrier
    s_mov_b64 exec, vcc
    s_waitcnt vmcnt(0)
    v_bfe_u32 v188, v189, 21, 8
    v_lshlrev_b32 v188, 2, v188
    v_add_u32 v188, 156288, v188
    ds_read_b32 v188, v188
    v_mov_b32 v190, 4
    v_and_b32 v191, 0xfff, v191
    v_add_u32 v191, s36, v191
    v_and_or_b32 v191, v189, s16, v191
    s_waitcnt lgkmcnt(0)
    ds_add_rtn_u32 v188, v188, v190 offset:576
    s_waitcnt lgkmcnt(0)
    ds_write_b16 v188, v189 offset:46080
    ds_write_b32 v188, v191 offset:64512
    s_mov_b64 exec, -1
    s_waitcnt lgkmcnt(0)
    s_barrier
    s_lshl_b32 s10, s4, 3
    v_mov_b32 v188, s10
    ds_read_b64 v[190:191], v188 offset:576
    v_lshrrev_b32 v189, 3, v253
    v_lshl_add_u32 v247, v189, 4, s12
    s_add_u32 s10, s12, 18432
    v_lshrrev_b32 v189, 1, v253
    v_lshl_add_u32 v248, v189, 2, s10
    s_add_u32 s10, s10, 2
    v_and_b32 v189, 48, v253
    v_lshl_add_u32 v250, v189, 1, s10
    v_and_b32 v189, 12, v253
    v_add_u32 v250, v250, v189
    v_lshrrev_b32 v189, 5, v253
    v_mul_u32_u24 v249, 18432, v189
    v_and_b32 v189, 15, v253
    v_lshl_add_u32 v249, v189, 2, v249
    s_add_u32 s10, s12, 2
    v_add_u32 v249, s10, v249
    ds_read_b128 v[236:239], v247
    ds_read_b32 v240, v248
    s_waitcnt lgkmcnt(0)
    v_readfirstlane_b32 s34, v190
    v_readfirstlane_b32 s35, v191
    s_add_u32 m0, s13, 0
    v_mad_u32_u16 v236, v236, s15, v243
    buffer_load_dwordx4 v236, s[40:43], 0 offen lds
    s_add_u32 m0, s13, 1056
    v_mad_u32_u16 v237, v237, s15, v243
    buffer_load_dwordx4 v237, s[40:43], 0 offen lds
    s_add_u32 m0, s13, 2112
    v_mad_u32_u16 v238, v238, s15, v243
    buffer_load_dwordx4 v238, s[40:43], 0 offen lds
    s_add_u32 m0, s13, 3168
    v_mad_u32_u16 v239, v239, s15, v243
    buffer_load_dwordx4 v239, s[40:43], 0 offen lds
    s_mov_b32 m0, s14
    v_and_b32 v240, 0xfffff, v240
    buffer_load_dwordx4 v[240:241], s[44:47], 0 idxen offen lds
    s_sub_u32 s10, s12, 46080
    s_sub_u32 s34, s34, s10
    s_sub_u32 s35, s35, s10
    s_sub_u32 s35, s35, 1152
    s_add_u32 s10, s34, 127
    s_lshr_b32 s10, s10, 7
    s_lshl1_add_u32 s10, s10, -1
    s_add_u32 s11, s35, 127
    s_lshr_b32 s11, s11, 6
    s_and_b32 s11, s11, -2
    s_max_i32 s17, s10, s11
L_LAST:
    s_branch L_GO
.section .rodata,"a"
.p2align 6
.amdhsa_kernel standalone__edge_featured_mpnn_gatedgcn__graph_kernel
  .amdhsa_next_free_vgpr 256
  .amdhsa_next_free_sgpr 102
  .amdhsa_accum_offset 256
  .amdhsa_group_segment_fixed_size 0
  .amdhsa_kernarg_size 96
  .amdhsa_user_sgpr_count 2
  .amdhsa_user_sgpr_kernarg_segment_ptr 1
  .amdhsa_system_sgpr_workgroup_id_x 1
.end_amdhsa_kernel
```

```asm
; @launch grid=(256,1,1) block=(512,1,1) lds=156800
.amdgcn_target "amdgcn-amd-amdhsa--gfx950"
.text
.globl standalone__edge_featured_mpnn_gatedgcn__graph_kernel
.p2align 8
.type standalone__edge_featured_mpnn_gatedgcn__graph_kernel,@function
standalone__edge_featured_mpnn_gatedgcn__graph_kernel:
    s_load_dwordx16 s[16:31], s[0:1], 0
    s_load_dwordx8 s[32:39], s[0:1], 64
    s_getpc_b64 s[64:65]
L_PC:
    s_and_b32 s3, s2, -8
    v_add_lshl_u32 v1, v0, s3, 7
    v_min_u32 v1, L_LAST-L_PC, v1
    v_cmpx_gt_u32 vcc, 8, v0
    s_cbranch_execz L_NOCPF
    global_load_dword v251, v1, s[64:65]
L_NOCPF:
    s_mov_b64 exec, -1
    s_cmp_ge_u32 s2, 256
    s_cbranch_scc1 L_END
    s_mul_i32 s10, s2, 12512
    v_lshl_add_u32 v1, v0, 4, s10
    s_add_u32 s11, s10, 12512
    s_min_u32 s11, s11, 3200000
    v_add_u32 v2, 0x2000, v1
    s_waitcnt lgkmcnt(0)
    global_load_dwordx4 v[96:99], v1, s[22:23] nt
    global_load_dwordx4 v[104:107], v1, s[20:21] nt
    v_cmpx_gt_u32 s[70:71], s11, v2
    s_cbranch_execz L_NO7
    global_load_dwordx4 v[100:103], v2, s[22:23] nt
    global_load_dwordx4 v[108:111], v2, s[20:21] nt
L_NO7:
    s_mov_b64 exec, -1
    s_load_dword s6, s[38:39], 0
    v_mov_b32 v255, v0
    v_lshrrev_b32 v188, 6, v0
    v_and_b32 v253, 63, v0
    v_readfirstlane_b32 s3, v188
    v_lshlrev_b32 v232, 4, v0
    v_lshlrev_b32 v190, 3, v0
    v_lshlrev_b32 v191, 2, v0
    v_and_b32 v192, 0x3fc, v191
    s_and_b32 s5, s2, 7
    s_lshr_b32 s4, s2, 3
    s_lshl_b32 s5, s5, 5
    s_add_u32 s5, s5, s4
    s_mul_i32 s9, s5, 196
    s_cmp_eq_u32 s3, 7
    s_cselect_b32 s101, 0, s3
    s_lshl_b32 s12, s101, 5
    s_add_u32 s9, s9, s12
    v_lshrrev_b32 v193, 3, v253
    v_lshl_add_u32 v193, v193, 2, s9
    v_and_b32 v243, 7, v253
    v_lshlrev_b32 v243, 4, v243
    v_lshl_add_u32 v234, v193, 7, v243
    s_lshl_b32 s101, s101, 10
    s_add_u32 s101, s101, 116736
    v_mov_b64 v[196:197], 0
    v_mov_b64 v[198:199], 0
    v_mov_b32 v194, 132
    ds_write2st64_b32 v192, v194, v196 offset0:20 offset1:24
    v_add_u32 v193, 46080, v232
    ds_write_b128 v193, v[196:199] offset:0
    ds_write_b128 v193, v[196:199] offset:8192
    ds_write_b128 v193, v[196:199] offset:16384
    ds_write_b128 v193, v[196:199] offset:24576
    ds_write_b128 v193, v[196:199] offset:32768
    s_mov_b32 s44, s18
    s_or_b32 s45, s19, 0x200000
    s_mov_b32 s46, 800000
    s_mov_b32 s47, 0x20000
    s_mov_b32 s48, s34
    s_mov_b32 s49, s35
    s_mov_b32 s50, 6400000
    s_mov_b32 s51, 0x20000
    s_mov_b32 s40, s16
    s_mov_b32 s41, s17
    s_mov_b32 s42, 6400000
    s_mov_b32 s43, 0x20000
    s_mov_b32 s52, s38
    s_mov_b32 s53, s39
    s_mov_b32 s54, 25165824
    s_mov_b32 s55, 0x20000
    s_lshl_b32 s12, s2, 7
    s_add_u32 s12, s12, 65536
    s_add_u32 s56, s38, s12
    s_addc_u32 s57, s39, 0
    s_mov_b32 s58, 16809984
    s_mov_b32 s59, 0x20000
    s_mov_b32 s64, 85599
    s_mov_b32 s65, 4294967100
    s_movk_i32 s66, 5368
    s_mov_b32 s67, 0xc000000
    s_mov_b32 s68, 32896
    v_add_u32 v136, 0, v191
    v_add_u32 v137, 1, v191
    v_add_u32 v138, 2, v191
    v_add_u32 v139, 3, v191
    s_lshl_b32 s10, s3, 28
    s_or_b32 s10, s10, 0x20000
    v_mov_b32 v140, s10
    v_or_b32 v141, 0x80000000, v140
    v_mov_b32 v184, 33
    v_mov_b32 v142, 0x400
    s_and_b32 s10, s3, 3
    s_lshr_b32 s4, s3, 2
    s_lshl1_add_u32 s4, s10, s4
    s_xor_b32 s4, s4, 1
    s_mul_i32 s10, s4, 49
    s_sub_i32 s10, s10, 6
    s_ashr_i32 s10, s10, 1
    s_max_i32 s7, s10, 0
    s_mul_i32 s13, s4, 4224
    s_add_u32 s13, s13, 82944
    s_lshl_b32 s14, s4, 10
    s_add_u32 s14, s14, 5120
    s_mul_i32 s12, s4, 2304
    s_add_u32 s12, s12, 46080
    s_movk_i32 s15, 128
    v_bfe_u32 v194, v255, 4, 4
    v_and_b32 v195, 7, v255
    v_cmp_eq_u32 vcc, v194, v195
    v_and_b32 v194, 8, v255
    v_lshlrev_b32 v194, 1, v194
    v_mov_b32 v196, 0x3f80
    v_lshlrev_b32 v196, v194, v196
    v_cndmask_b32 v196, 0, v196, vcc
    ds_write_b32 v192, v196 offset:0
    v_mov_b64 v[196:197], 0
    ds_write_b64 v190, v[196:197] offset:1024
    v_add_u32 v194, 155776, v192
    ds_write_b32 v194, v196
    v_lshrrev_b32 v223, 3, v255
    v_mad_u32_u24 v220, v223, s68, v243
    v_mul_u32_u24 v224, 160, v223
    v_add_u32 v221, v224, v243
    v_add_u32 v221, 46080, v221
    v_bfe_u32 v194, v255, 5, 1
    v_bfe_u32 v196, v255, 6, 1
    v_sub_u32 v194, v194, v196
    v_mul_i32_i24 v194, 640, v194
    v_add_u32 v224, v224, v194
    v_lshl_add_u32 v224, v195, 2, v224
    v_add_u32 v224, 13312, v224
    v_lshlrev_b32 v185, 4, v253
    v_and_b32 v241, 1, v253
    v_lshlrev_b32 v241, 4, v241
    s_bitcmp1_b32 s4, 0
    s_cselect_b32 s10, 1, -1
    s_lshl_b32 s10, s10, 24
    s_or_b32 s10, s10, 0xdddd
    v_mov_b32 v242, s10
    v_and_b32 v245, 16, v253
    v_and_b32 v194, 15, v253
    v_lshl_add_u32 v194, v194, 5, s14
    s_mov_b32 exec_hi, 0
    v_add_u32 v245, v245, v194
    s_mov_b32 exec_hi, -1
    v_and_b32 v194, 3, v253
    v_lshlrev_b32 v246, 3, v194
    v_bfe_u32 v196, v253, 2, 2
    v_and_b32 v197, 48, v253
    v_lshl_add_u32 v198, v196, 7, v197
    v_mul_u32_u24 v244, 1056, v194
    v_add3_u32 v244, v244, v198, s13
    v_bfe_u32 v197, v253, 2, 3
    v_lshrrev_b32 v196, 5, v253
    v_lshl_add_u32 v197, v196, 4, v197
    v_mul_u32_u24 v225, 160, v197
    v_add_u32 v225, v225, v246
    v_lshrrev_b32 v194, 3, v253
    v_lshl_add_u32 v247, v194, 4, s12
    s_add_u32 s10, s12, 18432
    v_lshrrev_b32 v194, 1, v253
    v_lshl_add_u32 v248, v194, 2, s10
    s_add_u32 s10, s10, 2
    v_and_b32 v194, 48, v253
    v_lshl_add_u32 v250, v194, 1, s10
    v_and_b32 v194, 12, v253
    v_add_u32 v250, v250, v194
    v_lshrrev_b32 v194, 5, v253
    v_mul_u32_u24 v249, 18432, v194
    v_and_b32 v194, 15, v253
    v_lshl_add_u32 v249, v194, 2, v249
    s_add_u32 s10, s12, 2
    v_add_u32 v249, s10, v249
    s_movk_i32 s69, 11520
    v_mov_b64 v[132:133], 0
    v_mov_b64 v[134:135], 0
    s_waitcnt lgkmcnt(0)
    s_barrier
    s_add_u32 s6, s6, 0x2020202
    v_lshlrev_b32 v186, v246, s6
    v_and_b32 v194, 4, v253
    v_mul_u32_u24 v194, 1212416, v194
    v_lshl_add_u32 v186, v194, 8, v186
    v_and_b32 v186, 0xfe000000, v186
    v_and_b32 v187, 7, v253
    v_mul_u32_u24 v187, 33, v187
    v_add_u32 v187, 792, v187
    v_lshlrev_b32 v222, 2, v223
    s_cmp_eq_u64 s[70:71], 0
    s_cbranch_scc1 L_R4
    s_waitcnt vmcnt(3)
    v_mul_u32_u24 v112, s64, v96
    v_mul_u32_u24 v113, s64, v97
    v_mul_u32_u24 v114, s64, v98
    v_mul_u32_u24 v115, s64, v99
    v_lshrrev_b32 v120, 29, v112
    v_lshrrev_b32 v121, 29, v113
    v_lshrrev_b32 v122, 29, v114
    v_lshrrev_b32 v123, 29, v115
    v_cmp_eq_u32 s[72:73], v120, v121
    v_cmp_eq_u32 s[76:77], v122, v123
    v_cmp_eq_u32 vcc, v120, v122
    v_cmp_eq_u32 s[88:89], v121, v123
    v_cmp_eq_u32 s[90:91], v120, v123
    v_cmp_eq_u32 s[10:11], v121, v122
    v_lshrrev_b32 v112, 24, v112
    v_lshrrev_b32 v113, 24, v113
    v_lshrrev_b32 v114, 24, v114
    v_lshrrev_b32 v115, 24, v115
    s_or_b64 s[74:75], s[72:73], s[88:89]
    s_or_b64 s[78:79], s[76:77], s[88:89]
    s_or_b64 s[72:73], s[72:73], vcc
    s_or_b64 s[76:77], s[76:77], vcc
    s_or_b64 s[72:73], s[72:73], s[90:91]
    s_or_b64 s[74:75], s[74:75], s[10:11]
    s_or_b64 s[76:77], s[76:77], s[10:11]
    s_or_b64 s[78:79], s[78:79], s[90:91]
    v_cndmask_b32 v120, 0, v142, s[72:73]
    v_lshl_add_u32 v120, v112, 2, v120
    ds_add_rtn_u32 v128, v120, v184 offset:5120
    v_cndmask_b32 v121, 0, v142, s[74:75]
    v_lshl_add_u32 v121, v113, 2, v121
    ds_add_rtn_u32 v129, v121, v184 offset:5120
    v_cndmask_b32 v122, 0, v142, s[76:77]
    v_lshl_add_u32 v122, v114, 2, v122
    ds_add_rtn_u32 v130, v122, v184 offset:5120
    v_cndmask_b32 v123, 0, v142, s[78:79]
    v_lshl_add_u32 v123, v115, 2, v123
    ds_add_rtn_u32 v131, v123, v184 offset:5120
    s_waitcnt vmcnt(1)
    s_mov_b64 exec, s[70:71]
    v_mul_u32_u24 v116, s64, v100
    v_mul_u32_u24 v117, s64, v101
    v_mul_u32_u24 v118, s64, v102
    v_mul_u32_u24 v119, s64, v103
    v_lshrrev_b32 v116, 24, v116
    v_lshrrev_b32 v117, 24, v117
    v_lshrrev_b32 v118, 24, v118
    v_lshrrev_b32 v119, 24, v119
    v_lshlrev_b32 v124, 2, v116
    ds_add_rtn_u32 v132, v124, v184 offset:5120
    v_lshlrev_b32 v125, 2, v117
    ds_add_rtn_u32 v133, v125, v184 offset:5120
    v_lshlrev_b32 v126, 2, v118
    ds_add_rtn_u32 v134, v126, v184 offset:5120
    v_lshlrev_b32 v127, 2, v119
    ds_add_rtn_u32 v135, v127, v184 offset:5120
    s_waitcnt lgkmcnt(7)
    s_mov_b64 exec, s[72:73]
    v_cmpx_le_u32 vcc, 132, v128
    ds_add_rtn_u32 v128, v120, v184 offset:4096
    s_waitcnt lgkmcnt(7)
    s_mov_b64 exec, s[74:75]
    v_cmpx_le_u32 vcc, 132, v129
    ds_add_rtn_u32 v129, v121, v184 offset:4096
    s_waitcnt lgkmcnt(7)
    s_mov_b64 exec, s[76:77]
    v_cmpx_le_u32 vcc, 132, v130
    ds_add_rtn_u32 v130, v122, v184 offset:4096
    s_waitcnt lgkmcnt(7)
    s_mov_b64 exec, s[78:79]
    v_cmpx_le_u32 vcc, 132, v131
    ds_add_rtn_u32 v131, v123, v184 offset:4096
    s_mov_b64 exec, s[70:71]
    s_waitcnt vmcnt(0)
    v_mad_i32_i24 v100, v116, s65, v100
    v_mul_u32_u24 v194, s66, v108
    v_lshl_or_b32 v108, v100, 18, v108
    v_and_or_b32 v194, v194, s67, v141
    v_mad_u32_u24 v100, v116, 40, s69
    v_or_b32 v108, v108, v194
    v_mad_i32_i24 v101, v117, s65, v101
    v_mul_u32_u24 v194, s66, v109
    v_lshl_or_b32 v109, v101, 18, v109
    v_and_or_b32 v194, v194, s67, v141
    v_mad_u32_u24 v101, v117, 40, s69
    v_or_b32 v109, v109, v194
    v_mad_i32_i24 v102, v118, s65, v102
    v_mul_u32_u24 v194, s66, v110
    v_lshl_or_b32 v110, v102, 18, v110
    v_and_or_b32 v194, v194, s67, v141
    v_mad_u32_u24 v102, v118, 40, s69
    v_or_b32 v110, v110, v194
    v_mad_i32_i24 v103, v119, s65, v103
    v_mul_u32_u24 v194, s66, v111
    v_lshl_or_b32 v111, v103, 18, v111
    v_and_or_b32 v194, v194, s67, v141
    v_mad_u32_u24 v103, v119, 40, s69
    v_or_b32 v111, v111, v194
    s_waitcnt lgkmcnt(7)
    v_bfe_u32 v194, v132, 3, 5
    v_add_lshl_u32 v100, v194, v100, 2
    v_and_b32 v194, 3, v194
    v_mad_i32_i24 v194, v194, -3, v100
    v_cmpx_gt_u32 vcc, 792, v132
    ds_write_b32 v100, v108
    ds_write_b8 v194, v136 offset:12
    s_mov_b64 exec, s[70:71]
    s_waitcnt lgkmcnt(8)
    v_bfe_u32 v194, v133, 3, 5
    v_add_lshl_u32 v101, v194, v101, 2
    v_and_b32 v194, 3, v194
    v_mad_i32_i24 v194, v194, -3, v101
    v_cmpx_gt_u32 vcc, 792, v133
    ds_write_b32 v101, v109
    ds_write_b8 v194, v137 offset:12
    s_mov_b64 exec, s[70:71]
    s_waitcnt lgkmcnt(9)
    v_bfe_u32 v194, v134, 3, 5
    v_add_lshl_u32 v102, v194, v102, 2
    v_and_b32 v194, 3, v194
    v_mad_i32_i24 v194, v194, -3, v102
    v_cmpx_gt_u32 vcc, 792, v134
    ds_write_b32 v102, v110
    ds_write_b8 v194, v138 offset:12
    s_mov_b64 exec, s[70:71]
    s_waitcnt lgkmcnt(10)
    v_bfe_u32 v194, v135, 3, 5
    v_add_lshl_u32 v103, v194, v103, 2
    v_and_b32 v194, 3, v194
    v_mad_i32_i24 v194, v194, -3, v103
    v_cmpx_gt_u32 vcc, 792, v135
    ds_write_b32 v103, v111
    ds_write_b8 v194, v139 offset:12
    s_mov_b64 exec, -1
    v_mad_i32_i24 v96, v112, s65, v96
    v_mul_u32_u24 v194, s66, v104
    v_lshl_or_b32 v104, v96, 18, v104
    v_and_or_b32 v194, v194, s67, v140
    v_mad_u32_u24 v96, v112, 40, s69
    v_or_b32 v104, v104, v194
    v_mad_i32_i24 v97, v113, s65, v97
    v_mul_u32_u24 v194, s66, v105
    v_lshl_or_b32 v105, v97, 18, v105
    v_and_or_b32 v194, v194, s67, v140
    v_mad_u32_u24 v97, v113, 40, s69
    v_or_b32 v105, v105, v194
    v_mad_i32_i24 v98, v114, s65, v98
    v_mul_u32_u24 v194, s66, v106
    v_lshl_or_b32 v106, v98, 18, v106
    v_and_or_b32 v194, v194, s67, v140
    v_mad_u32_u24 v98, v114, 40, s69
    v_or_b32 v106, v106, v194
    v_mad_i32_i24 v99, v115, s65, v99
    v_mul_u32_u24 v194, s66, v107
    v_lshl_or_b32 v107, v99, 18, v107
    v_and_or_b32 v194, v194, s67, v140
    v_mad_u32_u24 v99, v115, 40, s69
    v_or_b32 v107, v107, v194
    s_waitcnt lgkmcnt(11)
    v_bfe_u32 v194, v128, 3, 5
    v_add_lshl_u32 v96, v194, v96, 2
    v_and_b32 v194, 3, v194
    v_mad_i32_i24 v194, v194, -3, v96
    v_cmpx_gt_u32 vcc, 792, v128
    ds_write_b32 v96, v104
    ds_write_b8 v194, v136 offset:12
    s_mov_b64 exec, -1
    s_waitcnt lgkmcnt(12)
    v_bfe_u32 v194, v129, 3, 5
    v_add_lshl_u32 v97, v194, v97, 2
    v_and_b32 v194, 3, v194
    v_mad_i32_i24 v194, v194, -3, v97
    v_cmpx_gt_u32 vcc, 792, v129
    ds_write_b32 v97, v105
    ds_write_b8 v194, v137 offset:12
    s_mov_b64 exec, -1
    s_waitcnt lgkmcnt(13)
    v_bfe_u32 v194, v130, 3, 5
    v_add_lshl_u32 v98, v194, v98, 2
    v_and_b32 v194, 3, v194
    v_mad_i32_i24 v194, v194, -3, v98
    v_cmpx_gt_u32 vcc, 792, v130
    ds_write_b32 v98, v106
    ds_write_b8 v194, v138 offset:12
    s_mov_b64 exec, -1
    s_waitcnt lgkmcnt(14)
    v_bfe_u32 v194, v131, 3, 5
    v_add_lshl_u32 v99, v194, v99, 2
    v_and_b32 v194, 3, v194
    v_mad_i32_i24 v194, v194, -3, v99
    v_cmpx_gt_u32 vcc, 792, v131
    ds_write_b32 v99, v107
    ds_write_b8 v194, v139 offset:12
    s_mov_b64 exec, -1
    s_branch L_B1
L_R4:
    s_waitcnt vmcnt(1)
    v_mul_u32_u24 v112, s64, v96
    v_mul_u32_u24 v113, s64, v97
    v_mul_u32_u24 v114, s64, v98
    v_mul_u32_u24 v115, s64, v99
    v_lshrrev_b32 v120, 29, v112
    v_lshrrev_b32 v121, 29, v113
    v_lshrrev_b32 v122, 29, v114
    v_lshrrev_b32 v123, 29, v115
    v_cmp_eq_u32 s[72:73], v120, v121
    v_cmp_eq_u32 s[76:77], v122, v123
    v_cmp_eq_u32 vcc, v120, v122
    v_cmp_eq_u32 s[88:89], v121, v123
    v_cmp_eq_u32 s[90:91], v120, v123
    v_cmp_eq_u32 s[10:11], v121, v122
    v_lshrrev_b32 v112, 24, v112
    v_lshrrev_b32 v113, 24, v113
    v_lshrrev_b32 v114, 24, v114
    v_lshrrev_b32 v115, 24, v115
    s_or_b64 s[74:75], s[72:73], s[88:89]
    s_or_b64 s[78:79], s[76:77], s[88:89]
    s_or_b64 s[72:73], s[72:73], vcc
    s_or_b64 s[76:77], s[76:77], vcc
    s_or_b64 s[72:73], s[72:73], s[90:91]
    s_or_b64 s[74:75], s[74:75], s[10:11]
    s_or_b64 s[76:77], s[76:77], s[10:11]
    s_or_b64 s[78:79], s[78:79], s[90:91]
    v_cndmask_b32 v120, 0, v142, s[72:73]
    v_lshl_add_u32 v120, v112, 2, v120
    ds_add_rtn_u32 v128, v120, v184 offset:5120
    v_cndmask_b32 v121, 0, v142, s[74:75]
    v_lshl_add_u32 v121, v113, 2, v121
    ds_add_rtn_u32 v129, v121, v184 offset:5120
    v_cndmask_b32 v122, 0, v142, s[76:77]
    v_lshl_add_u32 v122, v114, 2, v122
    ds_add_rtn_u32 v130, v122, v184 offset:5120
    v_cndmask_b32 v123, 0, v142, s[78:79]
    v_lshl_add_u32 v123, v115, 2, v123
    ds_add_rtn_u32 v131, v123, v184 offset:5120
    s_waitcnt vmcnt(0)
    v_mad_i32_i24 v96, v112, s65, v96
    v_mul_u32_u24 v194, s66, v104
    v_lshl_or_b32 v104, v96, 18, v104
    v_and_or_b32 v194, v194, s67, v140
    v_mad_u32_u24 v96, v112, 40, s69
    v_or_b32 v104, v104, v194
    v_mad_i32_i24 v97, v113, s65, v97
    v_mul_u32_u24 v194, s66, v105
    v_lshl_or_b32 v105, v97, 18, v105
    v_and_or_b32 v194, v194, s67, v140
    v_mad_u32_u24 v97, v113, 40, s69
    v_or_b32 v105, v105, v194
    s_waitcnt lgkmcnt(3)
    s_mov_b64 exec, s[72:73]
    v_cmpx_le_u32 vcc, 132, v128
    ds_add_rtn_u32 v128, v120, v184 offset:4096
    s_waitcnt lgkmcnt(3)
    s_mov_b64 exec, s[74:75]
    v_cmpx_le_u32 vcc, 132, v129
    ds_add_rtn_u32 v129, v121, v184 offset:4096
    s_waitcnt lgkmcnt(3)
    s_mov_b64 exec, s[76:77]
    v_cmpx_le_u32 vcc, 132, v130
    ds_add_rtn_u32 v130, v122, v184 offset:4096
    s_waitcnt lgkmcnt(3)
    s_mov_b64 exec, s[78:79]
    v_cmpx_le_u32 vcc, 132, v131
    ds_add_rtn_u32 v131, v123, v184 offset:4096
    s_mov_b64 exec, -1
    v_mad_i32_i24 v98, v114, s65, v98
    v_mul_u32_u24 v194, s66, v106
    v_lshl_or_b32 v106, v98, 18, v106
    v_and_or_b32 v194, v194, s67, v140
    v_mad_u32_u24 v98, v114, 40, s69
    v_or_b32 v106, v106, v194
    v_mad_i32_i24 v99, v115, s65, v99
    v_mul_u32_u24 v194, s66, v107
    v_lshl_or_b32 v107, v99, 18, v107
    v_and_or_b32 v194, v194, s67, v140
    v_mad_u32_u24 v99, v115, 40, s69
    v_or_b32 v107, v107, v194
    s_waitcnt lgkmcnt(3)
    v_bfe_u32 v194, v128, 3, 5
    v_add_lshl_u32 v96, v194, v96, 2
    v_and_b32 v194, 3, v194
    v_mad_i32_i24 v194, v194, -3, v96
    v_cmpx_gt_u32 vcc, 792, v128
    ds_write_b32 v96, v104
    ds_write_b8 v194, v136 offset:12
    s_mov_b64 exec, -1
    s_waitcnt lgkmcnt(4)
    v_bfe_u32 v194, v129, 3, 5
    v_add_lshl_u32 v97, v194, v97, 2
    v_and_b32 v194, 3, v194
    v_mad_i32_i24 v194, v194, -3, v97
    v_cmpx_gt_u32 vcc, 792, v129
    ds_write_b32 v97, v105
    ds_write_b8 v194, v137 offset:12
    s_mov_b64 exec, -1
    s_waitcnt lgkmcnt(5)
    v_bfe_u32 v194, v130, 3, 5
    v_add_lshl_u32 v98, v194, v98, 2
    v_and_b32 v194, 3, v194
    v_mad_i32_i24 v194, v194, -3, v98
    v_cmpx_gt_u32 vcc, 792, v130
    ds_write_b32 v98, v106
    ds_write_b8 v194, v138 offset:12
    s_mov_b64 exec, -1
    s_waitcnt lgkmcnt(6)
    v_bfe_u32 v194, v131, 3, 5
    v_add_lshl_u32 v99, v194, v99, 2
    v_and_b32 v194, 3, v194
    v_mad_i32_i24 v194, v194, -3, v99
    v_cmpx_gt_u32 vcc, 792, v131
    ds_write_b32 v99, v107
    ds_write_b8 v194, v139 offset:12
    s_mov_b64 exec, -1
L_B1:
    s_cmp_ge_u32 s3, 2
    s_cbranch_scc1 L_NOC
    global_load_dwordx4 v[176:179], v232, s[28:29]
L_NOC:
    global_load_dwordx4 v[160:163], v232, s[26:27]
    global_load_dwordx4 v[164:167], v232, s[32:33]
    global_load_dwordx4 v[168:171], v232, s[24:25]
    global_load_dwordx4 v[172:175], v232, s[30:31]
    s_mov_b32 s64, 0x1000000
    s_waitcnt lgkmcnt(0)
    s_barrier
    ds_read_b128 v[192:195], v185 offset:5120
    ds_read_b32 v228, v222 offset:5120
    ds_read_b128 v[204:207], v221 offset:0
    ds_read_b32 v229, v222 offset:5376
    ds_read_b128 v[208:211], v221 offset:10240
    ds_read_b32 v230, v222 offset:5632
    ds_read_b128 v[212:215], v221 offset:20480
    ds_read_b32 v231, v222 offset:5888
    ds_read_b128 v[216:219], v221 offset:30720
    s_mov_b32 s80, 2105344
    s_mov_b32 s81, 4210688
    s_mov_b32 s82, 6316032
    s_waitcnt lgkmcnt(8)
    v_max3_u32 v188, v192, v193, v194
    v_max_u32 v188, v188, v195
    v_cmp_lt_u32 vcc, 1056, v188
    s_cbranch_vccnz L_POVF
L_POUT:
    s_waitcnt lgkmcnt(7)
    v_sub_u32 v228, v187, v228
    v_and_or_b32 v228, v228, s64, v186
    s_waitcnt lgkmcnt(6)
    v_or_b32 v207, v207, v228
    buffer_store_dwordx4 v[204:207], v220, s[56:59], 0 offen sc1
    s_waitcnt lgkmcnt(5)
    v_sub_u32 v229, v187, v229
    v_and_or_b32 v229, v229, s64, v186
    s_waitcnt lgkmcnt(4)
    v_or_b32 v211, v211, v229
    buffer_store_dwordx4 v[208:211], v220, s[56:59], s80 offen sc1
    s_waitcnt lgkmcnt(3)
    v_sub_u32 v230, v187, v230
    v_and_or_b32 v230, v230, s64, v186
    s_waitcnt lgkmcnt(2)
    v_or_b32 v215, v215, v230
    buffer_store_dwordx4 v[212:215], v220, s[56:59], s81 offen sc1
    s_waitcnt lgkmcnt(1)
    v_sub_u32 v231, v187, v231
    v_and_or_b32 v231, v231, s64, v186
    s_waitcnt lgkmcnt(0)
    v_or_b32 v219, v219, v231
    buffer_store_dwordx4 v[216:219], v220, s[56:59], s82 offen sc1
    s_mov_b32 s10, 0xbfb8aa3b
    s_mov_b32 s11, s10
    s_mov_b32 s64, 0x05040100
    s_mov_b32 s66, 0x07060302
    s_waitcnt vmcnt(4)
    v_max3_u32 v188, v128, v129, v130
    v_max3_u32 v189, v131, v132, v133
    v_max3_u32 v188, v188, v134, v135
    v_max_u32 v188, v188, v189
    v_cmp_le_u32 vcc, 792, v188
    s_cbranch_vccnz L_PEXT
L_PEXTR:
    v_perm_b32 v112, v170, v168, s64
    v_perm_b32 v113, v170, v168, s66
    v_perm_b32 v114, v171, v169, s64
    v_perm_b32 v115, v171, v169, s66
    v_add_u32 v116, 77824, v224
    ds_write2_b32 v116, v112, v113 offset0:0 offset1:8
    ds_write2_b32 v116, v114, v115 offset0:16 offset1:24
    v_lshlrev_b32 v96, 16, v160
    v_and_b32 v97, 0xffff0000, v160
    v_lshlrev_b32 v98, 16, v161
    v_and_b32 v99, 0xffff0000, v161
    v_lshlrev_b32 v100, 16, v162
    v_and_b32 v101, 0xffff0000, v162
    v_lshlrev_b32 v102, 16, v163
    v_and_b32 v103, 0xffff0000, v163
    v_pk_mul_f32 v[96:97], v[96:97], s[10:11]
    v_pk_mul_f32 v[98:99], v[98:99], s[10:11]
    v_pk_mul_f32 v[100:101], v[100:101], s[10:11]
    v_pk_mul_f32 v[102:103], v[102:103], s[10:11]
    v_cvt_pk_bf16_f32 v104, v96, v100
    v_cvt_pk_bf16_f32 v105, v97, v101
    v_cvt_pk_bf16_f32 v106, v98, v102
    v_cvt_pk_bf16_f32 v107, v99, v103
    ds_write2_b32 v224, v104, v105 offset0:0 offset1:8
    ds_write2_b32 v224, v106, v107 offset0:16 offset1:24
    v_perm_b32 v120, v166, v164, s64
    v_perm_b32 v121, v166, v164, s66
    v_perm_b32 v122, v167, v165, s64
    v_perm_b32 v123, v167, v165, s66
    v_add_u32 v124, 10240, v224
    ds_write2_b32 v124, v120, v121 offset0:0 offset1:8
    ds_write2_b32 v124, v122, v123 offset0:16 offset1:24
    v_perm_b32 v112, v174, v172, s64
    v_perm_b32 v113, v174, v172, s66
    v_perm_b32 v114, v175, v173, s64
    v_perm_b32 v115, v175, v173, s66
    v_add_u32 v116, 130176, v224
    ds_write2_b32 v116, v112, v113 offset0:0 offset1:8
    ds_write2_b32 v116, v114, v115 offset0:16 offset1:24
    s_cmp_ge_u32 s3, 2
    s_cbranch_scc1 L_NOWC
    v_lshlrev_b32 v96, 16, v176
    v_and_b32 v97, 0xffff0000, v176
    v_lshlrev_b32 v98, 16, v177
    v_and_b32 v99, 0xffff0000, v177
    v_lshlrev_b32 v100, 16, v178
    v_and_b32 v101, 0xffff0000, v178
    v_lshlrev_b32 v102, 16, v179
    v_and_b32 v103, 0xffff0000, v179
    v_pk_mul_f32 v[96:97], v[96:97], s[10:11]
    v_pk_mul_f32 v[98:99], v[98:99], s[10:11]
    v_pk_mul_f32 v[100:101], v[100:101], s[10:11]
    v_pk_mul_f32 v[102:103], v[102:103], s[10:11]
    v_cvt_pk_bf16_f32 v104, v96, v100
    v_cvt_pk_bf16_f32 v105, v97, v101
    v_cvt_pk_bf16_f32 v106, v98, v102
    v_cvt_pk_bf16_f32 v107, v99, v103
    v_add_u32 v108, 20480, v224
    ds_write2_b32 v108, v104, v105 offset0:0 offset1:8
    ds_write2_b32 v108, v106, v107 offset0:16 offset1:24
L_NOWC:
    s_mul_i32 s34, s5, 32896
    s_add_u32 s34, s34, 65536
    s_add_u32 s56, s38, s34
    s_addc_u32 s57, s39, 0
    s_mov_b32 s58, 32768
    s_mov_b32 s59, 0x20000
    s_add_u32 s34, s34, 8421376
    s_add_u32 s60, s38, s34
    s_addc_u32 s61, s39, 0
    s_mov_b32 s62, 32768
    s_mov_b32 s63, 0x20000
    s_movk_i32 s26, 8192
    s_movk_i32 s27, 16384
    s_movk_i32 s28, 24576
    s_waitcnt lgkmcnt(0)
    s_barrier
    v_add_u32 v225, 13312, v225
    ds_read_b64_tr_b16 v[0:1], v225 offset:0
    ds_read_b64_tr_b16 v[2:3], v225 offset:1280
    ds_read_b64_tr_b16 v[4:5], v225 offset:5120
    ds_read_b64_tr_b16 v[6:7], v225 offset:6400
    ds_read_b64_tr_b16 v[8:9], v225 offset:32
    ds_read_b64_tr_b16 v[10:11], v225 offset:1312
    ds_read_b64_tr_b16 v[12:13], v225 offset:5152
    ds_read_b64_tr_b16 v[14:15], v225 offset:6432
    ds_read_b64_tr_b16 v[16:17], v225 offset:64
    ds_read_b64_tr_b16 v[18:19], v225 offset:1344
    ds_read_b64_tr_b16 v[20:21], v225 offset:5184
    ds_read_b64_tr_b16 v[22:23], v225 offset:6464
    ds_read_b64_tr_b16 v[24:25], v225 offset:96
    ds_read_b64_tr_b16 v[26:27], v225 offset:1376
    v_mov_b64 v[64:65], 0
    v_mov_b64 v[66:67], 0
    v_mov_b32 v68, 0x20fffff
    v_mov_b32 v69, 0x20fffff
    v_mov_b32 v70, 0x20fffff
    v_mov_b32 v71, 0x20fffff
    v_lshl_add_u32 v72, v253, 4, s12
    ds_write_b128 v72, v[64:67] offset:0
    ds_write_b128 v72, v[68:71] offset:18432
    ds_write_b128 v72, v[64:67] offset:1024
    ds_write_b128 v72, v[68:71] offset:19456
    ds_write_b128 v72, v[64:67] offset:1280
    ds_write_b128 v72, v[68:71] offset:19712
    ds_read_b64_tr_b16 v[28:29], v225 offset:5216
    ds_read_b64_tr_b16 v[30:31], v225 offset:6496
    ds_read_b64_tr_b16 v[32:33], v225 offset:10240
    ds_read_b64_tr_b16 v[34:35], v225 offset:11520
    ds_read_b64_tr_b16 v[36:37], v225 offset:15360
    ds_read_b64_tr_b16 v[38:39], v225 offset:16640
    ds_read_b64_tr_b16 v[40:41], v225 offset:10272
    ds_read_b64_tr_b16 v[42:43], v225 offset:11552
    ds_read_b64_tr_b16 v[44:45], v225 offset:15392
    ds_read_b64_tr_b16 v[46:47], v225 offset:16672
    v_mov_b32 v192, v225
    s_mov_b32 exec_lo, 0
    v_subrev_u32 v192, 2560, v225
    s_mov_b32 exec_lo, -1
    v_mul_u32_u24 v156, 3128, v223
    v_add_u32 v157, 200192, v156
    v_add_u32 v158, 400384, v156
    v_add_u32 v159, 600576, v156
    s_mov_b32 s98, 0xf0f0f0f
    s_mov_b32 s99, 0xf0f0f0f
    v_mov_b32 v180, 0xfffff
    v_cndmask_b32 v176, 0, v180, s[98:99]
    v_add_lshl_u32 v191, v232, v243, 16
    v_add_u32 v152, 0x34000000, v191
    v_cndmask_b32 v152, 0, v152, s[98:99]
    v_add_u32 v153, 0x54000000, v191
    v_cndmask_b32 v153, 0, v153, s[98:99]
    v_add_u32 v154, 0x74000000, v191
    v_cndmask_b32 v154, 0, v154, s[98:99]
    v_add_u32 v155, 0x94000000, v191
    v_cndmask_b32 v155, 0, v155, s[98:99]
    v_mov_b32 v184, 4
    v_and_b32 v177, 31, v253
    v_add_lshl_u32 v179, v177, s7, 2
    v_lshrrev_b32 v191, 5, v253
    v_lshl_add_u32 v178, v191, 11, v179
    v_add_u32 v179, 153728, v179
    s_waitcnt lgkmcnt(4)
    ds_read_b64_tr_b16 v[48:49], v225 offset:10304
    ds_read_b64_tr_b16 v[50:51], v225 offset:11584
    ds_read_b64_tr_b16 v[52:53], v225 offset:15424
    ds_read_b64_tr_b16 v[54:55], v225 offset:16704
    ds_read_b64_tr_b16 v[56:57], v225 offset:10336
    ds_read_b64_tr_b16 v[58:59], v225 offset:11616
    ds_read_b64_tr_b16 v[60:61], v225 offset:15456
    ds_read_b64_tr_b16 v[62:63], v225 offset:16736
    ds_read_b64_tr_b16 v[80:81], v192 offset:20480
    ds_read_b64_tr_b16 v[82:83], v192 offset:21760
    ds_read_b64_tr_b16 v[84:85], v192 offset:20512
    ds_read_b64_tr_b16 v[86:87], v192 offset:21792
    ds_read_b64_tr_b16 v[88:89], v192 offset:20544
    ds_read_b64_tr_b16 v[90:91], v192 offset:21824
    ds_read_b64_tr_b16 v[92:93], v192 offset:20576
    ds_read_b64_tr_b16 v[94:95], v192 offset:21856
    v_add_u32 v225, 77824, v225
    s_movk_i32 s18, 0xffc
    s_movk_i32 s20, 32
    s_mov_b32 s21, 0
    s_mov_b32 s100, 0
    s_mov_b32 s16, 0x1ffffff
    s_mov_b32 s17, 0xffff
    s_mul_i32 s10, s4, 49
    s_sub_i32 s22, s10, 6
    s_ashr_i32 s22, s22, 1
    s_add_i32 s23, s10, 7
    s_ashr_i32 s23, s23, 1
    s_add_i32 s24, s10, 43
    s_ashr_i32 s24, s24, 1
    s_add_i32 s25, s22, 31
    s_cmp_eq_u32 s4, 7
    s_cselect_b32 s24, 196, s24
    s_cselect_b32 s25, 196, s25
    s_waitcnt vmcnt(0)
    buffer_load_dwordx4 v[128:131], v232, s[56:59], 0 offen sc1
    buffer_load_dwordx4 v[132:135], v232, s[56:59], s26 offen sc1
    buffer_load_dwordx4 v[136:139], v232, s[56:59], s27 offen sc1
    buffer_load_dwordx4 v[140:143], v232, s[56:59], s28 offen sc1
L_PW0:
    s_waitcnt vmcnt(3)
    v_xor_b32 v188, v131, v186
    v_and_b32_sdwa v96, v128, s18 dst_sel:DWORD dst_unused:UNUSED_PAD src0_sel:WORD_1 src1_sel:DWORD
    v_and_b32_sdwa v97, v129, s18 dst_sel:DWORD dst_unused:UNUSED_PAD src0_sel:WORD_1 src1_sel:DWORD
    v_and_b32_sdwa v98, v130, s18 dst_sel:DWORD dst_unused:UNUSED_PAD src0_sel:WORD_1 src1_sel:DWORD
    v_cmp_lt_u32 vcc, s16, v188
    v_cmp_ne_u32 s[64:65], 0, v128
    v_cmp_ne_u32 s[66:67], 0, v129
    v_cmp_ne_u32 s[68:69], 0, v130
    s_cbranch_vccnz L_RT0
    s_mov_b64 exec, s[64:65]
    ds_add_rtn_u32 v112, v96, v184 offset:1024
    s_mov_b64 exec, s[66:67]
    ds_add_rtn_u32 v113, v97, v184 offset:1024
    s_mov_b64 exec, s[68:69]
    ds_add_rtn_u32 v114, v98, v184 offset:1024
    s_mov_b64 exec, -1
    v_add_u32_sdwa v207, v131, v156 dst_sel:DWORD dst_unused:UNUSED_PAD src0_sel:BYTE_0 src1_sel:DWORD
    v_lshrrev_b32 v189, 28, v128
    v_lshl_add_u32 v207, v189, 8, v207
    v_and_b32 v189, 60, v96
    v_lshl_add_u32 v204, v189, 19, v207
    v_add_u32_sdwa v205, v131, v156 dst_sel:DWORD dst_unused:UNUSED_PAD src0_sel:BYTE_1 src1_sel:DWORD
    v_lshrrev_b32 v189, 28, v129
    v_lshl_add_u32 v205, v189, 8, v205
    v_and_b32 v189, 60, v97
    v_lshl_add_u32 v205, v189, 19, v205
    v_add_u32_sdwa v206, v131, v156 dst_sel:DWORD dst_unused:UNUSED_PAD src0_sel:BYTE_2 src1_sel:DWORD
    v_lshrrev_b32 v189, 28, v130
    v_lshl_add_u32 v206, v189, 8, v206
    v_and_b32 v189, 60, v98
    v_lshl_add_u32 v206, v189, 19, v206
    v_cndmask_b32 v188, v180, v207, s[64:65]
    s_nop 1
    v_mov_b32_dpp v189, v188 quad_perm:[2,2,3,3] row_mask:0xf bank_mask:0xf
    v_mov_b32_dpp v207, v188 quad_perm:[0,0,1,1] row_mask:0xf bank_mask:0xf
    s_nop 0
    v_mov_b32_dpp v207, v189 row_shr:4 row_mask:0xf bank_mask:0xa
L_PW1:
    s_waitcnt vmcnt(2)
    v_xor_b32 v188, v135, v186
    v_and_b32_sdwa v100, v132, s18 dst_sel:DWORD dst_unused:UNUSED_PAD src0_sel:WORD_1 src1_sel:DWORD
    v_and_b32_sdwa v101, v133, s18 dst_sel:DWORD dst_unused:UNUSED_PAD src0_sel:WORD_1 src1_sel:DWORD
    v_and_b32_sdwa v102, v134, s18 dst_sel:DWORD dst_unused:UNUSED_PAD src0_sel:WORD_1 src1_sel:DWORD
    v_cmp_lt_u32 vcc, s16, v188
    v_cmp_ne_u32 s[72:73], 0, v132
    v_cmp_ne_u32 s[74:75], 0, v133
    v_cmp_ne_u32 s[76:77], 0, v134
    s_cbranch_vccnz L_RT1
    s_mov_b64 exec, s[72:73]
    ds_add_rtn_u32 v116, v100, v184 offset:1024
    s_mov_b64 exec, s[74:75]
    ds_add_rtn_u32 v117, v101, v184 offset:1024
    s_mov_b64 exec, s[76:77]
    ds_add_rtn_u32 v118, v102, v184 offset:1024
    s_mov_b64 exec, -1
    v_add_u32_sdwa v211, v135, v157 dst_sel:DWORD dst_unused:UNUSED_PAD src0_sel:BYTE_0 src1_sel:DWORD
    v_lshrrev_b32 v189, 28, v132
    v_lshl_add_u32 v211, v189, 8, v211
    v_and_b32 v189, 60, v100
    v_lshl_add_u32 v208, v189, 19, v211
    v_add_u32_sdwa v209, v135, v157 dst_sel:DWORD dst_unused:UNUSED_PAD src0_sel:BYTE_1 src1_sel:DWORD
    v_lshrrev_b32 v189, 28, v133
    v_lshl_add_u32 v209, v189, 8, v209
    v_and_b32 v189, 60, v101
    v_lshl_add_u32 v209, v189, 19, v209
    v_add_u32_sdwa v210, v135, v157 dst_sel:DWORD dst_unused:UNUSED_PAD src0_sel:BYTE_2 src1_sel:DWORD
    v_lshrrev_b32 v189, 28, v134
    v_lshl_add_u32 v210, v189, 8, v210
    v_and_b32 v189, 60, v102
    v_lshl_add_u32 v210, v189, 19, v210
    v_cndmask_b32 v188, v180, v211, s[72:73]
    s_nop 1
    v_mov_b32_dpp v189, v188 quad_perm:[2,2,3,3] row_mask:0xf bank_mask:0xf
    v_mov_b32_dpp v211, v188 quad_perm:[0,0,1,1] row_mask:0xf bank_mask:0xf
    s_nop 0
    v_mov_b32_dpp v211, v189 row_shr:4 row_mask:0xf bank_mask:0xa
L_PW2:
    s_waitcnt vmcnt(1)
    v_xor_b32 v188, v139, v186
    v_and_b32_sdwa v104, v136, s18 dst_sel:DWORD dst_unused:UNUSED_PAD src0_sel:WORD_1 src1_sel:DWORD
    v_and_b32_sdwa v105, v137, s18 dst_sel:DWORD dst_unused:UNUSED_PAD src0_sel:WORD_1 src1_sel:DWORD
    v_and_b32_sdwa v106, v138, s18 dst_sel:DWORD dst_unused:UNUSED_PAD src0_sel:WORD_1 src1_sel:DWORD
    v_cmp_lt_u32 vcc, s16, v188
    v_cmp_ne_u32 s[80:81], 0, v136
    v_cmp_ne_u32 s[82:83], 0, v137
    v_cmp_ne_u32 s[84:85], 0, v138
    s_cbranch_vccnz L_RT2
    s_mov_b64 exec, s[80:81]
    ds_add_rtn_u32 v120, v104, v184 offset:1024
    s_mov_b64 exec, s[82:83]
    ds_add_rtn_u32 v121, v105, v184 offset:1024
    s_mov_b64 exec, s[84:85]
    ds_add_rtn_u32 v122, v106, v184 offset:1024
    s_mov_b64 exec, -1
    v_add_u32_sdwa v215, v139, v158 dst_sel:DWORD dst_unused:UNUSED_PAD src0_sel:BYTE_0 src1_sel:DWORD
    v_lshrrev_b32 v189, 28, v136
    v_lshl_add_u32 v215, v189, 8, v215
    v_and_b32 v189, 60, v104
    v_lshl_add_u32 v212, v189, 19, v215
    v_add_u32_sdwa v213, v139, v158 dst_sel:DWORD dst_unused:UNUSED_PAD src0_sel:BYTE_1 src1_sel:DWORD
    v_lshrrev_b32 v189, 28, v137
    v_lshl_add_u32 v213, v189, 8, v213
    v_and_b32 v189, 60, v105
    v_lshl_add_u32 v213, v189, 19, v213
    v_add_u32_sdwa v214, v139, v158 dst_sel:DWORD dst_unused:UNUSED_PAD src0_sel:BYTE_2 src1_sel:DWORD
    v_lshrrev_b32 v189, 28, v138
    v_lshl_add_u32 v214, v189, 8, v214
    v_and_b32 v189, 60, v106
    v_lshl_add_u32 v214, v189, 19, v214
    v_cndmask_b32 v188, v180, v215, s[80:81]
    s_nop 1
    v_mov_b32_dpp v189, v188 quad_perm:[2,2,3,3] row_mask:0xf bank_mask:0xf
    v_mov_b32_dpp v215, v188 quad_perm:[0,0,1,1] row_mask:0xf bank_mask:0xf
    s_nop 0
    v_mov_b32_dpp v215, v189 row_shr:4 row_mask:0xf bank_mask:0xa
L_PW3:
    s_waitcnt vmcnt(0)
    v_xor_b32 v188, v143, v186
    v_and_b32_sdwa v108, v140, s18 dst_sel:DWORD dst_unused:UNUSED_PAD src0_sel:WORD_1 src1_sel:DWORD
    v_and_b32_sdwa v109, v141, s18 dst_sel:DWORD dst_unused:UNUSED_PAD src0_sel:WORD_1 src1_sel:DWORD
    v_and_b32_sdwa v110, v142, s18 dst_sel:DWORD dst_unused:UNUSED_PAD src0_sel:WORD_1 src1_sel:DWORD
    v_cmp_lt_u32 vcc, s16, v188
    v_cmp_ne_u32 s[88:89], 0, v140
    v_cmp_ne_u32 s[90:91], 0, v141
    v_cmp_ne_u32 s[92:93], 0, v142
    s_cbranch_vccnz L_RT3
    s_mov_b64 exec, s[88:89]
    ds_add_rtn_u32 v124, v108, v184 offset:1024
    s_mov_b64 exec, s[90:91]
    ds_add_rtn_u32 v125, v109, v184 offset:1024
    s_mov_b64 exec, s[92:93]
    ds_add_rtn_u32 v126, v110, v184 offset:1024
    s_mov_b64 exec, -1
    v_or3_b32 v190, v131, v135, v139
    v_or_b32 v190, v190, v143
    v_and_b32 v190, 0x1000000, v190
    v_cmp_ne_u32 vcc, 0, v190
    s_cbranch_vccnz L_XT1
L_XT1R:
    v_add_u32_sdwa v219, v143, v159 dst_sel:DWORD dst_unused:UNUSED_PAD src0_sel:BYTE_0 src1_sel:DWORD
    v_lshrrev_b32 v189, 28, v140
    v_lshl_add_u32 v219, v189, 8, v219
    v_and_b32 v189, 60, v108
    v_lshl_add_u32 v216, v189, 19, v219
    v_add_u32_sdwa v217, v143, v159 dst_sel:DWORD dst_unused:UNUSED_PAD src0_sel:BYTE_1 src1_sel:DWORD
    v_lshrrev_b32 v189, 28, v141
    v_lshl_add_u32 v217, v189, 8, v217
    v_and_b32 v189, 60, v109
    v_lshl_add_u32 v217, v189, 19, v217
    v_add_u32_sdwa v218, v143, v159 dst_sel:DWORD dst_unused:UNUSED_PAD src0_sel:BYTE_2 src1_sel:DWORD
    v_lshrrev_b32 v189, 28, v142
    v_lshl_add_u32 v218, v189, 8, v218
    v_and_b32 v189, 60, v110
    v_lshl_add_u32 v218, v189, 19, v218
    v_cndmask_b32 v188, v180, v219, s[88:89]
    s_nop 1
    v_mov_b32_dpp v189, v188 quad_perm:[2,2,3,3] row_mask:0xf bank_mask:0xf
    v_mov_b32_dpp v219, v188 quad_perm:[0,0,1,1] row_mask:0xf bank_mask:0xf
    s_nop 0
    v_mov_b32_dpp v219, v189 row_shr:4 row_mask:0xf bank_mask:0xa
    v_mov_b32 v197, 640
    s_cmp_eq_u32 s3, 6
    s_cselect_b32 exec_hi, 0, -1
    s_cmp_eq_u32 s3, 7
    s_cselect_b64 exec, 1, exec
    s_add_u32 m0, s101, 0
    s_nop 0
    buffer_load_dwordx4 v234, s[40:43], 0 offen offset:0 lds
    s_add_u32 m0, s101, 6560
    s_nop 0
    buffer_load_dwordx4 v234, s[40:43], 0 offen offset:128 lds
    s_add_u32 m0, s101, 13120
    s_nop 0
    buffer_load_dwordx4 v234, s[40:43], 0 offen offset:256 lds
    s_add_u32 m0, s101, 19680
    s_nop 0
    buffer_load_dwordx4 v234, s[40:43], 0 offen offset:384 lds
    s_mov_b64 exec, -1
    s_waitcnt lgkmcnt(0)
    s_barrier
    ds_read_u16 v198, v178 offset:1024
    ds_read_u16 v199, v178 offset:2048
    ds_read_b128 v[160:163], v185 offset:1024
    ds_read_b128 v[164:167], v185 offset:2048
    ds_read_b128 v[168:171], v185 offset:3072
    ds_read_b128 v[172:175], v185 offset:4096
    ds_read_b32 v236, v197 offset:8
    s_lshl_b32 m0, s3, 10
    v_mov_b32 v240, v207
    s_add_u32 m0, m0, 13312
    s_nop 0
    buffer_load_dwordx4 v[240:241], s[44:47], 0 idxen offen lds
    s_cmp_lg_u32 s2, 0
    s_cbranch_scc1 L_NOK
    v_mov_b32 v237, s6
    v_mov_b32 v238, 0
    buffer_store_dword v237, v238, s[52:55], 0 offen sc1
L_NOK:
    s_waitcnt lgkmcnt(5)
    v_lshl_or_b32 v198, v199, 16, v198
    v_mov_b32 v199, v198
    s_waitcnt lgkmcnt(0)
    v_add_u32_sdwa v188, v160, v164 dst_sel:DWORD dst_unused:UNUSED_PAD src0_sel:WORD_0 src1_sel:WORD_0
    v_add_u32_sdwa v192, v168, v172 dst_sel:DWORD dst_unused:UNUSED_PAD src0_sel:WORD_0 src1_sel:WORD_0
    v_add_u32_dpp v199, v199, v199 row_shr:1 row_mask:0xf bank_mask:0xf bound_ctrl:0
    v_add_u32_sdwa v189, v161, v165 dst_sel:DWORD dst_unused:UNUSED_PAD src0_sel:WORD_0 src1_sel:WORD_0
    v_add_u32_sdwa v193, v169, v173 dst_sel:DWORD dst_unused:UNUSED_PAD src0_sel:WORD_0 src1_sel:WORD_0
    v_add_u32_dpp v199, v199, v199 row_shr:2 row_mask:0xf bank_mask:0xf bound_ctrl:0
    v_add_u32_sdwa v190, v162, v166 dst_sel:DWORD dst_unused:UNUSED_PAD src0_sel:WORD_0 src1_sel:WORD_0
    v_add_u32_sdwa v194, v170, v174 dst_sel:DWORD dst_unused:UNUSED_PAD src0_sel:WORD_0 src1_sel:WORD_0
    v_add_u32_dpp v199, v199, v199 row_shr:4 row_mask:0xf bank_mask:0xf bound_ctrl:0
    v_add_u32_sdwa v191, v163, v167 dst_sel:DWORD dst_unused:UNUSED_PAD src0_sel:WORD_0 src1_sel:WORD_0
    v_add_u32_sdwa v195, v171, v175 dst_sel:DWORD dst_unused:UNUSED_PAD src0_sel:WORD_0 src1_sel:WORD_0
    v_add_u32_dpp v199, v199, v199 row_shr:8 row_mask:0xf bank_mask:0xf bound_ctrl:0
    v_add_u32 v188, v188, v192
    v_add_u32 v189, v189, v193
    v_add_u32_dpp v199, v199, v199 row_bcast:15 row_mask:0xa bank_mask:0xf
    v_add_u32 v190, v190, v194
    v_add_u32 v191, v191, v195
    v_add_u32 v193, v188, v189
    v_add_u32 v194, v193, v190
    v_add_u32 v195, v194, v191
    v_mov_b32 v196, v195
    s_mov_b32 s96, -1
    s_mov_b32 s97, 0
    v_sub_u32 v200, v199, v198
    v_add_u32_sdwa v202, v199, v199 dst_sel:DWORD dst_unused:UNUSED_PAD src0_sel:WORD_0 src1_sel:WORD_1
    v_add_u32_dpp v196, v196, v196 row_shr:1 row_mask:0xf bank_mask:0xf bound_ctrl:0
    v_add_u32_sdwa v201, v200, v200 dst_sel:DWORD dst_unused:UNUSED_PAD src0_sel:WORD_0 src1_sel:WORD_1
    v_add_u32_sdwa v203, v198, v198 dst_sel:DWORD dst_unused:UNUSED_PAD src0_sel:WORD_0 src1_sel:WORD_1
    v_add_u32_dpp v196, v196, v196 row_shr:2 row_mask:0xf bank_mask:0xf bound_ctrl:0
    v_add_u32 v189, v188, v193
    v_add_u32 v190, v193, v194
    v_add_u32_dpp v196, v196, v196 row_shr:4 row_mask:0xf bank_mask:0xf bound_ctrl:0
    v_permlane32_swap_b32 v201, v202
    v_add_u32 v191, v194, v195
    v_add_u32_dpp v196, v196, v196 row_shr:8 row_mask:0xf bank_mask:0xf bound_ctrl:0
    v_add_u32 v201, v201, v202
    v_cndmask_b32 v203, 0, v203, s[96:97]
    v_add_u32_dpp v196, v196, v196 row_bcast:15 row_mask:0xa bank_mask:0xf
    v_add_u32 v202, v201, v203
    v_readfirstlane_b32 s19, v236
    v_add_u32_dpp v196, v196, v196 row_bcast:31 row_mask:0xc bank_mask:0xf
    s_lshl_b32 m0, s3, 10
    v_mov_b32 v240, v211
    s_add_u32 m0, m0, 21504
    s_nop 0
    buffer_load_dwordx4 v[240:241], s[44:47], 0 idxen offen lds
    v_sub_u32 v192, v196, v195
    v_readlane_b32 s10, v196, 63
    v_sub_u32_sdwa v203, v202, v198 dst_sel:DWORD dst_unused:UNUSED_PAD src0_sel:DWORD src1_sel:WORD_1
    v_lshl_add_u32 v188, v192, 1, v188
    v_lshl_add_u32 v189, v192, 1, v189
    v_lshl_add_u32 v190, v192, 1, v190
    v_lshl_add_u32 v191, v192, 1, v191
    s_lshr_b32 s11, s10, 5
    s_add_u32 s11, s11, 12
    s_and_b32 s11, s11, -32
    s_sub_i32 s11, s11, 12
    s_lshl_b32 s11, s11, 3
    s_lshr_b32 s10, s10, 1
    s_lshr_b32 s8, s4, 1
    s_mul_i32 s8, s8, s10
    s_add_i32 s11, s11, s8
    s_add_i32 s10, s10, s8
    s_bitcmp1_b32 s4, 0
    s_cselect_b32 s31, s11, s8
    s_cselect_b32 s10, s10, s11
    s_mov_b32 s8, 0
    s_mov_b32 s9, 0
    v_cmp_gt_i32 vcc, s31, v188
    v_cmp_gt_i32 s[34:35], s10, v188
    s_bcnt1_i32_b64 s11, vcc
    s_add_u32 s8, s8, s11
    s_bcnt1_i32_b64 s11, s[34:35]
    s_add_u32 s9, s9, s11
    v_cmp_gt_i32 vcc, s31, v189
    v_cmp_gt_i32 s[34:35], s10, v189
    s_bcnt1_i32_b64 s11, vcc
    s_add_u32 s8, s8, s11
    s_bcnt1_i32_b64 s11, s[34:35]
    s_add_u32 s9, s9, s11
    v_cmp_gt_i32 vcc, s31, v190
    v_cmp_gt_i32 s[34:35], s10, v190
    s_bcnt1_i32_b64 s11, vcc
    s_add_u32 s8, s8, s11
    s_bcnt1_i32_b64 s11, s[34:35]
    s_add_u32 s9, s9, s11
    v_cmp_gt_i32 vcc, s31, v191
    v_cmp_gt_i32 s[34:35], s10, v191
    s_bcnt1_i32_b64 s11, vcc
    s_add_u32 s8, s8, s11
    s_bcnt1_i32_b64 s11, s[34:35]
    s_add_u32 s9, s9, s11
    s_max_i32 s8, s8, s22
    s_min_i32 s8, s8, s23
    s_max_i32 s9, s9, s24
    s_min_i32 s9, s9, s25
    s_lshl_b32 m0, s3, 10
    v_mov_b32 v240, v215
    s_add_u32 m0, m0, 29696
    s_nop 0
    buffer_load_dwordx4 v[240:241], s[44:47], 0 idxen offen lds
    s_sub_u32 s22, s8, s7
    s_sub_u32 s23, s9, s7
    v_readlane_b32 s16, v201, s22
    v_readlane_b32 s30, v201, s23
    s_add_u32 s10, s22, 32
    s_add_u32 s11, s23, 32
    v_readlane_b32 s26, v200, s22
    v_readlane_b32 s28, v200, s23
    v_readlane_b32 s27, v200, s10
    v_readlane_b32 s29, v200, s11
    s_sub_u32 s31, s30, s16
    s_add_u32 s10, s31, 255
    s_lshr_b32 s10, s10, 8
    s_lshl_b32 s10, s10, 7
    s_sub_u32 s10, s10, s19
    s_max_i32 s10, s10, 0
    s_add_u32 s16, s16, s10
    s_add_u32 s10, s22, 16
    s_min_u32 s10, s10, s23
    s_sub_i32 s11, s23, 16
    v_cmp_ge_u32 s[34:35], s16, v203
    v_cmp_ge_u32 s[36:37], s16, v202
    v_cmp_gt_i32 vcc, s10, v177
    v_cmp_gt_i32 s[10:11], s11, v177
    v_cmp_le_u32 s[32:33], s22, v177
    v_cmp_gt_u32 s[96:97], s23, v177
    s_and_b64 s[34:35], s[34:35], vcc
    s_and_b64 s[36:37], s[36:37], vcc
    s_or_b64 s[34:35], s[34:35], s[10:11]
    s_or_b64 s[36:37], s[36:37], s[10:11]
    s_bcnt1_i32_b32 s24, s34
    s_bcnt1_i32_b32 s10, s36
    s_bcnt1_i32_b32 s11, s35
    s_bcnt1_i32_b32 s25, s37
    v_readlane_b32 s22, v200, s24
    v_readlane_b32 s10, v200, s10
    s_add_u32 s11, s11, 32
    s_add_u32 s16, s25, 32
    v_readlane_b32 s23, v200, s11
    v_readlane_b32 s11, v200, s16
    v_mov_b32 v188, s17
    v_cndmask_b32 v189, 0, v188, s[34:35]
    v_cndmask_b32 v188, 0, v188, s[36:37]
    s_and_b64 s[32:33], s[32:33], s[96:97]
    s_pack_lh_b32_b16 s22, s22, s10
    s_pack_lh_b32_b16 s23, s23, s11
    v_lshl_or_b32 v188, v188, 16, v189
    s_sub_u32 s16, s12, 37888
    s_pack_ll_b32_b16 s16, s16, s16
    s_sub_u32 s10, s22, s26
    s_sub_u32 s11, s23, s27
    s_mul_i32 s10, s10, 0x10001
    s_lshl_b32 vcc_lo, s10, 16
    s_pack_hh_b32_b16 s10, s10, s10
    s_lshl_b32 vcc_hi, s11, 16
    s_add_u32 vcc_hi, vcc_hi, s10
    s_add_u32 s96, vcc_hi, s11
    s_lshr_b32 s96, s96, 16
    s_sub_u32 s31, s31, s96
    s_cmp_gt_u32 s31, s96
    s_cselect_b32 s97, 0x4800480, 0
    s_add_u32 s16, s16, s97
    s_sub_u32 s10, s16, s26
    s_sub_u32 s11, s16, s27
    s_add_u32 s10, s10, vcc_lo
    s_add_u32 s11, s11, vcc_hi
    v_mov_b32 v192, s10
    v_mov_b32 v193, s11
    s_add_u32 s16, s16, 0x4800480
    s_sub_u32 s16, s16, s97
    s_sub_u32 s16, s16, s97
    s_sub_u32 s10, s28, s22
    s_sub_u32 s11, s29, s23
    s_mul_i32 s10, s10, 0x10001
    s_lshl_b32 vcc_lo, s10, 16
    s_pack_hh_b32_b16 s10, s10, s10
    s_lshl_b32 vcc_hi, s11, 16
    s_add_u32 vcc_hi, vcc_hi, s10
    s_sub_u32 s10, s16, s22
    s_sub_u32 s11, s16, s23
    s_add_u32 s10, s10, vcc_lo
    s_add_u32 s11, s11, vcc_hi
    v_mov_b32 v194, s10
    v_mov_b32 v195, s11
    v_bfi_b32 v192, v188, v192, v194
    v_bfi_b32 v193, v188, v193, v195
    s_mov_b32 exec_hi, 0
    v_mov_b32 v193, v192
    s_mov_b64 exec, s[32:33]
    v_add_u32 v200, v200, v193
    s_bfe_u32 s10, s97, 0x10007
    s_lshl1_add_u32 s10, s4, s10
    s_lshl_b32 s10, s10, 2
    v_cndmask_b32 v188, 4, 0, s[34:35]
    ds_write_b16 v178, v200 offset:1026
    ds_write_b16_d16_hi v178, v200 offset:2050
    s_mov_b32 exec_hi, 0
    v_xor_b32 v188, s10, v188
    ds_write_b32 v179, v188
    s_mov_b64 exec, -1
    s_min_u32 s10, s31, s96
    s_max_u32 s96, s31, s96
    s_mov_b32 s31, s10
    s_add_u32 s10, s96, s19
    s_mul_i32 s11, s30, 9216
    s_lshr_b32 s11, s11, 16
    s_max_u32 s10, s10, s11
    s_cmp_lt_u32 s10, 1152
    s_cbranch_scc1 L_LFIT
    ds_write_b32 v197, v184
L_LFIT:
    s_cmp_lg_u32 s19, 0
    s_cbranch_scc1 L_XCN
L_XCNR:
    s_lshl_b32 m0, s3, 10
    v_mov_b32 v240, v219
    s_add_u32 m0, m0, 37888
    s_nop 0
    buffer_load_dwordx4 v[240:241], s[44:47], 0 idxen offen lds
    v_and_or_b32 v128, v128, s17, v152
    v_or_b32 v204, v204, v176
    v_and_b32 v129, s17, v129
    v_and_b32 v130, s17, v130
    v_and_or_b32 v132, v132, s17, v153
    v_or_b32 v208, v208, v176
    v_and_b32 v133, s17, v133
    v_and_b32 v134, s17, v134
    v_and_or_b32 v136, v136, s17, v154
    v_or_b32 v212, v212, v176
    v_and_b32 v137, s17, v137
    v_and_b32 v138, s17, v138
    v_and_or_b32 v140, v140, s17, v155
    v_or_b32 v216, v216, v176
    v_and_b32 v141, s17, v141
    v_and_b32 v142, s17, v142
    s_waitcnt lgkmcnt(0)
    s_barrier
    ds_read_b64 v[202:203], v197
    ds_read_u16 v96, v96 offset:1026
    ds_read_u16 v97, v97 offset:1026
    ds_read_u16 v98, v98 offset:1026
    ds_read_u16 v100, v100 offset:1026
    ds_read_u16 v101, v101 offset:1026
    ds_read_u16 v102, v102 offset:1026
    ds_read_u16 v104, v104 offset:1026
    ds_read_u16 v105, v105 offset:1026
    ds_read_u16 v106, v106 offset:1026
    ds_read_u16 v108, v108 offset:1026
    ds_read_u16 v109, v109 offset:1026
    ds_read_u16 v110, v110 offset:1026
    s_add_u32 s24, s24, s7
    s_add_u32 s11, s25, s7
    s_and_b32 s10, s11, 15
    s_cmp_lt_u32 s11, s24
    s_cselect_b32 s25, s10, 16
    s_cmp_lg_u32 s97, 0
    s_cselect_b32 s23, s8, s11
    s_cselect_b32 s7, s8, s24
    s_cselect_b32 s8, s11, s8
    s_cselect_b32 s24, s9, s24
    s_cselect_b32 s9, s11, s9
    s_min_u32 s22, s8, 192
    s_min_u32 s23, s23, 192
    s_mov_b32 s30, s19
    s_waitcnt lgkmcnt(12)
    v_cmp_ne_u32 vcc, 0, v202
    v_readfirstlane_b32 s19, v203
    s_cbranch_vccnz L_OVF
    s_waitcnt lgkmcnt(11)
    v_add_u32 v96, v96, v112
    s_mov_b64 exec, s[64:65]
    ds_write2st64_b32 v96, v128, v204 offset0:148 offset1:220
    s_mov_b64 exec, -1
    s_waitcnt lgkmcnt(11)
    v_add_u32 v97, v97, v113
    s_mov_b64 exec, s[66:67]
    ds_write2st64_b32 v97, v129, v205 offset0:148 offset1:220
    s_mov_b64 exec, -1
    s_waitcnt lgkmcnt(11)
    v_add_u32 v98, v98, v114
    s_mov_b64 exec, s[68:69]
    ds_write2st64_b32 v98, v130, v206 offset0:148 offset1:220
    s_mov_b64 exec, -1
    s_waitcnt lgkmcnt(11)
    v_add_u32 v100, v100, v116
    s_mov_b64 exec, s[72:73]
    ds_write2st64_b32 v100, v132, v208 offset0:148 offset1:220
    s_mov_b64 exec, -1
    s_waitcnt lgkmcnt(11)
    v_add_u32 v101, v101, v117
    s_mov_b64 exec, s[74:75]
    ds_write2st64_b32 v101, v133, v209 offset0:148 offset1:220
    s_mov_b64 exec, -1
    s_waitcnt lgkmcnt(11)
    v_add_u32 v102, v102, v118
    s_mov_b64 exec, s[76:77]
    ds_write2st64_b32 v102, v134, v210 offset0:148 offset1:220
    s_mov_b64 exec, -1
    s_waitcnt lgkmcnt(11)
    v_add_u32 v104, v104, v120
    s_mov_b64 exec, s[80:81]
    ds_write2st64_b32 v104, v136, v212 offset0:148 offset1:220
    s_mov_b64 exec, -1
    s_waitcnt lgkmcnt(11)
    v_add_u32 v105, v105, v121
    s_mov_b64 exec, s[82:83]
    ds_write2st64_b32 v105, v137, v213 offset0:148 offset1:220
    s_mov_b64 exec, -1
    s_waitcnt lgkmcnt(11)
    v_add_u32 v106, v106, v122
    s_mov_b64 exec, s[84:85]
    ds_write2st64_b32 v106, v138, v214 offset0:148 offset1:220
    s_mov_b64 exec, -1
    s_waitcnt lgkmcnt(11)
    v_add_u32 v108, v108, v124
    s_mov_b64 exec, s[88:89]
    ds_write2st64_b32 v108, v140, v216 offset0:148 offset1:220
    s_mov_b64 exec, -1
    s_waitcnt lgkmcnt(11)
    v_add_u32 v109, v109, v125
    s_mov_b64 exec, s[90:91]
    ds_write2st64_b32 v109, v141, v217 offset0:148 offset1:220
    s_mov_b64 exec, -1
    s_waitcnt lgkmcnt(11)
    v_add_u32 v110, v110, v126
    s_mov_b64 exec, s[92:93]
    ds_write2st64_b32 v110, v142, v218 offset0:148 offset1:220
    s_mov_b64 exec, -1
    s_add_u32 s10, s96, 127
    s_lshr_b32 s10, s10, 7
    s_lshl1_add_u32 s10, s10, -1
    s_add_u32 s11, s31, 127
    s_lshr_b32 s11, s11, 6
    s_and_b32 s11, s11, -2
    s_max_i32 s17, s10, s11
    s_cselect_b32 s10, s96, s31
    s_sub_u32 s10, s10, 1
    s_andn2_b32 s99, 64, s10
L_CA:
    s_cmp_lg_u32 s21, 0
    s_cbranch_scc1 L_XT2
L_XT2R:
    ds_read_b64_tr_b16 v[96:97], v225 offset:0
    ds_read_b64_tr_b16 v[98:99], v225 offset:1280
    ds_read_b64_tr_b16 v[100:101], v225 offset:5120
    ds_read_b64_tr_b16 v[102:103], v225 offset:6400
    ds_read_b64_tr_b16 v[104:105], v225 offset:32
    ds_read_b64_tr_b16 v[106:107], v225 offset:1312
    ds_read_b64_tr_b16 v[108:109], v225 offset:5152
    ds_read_b64_tr_b16 v[110:111], v225 offset:6432
    ds_read_b64_tr_b16 v[112:113], v225 offset:64
    ds_read_b64_tr_b16 v[114:115], v225 offset:1344
    ds_read_b64_tr_b16 v[116:117], v225 offset:5184
    ds_read_b64_tr_b16 v[118:119], v225 offset:6464
    ds_read_b64_tr_b16 v[120:121], v225 offset:96
    ds_read_b64_tr_b16 v[122:123], v225 offset:1376
    ds_read_b64_tr_b16 v[124:125], v225 offset:5216
    ds_read_b64_tr_b16 v[126:127], v225 offset:6496
    s_waitcnt vmcnt(0) lgkmcnt(0)
    s_barrier
    s_cmp_lg_u32 s30, 0
    s_cbranch_scc1 L_XT3
L_XT3R:
    s_mov_b32 s10, 0x358637bd
    ds_read_b128 v[236:239], v247
    ds_read_b32 v240, v248
    v_lshrrev_b32 v188, 2, v253
    v_and_b32 v188, 12, v188
    v_subrev_u32 v188, s25, v188
    s_waitcnt lgkmcnt(0)
    s_add_u32 m0, s13, 0
    v_mad_u32_u16 v236, v236, s15, v243
    buffer_load_dwordx4 v236, s[40:43], 0 offen lds
    s_add_u32 m0, s13, 1056
    v_mad_u32_u16 v237, v237, s15, v243
    buffer_load_dwordx4 v237, s[40:43], 0 offen lds
    s_add_u32 m0, s13, 2112
    v_mad_u32_u16 v238, v238, s15, v243
    buffer_load_dwordx4 v238, s[40:43], 0 offen lds
    s_add_u32 m0, s13, 3168
    v_mad_u32_u16 v239, v239, s15, v243
    buffer_load_dwordx4 v239, s[40:43], 0 offen lds
    s_mov_b32 m0, s14
    v_and_b32 v240, 0xfffff, v240
    buffer_load_dwordx4 v[240:241], s[44:47], 0 idxen offen lds
L_LATE0:
    s_lshl_b32 s34, s22, 5
    s_lshl_b32 s35, s23, 5
    s_mov_b32 vcc_lo, 0xff00ff00
    s_mov_b32 vcc_hi, 0xff00ff00
    v_mov_b32 v176, s35
    v_mov_b32 v177, s34
    v_cndmask_b32 v176, v176, v177, vcc
    v_and_b32 v177, 4, v253
    v_lshlrev_b32 v177, 6, v177
    v_lshl_add_u32 v177, v246, 2, v177
    v_sub_u32 v177, v177, v176
    v_and_b32 v178, 48, v253
    s_movk_i32 s34, 832
    v_mad_u32_u24 v178, v246, s34, v178
    s_mov_b32 s34, 116736
    v_add3_u32 v178, v178, v176, s34
    v_and_b32 v176, 0x1ff, v177
    v_add_u32 v176, v176, v178
    ds_read_b128 v[160:163], v176 offset:0
    ds_read_b128 v[164:167], v176 offset:64
    v_add_u32 v177, 0x80, v177
    v_and_b32 v176, 0x1ff, v177
    v_add_u32 v176, v176, v178
    ds_read_b128 v[168:171], v176 offset:0
    ds_read_b128 v[172:175], v176 offset:64
    s_mov_b32 s34, 0xbfb8aa3b
    s_mov_b32 s35, s34
    s_waitcnt lgkmcnt(3)
    v_mfma_f32_16x16x32_bf16 v[204:207], v[160:163], v[96:99], 0
    v_mfma_f32_16x16x32_bf16 v[212:215], v[160:163], v[104:107], 0
    v_mfma_f32_16x16x32_bf16 v[220:223], v[160:163], v[112:115], 0
    v_mfma_f32_16x16x32_bf16 v[228:231], v[160:163], v[120:123], 0
    s_waitcnt lgkmcnt(2)
    v_mfma_f32_16x16x32_bf16 v[204:207], v[164:167], v[100:103], v[204:207]
    v_mfma_f32_16x16x32_bf16 v[212:215], v[164:167], v[108:111], v[212:215]
    v_mfma_f32_16x16x32_bf16 v[220:223], v[164:167], v[116:119], v[220:223]
    v_mfma_f32_16x16x32_bf16 v[228:231], v[164:167], v[124:127], v[228:231]
    s_waitcnt lgkmcnt(1)
    v_mfma_f32_16x16x32_bf16 v[208:211], v[168:171], v[96:99], 0
    v_mfma_f32_16x16x32_bf16 v[216:219], v[168:171], v[104:107], 0
    v_mfma_f32_16x16x32_bf16 v[224:227], v[168:171], v[112:115], 0
    v_mfma_f32_16x16x32_bf16 v[232:235], v[168:171], v[120:123], 0
    s_waitcnt lgkmcnt(0)
    v_mfma_f32_16x16x32_bf16 v[208:211], v[172:175], v[100:103], v[208:211]
    v_mfma_f32_16x16x32_bf16 v[216:219], v[172:175], v[108:111], v[216:219]
    v_mfma_f32_16x16x32_bf16 v[224:227], v[172:175], v[116:119], v[224:227]
    v_mfma_f32_16x16x32_bf16 v[232:235], v[172:175], v[124:127], v[232:235]
    s_mov_b32 s11, s10
    v_mov_b32 v189, s10
    v_mov_b64 v[96:97], s[10:11]
    v_mov_b64 v[98:99], s[10:11]
    v_mov_b64 v[100:101], s[10:11]
    v_mov_b64 v[102:103], s[10:11]
    v_mov_b64 v[104:105], s[10:11]
    v_mov_b64 v[106:107], s[10:11]
    v_mov_b64 v[108:109], s[10:11]
    v_mov_b64 v[110:111], s[10:11]
    v_cmp_ne_u32 vcc, 0, v188
    v_mov_b64 v[112:113], 0
    v_mov_b64 v[114:115], 0
    v_cndmask_b32 v128, 0, v189, vcc
    v_cmp_ne_u32 vcc, -1, v188
    v_mov_b64 v[116:117], 0
    v_mov_b64 v[118:119], 0
    v_cndmask_b32 v129, 0, v189, vcc
    v_cmp_ne_u32 vcc, -2, v188
    v_mov_b64 v[120:121], 0
    v_mov_b64 v[122:123], 0
    v_cndmask_b32 v130, 0, v189, vcc
    v_cmp_ne_u32 vcc, -3, v188
    v_mov_b64 v[124:125], 0
    v_mov_b64 v[126:127], 0
    v_cndmask_b32 v131, 0, v189, vcc
    v_mov_b64 v[144:145], 0
    v_mov_b64 v[146:147], 0
    v_mov_b64 v[148:149], 0
    v_mov_b64 v[150:151], 0
    v_mov_b64 v[152:153], 0
    v_mov_b64 v[154:155], 0
    v_mov_b64 v[156:157], 0
    v_mov_b64 v[158:159], 0
    v_mov_b64 v[132:133], v[128:129]
    v_mov_b64 v[134:135], v[130:131]
    v_mov_b64 v[136:137], v[128:129]
    v_mov_b64 v[138:139], v[130:131]
    v_mov_b64 v[140:141], v[128:129]
    v_mov_b64 v[142:143], v[130:131]
    v_pk_mul_f32 v[204:205], v[204:205], s[34:35]
    v_pk_mul_f32 v[206:207], v[206:207], s[34:35]
    v_pk_mul_f32 v[208:209], v[208:209], s[34:35]
    v_pk_mul_f32 v[210:211], v[210:211], s[34:35]
    v_pk_mul_f32 v[212:213], v[212:213], s[34:35]
    v_pk_mul_f32 v[214:215], v[214:215], s[34:35]
    v_pk_mul_f32 v[216:217], v[216:217], s[34:35]
    v_pk_mul_f32 v[218:219], v[218:219], s[34:35]
    v_pk_mul_f32 v[220:221], v[220:221], s[34:35]
    v_pk_mul_f32 v[222:223], v[222:223], s[34:35]
    v_pk_mul_f32 v[224:225], v[224:225], s[34:35]
    v_pk_mul_f32 v[226:227], v[226:227], s[34:35]
    v_pk_mul_f32 v[228:229], v[228:229], s[34:35]
    v_pk_mul_f32 v[230:231], v[230:231], s[34:35]
    v_pk_mul_f32 v[232:233], v[232:233], s[34:35]
    v_pk_mul_f32 v[234:235], v[234:235], s[34:35]
    v_cvt_pk_bf16_f32 v64, v204, v205
    v_cvt_pk_bf16_f32 v65, v206, v207
    v_cvt_pk_bf16_f32 v66, v208, v209
    v_cvt_pk_bf16_f32 v67, v210, v211
    v_cvt_pk_bf16_f32 v68, v212, v213
    v_cvt_pk_bf16_f32 v69, v214, v215
    v_cvt_pk_bf16_f32 v70, v216, v217
    v_cvt_pk_bf16_f32 v71, v218, v219
    v_cvt_pk_bf16_f32 v72, v220, v221
    v_cvt_pk_bf16_f32 v73, v222, v223
    v_cvt_pk_bf16_f32 v74, v224, v225
    v_cvt_pk_bf16_f32 v75, v226, v227
    v_cvt_pk_bf16_f32 v76, v228, v229
    v_cvt_pk_bf16_f32 v77, v230, v231
    v_cvt_pk_bf16_f32 v78, v232, v233
    v_cvt_pk_bf16_f32 v79, v234, v235
    v_permlane32_swap_b32 v80, v64
    v_permlane32_swap_b32 v81, v65
    v_permlane32_swap_b32 v82, v66
    v_permlane32_swap_b32 v83, v67
    v_permlane32_swap_b32 v84, v68
    v_permlane32_swap_b32 v85, v69
    v_permlane32_swap_b32 v86, v70
    v_permlane32_swap_b32 v87, v71
    v_permlane32_swap_b32 v88, v72
    v_permlane32_swap_b32 v89, v73
    v_permlane32_swap_b32 v90, v74
    v_permlane32_swap_b32 v91, v75
    v_permlane32_swap_b32 v92, v76
    v_permlane32_swap_b32 v93, v77
    v_permlane32_swap_b32 v94, v78
    v_permlane32_swap_b32 v95, v79
    s_mov_b32 s26, -1
    s_mov_b64 s[32:33], 0
    s_mov_b32 s28, 0
    s_mov_b32 s29, 0
L_GO:
    ds_read_u16 v251, v249 offset:0
    ds_read_u16 v252, v249 offset:64
    ds_read_b128 v[236:239], v247 offset:1152
    ds_read_b32 v240, v248 offset:1152
    s_lshr_b32 s10, s4, 1
    s_lshl_b32 s10, s10, 8
    s_add_u32 s10, s10, 155776
    v_lshl_add_u32 v255, v253, 2, s10
    s_bitcmp1_b32 s4, 0
    s_cselect_b32 s101, -1, 1
    s_max_i32 s10, s17, 1
    s_sub_u32 s10, s10, 1
    s_mul_i32 s10, s101, s10
    s_lshl_b32 s10, s10, 24
    v_mov_b32 v204, s10
    ds_add_u32 v255, v204
    v_mov_b32 v253, 0
    s_mov_b32 exec_hi, 0
    v_add_u32 v253, 0x200, v245
    s_mov_b32 exec_hi, -1
    v_mov_b64 v[204:205], 0
    v_mov_b64 v[206:207], 0
    v_mov_b64 v[208:209], 0
    v_mov_b64 v[210:211], 0
    v_mov_b64 v[212:213], 0
    v_mov_b64 v[214:215], 0
    v_mov_b64 v[216:217], 0
    v_mov_b64 v[218:219], 0
    v_mov_b64 v[220:221], 0
    v_mov_b64 v[222:223], 0
    v_mov_b64 v[224:225], 0
    v_mov_b64 v[226:227], 0
    v_mov_b64 v[228:229], 0
    v_mov_b64 v[230:231], 0
    v_mov_b64 v[232:233], 0
    v_mov_b64 v[234:235], 0
    v_mov_b64 v[184:185], 0
    v_mov_b64 v[186:187], 0
    s_waitcnt lgkmcnt(0)
    v_bfi_b32 v251, 31, v245, v251
    v_bfi_b32 v252, 31, v245, v252
    v_max_u32 v251, v251, v245
    v_max_u32 v252, v252, v253
    s_waitcnt vmcnt(0)
    ds_read_b128 v[176:179], v251
    ds_read_b128 v[180:183], v252
    ds_read_b128 v[160:163], v244 offset:0
    ds_read_b128 v[168:171], v244 offset:512
    ds_read_b128 v[164:167], v244 offset:64
    ds_read_b128 v[172:175], v244 offset:576
    s_cmp_lt_i32 s17, 1
    s_cbranch_scc1 L_DONE
    s_waitcnt lgkmcnt(4)
    v_mfma_f32_16x16x32_bf16 v[188:191], v[176:179], v[64:67], 0
    v_mfma_f32_16x16x32_bf16 v[196:199], v[176:179], v[68:71], 0
    v_mfma_f32_16x16x32_bf16 v[192:195], v[180:183], v[64:67], 0
    v_mfma_f32_16x16x32_bf16 v[200:203], v[180:183], v[68:71], 0
    s_waitcnt lgkmcnt(0)
    v_mfma_f32_16x16x32_bf16 v[188:191], v[160:163], v[0:3], v[188:191]
    v_mfma_f32_16x16x32_bf16 v[196:199], v[160:163], v[8:11], v[196:199]
    v_mfma_f32_16x16x32_bf16 v[192:195], v[168:171], v[0:3], v[192:195]
    v_mfma_f32_16x16x32_bf16 v[200:203], v[168:171], v[8:11], v[200:203]
    v_mfma_f32_16x16x32_bf16 v[188:191], v[164:167], v[4:7], v[188:191]
    v_mfma_f32_16x16x32_bf16 v[196:199], v[164:167], v[12:15], v[196:199]
    v_mfma_f32_16x16x32_bf16 v[192:195], v[172:175], v[4:7], v[192:195]
    v_mfma_f32_16x16x32_bf16 v[200:203], v[172:175], v[12:15], v[200:203]
    s_mov_b32 s16, 1
    s_cmp_eq_u32 s17, 1
    s_cbranch_scc1 L_LT0
    s_add_u32 m0, s13, 0
    v_mad_u32_u16 v236, v236, s15, v243
    buffer_load_dwordx4 v236, s[40:43], 0 offen lds
    s_add_u32 m0, s13, 1056
    v_mad_u32_u16 v237, v237, s15, v243
    buffer_load_dwordx4 v237, s[40:43], 0 offen lds
    s_add_u32 m0, s13, 2112
    v_mad_u32_u16 v238, v238, s15, v243
    buffer_load_dwordx4 v238, s[40:43], 0 offen lds
    s_add_u32 m0, s13, 3168
    v_mad_u32_u16 v239, v239, s15, v243
    buffer_load_dwordx4 v239, s[40:43], 0 offen lds
    s_mov_b32 m0, s14
    v_and_b32 v240, 0xfffff, v240
    buffer_load_dwordx4 v[240:241], s[44:47], 0 idxen offen lds
.p2align 6
L_LOOP1:
    s_setprio 1
    v_smfmac_f32_16x16x64_bf16 v[152:155], v[184:187], v[204:211], v242
    ds_read_u16 v236, v250 offset:0
    ds_read_u16 v237, v250 offset:16
    ds_add_rtn_u32 v238, v255, v242
    v_exp_f32 v188, v188
    v_smfmac_f32_16x16x64_bf16 v[156:159], v[184:187], v[212:219], v242
    v_exp_f32 v189, v189
    v_mfma_f32_16x16x32_bf16 v[204:207], v[160:163], v[32:35], 0
    v_exp_f32 v190, v190
    v_mfma_f32_16x16x32_bf16 v[212:215], v[160:163], v[40:43], 0
    v_exp_f32 v191, v191
    v_mfma_f32_16x16x32_bf16 v[208:211], v[168:171], v[32:35], 0
    v_exp_f32 v192, v192
    v_mfma_f32_16x16x32_bf16 v[216:219], v[168:171], v[40:43], 0
    v_exp_f32 v193, v193
    v_mfma_f32_16x16x32_bf16 v[204:207], v[164:167], v[36:39], v[204:207]
    v_exp_f32 v194, v194
    v_mfma_f32_16x16x32_bf16 v[212:215], v[164:167], v[44:47], v[212:215]
    v_exp_f32 v195, v195
    v_mfma_f32_16x16x32_bf16 v[208:211], v[172:175], v[36:39], v[208:211]
    s_waitcnt lgkmcnt(0)
    v_bfi_b32 v236, 31, v246, v236
    v_bfi_b32 v237, 31, v246, v237
    v_readfirstlane_b32 s96, v238
    v_exp_f32 v196, v196
    v_mfma_f32_16x16x32_bf16 v[216:219], v[172:175], v[44:47], v[216:219]
    v_exp_f32 v197, v197
    s_setprio 3
    v_smfmac_f32_16x16x64_bf16 v[136:139], v[184:187], v[220:227], v242
    v_exp_f32 v198, v198
    v_smfmac_f32_16x16x64_bf16 v[140:143], v[184:187], v[228:235], v242
    v_exp_f32 v199, v199
    v_exp_f32 v200, v200
    v_exp_f32 v201, v201
    v_exp_f32 v202, v202
    v_exp_f32 v203, v203
    v_pk_add_f32 v[188:189], v[188:189], 1.0 op_sel_hi:[1,0]
    v_pk_add_f32 v[190:191], v[190:191], 1.0 op_sel_hi:[1,0]
    v_pk_add_f32 v[192:193], v[192:193], 1.0 op_sel_hi:[1,0]
    v_pk_add_f32 v[194:195], v[194:195], 1.0 op_sel_hi:[1,0]
    v_pk_add_f32 v[196:197], v[196:197], 1.0 op_sel_hi:[1,0]
    v_pk_add_f32 v[198:199], v[198:199], 1.0 op_sel_hi:[1,0]
    v_pk_add_f32 v[200:201], v[200:201], 1.0 op_sel_hi:[1,0]
    v_pk_add_f32 v[202:203], v[202:203], 1.0 op_sel_hi:[1,0]
    s_setprio 1
    v_mfma_f32_16x16x32_bf16 v[220:223], v[176:179], v[72:75], 0
    ds_read_b64_tr_b16 v[184:185], v236
    ds_read_b64_tr_b16 v[186:187], v237
    ds_read_u16 v251, v249 offset:1152
    ds_read_u16 v252, v249 offset:1216
    v_rcp_f32 v188, v188
    v_mfma_f32_16x16x32_bf16 v[228:231], v[176:179], v[76:79], 0
    s_ashr_i32 s96, s96, 24
    s_mul_i32 s96, s96, s101
    v_rcp_f32 v189, v189
    v_mfma_f32_16x16x32_bf16 v[224:227], v[180:183], v[72:75], 0
    v_rcp_f32 v190, v190
    v_mfma_f32_16x16x32_bf16 v[232:235], v[180:183], v[76:79], 0
    v_rcp_f32 v191, v191
    v_mfma_f32_16x16x32_bf16 v[220:223], v[160:163], v[16:19], v[220:223]
    v_rcp_f32 v192, v192
    v_mfma_f32_16x16x32_bf16 v[228:231], v[160:163], v[24:27], v[228:231]
    v_rcp_f32 v193, v193
    v_mfma_f32_16x16x32_bf16 v[224:227], v[168:171], v[16:19], v[224:227]
    s_waitcnt lgkmcnt(0)
    v_bfi_b32 v251, 31, v245, v251
    v_bfi_b32 v252, 31, v245, v252
    v_max_u32 v251, v251, v245
    v_max_u32 v252, v252, v253
    ds_read_b128 v[236:239], v247 offset:128
    ds_read_b32 v240, v248 offset:128
    s_add_u32 s16, s16, 1
    v_rcp_f32 v194, v194
    v_mfma_f32_16x16x32_bf16 v[232:235], v[168:171], v[24:27], v[232:235]
    v_rcp_f32 v195, v195
    v_mfma_f32_16x16x32_bf16 v[220:223], v[164:167], v[20:23], v[220:223]
    v_rcp_f32 v196, v196
    v_mfma_f32_16x16x32_bf16 v[228:231], v[164:167], v[28:31], v[228:231]
    v_rcp_f32 v197, v197
    s_setprio 3
    v_mfma_f32_16x16x32_bf16 v[224:227], v[172:175], v[20:23], v[224:227]
    v_rcp_f32 v198, v198
    v_mfma_f32_16x16x32_bf16 v[232:235], v[172:175], v[28:31], v[232:235]
    v_rcp_f32 v199, v199
    v_rcp_f32 v200, v200
    v_rcp_f32 v201, v201
    v_rcp_f32 v202, v202
    v_rcp_f32 v203, v203
    v_pk_mul_f32 v[204:205], v[188:189], v[204:205]
    v_pk_mul_f32 v[206:207], v[190:191], v[206:207]
    v_pk_mul_f32 v[208:209], v[192:193], v[208:209]
    v_pk_mul_f32 v[210:211], v[194:195], v[210:211]
    v_pk_mul_f32 v[212:213], v[196:197], v[212:213]
    v_pk_mul_f32 v[214:215], v[198:199], v[214:215]
    v_pk_mul_f32 v[216:217], v[200:201], v[216:217]
    v_pk_mul_f32 v[218:219], v[202:203], v[218:219]
    s_cmp_ge_i32 s96, 1
    s_cbranch_scc0 L_PB00
L_PB01:
    s_setprio 1
    v_smfmac_f32_16x16x64_bf16 v[112:115], v[184:187], v[204:211], v242
    v_exp_f32 v220, v220
    v_smfmac_f32_16x16x64_bf16 v[116:119], v[184:187], v[212:219], v242
    v_exp_f32 v221, v221
    s_waitcnt vmcnt(0)
    ds_read_b128 v[176:179], v251
    ds_read_b128 v[180:183], v252
    v_mfma_f32_16x16x32_bf16 v[204:207], v[160:163], v[48:51], 0
    v_exp_f32 v222, v222
    v_mfma_f32_16x16x32_bf16 v[212:215], v[160:163], v[56:59], 0
    ds_read_b128 v[160:163], v244 offset:0
    v_exp_f32 v223, v223
    v_mfma_f32_16x16x32_bf16 v[208:211], v[168:171], v[48:51], 0
    v_exp_f32 v224, v224
    v_mfma_f32_16x16x32_bf16 v[216:219], v[168:171], v[56:59], 0
    ds_read_b128 v[168:171], v244 offset:512
    v_exp_f32 v225, v225
    v_mfma_f32_16x16x32_bf16 v[204:207], v[164:167], v[52:55], v[204:207]
    v_exp_f32 v226, v226
    v_mfma_f32_16x16x32_bf16 v[212:215], v[164:167], v[60:63], v[212:215]
    ds_read_b128 v[164:167], v244 offset:64
    v_exp_f32 v227, v227
    v_mfma_f32_16x16x32_bf16 v[208:211], v[172:175], v[52:55], v[208:211]
    v_exp_f32 v228, v228
    v_mfma_f32_16x16x32_bf16 v[216:219], v[172:175], v[60:63], v[216:219]
    ds_read_b128 v[172:175], v244 offset:576
    v_exp_f32 v229, v229
    s_setprio 3
    v_smfmac_f32_16x16x64_bf16 v[96:99], v[184:187], v[188:195], v242
    v_exp_f32 v230, v230
    v_smfmac_f32_16x16x64_bf16 v[100:103], v[184:187], v[196:203], v242
    v_exp_f32 v231, v231
    v_exp_f32 v232, v232
    v_exp_f32 v233, v233
    v_exp_f32 v234, v234
    v_exp_f32 v235, v235
    v_pk_add_f32 v[220:221], v[220:221], 1.0 op_sel_hi:[1,0]
    v_pk_add_f32 v[222:223], v[222:223], 1.0 op_sel_hi:[1,0]
    v_pk_add_f32 v[224:225], v[224:225], 1.0 op_sel_hi:[1,0]
    v_pk_add_f32 v[226:227], v[226:227], 1.0 op_sel_hi:[1,0]
    v_pk_add_f32 v[228:229], v[228:229], 1.0 op_sel_hi:[1,0]
    v_pk_add_f32 v[230:231], v[230:231], 1.0 op_sel_hi:[1,0]
    v_pk_add_f32 v[232:233], v[232:233], 1.0 op_sel_hi:[1,0]
    v_pk_add_f32 v[234:235], v[234:235], 1.0 op_sel_hi:[1,0]
    s_setprio 1
    s_waitcnt lgkmcnt(4)
    v_mfma_f32_16x16x32_bf16 v[188:191], v[176:179], v[80:83], 0
    v_rcp_f32 v220, v220
    v_mfma_f32_16x16x32_bf16 v[196:199], v[176:179], v[84:87], 0
    v_rcp_f32 v221, v221
    v_mfma_f32_16x16x32_bf16 v[192:195], v[180:183], v[80:83], 0
    v_rcp_f32 v222, v222
    v_mfma_f32_16x16x32_bf16 v[200:203], v[180:183], v[84:87], 0
    v_rcp_f32 v223, v223
    s_waitcnt lgkmcnt(3)
    v_mfma_f32_16x16x32_bf16 v[188:191], v[160:163], v[0:3], v[188:191]
    v_rcp_f32 v224, v224
    v_mfma_f32_16x16x32_bf16 v[196:199], v[160:163], v[8:11], v[196:199]
    v_rcp_f32 v225, v225
    s_waitcnt lgkmcnt(2)
    v_mfma_f32_16x16x32_bf16 v[192:195], v[168:171], v[0:3], v[192:195]
    v_rcp_f32 v226, v226
    v_mfma_f32_16x16x32_bf16 v[200:203], v[168:171], v[8:11], v[200:203]
    v_rcp_f32 v227, v227
    s_waitcnt lgkmcnt(1)
    v_mfma_f32_16x16x32_bf16 v[188:191], v[164:167], v[4:7], v[188:191]
    v_rcp_f32 v228, v228
    v_mfma_f32_16x16x32_bf16 v[196:199], v[164:167], v[12:15], v[196:199]
    v_rcp_f32 v229, v229
    s_setprio 3
    s_waitcnt lgkmcnt(0)
    v_mfma_f32_16x16x32_bf16 v[192:195], v[172:175], v[4:7], v[192:195]
    s_cmp_lt_u32 s16, s17
    s_cbranch_scc0 L_ND01
    s_add_u32 m0, s13, 0
    v_mad_u32_u16 v236, v236, s15, v243
    buffer_load_dwordx4 v236, s[40:43], 0 offen lds
    s_add_u32 m0, s13, 1056
    v_mad_u32_u16 v237, v237, s15, v243
    buffer_load_dwordx4 v237, s[40:43], 0 offen lds
    s_add_u32 m0, s13, 2112
    v_mad_u32_u16 v238, v238, s15, v243
    buffer_load_dwordx4 v238, s[40:43], 0 offen lds
    s_add_u32 m0, s13, 3168
    v_mad_u32_u16 v239, v239, s15, v243
    buffer_load_dwordx4 v239, s[40:43], 0 offen lds
    s_mov_b32 m0, s14
    v_and_b32 v240, 0xfffff, v240
    buffer_load_dwordx4 v[240:241], s[44:47], 0 idxen offen lds
L_ND01:
    v_rcp_f32 v230, v230
    v_mfma_f32_16x16x32_bf16 v[200:203], v[172:175], v[12:15], v[200:203]
    v_rcp_f32 v231, v231
    v_rcp_f32 v232, v232
    v_rcp_f32 v233, v233
    v_rcp_f32 v234, v234
    v_rcp_f32 v235, v235
    v_pk_mul_f32 v[204:205], v[220:221], v[204:205]
    v_pk_mul_f32 v[206:207], v[222:223], v[206:207]
    v_pk_mul_f32 v[208:209], v[224:225], v[208:209]
    v_pk_mul_f32 v[210:211], v[226:227], v[210:211]
    v_pk_mul_f32 v[212:213], v[228:229], v[212:213]
    v_pk_mul_f32 v[214:215], v[230:231], v[214:215]
    v_pk_mul_f32 v[216:217], v[232:233], v[216:217]
    v_pk_mul_f32 v[218:219], v[234:235], v[218:219]
    s_cmp_ge_u32 s16, s17
    s_cbranch_scc1 L_LT1
    s_setprio 1
    v_smfmac_f32_16x16x64_bf16 v[120:123], v[184:187], v[204:211], v242
    ds_read_u16 v236, v250 offset:1152
    ds_read_u16 v237, v250 offset:1168
    ds_add_rtn_u32 v238, v255, v242
    v_exp_f32 v188, v188
    v_smfmac_f32_16x16x64_bf16 v[124:127], v[184:187], v[212:219], v242
    v_exp_f32 v189, v189
    v_mfma_f32_16x16x32_bf16 v[204:207], v[160:163], v[32:35], 0
    v_exp_f32 v190, v190
    v_mfma_f32_16x16x32_bf16 v[212:215], v[160:163], v[40:43], 0
    v_exp_f32 v191, v191
    v_mfma_f32_16x16x32_bf16 v[208:211], v[168:171], v[32:35], 0
    v_exp_f32 v192, v192
    v_mfma_f32_16x16x32_bf16 v[216:219], v[168:171], v[40:43], 0
    v_exp_f32 v193, v193
    v_mfma_f32_16x16x32_bf16 v[204:207], v[164:167], v[36:39], v[204:207]
    v_exp_f32 v194, v194
    v_mfma_f32_16x16x32_bf16 v[212:215], v[164:167], v[44:47], v[212:215]
    v_exp_f32 v195, v195
    v_mfma_f32_16x16x32_bf16 v[208:211], v[172:175], v[36:39], v[208:211]
    s_waitcnt lgkmcnt(0)
    v_bfi_b32 v236, 31, v246, v236
    v_bfi_b32 v237, 31, v246, v237
    v_readfirstlane_b32 s96, v238
    v_exp_f32 v196, v196
    v_mfma_f32_16x16x32_bf16 v[216:219], v[172:175], v[44:47], v[216:219]
    v_exp_f32 v197, v197
    s_setprio 3
    v_smfmac_f32_16x16x64_bf16 v[104:107], v[184:187], v[220:227], v242
    v_exp_f32 v198, v198
    v_smfmac_f32_16x16x64_bf16 v[108:111], v[184:187], v[228:235], v242
    v_exp_f32 v199, v199
    v_exp_f32 v200, v200
    v_exp_f32 v201, v201
    v_exp_f32 v202, v202
    v_exp_f32 v203, v203
    v_pk_add_f32 v[188:189], v[188:189], 1.0 op_sel_hi:[1,0]
    v_pk_add_f32 v[190:191], v[190:191], 1.0 op_sel_hi:[1,0]
    v_pk_add_f32 v[192:193], v[192:193], 1.0 op_sel_hi:[1,0]
    v_pk_add_f32 v[194:195], v[194:195], 1.0 op_sel_hi:[1,0]
    v_pk_add_f32 v[196:197], v[196:197], 1.0 op_sel_hi:[1,0]
    v_pk_add_f32 v[198:199], v[198:199], 1.0 op_sel_hi:[1,0]
    v_pk_add_f32 v[200:201], v[200:201], 1.0 op_sel_hi:[1,0]
    v_pk_add_f32 v[202:203], v[202:203], 1.0 op_sel_hi:[1,0]
    s_setprio 1
    v_mfma_f32_16x16x32_bf16 v[220:223], v[176:179], v[88:91], 0
    ds_read_b64_tr_b16 v[184:185], v236
    ds_read_b64_tr_b16 v[186:187], v237
    ds_read_u16 v251, v249 offset:128
    ds_read_u16 v252, v249 offset:192
    v_rcp_f32 v188, v188
    v_mfma_f32_16x16x32_bf16 v[228:231], v[176:179], v[92:95], 0
    s_ashr_i32 s96, s96, 24
    s_mul_i32 s96, s96, s101
    v_rcp_f32 v189, v189
    v_mfma_f32_16x16x32_bf16 v[224:227], v[180:183], v[88:91], 0
    v_rcp_f32 v190, v190
    v_mfma_f32_16x16x32_bf16 v[232:235], v[180:183], v[92:95], 0
    v_rcp_f32 v191, v191
    v_mfma_f32_16x16x32_bf16 v[220:223], v[160:163], v[16:19], v[220:223]
    v_rcp_f32 v192, v192
    v_mfma_f32_16x16x32_bf16 v[228:231], v[160:163], v[24:27], v[228:231]
    v_rcp_f32 v193, v193
    v_mfma_f32_16x16x32_bf16 v[224:227], v[168:171], v[16:19], v[224:227]
    s_waitcnt lgkmcnt(0)
    v_bfi_b32 v251, 31, v245, v251
    v_bfi_b32 v252, 31, v245, v252
    v_max_u32 v251, v251, v245
    v_max_u32 v252, v252, v253
    ds_read_b128 v[236:239], v247 offset:1280
    ds_read_b32 v240, v248 offset:1280
    s_add_u32 s16, s16, 1
    v_rcp_f32 v194, v194
    v_mfma_f32_16x16x32_bf16 v[232:235], v[168:171], v[24:27], v[232:235]
    v_add_u32 v247, 0x80, v247
    v_add_u32 v248, 0x80, v248
    v_add_u32 v249, 0x80, v249
    v_add_u32 v250, 0x80, v250
    v_rcp_f32 v195, v195
    v_mfma_f32_16x16x32_bf16 v[220:223], v[164:167], v[20:23], v[220:223]
    v_rcp_f32 v196, v196
    v_mfma_f32_16x16x32_bf16 v[228:231], v[164:167], v[28:31], v[228:231]
    v_rcp_f32 v197, v197
    s_setprio 3
    v_mfma_f32_16x16x32_bf16 v[224:227], v[172:175], v[20:23], v[224:227]
    v_rcp_f32 v198, v198
    v_mfma_f32_16x16x32_bf16 v[232:235], v[172:175], v[28:31], v[232:235]
    v_rcp_f32 v199, v199
    v_rcp_f32 v200, v200
    v_rcp_f32 v201, v201
    v_rcp_f32 v202, v202
    v_rcp_f32 v203, v203
    v_pk_mul_f32 v[204:205], v[188:189], v[204:205]
    v_pk_mul_f32 v[206:207], v[190:191], v[206:207]
    v_pk_mul_f32 v[208:209], v[192:193], v[208:209]
    v_pk_mul_f32 v[210:211], v[194:195], v[210:211]
    v_pk_mul_f32 v[212:213], v[196:197], v[212:213]
    v_pk_mul_f32 v[214:215], v[198:199], v[214:215]
    v_pk_mul_f32 v[216:217], v[200:201], v[216:217]
    v_pk_mul_f32 v[218:219], v[202:203], v[218:219]
    s_cmp_ge_i32 s96, 1
    s_cbranch_scc0 L_PB10
L_PB11:
    s_setprio 1
    v_smfmac_f32_16x16x64_bf16 v[144:147], v[184:187], v[204:211], v242
    v_exp_f32 v220, v220
    v_smfmac_f32_16x16x64_bf16 v[148:151], v[184:187], v[212:219], v242
    v_exp_f32 v221, v221
    s_waitcnt vmcnt(0)
    ds_read_b128 v[176:179], v251
    ds_read_b128 v[180:183], v252
    v_mfma_f32_16x16x32_bf16 v[204:207], v[160:163], v[48:51], 0
    v_exp_f32 v222, v222
    v_mfma_f32_16x16x32_bf16 v[212:215], v[160:163], v[56:59], 0
    ds_read_b128 v[160:163], v244 offset:0
    v_exp_f32 v223, v223
    v_mfma_f32_16x16x32_bf16 v[208:211], v[168:171], v[48:51], 0
    v_exp_f32 v224, v224
    v_mfma_f32_16x16x32_bf16 v[216:219], v[168:171], v[56:59], 0
    ds_read_b128 v[168:171], v244 offset:512
    v_exp_f32 v225, v225
    v_mfma_f32_16x16x32_bf16 v[204:207], v[164:167], v[52:55], v[204:207]
    v_exp_f32 v226, v226
    v_mfma_f32_16x16x32_bf16 v[212:215], v[164:167], v[60:63], v[212:215]
    ds_read_b128 v[164:167], v244 offset:64
    v_exp_f32 v227, v227
    v_mfma_f32_16x16x32_bf16 v[208:211], v[172:175], v[52:55], v[208:211]
    v_exp_f32 v228, v228
    v_mfma_f32_16x16x32_bf16 v[216:219], v[172:175], v[60:63], v[216:219]
    ds_read_b128 v[172:175], v244 offset:576
    v_exp_f32 v229, v229
    s_setprio 3
    v_smfmac_f32_16x16x64_bf16 v[128:131], v[184:187], v[188:195], v242
    v_exp_f32 v230, v230
    v_smfmac_f32_16x16x64_bf16 v[132:135], v[184:187], v[196:203], v242
    v_exp_f32 v231, v231
    v_exp_f32 v232, v232
    v_exp_f32 v233, v233
    v_exp_f32 v234, v234
    v_exp_f32 v235, v235
    v_pk_add_f32 v[220:221], v[220:221], 1.0 op_sel_hi:[1,0]
    v_pk_add_f32 v[222:223], v[222:223], 1.0 op_sel_hi:[1,0]
    v_pk_add_f32 v[224:225], v[224:225], 1.0 op_sel_hi:[1,0]
    v_pk_add_f32 v[226:227], v[226:227], 1.0 op_sel_hi:[1,0]
    v_pk_add_f32 v[228:229], v[228:229], 1.0 op_sel_hi:[1,0]
    v_pk_add_f32 v[230:231], v[230:231], 1.0 op_sel_hi:[1,0]
    v_pk_add_f32 v[232:233], v[232:233], 1.0 op_sel_hi:[1,0]
    v_pk_add_f32 v[234:235], v[234:235], 1.0 op_sel_hi:[1,0]
    s_setprio 1
    s_waitcnt lgkmcnt(4)
    v_mfma_f32_16x16x32_bf16 v[188:191], v[176:179], v[64:67], 0
    v_rcp_f32 v220, v220
    v_mfma_f32_16x16x32_bf16 v[196:199], v[176:179], v[68:71], 0
    v_rcp_f32 v221, v221
    v_mfma_f32_16x16x32_bf16 v[192:195], v[180:183], v[64:67], 0
    v_rcp_f32 v222, v222
    v_mfma_f32_16x16x32_bf16 v[200:203], v[180:183], v[68:71], 0
    v_rcp_f32 v223, v223
    s_waitcnt lgkmcnt(3)
    v_mfma_f32_16x16x32_bf16 v[188:191], v[160:163], v[0:3], v[188:191]
    v_rcp_f32 v224, v224
    v_mfma_f32_16x16x32_bf16 v[196:199], v[160:163], v[8:11], v[196:199]
    v_rcp_f32 v225, v225
    s_waitcnt lgkmcnt(2)
    v_mfma_f32_16x16x32_bf16 v[192:195], v[168:171], v[0:3], v[192:195]
    v_rcp_f32 v226, v226
    v_mfma_f32_16x16x32_bf16 v[200:203], v[168:171], v[8:11], v[200:203]
    v_rcp_f32 v227, v227
    s_waitcnt lgkmcnt(1)
    v_mfma_f32_16x16x32_bf16 v[188:191], v[164:167], v[4:7], v[188:191]
    v_rcp_f32 v228, v228
    v_mfma_f32_16x16x32_bf16 v[196:199], v[164:167], v[12:15], v[196:199]
    v_rcp_f32 v229, v229
    s_setprio 3
    s_waitcnt lgkmcnt(0)
    v_mfma_f32_16x16x32_bf16 v[192:195], v[172:175], v[4:7], v[192:195]
    s_cmp_lt_u32 s16, s17
    s_cbranch_scc0 L_ND11
    s_add_u32 m0, s13, 0
    v_mad_u32_u16 v236, v236, s15, v243
    buffer_load_dwordx4 v236, s[40:43], 0 offen lds
    s_add_u32 m0, s13, 1056
    v_mad_u32_u16 v237, v237, s15, v243
    buffer_load_dwordx4 v237, s[40:43], 0 offen lds
    s_add_u32 m0, s13, 2112
    v_mad_u32_u16 v238, v238, s15, v243
    buffer_load_dwordx4 v238, s[40:43], 0 offen lds
    s_add_u32 m0, s13, 3168
    v_mad_u32_u16 v239, v239, s15, v243
    buffer_load_dwordx4 v239, s[40:43], 0 offen lds
    s_mov_b32 m0, s14
    v_and_b32 v240, 0xfffff, v240
    buffer_load_dwordx4 v[240:241], s[44:47], 0 idxen offen lds
L_ND11:
    v_rcp_f32 v230, v230
    v_mfma_f32_16x16x32_bf16 v[200:203], v[172:175], v[12:15], v[200:203]
    v_rcp_f32 v231, v231
    v_rcp_f32 v232, v232
    v_rcp_f32 v233, v233
    v_rcp_f32 v234, v234
    v_rcp_f32 v235, v235
    v_pk_mul_f32 v[204:205], v[220:221], v[204:205]
    v_pk_mul_f32 v[206:207], v[222:223], v[206:207]
    v_pk_mul_f32 v[208:209], v[224:225], v[208:209]
    v_pk_mul_f32 v[210:211], v[226:227], v[210:211]
    v_pk_mul_f32 v[212:213], v[228:229], v[212:213]
    v_pk_mul_f32 v[214:215], v[230:231], v[214:215]
    v_pk_mul_f32 v[216:217], v[232:233], v[216:217]
    v_pk_mul_f32 v[218:219], v[234:235], v[218:219]
    s_cmp_lt_u32 s16, s17
    s_cbranch_scc1 L_LOOP1
    s_branch L_LT0
.p2align 6
L_LOOP0:
    s_setprio 0
    v_smfmac_f32_16x16x64_bf16 v[152:155], v[184:187], v[204:211], v242
    ds_read_u16 v236, v250 offset:0
    ds_read_u16 v237, v250 offset:16
    ds_add_rtn_u32 v238, v255, v242
    v_exp_f32 v188, v188
    v_smfmac_f32_16x16x64_bf16 v[156:159], v[184:187], v[212:219], v242
    v_exp_f32 v189, v189
    v_mfma_f32_16x16x32_bf16 v[204:207], v[160:163], v[32:35], 0
    v_exp_f32 v190, v190
    v_mfma_f32_16x16x32_bf16 v[212:215], v[160:163], v[40:43], 0
    v_exp_f32 v191, v191
    v_mfma_f32_16x16x32_bf16 v[208:211], v[168:171], v[32:35], 0
    v_exp_f32 v192, v192
    v_mfma_f32_16x16x32_bf16 v[216:219], v[168:171], v[40:43], 0
    v_exp_f32 v193, v193
    v_mfma_f32_16x16x32_bf16 v[204:207], v[164:167], v[36:39], v[204:207]
    v_exp_f32 v194, v194
    v_mfma_f32_16x16x32_bf16 v[212:215], v[164:167], v[44:47], v[212:215]
    v_exp_f32 v195, v195
    v_mfma_f32_16x16x32_bf16 v[208:211], v[172:175], v[36:39], v[208:211]
    s_waitcnt lgkmcnt(0)
    v_bfi_b32 v236, 31, v246, v236
    v_bfi_b32 v237, 31, v246, v237
    v_readfirstlane_b32 s96, v238
    v_exp_f32 v196, v196
    v_mfma_f32_16x16x32_bf16 v[216:219], v[172:175], v[44:47], v[216:219]
    v_exp_f32 v197, v197
    s_setprio 3
    v_smfmac_f32_16x16x64_bf16 v[136:139], v[184:187], v[220:227], v242
    v_exp_f32 v198, v198
    v_smfmac_f32_16x16x64_bf16 v[140:143], v[184:187], v[228:235], v242
    v_exp_f32 v199, v199
    v_exp_f32 v200, v200
    v_exp_f32 v201, v201
    v_exp_f32 v202, v202
    v_exp_f32 v203, v203
    v_pk_add_f32 v[188:189], v[188:189], 1.0 op_sel_hi:[1,0]
    v_pk_add_f32 v[190:191], v[190:191], 1.0 op_sel_hi:[1,0]
    v_pk_add_f32 v[192:193], v[192:193], 1.0 op_sel_hi:[1,0]
    v_pk_add_f32 v[194:195], v[194:195], 1.0 op_sel_hi:[1,0]
    v_pk_add_f32 v[196:197], v[196:197], 1.0 op_sel_hi:[1,0]
    v_pk_add_f32 v[198:199], v[198:199], 1.0 op_sel_hi:[1,0]
    v_pk_add_f32 v[200:201], v[200:201], 1.0 op_sel_hi:[1,0]
    v_pk_add_f32 v[202:203], v[202:203], 1.0 op_sel_hi:[1,0]
    s_setprio 0
    v_mfma_f32_16x16x32_bf16 v[220:223], v[176:179], v[72:75], 0
    ds_read_b64_tr_b16 v[184:185], v236
    ds_read_b64_tr_b16 v[186:187], v237
    ds_read_u16 v251, v249 offset:1152
    ds_read_u16 v252, v249 offset:1216
    v_rcp_f32 v188, v188
    v_mfma_f32_16x16x32_bf16 v[228:231], v[176:179], v[76:79], 0
    s_ashr_i32 s96, s96, 24
    s_mul_i32 s96, s96, s101
    v_rcp_f32 v189, v189
    v_mfma_f32_16x16x32_bf16 v[224:227], v[180:183], v[72:75], 0
    v_rcp_f32 v190, v190
    v_mfma_f32_16x16x32_bf16 v[232:235], v[180:183], v[76:79], 0
    v_rcp_f32 v191, v191
    v_mfma_f32_16x16x32_bf16 v[220:223], v[160:163], v[16:19], v[220:223]
    v_rcp_f32 v192, v192
    v_mfma_f32_16x16x32_bf16 v[228:231], v[160:163], v[24:27], v[228:231]
    v_rcp_f32 v193, v193
    v_mfma_f32_16x16x32_bf16 v[224:227], v[168:171], v[16:19], v[224:227]
    s_waitcnt lgkmcnt(0)
    v_bfi_b32 v251, 31, v245, v251
    v_bfi_b32 v252, 31, v245, v252
    v_max_u32 v251, v251, v245
    v_max_u32 v252, v252, v253
    ds_read_b128 v[236:239], v247 offset:128
    ds_read_b32 v240, v248 offset:128
    s_add_u32 s16, s16, 1
    v_rcp_f32 v194, v194
    v_mfma_f32_16x16x32_bf16 v[232:235], v[168:171], v[24:27], v[232:235]
    v_rcp_f32 v195, v195
    v_mfma_f32_16x16x32_bf16 v[220:223], v[164:167], v[20:23], v[220:223]
    v_rcp_f32 v196, v196
    v_mfma_f32_16x16x32_bf16 v[228:231], v[164:167], v[28:31], v[228:231]
    v_rcp_f32 v197, v197
    s_setprio 3
    v_mfma_f32_16x16x32_bf16 v[224:227], v[172:175], v[20:23], v[224:227]
    v_rcp_f32 v198, v198
    v_mfma_f32_16x16x32_bf16 v[232:235], v[172:175], v[28:31], v[232:235]
    v_rcp_f32 v199, v199
    v_rcp_f32 v200, v200
    v_rcp_f32 v201, v201
    v_rcp_f32 v202, v202
    v_rcp_f32 v203, v203
    v_pk_mul_f32 v[204:205], v[188:189], v[204:205]
    v_pk_mul_f32 v[206:207], v[190:191], v[206:207]
    v_pk_mul_f32 v[208:209], v[192:193], v[208:209]
    v_pk_mul_f32 v[210:211], v[194:195], v[210:211]
    v_pk_mul_f32 v[212:213], v[196:197], v[212:213]
    v_pk_mul_f32 v[214:215], v[198:199], v[214:215]
    v_pk_mul_f32 v[216:217], v[200:201], v[216:217]
    v_pk_mul_f32 v[218:219], v[202:203], v[218:219]
    s_cmp_ge_i32 s96, 1
    s_cbranch_scc1 L_PB01
L_PB00:
    s_setprio 0
    v_smfmac_f32_16x16x64_bf16 v[112:115], v[184:187], v[204:211], v242
    v_exp_f32 v220, v220
    v_smfmac_f32_16x16x64_bf16 v[116:119], v[184:187], v[212:219], v242
    v_exp_f32 v221, v221
    s_waitcnt vmcnt(0)
    ds_read_b128 v[176:179], v251
    ds_read_b128 v[180:183], v252
    v_mfma_f32_16x16x32_bf16 v[204:207], v[160:163], v[48:51], 0
    v_exp_f32 v222, v222
    v_mfma_f32_16x16x32_bf16 v[212:215], v[160:163], v[56:59], 0
    ds_read_b128 v[160:163], v244 offset:0
    v_exp_f32 v223, v223
    v_mfma_f32_16x16x32_bf16 v[208:211], v[168:171], v[48:51], 0
    v_exp_f32 v224, v224
    v_mfma_f32_16x16x32_bf16 v[216:219], v[168:171], v[56:59], 0
    ds_read_b128 v[168:171], v244 offset:512
    v_exp_f32 v225, v225
    v_mfma_f32_16x16x32_bf16 v[204:207], v[164:167], v[52:55], v[204:207]
    v_exp_f32 v226, v226
    v_mfma_f32_16x16x32_bf16 v[212:215], v[164:167], v[60:63], v[212:215]
    ds_read_b128 v[164:167], v244 offset:64
    v_exp_f32 v227, v227
    v_mfma_f32_16x16x32_bf16 v[208:211], v[172:175], v[52:55], v[208:211]
    v_exp_f32 v228, v228
    v_mfma_f32_16x16x32_bf16 v[216:219], v[172:175], v[60:63], v[216:219]
    ds_read_b128 v[172:175], v244 offset:576
    v_exp_f32 v229, v229
    s_setprio 3
    v_smfmac_f32_16x16x64_bf16 v[96:99], v[184:187], v[188:195], v242
    v_exp_f32 v230, v230
    v_smfmac_f32_16x16x64_bf16 v[100:103], v[184:187], v[196:203], v242
    v_exp_f32 v231, v231
    v_exp_f32 v232, v232
    v_exp_f32 v233, v233
    v_exp_f32 v234, v234
    v_exp_f32 v235, v235
    v_pk_add_f32 v[220:221], v[220:221], 1.0 op_sel_hi:[1,0]
    v_pk_add_f32 v[222:223], v[222:223], 1.0 op_sel_hi:[1,0]
    v_pk_add_f32 v[224:225], v[224:225], 1.0 op_sel_hi:[1,0]
    v_pk_add_f32 v[226:227], v[226:227], 1.0 op_sel_hi:[1,0]
    v_pk_add_f32 v[228:229], v[228:229], 1.0 op_sel_hi:[1,0]
    v_pk_add_f32 v[230:231], v[230:231], 1.0 op_sel_hi:[1,0]
    v_pk_add_f32 v[232:233], v[232:233], 1.0 op_sel_hi:[1,0]
    v_pk_add_f32 v[234:235], v[234:235], 1.0 op_sel_hi:[1,0]
    s_setprio 0
    s_waitcnt lgkmcnt(4)
    v_mfma_f32_16x16x32_bf16 v[188:191], v[176:179], v[80:83], 0
    v_rcp_f32 v220, v220
    v_mfma_f32_16x16x32_bf16 v[196:199], v[176:179], v[84:87], 0
    v_rcp_f32 v221, v221
    v_mfma_f32_16x16x32_bf16 v[192:195], v[180:183], v[80:83], 0
    v_rcp_f32 v222, v222
    v_mfma_f32_16x16x32_bf16 v[200:203], v[180:183], v[84:87], 0
    v_rcp_f32 v223, v223
    s_waitcnt lgkmcnt(3)
    v_mfma_f32_16x16x32_bf16 v[188:191], v[160:163], v[0:3], v[188:191]
    v_rcp_f32 v224, v224
    v_mfma_f32_16x16x32_bf16 v[196:199], v[160:163], v[8:11], v[196:199]
    v_rcp_f32 v225, v225
    s_waitcnt lgkmcnt(2)
    v_mfma_f32_16x16x32_bf16 v[192:195], v[168:171], v[0:3], v[192:195]
    v_rcp_f32 v226, v226
    v_mfma_f32_16x16x32_bf16 v[200:203], v[168:171], v[8:11], v[200:203]
    v_rcp_f32 v227, v227
    s_waitcnt lgkmcnt(1)
    v_mfma_f32_16x16x32_bf16 v[188:191], v[164:167], v[4:7], v[188:191]
    v_rcp_f32 v228, v228
    v_mfma_f32_16x16x32_bf16 v[196:199], v[164:167], v[12:15], v[196:199]
    v_rcp_f32 v229, v229
    s_setprio 3
    s_waitcnt lgkmcnt(0)
    v_mfma_f32_16x16x32_bf16 v[192:195], v[172:175], v[4:7], v[192:195]
    s_cmp_lt_u32 s16, s17
    s_cbranch_scc0 L_ND00
    s_add_u32 m0, s13, 0
    v_mad_u32_u16 v236, v236, s15, v243
    buffer_load_dwordx4 v236, s[40:43], 0 offen lds
    s_add_u32 m0, s13, 1056
    v_mad_u32_u16 v237, v237, s15, v243
    buffer_load_dwordx4 v237, s[40:43], 0 offen lds
    s_add_u32 m0, s13, 2112
    v_mad_u32_u16 v238, v238, s15, v243
    buffer_load_dwordx4 v238, s[40:43], 0 offen lds
    s_add_u32 m0, s13, 3168
    v_mad_u32_u16 v239, v239, s15, v243
    buffer_load_dwordx4 v239, s[40:43], 0 offen lds
    s_mov_b32 m0, s14
    v_and_b32 v240, 0xfffff, v240
    buffer_load_dwordx4 v[240:241], s[44:47], 0 idxen offen lds
L_ND00:
    v_rcp_f32 v230, v230
    v_mfma_f32_16x16x32_bf16 v[200:203], v[172:175], v[12:15], v[200:203]
    v_rcp_f32 v231, v231
    v_rcp_f32 v232, v232
    v_rcp_f32 v233, v233
    v_rcp_f32 v234, v234
    v_rcp_f32 v235, v235
    v_pk_mul_f32 v[204:205], v[220:221], v[204:205]
    v_pk_mul_f32 v[206:207], v[222:223], v[206:207]
    v_pk_mul_f32 v[208:209], v[224:225], v[208:209]
    v_pk_mul_f32 v[210:211], v[226:227], v[210:211]
    v_pk_mul_f32 v[212:213], v[228:229], v[212:213]
    v_pk_mul_f32 v[214:215], v[230:231], v[214:215]
    v_pk_mul_f32 v[216:217], v[232:233], v[216:217]
    v_pk_mul_f32 v[218:219], v[234:235], v[218:219]
    s_cmp_ge_u32 s16, s17
    s_cbranch_scc1 L_LT1
    s_setprio 0
    v_smfmac_f32_16x16x64_bf16 v[120:123], v[184:187], v[204:211], v242
    ds_read_u16 v236, v250 offset:1152
    ds_read_u16 v237, v250 offset:1168
    ds_add_rtn_u32 v238, v255, v242
    v_exp_f32 v188, v188
    v_smfmac_f32_16x16x64_bf16 v[124:127], v[184:187], v[212:219], v242
    v_exp_f32 v189, v189
    v_mfma_f32_16x16x32_bf16 v[204:207], v[160:163], v[32:35], 0
    v_exp_f32 v190, v190
    v_mfma_f32_16x16x32_bf16 v[212:215], v[160:163], v[40:43], 0
    v_exp_f32 v191, v191
    v_mfma_f32_16x16x32_bf16 v[208:211], v[168:171], v[32:35], 0
    v_exp_f32 v192, v192
    v_mfma_f32_16x16x32_bf16 v[216:219], v[168:171], v[40:43], 0
    v_exp_f32 v193, v193
    v_mfma_f32_16x16x32_bf16 v[204:207], v[164:167], v[36:39], v[204:207]
    v_exp_f32 v194, v194
    v_mfma_f32_16x16x32_bf16 v[212:215], v[164:167], v[44:47], v[212:215]
    v_exp_f32 v195, v195
    v_mfma_f32_16x16x32_bf16 v[208:211], v[172:175], v[36:39], v[208:211]
    s_waitcnt lgkmcnt(0)
    v_bfi_b32 v236, 31, v246, v236
    v_bfi_b32 v237, 31, v246, v237
    v_readfirstlane_b32 s96, v238
    v_exp_f32 v196, v196
    v_mfma_f32_16x16x32_bf16 v[216:219], v[172:175], v[44:47], v[216:219]
    v_exp_f32 v197, v197
    s_setprio 3
    v_smfmac_f32_16x16x64_bf16 v[104:107], v[184:187], v[220:227], v242
    v_exp_f32 v198, v198
    v_smfmac_f32_16x16x64_bf16 v[108:111], v[184:187], v[228:235], v242
    v_exp_f32 v199, v199
    v_exp_f32 v200, v200
    v_exp_f32 v201, v201
    v_exp_f32 v202, v202
    v_exp_f32 v203, v203
    v_pk_add_f32 v[188:189], v[188:189], 1.0 op_sel_hi:[1,0]
    v_pk_add_f32 v[190:191], v[190:191], 1.0 op_sel_hi:[1,0]
    v_pk_add_f32 v[192:193], v[192:193], 1.0 op_sel_hi:[1,0]
    v_pk_add_f32 v[194:195], v[194:195], 1.0 op_sel_hi:[1,0]
    v_pk_add_f32 v[196:197], v[196:197], 1.0 op_sel_hi:[1,0]
    v_pk_add_f32 v[198:199], v[198:199], 1.0 op_sel_hi:[1,0]
    v_pk_add_f32 v[200:201], v[200:201], 1.0 op_sel_hi:[1,0]
    v_pk_add_f32 v[202:203], v[202:203], 1.0 op_sel_hi:[1,0]
    s_setprio 0
    v_mfma_f32_16x16x32_bf16 v[220:223], v[176:179], v[88:91], 0
    ds_read_b64_tr_b16 v[184:185], v236
    ds_read_b64_tr_b16 v[186:187], v237
    ds_read_u16 v251, v249 offset:128
    ds_read_u16 v252, v249 offset:192
    v_rcp_f32 v188, v188
    v_mfma_f32_16x16x32_bf16 v[228:231], v[176:179], v[92:95], 0
    s_ashr_i32 s96, s96, 24
    s_mul_i32 s96, s96, s101
    v_rcp_f32 v189, v189
    v_mfma_f32_16x16x32_bf16 v[224:227], v[180:183], v[88:91], 0
    v_rcp_f32 v190, v190
    v_mfma_f32_16x16x32_bf16 v[232:235], v[180:183], v[92:95], 0
    v_rcp_f32 v191, v191
    v_mfma_f32_16x16x32_bf16 v[220:223], v[160:163], v[16:19], v[220:223]
    v_rcp_f32 v192, v192
    v_mfma_f32_16x16x32_bf16 v[228:231], v[160:163], v[24:27], v[228:231]
    v_rcp_f32 v193, v193
    v_mfma_f32_16x16x32_bf16 v[224:227], v[168:171], v[16:19], v[224:227]
    s_waitcnt lgkmcnt(0)
    v_bfi_b32 v251, 31, v245, v251
    v_bfi_b32 v252, 31, v245, v252
    v_max_u32 v251, v251, v245
    v_max_u32 v252, v252, v253
    ds_read_b128 v[236:239], v247 offset:1280
    ds_read_b32 v240, v248 offset:1280
    s_add_u32 s16, s16, 1
    v_rcp_f32 v194, v194
    v_mfma_f32_16x16x32_bf16 v[232:235], v[168:171], v[24:27], v[232:235]
    v_add_u32 v247, 0x80, v247
    v_add_u32 v248, 0x80, v248
    v_add_u32 v249, 0x80, v249
    v_add_u32 v250, 0x80, v250
    v_rcp_f32 v195, v195
    v_mfma_f32_16x16x32_bf16 v[220:223], v[164:167], v[20:23], v[220:223]
    v_rcp_f32 v196, v196
    v_mfma_f32_16x16x32_bf16 v[228:231], v[164:167], v[28:31], v[228:231]
    v_rcp_f32 v197, v197
    s_setprio 3
    v_mfma_f32_16x16x32_bf16 v[224:227], v[172:175], v[20:23], v[224:227]
    v_rcp_f32 v198, v198
    v_mfma_f32_16x16x32_bf16 v[232:235], v[172:175], v[28:31], v[232:235]
    v_rcp_f32 v199, v199
    v_rcp_f32 v200, v200
    v_rcp_f32 v201, v201
    v_rcp_f32 v202, v202
    v_rcp_f32 v203, v203
    v_pk_mul_f32 v[204:205], v[188:189], v[204:205]
    v_pk_mul_f32 v[206:207], v[190:191], v[206:207]
    v_pk_mul_f32 v[208:209], v[192:193], v[208:209]
    v_pk_mul_f32 v[210:211], v[194:195], v[210:211]
    v_pk_mul_f32 v[212:213], v[196:197], v[212:213]
    v_pk_mul_f32 v[214:215], v[198:199], v[214:215]
    v_pk_mul_f32 v[216:217], v[200:201], v[216:217]
    v_pk_mul_f32 v[218:219], v[202:203], v[218:219]
    s_cmp_ge_i32 s96, 1
    s_cbranch_scc1 L_PB11
L_PB10:
    s_setprio 0
    v_smfmac_f32_16x16x64_bf16 v[144:147], v[184:187], v[204:211], v242
    v_exp_f32 v220, v220
    v_smfmac_f32_16x16x64_bf16 v[148:151], v[184:187], v[212:219], v242
    v_exp_f32 v221, v221
    s_waitcnt vmcnt(0)
    ds_read_b128 v[176:179], v251
    ds_read_b128 v[180:183], v252
    v_mfma_f32_16x16x32_bf16 v[204:207], v[160:163], v[48:51], 0
    v_exp_f32 v222, v222
    v_mfma_f32_16x16x32_bf16 v[212:215], v[160:163], v[56:59], 0
    ds_read_b128 v[160:163], v244 offset:0
    v_exp_f32 v223, v223
    v_mfma_f32_16x16x32_bf16 v[208:211], v[168:171], v[48:51], 0
    v_exp_f32 v224, v224
    v_mfma_f32_16x16x32_bf16 v[216:219], v[168:171], v[56:59], 0
    ds_read_b128 v[168:171], v244 offset:512
    v_exp_f32 v225, v225
    v_mfma_f32_16x16x32_bf16 v[204:207], v[164:167], v[52:55], v[204:207]
    v_exp_f32 v226, v226
    v_mfma_f32_16x16x32_bf16 v[212:215], v[164:167], v[60:63], v[212:215]
    ds_read_b128 v[164:167], v244 offset:64
    v_exp_f32 v227, v227
    v_mfma_f32_16x16x32_bf16 v[208:211], v[172:175], v[52:55], v[208:211]
    v_exp_f32 v228, v228
    v_mfma_f32_16x16x32_bf16 v[216:219], v[172:175], v[60:63], v[216:219]
    ds_read_b128 v[172:175], v244 offset:576
    v_exp_f32 v229, v229
    s_setprio 3
    v_smfmac_f32_16x16x64_bf16 v[128:131], v[184:187], v[188:195], v242
    v_exp_f32 v230, v230
    v_smfmac_f32_16x16x64_bf16 v[132:135], v[184:187], v[196:203], v242
    v_exp_f32 v231, v231
    v_exp_f32 v232, v232
    v_exp_f32 v233, v233
    v_exp_f32 v234, v234
    v_exp_f32 v235, v235
    v_pk_add_f32 v[220:221], v[220:221], 1.0 op_sel_hi:[1,0]
    v_pk_add_f32 v[222:223], v[222:223], 1.0 op_sel_hi:[1,0]
    v_pk_add_f32 v[224:225], v[224:225], 1.0 op_sel_hi:[1,0]
    v_pk_add_f32 v[226:227], v[226:227], 1.0 op_sel_hi:[1,0]
    v_pk_add_f32 v[228:229], v[228:229], 1.0 op_sel_hi:[1,0]
    v_pk_add_f32 v[230:231], v[230:231], 1.0 op_sel_hi:[1,0]
    v_pk_add_f32 v[232:233], v[232:233], 1.0 op_sel_hi:[1,0]
    v_pk_add_f32 v[234:235], v[234:235], 1.0 op_sel_hi:[1,0]
    s_setprio 0
    s_waitcnt lgkmcnt(4)
    v_mfma_f32_16x16x32_bf16 v[188:191], v[176:179], v[64:67], 0
    v_rcp_f32 v220, v220
    v_mfma_f32_16x16x32_bf16 v[196:199], v[176:179], v[68:71], 0
    v_rcp_f32 v221, v221
    v_mfma_f32_16x16x32_bf16 v[192:195], v[180:183], v[64:67], 0
    v_rcp_f32 v222, v222
    v_mfma_f32_16x16x32_bf16 v[200:203], v[180:183], v[68:71], 0
    v_rcp_f32 v223, v223
    s_waitcnt lgkmcnt(3)
    v_mfma_f32_16x16x32_bf16 v[188:191], v[160:163], v[0:3], v[188:191]
    v_rcp_f32 v224, v224
    v_mfma_f32_16x16x32_bf16 v[196:199], v[160:163], v[8:11], v[196:199]
    v_rcp_f32 v225, v225
    s_waitcnt lgkmcnt(2)
    v_mfma_f32_16x16x32_bf16 v[192:195], v[168:171], v[0:3], v[192:195]
    v_rcp_f32 v226, v226
    v_mfma_f32_16x16x32_bf16 v[200:203], v[168:171], v[8:11], v[200:203]
    v_rcp_f32 v227, v227
    s_waitcnt lgkmcnt(1)
    v_mfma_f32_16x16x32_bf16 v[188:191], v[164:167], v[4:7], v[188:191]
    v_rcp_f32 v228, v228
    v_mfma_f32_16x16x32_bf16 v[196:199], v[164:167], v[12:15], v[196:199]
    v_rcp_f32 v229, v229
    s_setprio 3
    s_waitcnt lgkmcnt(0)
    v_mfma_f32_16x16x32_bf16 v[192:195], v[172:175], v[4:7], v[192:195]
    s_cmp_lt_u32 s16, s17
    s_cbranch_scc0 L_ND10
    s_add_u32 m0, s13, 0
    v_mad_u32_u16 v236, v236, s15, v243
    buffer_load_dwordx4 v236, s[40:43], 0 offen lds
    s_add_u32 m0, s13, 1056
    v_mad_u32_u16 v237, v237, s15, v243
    buffer_load_dwordx4 v237, s[40:43], 0 offen lds
    s_add_u32 m0, s13, 2112
    v_mad_u32_u16 v238, v238, s15, v243
    buffer_load_dwordx4 v238, s[40:43], 0 offen lds
    s_add_u32 m0, s13, 3168
    v_mad_u32_u16 v239, v239, s15, v243
    buffer_load_dwordx4 v239, s[40:43], 0 offen lds
    s_mov_b32 m0, s14
    v_and_b32 v240, 0xfffff, v240
    buffer_load_dwordx4 v[240:241], s[44:47], 0 idxen offen lds
L_ND10:
    v_rcp_f32 v230, v230
    v_mfma_f32_16x16x32_bf16 v[200:203], v[172:175], v[12:15], v[200:203]
    v_rcp_f32 v231, v231
    v_rcp_f32 v232, v232
    v_rcp_f32 v233, v233
    v_rcp_f32 v234, v234
    v_rcp_f32 v235, v235
    v_pk_mul_f32 v[204:205], v[220:221], v[204:205]
    v_pk_mul_f32 v[206:207], v[222:223], v[206:207]
    v_pk_mul_f32 v[208:209], v[224:225], v[208:209]
    v_pk_mul_f32 v[210:211], v[226:227], v[210:211]
    v_pk_mul_f32 v[212:213], v[228:229], v[212:213]
    v_pk_mul_f32 v[214:215], v[230:231], v[214:215]
    v_pk_mul_f32 v[216:217], v[232:233], v[216:217]
    v_pk_mul_f32 v[218:219], v[234:235], v[218:219]
    s_cmp_lt_u32 s16, s17
    s_cbranch_scc1 L_LOOP0
L_LT0:
    s_cmp_lg_u32 s99, 0
    s_cbranch_scc1 L_LH0
    s_setprio 0
    v_smfmac_f32_16x16x64_bf16 v[152:155], v[184:187], v[204:211], v242
    ds_read_u16 v236, v250 offset:0
    ds_read_u16 v237, v250 offset:16
    v_exp_f32 v188, v188
    v_smfmac_f32_16x16x64_bf16 v[156:159], v[184:187], v[212:219], v242
    v_exp_f32 v189, v189
    v_mfma_f32_16x16x32_bf16 v[204:207], v[160:163], v[32:35], 0
    v_exp_f32 v190, v190
    v_mfma_f32_16x16x32_bf16 v[212:215], v[160:163], v[40:43], 0
    v_exp_f32 v191, v191
    v_mfma_f32_16x16x32_bf16 v[208:211], v[168:171], v[32:35], 0
    v_exp_f32 v192, v192
    v_mfma_f32_16x16x32_bf16 v[216:219], v[168:171], v[40:43], 0
    v_exp_f32 v193, v193
    v_mfma_f32_16x16x32_bf16 v[204:207], v[164:167], v[36:39], v[204:207]
    v_exp_f32 v194, v194
    v_mfma_f32_16x16x32_bf16 v[212:215], v[164:167], v[44:47], v[212:215]
    v_exp_f32 v195, v195
    v_mfma_f32_16x16x32_bf16 v[208:211], v[172:175], v[36:39], v[208:211]
    v_exp_f32 v196, v196
    v_mfma_f32_16x16x32_bf16 v[216:219], v[172:175], v[44:47], v[216:219]
    v_exp_f32 v197, v197
    v_smfmac_f32_16x16x64_bf16 v[136:139], v[184:187], v[220:227], v242
    s_waitcnt lgkmcnt(0)
    v_bfi_b32 v236, 31, v246, v236
    v_bfi_b32 v237, 31, v246, v237
    v_exp_f32 v198, v198
    s_setprio 3
    v_smfmac_f32_16x16x64_bf16 v[140:143], v[184:187], v[228:235], v242
    v_exp_f32 v199, v199
    v_exp_f32 v200, v200
    v_exp_f32 v201, v201
    v_exp_f32 v202, v202
    v_exp_f32 v203, v203
    v_pk_add_f32 v[188:189], v[188:189], 1.0 op_sel_hi:[1,0]
    v_pk_add_f32 v[190:191], v[190:191], 1.0 op_sel_hi:[1,0]
    v_pk_add_f32 v[192:193], v[192:193], 1.0 op_sel_hi:[1,0]
    v_pk_add_f32 v[194:195], v[194:195], 1.0 op_sel_hi:[1,0]
    v_pk_add_f32 v[196:197], v[196:197], 1.0 op_sel_hi:[1,0]
    v_pk_add_f32 v[198:199], v[198:199], 1.0 op_sel_hi:[1,0]
    v_pk_add_f32 v[200:201], v[200:201], 1.0 op_sel_hi:[1,0]
    v_pk_add_f32 v[202:203], v[202:203], 1.0 op_sel_hi:[1,0]
    s_setprio 0
    v_mfma_f32_16x16x32_bf16 v[220:223], v[176:179], v[72:75], 0
    ds_read_b64_tr_b16 v[184:185], v236
    ds_read_b64_tr_b16 v[186:187], v237
    v_rcp_f32 v188, v188
    v_mfma_f32_16x16x32_bf16 v[228:231], v[176:179], v[76:79], 0
    v_rcp_f32 v189, v189
    v_mfma_f32_16x16x32_bf16 v[224:227], v[180:183], v[72:75], 0
    v_rcp_f32 v190, v190
    v_mfma_f32_16x16x32_bf16 v[232:235], v[180:183], v[76:79], 0
    v_rcp_f32 v191, v191
    v_mfma_f32_16x16x32_bf16 v[220:223], v[160:163], v[16:19], v[220:223]
    v_rcp_f32 v192, v192
    v_mfma_f32_16x16x32_bf16 v[228:231], v[160:163], v[24:27], v[228:231]
    v_rcp_f32 v193, v193
    v_mfma_f32_16x16x32_bf16 v[224:227], v[168:171], v[16:19], v[224:227]
    v_rcp_f32 v194, v194
    v_mfma_f32_16x16x32_bf16 v[232:235], v[168:171], v[24:27], v[232:235]
    v_rcp_f32 v195, v195
    v_mfma_f32_16x16x32_bf16 v[220:223], v[164:167], v[20:23], v[220:223]
    v_rcp_f32 v196, v196
    v_mfma_f32_16x16x32_bf16 v[228:231], v[164:167], v[28:31], v[228:231]
    v_rcp_f32 v197, v197
    v_mfma_f32_16x16x32_bf16 v[224:227], v[172:175], v[20:23], v[224:227]
    v_rcp_f32 v198, v198
    s_setprio 3
    v_mfma_f32_16x16x32_bf16 v[232:235], v[172:175], v[28:31], v[232:235]
    v_rcp_f32 v199, v199
    v_rcp_f32 v200, v200
    v_rcp_f32 v201, v201
    v_rcp_f32 v202, v202
    v_rcp_f32 v203, v203
    v_pk_mul_f32 v[204:205], v[188:189], v[204:205]
    v_pk_mul_f32 v[206:207], v[190:191], v[206:207]
    v_pk_mul_f32 v[208:209], v[192:193], v[208:209]
    v_pk_mul_f32 v[210:211], v[194:195], v[210:211]
    v_pk_mul_f32 v[212:213], v[196:197], v[212:213]
    v_pk_mul_f32 v[214:215], v[198:199], v[214:215]
    v_pk_mul_f32 v[216:217], v[200:201], v[216:217]
    v_pk_mul_f32 v[218:219], v[202:203], v[218:219]
    s_setprio 0
    s_waitcnt lgkmcnt(0)
    v_smfmac_f32_16x16x64_bf16 v[112:115], v[184:187], v[204:211], v242
    v_exp_f32 v220, v220
    v_smfmac_f32_16x16x64_bf16 v[116:119], v[184:187], v[212:219], v242
    v_exp_f32 v221, v221
    v_mfma_f32_16x16x32_bf16 v[204:207], v[160:163], v[48:51], 0
    v_exp_f32 v222, v222
    v_mfma_f32_16x16x32_bf16 v[212:215], v[160:163], v[56:59], 0
    v_exp_f32 v223, v223
    v_mfma_f32_16x16x32_bf16 v[208:211], v[168:171], v[48:51], 0
    v_exp_f32 v224, v224
    v_mfma_f32_16x16x32_bf16 v[216:219], v[168:171], v[56:59], 0
    v_exp_f32 v225, v225
    v_mfma_f32_16x16x32_bf16 v[204:207], v[164:167], v[52:55], v[204:207]
    v_exp_f32 v226, v226
    v_mfma_f32_16x16x32_bf16 v[212:215], v[164:167], v[60:63], v[212:215]
    v_exp_f32 v227, v227
    v_mfma_f32_16x16x32_bf16 v[208:211], v[172:175], v[52:55], v[208:211]
    v_exp_f32 v228, v228
    v_mfma_f32_16x16x32_bf16 v[216:219], v[172:175], v[60:63], v[216:219]
    v_exp_f32 v229, v229
    v_smfmac_f32_16x16x64_bf16 v[96:99], v[184:187], v[188:195], v242
    v_exp_f32 v230, v230
    s_setprio 3
    v_smfmac_f32_16x16x64_bf16 v[100:103], v[184:187], v[196:203], v242
    v_exp_f32 v231, v231
    v_exp_f32 v232, v232
    v_exp_f32 v233, v233
    v_exp_f32 v234, v234
    v_exp_f32 v235, v235
    v_pk_add_f32 v[220:221], v[220:221], 1.0 op_sel_hi:[1,0]
    v_pk_add_f32 v[222:223], v[222:223], 1.0 op_sel_hi:[1,0]
    v_pk_add_f32 v[224:225], v[224:225], 1.0 op_sel_hi:[1,0]
    v_pk_add_f32 v[226:227], v[226:227], 1.0 op_sel_hi:[1,0]
    v_pk_add_f32 v[228:229], v[228:229], 1.0 op_sel_hi:[1,0]
    v_pk_add_f32 v[230:231], v[230:231], 1.0 op_sel_hi:[1,0]
    v_pk_add_f32 v[232:233], v[232:233], 1.0 op_sel_hi:[1,0]
    v_pk_add_f32 v[234:235], v[234:235], 1.0 op_sel_hi:[1,0]
    s_setprio 0
    v_rcp_f32 v220, v220
    v_rcp_f32 v221, v221
    v_rcp_f32 v222, v222
    v_rcp_f32 v223, v223
    v_rcp_f32 v224, v224
    v_rcp_f32 v225, v225
    v_rcp_f32 v226, v226
    v_rcp_f32 v227, v227
    v_rcp_f32 v228, v228
    v_rcp_f32 v229, v229
    v_rcp_f32 v230, v230
    v_rcp_f32 v231, v231
    v_rcp_f32 v232, v232
    v_rcp_f32 v233, v233
    v_rcp_f32 v234, v234
    v_rcp_f32 v235, v235
    v_pk_mul_f32 v[204:205], v[220:221], v[204:205]
    v_pk_mul_f32 v[206:207], v[222:223], v[206:207]
    v_pk_mul_f32 v[208:209], v[224:225], v[208:209]
    v_pk_mul_f32 v[210:211], v[226:227], v[210:211]
    v_pk_mul_f32 v[212:213], v[228:229], v[212:213]
    v_pk_mul_f32 v[214:215], v[230:231], v[214:215]
    v_pk_mul_f32 v[216:217], v[232:233], v[216:217]
    v_pk_mul_f32 v[218:219], v[234:235], v[218:219]
    v_smfmac_f32_16x16x64_bf16 v[104:107], v[184:187], v[220:227], v242
    v_smfmac_f32_16x16x64_bf16 v[108:111], v[184:187], v[228:235], v242
    v_smfmac_f32_16x16x64_bf16 v[120:123], v[184:187], v[204:211], v242
    v_smfmac_f32_16x16x64_bf16 v[124:127], v[184:187], v[212:219], v242
    s_branch L_DONE
L_LH0:
    s_setprio 0
    v_smfmac_f32_16x16x64_bf16 v[152:155], v[184:187], v[204:211], v242
    ds_read_u16 v236, v250 offset:0
    ds_read_u16 v237, v250 offset:16
    v_smfmac_f32_16x16x64_bf16 v[156:159], v[184:187], v[212:219], v242
    v_exp_f32 v188, v188
    v_mfma_f32_16x16x32_bf16 v[204:207], v[160:163], v[32:35], 0
    v_mfma_f32_16x16x32_bf16 v[212:215], v[160:163], v[40:43], 0
    v_exp_f32 v189, v189
    v_mfma_f32_16x16x32_bf16 v[204:207], v[164:167], v[36:39], v[204:207]
    v_mfma_f32_16x16x32_bf16 v[212:215], v[164:167], v[44:47], v[212:215]
    v_exp_f32 v190, v190
    v_smfmac_f32_16x16x64_bf16 v[136:139], v[184:187], v[220:227], v242
    s_waitcnt lgkmcnt(0)
    v_bfi_b32 v236, 31, v246, v236
    v_bfi_b32 v237, 31, v246, v237
    v_exp_f32 v191, v191
    s_setprio 3
    v_smfmac_f32_16x16x64_bf16 v[140:143], v[184:187], v[228:235], v242
    v_exp_f32 v196, v196
    v_exp_f32 v197, v197
    v_exp_f32 v198, v198
    v_exp_f32 v199, v199
    v_pk_add_f32 v[188:189], v[188:189], 1.0 op_sel_hi:[1,0]
    v_pk_add_f32 v[190:191], v[190:191], 1.0 op_sel_hi:[1,0]
    v_pk_add_f32 v[196:197], v[196:197], 1.0 op_sel_hi:[1,0]
    v_pk_add_f32 v[198:199], v[198:199], 1.0 op_sel_hi:[1,0]
    s_setprio 0
    v_mfma_f32_16x16x32_bf16 v[220:223], v[176:179], v[72:75], 0
    ds_read_b64_tr_b16 v[184:185], v236
    ds_read_b64_tr_b16 v[186:187], v237
    v_mfma_f32_16x16x32_bf16 v[228:231], v[176:179], v[76:79], 0
    v_rcp_f32 v188, v188
    v_mfma_f32_16x16x32_bf16 v[220:223], v[160:163], v[16:19], v[220:223]
    v_rcp_f32 v189, v189
    v_mfma_f32_16x16x32_bf16 v[228:231], v[160:163], v[24:27], v[228:231]
    v_rcp_f32 v190, v190
    v_mfma_f32_16x16x32_bf16 v[220:223], v[164:167], v[20:23], v[220:223]
    v_rcp_f32 v191, v191
    s_setprio 3
    v_mfma_f32_16x16x32_bf16 v[228:231], v[164:167], v[28:31], v[228:231]
    v_rcp_f32 v196, v196
    v_rcp_f32 v197, v197
    v_rcp_f32 v198, v198
    v_rcp_f32 v199, v199
    v_pk_mul_f32 v[204:205], v[188:189], v[204:205]
    v_pk_mul_f32 v[206:207], v[190:191], v[206:207]
    v_pk_mul_f32 v[212:213], v[196:197], v[212:213]
    v_pk_mul_f32 v[214:215], v[198:199], v[214:215]
    s_setprio 0
    s_waitcnt lgkmcnt(0)
    v_smfmac_f32_16x16x64_bf16 v[112:115], v[184:187], v[204:211], v242
    v_smfmac_f32_16x16x64_bf16 v[116:119], v[184:187], v[212:219], v242
    v_exp_f32 v220, v220
    v_mfma_f32_16x16x32_bf16 v[204:207], v[160:163], v[48:51], 0
    v_mfma_f32_16x16x32_bf16 v[212:215], v[160:163], v[56:59], 0
    v_exp_f32 v221, v221
    v_mfma_f32_16x16x32_bf16 v[204:207], v[164:167], v[52:55], v[204:207]
    v_mfma_f32_16x16x32_bf16 v[212:215], v[164:167], v[60:63], v[212:215]
    v_exp_f32 v222, v222
    v_smfmac_f32_16x16x64_bf16 v[96:99], v[184:187], v[188:195], v242
    v_exp_f32 v223, v223
    s_setprio 3
    v_smfmac_f32_16x16x64_bf16 v[100:103], v[184:187], v[196:203], v242
    v_exp_f32 v228, v228
    v_exp_f32 v229, v229
    v_exp_f32 v230, v230
    v_exp_f32 v231, v231
    v_pk_add_f32 v[220:221], v[220:221], 1.0 op_sel_hi:[1,0]
    v_pk_add_f32 v[222:223], v[222:223], 1.0 op_sel_hi:[1,0]
    v_pk_add_f32 v[228:229], v[228:229], 1.0 op_sel_hi:[1,0]
    v_pk_add_f32 v[230:231], v[230:231], 1.0 op_sel_hi:[1,0]
    s_setprio 0
    v_rcp_f32 v220, v220
    v_rcp_f32 v221, v221
    v_rcp_f32 v222, v222
    v_rcp_f32 v223, v223
    v_rcp_f32 v228, v228
    v_rcp_f32 v229, v229
    v_rcp_f32 v230, v230
    v_rcp_f32 v231, v231
    v_pk_mul_f32 v[204:205], v[220:221], v[204:205]
    v_pk_mul_f32 v[206:207], v[222:223], v[206:207]
    v_pk_mul_f32 v[212:213], v[228:229], v[212:213]
    v_pk_mul_f32 v[214:215], v[230:231], v[214:215]
    v_smfmac_f32_16x16x64_bf16 v[104:107], v[184:187], v[220:227], v242
    v_smfmac_f32_16x16x64_bf16 v[108:111], v[184:187], v[228:235], v242
    v_smfmac_f32_16x16x64_bf16 v[120:123], v[184:187], v[204:211], v242
    v_smfmac_f32_16x16x64_bf16 v[124:127], v[184:187], v[212:219], v242
    s_branch L_DONE
L_LT1:
    s_cmp_lg_u32 s99, 0
    s_cbranch_scc1 L_LH1
    s_setprio 0
    v_smfmac_f32_16x16x64_bf16 v[120:123], v[184:187], v[204:211], v242
    ds_read_u16 v236, v250 offset:1152
    ds_read_u16 v237, v250 offset:1168
    v_exp_f32 v188, v188
    v_smfmac_f32_16x16x64_bf16 v[124:127], v[184:187], v[212:219], v242
    v_exp_f32 v189, v189
    v_mfma_f32_16x16x32_bf16 v[204:207], v[160:163], v[32:35], 0
    v_exp_f32 v190, v190
    v_mfma_f32_16x16x32_bf16 v[212:215], v[160:163], v[40:43], 0
    v_exp_f32 v191, v191
    v_mfma_f32_16x16x32_bf16 v[208:211], v[168:171], v[32:35], 0
    v_exp_f32 v192, v192
    v_mfma_f32_16x16x32_bf16 v[216:219], v[168:171], v[40:43], 0
    v_exp_f32 v193, v193
    v_mfma_f32_16x16x32_bf16 v[204:207], v[164:167], v[36:39], v[204:207]
    v_exp_f32 v194, v194
    v_mfma_f32_16x16x32_bf16 v[212:215], v[164:167], v[44:47], v[212:215]
    v_exp_f32 v195, v195
    v_mfma_f32_16x16x32_bf16 v[208:211], v[172:175], v[36:39], v[208:211]
    v_exp_f32 v196, v196
    v_mfma_f32_16x16x32_bf16 v[216:219], v[172:175], v[44:47], v[216:219]
    v_exp_f32 v197, v197
    v_smfmac_f32_16x16x64_bf16 v[104:107], v[184:187], v[220:227], v242
    s_waitcnt lgkmcnt(0)
    v_bfi_b32 v236, 31, v246, v236
    v_bfi_b32 v237, 31, v246, v237
    v_exp_f32 v198, v198
    s_setprio 3
    v_smfmac_f32_16x16x64_bf16 v[108:111], v[184:187], v[228:235], v242
    v_exp_f32 v199, v199
    v_exp_f32 v200, v200
    v_exp_f32 v201, v201
    v_exp_f32 v202, v202
    v_exp_f32 v203, v203
    v_pk_add_f32 v[188:189], v[188:189], 1.0 op_sel_hi:[1,0]
    v_pk_add_f32 v[190:191], v[190:191], 1.0 op_sel_hi:[1,0]
    v_pk_add_f32 v[192:193], v[192:193], 1.0 op_sel_hi:[1,0]
    v_pk_add_f32 v[194:195], v[194:195], 1.0 op_sel_hi:[1,0]
    v_pk_add_f32 v[196:197], v[196:197], 1.0 op_sel_hi:[1,0]
    v_pk_add_f32 v[198:199], v[198:199], 1.0 op_sel_hi:[1,0]
    v_pk_add_f32 v[200:201], v[200:201], 1.0 op_sel_hi:[1,0]
    v_pk_add_f32 v[202:203], v[202:203], 1.0 op_sel_hi:[1,0]
    s_setprio 0
    v_mfma_f32_16x16x32_bf16 v[220:223], v[176:179], v[88:91], 0
    ds_read_b64_tr_b16 v[184:185], v236
    ds_read_b64_tr_b16 v[186:187], v237
    v_rcp_f32 v188, v188
    v_mfma_f32_16x16x32_bf16 v[228:231], v[176:179], v[92:95], 0
    v_rcp_f32 v189, v189
    v_mfma_f32_16x16x32_bf16 v[224:227], v[180:183], v[88:91], 0
    v_rcp_f32 v190, v190
    v_mfma_f32_16x16x32_bf16 v[232:235], v[180:183], v[92:95], 0
    v_rcp_f32 v191, v191
    v_mfma_f32_16x16x32_bf16 v[220:223], v[160:163], v[16:19], v[220:223]
    v_rcp_f32 v192, v192
    v_mfma_f32_16x16x32_bf16 v[228:231], v[160:163], v[24:27], v[228:231]
    v_rcp_f32 v193, v193
    v_mfma_f32_16x16x32_bf16 v[224:227], v[168:171], v[16:19], v[224:227]
    v_rcp_f32 v194, v194
    v_mfma_f32_16x16x32_bf16 v[232:235], v[168:171], v[24:27], v[232:235]
    v_rcp_f32 v195, v195
    v_mfma_f32_16x16x32_bf16 v[220:223], v[164:167], v[20:23], v[220:223]
    v_rcp_f32 v196, v196
    v_mfma_f32_16x16x32_bf16 v[228:231], v[164:167], v[28:31], v[228:231]
    v_rcp_f32 v197, v197
    v_mfma_f32_16x16x32_bf16 v[224:227], v[172:175], v[20:23], v[224:227]
    v_rcp_f32 v198, v198
    s_setprio 3
    v_mfma_f32_16x16x32_bf16 v[232:235], v[172:175], v[28:31], v[232:235]
    v_rcp_f32 v199, v199
    v_rcp_f32 v200, v200
    v_rcp_f32 v201, v201
    v_rcp_f32 v202, v202
    v_rcp_f32 v203, v203
    v_pk_mul_f32 v[204:205], v[188:189], v[204:205]
    v_pk_mul_f32 v[206:207], v[190:191], v[206:207]
    v_pk_mul_f32 v[208:209], v[192:193], v[208:209]
    v_pk_mul_f32 v[210:211], v[194:195], v[210:211]
    v_pk_mul_f32 v[212:213], v[196:197], v[212:213]
    v_pk_mul_f32 v[214:215], v[198:199], v[214:215]
    v_pk_mul_f32 v[216:217], v[200:201], v[216:217]
    v_pk_mul_f32 v[218:219], v[202:203], v[218:219]
    s_setprio 0
    s_waitcnt lgkmcnt(0)
    v_smfmac_f32_16x16x64_bf16 v[144:147], v[184:187], v[204:211], v242
    v_exp_f32 v220, v220
    v_smfmac_f32_16x16x64_bf16 v[148:151], v[184:187], v[212:219], v242
    v_exp_f32 v221, v221
    v_mfma_f32_16x16x32_bf16 v[204:207], v[160:163], v[48:51], 0
    v_exp_f32 v222, v222
    v_mfma_f32_16x16x32_bf16 v[212:215], v[160:163], v[56:59], 0
    v_exp_f32 v223, v223
    v_mfma_f32_16x16x32_bf16 v[208:211], v[168:171], v[48:51], 0
    v_exp_f32 v224, v224
    v_mfma_f32_16x16x32_bf16 v[216:219], v[168:171], v[56:59], 0
    v_exp_f32 v225, v225
    v_mfma_f32_16x16x32_bf16 v[204:207], v[164:167], v[52:55], v[204:207]
    v_exp_f32 v226, v226
    v_mfma_f32_16x16x32_bf16 v[212:215], v[164:167], v[60:63], v[212:215]
    v_exp_f32 v227, v227
    v_mfma_f32_16x16x32_bf16 v[208:211], v[172:175], v[52:55], v[208:211]
    v_exp_f32 v228, v228
    v_mfma_f32_16x16x32_bf16 v[216:219], v[172:175], v[60:63], v[216:219]
    v_exp_f32 v229, v229
    v_smfmac_f32_16x16x64_bf16 v[128:131], v[184:187], v[188:195], v242
    v_exp_f32 v230, v230
    s_setprio 3
    v_smfmac_f32_16x16x64_bf16 v[132:135], v[184:187], v[196:203], v242
    v_exp_f32 v231, v231
    v_exp_f32 v232, v232
    v_exp_f32 v233, v233
    v_exp_f32 v234, v234
    v_exp_f32 v235, v235
    v_pk_add_f32 v[220:221], v[220:221], 1.0 op_sel_hi:[1,0]
    v_pk_add_f32 v[222:223], v[222:223], 1.0 op_sel_hi:[1,0]
    v_pk_add_f32 v[224:225], v[224:225], 1.0 op_sel_hi:[1,0]
    v_pk_add_f32 v[226:227], v[226:227], 1.0 op_sel_hi:[1,0]
    v_pk_add_f32 v[228:229], v[228:229], 1.0 op_sel_hi:[1,0]
    v_pk_add_f32 v[230:231], v[230:231], 1.0 op_sel_hi:[1,0]
    v_pk_add_f32 v[232:233], v[232:233], 1.0 op_sel_hi:[1,0]
    v_pk_add_f32 v[234:235], v[234:235], 1.0 op_sel_hi:[1,0]
    s_setprio 0
    v_rcp_f32 v220, v220
    v_rcp_f32 v221, v221
    v_rcp_f32 v222, v222
    v_rcp_f32 v223, v223
    v_rcp_f32 v224, v224
    v_rcp_f32 v225, v225
    v_rcp_f32 v226, v226
    v_rcp_f32 v227, v227
    v_rcp_f32 v228, v228
    v_rcp_f32 v229, v229
    v_rcp_f32 v230, v230
    v_rcp_f32 v231, v231
    v_rcp_f32 v232, v232
    v_rcp_f32 v233, v233
    v_rcp_f32 v234, v234
    v_rcp_f32 v235, v235
    v_pk_mul_f32 v[204:205], v[220:221], v[204:205]
    v_pk_mul_f32 v[206:207], v[222:223], v[206:207]
    v_pk_mul_f32 v[208:209], v[224:225], v[208:209]
    v_pk_mul_f32 v[210:211], v[226:227], v[210:211]
    v_pk_mul_f32 v[212:213], v[228:229], v[212:213]
    v_pk_mul_f32 v[214:215], v[230:231], v[214:215]
    v_pk_mul_f32 v[216:217], v[232:233], v[216:217]
    v_pk_mul_f32 v[218:219], v[234:235], v[218:219]
    v_smfmac_f32_16x16x64_bf16 v[136:139], v[184:187], v[220:227], v242
    v_smfmac_f32_16x16x64_bf16 v[140:143], v[184:187], v[228:235], v242
    v_smfmac_f32_16x16x64_bf16 v[152:155], v[184:187], v[204:211], v242
    v_smfmac_f32_16x16x64_bf16 v[156:159], v[184:187], v[212:219], v242
    s_branch L_DONE
L_LH1:
    s_setprio 0
    v_smfmac_f32_16x16x64_bf16 v[120:123], v[184:187], v[204:211], v242
    ds_read_u16 v236, v250 offset:1152
    ds_read_u16 v237, v250 offset:1168
    v_smfmac_f32_16x16x64_bf16 v[124:127], v[184:187], v[212:219], v242
    v_exp_f32 v188, v188
    v_mfma_f32_16x16x32_bf16 v[204:207], v[160:163], v[32:35], 0
    v_mfma_f32_16x16x32_bf16 v[212:215], v[160:163], v[40:43], 0
    v_exp_f32 v189, v189
    v_mfma_f32_16x16x32_bf16 v[204:207], v[164:167], v[36:39], v[204:207]
    v_mfma_f32_16x16x32_bf16 v[212:215], v[164:167], v[44:47], v[212:215]
    v_exp_f32 v190, v190
    v_smfmac_f32_16x16x64_bf16 v[104:107], v[184:187], v[220:227], v242
    s_waitcnt lgkmcnt(0)
    v_bfi_b32 v236, 31, v246, v236
    v_bfi_b32 v237, 31, v246, v237
    v_exp_f32 v191, v191
    s_setprio 3
    v_smfmac_f32_16x16x64_bf16 v[108:111], v[184:187], v[228:235], v242
    v_exp_f32 v196, v196
    v_exp_f32 v197, v197
    v_exp_f32 v198, v198
    v_exp_f32 v199, v199
    v_pk_add_f32 v[188:189], v[188:189], 1.0 op_sel_hi:[1,0]
    v_pk_add_f32 v[190:191], v[190:191], 1.0 op_sel_hi:[1,0]
    v_pk_add_f32 v[196:197], v[196:197], 1.0 op_sel_hi:[1,0]
    v_pk_add_f32 v[198:199], v[198:199], 1.0 op_sel_hi:[1,0]
    s_setprio 0
    v_mfma_f32_16x16x32_bf16 v[220:223], v[176:179], v[88:91], 0
    ds_read_b64_tr_b16 v[184:185], v236
    ds_read_b64_tr_b16 v[186:187], v237
    v_mfma_f32_16x16x32_bf16 v[228:231], v[176:179], v[92:95], 0
    v_rcp_f32 v188, v188
    v_mfma_f32_16x16x32_bf16 v[220:223], v[160:163], v[16:19], v[220:223]
    v_rcp_f32 v189, v189
    v_mfma_f32_16x16x32_bf16 v[228:231], v[160:163], v[24:27], v[228:231]
    v_rcp_f32 v190, v190
    v_mfma_f32_16x16x32_bf16 v[220:223], v[164:167], v[20:23], v[220:223]
    v_rcp_f32 v191, v191
    s_setprio 3
    v_mfma_f32_16x16x32_bf16 v[228:231], v[164:167], v[28:31], v[228:231]
    v_rcp_f32 v196, v196
    v_rcp_f32 v197, v197
    v_rcp_f32 v198, v198
    v_rcp_f32 v199, v199
    v_pk_mul_f32 v[204:205], v[188:189], v[204:205]
    v_pk_mul_f32 v[206:207], v[190:191], v[206:207]
    v_pk_mul_f32 v[212:213], v[196:197], v[212:213]
    v_pk_mul_f32 v[214:215], v[198:199], v[214:215]
    s_setprio 0
    s_waitcnt lgkmcnt(0)
    v_smfmac_f32_16x16x64_bf16 v[144:147], v[184:187], v[204:211], v242
    v_smfmac_f32_16x16x64_bf16 v[148:151], v[184:187], v[212:219], v242
    v_exp_f32 v220, v220
    v_mfma_f32_16x16x32_bf16 v[204:207], v[160:163], v[48:51], 0
    v_mfma_f32_16x16x32_bf16 v[212:215], v[160:163], v[56:59], 0
    v_exp_f32 v221, v221
    v_mfma_f32_16x16x32_bf16 v[204:207], v[164:167], v[52:55], v[204:207]
    v_mfma_f32_16x16x32_bf16 v[212:215], v[164:167], v[60:63], v[212:215]
    v_exp_f32 v222, v222
    v_smfmac_f32_16x16x64_bf16 v[128:131], v[184:187], v[188:195], v242
    v_exp_f32 v223, v223
    s_setprio 3
    v_smfmac_f32_16x16x64_bf16 v[132:135], v[184:187], v[196:203], v242
    v_exp_f32 v228, v228
    v_exp_f32 v229, v229
    v_exp_f32 v230, v230
    v_exp_f32 v231, v231
    v_pk_add_f32 v[220:221], v[220:221], 1.0 op_sel_hi:[1,0]
    v_pk_add_f32 v[222:223], v[222:223], 1.0 op_sel_hi:[1,0]
    v_pk_add_f32 v[228:229], v[228:229], 1.0 op_sel_hi:[1,0]
    v_pk_add_f32 v[230:231], v[230:231], 1.0 op_sel_hi:[1,0]
    s_setprio 0
    v_rcp_f32 v220, v220
    v_rcp_f32 v221, v221
    v_rcp_f32 v222, v222
    v_rcp_f32 v223, v223
    v_rcp_f32 v228, v228
    v_rcp_f32 v229, v229
    v_rcp_f32 v230, v230
    v_rcp_f32 v231, v231
    v_pk_mul_f32 v[204:205], v[220:221], v[204:205]
    v_pk_mul_f32 v[206:207], v[222:223], v[206:207]
    v_pk_mul_f32 v[212:213], v[228:229], v[212:213]
    v_pk_mul_f32 v[214:215], v[230:231], v[214:215]
    v_smfmac_f32_16x16x64_bf16 v[136:139], v[184:187], v[220:227], v242
    v_smfmac_f32_16x16x64_bf16 v[140:143], v[184:187], v[228:235], v242
    v_smfmac_f32_16x16x64_bf16 v[152:155], v[184:187], v[204:211], v242
    v_smfmac_f32_16x16x64_bf16 v[156:159], v[184:187], v[212:219], v242
L_DONE:
    v_mbcnt_lo_u32_b32 v253, -1, 0
    v_mbcnt_hi_u32_b32 v253, -1, v253
    s_cmp_lg_u32 s19, 0
    s_cbranch_scc1 L_SLOW
L_EPI:
    s_setprio 0
    v_bfe_u32 v65, v253, 2, 3
    v_lshrrev_b32 v66, 5, v253
    v_lshl_add_u32 v65, v66, 4, v65
    v_mul_u32_u24 v65, 160, v65
    s_mov_b32 s10, 143488
    v_add3_u32 v65, v65, v246, s10
    v_and_b32 v64, 48, v253
    v_and_b32 v67, 15, v253
    v_lshlrev_b32 v68, 3, v67
    v_lshlrev_b32 v70, 3, v64
    s_movk_i32 s10, 832
    v_mad_u32_u24 v64, v246, s10, v64
    s_waitcnt lgkmcnt(0)
    s_lshl_b32 s22, s22, 5
    s_add_u32 s10, s22, 116736
    v_add_u32 v69, s10, v68
    s_sub_u32 s11, 0, s22
    v_add_u32 v80, s11, v70
    v_and_b32 v80, 0x1ff, v80
    v_add_u32 v72, v80, v69
    ds_read_b64 v[32:33], v72 offset:0
    s_sub_u32 s11, 32, s22
    v_add_u32 v81, s11, v70
    v_and_b32 v81, 0x1ff, v81
    v_add_u32 v72, v81, v69
    ds_read_b64 v[34:35], v72 offset:6656
    s_sub_u32 s11, 64, s22
    v_add_u32 v82, s11, v70
    v_and_b32 v82, 0x1ff, v82
    v_add_u32 v72, v82, v69
    ds_read_b64 v[36:37], v72 offset:13312
    s_sub_u32 s11, 96, s22
    v_add_u32 v83, s11, v70
    v_and_b32 v83, 0x1ff, v83
    v_add_u32 v72, v83, v69
    ds_read_b64 v[38:39], v72 offset:19968
    s_sub_u32 s11, 0, s22
    v_lshl_add_u32 v72, v68, 2, s11
    v_and_b32 v72, 0x1ff, v72
    v_add3_u32 v72, v72, v64, s10
    ds_read_b128 v[160:163], v72 offset:0
    ds_read_b128 v[164:167], v72 offset:64
    ds_read_b64_tr_b16 v[0:1], v65 offset:0
    ds_read_b64_tr_b16 v[2:3], v65 offset:1280
    ds_read_b64_tr_b16 v[8:9], v65 offset:32
    ds_read_b64_tr_b16 v[10:11], v65 offset:1312
    ds_read_b64_tr_b16 v[16:17], v65 offset:64
    ds_read_b64_tr_b16 v[18:19], v65 offset:1344
    ds_read_b64_tr_b16 v[24:25], v65 offset:96
    ds_read_b64_tr_b16 v[26:27], v65 offset:1376
    s_lshl_b32 s23, s23, 5
    s_add_u32 s10, s23, 116736
    v_add_u32 v69, s10, v68
    s_sub_u32 s11, 0, s23
    v_add_u32 v84, s11, v70
    v_and_b32 v84, 0x1ff, v84
    v_add_u32 v72, v84, v69
    ds_read_b64 v[40:41], v72 offset:0
    s_sub_u32 s11, 32, s23
    v_add_u32 v85, s11, v70
    v_and_b32 v85, 0x1ff, v85
    v_add_u32 v72, v85, v69
    ds_read_b64 v[42:43], v72 offset:6656
    s_sub_u32 s11, 64, s23
    v_add_u32 v86, s11, v70
    v_and_b32 v86, 0x1ff, v86
    v_add_u32 v72, v86, v69
    ds_read_b64 v[44:45], v72 offset:13312
    s_sub_u32 s11, 96, s23
    v_add_u32 v87, s11, v70
    v_and_b32 v87, 0x1ff, v87
    v_add_u32 v72, v87, v69
    ds_read_b64 v[46:47], v72 offset:19968
    s_sub_u32 s11, 0, s23
    v_lshl_add_u32 v72, v68, 2, s11
    v_and_b32 v72, 0x1ff, v72
    v_add3_u32 v72, v72, v64, s10
    ds_read_b128 v[168:171], v72 offset:0
    ds_read_b128 v[172:175], v72 offset:64
    ds_read_b64_tr_b16 v[4:5], v65 offset:5120
    ds_read_b64_tr_b16 v[6:7], v65 offset:6400
    ds_read_b64_tr_b16 v[12:13], v65 offset:5152
    ds_read_b64_tr_b16 v[14:15], v65 offset:6432
    ds_read_b64_tr_b16 v[20:21], v65 offset:5184
    ds_read_b64_tr_b16 v[22:23], v65 offset:6464
    ds_read_b64_tr_b16 v[28:29], v65 offset:5216
    ds_read_b64_tr_b16 v[30:31], v65 offset:6496
    s_lshl_b32 s10, s25, 5
    v_subrev_u32 v70, s10, v70
    v_cmpx_eq_u32 vcc, 0x0, v70
    s_cbranch_execz L_NS0
    v_add_f32 v96, v96, v128
    v_add_f32 v100, v100, v132
    v_add_f32 v104, v104, v136
    v_add_f32 v108, v108, v140
    v_add_f32 v112, v112, v144
    v_add_f32 v116, v116, v148
    v_add_f32 v120, v120, v152
    v_add_f32 v124, v124, v156
L_NS0:
    s_mov_b64 exec, -1
    v_cmpx_eq_u32 vcc, 0xffffffe0, v70
    s_cbranch_execz L_NS1
    v_add_f32 v97, v97, v129
    v_add_f32 v101, v101, v133
    v_add_f32 v105, v105, v137
    v_add_f32 v109, v109, v141
    v_add_f32 v113, v113, v145
    v_add_f32 v117, v117, v149
    v_add_f32 v121, v121, v153
    v_add_f32 v125, v125, v157
L_NS1:
    s_mov_b64 exec, -1
    v_cmpx_eq_u32 vcc, 0xffffffc0, v70
    s_cbranch_execz L_NS2
    v_add_f32 v98, v98, v130
    v_add_f32 v102, v102, v134
    v_add_f32 v106, v106, v138
    v_add_f32 v110, v110, v142
    v_add_f32 v114, v114, v146
    v_add_f32 v118, v118, v150
    v_add_f32 v122, v122, v154
    v_add_f32 v126, v126, v158
L_NS2:
    s_mov_b64 exec, -1
    v_cmpx_eq_u32 vcc, 0xffffffa0, v70
    s_cbranch_execz L_NS3
    v_add_f32 v99, v99, v131
    v_add_f32 v103, v103, v135
    v_add_f32 v107, v107, v139
    v_add_f32 v111, v111, v143
    v_add_f32 v115, v115, v147
    v_add_f32 v119, v119, v151
    v_add_f32 v123, v123, v155
    v_add_f32 v127, v127, v159
L_NS3:
    s_mov_b64 exec, -1
    s_mul_i32 s10, s5, 196
    s_add_u32 s34, s10, s8
    s_min_u32 s34, s34, 50000
    s_lshl_b32 s34, s34, 7
    s_add_u32 s35, s10, s24
    s_min_u32 s35, s35, 50000
    s_lshl_b32 s35, s35, 7
    s_add_u32 s36, s10, s7
    s_min_u32 s36, s36, 50000
    s_lshl_b32 s36, s36, 7
    s_add_u32 s37, s10, s9
    s_min_u32 s37, s37, 50000
    s_lshl_b32 s37, s37, 7
    s_add_u32 s56, s48, s36
    s_addc_u32 s57, s49, 0
    s_sub_u32 s58, s37, s36
    s_add_u32 s48, s48, s34
    s_addc_u32 s49, s49, 0
    s_sub_u32 s50, s35, s34
    s_lshl_b32 s10, s8, 5
    s_sub_u32 s10, s22, s10
    s_lshl_b32 s10, s10, 2
    v_add_u32 v74, s10, v68
    s_lshl_b32 s10, s7, 5
    s_sub_u32 s10, s23, s10
    s_lshl_b32 s10, s10, 2
    v_add_u32 v75, s10, v68
    v_rcp_f32 v128, v128
    v_rcp_f32 v129, v129
    v_rcp_f32 v130, v130
    v_rcp_f32 v131, v131
    v_rcp_f32 v132, v132
    v_rcp_f32 v133, v133
    v_rcp_f32 v134, v134
    v_rcp_f32 v135, v135
    v_rcp_f32 v136, v136
    v_rcp_f32 v137, v137
    v_rcp_f32 v138, v138
    v_rcp_f32 v139, v139
    v_rcp_f32 v140, v140
    v_rcp_f32 v141, v141
    v_rcp_f32 v142, v142
    v_rcp_f32 v143, v143
    v_rcp_f32 v96, v96
    v_rcp_f32 v97, v97
    v_rcp_f32 v98, v98
    v_rcp_f32 v99, v99
    v_rcp_f32 v100, v100
    v_rcp_f32 v101, v101
    v_rcp_f32 v102, v102
    v_rcp_f32 v103, v103
    v_rcp_f32 v104, v104
    v_rcp_f32 v105, v105
    v_rcp_f32 v106, v106
    v_rcp_f32 v107, v107
    v_rcp_f32 v108, v108
    v_rcp_f32 v109, v109
    v_rcp_f32 v110, v110
    v_rcp_f32 v111, v111
    s_waitcnt lgkmcnt(8)
    v_lshlrev_b32 v188, 16, v32
    v_and_b32 v192, 0xffff0000, v32
    v_lshlrev_b32 v196, 16, v33
    v_and_b32 v200, 0xffff0000, v33
    v_lshlrev_b32 v189, 16, v34
    v_and_b32 v193, 0xffff0000, v34
    v_lshlrev_b32 v197, 16, v35
    v_and_b32 v201, 0xffff0000, v35
    v_lshlrev_b32 v190, 16, v36
    v_and_b32 v194, 0xffff0000, v36
    v_lshlrev_b32 v198, 16, v37
    v_and_b32 v202, 0xffff0000, v37
    v_lshlrev_b32 v191, 16, v38
    v_and_b32 v195, 0xffff0000, v38
    v_lshlrev_b32 v199, 16, v39
    v_and_b32 v203, 0xffff0000, v39
    v_lshlrev_b32 v204, 16, v40
    v_and_b32 v208, 0xffff0000, v40
    v_lshlrev_b32 v212, 16, v41
    v_and_b32 v216, 0xffff0000, v41
    v_lshlrev_b32 v205, 16, v42
    v_and_b32 v209, 0xffff0000, v42
    v_lshlrev_b32 v213, 16, v43
    v_and_b32 v217, 0xffff0000, v43
    v_lshlrev_b32 v206, 16, v44
    v_and_b32 v210, 0xffff0000, v44
    v_lshlrev_b32 v214, 16, v45
    v_and_b32 v218, 0xffff0000, v45
    v_lshlrev_b32 v207, 16, v46
    v_and_b32 v211, 0xffff0000, v46
    v_lshlrev_b32 v215, 16, v47
    v_and_b32 v219, 0xffff0000, v47
    v_pk_fma_f32 v[112:113], v[112:113], v[96:97], v[188:189]
    v_pk_fma_f32 v[114:115], v[114:115], v[98:99], v[190:191]
    v_pk_fma_f32 v[116:117], v[116:117], v[100:101], v[192:193]
    v_pk_fma_f32 v[118:119], v[118:119], v[102:103], v[194:195]
    v_pk_fma_f32 v[120:121], v[120:121], v[104:105], v[196:197]
    v_pk_fma_f32 v[122:123], v[122:123], v[106:107], v[198:199]
    v_pk_fma_f32 v[124:125], v[124:125], v[108:109], v[200:201]
    v_pk_fma_f32 v[126:127], v[126:127], v[110:111], v[202:203]
    v_pk_fma_f32 v[144:145], v[144:145], v[128:129], v[204:205]
    v_pk_fma_f32 v[146:147], v[146:147], v[130:131], v[206:207]
    v_pk_fma_f32 v[148:149], v[148:149], v[132:133], v[208:209]
    v_pk_fma_f32 v[150:151], v[150:151], v[134:135], v[210:211]
    v_pk_fma_f32 v[152:153], v[152:153], v[136:137], v[212:213]
    v_pk_fma_f32 v[154:155], v[154:155], v[138:139], v[214:215]
    v_pk_fma_f32 v[156:157], v[156:157], v[140:141], v[216:217]
    v_pk_fma_f32 v[158:159], v[158:159], v[142:143], v[218:219]
    s_waitcnt lgkmcnt(0)
    v_mfma_f32_16x16x32_bf16 v[112:115], v[160:163], v[0:3], v[112:115]
    v_lshl_add_u32 v80, v80, 2, v74
    v_mfma_f32_16x16x32_bf16 v[116:119], v[160:163], v[8:11], v[116:119]
    v_lshl_add_u32 v81, v81, 2, v74
    v_mfma_f32_16x16x32_bf16 v[120:123], v[160:163], v[16:19], v[120:123]
    v_lshl_add_u32 v82, v82, 2, v74
    v_mfma_f32_16x16x32_bf16 v[124:127], v[160:163], v[24:27], v[124:127]
    v_lshl_add_u32 v83, v83, 2, v74
    v_mfma_f32_16x16x32_bf16 v[112:115], v[164:167], v[4:7], v[112:115]
    v_lshl_add_u32 v84, v84, 2, v75
    v_mfma_f32_16x16x32_bf16 v[116:119], v[164:167], v[12:15], v[116:119]
    v_lshl_add_u32 v85, v85, 2, v75
    v_mfma_f32_16x16x32_bf16 v[120:123], v[164:167], v[20:23], v[120:123]
    v_lshl_add_u32 v86, v86, 2, v75
    v_mfma_f32_16x16x32_bf16 v[124:127], v[164:167], v[28:31], v[124:127]
    v_lshl_add_u32 v87, v87, 2, v75
    v_mfma_f32_16x16x32_bf16 v[144:147], v[168:171], v[0:3], v[144:147]
    v_mfma_f32_16x16x32_bf16 v[148:151], v[168:171], v[8:11], v[148:151]
    v_mfma_f32_16x16x32_bf16 v[152:155], v[168:171], v[16:19], v[152:155]
    v_mfma_f32_16x16x32_bf16 v[156:159], v[168:171], v[24:27], v[156:159]
    v_mfma_f32_16x16x32_bf16 v[144:147], v[172:175], v[4:7], v[144:147]
    v_mfma_f32_16x16x32_bf16 v[148:151], v[172:175], v[12:15], v[148:151]
    v_mfma_f32_16x16x32_bf16 v[152:155], v[172:175], v[20:23], v[152:155]
    v_mfma_f32_16x16x32_bf16 v[156:159], v[172:175], v[28:31], v[156:159]
    v_cvt_pk_bf16_f32 v96, v112, v116
    v_cvt_pk_bf16_f32 v97, v120, v124
    v_pk_max_f16 v96, v96, v32
    v_pk_max_f16 v97, v97, v33
    buffer_store_dwordx2 v[96:97], v80, s[48:51], 0 offen sc1
    v_cvt_pk_bf16_f32 v98, v113, v117
    v_cvt_pk_bf16_f32 v99, v121, v125
    v_pk_max_f16 v98, v98, v34
    v_pk_max_f16 v99, v99, v35
    buffer_store_dwordx2 v[98:99], v81, s[48:51], 0 offen sc1
    v_cvt_pk_bf16_f32 v100, v114, v118
    v_cvt_pk_bf16_f32 v101, v122, v126
    v_pk_max_f16 v100, v100, v36
    v_pk_max_f16 v101, v101, v37
    buffer_store_dwordx2 v[100:101], v82, s[48:51], 0 offen sc1
    v_cvt_pk_bf16_f32 v102, v115, v119
    v_cvt_pk_bf16_f32 v103, v123, v127
    v_pk_max_f16 v102, v102, v38
    v_pk_max_f16 v103, v103, v39
    buffer_store_dwordx2 v[102:103], v83, s[48:51], 0 offen sc1
    v_cvt_pk_bf16_f32 v128, v144, v148
    v_cvt_pk_bf16_f32 v129, v152, v156
    v_pk_max_f16 v128, v128, v40
    v_pk_max_f16 v129, v129, v41
    buffer_store_dwordx2 v[128:129], v84, s[56:59], 0 offen sc1
    v_cvt_pk_bf16_f32 v130, v145, v149
    v_cvt_pk_bf16_f32 v131, v153, v157
    v_pk_max_f16 v130, v130, v42
    v_pk_max_f16 v131, v131, v43
    buffer_store_dwordx2 v[130:131], v85, s[56:59], 0 offen sc1
    v_cvt_pk_bf16_f32 v132, v146, v150
    v_cvt_pk_bf16_f32 v133, v154, v158
    v_pk_max_f16 v132, v132, v44
    v_pk_max_f16 v133, v133, v45
    buffer_store_dwordx2 v[132:133], v86, s[56:59], 0 offen sc1
    v_cvt_pk_bf16_f32 v134, v147, v151
    v_cvt_pk_bf16_f32 v135, v155, v159
    v_pk_max_f16 v134, v134, v46
    v_pk_max_f16 v135, v135, v47
    buffer_store_dwordx2 v[134:135], v87, s[56:59], 0 offen sc1
L_END:
    s_endpgm
L_RT0:
    s_waitcnt vmcnt(0)
    s_add_u32 s100, s100, 1
    s_cmp_gt_u32 s100, 200000
    s_cbranch_scc1 L_END
    s_sleep 1
    buffer_load_dwordx4 v[128:131], v232, s[56:59], 0 offen sc1
    buffer_load_dwordx4 v[132:135], v232, s[56:59], s26 offen sc1
    buffer_load_dwordx4 v[136:139], v232, s[56:59], s27 offen sc1
    buffer_load_dwordx4 v[140:143], v232, s[56:59], s28 offen sc1
    s_waitcnt vmcnt(0)
    s_branch L_PW0
L_RT1:
    s_waitcnt vmcnt(0)
    s_add_u32 s100, s100, 1
    s_cmp_gt_u32 s100, 200000
    s_cbranch_scc1 L_END
    s_sleep 1
    buffer_load_dwordx4 v[132:135], v232, s[56:59], s26 offen sc1
    buffer_load_dwordx4 v[136:139], v232, s[56:59], s27 offen sc1
    buffer_load_dwordx4 v[140:143], v232, s[56:59], s28 offen sc1
    s_waitcnt vmcnt(0)
    s_branch L_PW1
L_RT2:
    s_waitcnt vmcnt(0)
    s_add_u32 s100, s100, 1
    s_cmp_gt_u32 s100, 200000
    s_cbranch_scc1 L_END
    s_sleep 1
    buffer_load_dwordx4 v[136:139], v232, s[56:59], s27 offen sc1
    buffer_load_dwordx4 v[140:143], v232, s[56:59], s28 offen sc1
    s_waitcnt vmcnt(0)
    s_branch L_PW2
L_RT3:
    s_waitcnt vmcnt(0)
    s_add_u32 s100, s100, 1
    s_cmp_gt_u32 s100, 200000
    s_cbranch_scc1 L_END
    s_sleep 1
    buffer_load_dwordx4 v[140:143], v232, s[56:59], s28 offen sc1
    s_waitcnt vmcnt(0)
    s_branch L_PW3
L_XT1:
    v_and_b32 v190, 0x1000000, v131
    v_cmp_ne_u32 s[70:71], 0, v190
    s_bcnt1_i32_b64 s10, s[70:71]
    s_lshl2_add_u32 s21, s10, s21
    v_and_b32 v190, 0x1000000, v135
    v_cmp_ne_u32 s[78:79], 0, v190
    s_bcnt1_i32_b64 s10, s[78:79]
    s_lshl2_add_u32 s21, s10, s21
    v_and_b32 v190, 0x1000000, v139
    v_cmp_ne_u32 s[86:87], 0, v190
    s_bcnt1_i32_b64 s10, s[86:87]
    s_lshl2_add_u32 s21, s10, s21
    v_and_b32 v190, 0x1000000, v143
    v_cmp_ne_u32 s[94:95], 0, v190
    s_bcnt1_i32_b64 s10, s[94:95]
    s_lshl2_add_u32 s21, s10, s21
    s_mov_b64 exec, s[70:71]
    s_cbranch_execz L_XLa0
    s_movk_i32 s10, 0
    buffer_load_dwordx4 v[64:67], v232, s[60:63], s10 offen sc1
L_XLa0:
    s_mov_b64 exec, s[78:79]
    s_cbranch_execz L_XLa1
    s_movk_i32 s10, 8192
    buffer_load_dwordx4 v[68:71], v232, s[60:63], s10 offen sc1
L_XLa1:
    s_mov_b64 exec, s[86:87]
    s_cbranch_execz L_XLa2
    s_movk_i32 s10, 16384
    buffer_load_dwordx4 v[72:75], v232, s[60:63], s10 offen sc1
L_XLa2:
    s_mov_b64 exec, s[94:95]
    s_cbranch_execz L_XLa3
    s_movk_i32 s10, 24576
    buffer_load_dwordx4 v[76:79], v232, s[60:63], s10 offen sc1
L_XLa3:
    s_mov_b64 exec, -1
    v_or3_b32 v190, v129, v133, v137
    v_or_b32 v190, v190, v141
    v_and_b32 v190, 0x10000, v190
    v_mov_b32 v191, 640
    v_cmpx_ne_u32 vcc, 0, v190
    ds_write_b32 v191, v184 offset:4
    s_mov_b64 exec, 1
    v_mov_b32 v190, s21
    ds_add_u32 v191, v190 offset:8
    s_mov_b64 exec, -1
    s_branch L_XT1R
L_XCN:
    s_sub_u32 s10, s12, 37888
    s_add_u32 s11, s10, s96
    v_mov_b32 v188, s11
    s_add_u32 s11, s10, s31
    s_add_u32 s11, s11, 1152
    v_mov_b32 v189, s11
    s_lshl_b32 s10, s4, 3
    v_mov_b32 v190, s10
    ds_write_b64 v190, v[188:189] offset:576
    s_branch L_XCNR
L_XT2:
    s_waitcnt vmcnt(0)
    s_mov_b64 s[34:35], 0
    v_cmp_ne_u32 vcc, s6, v65
    s_and_b64 vcc, vcc, s[70:71]
    s_or_b64 s[34:35], s[34:35], vcc
    v_cmp_ne_u32 vcc, s6, v69
    s_and_b64 vcc, vcc, s[78:79]
    s_or_b64 s[34:35], s[34:35], vcc
    v_cmp_ne_u32 vcc, s6, v73
    s_and_b64 vcc, vcc, s[86:87]
    s_or_b64 s[34:35], s[34:35], vcc
    v_cmp_ne_u32 vcc, s6, v77
    s_and_b64 vcc, vcc, s[94:95]
    s_or_b64 s[34:35], s[34:35], vcc
    s_cbranch_scc0 L_XT2A
    s_add_u32 s100, s100, 1
    s_cmp_gt_u32 s100, 200000
    s_cbranch_scc1 L_END
    s_sleep 1
    s_mov_b64 exec, s[70:71]
    s_cbranch_execz L_XLb0
    s_movk_i32 s10, 0
    buffer_load_dwordx4 v[64:67], v232, s[60:63], s10 offen sc1
L_XLb0:
    s_mov_b64 exec, s[78:79]
    s_cbranch_execz L_XLb1
    s_movk_i32 s10, 8192
    buffer_load_dwordx4 v[68:71], v232, s[60:63], s10 offen sc1
L_XLb1:
    s_mov_b64 exec, s[86:87]
    s_cbranch_execz L_XLb2
    s_movk_i32 s10, 16384
    buffer_load_dwordx4 v[72:75], v232, s[60:63], s10 offen sc1
L_XLb2:
    s_mov_b64 exec, s[94:95]
    s_cbranch_execz L_XLb3
    s_movk_i32 s10, 24576
    buffer_load_dwordx4 v[76:79], v232, s[60:63], s10 offen sc1
L_XLb3:
    s_mov_b64 exec, -1
    s_branch L_XT2
L_XT2A:
    s_cmp_eq_u32 s20, 0
    s_cbranch_scc1 L_XT2R
    s_mov_b64 exec, s[70:71]
    v_bfe_u32 v65, v64, 18, 8
    v_lshlrev_b32 v65, 2, v65
    v_add_u32 v67, 153728, v65
    ds_read_b32 v67, v67
    v_add_u32_sdwa v66, v66, v156 dst_sel:DWORD dst_unused:UNUSED_PAD src0_sel:BYTE_0 src1_sel:DWORD
    v_lshrrev_b32 v189, 28, v64
    v_lshl_add_u32 v66, v189, 8, v66
    v_and_b32 v189, 60, v65
    v_lshl_add_u32 v66, v189, 19, v66
    v_and_b32 v64, 0xffff, v64
    s_waitcnt lgkmcnt(0)
    ds_add_rtn_u32 v67, v67, v184 offset:576
    s_waitcnt lgkmcnt(0)
    ds_write2st64_b32 v67, v64, v66 offset0:148 offset1:220
    s_mov_b64 exec, s[78:79]
    v_bfe_u32 v69, v68, 18, 8
    v_lshlrev_b32 v69, 2, v69
    v_add_u32 v71, 153728, v69
    ds_read_b32 v71, v71
    v_add_u32_sdwa v70, v70, v157 dst_sel:DWORD dst_unused:UNUSED_PAD src0_sel:BYTE_0 src1_sel:DWORD
    v_lshrrev_b32 v189, 28, v68
    v_lshl_add_u32 v70, v189, 8, v70
    v_and_b32 v189, 60, v69
    v_lshl_add_u32 v70, v189, 19, v70
    v_and_b32 v68, 0xffff, v68
    s_waitcnt lgkmcnt(0)
    ds_add_rtn_u32 v71, v71, v184 offset:576
    s_waitcnt lgkmcnt(0)
    ds_write2st64_b32 v71, v68, v70 offset0:148 offset1:220
    s_mov_b64 exec, s[86:87]
    v_bfe_u32 v73, v72, 18, 8
    v_lshlrev_b32 v73, 2, v73
    v_add_u32 v75, 153728, v73
    ds_read_b32 v75, v75
    v_add_u32_sdwa v74, v74, v158 dst_sel:DWORD dst_unused:UNUSED_PAD src0_sel:BYTE_0 src1_sel:DWORD
    v_lshrrev_b32 v189, 28, v72
    v_lshl_add_u32 v74, v189, 8, v74
    v_and_b32 v189, 60, v73
    v_lshl_add_u32 v74, v189, 19, v74
    v_and_b32 v72, 0xffff, v72
    s_waitcnt lgkmcnt(0)
    ds_add_rtn_u32 v75, v75, v184 offset:576
    s_waitcnt lgkmcnt(0)
    ds_write2st64_b32 v75, v72, v74 offset0:148 offset1:220
    s_mov_b64 exec, s[94:95]
    v_bfe_u32 v77, v76, 18, 8
    v_lshlrev_b32 v77, 2, v77
    v_add_u32 v79, 153728, v77
    ds_read_b32 v79, v79
    v_add_u32_sdwa v78, v78, v159 dst_sel:DWORD dst_unused:UNUSED_PAD src0_sel:BYTE_0 src1_sel:DWORD
    v_lshrrev_b32 v189, 28, v76
    v_lshl_add_u32 v78, v189, 8, v78
    v_and_b32 v189, 60, v77
    v_lshl_add_u32 v78, v189, 19, v78
    v_and_b32 v76, 0xffff, v76
    s_waitcnt lgkmcnt(0)
    ds_add_rtn_u32 v79, v79, v184 offset:576
    s_waitcnt lgkmcnt(0)
    ds_write2st64_b32 v79, v76, v78 offset0:148 offset1:220
    s_mov_b64 exec, -1
    s_waitcnt lgkmcnt(0)
    s_branch L_XT2R
L_XT3:
    s_lshl_b32 s10, s4, 3
    v_mov_b32 v188, s10
    ds_read_b64 v[188:189], v188 offset:576
    s_waitcnt lgkmcnt(0)
    v_readfirstlane_b32 s34, v188
    v_readfirstlane_b32 s35, v189
    s_sub_u32 s10, s12, 37888
    s_sub_u32 s34, s34, s10
    s_sub_u32 s35, s35, s10
    s_sub_u32 s35, s35, 1152
    s_add_u32 s10, s34, 127
    s_lshr_b32 s10, s10, 7
    s_lshl1_add_u32 s10, s10, -1
    s_add_u32 s11, s35, 127
    s_lshr_b32 s11, s11, 6
    s_and_b32 s11, s11, -2
    s_max_i32 s17, s10, s11
    s_cselect_b32 s10, s34, s35
    s_sub_u32 s10, s10, 1
    s_andn2_b32 s99, 64, s10
    s_branch L_XT3R
L_OVF:
    s_mov_b32 s20, 0
    s_mov_b32 s17, 0
    s_mov_b32 s30, 0
    s_mov_b32 s19, 4
    s_waitcnt lgkmcnt(0)
    s_branch L_CA
L_PEXT:
    v_mov_b32 v65, s6
    s_mov_b32 s34, 8421376
    v_subrev_u32 v68, 792, v128
    v_cmpx_gt_u32 vcc, 264, v68
    s_cbranch_execz L_PE0
    v_mov_b32 v64, v104
    v_mov_b32 v66, v136
    v_bfe_u32 v68, v128, 5, 3
    v_lshlrev_b32 v68, 4, v68
    v_mad_u32_u24 v68, v112, s68, v68
    buffer_store_dwordx4 v[64:67], v68, s[56:59], s34 offen sc1
L_PE0:
    s_mov_b64 exec, -1
    v_subrev_u32 v68, 792, v129
    v_cmpx_gt_u32 vcc, 264, v68
    s_cbranch_execz L_PE1
    v_mov_b32 v64, v105
    v_mov_b32 v66, v137
    v_bfe_u32 v68, v129, 5, 3
    v_lshlrev_b32 v68, 4, v68
    v_mad_u32_u24 v68, v113, s68, v68
    buffer_store_dwordx4 v[64:67], v68, s[56:59], s34 offen sc1
L_PE1:
    s_mov_b64 exec, -1
    v_subrev_u32 v68, 792, v130
    v_cmpx_gt_u32 vcc, 264, v68
    s_cbranch_execz L_PE2
    v_mov_b32 v64, v106
    v_mov_b32 v66, v138
    v_bfe_u32 v68, v130, 5, 3
    v_lshlrev_b32 v68, 4, v68
    v_mad_u32_u24 v68, v114, s68, v68
    buffer_store_dwordx4 v[64:67], v68, s[56:59], s34 offen sc1
L_PE2:
    s_mov_b64 exec, -1
    v_subrev_u32 v68, 792, v131
    v_cmpx_gt_u32 vcc, 264, v68
    s_cbranch_execz L_PE3
    v_mov_b32 v64, v107
    v_mov_b32 v66, v139
    v_bfe_u32 v68, v131, 5, 3
    v_lshlrev_b32 v68, 4, v68
    v_mad_u32_u24 v68, v115, s68, v68
    buffer_store_dwordx4 v[64:67], v68, s[56:59], s34 offen sc1
L_PE3:
    s_mov_b64 exec, -1
    v_subrev_u32 v68, 792, v132
    v_cmpx_gt_u32 vcc, 264, v68
    s_cbranch_execz L_PE4
    v_mov_b32 v64, v108
    v_mov_b32 v66, v136
    v_bfe_u32 v68, v132, 5, 3
    v_lshlrev_b32 v68, 4, v68
    v_mad_u32_u24 v68, v116, s68, v68
    buffer_store_dwordx4 v[64:67], v68, s[56:59], s34 offen sc1
L_PE4:
    s_mov_b64 exec, -1
    v_subrev_u32 v68, 792, v133
    v_cmpx_gt_u32 vcc, 264, v68
    s_cbranch_execz L_PE5
    v_mov_b32 v64, v109
    v_mov_b32 v66, v137
    v_bfe_u32 v68, v133, 5, 3
    v_lshlrev_b32 v68, 4, v68
    v_mad_u32_u24 v68, v117, s68, v68
    buffer_store_dwordx4 v[64:67], v68, s[56:59], s34 offen sc1
L_PE5:
    s_mov_b64 exec, -1
    v_subrev_u32 v68, 792, v134
    v_cmpx_gt_u32 vcc, 264, v68
    s_cbranch_execz L_PE6
    v_mov_b32 v64, v110
    v_mov_b32 v66, v138
    v_bfe_u32 v68, v134, 5, 3
    v_lshlrev_b32 v68, 4, v68
    v_mad_u32_u24 v68, v118, s68, v68
    buffer_store_dwordx4 v[64:67], v68, s[56:59], s34 offen sc1
L_PE6:
    s_mov_b64 exec, -1
    v_subrev_u32 v68, 792, v135
    v_cmpx_gt_u32 vcc, 264, v68
    s_cbranch_execz L_PE7
    v_mov_b32 v64, v111
    v_mov_b32 v66, v139
    v_bfe_u32 v68, v135, 5, 3
    v_lshlrev_b32 v68, 4, v68
    v_mad_u32_u24 v68, v119, s68, v68
    buffer_store_dwordx4 v[64:67], v68, s[56:59], s34 offen sc1
L_PE7:
    s_mov_b64 exec, -1
    s_branch L_PEXTR
L_POVF:
    s_movk_i32 s11, 1986
    v_mul_u32_u24 v64, s11, v192
    v_lshrrev_b32 v64, 16, v64
    v_mul_u32_u24 v65, s11, v193
    v_lshrrev_b32 v65, 16, v65
    v_mul_u32_u24 v66, s11, v194
    v_lshrrev_b32 v66, 16, v66
    v_mul_u32_u24 v67, s11, v195
    v_lshrrev_b32 v67, 16, v67
    v_add_u32 v69, v64, v65
    v_add_u32 v70, v69, v66
    v_add_u32 v71, v70, v67
    v_mov_b32 v72, v71
    s_nop 1
    v_add_u32_dpp v72, v72, v72 row_shr:1 row_mask:0xf bank_mask:0xf bound_ctrl:0
    s_nop 1
    v_add_u32_dpp v72, v72, v72 row_shr:2 row_mask:0xf bank_mask:0xf bound_ctrl:0
    s_nop 1
    v_add_u32_dpp v72, v72, v72 row_shr:4 row_mask:0xf bank_mask:0xf bound_ctrl:0
    s_nop 1
    v_add_u32_dpp v72, v72, v72 row_shr:8 row_mask:0xf bank_mask:0xf bound_ctrl:0
    s_nop 1
    v_add_u32_dpp v72, v72, v72 row_bcast:15 row_mask:0xa bank_mask:0xf
    s_nop 1
    v_add_u32_dpp v72, v72, v72 row_bcast:31 row_mask:0xc bank_mask:0xf
    s_nop 0
    v_sub_u32 v68, v72, v71
    v_add_u32 v71, v68, v70
    v_add_u32 v70, v68, v69
    v_add_u32 v69, v68, v64
    v_lshl_or_b32 v68, v64, 16, v68
    v_lshl_or_b32 v69, v65, 16, v69
    v_lshl_or_b32 v70, v66, 16, v70
    v_lshl_or_b32 v71, v67, 16, v71
    v_add_u32 v72, 154752, v185
    ds_write_b128 v72, v[68:71]
    s_lshl_b32 s10, s2, 10
    s_add_u32 s10, s10, 24772608
    buffer_store_dwordx4 v[68:71], v185, s[52:55], s10 offen sc1
    v_and_b32 v74, 0x3fc, v120
    v_add_u32 v74, 154752, v74
    ds_read_u16 v74, v74
    v_and_b32 v75, 0x3fc, v121
    v_add_u32 v75, 154752, v75
    ds_read_u16 v75, v75
    v_and_b32 v76, 0x3fc, v122
    v_add_u32 v76, 154752, v76
    ds_read_u16 v76, v76
    v_and_b32 v77, 0x3fc, v123
    v_add_u32 v77, 154752, v77
    ds_read_u16 v77, v77
    v_and_b32 v78, 0x3fc, v124
    v_add_u32 v78, 154752, v78
    ds_read_u16 v78, v78
    v_and_b32 v79, 0x3fc, v125
    v_add_u32 v79, 154752, v79
    ds_read_u16 v79, v79
    v_and_b32 v80, 0x3fc, v126
    v_add_u32 v80, 154752, v80
    ds_read_u16 v80, v80
    v_and_b32 v81, 0x3fc, v127
    v_add_u32 v81, 154752, v81
    ds_read_u16 v81, v81
    s_waitcnt lgkmcnt(0)
    v_cmpx_lt_u32 vcc, 1056, v228
    v_or_b32 v205, 0x10000, v205
    s_mov_b64 exec, -1
    v_cmpx_lt_u32 vcc, 1056, v229
    v_or_b32 v209, 0x10000, v209
    s_mov_b64 exec, -1
    v_cmpx_lt_u32 vcc, 1056, v230
    v_or_b32 v213, 0x10000, v213
    s_mov_b64 exec, -1
    v_cmpx_lt_u32 vcc, 1056, v231
    v_or_b32 v217, 0x10000, v217
    s_mov_b64 exec, -1
    s_mul_i32 s10, s2, 4152
    s_mov_b32 s34, 18874368
    s_mov_b32 s35, 23592960
    v_mul_u32_u24 v64, s11, v128
    v_lshrrev_b32 v64, 16, v64
    v_add3_u32 v64, v64, v74, s10
    v_lshlrev_b32 v65, 2, v64
    v_cmpx_le_u32 vcc, 1056, v128
    s_cbranch_execz L_PO0
    buffer_store_byte v136, v64, s[52:55], s35 offen sc1
    buffer_store_dword v104, v65, s[52:55], s34 offen sc1
L_PO0:
    s_mov_b64 exec, -1
    v_mul_u32_u24 v64, s11, v129
    v_lshrrev_b32 v64, 16, v64
    v_add3_u32 v64, v64, v75, s10
    v_lshlrev_b32 v65, 2, v64
    v_cmpx_le_u32 vcc, 1056, v129
    s_cbranch_execz L_PO1
    buffer_store_byte v137, v64, s[52:55], s35 offen sc1
    buffer_store_dword v105, v65, s[52:55], s34 offen sc1
L_PO1:
    s_mov_b64 exec, -1
    v_mul_u32_u24 v64, s11, v130
    v_lshrrev_b32 v64, 16, v64
    v_add3_u32 v64, v64, v76, s10
    v_lshlrev_b32 v65, 2, v64
    v_cmpx_le_u32 vcc, 1056, v130
    s_cbranch_execz L_PO2
    buffer_store_byte v138, v64, s[52:55], s35 offen sc1
    buffer_store_dword v106, v65, s[52:55], s34 offen sc1
L_PO2:
    s_mov_b64 exec, -1
    v_mul_u32_u24 v64, s11, v131
    v_lshrrev_b32 v64, 16, v64
    v_add3_u32 v64, v64, v77, s10
    v_lshlrev_b32 v65, 2, v64
    v_cmpx_le_u32 vcc, 1056, v131
    s_cbranch_execz L_PO3
    buffer_store_byte v139, v64, s[52:55], s35 offen sc1
    buffer_store_dword v107, v65, s[52:55], s34 offen sc1
L_PO3:
    s_mov_b64 exec, -1
    v_mul_u32_u24 v64, s11, v132
    v_lshrrev_b32 v64, 16, v64
    v_add3_u32 v64, v64, v78, s10
    v_lshlrev_b32 v65, 2, v64
    v_cmpx_le_u32 vcc, 1056, v132
    s_cbranch_execz L_PO4
    buffer_store_byte v136, v64, s[52:55], s35 offen sc1
    buffer_store_dword v108, v65, s[52:55], s34 offen sc1
L_PO4:
    s_mov_b64 exec, -1
    v_mul_u32_u24 v64, s11, v133
    v_lshrrev_b32 v64, 16, v64
    v_add3_u32 v64, v64, v79, s10
    v_lshlrev_b32 v65, 2, v64
    v_cmpx_le_u32 vcc, 1056, v133
    s_cbranch_execz L_PO5
    buffer_store_byte v137, v64, s[52:55], s35 offen sc1
    buffer_store_dword v109, v65, s[52:55], s34 offen sc1
L_PO5:
    s_mov_b64 exec, -1
    v_mul_u32_u24 v64, s11, v134
    v_lshrrev_b32 v64, 16, v64
    v_add3_u32 v64, v64, v80, s10
    v_lshlrev_b32 v65, 2, v64
    v_cmpx_le_u32 vcc, 1056, v134
    s_cbranch_execz L_PO6
    buffer_store_byte v138, v64, s[52:55], s35 offen sc1
    buffer_store_dword v110, v65, s[52:55], s34 offen sc1
L_PO6:
    s_mov_b64 exec, -1
    v_mul_u32_u24 v64, s11, v135
    v_lshrrev_b32 v64, 16, v64
    v_add3_u32 v64, v64, v81, s10
    v_lshlrev_b32 v65, 2, v64
    v_cmpx_le_u32 vcc, 1056, v135
    s_cbranch_execz L_PO7
    buffer_store_byte v139, v64, s[52:55], s35 offen sc1
    buffer_store_dword v111, v65, s[52:55], s34 offen sc1
L_PO7:
    s_mov_b64 exec, -1
    s_waitcnt vmcnt(0) lgkmcnt(0)
    s_barrier
    s_branch L_POUT
L_SLOW:
    s_setprio 0
    s_lshl_b32 s10, s3, 6
    v_add_u32 v255, s10, v253
    s_cmp_lg_u32 s19, 4
    s_cbranch_scc1 L_SL1
    s_mov_b32 s19, 1
    v_and_b32 v188, 0xff, v255
    v_lshlrev_b32 v189, 7, v188
    buffer_load_dword v190, v189, s[56:59], 0 offen offset:4 sc1
    v_lshlrev_b32 v189, 10, v188
    s_lshl_b32 s10, s5, 2
    s_add_u32 s10, s10, 24772608
    buffer_load_dword v191, v189, s[52:55], s10 offen sc1
    v_lshlrev_b32 v188, 2, v188
    v_add_u32 v188, 154752, v188
    s_waitcnt vmcnt(0)
    v_and_b32 v190, 0x10000, v190
    v_cmp_ne_u32 vcc, 0, v190
    v_mov_b32 v190, 2097152
    s_nop 0
    v_cndmask_b32 v190, v190, v191, vcc
    ds_write_b32 v188, v190
    s_waitcnt lgkmcnt(0)
    s_barrier
L_SL1:
    s_add_u32 s28, s28, 288
    s_cmp_lt_u32 s28, s29
    s_cbranch_scc1 L_BATCH
L_FIND:
    s_cmp_lg_u64 s[32:33], 0
    s_cbranch_scc1 L_GOT
    s_add_u32 s26, s26, 1
    s_cmp_ge_u32 s26, 4
    s_cbranch_scc1 L_EPI
    s_lshl_b32 s10, s26, 8
    s_add_u32 s10, s10, 154752
    v_lshl_add_u32 v188, v253, 2, s10
    ds_read_u16 v188, v188 offset:2
    s_waitcnt lgkmcnt(0)
    v_cmp_lt_u32 s[32:33], s20, v188
    s_nop 3
    s_branch L_FIND
L_GOT:
    s_ff1_i32_b64 s10, s[32:33]
    s_bitset0_b64 s[32:33], s10
    s_lshl_b32 s11, s26, 6
    s_add_u32 s27, s10, s11
    s_lshl_b32 s10, s27, 2
    s_add_u32 s10, s10, 154752
    v_mov_b32 v188, s10
    ds_read_b32 v188, v188
    s_waitcnt lgkmcnt(0)
    v_readfirstlane_b32 s10, v188
    s_nop 3
    s_lshr_b32 s29, s10, 16
    s_and_b32 s30, s10, 0xffff
    s_mov_b32 s28, s20
L_BATCH:
    s_waitcnt vmcnt(0)
    s_barrier
    v_mov_b64 v[192:193], 0
    v_mov_b64 v[194:195], 0
    v_mov_b32 v196, 0x20fffff
    v_mov_b32 v197, 0x20fffff
    v_mov_b32 v198, 0x20fffff
    v_mov_b32 v199, 0x20fffff
    v_lshl_add_u32 v200, v253, 4, s12
    ds_write_b128 v200, v[192:195] offset:0
    ds_write_b128 v200, v[196:199] offset:18432
    ds_write_b128 v200, v[192:195] offset:1024
    ds_write_b128 v200, v[196:199] offset:19456
    ds_write_b128 v200, v[192:195] offset:1280
    ds_write_b128 v200, v[196:199] offset:19712
    v_and_b32 v188, 15, v253
    v_mul_u32_u24 v189, 1152, v188
    v_add_u32 v189, 8192, v189
    v_lshlrev_b32 v188, 2, v188
    ds_write_b32 v188, v189 offset:576
    v_add_u32 v188, s28, v255
    s_mul_i32 s36, s27, 3128
    s_mul_i32 s11, s27, 4152
    s_add_u32 s11, s11, s30
    s_lshl_b32 s34, s11, 2
    s_add_u32 s34, s34, 18874368
    v_lshl_add_u32 v190, v188, 2, s34
    s_add_u32 s34, s11, 23592960
    v_add_u32 v191, s34, v188
    s_mul_i32 s10, s5, 32896
    s_lshl_b32 s34, s27, 7
    s_add_u32 s10, s10, s34
    s_add_u32 s10, s10, 65536
    v_and_b32 v206, 7, v188
    v_lshl_add_u32 v206, v206, 4, s10
    v_lshrrev_b32 v207, 3, v188
    v_cmpx_gt_u32 vcc, 32, v188
    v_add_u32 v190, 8421376, v206
    v_add_u32 v191, 8, v190
    v_cmpx_gt_u32 vcc, 24, v188
    v_lshl_add_u32 v190, v207, 2, v206
    v_add3_u32 v191, v206, v207, 12
    s_mov_b64 exec, -1
    s_add_u32 s10, s28, 288
    s_min_u32 s10, s10, s29
    v_cmp_gt_u32 vcc, s10, v188
    v_mov_b32 v206, 0x7ffffff0
    s_nop 0
    v_cndmask_b32 v190, v206, v190, vcc
    v_cndmask_b32 v191, v206, v191, vcc
    buffer_load_dwordx2 v[204:205], v190, s[52:55], 0 offen sc1
    buffer_load_ubyte v191, v191, s[52:55], 0 offen sc1
    s_waitcnt lgkmcnt(0)
    s_barrier
    s_waitcnt vmcnt(0)
    v_cmp_ne_u32 vcc, 3, v207
    v_cmp_eq_u32 s[10:11], s6, v205
    v_mov_b32 v206, s36
    s_or_b64 exec, vcc, s[10:11]
    v_cmpx_ne_u32 vcc, 0, v204
    v_bfe_u32 v190, v204, 18, 8
    v_lshlrev_b32 v190, 2, v190
    v_add_u32 v188, 153728, v190
    ds_read_b32 v188, v188
    v_add_u32_sdwa v191, v191, v206 dst_sel:DWORD dst_unused:UNUSED_PAD src0_sel:BYTE_0 src1_sel:DWORD
    v_lshrrev_b32 v189, 28, v204
    v_lshl_add_u32 v191, v189, 8, v191
    v_and_b32 v189, 60, v190
    v_lshl_add_u32 v191, v189, 19, v191
    v_mov_b32 v190, 4
    v_and_b32 v204, 0xffff, v204
    s_waitcnt lgkmcnt(0)
    ds_add_rtn_u32 v188, v188, v190 offset:576
    s_waitcnt lgkmcnt(0)
    ds_write2st64_b32 v188, v204, v191 offset0:148 offset1:220
    s_mov_b64 exec, -1
    s_waitcnt lgkmcnt(0)
    s_barrier
    v_lshrrev_b32 v190, 3, v253
    v_lshl_add_u32 v247, v190, 4, s12
    s_add_u32 s10, s12, 18432
    v_lshrrev_b32 v190, 1, v253
    v_lshl_add_u32 v248, v190, 2, s10
    s_add_u32 s10, s10, 2
    v_and_b32 v190, 48, v253
    v_lshl_add_u32 v250, v190, 1, s10
    v_and_b32 v190, 12, v253
    v_add_u32 v250, v250, v190
    v_lshrrev_b32 v190, 5, v253
    v_mul_u32_u24 v249, 18432, v190
    v_and_b32 v190, 15, v253
    v_lshl_add_u32 v249, v190, 2, v249
    s_add_u32 s10, s12, 2
    v_add_u32 v249, s10, v249
    ds_read_b128 v[236:239], v247
    ds_read_b32 v240, v248
    s_lshl_b32 s10, s4, 3
    v_mov_b32 v190, s10
    ds_read_b64 v[190:191], v190 offset:576
    s_waitcnt lgkmcnt(0)
    v_readfirstlane_b32 s34, v190
    v_readfirstlane_b32 s35, v191
    s_sub_u32 s10, s12, 37888
    s_sub_u32 s34, s34, s10
    s_sub_u32 s35, s35, s10
    s_sub_u32 s35, s35, 1152
    s_add_u32 s10, s34, 127
    s_lshr_b32 s10, s10, 7
    s_lshl1_add_u32 s10, s10, -1
    s_add_u32 s11, s35, 127
    s_lshr_b32 s11, s11, 6
    s_and_b32 s11, s11, -2
    s_max_i32 s17, s10, s11
    s_cselect_b32 s10, s34, s35
    s_sub_u32 s10, s10, 1
    s_andn2_b32 s99, 64, s10
    s_add_u32 m0, s13, 0
    v_mad_u32_u16 v236, v236, s15, v243
    buffer_load_dwordx4 v236, s[40:43], 0 offen lds
    s_add_u32 m0, s13, 1056
    v_mad_u32_u16 v237, v237, s15, v243
    buffer_load_dwordx4 v237, s[40:43], 0 offen lds
    s_add_u32 m0, s13, 2112
    v_mad_u32_u16 v238, v238, s15, v243
    buffer_load_dwordx4 v238, s[40:43], 0 offen lds
    s_add_u32 m0, s13, 3168
    v_mad_u32_u16 v239, v239, s15, v243
    buffer_load_dwordx4 v239, s[40:43], 0 offen lds
    s_mov_b32 m0, s14
    v_and_b32 v240, 0xfffff, v240
    buffer_load_dwordx4 v[240:241], s[44:47], 0 idxen offen lds
L_LAST:
    s_branch L_GO
.section .rodata,"a"
.p2align 6
.amdhsa_kernel standalone__edge_featured_mpnn_gatedgcn__graph_kernel
  .amdhsa_next_free_vgpr 256
  .amdhsa_next_free_sgpr 102
  .amdhsa_accum_offset 256
  .amdhsa_group_segment_fixed_size 0
  .amdhsa_kernarg_size 96
  .amdhsa_user_sgpr_count 2
  .amdhsa_user_sgpr_kernarg_segment_ptr 1
  .amdhsa_system_sgpr_workgroup_id_x 1
.end_amdhsa_kernel
```

```asm
; @launch grid=(256,1,1) block=(512,1,1) lds=156800
.amdgcn_target "amdgcn-amd-amdhsa--gfx950"
.text
.globl standalone__edge_featured_mpnn_gatedgcn__graph_kernel
.p2align 8
.type standalone__edge_featured_mpnn_gatedgcn__graph_kernel,@function
standalone__edge_featured_mpnn_gatedgcn__graph_kernel:
    s_load_dwordx16 s[16:31], s[0:1], 0
    s_load_dwordx8 s[32:39], s[0:1], 64
    s_getpc_b64 s[64:65]
L_PC:
    s_and_b32 s3, s2, -8
    v_add_lshl_u32 v1, v0, s3, 7
    v_min_u32 v1, L_LAST-L_PC, v1
    v_cmpx_gt_u32 vcc, 8, v0
    s_cbranch_execz L_NOCPF
    global_load_dword v251, v1, s[64:65]
L_NOCPF:
    s_mov_b64 exec, -1
    s_cmp_ge_u32 s2, 256
    s_cbranch_scc1 L_END
    s_mul_i32 s10, s2, 12512
    v_lshl_add_u32 v1, v0, 4, s10
    s_add_u32 s11, s10, 12512
    s_min_u32 s11, s11, 3200000
    v_add_u32 v2, 0x2000, v1
    s_waitcnt lgkmcnt(0)
    global_load_dwordx4 v[96:99], v1, s[22:23] nt
    global_load_dwordx4 v[104:107], v1, s[20:21] nt
    v_cmpx_gt_u32 s[70:71], s11, v2
    s_cbranch_execz L_NO7
    global_load_dwordx4 v[100:103], v2, s[22:23] nt
    global_load_dwordx4 v[108:111], v2, s[20:21] nt
L_NO7:
    s_mov_b64 exec, -1
    s_load_dword s6, s[38:39], 0
    v_mov_b32 v255, v0
    v_lshrrev_b32 v188, 6, v0
    v_and_b32 v253, 63, v0
    v_readfirstlane_b32 s3, v188
    v_lshlrev_b32 v232, 4, v0
    v_lshlrev_b32 v190, 3, v0
    v_lshlrev_b32 v191, 2, v0
    v_and_b32 v192, 0x3fc, v191
    s_and_b32 s5, s2, 7
    s_lshr_b32 s4, s2, 3
    s_lshl_b32 s5, s5, 5
    s_add_u32 s5, s5, s4
    s_mul_i32 s9, s5, 196
    s_cmp_eq_u32 s3, 7
    s_cselect_b32 s101, 0, s3
    s_lshl_b32 s12, s101, 5
    s_add_u32 s9, s9, s12
    v_lshrrev_b32 v193, 3, v253
    v_lshl_add_u32 v193, v193, 2, s9
    v_and_b32 v243, 7, v253
    v_lshlrev_b32 v243, 4, v243
    v_lshl_add_u32 v234, v193, 7, v243
    s_lshl_b32 s101, s101, 10
    s_add_u32 s101, s101, 116736
    v_mov_b64 v[196:197], 0
    v_mov_b64 v[198:199], 0
    v_mov_b32 v194, 132
    ds_write2st64_b32 v192, v194, v196 offset0:20 offset1:24
    v_add_u32 v193, 46080, v232
    ds_write_b128 v193, v[196:199] offset:0
    ds_write_b128 v193, v[196:199] offset:8192
    ds_write_b128 v193, v[196:199] offset:16384
    ds_write_b128 v193, v[196:199] offset:24576
    ds_write_b128 v193, v[196:199] offset:32768
    s_mov_b32 s44, s18
    s_or_b32 s45, s19, 0x200000
    s_mov_b32 s46, 800000
    s_mov_b32 s47, 0x20000
    s_mov_b32 s48, s34
    s_mov_b32 s49, s35
    s_mov_b32 s50, 6400000
    s_mov_b32 s51, 0x20000
    s_mov_b32 s40, s16
    s_mov_b32 s41, s17
    s_mov_b32 s42, 6400000
    s_mov_b32 s43, 0x20000
    s_mov_b32 s52, s38
    s_mov_b32 s53, s39
    s_mov_b32 s54, 25165824
    s_mov_b32 s55, 0x20000
    s_lshl_b32 s12, s2, 7
    s_add_u32 s12, s12, 65536
    s_add_u32 s56, s38, s12
    s_addc_u32 s57, s39, 0
    s_mov_b32 s58, 16809984
    s_mov_b32 s59, 0x20000
    s_mov_b32 s64, 85599
    s_mov_b32 s65, 4294967100
    s_movk_i32 s66, 5368
    s_mov_b32 s67, 0xc000000
    s_mov_b32 s68, 32896
    v_add_u32 v136, 0, v191
    v_add_u32 v137, 1, v191
    v_add_u32 v138, 2, v191
    v_add_u32 v139, 3, v191
    s_lshl_b32 s10, s3, 28
    s_or_b32 s10, s10, 0x20000
    v_mov_b32 v140, s10
    v_or_b32 v141, 0x80000000, v140
    v_mov_b32 v184, 33
    v_mov_b32 v142, 0x400
    s_and_b32 s10, s3, 3
    s_lshr_b32 s4, s3, 2
    s_lshl1_add_u32 s4, s10, s4
    s_xor_b32 s4, s4, 1
    s_mul_i32 s10, s4, 49
    s_sub_i32 s10, s10, 6
    s_ashr_i32 s10, s10, 1
    s_max_i32 s7, s10, 0
    s_mul_i32 s13, s4, 4224
    s_add_u32 s13, s13, 82944
    s_lshl_b32 s14, s4, 10
    s_add_u32 s14, s14, 5120
    s_mul_i32 s12, s4, 2304
    s_add_u32 s12, s12, 46080
    s_movk_i32 s15, 128
    v_bfe_u32 v194, v255, 4, 4
    v_and_b32 v195, 7, v255
    v_cmp_eq_u32 vcc, v194, v195
    v_and_b32 v194, 8, v255
    v_lshlrev_b32 v194, 1, v194
    v_mov_b32 v196, 0x3f80
    v_lshlrev_b32 v196, v194, v196
    v_cndmask_b32 v196, 0, v196, vcc
    ds_write_b32 v192, v196 offset:0
    v_mov_b64 v[196:197], 0
    ds_write_b64 v190, v[196:197] offset:1024
    v_add_u32 v194, 155776, v192
    ds_write_b32 v194, v196
    v_lshrrev_b32 v223, 3, v255
    v_mad_u32_u24 v220, v223, s68, v243
    v_mul_u32_u24 v224, 160, v223
    v_add_u32 v221, v224, v243
    v_add_u32 v221, 46080, v221
    v_bfe_u32 v194, v255, 5, 1
    v_bfe_u32 v196, v255, 6, 1
    v_sub_u32 v194, v194, v196
    v_mul_i32_i24 v194, 640, v194
    v_add_u32 v224, v224, v194
    v_lshl_add_u32 v224, v195, 2, v224
    v_add_u32 v224, 13312, v224
    v_lshlrev_b32 v185, 4, v253
    v_and_b32 v241, 1, v253
    v_lshlrev_b32 v241, 4, v241
    s_bitcmp1_b32 s4, 0
    s_cselect_b32 s10, 1, -1
    s_lshl_b32 s10, s10, 24
    s_or_b32 s10, s10, 0xdddd
    v_mov_b32 v242, s10
    v_and_b32 v245, 16, v253
    v_and_b32 v194, 15, v253
    v_lshl_add_u32 v194, v194, 5, s14
    s_mov_b32 exec_hi, 0
    v_add_u32 v245, v245, v194
    s_mov_b32 exec_hi, -1
    v_and_b32 v194, 3, v253
    v_lshlrev_b32 v246, 3, v194
    v_bfe_u32 v196, v253, 2, 2
    v_and_b32 v197, 48, v253
    v_lshl_add_u32 v198, v196, 7, v197
    v_mul_u32_u24 v244, 1056, v194
    v_add3_u32 v244, v244, v198, s13
    v_bfe_u32 v197, v253, 2, 3
    v_lshrrev_b32 v196, 5, v253
    v_lshl_add_u32 v197, v196, 4, v197
    v_mul_u32_u24 v225, 160, v197
    v_add_u32 v225, v225, v246
    v_lshrrev_b32 v194, 3, v253
    v_lshl_add_u32 v247, v194, 4, s12
    s_add_u32 s10, s12, 18432
    v_lshrrev_b32 v194, 1, v253
    v_lshl_add_u32 v248, v194, 2, s10
    s_add_u32 s10, s10, 2
    v_and_b32 v194, 48, v253
    v_lshl_add_u32 v250, v194, 1, s10
    v_and_b32 v194, 12, v253
    v_add_u32 v250, v250, v194
    v_lshrrev_b32 v194, 5, v253
    v_mul_u32_u24 v249, 18432, v194
    v_and_b32 v194, 15, v253
    v_lshl_add_u32 v249, v194, 2, v249
    s_add_u32 s10, s12, 2
    v_add_u32 v249, s10, v249
    s_movk_i32 s69, 11520
    v_mov_b64 v[132:133], 0
    v_mov_b64 v[134:135], 0
    s_waitcnt lgkmcnt(0)
    s_barrier
    s_add_u32 s6, s6, 0x2020202
    v_lshlrev_b32 v186, v246, s6
    v_and_b32 v194, 4, v253
    v_mul_u32_u24 v194, 1212416, v194
    v_lshl_add_u32 v186, v194, 8, v186
    v_and_b32 v186, 0xfe000000, v186
    v_and_b32 v187, 7, v253
    v_mul_u32_u24 v187, 33, v187
    v_add_u32 v187, 792, v187
    v_lshlrev_b32 v222, 2, v223
    s_cmp_eq_u64 s[70:71], 0
    s_cbranch_scc1 L_R4
    s_waitcnt vmcnt(3)
    v_mul_u32_u24 v112, s64, v96
    v_mul_u32_u24 v113, s64, v97
    v_mul_u32_u24 v114, s64, v98
    v_mul_u32_u24 v115, s64, v99
    v_lshrrev_b32 v120, 29, v112
    v_lshrrev_b32 v121, 29, v113
    v_lshrrev_b32 v122, 29, v114
    v_lshrrev_b32 v123, 29, v115
    v_cmp_eq_u32 s[72:73], v120, v121
    v_cmp_eq_u32 s[76:77], v122, v123
    v_cmp_eq_u32 vcc, v120, v122
    v_cmp_eq_u32 s[88:89], v121, v123
    v_cmp_eq_u32 s[90:91], v120, v123
    v_cmp_eq_u32 s[10:11], v121, v122
    v_lshrrev_b32 v112, 24, v112
    v_lshrrev_b32 v113, 24, v113
    v_lshrrev_b32 v114, 24, v114
    v_lshrrev_b32 v115, 24, v115
    s_or_b64 s[74:75], s[72:73], s[88:89]
    s_or_b64 s[78:79], s[76:77], s[88:89]
    s_or_b64 s[72:73], s[72:73], vcc
    s_or_b64 s[76:77], s[76:77], vcc
    s_or_b64 s[72:73], s[72:73], s[90:91]
    s_or_b64 s[74:75], s[74:75], s[10:11]
    s_or_b64 s[76:77], s[76:77], s[10:11]
    s_or_b64 s[78:79], s[78:79], s[90:91]
    v_cndmask_b32 v120, 0, v142, s[72:73]
    v_lshl_add_u32 v120, v112, 2, v120
    ds_add_rtn_u32 v128, v120, v184 offset:5120
    v_cndmask_b32 v121, 0, v142, s[74:75]
    v_lshl_add_u32 v121, v113, 2, v121
    ds_add_rtn_u32 v129, v121, v184 offset:5120
    v_cndmask_b32 v122, 0, v142, s[76:77]
    v_lshl_add_u32 v122, v114, 2, v122
    ds_add_rtn_u32 v130, v122, v184 offset:5120
    v_cndmask_b32 v123, 0, v142, s[78:79]
    v_lshl_add_u32 v123, v115, 2, v123
    ds_add_rtn_u32 v131, v123, v184 offset:5120
    s_waitcnt vmcnt(1)
    s_mov_b64 exec, s[70:71]
    v_mul_u32_u24 v116, s64, v100
    v_mul_u32_u24 v117, s64, v101
    v_mul_u32_u24 v118, s64, v102
    v_mul_u32_u24 v119, s64, v103
    v_lshrrev_b32 v116, 24, v116
    v_lshrrev_b32 v117, 24, v117
    v_lshrrev_b32 v118, 24, v118
    v_lshrrev_b32 v119, 24, v119
    v_lshlrev_b32 v124, 2, v116
    ds_add_rtn_u32 v132, v124, v184 offset:5120
    v_lshlrev_b32 v125, 2, v117
    ds_add_rtn_u32 v133, v125, v184 offset:5120
    v_lshlrev_b32 v126, 2, v118
    ds_add_rtn_u32 v134, v126, v184 offset:5120
    v_lshlrev_b32 v127, 2, v119
    ds_add_rtn_u32 v135, v127, v184 offset:5120
    s_waitcnt lgkmcnt(7)
    s_mov_b64 exec, s[72:73]
    v_cmpx_le_u32 vcc, 132, v128
    ds_add_rtn_u32 v128, v120, v184 offset:4096
    s_waitcnt lgkmcnt(7)
    s_mov_b64 exec, s[74:75]
    v_cmpx_le_u32 vcc, 132, v129
    ds_add_rtn_u32 v129, v121, v184 offset:4096
    s_waitcnt lgkmcnt(7)
    s_mov_b64 exec, s[76:77]
    v_cmpx_le_u32 vcc, 132, v130
    ds_add_rtn_u32 v130, v122, v184 offset:4096
    s_waitcnt lgkmcnt(7)
    s_mov_b64 exec, s[78:79]
    v_cmpx_le_u32 vcc, 132, v131
    ds_add_rtn_u32 v131, v123, v184 offset:4096
    s_mov_b64 exec, s[70:71]
    s_waitcnt vmcnt(0)
    v_mad_i32_i24 v100, v116, s65, v100
    v_mul_u32_u24 v194, s66, v108
    v_lshl_or_b32 v108, v100, 18, v108
    v_and_or_b32 v194, v194, s67, v141
    v_mad_u32_u24 v100, v116, 40, s69
    v_or_b32 v108, v108, v194
    v_mad_i32_i24 v101, v117, s65, v101
    v_mul_u32_u24 v194, s66, v109
    v_lshl_or_b32 v109, v101, 18, v109
    v_and_or_b32 v194, v194, s67, v141
    v_mad_u32_u24 v101, v117, 40, s69
    v_or_b32 v109, v109, v194
    v_mad_i32_i24 v102, v118, s65, v102
    v_mul_u32_u24 v194, s66, v110
    v_lshl_or_b32 v110, v102, 18, v110
    v_and_or_b32 v194, v194, s67, v141
    v_mad_u32_u24 v102, v118, 40, s69
    v_or_b32 v110, v110, v194
    v_mad_i32_i24 v103, v119, s65, v103
    v_mul_u32_u24 v194, s66, v111
    v_lshl_or_b32 v111, v103, 18, v111
    v_and_or_b32 v194, v194, s67, v141
    v_mad_u32_u24 v103, v119, 40, s69
    v_or_b32 v111, v111, v194
    s_waitcnt lgkmcnt(7)
    v_bfe_u32 v194, v132, 3, 5
    v_add_lshl_u32 v100, v194, v100, 2
    v_and_b32 v194, 3, v194
    v_mad_i32_i24 v194, v194, -3, v100
    v_cmpx_gt_u32 vcc, 792, v132
    ds_write_b32 v100, v108
    ds_write_b8 v194, v136 offset:12
    s_mov_b64 exec, s[70:71]
    s_waitcnt lgkmcnt(8)
    v_bfe_u32 v194, v133, 3, 5
    v_add_lshl_u32 v101, v194, v101, 2
    v_and_b32 v194, 3, v194
    v_mad_i32_i24 v194, v194, -3, v101
    v_cmpx_gt_u32 vcc, 792, v133
    ds_write_b32 v101, v109
    ds_write_b8 v194, v137 offset:12
    s_mov_b64 exec, s[70:71]
    s_waitcnt lgkmcnt(9)
    v_bfe_u32 v194, v134, 3, 5
    v_add_lshl_u32 v102, v194, v102, 2
    v_and_b32 v194, 3, v194
    v_mad_i32_i24 v194, v194, -3, v102
    v_cmpx_gt_u32 vcc, 792, v134
    ds_write_b32 v102, v110
    ds_write_b8 v194, v138 offset:12
    s_mov_b64 exec, s[70:71]
    s_waitcnt lgkmcnt(10)
    v_bfe_u32 v194, v135, 3, 5
    v_add_lshl_u32 v103, v194, v103, 2
    v_and_b32 v194, 3, v194
    v_mad_i32_i24 v194, v194, -3, v103
    v_cmpx_gt_u32 vcc, 792, v135
    ds_write_b32 v103, v111
    ds_write_b8 v194, v139 offset:12
    s_mov_b64 exec, -1
    v_mad_i32_i24 v96, v112, s65, v96
    v_mul_u32_u24 v194, s66, v104
    v_lshl_or_b32 v104, v96, 18, v104
    v_and_or_b32 v194, v194, s67, v140
    v_mad_u32_u24 v96, v112, 40, s69
    v_or_b32 v104, v104, v194
    v_mad_i32_i24 v97, v113, s65, v97
    v_mul_u32_u24 v194, s66, v105
    v_lshl_or_b32 v105, v97, 18, v105
    v_and_or_b32 v194, v194, s67, v140
    v_mad_u32_u24 v97, v113, 40, s69
    v_or_b32 v105, v105, v194
    v_mad_i32_i24 v98, v114, s65, v98
    v_mul_u32_u24 v194, s66, v106
    v_lshl_or_b32 v106, v98, 18, v106
    v_and_or_b32 v194, v194, s67, v140
    v_mad_u32_u24 v98, v114, 40, s69
    v_or_b32 v106, v106, v194
    v_mad_i32_i24 v99, v115, s65, v99
    v_mul_u32_u24 v194, s66, v107
    v_lshl_or_b32 v107, v99, 18, v107
    v_and_or_b32 v194, v194, s67, v140
    v_mad_u32_u24 v99, v115, 40, s69
    v_or_b32 v107, v107, v194
    s_waitcnt lgkmcnt(11)
    v_bfe_u32 v194, v128, 3, 5
    v_add_lshl_u32 v96, v194, v96, 2
    v_and_b32 v194, 3, v194
    v_mad_i32_i24 v194, v194, -3, v96
    v_cmpx_gt_u32 vcc, 792, v128
    ds_write_b32 v96, v104
    ds_write_b8 v194, v136 offset:12
    s_mov_b64 exec, -1
    s_waitcnt lgkmcnt(12)
    v_bfe_u32 v194, v129, 3, 5
    v_add_lshl_u32 v97, v194, v97, 2
    v_and_b32 v194, 3, v194
    v_mad_i32_i24 v194, v194, -3, v97
    v_cmpx_gt_u32 vcc, 792, v129
    ds_write_b32 v97, v105
    ds_write_b8 v194, v137 offset:12
    s_mov_b64 exec, -1
    s_waitcnt lgkmcnt(13)
    v_bfe_u32 v194, v130, 3, 5
    v_add_lshl_u32 v98, v194, v98, 2
    v_and_b32 v194, 3, v194
    v_mad_i32_i24 v194, v194, -3, v98
    v_cmpx_gt_u32 vcc, 792, v130
    ds_write_b32 v98, v106
    ds_write_b8 v194, v138 offset:12
    s_mov_b64 exec, -1
    s_waitcnt lgkmcnt(14)
    v_bfe_u32 v194, v131, 3, 5
    v_add_lshl_u32 v99, v194, v99, 2
    v_and_b32 v194, 3, v194
    v_mad_i32_i24 v194, v194, -3, v99
    v_cmpx_gt_u32 vcc, 792, v131
    ds_write_b32 v99, v107
    ds_write_b8 v194, v139 offset:12
    s_mov_b64 exec, -1
    s_branch L_B1
L_R4:
    s_waitcnt vmcnt(1)
    v_mul_u32_u24 v112, s64, v96
    v_mul_u32_u24 v113, s64, v97
    v_mul_u32_u24 v114, s64, v98
    v_mul_u32_u24 v115, s64, v99
    v_lshrrev_b32 v120, 29, v112
    v_lshrrev_b32 v121, 29, v113
    v_lshrrev_b32 v122, 29, v114
    v_lshrrev_b32 v123, 29, v115
    v_cmp_eq_u32 s[72:73], v120, v121
    v_cmp_eq_u32 s[76:77], v122, v123
    v_cmp_eq_u32 vcc, v120, v122
    v_cmp_eq_u32 s[88:89], v121, v123
    v_cmp_eq_u32 s[90:91], v120, v123
    v_cmp_eq_u32 s[10:11], v121, v122
    v_lshrrev_b32 v112, 24, v112
    v_lshrrev_b32 v113, 24, v113
    v_lshrrev_b32 v114, 24, v114
    v_lshrrev_b32 v115, 24, v115
    s_or_b64 s[74:75], s[72:73], s[88:89]
    s_or_b64 s[78:79], s[76:77], s[88:89]
    s_or_b64 s[72:73], s[72:73], vcc
    s_or_b64 s[76:77], s[76:77], vcc
    s_or_b64 s[72:73], s[72:73], s[90:91]
    s_or_b64 s[74:75], s[74:75], s[10:11]
    s_or_b64 s[76:77], s[76:77], s[10:11]
    s_or_b64 s[78:79], s[78:79], s[90:91]
    v_cndmask_b32 v120, 0, v142, s[72:73]
    v_lshl_add_u32 v120, v112, 2, v120
    ds_add_rtn_u32 v128, v120, v184 offset:5120
    v_cndmask_b32 v121, 0, v142, s[74:75]
    v_lshl_add_u32 v121, v113, 2, v121
    ds_add_rtn_u32 v129, v121, v184 offset:5120
    v_cndmask_b32 v122, 0, v142, s[76:77]
    v_lshl_add_u32 v122, v114, 2, v122
    ds_add_rtn_u32 v130, v122, v184 offset:5120
    v_cndmask_b32 v123, 0, v142, s[78:79]
    v_lshl_add_u32 v123, v115, 2, v123
    ds_add_rtn_u32 v131, v123, v184 offset:5120
    s_waitcnt vmcnt(0)
    v_mad_i32_i24 v96, v112, s65, v96
    v_mul_u32_u24 v194, s66, v104
    v_lshl_or_b32 v104, v96, 18, v104
    v_and_or_b32 v194, v194, s67, v140
    v_mad_u32_u24 v96, v112, 40, s69
    v_or_b32 v104, v104, v194
    v_mad_i32_i24 v97, v113, s65, v97
    v_mul_u32_u24 v194, s66, v105
    v_lshl_or_b32 v105, v97, 18, v105
    v_and_or_b32 v194, v194, s67, v140
    v_mad_u32_u24 v97, v113, 40, s69
    v_or_b32 v105, v105, v194
    s_waitcnt lgkmcnt(3)
    s_mov_b64 exec, s[72:73]
    v_cmpx_le_u32 vcc, 132, v128
    ds_add_rtn_u32 v128, v120, v184 offset:4096
    s_waitcnt lgkmcnt(3)
    s_mov_b64 exec, s[74:75]
    v_cmpx_le_u32 vcc, 132, v129
    ds_add_rtn_u32 v129, v121, v184 offset:4096
    s_waitcnt lgkmcnt(3)
    s_mov_b64 exec, s[76:77]
    v_cmpx_le_u32 vcc, 132, v130
    ds_add_rtn_u32 v130, v122, v184 offset:4096
    s_waitcnt lgkmcnt(3)
    s_mov_b64 exec, s[78:79]
    v_cmpx_le_u32 vcc, 132, v131
    ds_add_rtn_u32 v131, v123, v184 offset:4096
    s_mov_b64 exec, -1
    v_mad_i32_i24 v98, v114, s65, v98
    v_mul_u32_u24 v194, s66, v106
    v_lshl_or_b32 v106, v98, 18, v106
    v_and_or_b32 v194, v194, s67, v140
    v_mad_u32_u24 v98, v114, 40, s69
    v_or_b32 v106, v106, v194
    v_mad_i32_i24 v99, v115, s65, v99
    v_mul_u32_u24 v194, s66, v107
    v_lshl_or_b32 v107, v99, 18, v107
    v_and_or_b32 v194, v194, s67, v140
    v_mad_u32_u24 v99, v115, 40, s69
    v_or_b32 v107, v107, v194
    s_waitcnt lgkmcnt(3)
    v_bfe_u32 v194, v128, 3, 5
    v_add_lshl_u32 v96, v194, v96, 2
    v_and_b32 v194, 3, v194
    v_mad_i32_i24 v194, v194, -3, v96
    v_cmpx_gt_u32 vcc, 792, v128
    ds_write_b32 v96, v104
    ds_write_b8 v194, v136 offset:12
    s_mov_b64 exec, -1
    s_waitcnt lgkmcnt(4)
    v_bfe_u32 v194, v129, 3, 5
    v_add_lshl_u32 v97, v194, v97, 2
    v_and_b32 v194, 3, v194
    v_mad_i32_i24 v194, v194, -3, v97
    v_cmpx_gt_u32 vcc, 792, v129
    ds_write_b32 v97, v105
    ds_write_b8 v194, v137 offset:12
    s_mov_b64 exec, -1
    s_waitcnt lgkmcnt(5)
    v_bfe_u32 v194, v130, 3, 5
    v_add_lshl_u32 v98, v194, v98, 2
    v_and_b32 v194, 3, v194
    v_mad_i32_i24 v194, v194, -3, v98
    v_cmpx_gt_u32 vcc, 792, v130
    ds_write_b32 v98, v106
    ds_write_b8 v194, v138 offset:12
    s_mov_b64 exec, -1
    s_waitcnt lgkmcnt(6)
    v_bfe_u32 v194, v131, 3, 5
    v_add_lshl_u32 v99, v194, v99, 2
    v_and_b32 v194, 3, v194
    v_mad_i32_i24 v194, v194, -3, v99
    v_cmpx_gt_u32 vcc, 792, v131
    ds_write_b32 v99, v107
    ds_write_b8 v194, v139 offset:12
    s_mov_b64 exec, -1
L_B1:
    s_cmp_ge_u32 s3, 2
    s_cbranch_scc1 L_NOC
    global_load_dwordx4 v[176:179], v232, s[28:29]
L_NOC:
    global_load_dwordx4 v[160:163], v232, s[26:27]
    global_load_dwordx4 v[164:167], v232, s[32:33]
    global_load_dwordx4 v[168:171], v232, s[24:25]
    global_load_dwordx4 v[172:175], v232, s[30:31]
    s_mov_b32 s64, 0x1000000
    s_waitcnt lgkmcnt(0)
    s_barrier
    ds_read_b128 v[192:195], v185 offset:5120
    ds_read_b32 v228, v222 offset:5120
    ds_read_b128 v[204:207], v221 offset:0
    ds_read_b32 v229, v222 offset:5376
    ds_read_b128 v[208:211], v221 offset:10240
    ds_read_b32 v230, v222 offset:5632
    ds_read_b128 v[212:215], v221 offset:20480
    ds_read_b32 v231, v222 offset:5888
    ds_read_b128 v[216:219], v221 offset:30720
    s_mov_b32 s80, 2105344
    s_mov_b32 s81, 4210688
    s_mov_b32 s82, 6316032
    s_waitcnt lgkmcnt(8)
    v_max3_u32 v188, v192, v193, v194
    v_max_u32 v188, v188, v195
    v_cmp_lt_u32 vcc, 1056, v188
    s_cbranch_vccnz L_POVF
L_POUT:
    s_waitcnt lgkmcnt(7)
    v_sub_u32 v228, v187, v228
    v_and_or_b32 v228, v228, s64, v186
    s_waitcnt lgkmcnt(6)
    v_or_b32 v207, v207, v228
    buffer_store_dwordx4 v[204:207], v220, s[56:59], 0 offen sc1
    s_waitcnt lgkmcnt(5)
    v_sub_u32 v229, v187, v229
    v_and_or_b32 v229, v229, s64, v186
    s_waitcnt lgkmcnt(4)
    v_or_b32 v211, v211, v229
    buffer_store_dwordx4 v[208:211], v220, s[56:59], s80 offen sc1
    s_waitcnt lgkmcnt(3)
    v_sub_u32 v230, v187, v230
    v_and_or_b32 v230, v230, s64, v186
    s_waitcnt lgkmcnt(2)
    v_or_b32 v215, v215, v230
    buffer_store_dwordx4 v[212:215], v220, s[56:59], s81 offen sc1
    s_waitcnt lgkmcnt(1)
    v_sub_u32 v231, v187, v231
    v_and_or_b32 v231, v231, s64, v186
    s_waitcnt lgkmcnt(0)
    v_or_b32 v219, v219, v231
    buffer_store_dwordx4 v[216:219], v220, s[56:59], s82 offen sc1
    s_mov_b32 s10, 0xbfb8aa3b
    s_mov_b32 s11, s10
    s_mov_b32 s64, 0x05040100
    s_mov_b32 s66, 0x07060302
    s_waitcnt vmcnt(4)
    v_max3_u32 v188, v128, v129, v130
    v_max3_u32 v189, v131, v132, v133
    v_max3_u32 v188, v188, v134, v135
    v_max_u32 v188, v188, v189
    v_cmp_le_u32 vcc, 792, v188
    s_cbranch_vccnz L_PEXT
L_PEXTR:
    v_perm_b32 v112, v170, v168, s64
    v_perm_b32 v113, v170, v168, s66
    v_perm_b32 v114, v171, v169, s64
    v_perm_b32 v115, v171, v169, s66
    v_add_u32 v116, 77824, v224
    ds_write2_b32 v116, v112, v113 offset0:0 offset1:8
    ds_write2_b32 v116, v114, v115 offset0:16 offset1:24
    v_lshlrev_b32 v96, 16, v160
    v_and_b32 v97, 0xffff0000, v160
    v_lshlrev_b32 v98, 16, v161
    v_and_b32 v99, 0xffff0000, v161
    v_lshlrev_b32 v100, 16, v162
    v_and_b32 v101, 0xffff0000, v162
    v_lshlrev_b32 v102, 16, v163
    v_and_b32 v103, 0xffff0000, v163
    v_pk_mul_f32 v[96:97], v[96:97], s[10:11]
    v_pk_mul_f32 v[98:99], v[98:99], s[10:11]
    v_pk_mul_f32 v[100:101], v[100:101], s[10:11]
    v_pk_mul_f32 v[102:103], v[102:103], s[10:11]
    v_cvt_pk_bf16_f32 v104, v96, v100
    v_cvt_pk_bf16_f32 v105, v97, v101
    v_cvt_pk_bf16_f32 v106, v98, v102
    v_cvt_pk_bf16_f32 v107, v99, v103
    ds_write2_b32 v224, v104, v105 offset0:0 offset1:8
    ds_write2_b32 v224, v106, v107 offset0:16 offset1:24
    v_perm_b32 v120, v166, v164, s64
    v_perm_b32 v121, v166, v164, s66
    v_perm_b32 v122, v167, v165, s64
    v_perm_b32 v123, v167, v165, s66
    v_add_u32 v124, 10240, v224
    ds_write2_b32 v124, v120, v121 offset0:0 offset1:8
    ds_write2_b32 v124, v122, v123 offset0:16 offset1:24
    v_perm_b32 v112, v174, v172, s64
    v_perm_b32 v113, v174, v172, s66
    v_perm_b32 v114, v175, v173, s64
    v_perm_b32 v115, v175, v173, s66
    v_add_u32 v116, 130176, v224
    ds_write2_b32 v116, v112, v113 offset0:0 offset1:8
    ds_write2_b32 v116, v114, v115 offset0:16 offset1:24
    s_cmp_ge_u32 s3, 2
    s_cbranch_scc1 L_NOWC
    v_lshlrev_b32 v96, 16, v176
    v_and_b32 v97, 0xffff0000, v176
    v_lshlrev_b32 v98, 16, v177
    v_and_b32 v99, 0xffff0000, v177
    v_lshlrev_b32 v100, 16, v178
    v_and_b32 v101, 0xffff0000, v178
    v_lshlrev_b32 v102, 16, v179
    v_and_b32 v103, 0xffff0000, v179
    v_pk_mul_f32 v[96:97], v[96:97], s[10:11]
    v_pk_mul_f32 v[98:99], v[98:99], s[10:11]
    v_pk_mul_f32 v[100:101], v[100:101], s[10:11]
    v_pk_mul_f32 v[102:103], v[102:103], s[10:11]
    v_cvt_pk_bf16_f32 v104, v96, v100
    v_cvt_pk_bf16_f32 v105, v97, v101
    v_cvt_pk_bf16_f32 v106, v98, v102
    v_cvt_pk_bf16_f32 v107, v99, v103
    v_add_u32 v108, 20480, v224
    ds_write2_b32 v108, v104, v105 offset0:0 offset1:8
    ds_write2_b32 v108, v106, v107 offset0:16 offset1:24
L_NOWC:
    s_mul_i32 s34, s5, 32896
    s_add_u32 s34, s34, 65536
    s_add_u32 s56, s38, s34
    s_addc_u32 s57, s39, 0
    s_mov_b32 s58, 32768
    s_mov_b32 s59, 0x20000
    s_add_u32 s34, s34, 8421376
    s_add_u32 s60, s38, s34
    s_addc_u32 s61, s39, 0
    s_mov_b32 s62, 32768
    s_mov_b32 s63, 0x20000
    s_movk_i32 s26, 8192
    s_movk_i32 s27, 16384
    s_movk_i32 s28, 24576
    s_waitcnt lgkmcnt(0)
    s_barrier
    v_add_u32 v225, 13312, v225
    ds_read_b64_tr_b16 v[0:1], v225 offset:0
    ds_read_b64_tr_b16 v[2:3], v225 offset:1280
    ds_read_b64_tr_b16 v[4:5], v225 offset:5120
    ds_read_b64_tr_b16 v[6:7], v225 offset:6400
    ds_read_b64_tr_b16 v[8:9], v225 offset:32
    ds_read_b64_tr_b16 v[10:11], v225 offset:1312
    ds_read_b64_tr_b16 v[12:13], v225 offset:5152
    ds_read_b64_tr_b16 v[14:15], v225 offset:6432
    ds_read_b64_tr_b16 v[16:17], v225 offset:64
    ds_read_b64_tr_b16 v[18:19], v225 offset:1344
    ds_read_b64_tr_b16 v[20:21], v225 offset:5184
    ds_read_b64_tr_b16 v[22:23], v225 offset:6464
    ds_read_b64_tr_b16 v[24:25], v225 offset:96
    ds_read_b64_tr_b16 v[26:27], v225 offset:1376
    v_mov_b64 v[64:65], 0
    v_mov_b64 v[66:67], 0
    v_mov_b32 v68, 0x20fffff
    v_mov_b32 v69, 0x20fffff
    v_mov_b32 v70, 0x20fffff
    v_mov_b32 v71, 0x20fffff
    v_lshl_add_u32 v72, v253, 4, s12
    ds_write_b128 v72, v[64:67] offset:0
    ds_write_b128 v72, v[68:71] offset:18432
    ds_write_b128 v72, v[64:67] offset:1024
    ds_write_b128 v72, v[68:71] offset:19456
    ds_write_b128 v72, v[64:67] offset:1280
    ds_write_b128 v72, v[68:71] offset:19712
    ds_read_b64_tr_b16 v[28:29], v225 offset:5216
    ds_read_b64_tr_b16 v[30:31], v225 offset:6496
    ds_read_b64_tr_b16 v[32:33], v225 offset:10240
    ds_read_b64_tr_b16 v[34:35], v225 offset:11520
    ds_read_b64_tr_b16 v[36:37], v225 offset:15360
    ds_read_b64_tr_b16 v[38:39], v225 offset:16640
    ds_read_b64_tr_b16 v[40:41], v225 offset:10272
    ds_read_b64_tr_b16 v[42:43], v225 offset:11552
    ds_read_b64_tr_b16 v[44:45], v225 offset:15392
    ds_read_b64_tr_b16 v[46:47], v225 offset:16672
    v_mov_b32 v192, v225
    s_mov_b32 exec_lo, 0
    v_subrev_u32 v192, 2560, v225
    s_mov_b32 exec_lo, -1
    v_mul_u32_u24 v156, 3128, v223
    v_add_u32 v157, 200192, v156
    v_add_u32 v158, 400384, v156
    v_add_u32 v159, 600576, v156
    s_mov_b32 s98, 0xf0f0f0f
    s_mov_b32 s99, 0xf0f0f0f
    v_mov_b32 v180, 0xfffff
    v_cndmask_b32 v176, 0, v180, s[98:99]
    v_add_lshl_u32 v191, v232, v243, 16
    v_add_u32 v152, 0x34000000, v191
    v_cndmask_b32 v152, 0, v152, s[98:99]
    v_add_u32 v153, 0x54000000, v191
    v_cndmask_b32 v153, 0, v153, s[98:99]
    v_add_u32 v154, 0x74000000, v191
    v_cndmask_b32 v154, 0, v154, s[98:99]
    v_add_u32 v155, 0x94000000, v191
    v_cndmask_b32 v155, 0, v155, s[98:99]
    v_mov_b32 v184, 4
    v_and_b32 v177, 31, v253
    v_add_lshl_u32 v179, v177, s7, 2
    v_lshrrev_b32 v191, 5, v253
    v_lshl_add_u32 v178, v191, 11, v179
    v_add_u32 v179, 153728, v179
    s_waitcnt lgkmcnt(4)
    ds_read_b64_tr_b16 v[48:49], v225 offset:10304
    ds_read_b64_tr_b16 v[50:51], v225 offset:11584
    ds_read_b64_tr_b16 v[52:53], v225 offset:15424
    ds_read_b64_tr_b16 v[54:55], v225 offset:16704
    ds_read_b64_tr_b16 v[56:57], v225 offset:10336
    ds_read_b64_tr_b16 v[58:59], v225 offset:11616
    ds_read_b64_tr_b16 v[60:61], v225 offset:15456
    ds_read_b64_tr_b16 v[62:63], v225 offset:16736
    ds_read_b64_tr_b16 v[80:81], v192 offset:20480
    ds_read_b64_tr_b16 v[82:83], v192 offset:21760
    ds_read_b64_tr_b16 v[84:85], v192 offset:20512
    ds_read_b64_tr_b16 v[86:87], v192 offset:21792
    ds_read_b64_tr_b16 v[88:89], v192 offset:20544
    ds_read_b64_tr_b16 v[90:91], v192 offset:21824
    ds_read_b64_tr_b16 v[92:93], v192 offset:20576
    ds_read_b64_tr_b16 v[94:95], v192 offset:21856
    v_add_u32 v225, 77824, v225
    s_movk_i32 s18, 0xffc
    s_movk_i32 s20, 32
    s_mov_b32 s21, 0
    s_mov_b32 s100, 0
    s_mov_b32 s16, 0x1ffffff
    s_mov_b32 s17, 0xffff
    s_mul_i32 s10, s4, 49
    s_sub_i32 s22, s10, 6
    s_ashr_i32 s22, s22, 1
    s_add_i32 s23, s10, 7
    s_ashr_i32 s23, s23, 1
    s_add_i32 s24, s10, 43
    s_ashr_i32 s24, s24, 1
    s_add_i32 s25, s22, 31
    s_cmp_eq_u32 s4, 7
    s_cselect_b32 s24, 196, s24
    s_cselect_b32 s25, 196, s25
    s_waitcnt vmcnt(0)
    buffer_load_dwordx4 v[128:131], v232, s[56:59], 0 offen sc1
    buffer_load_dwordx4 v[132:135], v232, s[56:59], s26 offen sc1
    buffer_load_dwordx4 v[136:139], v232, s[56:59], s27 offen sc1
    buffer_load_dwordx4 v[140:143], v232, s[56:59], s28 offen sc1
L_PW0:
    s_waitcnt vmcnt(3)
    v_xor_b32 v188, v131, v186
    v_and_b32_sdwa v96, v128, s18 dst_sel:DWORD dst_unused:UNUSED_PAD src0_sel:WORD_1 src1_sel:DWORD
    v_and_b32_sdwa v97, v129, s18 dst_sel:DWORD dst_unused:UNUSED_PAD src0_sel:WORD_1 src1_sel:DWORD
    v_and_b32_sdwa v98, v130, s18 dst_sel:DWORD dst_unused:UNUSED_PAD src0_sel:WORD_1 src1_sel:DWORD
    v_cmp_lt_u32 vcc, s16, v188
    v_cmp_ne_u32 s[64:65], 0, v128
    v_cmp_ne_u32 s[66:67], 0, v129
    v_cmp_ne_u32 s[68:69], 0, v130
    s_cbranch_vccnz L_RT0
    s_mov_b64 exec, s[64:65]
    ds_add_rtn_u32 v112, v96, v184 offset:1024
    s_mov_b64 exec, s[66:67]
    ds_add_rtn_u32 v113, v97, v184 offset:1024
    s_mov_b64 exec, s[68:69]
    ds_add_rtn_u32 v114, v98, v184 offset:1024
    s_mov_b64 exec, -1
    v_add_u32_sdwa v207, v131, v156 dst_sel:DWORD dst_unused:UNUSED_PAD src0_sel:BYTE_0 src1_sel:DWORD
    v_lshrrev_b32 v189, 28, v128
    v_lshl_add_u32 v207, v189, 8, v207
    v_and_b32 v189, 60, v96
    v_lshl_add_u32 v204, v189, 19, v207
    v_add_u32_sdwa v205, v131, v156 dst_sel:DWORD dst_unused:UNUSED_PAD src0_sel:BYTE_1 src1_sel:DWORD
    v_lshrrev_b32 v189, 28, v129
    v_lshl_add_u32 v205, v189, 8, v205
    v_and_b32 v189, 60, v97
    v_lshl_add_u32 v205, v189, 19, v205
    v_add_u32_sdwa v206, v131, v156 dst_sel:DWORD dst_unused:UNUSED_PAD src0_sel:BYTE_2 src1_sel:DWORD
    v_lshrrev_b32 v189, 28, v130
    v_lshl_add_u32 v206, v189, 8, v206
    v_and_b32 v189, 60, v98
    v_lshl_add_u32 v206, v189, 19, v206
    v_cndmask_b32 v188, v180, v207, s[64:65]
    s_nop 1
    v_mov_b32_dpp v189, v188 quad_perm:[2,2,3,3] row_mask:0xf bank_mask:0xf
    v_mov_b32_dpp v207, v188 quad_perm:[0,0,1,1] row_mask:0xf bank_mask:0xf
    s_nop 0
    v_mov_b32_dpp v207, v189 row_shr:4 row_mask:0xf bank_mask:0xa
L_PW1:
    s_waitcnt vmcnt(2)
    v_xor_b32 v188, v135, v186
    v_and_b32_sdwa v100, v132, s18 dst_sel:DWORD dst_unused:UNUSED_PAD src0_sel:WORD_1 src1_sel:DWORD
    v_and_b32_sdwa v101, v133, s18 dst_sel:DWORD dst_unused:UNUSED_PAD src0_sel:WORD_1 src1_sel:DWORD
    v_and_b32_sdwa v102, v134, s18 dst_sel:DWORD dst_unused:UNUSED_PAD src0_sel:WORD_1 src1_sel:DWORD
    v_cmp_lt_u32 vcc, s16, v188
    v_cmp_ne_u32 s[72:73], 0, v132
    v_cmp_ne_u32 s[74:75], 0, v133
    v_cmp_ne_u32 s[76:77], 0, v134
    s_cbranch_vccnz L_RT1
    s_mov_b64 exec, s[72:73]
    ds_add_rtn_u32 v116, v100, v184 offset:1024
    s_mov_b64 exec, s[74:75]
    ds_add_rtn_u32 v117, v101, v184 offset:1024
    s_mov_b64 exec, s[76:77]
    ds_add_rtn_u32 v118, v102, v184 offset:1024
    s_mov_b64 exec, -1
    v_add_u32_sdwa v211, v135, v157 dst_sel:DWORD dst_unused:UNUSED_PAD src0_sel:BYTE_0 src1_sel:DWORD
    v_lshrrev_b32 v189, 28, v132
    v_lshl_add_u32 v211, v189, 8, v211
    v_and_b32 v189, 60, v100
    v_lshl_add_u32 v208, v189, 19, v211
    v_add_u32_sdwa v209, v135, v157 dst_sel:DWORD dst_unused:UNUSED_PAD src0_sel:BYTE_1 src1_sel:DWORD
    v_lshrrev_b32 v189, 28, v133
    v_lshl_add_u32 v209, v189, 8, v209
    v_and_b32 v189, 60, v101
    v_lshl_add_u32 v209, v189, 19, v209
    v_add_u32_sdwa v210, v135, v157 dst_sel:DWORD dst_unused:UNUSED_PAD src0_sel:BYTE_2 src1_sel:DWORD
    v_lshrrev_b32 v189, 28, v134
    v_lshl_add_u32 v210, v189, 8, v210
    v_and_b32 v189, 60, v102
    v_lshl_add_u32 v210, v189, 19, v210
    v_cndmask_b32 v188, v180, v211, s[72:73]
    s_nop 1
    v_mov_b32_dpp v189, v188 quad_perm:[2,2,3,3] row_mask:0xf bank_mask:0xf
    v_mov_b32_dpp v211, v188 quad_perm:[0,0,1,1] row_mask:0xf bank_mask:0xf
    s_nop 0
    v_mov_b32_dpp v211, v189 row_shr:4 row_mask:0xf bank_mask:0xa
L_PW2:
    s_waitcnt vmcnt(1)
    v_xor_b32 v188, v139, v186
    v_and_b32_sdwa v104, v136, s18 dst_sel:DWORD dst_unused:UNUSED_PAD src0_sel:WORD_1 src1_sel:DWORD
    v_and_b32_sdwa v105, v137, s18 dst_sel:DWORD dst_unused:UNUSED_PAD src0_sel:WORD_1 src1_sel:DWORD
    v_and_b32_sdwa v106, v138, s18 dst_sel:DWORD dst_unused:UNUSED_PAD src0_sel:WORD_1 src1_sel:DWORD
    v_cmp_lt_u32 vcc, s16, v188
    v_cmp_ne_u32 s[80:81], 0, v136
    v_cmp_ne_u32 s[82:83], 0, v137
    v_cmp_ne_u32 s[84:85], 0, v138
    s_cbranch_vccnz L_RT2
    s_mov_b64 exec, s[80:81]
    ds_add_rtn_u32 v120, v104, v184 offset:1024
    s_mov_b64 exec, s[82:83]
    ds_add_rtn_u32 v121, v105, v184 offset:1024
    s_mov_b64 exec, s[84:85]
    ds_add_rtn_u32 v122, v106, v184 offset:1024
    s_mov_b64 exec, -1
    v_add_u32_sdwa v215, v139, v158 dst_sel:DWORD dst_unused:UNUSED_PAD src0_sel:BYTE_0 src1_sel:DWORD
    v_lshrrev_b32 v189, 28, v136
    v_lshl_add_u32 v215, v189, 8, v215
    v_and_b32 v189, 60, v104
    v_lshl_add_u32 v212, v189, 19, v215
    v_add_u32_sdwa v213, v139, v158 dst_sel:DWORD dst_unused:UNUSED_PAD src0_sel:BYTE_1 src1_sel:DWORD
    v_lshrrev_b32 v189, 28, v137
    v_lshl_add_u32 v213, v189, 8, v213
    v_and_b32 v189, 60, v105
    v_lshl_add_u32 v213, v189, 19, v213
    v_add_u32_sdwa v214, v139, v158 dst_sel:DWORD dst_unused:UNUSED_PAD src0_sel:BYTE_2 src1_sel:DWORD
    v_lshrrev_b32 v189, 28, v138
    v_lshl_add_u32 v214, v189, 8, v214
    v_and_b32 v189, 60, v106
    v_lshl_add_u32 v214, v189, 19, v214
    v_cndmask_b32 v188, v180, v215, s[80:81]
    s_nop 1
    v_mov_b32_dpp v189, v188 quad_perm:[2,2,3,3] row_mask:0xf bank_mask:0xf
    v_mov_b32_dpp v215, v188 quad_perm:[0,0,1,1] row_mask:0xf bank_mask:0xf
    s_nop 0
    v_mov_b32_dpp v215, v189 row_shr:4 row_mask:0xf bank_mask:0xa
L_PW3:
    s_waitcnt vmcnt(0)
    v_xor_b32 v188, v143, v186
    v_and_b32_sdwa v108, v140, s18 dst_sel:DWORD dst_unused:UNUSED_PAD src0_sel:WORD_1 src1_sel:DWORD
    v_and_b32_sdwa v109, v141, s18 dst_sel:DWORD dst_unused:UNUSED_PAD src0_sel:WORD_1 src1_sel:DWORD
    v_and_b32_sdwa v110, v142, s18 dst_sel:DWORD dst_unused:UNUSED_PAD src0_sel:WORD_1 src1_sel:DWORD
    v_cmp_lt_u32 vcc, s16, v188
    v_cmp_ne_u32 s[88:89], 0, v140
    v_cmp_ne_u32 s[90:91], 0, v141
    v_cmp_ne_u32 s[92:93], 0, v142
    s_cbranch_vccnz L_RT3
    s_mov_b64 exec, s[88:89]
    ds_add_rtn_u32 v124, v108, v184 offset:1024
    s_mov_b64 exec, s[90:91]
    ds_add_rtn_u32 v125, v109, v184 offset:1024
    s_mov_b64 exec, s[92:93]
    ds_add_rtn_u32 v126, v110, v184 offset:1024
    s_mov_b64 exec, -1
    v_or3_b32 v190, v131, v135, v139
    v_or_b32 v190, v190, v143
    v_and_b32 v190, 0x1000000, v190
    v_cmp_ne_u32 vcc, 0, v190
    s_cbranch_vccnz L_XT1
L_XT1R:
    v_add_u32_sdwa v219, v143, v159 dst_sel:DWORD dst_unused:UNUSED_PAD src0_sel:BYTE_0 src1_sel:DWORD
    v_lshrrev_b32 v189, 28, v140
    v_lshl_add_u32 v219, v189, 8, v219
    v_and_b32 v189, 60, v108
    v_lshl_add_u32 v216, v189, 19, v219
    v_add_u32_sdwa v217, v143, v159 dst_sel:DWORD dst_unused:UNUSED_PAD src0_sel:BYTE_1 src1_sel:DWORD
    v_lshrrev_b32 v189, 28, v141
    v_lshl_add_u32 v217, v189, 8, v217
    v_and_b32 v189, 60, v109
    v_lshl_add_u32 v217, v189, 19, v217
    v_add_u32_sdwa v218, v143, v159 dst_sel:DWORD dst_unused:UNUSED_PAD src0_sel:BYTE_2 src1_sel:DWORD
    v_lshrrev_b32 v189, 28, v142
    v_lshl_add_u32 v218, v189, 8, v218
    v_and_b32 v189, 60, v110
    v_lshl_add_u32 v218, v189, 19, v218
    v_cndmask_b32 v188, v180, v219, s[88:89]
    s_nop 1
    v_mov_b32_dpp v189, v188 quad_perm:[2,2,3,3] row_mask:0xf bank_mask:0xf
    v_mov_b32_dpp v219, v188 quad_perm:[0,0,1,1] row_mask:0xf bank_mask:0xf
    s_nop 0
    v_mov_b32_dpp v219, v189 row_shr:4 row_mask:0xf bank_mask:0xa
    v_mov_b32 v197, 640
    s_cmp_eq_u32 s3, 6
    s_cselect_b32 exec_hi, 0, -1
    s_cmp_eq_u32 s3, 7
    s_cselect_b64 exec, 1, exec
    s_add_u32 m0, s101, 0
    s_nop 0
    buffer_load_dwordx4 v234, s[40:43], 0 offen offset:0 lds
    s_add_u32 m0, s101, 6560
    s_nop 0
    buffer_load_dwordx4 v234, s[40:43], 0 offen offset:128 lds
    s_add_u32 m0, s101, 13120
    s_nop 0
    buffer_load_dwordx4 v234, s[40:43], 0 offen offset:256 lds
    s_add_u32 m0, s101, 19680
    s_nop 0
    buffer_load_dwordx4 v234, s[40:43], 0 offen offset:384 lds
    s_mov_b64 exec, -1
    s_waitcnt lgkmcnt(0)
    s_barrier
    ds_read_u16 v198, v178 offset:1024
    ds_read_u16 v199, v178 offset:2048
    ds_read_b128 v[160:163], v185 offset:1024
    ds_read_b128 v[164:167], v185 offset:2048
    ds_read_b128 v[168:171], v185 offset:3072
    ds_read_b128 v[172:175], v185 offset:4096
    ds_read_b32 v236, v197 offset:8
    s_lshl_b32 m0, s3, 10
    v_mov_b32 v240, v207
    s_add_u32 m0, m0, 13312
    s_nop 0
    buffer_load_dwordx4 v[240:241], s[44:47], 0 idxen offen lds
    s_cmp_lg_u32 s2, 0
    s_cbranch_scc1 L_NOK
    v_mov_b32 v237, s6
    v_mov_b32 v238, 0
    buffer_store_dword v237, v238, s[52:55], 0 offen sc1
L_NOK:
    s_waitcnt lgkmcnt(5)
    v_lshl_or_b32 v198, v199, 16, v198
    v_mov_b32 v199, v198
    s_waitcnt lgkmcnt(0)
    v_add_u32_sdwa v188, v160, v164 dst_sel:DWORD dst_unused:UNUSED_PAD src0_sel:WORD_0 src1_sel:WORD_0
    v_add_u32_sdwa v192, v168, v172 dst_sel:DWORD dst_unused:UNUSED_PAD src0_sel:WORD_0 src1_sel:WORD_0
    v_add_u32_dpp v199, v199, v199 row_shr:1 row_mask:0xf bank_mask:0xf bound_ctrl:0
    v_add_u32_sdwa v189, v161, v165 dst_sel:DWORD dst_unused:UNUSED_PAD src0_sel:WORD_0 src1_sel:WORD_0
    v_add_u32_sdwa v193, v169, v173 dst_sel:DWORD dst_unused:UNUSED_PAD src0_sel:WORD_0 src1_sel:WORD_0
    v_add_u32_dpp v199, v199, v199 row_shr:2 row_mask:0xf bank_mask:0xf bound_ctrl:0
    v_add_u32_sdwa v190, v162, v166 dst_sel:DWORD dst_unused:UNUSED_PAD src0_sel:WORD_0 src1_sel:WORD_0
    v_add_u32_sdwa v194, v170, v174 dst_sel:DWORD dst_unused:UNUSED_PAD src0_sel:WORD_0 src1_sel:WORD_0
    v_add_u32_dpp v199, v199, v199 row_shr:4 row_mask:0xf bank_mask:0xf bound_ctrl:0
    v_add_u32_sdwa v191, v163, v167 dst_sel:DWORD dst_unused:UNUSED_PAD src0_sel:WORD_0 src1_sel:WORD_0
    v_add_u32_sdwa v195, v171, v175 dst_sel:DWORD dst_unused:UNUSED_PAD src0_sel:WORD_0 src1_sel:WORD_0
    v_add_u32_dpp v199, v199, v199 row_shr:8 row_mask:0xf bank_mask:0xf bound_ctrl:0
    v_add_u32 v188, v188, v192
    v_add_u32 v189, v189, v193
    v_add_u32_dpp v199, v199, v199 row_bcast:15 row_mask:0xa bank_mask:0xf
    v_add_u32 v190, v190, v194
    v_add_u32 v191, v191, v195
    v_add_u32 v193, v188, v189
    v_add_u32 v194, v193, v190
    v_add_u32 v195, v194, v191
    v_mov_b32 v196, v195
    s_mov_b32 s96, -1
    s_mov_b32 s97, 0
    v_sub_u32 v200, v199, v198
    v_add_u32_sdwa v202, v199, v199 dst_sel:DWORD dst_unused:UNUSED_PAD src0_sel:WORD_0 src1_sel:WORD_1
    v_add_u32_dpp v196, v196, v196 row_shr:1 row_mask:0xf bank_mask:0xf bound_ctrl:0
    v_add_u32_sdwa v201, v200, v200 dst_sel:DWORD dst_unused:UNUSED_PAD src0_sel:WORD_0 src1_sel:WORD_1
    v_add_u32_sdwa v203, v198, v198 dst_sel:DWORD dst_unused:UNUSED_PAD src0_sel:WORD_0 src1_sel:WORD_1
    v_add_u32_dpp v196, v196, v196 row_shr:2 row_mask:0xf bank_mask:0xf bound_ctrl:0
    v_add_u32 v189, v188, v193
    v_add_u32 v190, v193, v194
    v_add_u32_dpp v196, v196, v196 row_shr:4 row_mask:0xf bank_mask:0xf bound_ctrl:0
    v_permlane32_swap_b32 v201, v202
    v_add_u32 v191, v194, v195
    v_add_u32_dpp v196, v196, v196 row_shr:8 row_mask:0xf bank_mask:0xf bound_ctrl:0
    v_add_u32 v201, v201, v202
    v_cndmask_b32 v203, 0, v203, s[96:97]
    v_add_u32_dpp v196, v196, v196 row_bcast:15 row_mask:0xa bank_mask:0xf
    v_add_u32 v202, v201, v203
    v_readfirstlane_b32 s19, v236
    v_add_u32_dpp v196, v196, v196 row_bcast:31 row_mask:0xc bank_mask:0xf
    s_lshl_b32 m0, s3, 10
    v_mov_b32 v240, v211
    s_add_u32 m0, m0, 21504
    s_nop 0
    buffer_load_dwordx4 v[240:241], s[44:47], 0 idxen offen lds
    v_sub_u32 v192, v196, v195
    v_readlane_b32 s10, v196, 63
    v_sub_u32_sdwa v203, v202, v198 dst_sel:DWORD dst_unused:UNUSED_PAD src0_sel:DWORD src1_sel:WORD_1
    v_lshl_add_u32 v188, v192, 1, v188
    v_lshl_add_u32 v189, v192, 1, v189
    v_lshl_add_u32 v190, v192, 1, v190
    v_lshl_add_u32 v191, v192, 1, v191
    s_lshr_b32 s11, s10, 5
    s_add_u32 s11, s11, 12
    s_and_b32 s11, s11, -32
    s_sub_i32 s11, s11, 12
    s_lshl_b32 s11, s11, 3
    s_lshr_b32 s10, s10, 1
    s_lshr_b32 s8, s4, 1
    s_mul_i32 s8, s8, s10
    s_add_i32 s11, s11, s8
    s_add_i32 s10, s10, s8
    s_bitcmp1_b32 s4, 0
    s_cselect_b32 s31, s11, s8
    s_cselect_b32 s10, s10, s11
    s_mov_b32 s8, 0
    s_mov_b32 s9, 0
    v_cmp_gt_i32 vcc, s31, v188
    v_cmp_gt_i32 s[34:35], s10, v188
    s_bcnt1_i32_b64 s11, vcc
    s_add_u32 s8, s8, s11
    s_bcnt1_i32_b64 s11, s[34:35]
    s_add_u32 s9, s9, s11
    v_cmp_gt_i32 vcc, s31, v189
    v_cmp_gt_i32 s[34:35], s10, v189
    s_bcnt1_i32_b64 s11, vcc
    s_add_u32 s8, s8, s11
    s_bcnt1_i32_b64 s11, s[34:35]
    s_add_u32 s9, s9, s11
    v_cmp_gt_i32 vcc, s31, v190
    v_cmp_gt_i32 s[34:35], s10, v190
    s_bcnt1_i32_b64 s11, vcc
    s_add_u32 s8, s8, s11
    s_bcnt1_i32_b64 s11, s[34:35]
    s_add_u32 s9, s9, s11
    v_cmp_gt_i32 vcc, s31, v191
    v_cmp_gt_i32 s[34:35], s10, v191
    s_bcnt1_i32_b64 s11, vcc
    s_add_u32 s8, s8, s11
    s_bcnt1_i32_b64 s11, s[34:35]
    s_add_u32 s9, s9, s11
    s_max_i32 s8, s8, s22
    s_min_i32 s8, s8, s23
    s_max_i32 s9, s9, s24
    s_min_i32 s9, s9, s25
    s_lshl_b32 m0, s3, 10
    v_mov_b32 v240, v215
    s_add_u32 m0, m0, 29696
    s_nop 0
    buffer_load_dwordx4 v[240:241], s[44:47], 0 idxen offen lds
    s_sub_u32 s22, s8, s7
    s_sub_u32 s23, s9, s7
    v_readlane_b32 s16, v201, s22
    v_readlane_b32 s30, v201, s23
    s_add_u32 s10, s22, 32
    s_add_u32 s11, s23, 32
    v_readlane_b32 s26, v200, s22
    v_readlane_b32 s28, v200, s23
    v_readlane_b32 s27, v200, s10
    v_readlane_b32 s29, v200, s11
    s_sub_u32 s31, s30, s16
    s_add_u32 s10, s31, 255
    s_lshr_b32 s10, s10, 8
    s_lshl_b32 s10, s10, 7
    s_sub_u32 s10, s10, s19
    s_max_i32 s10, s10, 0
    s_add_u32 s16, s16, s10
    s_add_u32 s10, s22, 16
    s_min_u32 s10, s10, s23
    s_sub_i32 s11, s23, 16
    v_cmp_ge_u32 s[34:35], s16, v203
    v_cmp_ge_u32 s[36:37], s16, v202
    v_cmp_gt_i32 vcc, s10, v177
    v_cmp_gt_i32 s[10:11], s11, v177
    v_cmp_le_u32 s[32:33], s22, v177
    v_cmp_gt_u32 s[96:97], s23, v177
    s_and_b64 s[34:35], s[34:35], vcc
    s_and_b64 s[36:37], s[36:37], vcc
    s_or_b64 s[34:35], s[34:35], s[10:11]
    s_or_b64 s[36:37], s[36:37], s[10:11]
    s_bcnt1_i32_b32 s24, s34
    s_bcnt1_i32_b32 s10, s36
    s_bcnt1_i32_b32 s11, s35
    s_bcnt1_i32_b32 s25, s37
    v_readlane_b32 s22, v200, s24
    v_readlane_b32 s10, v200, s10
    s_add_u32 s11, s11, 32
    s_add_u32 s16, s25, 32
    v_readlane_b32 s23, v200, s11
    v_readlane_b32 s11, v200, s16
    v_mov_b32 v188, s17
    v_cndmask_b32 v189, 0, v188, s[34:35]
    v_cndmask_b32 v188, 0, v188, s[36:37]
    s_and_b64 s[32:33], s[32:33], s[96:97]
    s_pack_lh_b32_b16 s22, s22, s10
    s_pack_lh_b32_b16 s23, s23, s11
    v_lshl_or_b32 v188, v188, 16, v189
    s_sub_u32 s16, s12, 37888
    s_pack_ll_b32_b16 s16, s16, s16
    s_sub_u32 s10, s22, s26
    s_sub_u32 s11, s23, s27
    s_mul_i32 s10, s10, 0x10001
    s_lshl_b32 vcc_lo, s10, 16
    s_pack_hh_b32_b16 s10, s10, s10
    s_lshl_b32 vcc_hi, s11, 16
    s_add_u32 vcc_hi, vcc_hi, s10
    s_add_u32 s96, vcc_hi, s11
    s_lshr_b32 s96, s96, 16
    s_sub_u32 s31, s31, s96
    s_cmp_gt_u32 s31, s96
    s_cselect_b32 s97, 0x4800480, 0
    s_add_u32 s16, s16, s97
    s_sub_u32 s10, s16, s26
    s_sub_u32 s11, s16, s27
    s_add_u32 s10, s10, vcc_lo
    s_add_u32 s11, s11, vcc_hi
    v_mov_b32 v192, s10
    v_mov_b32 v193, s11
    s_add_u32 s16, s16, 0x4800480
    s_sub_u32 s16, s16, s97
    s_sub_u32 s16, s16, s97
    s_sub_u32 s10, s28, s22
    s_sub_u32 s11, s29, s23
    s_mul_i32 s10, s10, 0x10001
    s_lshl_b32 vcc_lo, s10, 16
    s_pack_hh_b32_b16 s10, s10, s10
    s_lshl_b32 vcc_hi, s11, 16
    s_add_u32 vcc_hi, vcc_hi, s10
    s_sub_u32 s10, s16, s22
    s_sub_u32 s11, s16, s23
    s_add_u32 s10, s10, vcc_lo
    s_add_u32 s11, s11, vcc_hi
    v_mov_b32 v194, s10
    v_mov_b32 v195, s11
    v_bfi_b32 v192, v188, v192, v194
    v_bfi_b32 v193, v188, v193, v195
    s_mov_b32 exec_hi, 0
    v_mov_b32 v193, v192
    s_mov_b64 exec, s[32:33]
    v_add_u32 v200, v200, v193
    s_bfe_u32 s10, s97, 0x10007
    s_lshl1_add_u32 s10, s4, s10
    s_lshl_b32 s10, s10, 2
    v_cndmask_b32 v188, 4, 0, s[34:35]
    ds_write_b16 v178, v200 offset:1026
    ds_write_b16_d16_hi v178, v200 offset:2050
    s_mov_b32 exec_hi, 0
    v_xor_b32 v188, s10, v188
    ds_write_b32 v179, v188
    s_mov_b64 exec, -1
    s_min_u32 s10, s31, s96
    s_max_u32 s96, s31, s96
    s_mov_b32 s31, s10
    s_add_u32 s10, s96, s19
    s_mul_i32 s11, s30, 9216
    s_lshr_b32 s11, s11, 16
    s_max_u32 s10, s10, s11
    s_cmp_lt_u32 s10, 1152
    s_cbranch_scc1 L_LFIT
    ds_write_b32 v197, v184
L_LFIT:
    s_cmp_lg_u32 s19, 0
    s_cbranch_scc1 L_XCN
L_XCNR:
    s_lshl_b32 m0, s3, 10
    v_mov_b32 v240, v219
    s_add_u32 m0, m0, 37888
    s_nop 0
    buffer_load_dwordx4 v[240:241], s[44:47], 0 idxen offen lds
    v_and_or_b32 v128, v128, s17, v152
    v_or_b32 v204, v204, v176
    v_and_b32 v129, s17, v129
    v_and_b32 v130, s17, v130
    v_and_or_b32 v132, v132, s17, v153
    v_or_b32 v208, v208, v176
    v_and_b32 v133, s17, v133
    v_and_b32 v134, s17, v134
    v_and_or_b32 v136, v136, s17, v154
    v_or_b32 v212, v212, v176
    v_and_b32 v137, s17, v137
    v_and_b32 v138, s17, v138
    v_and_or_b32 v140, v140, s17, v155
    v_or_b32 v216, v216, v176
    v_and_b32 v141, s17, v141
    v_and_b32 v142, s17, v142
    s_waitcnt lgkmcnt(0)
    s_barrier
    ds_read_b64 v[202:203], v197
    ds_read_u16 v96, v96 offset:1026
    ds_read_u16 v97, v97 offset:1026
    ds_read_u16 v98, v98 offset:1026
    ds_read_u16 v100, v100 offset:1026
    ds_read_u16 v101, v101 offset:1026
    ds_read_u16 v102, v102 offset:1026
    ds_read_u16 v104, v104 offset:1026
    ds_read_u16 v105, v105 offset:1026
    ds_read_u16 v106, v106 offset:1026
    ds_read_u16 v108, v108 offset:1026
    ds_read_u16 v109, v109 offset:1026
    ds_read_u16 v110, v110 offset:1026
    s_add_u32 s24, s24, s7
    s_add_u32 s11, s25, s7
    s_and_b32 s10, s11, 15
    s_cmp_lt_u32 s11, s24
    s_cselect_b32 s25, s10, 16
    s_cmp_lg_u32 s97, 0
    s_cselect_b32 s23, s8, s11
    s_cselect_b32 s7, s8, s24
    s_cselect_b32 s8, s11, s8
    s_cselect_b32 s24, s9, s24
    s_cselect_b32 s9, s11, s9
    s_min_u32 s22, s8, 192
    s_min_u32 s23, s23, 192
    s_mov_b32 s30, s19
    s_waitcnt lgkmcnt(12)
    v_cmp_ne_u32 vcc, 0, v202
    v_readfirstlane_b32 s19, v203
    s_cbranch_vccnz L_OVF
    s_waitcnt lgkmcnt(11)
    v_add_u32 v96, v96, v112
    s_mov_b64 exec, s[64:65]
    ds_write2st64_b32 v96, v128, v204 offset0:148 offset1:220
    s_mov_b64 exec, -1
    s_waitcnt lgkmcnt(11)
    v_add_u32 v97, v97, v113
    s_mov_b64 exec, s[66:67]
    ds_write2st64_b32 v97, v129, v205 offset0:148 offset1:220
    s_mov_b64 exec, -1
    s_waitcnt lgkmcnt(11)
    v_add_u32 v98, v98, v114
    s_mov_b64 exec, s[68:69]
    ds_write2st64_b32 v98, v130, v206 offset0:148 offset1:220
    s_mov_b64 exec, -1
    s_waitcnt lgkmcnt(11)
    v_add_u32 v100, v100, v116
    s_mov_b64 exec, s[72:73]
    ds_write2st64_b32 v100, v132, v208 offset0:148 offset1:220
    s_mov_b64 exec, -1
    s_waitcnt lgkmcnt(11)
    v_add_u32 v101, v101, v117
    s_mov_b64 exec, s[74:75]
    ds_write2st64_b32 v101, v133, v209 offset0:148 offset1:220
    s_mov_b64 exec, -1
    s_waitcnt lgkmcnt(11)
    v_add_u32 v102, v102, v118
    s_mov_b64 exec, s[76:77]
    ds_write2st64_b32 v102, v134, v210 offset0:148 offset1:220
    s_mov_b64 exec, -1
    s_waitcnt lgkmcnt(11)
    v_add_u32 v104, v104, v120
    s_mov_b64 exec, s[80:81]
    ds_write2st64_b32 v104, v136, v212 offset0:148 offset1:220
    s_mov_b64 exec, -1
    s_waitcnt lgkmcnt(11)
    v_add_u32 v105, v105, v121
    s_mov_b64 exec, s[82:83]
    ds_write2st64_b32 v105, v137, v213 offset0:148 offset1:220
    s_mov_b64 exec, -1
    s_waitcnt lgkmcnt(11)
    v_add_u32 v106, v106, v122
    s_mov_b64 exec, s[84:85]
    ds_write2st64_b32 v106, v138, v214 offset0:148 offset1:220
    s_mov_b64 exec, -1
    s_waitcnt lgkmcnt(11)
    v_add_u32 v108, v108, v124
    s_mov_b64 exec, s[88:89]
    ds_write2st64_b32 v108, v140, v216 offset0:148 offset1:220
    s_mov_b64 exec, -1
    s_waitcnt lgkmcnt(11)
    v_add_u32 v109, v109, v125
    s_mov_b64 exec, s[90:91]
    ds_write2st64_b32 v109, v141, v217 offset0:148 offset1:220
    s_mov_b64 exec, -1
    s_waitcnt lgkmcnt(11)
    v_add_u32 v110, v110, v126
    s_mov_b64 exec, s[92:93]
    ds_write2st64_b32 v110, v142, v218 offset0:148 offset1:220
    s_mov_b64 exec, -1
    s_add_u32 s10, s96, 127
    s_lshr_b32 s10, s10, 7
    s_lshl1_add_u32 s10, s10, -1
    s_add_u32 s11, s31, 127
    s_lshr_b32 s11, s11, 6
    s_and_b32 s11, s11, -2
    s_max_i32 s17, s10, s11
    s_cselect_b32 s10, s96, s31
    s_sub_u32 s10, s10, 1
    s_andn2_b32 s99, 64, s10
L_CA:
    s_cmp_lg_u32 s21, 0
    s_cbranch_scc1 L_XT2
L_XT2R:
    ds_read_b64_tr_b16 v[96:97], v225 offset:0
    ds_read_b64_tr_b16 v[98:99], v225 offset:1280
    ds_read_b64_tr_b16 v[100:101], v225 offset:5120
    ds_read_b64_tr_b16 v[102:103], v225 offset:6400
    ds_read_b64_tr_b16 v[104:105], v225 offset:32
    ds_read_b64_tr_b16 v[106:107], v225 offset:1312
    ds_read_b64_tr_b16 v[108:109], v225 offset:5152
    ds_read_b64_tr_b16 v[110:111], v225 offset:6432
    ds_read_b64_tr_b16 v[112:113], v225 offset:64
    ds_read_b64_tr_b16 v[114:115], v225 offset:1344
    ds_read_b64_tr_b16 v[116:117], v225 offset:5184
    ds_read_b64_tr_b16 v[118:119], v225 offset:6464
    ds_read_b64_tr_b16 v[120:121], v225 offset:96
    ds_read_b64_tr_b16 v[122:123], v225 offset:1376
    ds_read_b64_tr_b16 v[124:125], v225 offset:5216
    ds_read_b64_tr_b16 v[126:127], v225 offset:6496
    s_waitcnt vmcnt(0) lgkmcnt(0)
    s_barrier
    s_cmp_lg_u32 s30, 0
    s_cbranch_scc1 L_XT3
L_XT3R:
    s_mov_b32 s10, 0x358637bd
    ds_read_b128 v[236:239], v247
    ds_read_b32 v240, v248
    v_lshrrev_b32 v188, 2, v253
    v_and_b32 v188, 12, v188
    v_subrev_u32 v188, s25, v188
    s_waitcnt lgkmcnt(0)
    s_cmp_ge_u32 s3, 4
    s_cbranch_scc1 L_LATE0
    s_add_u32 m0, s13, 0
    v_mad_u32_u16 v236, v236, s15, v243
    buffer_load_dwordx4 v236, s[40:43], 0 offen lds
    s_add_u32 m0, s13, 1056
    v_mad_u32_u16 v237, v237, s15, v243
    buffer_load_dwordx4 v237, s[40:43], 0 offen lds
    s_add_u32 m0, s13, 2112
    v_mad_u32_u16 v238, v238, s15, v243
    buffer_load_dwordx4 v238, s[40:43], 0 offen lds
    s_add_u32 m0, s13, 3168
    v_mad_u32_u16 v239, v239, s15, v243
    buffer_load_dwordx4 v239, s[40:43], 0 offen lds
    s_mov_b32 m0, s14
    v_and_b32 v240, 0xfffff, v240
    buffer_load_dwordx4 v[240:241], s[44:47], 0 idxen offen lds
L_LATE0:
    s_lshl_b32 s34, s22, 5
    s_lshl_b32 s35, s23, 5
    s_mov_b32 vcc_lo, 0xff00ff00
    s_mov_b32 vcc_hi, 0xff00ff00
    v_mov_b32 v176, s35
    v_mov_b32 v177, s34
    v_cndmask_b32 v176, v176, v177, vcc
    v_and_b32 v177, 4, v253
    v_lshlrev_b32 v177, 6, v177
    v_lshl_add_u32 v177, v246, 2, v177
    v_sub_u32 v177, v177, v176
    v_and_b32 v178, 48, v253
    s_movk_i32 s34, 832
    v_mad_u32_u24 v178, v246, s34, v178
    s_mov_b32 s34, 116736
    v_add3_u32 v178, v178, v176, s34
    v_and_b32 v176, 0x1ff, v177
    v_add_u32 v176, v176, v178
    ds_read_b128 v[160:163], v176 offset:0
    ds_read_b128 v[164:167], v176 offset:64
    v_add_u32 v177, 0x80, v177
    v_and_b32 v176, 0x1ff, v177
    v_add_u32 v176, v176, v178
    ds_read_b128 v[168:171], v176 offset:0
    ds_read_b128 v[172:175], v176 offset:64
    s_mov_b32 s34, 0xbfb8aa3b
    s_mov_b32 s35, s34
    s_waitcnt lgkmcnt(3)
    v_mfma_f32_16x16x32_bf16 v[204:207], v[160:163], v[96:99], 0
    v_mfma_f32_16x16x32_bf16 v[212:215], v[160:163], v[104:107], 0
    v_mfma_f32_16x16x32_bf16 v[220:223], v[160:163], v[112:115], 0
    v_mfma_f32_16x16x32_bf16 v[228:231], v[160:163], v[120:123], 0
    s_waitcnt lgkmcnt(2)
    v_mfma_f32_16x16x32_bf16 v[204:207], v[164:167], v[100:103], v[204:207]
    v_mfma_f32_16x16x32_bf16 v[212:215], v[164:167], v[108:111], v[212:215]
    v_mfma_f32_16x16x32_bf16 v[220:223], v[164:167], v[116:119], v[220:223]
    v_mfma_f32_16x16x32_bf16 v[228:231], v[164:167], v[124:127], v[228:231]
    s_waitcnt lgkmcnt(1)
    v_mfma_f32_16x16x32_bf16 v[208:211], v[168:171], v[96:99], 0
    v_mfma_f32_16x16x32_bf16 v[216:219], v[168:171], v[104:107], 0
    v_mfma_f32_16x16x32_bf16 v[224:227], v[168:171], v[112:115], 0
    v_mfma_f32_16x16x32_bf16 v[232:235], v[168:171], v[120:123], 0
    s_waitcnt lgkmcnt(0)
    v_mfma_f32_16x16x32_bf16 v[208:211], v[172:175], v[100:103], v[208:211]
    v_mfma_f32_16x16x32_bf16 v[216:219], v[172:175], v[108:111], v[216:219]
    v_mfma_f32_16x16x32_bf16 v[224:227], v[172:175], v[116:119], v[224:227]
    v_mfma_f32_16x16x32_bf16 v[232:235], v[172:175], v[124:127], v[232:235]
    s_mov_b32 s11, s10
    v_mov_b32 v189, s10
    v_mov_b64 v[96:97], s[10:11]
    v_mov_b64 v[98:99], s[10:11]
    v_mov_b64 v[100:101], s[10:11]
    v_mov_b64 v[102:103], s[10:11]
    v_mov_b64 v[104:105], s[10:11]
    v_mov_b64 v[106:107], s[10:11]
    v_mov_b64 v[108:109], s[10:11]
    v_mov_b64 v[110:111], s[10:11]
    v_cmp_ne_u32 vcc, 0, v188
    v_mov_b64 v[112:113], 0
    v_mov_b64 v[114:115], 0
    v_cndmask_b32 v128, 0, v189, vcc
    v_cmp_ne_u32 vcc, -1, v188
    v_mov_b64 v[116:117], 0
    v_mov_b64 v[118:119], 0
    v_cndmask_b32 v129, 0, v189, vcc
    v_cmp_ne_u32 vcc, -2, v188
    v_mov_b64 v[120:121], 0
    v_mov_b64 v[122:123], 0
    v_cndmask_b32 v130, 0, v189, vcc
    v_cmp_ne_u32 vcc, -3, v188
    v_mov_b64 v[124:125], 0
    v_mov_b64 v[126:127], 0
    v_cndmask_b32 v131, 0, v189, vcc
    v_mov_b64 v[144:145], 0
    v_mov_b64 v[146:147], 0
    v_mov_b64 v[148:149], 0
    v_mov_b64 v[150:151], 0
    v_mov_b64 v[152:153], 0
    v_mov_b64 v[154:155], 0
    v_mov_b64 v[156:157], 0
    v_mov_b64 v[158:159], 0
    v_mov_b64 v[132:133], v[128:129]
    v_mov_b64 v[134:135], v[130:131]
    v_mov_b64 v[136:137], v[128:129]
    v_mov_b64 v[138:139], v[130:131]
    v_mov_b64 v[140:141], v[128:129]
    v_mov_b64 v[142:143], v[130:131]
    v_pk_mul_f32 v[204:205], v[204:205], s[34:35]
    v_pk_mul_f32 v[206:207], v[206:207], s[34:35]
    v_pk_mul_f32 v[208:209], v[208:209], s[34:35]
    v_pk_mul_f32 v[210:211], v[210:211], s[34:35]
    v_pk_mul_f32 v[212:213], v[212:213], s[34:35]
    v_pk_mul_f32 v[214:215], v[214:215], s[34:35]
    v_pk_mul_f32 v[216:217], v[216:217], s[34:35]
    v_pk_mul_f32 v[218:219], v[218:219], s[34:35]
    v_pk_mul_f32 v[220:221], v[220:221], s[34:35]
    v_pk_mul_f32 v[222:223], v[222:223], s[34:35]
    v_pk_mul_f32 v[224:225], v[224:225], s[34:35]
    v_pk_mul_f32 v[226:227], v[226:227], s[34:35]
    v_pk_mul_f32 v[228:229], v[228:229], s[34:35]
    v_pk_mul_f32 v[230:231], v[230:231], s[34:35]
    v_pk_mul_f32 v[232:233], v[232:233], s[34:35]
    v_pk_mul_f32 v[234:235], v[234:235], s[34:35]
    v_cvt_pk_bf16_f32 v64, v204, v205
    v_cvt_pk_bf16_f32 v65, v206, v207
    v_cvt_pk_bf16_f32 v66, v208, v209
    v_cvt_pk_bf16_f32 v67, v210, v211
    v_cvt_pk_bf16_f32 v68, v212, v213
    v_cvt_pk_bf16_f32 v69, v214, v215
    v_cvt_pk_bf16_f32 v70, v216, v217
    v_cvt_pk_bf16_f32 v71, v218, v219
    v_cvt_pk_bf16_f32 v72, v220, v221
    v_cvt_pk_bf16_f32 v73, v222, v223
    v_cvt_pk_bf16_f32 v74, v224, v225
    v_cvt_pk_bf16_f32 v75, v226, v227
    v_cvt_pk_bf16_f32 v76, v228, v229
    v_cvt_pk_bf16_f32 v77, v230, v231
    v_cvt_pk_bf16_f32 v78, v232, v233
    v_cvt_pk_bf16_f32 v79, v234, v235
    v_permlane32_swap_b32 v80, v64
    v_permlane32_swap_b32 v81, v65
    v_permlane32_swap_b32 v82, v66
    v_permlane32_swap_b32 v83, v67
    v_permlane32_swap_b32 v84, v68
    v_permlane32_swap_b32 v85, v69
    v_permlane32_swap_b32 v86, v70
    v_permlane32_swap_b32 v87, v71
    v_permlane32_swap_b32 v88, v72
    v_permlane32_swap_b32 v89, v73
    v_permlane32_swap_b32 v90, v74
    v_permlane32_swap_b32 v91, v75
    v_permlane32_swap_b32 v92, v76
    v_permlane32_swap_b32 v93, v77
    v_permlane32_swap_b32 v94, v78
    v_permlane32_swap_b32 v95, v79
    s_mov_b32 s26, -1
    s_mov_b64 s[32:33], 0
    s_mov_b32 s28, 0
    s_mov_b32 s29, 0
    s_cmp_lt_u32 s3, 4
    s_cbranch_scc1 L_GO
    s_add_u32 m0, s13, 0
    v_mad_u32_u16 v236, v236, s15, v243
    buffer_load_dwordx4 v236, s[40:43], 0 offen lds
    s_add_u32 m0, s13, 1056
    v_mad_u32_u16 v237, v237, s15, v243
    buffer_load_dwordx4 v237, s[40:43], 0 offen lds
    s_add_u32 m0, s13, 2112
    v_mad_u32_u16 v238, v238, s15, v243
    buffer_load_dwordx4 v238, s[40:43], 0 offen lds
    s_add_u32 m0, s13, 3168
    v_mad_u32_u16 v239, v239, s15, v243
    buffer_load_dwordx4 v239, s[40:43], 0 offen lds
    s_mov_b32 m0, s14
    v_and_b32 v240, 0xfffff, v240
    buffer_load_dwordx4 v[240:241], s[44:47], 0 idxen offen lds
L_GO:
    ds_read_u16 v251, v249 offset:0
    ds_read_u16 v252, v249 offset:64
    ds_read_b128 v[236:239], v247 offset:1152
    ds_read_b32 v240, v248 offset:1152
    s_lshr_b32 s10, s4, 1
    s_lshl_b32 s10, s10, 8
    s_add_u32 s10, s10, 155776
    v_lshl_add_u32 v255, v253, 2, s10
    s_bitcmp1_b32 s4, 0
    s_cselect_b32 s101, -1, 1
    s_max_i32 s10, s17, 1
    s_sub_u32 s10, s10, 1
    s_mul_i32 s10, s101, s10
    s_lshl_b32 s10, s10, 24
    v_mov_b32 v204, s10
    ds_add_u32 v255, v204
    v_mov_b32 v253, 0
    s_mov_b32 exec_hi, 0
    v_add_u32 v253, 0x200, v245
    s_mov_b32 exec_hi, -1
    v_mov_b64 v[204:205], 0
    v_mov_b64 v[206:207], 0
    v_mov_b64 v[208:209], 0
    v_mov_b64 v[210:211], 0
    v_mov_b64 v[212:213], 0
    v_mov_b64 v[214:215], 0
    v_mov_b64 v[216:217], 0
    v_mov_b64 v[218:219], 0
    v_mov_b64 v[220:221], 0
    v_mov_b64 v[222:223], 0
    v_mov_b64 v[224:225], 0
    v_mov_b64 v[226:227], 0
    v_mov_b64 v[228:229], 0
    v_mov_b64 v[230:231], 0
    v_mov_b64 v[232:233], 0
    v_mov_b64 v[234:235], 0
    v_mov_b64 v[184:185], 0
    v_mov_b64 v[186:187], 0
    s_waitcnt lgkmcnt(0)
    v_bfi_b32 v251, 31, v245, v251
    v_bfi_b32 v252, 31, v245, v252
    v_max_u32 v251, v251, v245
    v_max_u32 v252, v252, v253
    s_waitcnt vmcnt(0)
    ds_read_b128 v[176:179], v251
    ds_read_b128 v[180:183], v252
    ds_read_b128 v[160:163], v244 offset:0
    ds_read_b128 v[168:171], v244 offset:512
    ds_read_b128 v[164:167], v244 offset:64
    ds_read_b128 v[172:175], v244 offset:576
    s_cmp_lt_i32 s17, 1
    s_cbranch_scc1 L_DONE
    s_waitcnt lgkmcnt(4)
    v_mfma_f32_16x16x32_bf16 v[188:191], v[176:179], v[64:67], 0
    v_mfma_f32_16x16x32_bf16 v[196:199], v[176:179], v[68:71], 0
    v_mfma_f32_16x16x32_bf16 v[192:195], v[180:183], v[64:67], 0
    v_mfma_f32_16x16x32_bf16 v[200:203], v[180:183], v[68:71], 0
    s_waitcnt lgkmcnt(0)
    v_mfma_f32_16x16x32_bf16 v[188:191], v[160:163], v[0:3], v[188:191]
    v_mfma_f32_16x16x32_bf16 v[196:199], v[160:163], v[8:11], v[196:199]
    v_mfma_f32_16x16x32_bf16 v[192:195], v[168:171], v[0:3], v[192:195]
    v_mfma_f32_16x16x32_bf16 v[200:203], v[168:171], v[8:11], v[200:203]
    v_mfma_f32_16x16x32_bf16 v[188:191], v[164:167], v[4:7], v[188:191]
    v_mfma_f32_16x16x32_bf16 v[196:199], v[164:167], v[12:15], v[196:199]
    v_mfma_f32_16x16x32_bf16 v[192:195], v[172:175], v[4:7], v[192:195]
    v_mfma_f32_16x16x32_bf16 v[200:203], v[172:175], v[12:15], v[200:203]
    s_mov_b32 s16, 1
    s_cmp_eq_u32 s17, 1
    s_cbranch_scc1 L_LT0
    s_add_u32 m0, s13, 0
    v_mad_u32_u16 v236, v236, s15, v243
    buffer_load_dwordx4 v236, s[40:43], 0 offen lds
    s_add_u32 m0, s13, 1056
    v_mad_u32_u16 v237, v237, s15, v243
    buffer_load_dwordx4 v237, s[40:43], 0 offen lds
    s_add_u32 m0, s13, 2112
    v_mad_u32_u16 v238, v238, s15, v243
    buffer_load_dwordx4 v238, s[40:43], 0 offen lds
    s_add_u32 m0, s13, 3168
    v_mad_u32_u16 v239, v239, s15, v243
    buffer_load_dwordx4 v239, s[40:43], 0 offen lds
    s_mov_b32 m0, s14
    v_and_b32 v240, 0xfffff, v240
    buffer_load_dwordx4 v[240:241], s[44:47], 0 idxen offen lds
.p2align 6
L_LOOP1:
    s_setprio 1
    v_smfmac_f32_16x16x64_bf16 v[152:155], v[184:187], v[204:211], v242
    ds_read_u16 v236, v250 offset:0
    ds_read_u16 v237, v250 offset:16
    ds_add_rtn_u32 v238, v255, v242
    v_exp_f32 v188, v188
    v_smfmac_f32_16x16x64_bf16 v[156:159], v[184:187], v[212:219], v242
    v_exp_f32 v189, v189
    v_mfma_f32_16x16x32_bf16 v[204:207], v[160:163], v[32:35], 0
    v_exp_f32 v190, v190
    v_mfma_f32_16x16x32_bf16 v[212:215], v[160:163], v[40:43], 0
    v_exp_f32 v191, v191
    v_mfma_f32_16x16x32_bf16 v[208:211], v[168:171], v[32:35], 0
    v_exp_f32 v192, v192
    v_mfma_f32_16x16x32_bf16 v[216:219], v[168:171], v[40:43], 0
    v_exp_f32 v193, v193
    v_mfma_f32_16x16x32_bf16 v[204:207], v[164:167], v[36:39], v[204:207]
    v_exp_f32 v194, v194
    v_mfma_f32_16x16x32_bf16 v[212:215], v[164:167], v[44:47], v[212:215]
    v_exp_f32 v195, v195
    v_mfma_f32_16x16x32_bf16 v[208:211], v[172:175], v[36:39], v[208:211]
    s_waitcnt lgkmcnt(0)
    v_bfi_b32 v236, 31, v246, v236
    v_bfi_b32 v237, 31, v246, v237
    v_readfirstlane_b32 s96, v238
    v_exp_f32 v196, v196
    v_mfma_f32_16x16x32_bf16 v[216:219], v[172:175], v[44:47], v[216:219]
    v_exp_f32 v197, v197
    s_setprio 3
    v_smfmac_f32_16x16x64_bf16 v[136:139], v[184:187], v[220:227], v242
    v_exp_f32 v198, v198
    v_smfmac_f32_16x16x64_bf16 v[140:143], v[184:187], v[228:235], v242
    v_exp_f32 v199, v199
    v_exp_f32 v200, v200
    v_exp_f32 v201, v201
    v_exp_f32 v202, v202
    v_exp_f32 v203, v203
    v_pk_add_f32 v[188:189], v[188:189], 1.0 op_sel_hi:[1,0]
    v_pk_add_f32 v[190:191], v[190:191], 1.0 op_sel_hi:[1,0]
    v_pk_add_f32 v[192:193], v[192:193], 1.0 op_sel_hi:[1,0]
    v_pk_add_f32 v[194:195], v[194:195], 1.0 op_sel_hi:[1,0]
    v_pk_add_f32 v[196:197], v[196:197], 1.0 op_sel_hi:[1,0]
    v_pk_add_f32 v[198:199], v[198:199], 1.0 op_sel_hi:[1,0]
    v_pk_add_f32 v[200:201], v[200:201], 1.0 op_sel_hi:[1,0]
    v_pk_add_f32 v[202:203], v[202:203], 1.0 op_sel_hi:[1,0]
    s_setprio 1
    v_mfma_f32_16x16x32_bf16 v[220:223], v[176:179], v[72:75], 0
    ds_read_b64_tr_b16 v[184:185], v236
    ds_read_b64_tr_b16 v[186:187], v237
    ds_read_u16 v251, v249 offset:1152
    ds_read_u16 v252, v249 offset:1216
    v_rcp_f32 v188, v188
    v_mfma_f32_16x16x32_bf16 v[228:231], v[176:179], v[76:79], 0
    s_ashr_i32 s96, s96, 24
    s_mul_i32 s96, s96, s101
    v_rcp_f32 v189, v189
    v_mfma_f32_16x16x32_bf16 v[224:227], v[180:183], v[72:75], 0
    v_rcp_f32 v190, v190
    v_mfma_f32_16x16x32_bf16 v[232:235], v[180:183], v[76:79], 0
    v_rcp_f32 v191, v191
    v_mfma_f32_16x16x32_bf16 v[220:223], v[160:163], v[16:19], v[220:223]
    v_rcp_f32 v192, v192
    v_mfma_f32_16x16x32_bf16 v[228:231], v[160:163], v[24:27], v[228:231]
    v_rcp_f32 v193, v193
    v_mfma_f32_16x16x32_bf16 v[224:227], v[168:171], v[16:19], v[224:227]
    s_waitcnt lgkmcnt(0)
    v_bfi_b32 v251, 31, v245, v251
    v_bfi_b32 v252, 31, v245, v252
    v_max_u32 v251, v251, v245
    v_max_u32 v252, v252, v253
    ds_read_b128 v[236:239], v247 offset:128
    ds_read_b32 v240, v248 offset:128
    s_add_u32 s16, s16, 1
    v_rcp_f32 v194, v194
    v_mfma_f32_16x16x32_bf16 v[232:235], v[168:171], v[24:27], v[232:235]
    v_rcp_f32 v195, v195
    v_mfma_f32_16x16x32_bf16 v[220:223], v[164:167], v[20:23], v[220:223]
    v_rcp_f32 v196, v196
    v_mfma_f32_16x16x32_bf16 v[228:231], v[164:167], v[28:31], v[228:231]
    v_rcp_f32 v197, v197
    s_setprio 3
    v_mfma_f32_16x16x32_bf16 v[224:227], v[172:175], v[20:23], v[224:227]
    v_rcp_f32 v198, v198
    v_mfma_f32_16x16x32_bf16 v[232:235], v[172:175], v[28:31], v[232:235]
    v_rcp_f32 v199, v199
    v_rcp_f32 v200, v200
    v_rcp_f32 v201, v201
    v_rcp_f32 v202, v202
    v_rcp_f32 v203, v203
    v_pk_mul_f32 v[204:205], v[188:189], v[204:205]
    v_pk_mul_f32 v[206:207], v[190:191], v[206:207]
    v_pk_mul_f32 v[208:209], v[192:193], v[208:209]
    v_pk_mul_f32 v[210:211], v[194:195], v[210:211]
    v_pk_mul_f32 v[212:213], v[196:197], v[212:213]
    v_pk_mul_f32 v[214:215], v[198:199], v[214:215]
    v_pk_mul_f32 v[216:217], v[200:201], v[216:217]
    v_pk_mul_f32 v[218:219], v[202:203], v[218:219]
    s_cmp_ge_i32 s96, 1
    s_cbranch_scc0 L_PB00
L_PB01:
    s_setprio 1
    v_smfmac_f32_16x16x64_bf16 v[112:115], v[184:187], v[204:211], v242
    v_exp_f32 v220, v220
    v_smfmac_f32_16x16x64_bf16 v[116:119], v[184:187], v[212:219], v242
    v_exp_f32 v221, v221
    s_waitcnt vmcnt(0)
    ds_read_b128 v[176:179], v251
    ds_read_b128 v[180:183], v252
    v_mfma_f32_16x16x32_bf16 v[204:207], v[160:163], v[48:51], 0
    v_exp_f32 v222, v222
    v_mfma_f32_16x16x32_bf16 v[212:215], v[160:163], v[56:59], 0
    ds_read_b128 v[160:163], v244 offset:0
    v_exp_f32 v223, v223
    v_mfma_f32_16x16x32_bf16 v[208:211], v[168:171], v[48:51], 0
    v_exp_f32 v224, v224
    v_mfma_f32_16x16x32_bf16 v[216:219], v[168:171], v[56:59], 0
    ds_read_b128 v[168:171], v244 offset:512
    v_exp_f32 v225, v225
    v_mfma_f32_16x16x32_bf16 v[204:207], v[164:167], v[52:55], v[204:207]
    v_exp_f32 v226, v226
    v_mfma_f32_16x16x32_bf16 v[212:215], v[164:167], v[60:63], v[212:215]
    ds_read_b128 v[164:167], v244 offset:64
    v_exp_f32 v227, v227
    v_mfma_f32_16x16x32_bf16 v[208:211], v[172:175], v[52:55], v[208:211]
    v_exp_f32 v228, v228
    v_mfma_f32_16x16x32_bf16 v[216:219], v[172:175], v[60:63], v[216:219]
    ds_read_b128 v[172:175], v244 offset:576
    v_exp_f32 v229, v229
    s_setprio 3
    v_smfmac_f32_16x16x64_bf16 v[96:99], v[184:187], v[188:195], v242
    v_exp_f32 v230, v230
    v_smfmac_f32_16x16x64_bf16 v[100:103], v[184:187], v[196:203], v242
    v_exp_f32 v231, v231
    v_exp_f32 v232, v232
    v_exp_f32 v233, v233
    v_exp_f32 v234, v234
    v_exp_f32 v235, v235
    v_pk_add_f32 v[220:221], v[220:221], 1.0 op_sel_hi:[1,0]
    v_pk_add_f32 v[222:223], v[222:223], 1.0 op_sel_hi:[1,0]
    v_pk_add_f32 v[224:225], v[224:225], 1.0 op_sel_hi:[1,0]
    v_pk_add_f32 v[226:227], v[226:227], 1.0 op_sel_hi:[1,0]
    v_pk_add_f32 v[228:229], v[228:229], 1.0 op_sel_hi:[1,0]
    v_pk_add_f32 v[230:231], v[230:231], 1.0 op_sel_hi:[1,0]
    v_pk_add_f32 v[232:233], v[232:233], 1.0 op_sel_hi:[1,0]
    v_pk_add_f32 v[234:235], v[234:235], 1.0 op_sel_hi:[1,0]
    s_setprio 1
    s_waitcnt lgkmcnt(4)
    v_mfma_f32_16x16x32_bf16 v[188:191], v[176:179], v[80:83], 0
    v_rcp_f32 v220, v220
    v_mfma_f32_16x16x32_bf16 v[196:199], v[176:179], v[84:87], 0
    v_rcp_f32 v221, v221
    v_mfma_f32_16x16x32_bf16 v[192:195], v[180:183], v[80:83], 0
    v_rcp_f32 v222, v222
    v_mfma_f32_16x16x32_bf16 v[200:203], v[180:183], v[84:87], 0
    v_rcp_f32 v223, v223
    s_waitcnt lgkmcnt(3)
    v_mfma_f32_16x16x32_bf16 v[188:191], v[160:163], v[0:3], v[188:191]
    v_rcp_f32 v224, v224
    v_mfma_f32_16x16x32_bf16 v[196:199], v[160:163], v[8:11], v[196:199]
    v_rcp_f32 v225, v225
    s_waitcnt lgkmcnt(2)
    v_mfma_f32_16x16x32_bf16 v[192:195], v[168:171], v[0:3], v[192:195]
    v_rcp_f32 v226, v226
    v_mfma_f32_16x16x32_bf16 v[200:203], v[168:171], v[8:11], v[200:203]
    v_rcp_f32 v227, v227
    s_waitcnt lgkmcnt(1)
    v_mfma_f32_16x16x32_bf16 v[188:191], v[164:167], v[4:7], v[188:191]
    v_rcp_f32 v228, v228
    v_mfma_f32_16x16x32_bf16 v[196:199], v[164:167], v[12:15], v[196:199]
    v_rcp_f32 v229, v229
    s_setprio 3
    s_waitcnt lgkmcnt(0)
    v_mfma_f32_16x16x32_bf16 v[192:195], v[172:175], v[4:7], v[192:195]
    s_cmp_lt_u32 s16, s17
    s_cbranch_scc0 L_ND01
    s_add_u32 m0, s13, 0
    v_mad_u32_u16 v236, v236, s15, v243
    buffer_load_dwordx4 v236, s[40:43], 0 offen lds
    s_add_u32 m0, s13, 1056
    v_mad_u32_u16 v237, v237, s15, v243
    buffer_load_dwordx4 v237, s[40:43], 0 offen lds
    s_add_u32 m0, s13, 2112
    v_mad_u32_u16 v238, v238, s15, v243
    buffer_load_dwordx4 v238, s[40:43], 0 offen lds
    s_add_u32 m0, s13, 3168
    v_mad_u32_u16 v239, v239, s15, v243
    buffer_load_dwordx4 v239, s[40:43], 0 offen lds
    s_mov_b32 m0, s14
    v_and_b32 v240, 0xfffff, v240
    buffer_load_dwordx4 v[240:241], s[44:47], 0 idxen offen lds
L_ND01:
    v_rcp_f32 v230, v230
    v_mfma_f32_16x16x32_bf16 v[200:203], v[172:175], v[12:15], v[200:203]
    v_rcp_f32 v231, v231
    v_rcp_f32 v232, v232
    v_rcp_f32 v233, v233
    v_rcp_f32 v234, v234
    v_rcp_f32 v235, v235
    v_pk_mul_f32 v[204:205], v[220:221], v[204:205]
    v_pk_mul_f32 v[206:207], v[222:223], v[206:207]
    v_pk_mul_f32 v[208:209], v[224:225], v[208:209]
    v_pk_mul_f32 v[210:211], v[226:227], v[210:211]
    v_pk_mul_f32 v[212:213], v[228:229], v[212:213]
    v_pk_mul_f32 v[214:215], v[230:231], v[214:215]
    v_pk_mul_f32 v[216:217], v[232:233], v[216:217]
    v_pk_mul_f32 v[218:219], v[234:235], v[218:219]
    s_cmp_ge_u32 s16, s17
    s_cbranch_scc1 L_LT1
    s_setprio 1
    v_smfmac_f32_16x16x64_bf16 v[120:123], v[184:187], v[204:211], v242
    ds_read_u16 v236, v250 offset:1152
    ds_read_u16 v237, v250 offset:1168
    ds_add_rtn_u32 v238, v255, v242
    v_exp_f32 v188, v188
    v_smfmac_f32_16x16x64_bf16 v[124:127], v[184:187], v[212:219], v242
    v_exp_f32 v189, v189
    v_mfma_f32_16x16x32_bf16 v[204:207], v[160:163], v[32:35], 0
    v_exp_f32 v190, v190
    v_mfma_f32_16x16x32_bf16 v[212:215], v[160:163], v[40:43], 0
    v_exp_f32 v191, v191
    v_mfma_f32_16x16x32_bf16 v[208:211], v[168:171], v[32:35], 0
    v_exp_f32 v192, v192
    v_mfma_f32_16x16x32_bf16 v[216:219], v[168:171], v[40:43], 0
    v_exp_f32 v193, v193
    v_mfma_f32_16x16x32_bf16 v[204:207], v[164:167], v[36:39], v[204:207]
    v_exp_f32 v194, v194
    v_mfma_f32_16x16x32_bf16 v[212:215], v[164:167], v[44:47], v[212:215]
    v_exp_f32 v195, v195
    v_mfma_f32_16x16x32_bf16 v[208:211], v[172:175], v[36:39], v[208:211]
    s_waitcnt lgkmcnt(0)
    v_bfi_b32 v236, 31, v246, v236
    v_bfi_b32 v237, 31, v246, v237
    v_readfirstlane_b32 s96, v238
    v_exp_f32 v196, v196
    v_mfma_f32_16x16x32_bf16 v[216:219], v[172:175], v[44:47], v[216:219]
    v_exp_f32 v197, v197
    s_setprio 3
    v_smfmac_f32_16x16x64_bf16 v[104:107], v[184:187], v[220:227], v242
    v_exp_f32 v198, v198
    v_smfmac_f32_16x16x64_bf16 v[108:111], v[184:187], v[228:235], v242
    v_exp_f32 v199, v199
    v_exp_f32 v200, v200
    v_exp_f32 v201, v201
    v_exp_f32 v202, v202
    v_exp_f32 v203, v203
    v_pk_add_f32 v[188:189], v[188:189], 1.0 op_sel_hi:[1,0]
    v_pk_add_f32 v[190:191], v[190:191], 1.0 op_sel_hi:[1,0]
    v_pk_add_f32 v[192:193], v[192:193], 1.0 op_sel_hi:[1,0]
    v_pk_add_f32 v[194:195], v[194:195], 1.0 op_sel_hi:[1,0]
    v_pk_add_f32 v[196:197], v[196:197], 1.0 op_sel_hi:[1,0]
    v_pk_add_f32 v[198:199], v[198:199], 1.0 op_sel_hi:[1,0]
    v_pk_add_f32 v[200:201], v[200:201], 1.0 op_sel_hi:[1,0]
    v_pk_add_f32 v[202:203], v[202:203], 1.0 op_sel_hi:[1,0]
    s_setprio 1
    v_mfma_f32_16x16x32_bf16 v[220:223], v[176:179], v[88:91], 0
    ds_read_b64_tr_b16 v[184:185], v236
    ds_read_b64_tr_b16 v[186:187], v237
    ds_read_u16 v251, v249 offset:128
    ds_read_u16 v252, v249 offset:192
    v_rcp_f32 v188, v188
    v_mfma_f32_16x16x32_bf16 v[228:231], v[176:179], v[92:95], 0
    s_ashr_i32 s96, s96, 24
    s_mul_i32 s96, s96, s101
    v_rcp_f32 v189, v189
    v_mfma_f32_16x16x32_bf16 v[224:227], v[180:183], v[88:91], 0
    v_rcp_f32 v190, v190
    v_mfma_f32_16x16x32_bf16 v[232:235], v[180:183], v[92:95], 0
    v_rcp_f32 v191, v191
    v_mfma_f32_16x16x32_bf16 v[220:223], v[160:163], v[16:19], v[220:223]
    v_rcp_f32 v192, v192
    v_mfma_f32_16x16x32_bf16 v[228:231], v[160:163], v[24:27], v[228:231]
    v_rcp_f32 v193, v193
    v_mfma_f32_16x16x32_bf16 v[224:227], v[168:171], v[16:19], v[224:227]
    s_waitcnt lgkmcnt(0)
    v_bfi_b32 v251, 31, v245, v251
    v_bfi_b32 v252, 31, v245, v252
    v_max_u32 v251, v251, v245
    v_max_u32 v252, v252, v253
    ds_read_b128 v[236:239], v247 offset:1280
    ds_read_b32 v240, v248 offset:1280
    s_add_u32 s16, s16, 1
    v_rcp_f32 v194, v194
    v_mfma_f32_16x16x32_bf16 v[232:235], v[168:171], v[24:27], v[232:235]
    v_add_u32 v247, 0x80, v247
    v_add_u32 v248, 0x80, v248
    v_add_u32 v249, 0x80, v249
    v_add_u32 v250, 0x80, v250
    v_rcp_f32 v195, v195
    v_mfma_f32_16x16x32_bf16 v[220:223], v[164:167], v[20:23], v[220:223]
    v_rcp_f32 v196, v196
    v_mfma_f32_16x16x32_bf16 v[228:231], v[164:167], v[28:31], v[228:231]
    v_rcp_f32 v197, v197
    s_setprio 3
    v_mfma_f32_16x16x32_bf16 v[224:227], v[172:175], v[20:23], v[224:227]
    v_rcp_f32 v198, v198
    v_mfma_f32_16x16x32_bf16 v[232:235], v[172:175], v[28:31], v[232:235]
    v_rcp_f32 v199, v199
    v_rcp_f32 v200, v200
    v_rcp_f32 v201, v201
    v_rcp_f32 v202, v202
    v_rcp_f32 v203, v203
    v_pk_mul_f32 v[204:205], v[188:189], v[204:205]
    v_pk_mul_f32 v[206:207], v[190:191], v[206:207]
    v_pk_mul_f32 v[208:209], v[192:193], v[208:209]
    v_pk_mul_f32 v[210:211], v[194:195], v[210:211]
    v_pk_mul_f32 v[212:213], v[196:197], v[212:213]
    v_pk_mul_f32 v[214:215], v[198:199], v[214:215]
    v_pk_mul_f32 v[216:217], v[200:201], v[216:217]
    v_pk_mul_f32 v[218:219], v[202:203], v[218:219]
    s_cmp_ge_i32 s96, 1
    s_cbranch_scc0 L_PB10
L_PB11:
    s_setprio 1
    v_smfmac_f32_16x16x64_bf16 v[144:147], v[184:187], v[204:211], v242
    v_exp_f32 v220, v220
    v_smfmac_f32_16x16x64_bf16 v[148:151], v[184:187], v[212:219], v242
    v_exp_f32 v221, v221
    s_waitcnt vmcnt(0)
    ds_read_b128 v[176:179], v251
    ds_read_b128 v[180:183], v252
    v_mfma_f32_16x16x32_bf16 v[204:207], v[160:163], v[48:51], 0
    v_exp_f32 v222, v222
    v_mfma_f32_16x16x32_bf16 v[212:215], v[160:163], v[56:59], 0
    ds_read_b128 v[160:163], v244 offset:0
    v_exp_f32 v223, v223
    v_mfma_f32_16x16x32_bf16 v[208:211], v[168:171], v[48:51], 0
    v_exp_f32 v224, v224
    v_mfma_f32_16x16x32_bf16 v[216:219], v[168:171], v[56:59], 0
    ds_read_b128 v[168:171], v244 offset:512
    v_exp_f32 v225, v225
    v_mfma_f32_16x16x32_bf16 v[204:207], v[164:167], v[52:55], v[204:207]
    v_exp_f32 v226, v226
    v_mfma_f32_16x16x32_bf16 v[212:215], v[164:167], v[60:63], v[212:215]
    ds_read_b128 v[164:167], v244 offset:64
    v_exp_f32 v227, v227
    v_mfma_f32_16x16x32_bf16 v[208:211], v[172:175], v[52:55], v[208:211]
    v_exp_f32 v228, v228
    v_mfma_f32_16x16x32_bf16 v[216:219], v[172:175], v[60:63], v[216:219]
    ds_read_b128 v[172:175], v244 offset:576
    v_exp_f32 v229, v229
    s_setprio 3
    v_smfmac_f32_16x16x64_bf16 v[128:131], v[184:187], v[188:195], v242
    v_exp_f32 v230, v230
    v_smfmac_f32_16x16x64_bf16 v[132:135], v[184:187], v[196:203], v242
    v_exp_f32 v231, v231
    v_exp_f32 v232, v232
    v_exp_f32 v233, v233
    v_exp_f32 v234, v234
    v_exp_f32 v235, v235
    v_pk_add_f32 v[220:221], v[220:221], 1.0 op_sel_hi:[1,0]
    v_pk_add_f32 v[222:223], v[222:223], 1.0 op_sel_hi:[1,0]
    v_pk_add_f32 v[224:225], v[224:225], 1.0 op_sel_hi:[1,0]
    v_pk_add_f32 v[226:227], v[226:227], 1.0 op_sel_hi:[1,0]
    v_pk_add_f32 v[228:229], v[228:229], 1.0 op_sel_hi:[1,0]
    v_pk_add_f32 v[230:231], v[230:231], 1.0 op_sel_hi:[1,0]
    v_pk_add_f32 v[232:233], v[232:233], 1.0 op_sel_hi:[1,0]
    v_pk_add_f32 v[234:235], v[234:235], 1.0 op_sel_hi:[1,0]
    s_setprio 1
    s_waitcnt lgkmcnt(4)
    v_mfma_f32_16x16x32_bf16 v[188:191], v[176:179], v[64:67], 0
    v_rcp_f32 v220, v220
    v_mfma_f32_16x16x32_bf16 v[196:199], v[176:179], v[68:71], 0
    v_rcp_f32 v221, v221
    v_mfma_f32_16x16x32_bf16 v[192:195], v[180:183], v[64:67], 0
    v_rcp_f32 v222, v222
    v_mfma_f32_16x16x32_bf16 v[200:203], v[180:183], v[68:71], 0
    v_rcp_f32 v223, v223
    s_waitcnt lgkmcnt(3)
    v_mfma_f32_16x16x32_bf16 v[188:191], v[160:163], v[0:3], v[188:191]
    v_rcp_f32 v224, v224
    v_mfma_f32_16x16x32_bf16 v[196:199], v[160:163], v[8:11], v[196:199]
    v_rcp_f32 v225, v225
    s_waitcnt lgkmcnt(2)
    v_mfma_f32_16x16x32_bf16 v[192:195], v[168:171], v[0:3], v[192:195]
    v_rcp_f32 v226, v226
    v_mfma_f32_16x16x32_bf16 v[200:203], v[168:171], v[8:11], v[200:203]
    v_rcp_f32 v227, v227
    s_waitcnt lgkmcnt(1)
    v_mfma_f32_16x16x32_bf16 v[188:191], v[164:167], v[4:7], v[188:191]
    v_rcp_f32 v228, v228
    v_mfma_f32_16x16x32_bf16 v[196:199], v[164:167], v[12:15], v[196:199]
    v_rcp_f32 v229, v229
    s_setprio 3
    s_waitcnt lgkmcnt(0)
    v_mfma_f32_16x16x32_bf16 v[192:195], v[172:175], v[4:7], v[192:195]
    s_cmp_lt_u32 s16, s17
    s_cbranch_scc0 L_ND11
    s_add_u32 m0, s13, 0
    v_mad_u32_u16 v236, v236, s15, v243
    buffer_load_dwordx4 v236, s[40:43], 0 offen lds
    s_add_u32 m0, s13, 1056
    v_mad_u32_u16 v237, v237, s15, v243
    buffer_load_dwordx4 v237, s[40:43], 0 offen lds
    s_add_u32 m0, s13, 2112
    v_mad_u32_u16 v238, v238, s15, v243
    buffer_load_dwordx4 v238, s[40:43], 0 offen lds
    s_add_u32 m0, s13, 3168
    v_mad_u32_u16 v239, v239, s15, v243
    buffer_load_dwordx4 v239, s[40:43], 0 offen lds
    s_mov_b32 m0, s14
    v_and_b32 v240, 0xfffff, v240
    buffer_load_dwordx4 v[240:241], s[44:47], 0 idxen offen lds
L_ND11:
    v_rcp_f32 v230, v230
    v_mfma_f32_16x16x32_bf16 v[200:203], v[172:175], v[12:15], v[200:203]
    v_rcp_f32 v231, v231
    v_rcp_f32 v232, v232
    v_rcp_f32 v233, v233
    v_rcp_f32 v234, v234
    v_rcp_f32 v235, v235
    v_pk_mul_f32 v[204:205], v[220:221], v[204:205]
    v_pk_mul_f32 v[206:207], v[222:223], v[206:207]
    v_pk_mul_f32 v[208:209], v[224:225], v[208:209]
    v_pk_mul_f32 v[210:211], v[226:227], v[210:211]
    v_pk_mul_f32 v[212:213], v[228:229], v[212:213]
    v_pk_mul_f32 v[214:215], v[230:231], v[214:215]
    v_pk_mul_f32 v[216:217], v[232:233], v[216:217]
    v_pk_mul_f32 v[218:219], v[234:235], v[218:219]
    s_cmp_lt_u32 s16, s17
    s_cbranch_scc1 L_LOOP1
    s_branch L_LT0
.p2align 6
L_LOOP0:
    s_setprio 0
    v_smfmac_f32_16x16x64_bf16 v[152:155], v[184:187], v[204:211], v242
    ds_read_u16 v236, v250 offset:0
    ds_read_u16 v237, v250 offset:16
    ds_add_rtn_u32 v238, v255, v242
    v_exp_f32 v188, v188
    v_smfmac_f32_16x16x64_bf16 v[156:159], v[184:187], v[212:219], v242
    v_exp_f32 v189, v189
    v_mfma_f32_16x16x32_bf16 v[204:207], v[160:163], v[32:35], 0
    v_exp_f32 v190, v190
    v_mfma_f32_16x16x32_bf16 v[212:215], v[160:163], v[40:43], 0
    v_exp_f32 v191, v191
    v_mfma_f32_16x16x32_bf16 v[208:211], v[168:171], v[32:35], 0
    v_exp_f32 v192, v192
    v_mfma_f32_16x16x32_bf16 v[216:219], v[168:171], v[40:43], 0
    v_exp_f32 v193, v193
    v_mfma_f32_16x16x32_bf16 v[204:207], v[164:167], v[36:39], v[204:207]
    v_exp_f32 v194, v194
    v_mfma_f32_16x16x32_bf16 v[212:215], v[164:167], v[44:47], v[212:215]
    v_exp_f32 v195, v195
    v_mfma_f32_16x16x32_bf16 v[208:211], v[172:175], v[36:39], v[208:211]
    s_waitcnt lgkmcnt(0)
    v_bfi_b32 v236, 31, v246, v236
    v_bfi_b32 v237, 31, v246, v237
    v_readfirstlane_b32 s96, v238
    v_exp_f32 v196, v196
    v_mfma_f32_16x16x32_bf16 v[216:219], v[172:175], v[44:47], v[216:219]
    v_exp_f32 v197, v197
    s_setprio 3
    v_smfmac_f32_16x16x64_bf16 v[136:139], v[184:187], v[220:227], v242
    v_exp_f32 v198, v198
    v_smfmac_f32_16x16x64_bf16 v[140:143], v[184:187], v[228:235], v242
    v_exp_f32 v199, v199
    v_exp_f32 v200, v200
    v_exp_f32 v201, v201
    v_exp_f32 v202, v202
    v_exp_f32 v203, v203
    v_pk_add_f32 v[188:189], v[188:189], 1.0 op_sel_hi:[1,0]
    v_pk_add_f32 v[190:191], v[190:191], 1.0 op_sel_hi:[1,0]
    v_pk_add_f32 v[192:193], v[192:193], 1.0 op_sel_hi:[1,0]
    v_pk_add_f32 v[194:195], v[194:195], 1.0 op_sel_hi:[1,0]
    v_pk_add_f32 v[196:197], v[196:197], 1.0 op_sel_hi:[1,0]
    v_pk_add_f32 v[198:199], v[198:199], 1.0 op_sel_hi:[1,0]
    v_pk_add_f32 v[200:201], v[200:201], 1.0 op_sel_hi:[1,0]
    v_pk_add_f32 v[202:203], v[202:203], 1.0 op_sel_hi:[1,0]
    s_setprio 0
    v_mfma_f32_16x16x32_bf16 v[220:223], v[176:179], v[72:75], 0
    ds_read_b64_tr_b16 v[184:185], v236
    ds_read_b64_tr_b16 v[186:187], v237
    ds_read_u16 v251, v249 offset:1152
    ds_read_u16 v252, v249 offset:1216
    v_rcp_f32 v188, v188
    v_mfma_f32_16x16x32_bf16 v[228:231], v[176:179], v[76:79], 0
    s_ashr_i32 s96, s96, 24
    s_mul_i32 s96, s96, s101
    v_rcp_f32 v189, v189
    v_mfma_f32_16x16x32_bf16 v[224:227], v[180:183], v[72:75], 0
    v_rcp_f32 v190, v190
    v_mfma_f32_16x16x32_bf16 v[232:235], v[180:183], v[76:79], 0
    v_rcp_f32 v191, v191
    v_mfma_f32_16x16x32_bf16 v[220:223], v[160:163], v[16:19], v[220:223]
    v_rcp_f32 v192, v192
    v_mfma_f32_16x16x32_bf16 v[228:231], v[160:163], v[24:27], v[228:231]
    v_rcp_f32 v193, v193
    v_mfma_f32_16x16x32_bf16 v[224:227], v[168:171], v[16:19], v[224:227]
    s_waitcnt lgkmcnt(0)
    v_bfi_b32 v251, 31, v245, v251
    v_bfi_b32 v252, 31, v245, v252
    v_max_u32 v251, v251, v245
    v_max_u32 v252, v252, v253
    ds_read_b128 v[236:239], v247 offset:128
    ds_read_b32 v240, v248 offset:128
    s_add_u32 s16, s16, 1
    v_rcp_f32 v194, v194
    v_mfma_f32_16x16x32_bf16 v[232:235], v[168:171], v[24:27], v[232:235]
    v_rcp_f32 v195, v195
    v_mfma_f32_16x16x32_bf16 v[220:223], v[164:167], v[20:23], v[220:223]
    v_rcp_f32 v196, v196
    v_mfma_f32_16x16x32_bf16 v[228:231], v[164:167], v[28:31], v[228:231]
    v_rcp_f32 v197, v197
    s_setprio 3
    v_mfma_f32_16x16x32_bf16 v[224:227], v[172:175], v[20:23], v[224:227]
    v_rcp_f32 v198, v198
    v_mfma_f32_16x16x32_bf16 v[232:235], v[172:175], v[28:31], v[232:235]
    v_rcp_f32 v199, v199
    v_rcp_f32 v200, v200
    v_rcp_f32 v201, v201
    v_rcp_f32 v202, v202
    v_rcp_f32 v203, v203
    v_pk_mul_f32 v[204:205], v[188:189], v[204:205]
    v_pk_mul_f32 v[206:207], v[190:191], v[206:207]
    v_pk_mul_f32 v[208:209], v[192:193], v[208:209]
    v_pk_mul_f32 v[210:211], v[194:195], v[210:211]
    v_pk_mul_f32 v[212:213], v[196:197], v[212:213]
    v_pk_mul_f32 v[214:215], v[198:199], v[214:215]
    v_pk_mul_f32 v[216:217], v[200:201], v[216:217]
    v_pk_mul_f32 v[218:219], v[202:203], v[218:219]
    s_cmp_ge_i32 s96, 1
    s_cbranch_scc1 L_PB01
L_PB00:
    s_setprio 0
    v_smfmac_f32_16x16x64_bf16 v[112:115], v[184:187], v[204:211], v242
    v_exp_f32 v220, v220
    v_smfmac_f32_16x16x64_bf16 v[116:119], v[184:187], v[212:219], v242
    v_exp_f32 v221, v221
    s_waitcnt vmcnt(0)
    ds_read_b128 v[176:179], v251
    ds_read_b128 v[180:183], v252
    v_mfma_f32_16x16x32_bf16 v[204:207], v[160:163], v[48:51], 0
    v_exp_f32 v222, v222
    v_mfma_f32_16x16x32_bf16 v[212:215], v[160:163], v[56:59], 0
    ds_read_b128 v[160:163], v244 offset:0
    v_exp_f32 v223, v223
    v_mfma_f32_16x16x32_bf16 v[208:211], v[168:171], v[48:51], 0
    v_exp_f32 v224, v224
    v_mfma_f32_16x16x32_bf16 v[216:219], v[168:171], v[56:59], 0
    ds_read_b128 v[168:171], v244 offset:512
    v_exp_f32 v225, v225
    v_mfma_f32_16x16x32_bf16 v[204:207], v[164:167], v[52:55], v[204:207]
    v_exp_f32 v226, v226
    v_mfma_f32_16x16x32_bf16 v[212:215], v[164:167], v[60:63], v[212:215]
    ds_read_b128 v[164:167], v244 offset:64
    v_exp_f32 v227, v227
    v_mfma_f32_16x16x32_bf16 v[208:211], v[172:175], v[52:55], v[208:211]
    v_exp_f32 v228, v228
    v_mfma_f32_16x16x32_bf16 v[216:219], v[172:175], v[60:63], v[216:219]
    ds_read_b128 v[172:175], v244 offset:576
    v_exp_f32 v229, v229
    s_setprio 3
    v_smfmac_f32_16x16x64_bf16 v[96:99], v[184:187], v[188:195], v242
    v_exp_f32 v230, v230
    v_smfmac_f32_16x16x64_bf16 v[100:103], v[184:187], v[196:203], v242
    v_exp_f32 v231, v231
    v_exp_f32 v232, v232
    v_exp_f32 v233, v233
    v_exp_f32 v234, v234
    v_exp_f32 v235, v235
    v_pk_add_f32 v[220:221], v[220:221], 1.0 op_sel_hi:[1,0]
    v_pk_add_f32 v[222:223], v[222:223], 1.0 op_sel_hi:[1,0]
    v_pk_add_f32 v[224:225], v[224:225], 1.0 op_sel_hi:[1,0]
    v_pk_add_f32 v[226:227], v[226:227], 1.0 op_sel_hi:[1,0]
    v_pk_add_f32 v[228:229], v[228:229], 1.0 op_sel_hi:[1,0]
    v_pk_add_f32 v[230:231], v[230:231], 1.0 op_sel_hi:[1,0]
    v_pk_add_f32 v[232:233], v[232:233], 1.0 op_sel_hi:[1,0]
    v_pk_add_f32 v[234:235], v[234:235], 1.0 op_sel_hi:[1,0]
    s_setprio 0
    s_waitcnt lgkmcnt(4)
    v_mfma_f32_16x16x32_bf16 v[188:191], v[176:179], v[80:83], 0
    v_rcp_f32 v220, v220
    v_mfma_f32_16x16x32_bf16 v[196:199], v[176:179], v[84:87], 0
    v_rcp_f32 v221, v221
    v_mfma_f32_16x16x32_bf16 v[192:195], v[180:183], v[80:83], 0
    v_rcp_f32 v222, v222
    v_mfma_f32_16x16x32_bf16 v[200:203], v[180:183], v[84:87], 0
    v_rcp_f32 v223, v223
    s_waitcnt lgkmcnt(3)
    v_mfma_f32_16x16x32_bf16 v[188:191], v[160:163], v[0:3], v[188:191]
    v_rcp_f32 v224, v224
    v_mfma_f32_16x16x32_bf16 v[196:199], v[160:163], v[8:11], v[196:199]
    v_rcp_f32 v225, v225
    s_waitcnt lgkmcnt(2)
    v_mfma_f32_16x16x32_bf16 v[192:195], v[168:171], v[0:3], v[192:195]
    v_rcp_f32 v226, v226
    v_mfma_f32_16x16x32_bf16 v[200:203], v[168:171], v[8:11], v[200:203]
    v_rcp_f32 v227, v227
    s_waitcnt lgkmcnt(1)
    v_mfma_f32_16x16x32_bf16 v[188:191], v[164:167], v[4:7], v[188:191]
    v_rcp_f32 v228, v228
    v_mfma_f32_16x16x32_bf16 v[196:199], v[164:167], v[12:15], v[196:199]
    v_rcp_f32 v229, v229
    s_setprio 3
    s_waitcnt lgkmcnt(0)
    v_mfma_f32_16x16x32_bf16 v[192:195], v[172:175], v[4:7], v[192:195]
    s_cmp_lt_u32 s16, s17
    s_cbranch_scc0 L_ND00
    s_add_u32 m0, s13, 0
    v_mad_u32_u16 v236, v236, s15, v243
    buffer_load_dwordx4 v236, s[40:43], 0 offen lds
    s_add_u32 m0, s13, 1056
    v_mad_u32_u16 v237, v237, s15, v243
    buffer_load_dwordx4 v237, s[40:43], 0 offen lds
    s_add_u32 m0, s13, 2112
    v_mad_u32_u16 v238, v238, s15, v243
    buffer_load_dwordx4 v238, s[40:43], 0 offen lds
    s_add_u32 m0, s13, 3168
    v_mad_u32_u16 v239, v239, s15, v243
    buffer_load_dwordx4 v239, s[40:43], 0 offen lds
    s_mov_b32 m0, s14
    v_and_b32 v240, 0xfffff, v240
    buffer_load_dwordx4 v[240:241], s[44:47], 0 idxen offen lds
L_ND00:
    v_rcp_f32 v230, v230
    v_mfma_f32_16x16x32_bf16 v[200:203], v[172:175], v[12:15], v[200:203]
    v_rcp_f32 v231, v231
    v_rcp_f32 v232, v232
    v_rcp_f32 v233, v233
    v_rcp_f32 v234, v234
    v_rcp_f32 v235, v235
    v_pk_mul_f32 v[204:205], v[220:221], v[204:205]
    v_pk_mul_f32 v[206:207], v[222:223], v[206:207]
    v_pk_mul_f32 v[208:209], v[224:225], v[208:209]
    v_pk_mul_f32 v[210:211], v[226:227], v[210:211]
    v_pk_mul_f32 v[212:213], v[228:229], v[212:213]
    v_pk_mul_f32 v[214:215], v[230:231], v[214:215]
    v_pk_mul_f32 v[216:217], v[232:233], v[216:217]
    v_pk_mul_f32 v[218:219], v[234:235], v[218:219]
    s_cmp_ge_u32 s16, s17
    s_cbranch_scc1 L_LT1
    s_setprio 0
    v_smfmac_f32_16x16x64_bf16 v[120:123], v[184:187], v[204:211], v242
    ds_read_u16 v236, v250 offset:1152
    ds_read_u16 v237, v250 offset:1168
    ds_add_rtn_u32 v238, v255, v242
    v_exp_f32 v188, v188
    v_smfmac_f32_16x16x64_bf16 v[124:127], v[184:187], v[212:219], v242
    v_exp_f32 v189, v189
    v_mfma_f32_16x16x32_bf16 v[204:207], v[160:163], v[32:35], 0
    v_exp_f32 v190, v190
    v_mfma_f32_16x16x32_bf16 v[212:215], v[160:163], v[40:43], 0
    v_exp_f32 v191, v191
    v_mfma_f32_16x16x32_bf16 v[208:211], v[168:171], v[32:35], 0
    v_exp_f32 v192, v192
    v_mfma_f32_16x16x32_bf16 v[216:219], v[168:171], v[40:43], 0
    v_exp_f32 v193, v193
    v_mfma_f32_16x16x32_bf16 v[204:207], v[164:167], v[36:39], v[204:207]
    v_exp_f32 v194, v194
    v_mfma_f32_16x16x32_bf16 v[212:215], v[164:167], v[44:47], v[212:215]
    v_exp_f32 v195, v195
    v_mfma_f32_16x16x32_bf16 v[208:211], v[172:175], v[36:39], v[208:211]
    s_waitcnt lgkmcnt(0)
    v_bfi_b32 v236, 31, v246, v236
    v_bfi_b32 v237, 31, v246, v237
    v_readfirstlane_b32 s96, v238
    v_exp_f32 v196, v196
    v_mfma_f32_16x16x32_bf16 v[216:219], v[172:175], v[44:47], v[216:219]
    v_exp_f32 v197, v197
    s_setprio 3
    v_smfmac_f32_16x16x64_bf16 v[104:107], v[184:187], v[220:227], v242
    v_exp_f32 v198, v198
    v_smfmac_f32_16x16x64_bf16 v[108:111], v[184:187], v[228:235], v242
    v_exp_f32 v199, v199
    v_exp_f32 v200, v200
    v_exp_f32 v201, v201
    v_exp_f32 v202, v202
    v_exp_f32 v203, v203
    v_pk_add_f32 v[188:189], v[188:189], 1.0 op_sel_hi:[1,0]
    v_pk_add_f32 v[190:191], v[190:191], 1.0 op_sel_hi:[1,0]
    v_pk_add_f32 v[192:193], v[192:193], 1.0 op_sel_hi:[1,0]
    v_pk_add_f32 v[194:195], v[194:195], 1.0 op_sel_hi:[1,0]
    v_pk_add_f32 v[196:197], v[196:197], 1.0 op_sel_hi:[1,0]
    v_pk_add_f32 v[198:199], v[198:199], 1.0 op_sel_hi:[1,0]
    v_pk_add_f32 v[200:201], v[200:201], 1.0 op_sel_hi:[1,0]
    v_pk_add_f32 v[202:203], v[202:203], 1.0 op_sel_hi:[1,0]
    s_setprio 0
    v_mfma_f32_16x16x32_bf16 v[220:223], v[176:179], v[88:91], 0
    ds_read_b64_tr_b16 v[184:185], v236
    ds_read_b64_tr_b16 v[186:187], v237
    ds_read_u16 v251, v249 offset:128
    ds_read_u16 v252, v249 offset:192
    v_rcp_f32 v188, v188
    v_mfma_f32_16x16x32_bf16 v[228:231], v[176:179], v[92:95], 0
    s_ashr_i32 s96, s96, 24
    s_mul_i32 s96, s96, s101
    v_rcp_f32 v189, v189
    v_mfma_f32_16x16x32_bf16 v[224:227], v[180:183], v[88:91], 0
    v_rcp_f32 v190, v190
    v_mfma_f32_16x16x32_bf16 v[232:235], v[180:183], v[92:95], 0
    v_rcp_f32 v191, v191
    v_mfma_f32_16x16x32_bf16 v[220:223], v[160:163], v[16:19], v[220:223]
    v_rcp_f32 v192, v192
    v_mfma_f32_16x16x32_bf16 v[228:231], v[160:163], v[24:27], v[228:231]
    v_rcp_f32 v193, v193
    v_mfma_f32_16x16x32_bf16 v[224:227], v[168:171], v[16:19], v[224:227]
    s_waitcnt lgkmcnt(0)
    v_bfi_b32 v251, 31, v245, v251
    v_bfi_b32 v252, 31, v245, v252
    v_max_u32 v251, v251, v245
    v_max_u32 v252, v252, v253
    ds_read_b128 v[236:239], v247 offset:1280
    ds_read_b32 v240, v248 offset:1280
    s_add_u32 s16, s16, 1
    v_rcp_f32 v194, v194
    v_mfma_f32_16x16x32_bf16 v[232:235], v[168:171], v[24:27], v[232:235]
    v_add_u32 v247, 0x80, v247
    v_add_u32 v248, 0x80, v248
    v_add_u32 v249, 0x80, v249
    v_add_u32 v250, 0x80, v250
    v_rcp_f32 v195, v195
    v_mfma_f32_16x16x32_bf16 v[220:223], v[164:167], v[20:23], v[220:223]
    v_rcp_f32 v196, v196
    v_mfma_f32_16x16x32_bf16 v[228:231], v[164:167], v[28:31], v[228:231]
    v_rcp_f32 v197, v197
    s_setprio 3
    v_mfma_f32_16x16x32_bf16 v[224:227], v[172:175], v[20:23], v[224:227]
    v_rcp_f32 v198, v198
    v_mfma_f32_16x16x32_bf16 v[232:235], v[172:175], v[28:31], v[232:235]
    v_rcp_f32 v199, v199
    v_rcp_f32 v200, v200
    v_rcp_f32 v201, v201
    v_rcp_f32 v202, v202
    v_rcp_f32 v203, v203
    v_pk_mul_f32 v[204:205], v[188:189], v[204:205]
    v_pk_mul_f32 v[206:207], v[190:191], v[206:207]
    v_pk_mul_f32 v[208:209], v[192:193], v[208:209]
    v_pk_mul_f32 v[210:211], v[194:195], v[210:211]
    v_pk_mul_f32 v[212:213], v[196:197], v[212:213]
    v_pk_mul_f32 v[214:215], v[198:199], v[214:215]
    v_pk_mul_f32 v[216:217], v[200:201], v[216:217]
    v_pk_mul_f32 v[218:219], v[202:203], v[218:219]
    s_cmp_ge_i32 s96, 1
    s_cbranch_scc1 L_PB11
L_PB10:
    s_setprio 0
    v_smfmac_f32_16x16x64_bf16 v[144:147], v[184:187], v[204:211], v242
    v_exp_f32 v220, v220
    v_smfmac_f32_16x16x64_bf16 v[148:151], v[184:187], v[212:219], v242
    v_exp_f32 v221, v221
    s_waitcnt vmcnt(0)
    ds_read_b128 v[176:179], v251
    ds_read_b128 v[180:183], v252
    v_mfma_f32_16x16x32_bf16 v[204:207], v[160:163], v[48:51], 0
    v_exp_f32 v222, v222
    v_mfma_f32_16x16x32_bf16 v[212:215], v[160:163], v[56:59], 0
    ds_read_b128 v[160:163], v244 offset:0
    v_exp_f32 v223, v223
    v_mfma_f32_16x16x32_bf16 v[208:211], v[168:171], v[48:51], 0
    v_exp_f32 v224, v224
    v_mfma_f32_16x16x32_bf16 v[216:219], v[168:171], v[56:59], 0
    ds_read_b128 v[168:171], v244 offset:512
    v_exp_f32 v225, v225
    v_mfma_f32_16x16x32_bf16 v[204:207], v[164:167], v[52:55], v[204:207]
    v_exp_f32 v226, v226
    v_mfma_f32_16x16x32_bf16 v[212:215], v[164:167], v[60:63], v[212:215]
    ds_read_b128 v[164:167], v244 offset:64
    v_exp_f32 v227, v227
    v_mfma_f32_16x16x32_bf16 v[208:211], v[172:175], v[52:55], v[208:211]
    v_exp_f32 v228, v228
    v_mfma_f32_16x16x32_bf16 v[216:219], v[172:175], v[60:63], v[216:219]
    ds_read_b128 v[172:175], v244 offset:576
    v_exp_f32 v229, v229
    s_setprio 3
    v_smfmac_f32_16x16x64_bf16 v[128:131], v[184:187], v[188:195], v242
    v_exp_f32 v230, v230
    v_smfmac_f32_16x16x64_bf16 v[132:135], v[184:187], v[196:203], v242
    v_exp_f32 v231, v231
    v_exp_f32 v232, v232
    v_exp_f32 v233, v233
    v_exp_f32 v234, v234
    v_exp_f32 v235, v235
    v_pk_add_f32 v[220:221], v[220:221], 1.0 op_sel_hi:[1,0]
    v_pk_add_f32 v[222:223], v[222:223], 1.0 op_sel_hi:[1,0]
    v_pk_add_f32 v[224:225], v[224:225], 1.0 op_sel_hi:[1,0]
    v_pk_add_f32 v[226:227], v[226:227], 1.0 op_sel_hi:[1,0]
    v_pk_add_f32 v[228:229], v[228:229], 1.0 op_sel_hi:[1,0]
    v_pk_add_f32 v[230:231], v[230:231], 1.0 op_sel_hi:[1,0]
    v_pk_add_f32 v[232:233], v[232:233], 1.0 op_sel_hi:[1,0]
    v_pk_add_f32 v[234:235], v[234:235], 1.0 op_sel_hi:[1,0]
    s_setprio 0
    s_waitcnt lgkmcnt(4)
    v_mfma_f32_16x16x32_bf16 v[188:191], v[176:179], v[64:67], 0
    v_rcp_f32 v220, v220
    v_mfma_f32_16x16x32_bf16 v[196:199], v[176:179], v[68:71], 0
    v_rcp_f32 v221, v221
    v_mfma_f32_16x16x32_bf16 v[192:195], v[180:183], v[64:67], 0
    v_rcp_f32 v222, v222
    v_mfma_f32_16x16x32_bf16 v[200:203], v[180:183], v[68:71], 0
    v_rcp_f32 v223, v223
    s_waitcnt lgkmcnt(3)
    v_mfma_f32_16x16x32_bf16 v[188:191], v[160:163], v[0:3], v[188:191]
    v_rcp_f32 v224, v224
    v_mfma_f32_16x16x32_bf16 v[196:199], v[160:163], v[8:11], v[196:199]
    v_rcp_f32 v225, v225
    s_waitcnt lgkmcnt(2)
    v_mfma_f32_16x16x32_bf16 v[192:195], v[168:171], v[0:3], v[192:195]
    v_rcp_f32 v226, v226
    v_mfma_f32_16x16x32_bf16 v[200:203], v[168:171], v[8:11], v[200:203]
    v_rcp_f32 v227, v227
    s_waitcnt lgkmcnt(1)
    v_mfma_f32_16x16x32_bf16 v[188:191], v[164:167], v[4:7], v[188:191]
    v_rcp_f32 v228, v228
    v_mfma_f32_16x16x32_bf16 v[196:199], v[164:167], v[12:15], v[196:199]
    v_rcp_f32 v229, v229
    s_setprio 3
    s_waitcnt lgkmcnt(0)
    v_mfma_f32_16x16x32_bf16 v[192:195], v[172:175], v[4:7], v[192:195]
    s_cmp_lt_u32 s16, s17
    s_cbranch_scc0 L_ND10
    s_add_u32 m0, s13, 0
    v_mad_u32_u16 v236, v236, s15, v243
    buffer_load_dwordx4 v236, s[40:43], 0 offen lds
    s_add_u32 m0, s13, 1056
    v_mad_u32_u16 v237, v237, s15, v243
    buffer_load_dwordx4 v237, s[40:43], 0 offen lds
    s_add_u32 m0, s13, 2112
    v_mad_u32_u16 v238, v238, s15, v243
    buffer_load_dwordx4 v238, s[40:43], 0 offen lds
    s_add_u32 m0, s13, 3168
    v_mad_u32_u16 v239, v239, s15, v243
    buffer_load_dwordx4 v239, s[40:43], 0 offen lds
    s_mov_b32 m0, s14
    v_and_b32 v240, 0xfffff, v240
    buffer_load_dwordx4 v[240:241], s[44:47], 0 idxen offen lds
L_ND10:
    v_rcp_f32 v230, v230
    v_mfma_f32_16x16x32_bf16 v[200:203], v[172:175], v[12:15], v[200:203]
    v_rcp_f32 v231, v231
    v_rcp_f32 v232, v232
    v_rcp_f32 v233, v233
    v_rcp_f32 v234, v234
    v_rcp_f32 v235, v235
    v_pk_mul_f32 v[204:205], v[220:221], v[204:205]
    v_pk_mul_f32 v[206:207], v[222:223], v[206:207]
    v_pk_mul_f32 v[208:209], v[224:225], v[208:209]
    v_pk_mul_f32 v[210:211], v[226:227], v[210:211]
    v_pk_mul_f32 v[212:213], v[228:229], v[212:213]
    v_pk_mul_f32 v[214:215], v[230:231], v[214:215]
    v_pk_mul_f32 v[216:217], v[232:233], v[216:217]
    v_pk_mul_f32 v[218:219], v[234:235], v[218:219]
    s_cmp_lt_u32 s16, s17
    s_cbranch_scc1 L_LOOP0
L_LT0:
    s_cmp_lg_u32 s99, 0
    s_cbranch_scc1 L_LH0
    s_setprio 0
    v_smfmac_f32_16x16x64_bf16 v[152:155], v[184:187], v[204:211], v242
    ds_read_u16 v236, v250 offset:0
    ds_read_u16 v237, v250 offset:16
    v_exp_f32 v188, v188
    v_smfmac_f32_16x16x64_bf16 v[156:159], v[184:187], v[212:219], v242
    v_exp_f32 v189, v189
    v_mfma_f32_16x16x32_bf16 v[204:207], v[160:163], v[32:35], 0
    v_exp_f32 v190, v190
    v_mfma_f32_16x16x32_bf16 v[212:215], v[160:163], v[40:43], 0
    v_exp_f32 v191, v191
    v_mfma_f32_16x16x32_bf16 v[208:211], v[168:171], v[32:35], 0
    v_exp_f32 v192, v192
    v_mfma_f32_16x16x32_bf16 v[216:219], v[168:171], v[40:43], 0
    v_exp_f32 v193, v193
    v_mfma_f32_16x16x32_bf16 v[204:207], v[164:167], v[36:39], v[204:207]
    v_exp_f32 v194, v194
    v_mfma_f32_16x16x32_bf16 v[212:215], v[164:167], v[44:47], v[212:215]
    v_exp_f32 v195, v195
    v_mfma_f32_16x16x32_bf16 v[208:211], v[172:175], v[36:39], v[208:211]
    v_exp_f32 v196, v196
    v_mfma_f32_16x16x32_bf16 v[216:219], v[172:175], v[44:47], v[216:219]
    v_exp_f32 v197, v197
    v_smfmac_f32_16x16x64_bf16 v[136:139], v[184:187], v[220:227], v242
    s_waitcnt lgkmcnt(0)
    v_bfi_b32 v236, 31, v246, v236
    v_bfi_b32 v237, 31, v246, v237
    v_exp_f32 v198, v198
    s_setprio 3
    v_smfmac_f32_16x16x64_bf16 v[140:143], v[184:187], v[228:235], v242
    v_exp_f32 v199, v199
    v_exp_f32 v200, v200
    v_exp_f32 v201, v201
    v_exp_f32 v202, v202
    v_exp_f32 v203, v203
    v_pk_add_f32 v[188:189], v[188:189], 1.0 op_sel_hi:[1,0]
    v_pk_add_f32 v[190:191], v[190:191], 1.0 op_sel_hi:[1,0]
    v_pk_add_f32 v[192:193], v[192:193], 1.0 op_sel_hi:[1,0]
    v_pk_add_f32 v[194:195], v[194:195], 1.0 op_sel_hi:[1,0]
    v_pk_add_f32 v[196:197], v[196:197], 1.0 op_sel_hi:[1,0]
    v_pk_add_f32 v[198:199], v[198:199], 1.0 op_sel_hi:[1,0]
    v_pk_add_f32 v[200:201], v[200:201], 1.0 op_sel_hi:[1,0]
    v_pk_add_f32 v[202:203], v[202:203], 1.0 op_sel_hi:[1,0]
    s_setprio 0
    v_mfma_f32_16x16x32_bf16 v[220:223], v[176:179], v[72:75], 0
    ds_read_b64_tr_b16 v[184:185], v236
    ds_read_b64_tr_b16 v[186:187], v237
    v_rcp_f32 v188, v188
    v_mfma_f32_16x16x32_bf16 v[228:231], v[176:179], v[76:79], 0
    v_rcp_f32 v189, v189
    v_mfma_f32_16x16x32_bf16 v[224:227], v[180:183], v[72:75], 0
    v_rcp_f32 v190, v190
    v_mfma_f32_16x16x32_bf16 v[232:235], v[180:183], v[76:79], 0
    v_rcp_f32 v191, v191
    v_mfma_f32_16x16x32_bf16 v[220:223], v[160:163], v[16:19], v[220:223]
    v_rcp_f32 v192, v192
    v_mfma_f32_16x16x32_bf16 v[228:231], v[160:163], v[24:27], v[228:231]
    v_rcp_f32 v193, v193
    v_mfma_f32_16x16x32_bf16 v[224:227], v[168:171], v[16:19], v[224:227]
    v_rcp_f32 v194, v194
    v_mfma_f32_16x16x32_bf16 v[232:235], v[168:171], v[24:27], v[232:235]
    v_rcp_f32 v195, v195
    v_mfma_f32_16x16x32_bf16 v[220:223], v[164:167], v[20:23], v[220:223]
    v_rcp_f32 v196, v196
    v_mfma_f32_16x16x32_bf16 v[228:231], v[164:167], v[28:31], v[228:231]
    v_rcp_f32 v197, v197
    v_mfma_f32_16x16x32_bf16 v[224:227], v[172:175], v[20:23], v[224:227]
    v_rcp_f32 v198, v198
    s_setprio 3
    v_mfma_f32_16x16x32_bf16 v[232:235], v[172:175], v[28:31], v[232:235]
    v_rcp_f32 v199, v199
    v_rcp_f32 v200, v200
    v_rcp_f32 v201, v201
    v_rcp_f32 v202, v202
    v_rcp_f32 v203, v203
    v_pk_mul_f32 v[204:205], v[188:189], v[204:205]
    v_pk_mul_f32 v[206:207], v[190:191], v[206:207]
    v_pk_mul_f32 v[208:209], v[192:193], v[208:209]
    v_pk_mul_f32 v[210:211], v[194:195], v[210:211]
    v_pk_mul_f32 v[212:213], v[196:197], v[212:213]
    v_pk_mul_f32 v[214:215], v[198:199], v[214:215]
    v_pk_mul_f32 v[216:217], v[200:201], v[216:217]
    v_pk_mul_f32 v[218:219], v[202:203], v[218:219]
    s_setprio 0
    s_waitcnt lgkmcnt(0)
    v_smfmac_f32_16x16x64_bf16 v[112:115], v[184:187], v[204:211], v242
    v_exp_f32 v220, v220
    v_smfmac_f32_16x16x64_bf16 v[116:119], v[184:187], v[212:219], v242
    v_exp_f32 v221, v221
    v_mfma_f32_16x16x32_bf16 v[204:207], v[160:163], v[48:51], 0
    v_exp_f32 v222, v222
    v_mfma_f32_16x16x32_bf16 v[212:215], v[160:163], v[56:59], 0
    v_exp_f32 v223, v223
    v_mfma_f32_16x16x32_bf16 v[208:211], v[168:171], v[48:51], 0
    v_exp_f32 v224, v224
    v_mfma_f32_16x16x32_bf16 v[216:219], v[168:171], v[56:59], 0
    v_exp_f32 v225, v225
    v_mfma_f32_16x16x32_bf16 v[204:207], v[164:167], v[52:55], v[204:207]
    v_exp_f32 v226, v226
    v_mfma_f32_16x16x32_bf16 v[212:215], v[164:167], v[60:63], v[212:215]
    v_exp_f32 v227, v227
    v_mfma_f32_16x16x32_bf16 v[208:211], v[172:175], v[52:55], v[208:211]
    v_exp_f32 v228, v228
    v_mfma_f32_16x16x32_bf16 v[216:219], v[172:175], v[60:63], v[216:219]
    v_exp_f32 v229, v229
    v_smfmac_f32_16x16x64_bf16 v[96:99], v[184:187], v[188:195], v242
    v_exp_f32 v230, v230
    s_setprio 3
    v_smfmac_f32_16x16x64_bf16 v[100:103], v[184:187], v[196:203], v242
    v_exp_f32 v231, v231
    v_exp_f32 v232, v232
    v_exp_f32 v233, v233
    v_exp_f32 v234, v234
    v_exp_f32 v235, v235
    v_pk_add_f32 v[220:221], v[220:221], 1.0 op_sel_hi:[1,0]
    v_pk_add_f32 v[222:223], v[222:223], 1.0 op_sel_hi:[1,0]
    v_pk_add_f32 v[224:225], v[224:225], 1.0 op_sel_hi:[1,0]
    v_pk_add_f32 v[226:227], v[226:227], 1.0 op_sel_hi:[1,0]
    v_pk_add_f32 v[228:229], v[228:229], 1.0 op_sel_hi:[1,0]
    v_pk_add_f32 v[230:231], v[230:231], 1.0 op_sel_hi:[1,0]
    v_pk_add_f32 v[232:233], v[232:233], 1.0 op_sel_hi:[1,0]
    v_pk_add_f32 v[234:235], v[234:235], 1.0 op_sel_hi:[1,0]
    s_setprio 0
    v_rcp_f32 v220, v220
    v_rcp_f32 v221, v221
    v_rcp_f32 v222, v222
    v_rcp_f32 v223, v223
    v_rcp_f32 v224, v224
    v_rcp_f32 v225, v225
    v_rcp_f32 v226, v226
    v_rcp_f32 v227, v227
    v_rcp_f32 v228, v228
    v_rcp_f32 v229, v229
    v_rcp_f32 v230, v230
    v_rcp_f32 v231, v231
    v_rcp_f32 v232, v232
    v_rcp_f32 v233, v233
    v_rcp_f32 v234, v234
    v_rcp_f32 v235, v235
    v_pk_mul_f32 v[204:205], v[220:221], v[204:205]
    v_pk_mul_f32 v[206:207], v[222:223], v[206:207]
    v_pk_mul_f32 v[208:209], v[224:225], v[208:209]
    v_pk_mul_f32 v[210:211], v[226:227], v[210:211]
    v_pk_mul_f32 v[212:213], v[228:229], v[212:213]
    v_pk_mul_f32 v[214:215], v[230:231], v[214:215]
    v_pk_mul_f32 v[216:217], v[232:233], v[216:217]
    v_pk_mul_f32 v[218:219], v[234:235], v[218:219]
    v_smfmac_f32_16x16x64_bf16 v[104:107], v[184:187], v[220:227], v242
    v_smfmac_f32_16x16x64_bf16 v[108:111], v[184:187], v[228:235], v242
    v_smfmac_f32_16x16x64_bf16 v[120:123], v[184:187], v[204:211], v242
    v_smfmac_f32_16x16x64_bf16 v[124:127], v[184:187], v[212:219], v242
    s_branch L_DONE
L_LH0:
    s_setprio 0
    v_smfmac_f32_16x16x64_bf16 v[152:155], v[184:187], v[204:211], v242
    ds_read_u16 v236, v250 offset:0
    ds_read_u16 v237, v250 offset:16
    v_smfmac_f32_16x16x64_bf16 v[156:159], v[184:187], v[212:219], v242
    v_exp_f32 v188, v188
    v_mfma_f32_16x16x32_bf16 v[204:207], v[160:163], v[32:35], 0
    v_mfma_f32_16x16x32_bf16 v[212:215], v[160:163], v[40:43], 0
    v_exp_f32 v189, v189
    v_mfma_f32_16x16x32_bf16 v[204:207], v[164:167], v[36:39], v[204:207]
    v_mfma_f32_16x16x32_bf16 v[212:215], v[164:167], v[44:47], v[212:215]
    v_exp_f32 v190, v190
    v_smfmac_f32_16x16x64_bf16 v[136:139], v[184:187], v[220:227], v242
    s_waitcnt lgkmcnt(0)
    v_bfi_b32 v236, 31, v246, v236
    v_bfi_b32 v237, 31, v246, v237
    v_exp_f32 v191, v191
    s_setprio 3
    v_smfmac_f32_16x16x64_bf16 v[140:143], v[184:187], v[228:235], v242
    v_exp_f32 v196, v196
    v_exp_f32 v197, v197
    v_exp_f32 v198, v198
    v_exp_f32 v199, v199
    v_pk_add_f32 v[188:189], v[188:189], 1.0 op_sel_hi:[1,0]
    v_pk_add_f32 v[190:191], v[190:191], 1.0 op_sel_hi:[1,0]
    v_pk_add_f32 v[196:197], v[196:197], 1.0 op_sel_hi:[1,0]
    v_pk_add_f32 v[198:199], v[198:199], 1.0 op_sel_hi:[1,0]
    s_setprio 0
    v_mfma_f32_16x16x32_bf16 v[220:223], v[176:179], v[72:75], 0
    ds_read_b64_tr_b16 v[184:185], v236
    ds_read_b64_tr_b16 v[186:187], v237
    v_mfma_f32_16x16x32_bf16 v[228:231], v[176:179], v[76:79], 0
    v_rcp_f32 v188, v188
    v_mfma_f32_16x16x32_bf16 v[220:223], v[160:163], v[16:19], v[220:223]
    v_rcp_f32 v189, v189
    v_mfma_f32_16x16x32_bf16 v[228:231], v[160:163], v[24:27], v[228:231]
    v_rcp_f32 v190, v190
    v_mfma_f32_16x16x32_bf16 v[220:223], v[164:167], v[20:23], v[220:223]
    v_rcp_f32 v191, v191
    s_setprio 3
    v_mfma_f32_16x16x32_bf16 v[228:231], v[164:167], v[28:31], v[228:231]
    v_rcp_f32 v196, v196
    v_rcp_f32 v197, v197
    v_rcp_f32 v198, v198
    v_rcp_f32 v199, v199
    v_pk_mul_f32 v[204:205], v[188:189], v[204:205]
    v_pk_mul_f32 v[206:207], v[190:191], v[206:207]
    v_pk_mul_f32 v[212:213], v[196:197], v[212:213]
    v_pk_mul_f32 v[214:215], v[198:199], v[214:215]
    s_setprio 0
    s_waitcnt lgkmcnt(0)
    v_smfmac_f32_16x16x64_bf16 v[112:115], v[184:187], v[204:211], v242
    v_smfmac_f32_16x16x64_bf16 v[116:119], v[184:187], v[212:219], v242
    v_exp_f32 v220, v220
    v_mfma_f32_16x16x32_bf16 v[204:207], v[160:163], v[48:51], 0
    v_mfma_f32_16x16x32_bf16 v[212:215], v[160:163], v[56:59], 0
    v_exp_f32 v221, v221
    v_mfma_f32_16x16x32_bf16 v[204:207], v[164:167], v[52:55], v[204:207]
    v_mfma_f32_16x16x32_bf16 v[212:215], v[164:167], v[60:63], v[212:215]
    v_exp_f32 v222, v222
    v_smfmac_f32_16x16x64_bf16 v[96:99], v[184:187], v[188:195], v242
    v_exp_f32 v223, v223
    s_setprio 3
    v_smfmac_f32_16x16x64_bf16 v[100:103], v[184:187], v[196:203], v242
    v_exp_f32 v228, v228
    v_exp_f32 v229, v229
    v_exp_f32 v230, v230
    v_exp_f32 v231, v231
    v_pk_add_f32 v[220:221], v[220:221], 1.0 op_sel_hi:[1,0]
    v_pk_add_f32 v[222:223], v[222:223], 1.0 op_sel_hi:[1,0]
    v_pk_add_f32 v[228:229], v[228:229], 1.0 op_sel_hi:[1,0]
    v_pk_add_f32 v[230:231], v[230:231], 1.0 op_sel_hi:[1,0]
    s_setprio 0
    v_rcp_f32 v220, v220
    v_rcp_f32 v221, v221
    v_rcp_f32 v222, v222
    v_rcp_f32 v223, v223
    v_rcp_f32 v228, v228
    v_rcp_f32 v229, v229
    v_rcp_f32 v230, v230
    v_rcp_f32 v231, v231
    v_pk_mul_f32 v[204:205], v[220:221], v[204:205]
    v_pk_mul_f32 v[206:207], v[222:223], v[206:207]
    v_pk_mul_f32 v[212:213], v[228:229], v[212:213]
    v_pk_mul_f32 v[214:215], v[230:231], v[214:215]
    v_smfmac_f32_16x16x64_bf16 v[104:107], v[184:187], v[220:227], v242
    v_smfmac_f32_16x16x64_bf16 v[108:111], v[184:187], v[228:235], v242
    v_smfmac_f32_16x16x64_bf16 v[120:123], v[184:187], v[204:211], v242
    v_smfmac_f32_16x16x64_bf16 v[124:127], v[184:187], v[212:219], v242
    s_branch L_DONE
L_LT1:
    s_cmp_lg_u32 s99, 0
    s_cbranch_scc1 L_LH1
    s_setprio 0
    v_smfmac_f32_16x16x64_bf16 v[120:123], v[184:187], v[204:211], v242
    ds_read_u16 v236, v250 offset:1152
    ds_read_u16 v237, v250 offset:1168
    v_exp_f32 v188, v188
    v_smfmac_f32_16x16x64_bf16 v[124:127], v[184:187], v[212:219], v242
    v_exp_f32 v189, v189
    v_mfma_f32_16x16x32_bf16 v[204:207], v[160:163], v[32:35], 0
    v_exp_f32 v190, v190
    v_mfma_f32_16x16x32_bf16 v[212:215], v[160:163], v[40:43], 0
    v_exp_f32 v191, v191
    v_mfma_f32_16x16x32_bf16 v[208:211], v[168:171], v[32:35], 0
    v_exp_f32 v192, v192
    v_mfma_f32_16x16x32_bf16 v[216:219], v[168:171], v[40:43], 0
    v_exp_f32 v193, v193
    v_mfma_f32_16x16x32_bf16 v[204:207], v[164:167], v[36:39], v[204:207]
    v_exp_f32 v194, v194
    v_mfma_f32_16x16x32_bf16 v[212:215], v[164:167], v[44:47], v[212:215]
    v_exp_f32 v195, v195
    v_mfma_f32_16x16x32_bf16 v[208:211], v[172:175], v[36:39], v[208:211]
    v_exp_f32 v196, v196
    v_mfma_f32_16x16x32_bf16 v[216:219], v[172:175], v[44:47], v[216:219]
    v_exp_f32 v197, v197
    v_smfmac_f32_16x16x64_bf16 v[104:107], v[184:187], v[220:227], v242
    s_waitcnt lgkmcnt(0)
    v_bfi_b32 v236, 31, v246, v236
    v_bfi_b32 v237, 31, v246, v237
    v_exp_f32 v198, v198
    s_setprio 3
    v_smfmac_f32_16x16x64_bf16 v[108:111], v[184:187], v[228:235], v242
    v_exp_f32 v199, v199
    v_exp_f32 v200, v200
    v_exp_f32 v201, v201
    v_exp_f32 v202, v202
    v_exp_f32 v203, v203
    v_pk_add_f32 v[188:189], v[188:189], 1.0 op_sel_hi:[1,0]
    v_pk_add_f32 v[190:191], v[190:191], 1.0 op_sel_hi:[1,0]
    v_pk_add_f32 v[192:193], v[192:193], 1.0 op_sel_hi:[1,0]
    v_pk_add_f32 v[194:195], v[194:195], 1.0 op_sel_hi:[1,0]
    v_pk_add_f32 v[196:197], v[196:197], 1.0 op_sel_hi:[1,0]
    v_pk_add_f32 v[198:199], v[198:199], 1.0 op_sel_hi:[1,0]
    v_pk_add_f32 v[200:201], v[200:201], 1.0 op_sel_hi:[1,0]
    v_pk_add_f32 v[202:203], v[202:203], 1.0 op_sel_hi:[1,0]
    s_setprio 0
    v_mfma_f32_16x16x32_bf16 v[220:223], v[176:179], v[88:91], 0
    ds_read_b64_tr_b16 v[184:185], v236
    ds_read_b64_tr_b16 v[186:187], v237
    v_rcp_f32 v188, v188
    v_mfma_f32_16x16x32_bf16 v[228:231], v[176:179], v[92:95], 0
    v_rcp_f32 v189, v189
    v_mfma_f32_16x16x32_bf16 v[224:227], v[180:183], v[88:91], 0
    v_rcp_f32 v190, v190
    v_mfma_f32_16x16x32_bf16 v[232:235], v[180:183], v[92:95], 0
    v_rcp_f32 v191, v191
    v_mfma_f32_16x16x32_bf16 v[220:223], v[160:163], v[16:19], v[220:223]
    v_rcp_f32 v192, v192
    v_mfma_f32_16x16x32_bf16 v[228:231], v[160:163], v[24:27], v[228:231]
    v_rcp_f32 v193, v193
    v_mfma_f32_16x16x32_bf16 v[224:227], v[168:171], v[16:19], v[224:227]
    v_rcp_f32 v194, v194
    v_mfma_f32_16x16x32_bf16 v[232:235], v[168:171], v[24:27], v[232:235]
    v_rcp_f32 v195, v195
    v_mfma_f32_16x16x32_bf16 v[220:223], v[164:167], v[20:23], v[220:223]
    v_rcp_f32 v196, v196
    v_mfma_f32_16x16x32_bf16 v[228:231], v[164:167], v[28:31], v[228:231]
    v_rcp_f32 v197, v197
    v_mfma_f32_16x16x32_bf16 v[224:227], v[172:175], v[20:23], v[224:227]
    v_rcp_f32 v198, v198
    s_setprio 3
    v_mfma_f32_16x16x32_bf16 v[232:235], v[172:175], v[28:31], v[232:235]
    v_rcp_f32 v199, v199
    v_rcp_f32 v200, v200
    v_rcp_f32 v201, v201
    v_rcp_f32 v202, v202
    v_rcp_f32 v203, v203
    v_pk_mul_f32 v[204:205], v[188:189], v[204:205]
    v_pk_mul_f32 v[206:207], v[190:191], v[206:207]
    v_pk_mul_f32 v[208:209], v[192:193], v[208:209]
    v_pk_mul_f32 v[210:211], v[194:195], v[210:211]
    v_pk_mul_f32 v[212:213], v[196:197], v[212:213]
    v_pk_mul_f32 v[214:215], v[198:199], v[214:215]
    v_pk_mul_f32 v[216:217], v[200:201], v[216:217]
    v_pk_mul_f32 v[218:219], v[202:203], v[218:219]
    s_setprio 0
    s_waitcnt lgkmcnt(0)
    v_smfmac_f32_16x16x64_bf16 v[144:147], v[184:187], v[204:211], v242
    v_exp_f32 v220, v220
    v_smfmac_f32_16x16x64_bf16 v[148:151], v[184:187], v[212:219], v242
    v_exp_f32 v221, v221
    v_mfma_f32_16x16x32_bf16 v[204:207], v[160:163], v[48:51], 0
    v_exp_f32 v222, v222
    v_mfma_f32_16x16x32_bf16 v[212:215], v[160:163], v[56:59], 0
    v_exp_f32 v223, v223
    v_mfma_f32_16x16x32_bf16 v[208:211], v[168:171], v[48:51], 0
    v_exp_f32 v224, v224
    v_mfma_f32_16x16x32_bf16 v[216:219], v[168:171], v[56:59], 0
    v_exp_f32 v225, v225
    v_mfma_f32_16x16x32_bf16 v[204:207], v[164:167], v[52:55], v[204:207]
    v_exp_f32 v226, v226
    v_mfma_f32_16x16x32_bf16 v[212:215], v[164:167], v[60:63], v[212:215]
    v_exp_f32 v227, v227
    v_mfma_f32_16x16x32_bf16 v[208:211], v[172:175], v[52:55], v[208:211]
    v_exp_f32 v228, v228
    v_mfma_f32_16x16x32_bf16 v[216:219], v[172:175], v[60:63], v[216:219]
    v_exp_f32 v229, v229
    v_smfmac_f32_16x16x64_bf16 v[128:131], v[184:187], v[188:195], v242
    v_exp_f32 v230, v230
    s_setprio 3
    v_smfmac_f32_16x16x64_bf16 v[132:135], v[184:187], v[196:203], v242
    v_exp_f32 v231, v231
    v_exp_f32 v232, v232
    v_exp_f32 v233, v233
    v_exp_f32 v234, v234
    v_exp_f32 v235, v235
    v_pk_add_f32 v[220:221], v[220:221], 1.0 op_sel_hi:[1,0]
    v_pk_add_f32 v[222:223], v[222:223], 1.0 op_sel_hi:[1,0]
    v_pk_add_f32 v[224:225], v[224:225], 1.0 op_sel_hi:[1,0]
    v_pk_add_f32 v[226:227], v[226:227], 1.0 op_sel_hi:[1,0]
    v_pk_add_f32 v[228:229], v[228:229], 1.0 op_sel_hi:[1,0]
    v_pk_add_f32 v[230:231], v[230:231], 1.0 op_sel_hi:[1,0]
    v_pk_add_f32 v[232:233], v[232:233], 1.0 op_sel_hi:[1,0]
    v_pk_add_f32 v[234:235], v[234:235], 1.0 op_sel_hi:[1,0]
    s_setprio 0
    v_rcp_f32 v220, v220
    v_rcp_f32 v221, v221
    v_rcp_f32 v222, v222
    v_rcp_f32 v223, v223
    v_rcp_f32 v224, v224
    v_rcp_f32 v225, v225
    v_rcp_f32 v226, v226
    v_rcp_f32 v227, v227
    v_rcp_f32 v228, v228
    v_rcp_f32 v229, v229
    v_rcp_f32 v230, v230
    v_rcp_f32 v231, v231
    v_rcp_f32 v232, v232
    v_rcp_f32 v233, v233
    v_rcp_f32 v234, v234
    v_rcp_f32 v235, v235
    v_pk_mul_f32 v[204:205], v[220:221], v[204:205]
    v_pk_mul_f32 v[206:207], v[222:223], v[206:207]
    v_pk_mul_f32 v[208:209], v[224:225], v[208:209]
    v_pk_mul_f32 v[210:211], v[226:227], v[210:211]
    v_pk_mul_f32 v[212:213], v[228:229], v[212:213]
    v_pk_mul_f32 v[214:215], v[230:231], v[214:215]
    v_pk_mul_f32 v[216:217], v[232:233], v[216:217]
    v_pk_mul_f32 v[218:219], v[234:235], v[218:219]
    v_smfmac_f32_16x16x64_bf16 v[136:139], v[184:187], v[220:227], v242
    v_smfmac_f32_16x16x64_bf16 v[140:143], v[184:187], v[228:235], v242
    v_smfmac_f32_16x16x64_bf16 v[152:155], v[184:187], v[204:211], v242
    v_smfmac_f32_16x16x64_bf16 v[156:159], v[184:187], v[212:219], v242
    s_branch L_DONE
L_LH1:
    s_setprio 0
    v_smfmac_f32_16x16x64_bf16 v[120:123], v[184:187], v[204:211], v242
    ds_read_u16 v236, v250 offset:1152
    ds_read_u16 v237, v250 offset:1168
    v_smfmac_f32_16x16x64_bf16 v[124:127], v[184:187], v[212:219], v242
    v_exp_f32 v188, v188
    v_mfma_f32_16x16x32_bf16 v[204:207], v[160:163], v[32:35], 0
    v_mfma_f32_16x16x32_bf16 v[212:215], v[160:163], v[40:43], 0
    v_exp_f32 v189, v189
    v_mfma_f32_16x16x32_bf16 v[204:207], v[164:167], v[36:39], v[204:207]
    v_mfma_f32_16x16x32_bf16 v[212:215], v[164:167], v[44:47], v[212:215]
    v_exp_f32 v190, v190
    v_smfmac_f32_16x16x64_bf16 v[104:107], v[184:187], v[220:227], v242
    s_waitcnt lgkmcnt(0)
    v_bfi_b32 v236, 31, v246, v236
    v_bfi_b32 v237, 31, v246, v237
    v_exp_f32 v191, v191
    s_setprio 3
    v_smfmac_f32_16x16x64_bf16 v[108:111], v[184:187], v[228:235], v242
    v_exp_f32 v196, v196
    v_exp_f32 v197, v197
    v_exp_f32 v198, v198
    v_exp_f32 v199, v199
    v_pk_add_f32 v[188:189], v[188:189], 1.0 op_sel_hi:[1,0]
    v_pk_add_f32 v[190:191], v[190:191], 1.0 op_sel_hi:[1,0]
    v_pk_add_f32 v[196:197], v[196:197], 1.0 op_sel_hi:[1,0]
    v_pk_add_f32 v[198:199], v[198:199], 1.0 op_sel_hi:[1,0]
    s_setprio 0
    v_mfma_f32_16x16x32_bf16 v[220:223], v[176:179], v[88:91], 0
    ds_read_b64_tr_b16 v[184:185], v236
    ds_read_b64_tr_b16 v[186:187], v237
    v_mfma_f32_16x16x32_bf16 v[228:231], v[176:179], v[92:95], 0
    v_rcp_f32 v188, v188
    v_mfma_f32_16x16x32_bf16 v[220:223], v[160:163], v[16:19], v[220:223]
    v_rcp_f32 v189, v189
    v_mfma_f32_16x16x32_bf16 v[228:231], v[160:163], v[24:27], v[228:231]
    v_rcp_f32 v190, v190
    v_mfma_f32_16x16x32_bf16 v[220:223], v[164:167], v[20:23], v[220:223]
    v_rcp_f32 v191, v191
    s_setprio 3
    v_mfma_f32_16x16x32_bf16 v[228:231], v[164:167], v[28:31], v[228:231]
    v_rcp_f32 v196, v196
    v_rcp_f32 v197, v197
    v_rcp_f32 v198, v198
    v_rcp_f32 v199, v199
    v_pk_mul_f32 v[204:205], v[188:189], v[204:205]
    v_pk_mul_f32 v[206:207], v[190:191], v[206:207]
    v_pk_mul_f32 v[212:213], v[196:197], v[212:213]
    v_pk_mul_f32 v[214:215], v[198:199], v[214:215]
    s_setprio 0
    s_waitcnt lgkmcnt(0)
    v_smfmac_f32_16x16x64_bf16 v[144:147], v[184:187], v[204:211], v242
    v_smfmac_f32_16x16x64_bf16 v[148:151], v[184:187], v[212:219], v242
    v_exp_f32 v220, v220
    v_mfma_f32_16x16x32_bf16 v[204:207], v[160:163], v[48:51], 0
    v_mfma_f32_16x16x32_bf16 v[212:215], v[160:163], v[56:59], 0
    v_exp_f32 v221, v221
    v_mfma_f32_16x16x32_bf16 v[204:207], v[164:167], v[52:55], v[204:207]
    v_mfma_f32_16x16x32_bf16 v[212:215], v[164:167], v[60:63], v[212:215]
    v_exp_f32 v222, v222
    v_smfmac_f32_16x16x64_bf16 v[128:131], v[184:187], v[188:195], v242
    v_exp_f32 v223, v223
    s_setprio 3
    v_smfmac_f32_16x16x64_bf16 v[132:135], v[184:187], v[196:203], v242
    v_exp_f32 v228, v228
    v_exp_f32 v229, v229
    v_exp_f32 v230, v230
    v_exp_f32 v231, v231
    v_pk_add_f32 v[220:221], v[220:221], 1.0 op_sel_hi:[1,0]
    v_pk_add_f32 v[222:223], v[222:223], 1.0 op_sel_hi:[1,0]
    v_pk_add_f32 v[228:229], v[228:229], 1.0 op_sel_hi:[1,0]
    v_pk_add_f32 v[230:231], v[230:231], 1.0 op_sel_hi:[1,0]
    s_setprio 0
    v_rcp_f32 v220, v220
    v_rcp_f32 v221, v221
    v_rcp_f32 v222, v222
    v_rcp_f32 v223, v223
    v_rcp_f32 v228, v228
    v_rcp_f32 v229, v229
    v_rcp_f32 v230, v230
    v_rcp_f32 v231, v231
    v_pk_mul_f32 v[204:205], v[220:221], v[204:205]
    v_pk_mul_f32 v[206:207], v[222:223], v[206:207]
    v_pk_mul_f32 v[212:213], v[228:229], v[212:213]
    v_pk_mul_f32 v[214:215], v[230:231], v[214:215]
    v_smfmac_f32_16x16x64_bf16 v[136:139], v[184:187], v[220:227], v242
    v_smfmac_f32_16x16x64_bf16 v[140:143], v[184:187], v[228:235], v242
    v_smfmac_f32_16x16x64_bf16 v[152:155], v[184:187], v[204:211], v242
    v_smfmac_f32_16x16x64_bf16 v[156:159], v[184:187], v[212:219], v242
L_DONE:
    v_mbcnt_lo_u32_b32 v253, -1, 0
    v_mbcnt_hi_u32_b32 v253, -1, v253
    s_cmp_lg_u32 s19, 0
    s_cbranch_scc1 L_SLOW
L_EPI:
    s_setprio 0
    v_bfe_u32 v65, v253, 2, 3
    v_lshrrev_b32 v66, 5, v253
    v_lshl_add_u32 v65, v66, 4, v65
    v_mul_u32_u24 v65, 160, v65
    s_mov_b32 s10, 143488
    v_add3_u32 v65, v65, v246, s10
    v_and_b32 v64, 48, v253
    v_and_b32 v67, 15, v253
    v_lshlrev_b32 v68, 3, v67
    v_lshlrev_b32 v70, 3, v64
    s_movk_i32 s10, 832
    v_mad_u32_u24 v64, v246, s10, v64
    s_waitcnt lgkmcnt(0)
    s_lshl_b32 s22, s22, 5
    s_add_u32 s10, s22, 116736
    v_add_u32 v69, s10, v68
    s_sub_u32 s11, 0, s22
    v_add_u32 v80, s11, v70
    v_and_b32 v80, 0x1ff, v80
    v_add_u32 v72, v80, v69
    ds_read_b64 v[32:33], v72 offset:0
    s_sub_u32 s11, 32, s22
    v_add_u32 v81, s11, v70
    v_and_b32 v81, 0x1ff, v81
    v_add_u32 v72, v81, v69
    ds_read_b64 v[34:35], v72 offset:6656
    s_sub_u32 s11, 64, s22
    v_add_u32 v82, s11, v70
    v_and_b32 v82, 0x1ff, v82
    v_add_u32 v72, v82, v69
    ds_read_b64 v[36:37], v72 offset:13312
    s_sub_u32 s11, 96, s22
    v_add_u32 v83, s11, v70
    v_and_b32 v83, 0x1ff, v83
    v_add_u32 v72, v83, v69
    ds_read_b64 v[38:39], v72 offset:19968
    s_sub_u32 s11, 0, s22
    v_lshl_add_u32 v72, v68, 2, s11
    v_and_b32 v72, 0x1ff, v72
    v_add3_u32 v72, v72, v64, s10
    ds_read_b128 v[160:163], v72 offset:0
    ds_read_b128 v[164:167], v72 offset:64
    ds_read_b64_tr_b16 v[0:1], v65 offset:0
    ds_read_b64_tr_b16 v[2:3], v65 offset:1280
    ds_read_b64_tr_b16 v[8:9], v65 offset:32
    ds_read_b64_tr_b16 v[10:11], v65 offset:1312
    ds_read_b64_tr_b16 v[16:17], v65 offset:64
    ds_read_b64_tr_b16 v[18:19], v65 offset:1344
    ds_read_b64_tr_b16 v[24:25], v65 offset:96
    ds_read_b64_tr_b16 v[26:27], v65 offset:1376
    s_lshl_b32 s23, s23, 5
    s_add_u32 s10, s23, 116736
    v_add_u32 v69, s10, v68
    s_sub_u32 s11, 0, s23
    v_add_u32 v84, s11, v70
    v_and_b32 v84, 0x1ff, v84
    v_add_u32 v72, v84, v69
    ds_read_b64 v[40:41], v72 offset:0
    s_sub_u32 s11, 32, s23
    v_add_u32 v85, s11, v70
    v_and_b32 v85, 0x1ff, v85
    v_add_u32 v72, v85, v69
    ds_read_b64 v[42:43], v72 offset:6656
    s_sub_u32 s11, 64, s23
    v_add_u32 v86, s11, v70
    v_and_b32 v86, 0x1ff, v86
    v_add_u32 v72, v86, v69
    ds_read_b64 v[44:45], v72 offset:13312
    s_sub_u32 s11, 96, s23
    v_add_u32 v87, s11, v70
    v_and_b32 v87, 0x1ff, v87
    v_add_u32 v72, v87, v69
    ds_read_b64 v[46:47], v72 offset:19968
    s_sub_u32 s11, 0, s23
    v_lshl_add_u32 v72, v68, 2, s11
    v_and_b32 v72, 0x1ff, v72
    v_add3_u32 v72, v72, v64, s10
    ds_read_b128 v[168:171], v72 offset:0
    ds_read_b128 v[172:175], v72 offset:64
    ds_read_b64_tr_b16 v[4:5], v65 offset:5120
    ds_read_b64_tr_b16 v[6:7], v65 offset:6400
    ds_read_b64_tr_b16 v[12:13], v65 offset:5152
    ds_read_b64_tr_b16 v[14:15], v65 offset:6432
    ds_read_b64_tr_b16 v[20:21], v65 offset:5184
    ds_read_b64_tr_b16 v[22:23], v65 offset:6464
    ds_read_b64_tr_b16 v[28:29], v65 offset:5216
    ds_read_b64_tr_b16 v[30:31], v65 offset:6496
    s_lshl_b32 s10, s25, 5
    v_subrev_u32 v70, s10, v70
    v_cmpx_eq_u32 vcc, 0x0, v70
    s_cbranch_execz L_NS0
    v_add_f32 v96, v96, v128
    v_add_f32 v100, v100, v132
    v_add_f32 v104, v104, v136
    v_add_f32 v108, v108, v140
    v_add_f32 v112, v112, v144
    v_add_f32 v116, v116, v148
    v_add_f32 v120, v120, v152
    v_add_f32 v124, v124, v156
L_NS0:
    s_mov_b64 exec, -1
    v_cmpx_eq_u32 vcc, 0xffffffe0, v70
    s_cbranch_execz L_NS1
    v_add_f32 v97, v97, v129
    v_add_f32 v101, v101, v133
    v_add_f32 v105, v105, v137
    v_add_f32 v109, v109, v141
    v_add_f32 v113, v113, v145
    v_add_f32 v117, v117, v149
    v_add_f32 v121, v121, v153
    v_add_f32 v125, v125, v157
L_NS1:
    s_mov_b64 exec, -1
    v_cmpx_eq_u32 vcc, 0xffffffc0, v70
    s_cbranch_execz L_NS2
    v_add_f32 v98, v98, v130
    v_add_f32 v102, v102, v134
    v_add_f32 v106, v106, v138
    v_add_f32 v110, v110, v142
    v_add_f32 v114, v114, v146
    v_add_f32 v118, v118, v150
    v_add_f32 v122, v122, v154
    v_add_f32 v126, v126, v158
L_NS2:
    s_mov_b64 exec, -1
    v_cmpx_eq_u32 vcc, 0xffffffa0, v70
    s_cbranch_execz L_NS3
    v_add_f32 v99, v99, v131
    v_add_f32 v103, v103, v135
    v_add_f32 v107, v107, v139
    v_add_f32 v111, v111, v143
    v_add_f32 v115, v115, v147
    v_add_f32 v119, v119, v151
    v_add_f32 v123, v123, v155
    v_add_f32 v127, v127, v159
L_NS3:
    s_mov_b64 exec, -1
    s_mul_i32 s10, s5, 196
    s_add_u32 s34, s10, s8
    s_min_u32 s34, s34, 50000
    s_lshl_b32 s34, s34, 7
    s_add_u32 s35, s10, s24
    s_min_u32 s35, s35, 50000
    s_lshl_b32 s35, s35, 7
    s_add_u32 s36, s10, s7
    s_min_u32 s36, s36, 50000
    s_lshl_b32 s36, s36, 7
    s_add_u32 s37, s10, s9
    s_min_u32 s37, s37, 50000
    s_lshl_b32 s37, s37, 7
    s_add_u32 s56, s48, s36
    s_addc_u32 s57, s49, 0
    s_sub_u32 s58, s37, s36
    s_add_u32 s48, s48, s34
    s_addc_u32 s49, s49, 0
    s_sub_u32 s50, s35, s34
    s_lshl_b32 s10, s8, 5
    s_sub_u32 s10, s22, s10
    s_lshl_b32 s10, s10, 2
    v_add_u32 v74, s10, v68
    s_lshl_b32 s10, s7, 5
    s_sub_u32 s10, s23, s10
    s_lshl_b32 s10, s10, 2
    v_add_u32 v75, s10, v68
    v_rcp_f32 v128, v128
    v_rcp_f32 v129, v129
    v_rcp_f32 v130, v130
    v_rcp_f32 v131, v131
    v_rcp_f32 v132, v132
    v_rcp_f32 v133, v133
    v_rcp_f32 v134, v134
    v_rcp_f32 v135, v135
    v_rcp_f32 v136, v136
    v_rcp_f32 v137, v137
    v_rcp_f32 v138, v138
    v_rcp_f32 v139, v139
    v_rcp_f32 v140, v140
    v_rcp_f32 v141, v141
    v_rcp_f32 v142, v142
    v_rcp_f32 v143, v143
    v_rcp_f32 v96, v96
    v_rcp_f32 v97, v97
    v_rcp_f32 v98, v98
    v_rcp_f32 v99, v99
    v_rcp_f32 v100, v100
    v_rcp_f32 v101, v101
    v_rcp_f32 v102, v102
    v_rcp_f32 v103, v103
    v_rcp_f32 v104, v104
    v_rcp_f32 v105, v105
    v_rcp_f32 v106, v106
    v_rcp_f32 v107, v107
    v_rcp_f32 v108, v108
    v_rcp_f32 v109, v109
    v_rcp_f32 v110, v110
    v_rcp_f32 v111, v111
    s_waitcnt lgkmcnt(8)
    v_lshlrev_b32 v188, 16, v32
    v_and_b32 v192, 0xffff0000, v32
    v_lshlrev_b32 v196, 16, v33
    v_and_b32 v200, 0xffff0000, v33
    v_lshlrev_b32 v189, 16, v34
    v_and_b32 v193, 0xffff0000, v34
    v_lshlrev_b32 v197, 16, v35
    v_and_b32 v201, 0xffff0000, v35
    v_lshlrev_b32 v190, 16, v36
    v_and_b32 v194, 0xffff0000, v36
    v_lshlrev_b32 v198, 16, v37
    v_and_b32 v202, 0xffff0000, v37
    v_lshlrev_b32 v191, 16, v38
    v_and_b32 v195, 0xffff0000, v38
    v_lshlrev_b32 v199, 16, v39
    v_and_b32 v203, 0xffff0000, v39
    v_lshlrev_b32 v204, 16, v40
    v_and_b32 v208, 0xffff0000, v40
    v_lshlrev_b32 v212, 16, v41
    v_and_b32 v216, 0xffff0000, v41
    v_lshlrev_b32 v205, 16, v42
    v_and_b32 v209, 0xffff0000, v42
    v_lshlrev_b32 v213, 16, v43
    v_and_b32 v217, 0xffff0000, v43
    v_lshlrev_b32 v206, 16, v44
    v_and_b32 v210, 0xffff0000, v44
    v_lshlrev_b32 v214, 16, v45
    v_and_b32 v218, 0xffff0000, v45
    v_lshlrev_b32 v207, 16, v46
    v_and_b32 v211, 0xffff0000, v46
    v_lshlrev_b32 v215, 16, v47
    v_and_b32 v219, 0xffff0000, v47
    v_pk_fma_f32 v[112:113], v[112:113], v[96:97], v[188:189]
    v_pk_fma_f32 v[114:115], v[114:115], v[98:99], v[190:191]
    v_pk_fma_f32 v[116:117], v[116:117], v[100:101], v[192:193]
    v_pk_fma_f32 v[118:119], v[118:119], v[102:103], v[194:195]
    v_pk_fma_f32 v[120:121], v[120:121], v[104:105], v[196:197]
    v_pk_fma_f32 v[122:123], v[122:123], v[106:107], v[198:199]
    v_pk_fma_f32 v[124:125], v[124:125], v[108:109], v[200:201]
    v_pk_fma_f32 v[126:127], v[126:127], v[110:111], v[202:203]
    v_pk_fma_f32 v[144:145], v[144:145], v[128:129], v[204:205]
    v_pk_fma_f32 v[146:147], v[146:147], v[130:131], v[206:207]
    v_pk_fma_f32 v[148:149], v[148:149], v[132:133], v[208:209]
    v_pk_fma_f32 v[150:151], v[150:151], v[134:135], v[210:211]
    v_pk_fma_f32 v[152:153], v[152:153], v[136:137], v[212:213]
    v_pk_fma_f32 v[154:155], v[154:155], v[138:139], v[214:215]
    v_pk_fma_f32 v[156:157], v[156:157], v[140:141], v[216:217]
    v_pk_fma_f32 v[158:159], v[158:159], v[142:143], v[218:219]
    s_waitcnt lgkmcnt(0)
    v_mfma_f32_16x16x32_bf16 v[112:115], v[160:163], v[0:3], v[112:115]
    v_lshl_add_u32 v80, v80, 2, v74
    v_mfma_f32_16x16x32_bf16 v[116:119], v[160:163], v[8:11], v[116:119]
    v_lshl_add_u32 v81, v81, 2, v74
    v_mfma_f32_16x16x32_bf16 v[120:123], v[160:163], v[16:19], v[120:123]
    v_lshl_add_u32 v82, v82, 2, v74
    v_mfma_f32_16x16x32_bf16 v[124:127], v[160:163], v[24:27], v[124:127]
    v_lshl_add_u32 v83, v83, 2, v74
    v_mfma_f32_16x16x32_bf16 v[112:115], v[164:167], v[4:7], v[112:115]
    v_lshl_add_u32 v84, v84, 2, v75
    v_mfma_f32_16x16x32_bf16 v[116:119], v[164:167], v[12:15], v[116:119]
    v_lshl_add_u32 v85, v85, 2, v75
    v_mfma_f32_16x16x32_bf16 v[120:123], v[164:167], v[20:23], v[120:123]
    v_lshl_add_u32 v86, v86, 2, v75
    v_mfma_f32_16x16x32_bf16 v[124:127], v[164:167], v[28:31], v[124:127]
    v_lshl_add_u32 v87, v87, 2, v75
    v_mfma_f32_16x16x32_bf16 v[144:147], v[168:171], v[0:3], v[144:147]
    v_mfma_f32_16x16x32_bf16 v[148:151], v[168:171], v[8:11], v[148:151]
    v_mfma_f32_16x16x32_bf16 v[152:155], v[168:171], v[16:19], v[152:155]
    v_mfma_f32_16x16x32_bf16 v[156:159], v[168:171], v[24:27], v[156:159]
    v_mfma_f32_16x16x32_bf16 v[144:147], v[172:175], v[4:7], v[144:147]
    v_mfma_f32_16x16x32_bf16 v[148:151], v[172:175], v[12:15], v[148:151]
    v_mfma_f32_16x16x32_bf16 v[152:155], v[172:175], v[20:23], v[152:155]
    v_mfma_f32_16x16x32_bf16 v[156:159], v[172:175], v[28:31], v[156:159]
    v_cvt_pk_bf16_f32 v96, v112, v116
    v_cvt_pk_bf16_f32 v97, v120, v124
    v_pk_max_f16 v96, v96, v32
    v_pk_max_f16 v97, v97, v33
    buffer_store_dwordx2 v[96:97], v80, s[48:51], 0 offen sc1
    v_cvt_pk_bf16_f32 v98, v113, v117
    v_cvt_pk_bf16_f32 v99, v121, v125
    v_pk_max_f16 v98, v98, v34
    v_pk_max_f16 v99, v99, v35
    buffer_store_dwordx2 v[98:99], v81, s[48:51], 0 offen sc1
    v_cvt_pk_bf16_f32 v100, v114, v118
    v_cvt_pk_bf16_f32 v101, v122, v126
    v_pk_max_f16 v100, v100, v36
    v_pk_max_f16 v101, v101, v37
    buffer_store_dwordx2 v[100:101], v82, s[48:51], 0 offen sc1
    v_cvt_pk_bf16_f32 v102, v115, v119
    v_cvt_pk_bf16_f32 v103, v123, v127
    v_pk_max_f16 v102, v102, v38
    v_pk_max_f16 v103, v103, v39
    buffer_store_dwordx2 v[102:103], v83, s[48:51], 0 offen sc1
    v_cvt_pk_bf16_f32 v128, v144, v148
    v_cvt_pk_bf16_f32 v129, v152, v156
    v_pk_max_f16 v128, v128, v40
    v_pk_max_f16 v129, v129, v41
    buffer_store_dwordx2 v[128:129], v84, s[56:59], 0 offen sc1
    v_cvt_pk_bf16_f32 v130, v145, v149
    v_cvt_pk_bf16_f32 v131, v153, v157
    v_pk_max_f16 v130, v130, v42
    v_pk_max_f16 v131, v131, v43
    buffer_store_dwordx2 v[130:131], v85, s[56:59], 0 offen sc1
    v_cvt_pk_bf16_f32 v132, v146, v150
    v_cvt_pk_bf16_f32 v133, v154, v158
    v_pk_max_f16 v132, v132, v44
    v_pk_max_f16 v133, v133, v45
    buffer_store_dwordx2 v[132:133], v86, s[56:59], 0 offen sc1
    v_cvt_pk_bf16_f32 v134, v147, v151
    v_cvt_pk_bf16_f32 v135, v155, v159
    v_pk_max_f16 v134, v134, v46
    v_pk_max_f16 v135, v135, v47
    buffer_store_dwordx2 v[134:135], v87, s[56:59], 0 offen sc1
L_END:
    s_endpgm
L_RT0:
    s_waitcnt vmcnt(0)
    s_add_u32 s100, s100, 1
    s_cmp_gt_u32 s100, 200000
    s_cbranch_scc1 L_END
    s_sleep 1
    buffer_load_dwordx4 v[128:131], v232, s[56:59], 0 offen sc1
    buffer_load_dwordx4 v[132:135], v232, s[56:59], s26 offen sc1
    buffer_load_dwordx4 v[136:139], v232, s[56:59], s27 offen sc1
    buffer_load_dwordx4 v[140:143], v232, s[56:59], s28 offen sc1
    s_waitcnt vmcnt(0)
    s_branch L_PW0
L_RT1:
    s_waitcnt vmcnt(0)
    s_add_u32 s100, s100, 1
    s_cmp_gt_u32 s100, 200000
    s_cbranch_scc1 L_END
    s_sleep 1
    buffer_load_dwordx4 v[132:135], v232, s[56:59], s26 offen sc1
    buffer_load_dwordx4 v[136:139], v232, s[56:59], s27 offen sc1
    buffer_load_dwordx4 v[140:143], v232, s[56:59], s28 offen sc1
    s_waitcnt vmcnt(0)
    s_branch L_PW1
L_RT2:
    s_waitcnt vmcnt(0)
    s_add_u32 s100, s100, 1
    s_cmp_gt_u32 s100, 200000
    s_cbranch_scc1 L_END
    s_sleep 1
    buffer_load_dwordx4 v[136:139], v232, s[56:59], s27 offen sc1
    buffer_load_dwordx4 v[140:143], v232, s[56:59], s28 offen sc1
    s_waitcnt vmcnt(0)
    s_branch L_PW2
L_RT3:
    s_waitcnt vmcnt(0)
    s_add_u32 s100, s100, 1
    s_cmp_gt_u32 s100, 200000
    s_cbranch_scc1 L_END
    s_sleep 1
    buffer_load_dwordx4 v[140:143], v232, s[56:59], s28 offen sc1
    s_waitcnt vmcnt(0)
    s_branch L_PW3
L_XT1:
    v_and_b32 v190, 0x1000000, v131
    v_cmp_ne_u32 s[70:71], 0, v190
    s_bcnt1_i32_b64 s10, s[70:71]
    s_lshl2_add_u32 s21, s10, s21
    v_and_b32 v190, 0x1000000, v135
    v_cmp_ne_u32 s[78:79], 0, v190
    s_bcnt1_i32_b64 s10, s[78:79]
    s_lshl2_add_u32 s21, s10, s21
    v_and_b32 v190, 0x1000000, v139
    v_cmp_ne_u32 s[86:87], 0, v190
    s_bcnt1_i32_b64 s10, s[86:87]
    s_lshl2_add_u32 s21, s10, s21
    v_and_b32 v190, 0x1000000, v143
    v_cmp_ne_u32 s[94:95], 0, v190
    s_bcnt1_i32_b64 s10, s[94:95]
    s_lshl2_add_u32 s21, s10, s21
    s_mov_b64 exec, s[70:71]
    s_cbranch_execz L_XLa0
    s_movk_i32 s10, 0
    buffer_load_dwordx4 v[64:67], v232, s[60:63], s10 offen sc1
L_XLa0:
    s_mov_b64 exec, s[78:79]
    s_cbranch_execz L_XLa1
    s_movk_i32 s10, 8192
    buffer_load_dwordx4 v[68:71], v232, s[60:63], s10 offen sc1
L_XLa1:
    s_mov_b64 exec, s[86:87]
    s_cbranch_execz L_XLa2
    s_movk_i32 s10, 16384
    buffer_load_dwordx4 v[72:75], v232, s[60:63], s10 offen sc1
L_XLa2:
    s_mov_b64 exec, s[94:95]
    s_cbranch_execz L_XLa3
    s_movk_i32 s10, 24576
    buffer_load_dwordx4 v[76:79], v232, s[60:63], s10 offen sc1
L_XLa3:
    s_mov_b64 exec, -1
    v_or3_b32 v190, v129, v133, v137
    v_or_b32 v190, v190, v141
    v_and_b32 v190, 0x10000, v190
    v_mov_b32 v191, 640
    v_cmpx_ne_u32 vcc, 0, v190
    ds_write_b32 v191, v184 offset:4
    s_mov_b64 exec, 1
    v_mov_b32 v190, s21
    ds_add_u32 v191, v190 offset:8
    s_mov_b64 exec, -1
    s_branch L_XT1R
L_XCN:
    s_sub_u32 s10, s12, 37888
    s_add_u32 s11, s10, s96
    v_mov_b32 v188, s11
    s_add_u32 s11, s10, s31
    s_add_u32 s11, s11, 1152
    v_mov_b32 v189, s11
    s_lshl_b32 s10, s4, 3
    v_mov_b32 v190, s10
    ds_write_b64 v190, v[188:189] offset:576
    s_branch L_XCNR
L_XT2:
    s_waitcnt vmcnt(0)
    s_mov_b64 s[34:35], 0
    v_cmp_ne_u32 vcc, s6, v65
    s_and_b64 vcc, vcc, s[70:71]
    s_or_b64 s[34:35], s[34:35], vcc
    v_cmp_ne_u32 vcc, s6, v69
    s_and_b64 vcc, vcc, s[78:79]
    s_or_b64 s[34:35], s[34:35], vcc
    v_cmp_ne_u32 vcc, s6, v73
    s_and_b64 vcc, vcc, s[86:87]
    s_or_b64 s[34:35], s[34:35], vcc
    v_cmp_ne_u32 vcc, s6, v77
    s_and_b64 vcc, vcc, s[94:95]
    s_or_b64 s[34:35], s[34:35], vcc
    s_cbranch_scc0 L_XT2A
    s_add_u32 s100, s100, 1
    s_cmp_gt_u32 s100, 200000
    s_cbranch_scc1 L_END
    s_sleep 1
    s_mov_b64 exec, s[70:71]
    s_cbranch_execz L_XLb0
    s_movk_i32 s10, 0
    buffer_load_dwordx4 v[64:67], v232, s[60:63], s10 offen sc1
L_XLb0:
    s_mov_b64 exec, s[78:79]
    s_cbranch_execz L_XLb1
    s_movk_i32 s10, 8192
    buffer_load_dwordx4 v[68:71], v232, s[60:63], s10 offen sc1
L_XLb1:
    s_mov_b64 exec, s[86:87]
    s_cbranch_execz L_XLb2
    s_movk_i32 s10, 16384
    buffer_load_dwordx4 v[72:75], v232, s[60:63], s10 offen sc1
L_XLb2:
    s_mov_b64 exec, s[94:95]
    s_cbranch_execz L_XLb3
    s_movk_i32 s10, 24576
    buffer_load_dwordx4 v[76:79], v232, s[60:63], s10 offen sc1
L_XLb3:
    s_mov_b64 exec, -1
    s_branch L_XT2
L_XT2A:
    s_cmp_eq_u32 s20, 0
    s_cbranch_scc1 L_XT2R
    s_mov_b64 exec, s[70:71]
    v_bfe_u32 v65, v64, 18, 8
    v_lshlrev_b32 v65, 2, v65
    v_add_u32 v67, 153728, v65
    ds_read_b32 v67, v67
    v_add_u32_sdwa v66, v66, v156 dst_sel:DWORD dst_unused:UNUSED_PAD src0_sel:BYTE_0 src1_sel:DWORD
    v_lshrrev_b32 v189, 28, v64
    v_lshl_add_u32 v66, v189, 8, v66
    v_and_b32 v189, 60, v65
    v_lshl_add_u32 v66, v189, 19, v66
    v_and_b32 v64, 0xffff, v64
    s_waitcnt lgkmcnt(0)
    ds_add_rtn_u32 v67, v67, v184 offset:576
    s_waitcnt lgkmcnt(0)
    ds_write2st64_b32 v67, v64, v66 offset0:148 offset1:220
    s_mov_b64 exec, s[78:79]
    v_bfe_u32 v69, v68, 18, 8
    v_lshlrev_b32 v69, 2, v69
    v_add_u32 v71, 153728, v69
    ds_read_b32 v71, v71
    v_add_u32_sdwa v70, v70, v157 dst_sel:DWORD dst_unused:UNUSED_PAD src0_sel:BYTE_0 src1_sel:DWORD
    v_lshrrev_b32 v189, 28, v68
    v_lshl_add_u32 v70, v189, 8, v70
    v_and_b32 v189, 60, v69
    v_lshl_add_u32 v70, v189, 19, v70
    v_and_b32 v68, 0xffff, v68
    s_waitcnt lgkmcnt(0)
    ds_add_rtn_u32 v71, v71, v184 offset:576
    s_waitcnt lgkmcnt(0)
    ds_write2st64_b32 v71, v68, v70 offset0:148 offset1:220
    s_mov_b64 exec, s[86:87]
    v_bfe_u32 v73, v72, 18, 8
    v_lshlrev_b32 v73, 2, v73
    v_add_u32 v75, 153728, v73
    ds_read_b32 v75, v75
    v_add_u32_sdwa v74, v74, v158 dst_sel:DWORD dst_unused:UNUSED_PAD src0_sel:BYTE_0 src1_sel:DWORD
    v_lshrrev_b32 v189, 28, v72
    v_lshl_add_u32 v74, v189, 8, v74
    v_and_b32 v189, 60, v73
    v_lshl_add_u32 v74, v189, 19, v74
    v_and_b32 v72, 0xffff, v72
    s_waitcnt lgkmcnt(0)
    ds_add_rtn_u32 v75, v75, v184 offset:576
    s_waitcnt lgkmcnt(0)
    ds_write2st64_b32 v75, v72, v74 offset0:148 offset1:220
    s_mov_b64 exec, s[94:95]
    v_bfe_u32 v77, v76, 18, 8
    v_lshlrev_b32 v77, 2, v77
    v_add_u32 v79, 153728, v77
    ds_read_b32 v79, v79
    v_add_u32_sdwa v78, v78, v159 dst_sel:DWORD dst_unused:UNUSED_PAD src0_sel:BYTE_0 src1_sel:DWORD
    v_lshrrev_b32 v189, 28, v76
    v_lshl_add_u32 v78, v189, 8, v78
    v_and_b32 v189, 60, v77
    v_lshl_add_u32 v78, v189, 19, v78
    v_and_b32 v76, 0xffff, v76
    s_waitcnt lgkmcnt(0)
    ds_add_rtn_u32 v79, v79, v184 offset:576
    s_waitcnt lgkmcnt(0)
    ds_write2st64_b32 v79, v76, v78 offset0:148 offset1:220
    s_mov_b64 exec, -1
    s_waitcnt lgkmcnt(0)
    s_branch L_XT2R
L_XT3:
    s_lshl_b32 s10, s4, 3
    v_mov_b32 v188, s10
    ds_read_b64 v[188:189], v188 offset:576
    s_waitcnt lgkmcnt(0)
    v_readfirstlane_b32 s34, v188
    v_readfirstlane_b32 s35, v189
    s_sub_u32 s10, s12, 37888
    s_sub_u32 s34, s34, s10
    s_sub_u32 s35, s35, s10
    s_sub_u32 s35, s35, 1152
    s_add_u32 s10, s34, 127
    s_lshr_b32 s10, s10, 7
    s_lshl1_add_u32 s10, s10, -1
    s_add_u32 s11, s35, 127
    s_lshr_b32 s11, s11, 6
    s_and_b32 s11, s11, -2
    s_max_i32 s17, s10, s11
    s_cselect_b32 s10, s34, s35
    s_sub_u32 s10, s10, 1
    s_andn2_b32 s99, 64, s10
    s_branch L_XT3R
L_OVF:
    s_mov_b32 s20, 0
    s_mov_b32 s17, 0
    s_mov_b32 s30, 0
    s_mov_b32 s19, 4
    s_waitcnt lgkmcnt(0)
    s_branch L_CA
L_PEXT:
    v_mov_b32 v65, s6
    s_mov_b32 s34, 8421376
    v_subrev_u32 v68, 792, v128
    v_cmpx_gt_u32 vcc, 264, v68
    s_cbranch_execz L_PE0
    v_mov_b32 v64, v104
    v_mov_b32 v66, v136
    v_bfe_u32 v68, v128, 5, 3
    v_lshlrev_b32 v68, 4, v68
    v_mad_u32_u24 v68, v112, s68, v68
    buffer_store_dwordx4 v[64:67], v68, s[56:59], s34 offen sc1
L_PE0:
    s_mov_b64 exec, -1
    v_subrev_u32 v68, 792, v129
    v_cmpx_gt_u32 vcc, 264, v68
    s_cbranch_execz L_PE1
    v_mov_b32 v64, v105
    v_mov_b32 v66, v137
    v_bfe_u32 v68, v129, 5, 3
    v_lshlrev_b32 v68, 4, v68
    v_mad_u32_u24 v68, v113, s68, v68
    buffer_store_dwordx4 v[64:67], v68, s[56:59], s34 offen sc1
L_PE1:
    s_mov_b64 exec, -1
    v_subrev_u32 v68, 792, v130
    v_cmpx_gt_u32 vcc, 264, v68
    s_cbranch_execz L_PE2
    v_mov_b32 v64, v106
    v_mov_b32 v66, v138
    v_bfe_u32 v68, v130, 5, 3
    v_lshlrev_b32 v68, 4, v68
    v_mad_u32_u24 v68, v114, s68, v68
    buffer_store_dwordx4 v[64:67], v68, s[56:59], s34 offen sc1
L_PE2:
    s_mov_b64 exec, -1
    v_subrev_u32 v68, 792, v131
    v_cmpx_gt_u32 vcc, 264, v68
    s_cbranch_execz L_PE3
    v_mov_b32 v64, v107
    v_mov_b32 v66, v139
    v_bfe_u32 v68, v131, 5, 3
    v_lshlrev_b32 v68, 4, v68
    v_mad_u32_u24 v68, v115, s68, v68
    buffer_store_dwordx4 v[64:67], v68, s[56:59], s34 offen sc1
L_PE3:
    s_mov_b64 exec, -1
    v_subrev_u32 v68, 792, v132
    v_cmpx_gt_u32 vcc, 264, v68
    s_cbranch_execz L_PE4
    v_mov_b32 v64, v108
    v_mov_b32 v66, v136
    v_bfe_u32 v68, v132, 5, 3
    v_lshlrev_b32 v68, 4, v68
    v_mad_u32_u24 v68, v116, s68, v68
    buffer_store_dwordx4 v[64:67], v68, s[56:59], s34 offen sc1
L_PE4:
    s_mov_b64 exec, -1
    v_subrev_u32 v68, 792, v133
    v_cmpx_gt_u32 vcc, 264, v68
    s_cbranch_execz L_PE5
    v_mov_b32 v64, v109
    v_mov_b32 v66, v137
    v_bfe_u32 v68, v133, 5, 3
    v_lshlrev_b32 v68, 4, v68
    v_mad_u32_u24 v68, v117, s68, v68
    buffer_store_dwordx4 v[64:67], v68, s[56:59], s34 offen sc1
L_PE5:
    s_mov_b64 exec, -1
    v_subrev_u32 v68, 792, v134
    v_cmpx_gt_u32 vcc, 264, v68
    s_cbranch_execz L_PE6
    v_mov_b32 v64, v110
    v_mov_b32 v66, v138
    v_bfe_u32 v68, v134, 5, 3
    v_lshlrev_b32 v68, 4, v68
    v_mad_u32_u24 v68, v118, s68, v68
    buffer_store_dwordx4 v[64:67], v68, s[56:59], s34 offen sc1
L_PE6:
    s_mov_b64 exec, -1
    v_subrev_u32 v68, 792, v135
    v_cmpx_gt_u32 vcc, 264, v68
    s_cbranch_execz L_PE7
    v_mov_b32 v64, v111
    v_mov_b32 v66, v139
    v_bfe_u32 v68, v135, 5, 3
    v_lshlrev_b32 v68, 4, v68
    v_mad_u32_u24 v68, v119, s68, v68
    buffer_store_dwordx4 v[64:67], v68, s[56:59], s34 offen sc1
L_PE7:
    s_mov_b64 exec, -1
    s_branch L_PEXTR
L_POVF:
    s_movk_i32 s11, 1986
    v_mul_u32_u24 v64, s11, v192
    v_lshrrev_b32 v64, 16, v64
    v_mul_u32_u24 v65, s11, v193
    v_lshrrev_b32 v65, 16, v65
    v_mul_u32_u24 v66, s11, v194
    v_lshrrev_b32 v66, 16, v66
    v_mul_u32_u24 v67, s11, v195
    v_lshrrev_b32 v67, 16, v67
    v_add_u32 v69, v64, v65
    v_add_u32 v70, v69, v66
    v_add_u32 v71, v70, v67
    v_mov_b32 v72, v71
    s_nop 1
    v_add_u32_dpp v72, v72, v72 row_shr:1 row_mask:0xf bank_mask:0xf bound_ctrl:0
    s_nop 1
    v_add_u32_dpp v72, v72, v72 row_shr:2 row_mask:0xf bank_mask:0xf bound_ctrl:0
    s_nop 1
    v_add_u32_dpp v72, v72, v72 row_shr:4 row_mask:0xf bank_mask:0xf bound_ctrl:0
    s_nop 1
    v_add_u32_dpp v72, v72, v72 row_shr:8 row_mask:0xf bank_mask:0xf bound_ctrl:0
    s_nop 1
    v_add_u32_dpp v72, v72, v72 row_bcast:15 row_mask:0xa bank_mask:0xf
    s_nop 1
    v_add_u32_dpp v72, v72, v72 row_bcast:31 row_mask:0xc bank_mask:0xf
    s_nop 0
    v_sub_u32 v68, v72, v71
    v_add_u32 v71, v68, v70
    v_add_u32 v70, v68, v69
    v_add_u32 v69, v68, v64
    v_lshl_or_b32 v68, v64, 16, v68
    v_lshl_or_b32 v69, v65, 16, v69
    v_lshl_or_b32 v70, v66, 16, v70
    v_lshl_or_b32 v71, v67, 16, v71
    v_add_u32 v72, 154752, v185
    ds_write_b128 v72, v[68:71]
    s_lshl_b32 s10, s2, 10
    s_add_u32 s10, s10, 24772608
    buffer_store_dwordx4 v[68:71], v185, s[52:55], s10 offen sc1
    v_and_b32 v74, 0x3fc, v120
    v_add_u32 v74, 154752, v74
    ds_read_u16 v74, v74
    v_and_b32 v75, 0x3fc, v121
    v_add_u32 v75, 154752, v75
    ds_read_u16 v75, v75
    v_and_b32 v76, 0x3fc, v122
    v_add_u32 v76, 154752, v76
    ds_read_u16 v76, v76
    v_and_b32 v77, 0x3fc, v123
    v_add_u32 v77, 154752, v77
    ds_read_u16 v77, v77
    v_and_b32 v78, 0x3fc, v124
    v_add_u32 v78, 154752, v78
    ds_read_u16 v78, v78
    v_and_b32 v79, 0x3fc, v125
    v_add_u32 v79, 154752, v79
    ds_read_u16 v79, v79
    v_and_b32 v80, 0x3fc, v126
    v_add_u32 v80, 154752, v80
    ds_read_u16 v80, v80
    v_and_b32 v81, 0x3fc, v127
    v_add_u32 v81, 154752, v81
    ds_read_u16 v81, v81
    s_waitcnt lgkmcnt(0)
    v_cmpx_lt_u32 vcc, 1056, v228
    v_or_b32 v205, 0x10000, v205
    s_mov_b64 exec, -1
    v_cmpx_lt_u32 vcc, 1056, v229
    v_or_b32 v209, 0x10000, v209
    s_mov_b64 exec, -1
    v_cmpx_lt_u32 vcc, 1056, v230
    v_or_b32 v213, 0x10000, v213
    s_mov_b64 exec, -1
    v_cmpx_lt_u32 vcc, 1056, v231
    v_or_b32 v217, 0x10000, v217
    s_mov_b64 exec, -1
    s_mul_i32 s10, s2, 4152
    s_mov_b32 s34, 18874368
    s_mov_b32 s35, 23592960
    v_mul_u32_u24 v64, s11, v128
    v_lshrrev_b32 v64, 16, v64
    v_add3_u32 v64, v64, v74, s10
    v_lshlrev_b32 v65, 2, v64
    v_cmpx_le_u32 vcc, 1056, v128
    s_cbranch_execz L_PO0
    buffer_store_byte v136, v64, s[52:55], s35 offen sc1
    buffer_store_dword v104, v65, s[52:55], s34 offen sc1
L_PO0:
    s_mov_b64 exec, -1
    v_mul_u32_u24 v64, s11, v129
    v_lshrrev_b32 v64, 16, v64
    v_add3_u32 v64, v64, v75, s10
    v_lshlrev_b32 v65, 2, v64
    v_cmpx_le_u32 vcc, 1056, v129
    s_cbranch_execz L_PO1
    buffer_store_byte v137, v64, s[52:55], s35 offen sc1
    buffer_store_dword v105, v65, s[52:55], s34 offen sc1
L_PO1:
    s_mov_b64 exec, -1
    v_mul_u32_u24 v64, s11, v130
    v_lshrrev_b32 v64, 16, v64
    v_add3_u32 v64, v64, v76, s10
    v_lshlrev_b32 v65, 2, v64
    v_cmpx_le_u32 vcc, 1056, v130
    s_cbranch_execz L_PO2
    buffer_store_byte v138, v64, s[52:55], s35 offen sc1
    buffer_store_dword v106, v65, s[52:55], s34 offen sc1
L_PO2:
    s_mov_b64 exec, -1
    v_mul_u32_u24 v64, s11, v131
    v_lshrrev_b32 v64, 16, v64
    v_add3_u32 v64, v64, v77, s10
    v_lshlrev_b32 v65, 2, v64
    v_cmpx_le_u32 vcc, 1056, v131
    s_cbranch_execz L_PO3
    buffer_store_byte v139, v64, s[52:55], s35 offen sc1
    buffer_store_dword v107, v65, s[52:55], s34 offen sc1
L_PO3:
    s_mov_b64 exec, -1
    v_mul_u32_u24 v64, s11, v132
    v_lshrrev_b32 v64, 16, v64
    v_add3_u32 v64, v64, v78, s10
    v_lshlrev_b32 v65, 2, v64
    v_cmpx_le_u32 vcc, 1056, v132
    s_cbranch_execz L_PO4
    buffer_store_byte v136, v64, s[52:55], s35 offen sc1
    buffer_store_dword v108, v65, s[52:55], s34 offen sc1
L_PO4:
    s_mov_b64 exec, -1
    v_mul_u32_u24 v64, s11, v133
    v_lshrrev_b32 v64, 16, v64
    v_add3_u32 v64, v64, v79, s10
    v_lshlrev_b32 v65, 2, v64
    v_cmpx_le_u32 vcc, 1056, v133
    s_cbranch_execz L_PO5
    buffer_store_byte v137, v64, s[52:55], s35 offen sc1
    buffer_store_dword v109, v65, s[52:55], s34 offen sc1
L_PO5:
    s_mov_b64 exec, -1
    v_mul_u32_u24 v64, s11, v134
    v_lshrrev_b32 v64, 16, v64
    v_add3_u32 v64, v64, v80, s10
    v_lshlrev_b32 v65, 2, v64
    v_cmpx_le_u32 vcc, 1056, v134
    s_cbranch_execz L_PO6
    buffer_store_byte v138, v64, s[52:55], s35 offen sc1
    buffer_store_dword v110, v65, s[52:55], s34 offen sc1
L_PO6:
    s_mov_b64 exec, -1
    v_mul_u32_u24 v64, s11, v135
    v_lshrrev_b32 v64, 16, v64
    v_add3_u32 v64, v64, v81, s10
    v_lshlrev_b32 v65, 2, v64
    v_cmpx_le_u32 vcc, 1056, v135
    s_cbranch_execz L_PO7
    buffer_store_byte v139, v64, s[52:55], s35 offen sc1
    buffer_store_dword v111, v65, s[52:55], s34 offen sc1
L_PO7:
    s_mov_b64 exec, -1
    s_waitcnt vmcnt(0) lgkmcnt(0)
    s_barrier
    s_branch L_POUT
L_SLOW:
    s_setprio 0
    s_lshl_b32 s10, s3, 6
    v_add_u32 v255, s10, v253
    s_cmp_lg_u32 s19, 4
    s_cbranch_scc1 L_SL1
    s_mov_b32 s19, 1
    v_and_b32 v188, 0xff, v255
    v_lshlrev_b32 v189, 7, v188
    buffer_load_dword v190, v189, s[56:59], 0 offen offset:4 sc1
    v_lshlrev_b32 v189, 10, v188
    s_lshl_b32 s10, s5, 2
    s_add_u32 s10, s10, 24772608
    buffer_load_dword v191, v189, s[52:55], s10 offen sc1
    v_lshlrev_b32 v188, 2, v188
    v_add_u32 v188, 154752, v188
    s_waitcnt vmcnt(0)
    v_and_b32 v190, 0x10000, v190
    v_cmp_ne_u32 vcc, 0, v190
    v_mov_b32 v190, 2097152
    s_nop 0
    v_cndmask_b32 v190, v190, v191, vcc
    ds_write_b32 v188, v190
    s_waitcnt lgkmcnt(0)
    s_barrier
L_SL1:
    s_add_u32 s28, s28, 288
    s_cmp_lt_u32 s28, s29
    s_cbranch_scc1 L_BATCH
L_FIND:
    s_cmp_lg_u64 s[32:33], 0
    s_cbranch_scc1 L_GOT
    s_add_u32 s26, s26, 1
    s_cmp_ge_u32 s26, 4
    s_cbranch_scc1 L_EPI
    s_lshl_b32 s10, s26, 8
    s_add_u32 s10, s10, 154752
    v_lshl_add_u32 v188, v253, 2, s10
    ds_read_u16 v188, v188 offset:2
    s_waitcnt lgkmcnt(0)
    v_cmp_lt_u32 s[32:33], s20, v188
    s_nop 3
    s_branch L_FIND
L_GOT:
    s_ff1_i32_b64 s10, s[32:33]
    s_bitset0_b64 s[32:33], s10
    s_lshl_b32 s11, s26, 6
    s_add_u32 s27, s10, s11
    s_lshl_b32 s10, s27, 2
    s_add_u32 s10, s10, 154752
    v_mov_b32 v188, s10
    ds_read_b32 v188, v188
    s_waitcnt lgkmcnt(0)
    v_readfirstlane_b32 s10, v188
    s_nop 3
    s_lshr_b32 s29, s10, 16
    s_and_b32 s30, s10, 0xffff
    s_mov_b32 s28, s20
L_BATCH:
    s_waitcnt vmcnt(0)
    s_barrier
    v_mov_b64 v[192:193], 0
    v_mov_b64 v[194:195], 0
    v_mov_b32 v196, 0x20fffff
    v_mov_b32 v197, 0x20fffff
    v_mov_b32 v198, 0x20fffff
    v_mov_b32 v199, 0x20fffff
    v_lshl_add_u32 v200, v253, 4, s12
    ds_write_b128 v200, v[192:195] offset:0
    ds_write_b128 v200, v[196:199] offset:18432
    ds_write_b128 v200, v[192:195] offset:1024
    ds_write_b128 v200, v[196:199] offset:19456
    ds_write_b128 v200, v[192:195] offset:1280
    ds_write_b128 v200, v[196:199] offset:19712
    v_and_b32 v188, 15, v253
    v_mul_u32_u24 v189, 1152, v188
    v_add_u32 v189, 8192, v189
    v_lshlrev_b32 v188, 2, v188
    ds_write_b32 v188, v189 offset:576
    v_add_u32 v188, s28, v255
    s_mul_i32 s36, s27, 3128
    s_mul_i32 s11, s27, 4152
    s_add_u32 s11, s11, s30
    s_lshl_b32 s34, s11, 2
    s_add_u32 s34, s34, 18874368
    v_lshl_add_u32 v190, v188, 2, s34
    s_add_u32 s34, s11, 23592960
    v_add_u32 v191, s34, v188
    s_mul_i32 s10, s5, 32896
    s_lshl_b32 s34, s27, 7
    s_add_u32 s10, s10, s34
    s_add_u32 s10, s10, 65536
    v_and_b32 v206, 7, v188
    v_lshl_add_u32 v206, v206, 4, s10
    v_lshrrev_b32 v207, 3, v188
    v_cmpx_gt_u32 vcc, 32, v188
    v_add_u32 v190, 8421376, v206
    v_add_u32 v191, 8, v190
    v_cmpx_gt_u32 vcc, 24, v188
    v_lshl_add_u32 v190, v207, 2, v206
    v_add3_u32 v191, v206, v207, 12
    s_mov_b64 exec, -1
    s_add_u32 s10, s28, 288
    s_min_u32 s10, s10, s29
    v_cmp_gt_u32 vcc, s10, v188
    v_mov_b32 v206, 0x7ffffff0
    s_nop 0
    v_cndmask_b32 v190, v206, v190, vcc
    v_cndmask_b32 v191, v206, v191, vcc
    buffer_load_dwordx2 v[204:205], v190, s[52:55], 0 offen sc1
    buffer_load_ubyte v191, v191, s[52:55], 0 offen sc1
    s_waitcnt lgkmcnt(0)
    s_barrier
    s_waitcnt vmcnt(0)
    v_cmp_ne_u32 vcc, 3, v207
    v_cmp_eq_u32 s[10:11], s6, v205
    v_mov_b32 v206, s36
    s_or_b64 exec, vcc, s[10:11]
    v_cmpx_ne_u32 vcc, 0, v204
    v_bfe_u32 v190, v204, 18, 8
    v_lshlrev_b32 v190, 2, v190
    v_add_u32 v188, 153728, v190
    ds_read_b32 v188, v188
    v_add_u32_sdwa v191, v191, v206 dst_sel:DWORD dst_unused:UNUSED_PAD src0_sel:BYTE_0 src1_sel:DWORD
    v_lshrrev_b32 v189, 28, v204
    v_lshl_add_u32 v191, v189, 8, v191
    v_and_b32 v189, 60, v190
    v_lshl_add_u32 v191, v189, 19, v191
    v_mov_b32 v190, 4
    v_and_b32 v204, 0xffff, v204
    s_waitcnt lgkmcnt(0)
    ds_add_rtn_u32 v188, v188, v190 offset:576
    s_waitcnt lgkmcnt(0)
    ds_write2st64_b32 v188, v204, v191 offset0:148 offset1:220
    s_mov_b64 exec, -1
    s_waitcnt lgkmcnt(0)
    s_barrier
    v_lshrrev_b32 v190, 3, v253
    v_lshl_add_u32 v247, v190, 4, s12
    s_add_u32 s10, s12, 18432
    v_lshrrev_b32 v190, 1, v253
    v_lshl_add_u32 v248, v190, 2, s10
    s_add_u32 s10, s10, 2
    v_and_b32 v190, 48, v253
    v_lshl_add_u32 v250, v190, 1, s10
    v_and_b32 v190, 12, v253
    v_add_u32 v250, v250, v190
    v_lshrrev_b32 v190, 5, v253
    v_mul_u32_u24 v249, 18432, v190
    v_and_b32 v190, 15, v253
    v_lshl_add_u32 v249, v190, 2, v249
    s_add_u32 s10, s12, 2
    v_add_u32 v249, s10, v249
    ds_read_b128 v[236:239], v247
    ds_read_b32 v240, v248
    s_lshl_b32 s10, s4, 3
    v_mov_b32 v190, s10
    ds_read_b64 v[190:191], v190 offset:576
    s_waitcnt lgkmcnt(0)
    v_readfirstlane_b32 s34, v190
    v_readfirstlane_b32 s35, v191
    s_sub_u32 s10, s12, 37888
    s_sub_u32 s34, s34, s10
    s_sub_u32 s35, s35, s10
    s_sub_u32 s35, s35, 1152
    s_add_u32 s10, s34, 127
    s_lshr_b32 s10, s10, 7
    s_lshl1_add_u32 s10, s10, -1
    s_add_u32 s11, s35, 127
    s_lshr_b32 s11, s11, 6
    s_and_b32 s11, s11, -2
    s_max_i32 s17, s10, s11
    s_cselect_b32 s10, s34, s35
    s_sub_u32 s10, s10, 1
    s_andn2_b32 s99, 64, s10
    s_add_u32 m0, s13, 0
    v_mad_u32_u16 v236, v236, s15, v243
    buffer_load_dwordx4 v236, s[40:43], 0 offen lds
    s_add_u32 m0, s13, 1056
    v_mad_u32_u16 v237, v237, s15, v243
    buffer_load_dwordx4 v237, s[40:43], 0 offen lds
    s_add_u32 m0, s13, 2112
    v_mad_u32_u16 v238, v238, s15, v243
    buffer_load_dwordx4 v238, s[40:43], 0 offen lds
    s_add_u32 m0, s13, 3168
    v_mad_u32_u16 v239, v239, s15, v243
    buffer_load_dwordx4 v239, s[40:43], 0 offen lds
    s_mov_b32 m0, s14
    v_and_b32 v240, 0xfffff, v240
    buffer_load_dwordx4 v[240:241], s[44:47], 0 idxen offen lds
L_LAST:
    s_branch L_GO
.section .rodata,"a"
.p2align 6
.amdhsa_kernel standalone__edge_featured_mpnn_gatedgcn__graph_kernel
  .amdhsa_next_free_vgpr 256
  .amdhsa_next_free_sgpr 102
  .amdhsa_accum_offset 256
  .amdhsa_group_segment_fixed_size 0
  .amdhsa_kernarg_size 96
  .amdhsa_user_sgpr_count 2
  .amdhsa_user_sgpr_kernarg_segment_ptr 1
  .amdhsa_system_sgpr_workgroup_id_x 1
.end_amdhsa_kernel
```

```asm
; @launch grid=(256,1,1) block=(512,1,1) lds=157824
.amdgcn_target "amdgcn-amd-amdhsa--gfx950"
.text
.globl standalone__edge_featured_mpnn_gatedgcn__graph_kernel
.p2align 8
.type standalone__edge_featured_mpnn_gatedgcn__graph_kernel,@function
standalone__edge_featured_mpnn_gatedgcn__graph_kernel:
    s_load_dwordx16 s[16:31], s[0:1], 0
    s_load_dwordx8 s[32:39], s[0:1], 64
    s_getpc_b64 s[64:65]
L_PC:
    s_and_b32 s3, s2, -8
    v_add_lshl_u32 v1, v0, s3, 7
    v_min_u32 v1, L_LAST-L_PC, v1
    v_cmpx_gt_u32 vcc, 8, v0
    s_cbranch_execz L_NOCPF
    global_load_dword v251, v1, s[64:65]
L_NOCPF:
    s_mov_b64 exec, -1
    s_cmp_ge_u32 s2, 256
    s_cbranch_scc1 L_END
    s_mul_i32 s10, s2, 12512
    v_lshl_add_u32 v1, v0, 4, s10
    s_add_u32 s11, s10, 12512
    s_min_u32 s11, s11, 3200000
    v_add_u32 v2, 0x2000, v1
    s_waitcnt lgkmcnt(0)
    global_load_dwordx4 v[128:131], v1, s[22:23] nt
    global_load_dwordx4 v[96:99], v1, s[20:21] nt
    v_cmpx_gt_u32 s[70:71], s11, v2
    s_cbranch_execz L_NO7
    global_load_dwordx4 v[132:135], v2, s[22:23] nt
    global_load_dwordx4 v[100:103], v2, s[20:21] nt
L_NO7:
    s_mov_b64 exec, -1
    s_load_dword s6, s[38:39], 0
    v_mov_b32 v255, v0
    v_lshrrev_b32 v188, 6, v0
    v_and_b32 v253, 63, v0
    v_readfirstlane_b32 s3, v188
    v_lshlrev_b32 v232, 4, v0
    v_lshlrev_b32 v190, 3, v0
    v_lshlrev_b32 v191, 2, v0
    v_and_b32 v192, 0x3fc, v191
    s_and_b32 s5, s2, 7
    s_lshr_b32 s4, s2, 3
    s_lshl_b32 s5, s5, 5
    s_add_u32 s5, s5, s4
    s_mul_i32 s9, s5, 196
    s_cmp_eq_u32 s3, 7
    s_cselect_b32 s101, 0, s3
    s_lshl_b32 s12, s101, 5
    s_add_u32 s9, s9, s12
    v_lshrrev_b32 v193, 3, v253
    v_lshl_add_u32 v193, v193, 2, s9
    v_and_b32 v243, 7, v253
    v_lshlrev_b32 v243, 4, v243
    v_lshl_add_u32 v234, v193, 7, v243
    s_lshl_b32 s101, s101, 10
    s_add_u32 s101, s101, 116736
    v_mov_b64 v[196:197], 0
    v_mov_b64 v[198:199], 0
    v_mov_b32 v194, 132
    ds_write2st64_b32 v192, v194, v196 offset0:20 offset1:24
    v_add_u32 v193, 46080, v232
    ds_write_b128 v193, v[196:199] offset:0
    ds_write_b128 v193, v[196:199] offset:8192
    ds_write_b128 v193, v[196:199] offset:16384
    ds_write_b128 v193, v[196:199] offset:24576
    ds_write_b128 v193, v[196:199] offset:32768
    s_mov_b32 s44, s18
    s_or_b32 s45, s19, 0x200000
    s_mov_b32 s46, 800000
    s_mov_b32 s47, 0x20000
    s_mov_b32 s48, s34
    s_mov_b32 s49, s35
    s_mov_b32 s50, 6400000
    s_mov_b32 s51, 0x20000
    s_mov_b32 s40, s16
    s_mov_b32 s41, s17
    s_mov_b32 s42, 6400000
    s_mov_b32 s43, 0x20000
    s_mov_b32 s52, s38
    s_mov_b32 s53, s39
    s_mov_b32 s54, 25165824
    s_mov_b32 s55, 0x20000
    s_lshl_b32 s12, s2, 7
    s_add_u32 s12, s12, 65536
    s_add_u32 s56, s38, s12
    s_addc_u32 s57, s39, 0
    s_mov_b32 s58, 16809984
    s_mov_b32 s59, 0x20000
    s_mov_b32 s64, 85599
    s_mov_b32 s65, 4294967100
    s_movk_i32 s66, 5368
    s_mov_b32 s67, 0xc000000
    s_mov_b32 s68, 32896
    v_add_u32 v120, 0, v191
    v_add_u32 v121, 1, v191
    v_add_u32 v122, 2, v191
    v_add_u32 v123, 3, v191
    s_lshl_b32 s10, s3, 28
    s_or_b32 s10, s10, 0x20000
    v_mov_b32 v144, s10
    v_or_b32 v145, 0x80000000, v144
    v_mov_b32 v184, 33
    v_mov_b32 v146, 0x400
    s_and_b32 s10, s3, 3
    s_lshr_b32 s4, s3, 2
    s_lshl1_add_u32 s4, s10, s4
    s_xor_b32 s4, s4, 1
    s_mul_i32 s10, s4, 49
    s_sub_i32 s10, s10, 6
    s_ashr_i32 s10, s10, 1
    s_max_i32 s7, s10, 0
    s_mul_i32 s13, s4, 4224
    s_add_u32 s13, s13, 82944
    s_lshl_b32 s14, s4, 10
    s_add_u32 s14, s14, 5120
    s_mul_i32 s12, s4, 2304
    s_add_u32 s12, s12, 46080
    s_movk_i32 s15, 128
    v_bfe_u32 v194, v255, 4, 4
    v_and_b32 v195, 7, v255
    v_cmp_eq_u32 vcc, v194, v195
    v_and_b32 v194, 8, v255
    v_lshlrev_b32 v194, 1, v194
    v_mov_b32 v196, 0x3f80
    v_lshlrev_b32 v196, v194, v196
    v_cndmask_b32 v196, 0, v196, vcc
    ds_write_b32 v192, v196 offset:0
    v_mov_b64 v[196:197], 0
    ds_write_b64 v190, v[196:197] offset:1024
    v_add_u32 v194, 155776, v192
    ds_write_b32 v194, v196
    v_lshrrev_b32 v223, 3, v255
    v_mad_u32_u24 v220, v223, s68, v243
    v_mul_u32_u24 v224, 160, v223
    v_add_u32 v221, v224, v243
    v_add_u32 v221, 46080, v221
    v_bfe_u32 v194, v255, 5, 1
    v_bfe_u32 v196, v255, 6, 1
    v_sub_u32 v194, v194, v196
    v_mul_i32_i24 v194, 640, v194
    v_add_u32 v224, v224, v194
    v_lshl_add_u32 v224, v195, 2, v224
    v_add_u32 v224, 13312, v224
    v_lshlrev_b32 v185, 4, v253
    v_and_b32 v241, 1, v253
    v_lshlrev_b32 v241, 4, v241
    s_bitcmp1_b32 s4, 0
    s_cselect_b32 s10, 1, -1
    s_lshl_b32 s10, s10, 24
    s_or_b32 s10, s10, 0xdddd
    v_mov_b32 v242, s10
    v_and_b32 v245, 16, v253
    v_and_b32 v194, 15, v253
    v_lshl_add_u32 v194, v194, 5, s14
    s_mov_b32 exec_hi, 0
    v_add_u32 v245, v245, v194
    s_mov_b32 exec_hi, -1
    v_and_b32 v194, 3, v253
    v_lshlrev_b32 v246, 3, v194
    v_bfe_u32 v196, v253, 2, 2
    v_and_b32 v197, 48, v253
    v_lshl_add_u32 v198, v196, 7, v197
    v_mul_u32_u24 v244, 1056, v194
    v_add3_u32 v244, v244, v198, s13
    v_bfe_u32 v197, v253, 2, 3
    v_lshrrev_b32 v196, 5, v253
    v_lshl_add_u32 v197, v196, 4, v197
    v_mul_u32_u24 v225, 160, v197
    v_add_u32 v225, v225, v246
    v_lshrrev_b32 v194, 3, v253
    v_lshl_add_u32 v247, v194, 4, s12
    s_add_u32 s10, s12, 18432
    v_lshrrev_b32 v194, 1, v253
    v_lshl_add_u32 v248, v194, 2, s10
    s_add_u32 s10, s10, 2
    v_and_b32 v194, 48, v253
    v_lshl_add_u32 v250, v194, 1, s10
    v_and_b32 v194, 12, v253
    v_add_u32 v250, v250, v194
    v_lshrrev_b32 v194, 5, v253
    v_mul_u32_u24 v249, 18432, v194
    v_and_b32 v194, 15, v253
    v_lshl_add_u32 v249, v194, 2, v249
    s_add_u32 s10, s12, 2
    v_add_u32 v249, s10, v249
    s_movk_i32 s69, 11520
    v_mov_b64 v[116:117], 0
    v_mov_b64 v[118:119], 0
    s_waitcnt lgkmcnt(0)
    s_barrier
    s_add_u32 s6, s6, 0x2020202
    v_lshlrev_b32 v186, v246, s6
    v_and_b32 v194, 4, v253
    v_mul_u32_u24 v194, 1212416, v194
    v_lshl_add_u32 v186, v194, 8, v186
    v_and_b32 v186, 0xfe000000, v186
    v_and_b32 v187, 7, v253
    v_mul_u32_u24 v187, 33, v187
    v_add_u32 v187, 792, v187
    v_lshlrev_b32 v222, 2, v223
    s_cmp_eq_u64 s[70:71], 0
    s_cbranch_scc1 L_R4
    s_waitcnt vmcnt(3)
    v_mul_u32_u24 v104, s64, v128
    v_mul_u32_u24 v105, s64, v129
    v_mul_u32_u24 v106, s64, v130
    v_mul_u32_u24 v107, s64, v131
    v_lshrrev_b32 v136, 29, v104
    v_lshrrev_b32 v137, 29, v105
    v_lshrrev_b32 v138, 29, v106
    v_lshrrev_b32 v139, 29, v107
    v_cmp_eq_u32 s[72:73], v136, v137
    v_cmp_eq_u32 s[76:77], v138, v139
    v_cmp_eq_u32 vcc, v136, v138
    v_cmp_eq_u32 s[88:89], v137, v139
    v_cmp_eq_u32 s[90:91], v136, v139
    v_cmp_eq_u32 s[10:11], v137, v138
    v_lshrrev_b32 v104, 24, v104
    v_lshrrev_b32 v105, 24, v105
    v_lshrrev_b32 v106, 24, v106
    v_lshrrev_b32 v107, 24, v107
    s_or_b64 s[74:75], s[72:73], s[88:89]
    s_or_b64 s[78:79], s[76:77], s[88:89]
    s_or_b64 s[72:73], s[72:73], vcc
    s_or_b64 s[76:77], s[76:77], vcc
    s_or_b64 s[72:73], s[72:73], s[90:91]
    s_or_b64 s[74:75], s[74:75], s[10:11]
    s_or_b64 s[76:77], s[76:77], s[10:11]
    s_or_b64 s[78:79], s[78:79], s[90:91]
    v_cndmask_b32 v136, 0, v146, s[72:73]
    v_lshl_add_u32 v136, v104, 2, v136
    ds_add_rtn_u32 v112, v136, v184 offset:5120
    v_cndmask_b32 v137, 0, v146, s[74:75]
    v_lshl_add_u32 v137, v105, 2, v137
    ds_add_rtn_u32 v113, v137, v184 offset:5120
    v_cndmask_b32 v138, 0, v146, s[76:77]
    v_lshl_add_u32 v138, v106, 2, v138
    ds_add_rtn_u32 v114, v138, v184 offset:5120
    v_cndmask_b32 v139, 0, v146, s[78:79]
    v_lshl_add_u32 v139, v107, 2, v139
    ds_add_rtn_u32 v115, v139, v184 offset:5120
    s_waitcnt vmcnt(1)
    s_mov_b64 exec, s[70:71]
    v_mul_u32_u24 v108, s64, v132
    v_mul_u32_u24 v109, s64, v133
    v_mul_u32_u24 v110, s64, v134
    v_mul_u32_u24 v111, s64, v135
    v_lshrrev_b32 v108, 24, v108
    v_lshrrev_b32 v109, 24, v109
    v_lshrrev_b32 v110, 24, v110
    v_lshrrev_b32 v111, 24, v111
    v_lshlrev_b32 v140, 2, v108
    ds_add_rtn_u32 v116, v140, v184 offset:5120
    v_lshlrev_b32 v141, 2, v109
    ds_add_rtn_u32 v117, v141, v184 offset:5120
    v_lshlrev_b32 v142, 2, v110
    ds_add_rtn_u32 v118, v142, v184 offset:5120
    v_lshlrev_b32 v143, 2, v111
    ds_add_rtn_u32 v119, v143, v184 offset:5120
    s_waitcnt lgkmcnt(7)
    s_mov_b64 exec, s[72:73]
    v_cmpx_le_u32 vcc, 132, v112
    ds_add_rtn_u32 v112, v136, v184 offset:4096
    s_waitcnt lgkmcnt(7)
    s_mov_b64 exec, s[74:75]
    v_cmpx_le_u32 vcc, 132, v113
    ds_add_rtn_u32 v113, v137, v184 offset:4096
    s_waitcnt lgkmcnt(7)
    s_mov_b64 exec, s[76:77]
    v_cmpx_le_u32 vcc, 132, v114
    ds_add_rtn_u32 v114, v138, v184 offset:4096
    s_waitcnt lgkmcnt(7)
    s_mov_b64 exec, s[78:79]
    v_cmpx_le_u32 vcc, 132, v115
    ds_add_rtn_u32 v115, v139, v184 offset:4096
    s_mov_b64 exec, s[70:71]
    s_waitcnt vmcnt(0)
    v_mad_i32_i24 v132, v108, s65, v132
    v_mul_u32_u24 v194, s66, v100
    v_lshl_or_b32 v100, v132, 18, v100
    v_and_or_b32 v194, v194, s67, v145
    v_mad_u32_u24 v132, v108, 40, s69
    v_or_b32 v100, v100, v194
    v_mad_i32_i24 v133, v109, s65, v133
    v_mul_u32_u24 v194, s66, v101
    v_lshl_or_b32 v101, v133, 18, v101
    v_and_or_b32 v194, v194, s67, v145
    v_mad_u32_u24 v133, v109, 40, s69
    v_or_b32 v101, v101, v194
    v_mad_i32_i24 v134, v110, s65, v134
    v_mul_u32_u24 v194, s66, v102
    v_lshl_or_b32 v102, v134, 18, v102
    v_and_or_b32 v194, v194, s67, v145
    v_mad_u32_u24 v134, v110, 40, s69
    v_or_b32 v102, v102, v194
    v_mad_i32_i24 v135, v111, s65, v135
    v_mul_u32_u24 v194, s66, v103
    v_lshl_or_b32 v103, v135, 18, v103
    v_and_or_b32 v194, v194, s67, v145
    v_mad_u32_u24 v135, v111, 40, s69
    v_or_b32 v103, v103, v194
    s_waitcnt lgkmcnt(7)
    v_bfe_u32 v194, v116, 3, 5
    v_add_lshl_u32 v132, v194, v132, 2
    v_and_b32 v194, 3, v194
    v_mad_i32_i24 v194, v194, -3, v132
    v_cmpx_gt_u32 vcc, 792, v116
    ds_write_b32 v132, v100
    ds_write_b8 v194, v120 offset:12
    s_mov_b64 exec, s[70:71]
    s_waitcnt lgkmcnt(8)
    v_bfe_u32 v194, v117, 3, 5
    v_add_lshl_u32 v133, v194, v133, 2
    v_and_b32 v194, 3, v194
    v_mad_i32_i24 v194, v194, -3, v133
    v_cmpx_gt_u32 vcc, 792, v117
    ds_write_b32 v133, v101
    ds_write_b8 v194, v121 offset:12
    s_mov_b64 exec, s[70:71]
    s_waitcnt lgkmcnt(9)
    v_bfe_u32 v194, v118, 3, 5
    v_add_lshl_u32 v134, v194, v134, 2
    v_and_b32 v194, 3, v194
    v_mad_i32_i24 v194, v194, -3, v134
    v_cmpx_gt_u32 vcc, 792, v118
    ds_write_b32 v134, v102
    ds_write_b8 v194, v122 offset:12
    s_mov_b64 exec, s[70:71]
    s_waitcnt lgkmcnt(10)
    v_bfe_u32 v194, v119, 3, 5
    v_add_lshl_u32 v135, v194, v135, 2
    v_and_b32 v194, 3, v194
    v_mad_i32_i24 v194, v194, -3, v135
    v_cmpx_gt_u32 vcc, 792, v119
    ds_write_b32 v135, v103
    ds_write_b8 v194, v123 offset:12
    s_mov_b64 exec, -1
    v_mad_i32_i24 v128, v104, s65, v128
    v_mul_u32_u24 v194, s66, v96
    v_lshl_or_b32 v96, v128, 18, v96
    v_and_or_b32 v194, v194, s67, v144
    v_mad_u32_u24 v128, v104, 40, s69
    v_or_b32 v96, v96, v194
    v_mad_i32_i24 v129, v105, s65, v129
    v_mul_u32_u24 v194, s66, v97
    v_lshl_or_b32 v97, v129, 18, v97
    v_and_or_b32 v194, v194, s67, v144
    v_mad_u32_u24 v129, v105, 40, s69
    v_or_b32 v97, v97, v194
    v_mad_i32_i24 v130, v106, s65, v130
    v_mul_u32_u24 v194, s66, v98
    v_lshl_or_b32 v98, v130, 18, v98
    v_and_or_b32 v194, v194, s67, v144
    v_mad_u32_u24 v130, v106, 40, s69
    v_or_b32 v98, v98, v194
    v_mad_i32_i24 v131, v107, s65, v131
    v_mul_u32_u24 v194, s66, v99
    v_lshl_or_b32 v99, v131, 18, v99
    v_and_or_b32 v194, v194, s67, v144
    v_mad_u32_u24 v131, v107, 40, s69
    v_or_b32 v99, v99, v194
    s_waitcnt lgkmcnt(11)
    v_bfe_u32 v194, v112, 3, 5
    v_add_lshl_u32 v128, v194, v128, 2
    v_and_b32 v194, 3, v194
    v_mad_i32_i24 v194, v194, -3, v128
    v_cmpx_gt_u32 vcc, 792, v112
    ds_write_b32 v128, v96
    ds_write_b8 v194, v120 offset:12
    s_mov_b64 exec, -1
    s_waitcnt lgkmcnt(12)
    v_bfe_u32 v194, v113, 3, 5
    v_add_lshl_u32 v129, v194, v129, 2
    v_and_b32 v194, 3, v194
    v_mad_i32_i24 v194, v194, -3, v129
    v_cmpx_gt_u32 vcc, 792, v113
    ds_write_b32 v129, v97
    ds_write_b8 v194, v121 offset:12
    s_mov_b64 exec, -1
    s_waitcnt lgkmcnt(13)
    v_bfe_u32 v194, v114, 3, 5
    v_add_lshl_u32 v130, v194, v130, 2
    v_and_b32 v194, 3, v194
    v_mad_i32_i24 v194, v194, -3, v130
    v_cmpx_gt_u32 vcc, 792, v114
    ds_write_b32 v130, v98
    ds_write_b8 v194, v122 offset:12
    s_mov_b64 exec, -1
    s_waitcnt lgkmcnt(14)
    v_bfe_u32 v194, v115, 3, 5
    v_add_lshl_u32 v131, v194, v131, 2
    v_and_b32 v194, 3, v194
    v_mad_i32_i24 v194, v194, -3, v131
    v_cmpx_gt_u32 vcc, 792, v115
    ds_write_b32 v131, v99
    ds_write_b8 v194, v123 offset:12
    s_mov_b64 exec, -1
    s_branch L_B1
L_R4:
    s_waitcnt vmcnt(1)
    v_mul_u32_u24 v104, s64, v128
    v_mul_u32_u24 v105, s64, v129
    v_mul_u32_u24 v106, s64, v130
    v_mul_u32_u24 v107, s64, v131
    v_lshrrev_b32 v136, 29, v104
    v_lshrrev_b32 v137, 29, v105
    v_lshrrev_b32 v138, 29, v106
    v_lshrrev_b32 v139, 29, v107
    v_cmp_eq_u32 s[72:73], v136, v137
    v_cmp_eq_u32 s[76:77], v138, v139
    v_cmp_eq_u32 vcc, v136, v138
    v_cmp_eq_u32 s[88:89], v137, v139
    v_cmp_eq_u32 s[90:91], v136, v139
    v_cmp_eq_u32 s[10:11], v137, v138
    v_lshrrev_b32 v104, 24, v104
    v_lshrrev_b32 v105, 24, v105
    v_lshrrev_b32 v106, 24, v106
    v_lshrrev_b32 v107, 24, v107
    s_or_b64 s[74:75], s[72:73], s[88:89]
    s_or_b64 s[78:79], s[76:77], s[88:89]
    s_or_b64 s[72:73], s[72:73], vcc
    s_or_b64 s[76:77], s[76:77], vcc
    s_or_b64 s[72:73], s[72:73], s[90:91]
    s_or_b64 s[74:75], s[74:75], s[10:11]
    s_or_b64 s[76:77], s[76:77], s[10:11]
    s_or_b64 s[78:79], s[78:79], s[90:91]
    v_cndmask_b32 v136, 0, v146, s[72:73]
    v_lshl_add_u32 v136, v104, 2, v136
    ds_add_rtn_u32 v112, v136, v184 offset:5120
    v_cndmask_b32 v137, 0, v146, s[74:75]
    v_lshl_add_u32 v137, v105, 2, v137
    ds_add_rtn_u32 v113, v137, v184 offset:5120
    v_cndmask_b32 v138, 0, v146, s[76:77]
    v_lshl_add_u32 v138, v106, 2, v138
    ds_add_rtn_u32 v114, v138, v184 offset:5120
    v_cndmask_b32 v139, 0, v146, s[78:79]
    v_lshl_add_u32 v139, v107, 2, v139
    ds_add_rtn_u32 v115, v139, v184 offset:5120
    s_waitcnt vmcnt(0)
    v_mad_i32_i24 v128, v104, s65, v128
    v_mul_u32_u24 v194, s66, v96
    v_lshl_or_b32 v96, v128, 18, v96
    v_and_or_b32 v194, v194, s67, v144
    v_mad_u32_u24 v128, v104, 40, s69
    v_or_b32 v96, v96, v194
    v_mad_i32_i24 v129, v105, s65, v129
    v_mul_u32_u24 v194, s66, v97
    v_lshl_or_b32 v97, v129, 18, v97
    v_and_or_b32 v194, v194, s67, v144
    v_mad_u32_u24 v129, v105, 40, s69
    v_or_b32 v97, v97, v194
    s_waitcnt lgkmcnt(3)
    s_mov_b64 exec, s[72:73]
    v_cmpx_le_u32 vcc, 132, v112
    ds_add_rtn_u32 v112, v136, v184 offset:4096
    s_waitcnt lgkmcnt(3)
    s_mov_b64 exec, s[74:75]
    v_cmpx_le_u32 vcc, 132, v113
    ds_add_rtn_u32 v113, v137, v184 offset:4096
    s_waitcnt lgkmcnt(3)
    s_mov_b64 exec, s[76:77]
    v_cmpx_le_u32 vcc, 132, v114
    ds_add_rtn_u32 v114, v138, v184 offset:4096
    s_waitcnt lgkmcnt(3)
    s_mov_b64 exec, s[78:79]
    v_cmpx_le_u32 vcc, 132, v115
    ds_add_rtn_u32 v115, v139, v184 offset:4096
    s_mov_b64 exec, -1
    v_mad_i32_i24 v130, v106, s65, v130
    v_mul_u32_u24 v194, s66, v98
    v_lshl_or_b32 v98, v130, 18, v98
    v_and_or_b32 v194, v194, s67, v144
    v_mad_u32_u24 v130, v106, 40, s69
    v_or_b32 v98, v98, v194
    v_mad_i32_i24 v131, v107, s65, v131
    v_mul_u32_u24 v194, s66, v99
    v_lshl_or_b32 v99, v131, 18, v99
    v_and_or_b32 v194, v194, s67, v144
    v_mad_u32_u24 v131, v107, 40, s69
    v_or_b32 v99, v99, v194
    s_waitcnt lgkmcnt(3)
    v_bfe_u32 v194, v112, 3, 5
    v_add_lshl_u32 v128, v194, v128, 2
    v_and_b32 v194, 3, v194
    v_mad_i32_i24 v194, v194, -3, v128
    v_cmpx_gt_u32 vcc, 792, v112
    ds_write_b32 v128, v96
    ds_write_b8 v194, v120 offset:12
    s_mov_b64 exec, -1
    s_waitcnt lgkmcnt(4)
    v_bfe_u32 v194, v113, 3, 5
    v_add_lshl_u32 v129, v194, v129, 2
    v_and_b32 v194, 3, v194
    v_mad_i32_i24 v194, v194, -3, v129
    v_cmpx_gt_u32 vcc, 792, v113
    ds_write_b32 v129, v97
    ds_write_b8 v194, v121 offset:12
    s_mov_b64 exec, -1
    s_waitcnt lgkmcnt(5)
    v_bfe_u32 v194, v114, 3, 5
    v_add_lshl_u32 v130, v194, v130, 2
    v_and_b32 v194, 3, v194
    v_mad_i32_i24 v194, v194, -3, v130
    v_cmpx_gt_u32 vcc, 792, v114
    ds_write_b32 v130, v98
    ds_write_b8 v194, v122 offset:12
    s_mov_b64 exec, -1
    s_waitcnt lgkmcnt(6)
    v_bfe_u32 v194, v115, 3, 5
    v_add_lshl_u32 v131, v194, v131, 2
    v_and_b32 v194, 3, v194
    v_mad_i32_i24 v194, v194, -3, v131
    v_cmpx_gt_u32 vcc, 792, v115
    ds_write_b32 v131, v99
    ds_write_b8 v194, v123 offset:12
    s_mov_b64 exec, -1
L_B1:
    s_cmp_ge_u32 s3, 2
    s_cbranch_scc1 L_NOC
    global_load_dwordx4 v[176:179], v232, s[28:29]
L_NOC:
    global_load_dwordx4 v[160:163], v232, s[26:27]
    global_load_dwordx4 v[164:167], v232, s[32:33]
    global_load_dwordx4 v[168:171], v232, s[24:25]
    global_load_dwordx4 v[172:175], v232, s[30:31]
    s_mov_b32 s64, 0x1000000
    s_waitcnt lgkmcnt(0)
    s_barrier
    ds_read_b128 v[192:195], v185 offset:5120
    ds_read_b32 v228, v222 offset:5120
    ds_read_b128 v[204:207], v221 offset:0
    ds_read_b32 v229, v222 offset:5376
    ds_read_b128 v[208:211], v221 offset:10240
    ds_read_b32 v230, v222 offset:5632
    ds_read_b128 v[212:215], v221 offset:20480
    ds_read_b32 v231, v222 offset:5888
    ds_read_b128 v[216:219], v221 offset:30720
    s_mov_b32 s80, 2105344
    s_mov_b32 s81, 4210688
    s_mov_b32 s82, 6316032
    s_waitcnt lgkmcnt(8)
    v_max3_u32 v188, v192, v193, v194
    v_max_u32 v188, v188, v195
    v_cmp_lt_u32 vcc, 1056, v188
    s_cbranch_vccnz L_POVF
L_POUT:
    s_waitcnt lgkmcnt(7)
    v_sub_u32 v228, v187, v228
    v_and_or_b32 v228, v228, s64, v186
    s_waitcnt lgkmcnt(6)
    v_or_b32 v207, v207, v228
    buffer_store_dwordx4 v[204:207], v220, s[56:59], 0 offen sc1
    s_waitcnt lgkmcnt(5)
    v_sub_u32 v229, v187, v229
    v_and_or_b32 v229, v229, s64, v186
    s_waitcnt lgkmcnt(4)
    v_or_b32 v211, v211, v229
    buffer_store_dwordx4 v[208:211], v220, s[56:59], s80 offen sc1
    s_waitcnt lgkmcnt(3)
    v_sub_u32 v230, v187, v230
    v_and_or_b32 v230, v230, s64, v186
    s_waitcnt lgkmcnt(2)
    v_or_b32 v215, v215, v230
    buffer_store_dwordx4 v[212:215], v220, s[56:59], s81 offen sc1
    s_waitcnt lgkmcnt(1)
    v_sub_u32 v231, v187, v231
    v_and_or_b32 v231, v231, s64, v186
    s_waitcnt lgkmcnt(0)
    v_or_b32 v219, v219, v231
    buffer_store_dwordx4 v[216:219], v220, s[56:59], s82 offen sc1
    s_mov_b32 s10, 0xbfb8aa3b
    s_mov_b32 s11, s10
    s_mov_b32 s64, 0x05040100
    s_mov_b32 s66, 0x07060302
    s_waitcnt vmcnt(4)
    v_perm_b32 v144, v170, v168, s64
    v_perm_b32 v145, v170, v168, s66
    v_perm_b32 v146, v171, v169, s64
    v_perm_b32 v147, v171, v169, s66
    v_add_u32 v148, 77824, v224
    ds_write2_b32 v148, v144, v145 offset0:0 offset1:8
    ds_write2_b32 v148, v146, v147 offset0:16 offset1:24
    v_lshlrev_b32 v128, 16, v160
    v_and_b32 v129, 0xffff0000, v160
    v_lshlrev_b32 v130, 16, v161
    v_and_b32 v131, 0xffff0000, v161
    v_lshlrev_b32 v132, 16, v162
    v_and_b32 v133, 0xffff0000, v162
    v_lshlrev_b32 v134, 16, v163
    v_and_b32 v135, 0xffff0000, v163
    v_pk_mul_f32 v[128:129], v[128:129], s[10:11]
    v_pk_mul_f32 v[130:131], v[130:131], s[10:11]
    v_pk_mul_f32 v[132:133], v[132:133], s[10:11]
    v_pk_mul_f32 v[134:135], v[134:135], s[10:11]
    v_cvt_pk_bf16_f32 v136, v128, v132
    v_cvt_pk_bf16_f32 v137, v129, v133
    v_cvt_pk_bf16_f32 v138, v130, v134
    v_cvt_pk_bf16_f32 v139, v131, v135
    ds_write2_b32 v224, v136, v137 offset0:0 offset1:8
    ds_write2_b32 v224, v138, v139 offset0:16 offset1:24
    v_perm_b32 v152, v166, v164, s64
    v_perm_b32 v153, v166, v164, s66
    v_perm_b32 v154, v167, v165, s64
    v_perm_b32 v155, v167, v165, s66
    v_add_u32 v156, 10240, v224
    ds_write2_b32 v156, v152, v153 offset0:0 offset1:8
    ds_write2_b32 v156, v154, v155 offset0:16 offset1:24
    v_perm_b32 v144, v174, v172, s64
    v_perm_b32 v145, v174, v172, s66
    v_perm_b32 v146, v175, v173, s64
    v_perm_b32 v147, v175, v173, s66
    v_add_u32 v148, 130176, v224
    ds_write2_b32 v148, v144, v145 offset0:0 offset1:8
    ds_write2_b32 v148, v146, v147 offset0:16 offset1:24
    s_cmp_ge_u32 s3, 2
    s_cbranch_scc1 L_NOWC
    v_lshlrev_b32 v128, 16, v176
    v_and_b32 v129, 0xffff0000, v176
    v_lshlrev_b32 v130, 16, v177
    v_and_b32 v131, 0xffff0000, v177
    v_lshlrev_b32 v132, 16, v178
    v_and_b32 v133, 0xffff0000, v178
    v_lshlrev_b32 v134, 16, v179
    v_and_b32 v135, 0xffff0000, v179
    v_pk_mul_f32 v[128:129], v[128:129], s[10:11]
    v_pk_mul_f32 v[130:131], v[130:131], s[10:11]
    v_pk_mul_f32 v[132:133], v[132:133], s[10:11]
    v_pk_mul_f32 v[134:135], v[134:135], s[10:11]
    v_cvt_pk_bf16_f32 v136, v128, v132
    v_cvt_pk_bf16_f32 v137, v129, v133
    v_cvt_pk_bf16_f32 v138, v130, v134
    v_cvt_pk_bf16_f32 v139, v131, v135
    v_add_u32 v140, 20480, v224
    ds_write2_b32 v140, v136, v137 offset0:0 offset1:8
    ds_write2_b32 v140, v138, v139 offset0:16 offset1:24
L_NOWC:
    s_mul_i32 s34, s5, 32896
    s_add_u32 s34, s34, 65536
    s_add_u32 s56, s38, s34
    s_addc_u32 s57, s39, 0
    s_mov_b32 s58, 32768
    s_mov_b32 s59, 0x20000
    s_add_u32 s34, s34, 8421376
    s_add_u32 s60, s38, s34
    s_addc_u32 s61, s39, 0
    s_mov_b32 s62, 32768
    s_mov_b32 s63, 0x20000
    s_movk_i32 s26, 8192
    s_movk_i32 s27, 16384
    s_movk_i32 s28, 24576
    s_waitcnt lgkmcnt(0)
    s_barrier
    v_add_u32 v225, 13312, v225
    ds_read_b64_tr_b16 v[0:1], v225 offset:0
    ds_read_b64_tr_b16 v[2:3], v225 offset:1280
    ds_read_b64_tr_b16 v[4:5], v225 offset:5120
    ds_read_b64_tr_b16 v[6:7], v225 offset:6400
    ds_read_b64_tr_b16 v[8:9], v225 offset:32
    ds_read_b64_tr_b16 v[10:11], v225 offset:1312
    ds_read_b64_tr_b16 v[12:13], v225 offset:5152
    ds_read_b64_tr_b16 v[14:15], v225 offset:6432
    ds_read_b64_tr_b16 v[16:17], v225 offset:64
    ds_read_b64_tr_b16 v[18:19], v225 offset:1344
    ds_read_b64_tr_b16 v[20:21], v225 offset:5184
    ds_read_b64_tr_b16 v[22:23], v225 offset:6464
    ds_read_b64_tr_b16 v[24:25], v225 offset:96
    ds_read_b64_tr_b16 v[26:27], v225 offset:1376
    v_mov_b64 v[64:65], 0
    v_mov_b64 v[66:67], 0
    v_mov_b32 v68, 0x20fffff
    v_mov_b32 v69, 0x20fffff
    v_mov_b32 v70, 0x20fffff
    v_mov_b32 v71, 0x20fffff
    v_lshl_add_u32 v72, v253, 4, s12
    ds_write_b128 v72, v[64:67] offset:0
    ds_write_b128 v72, v[68:71] offset:18432
    ds_write_b128 v72, v[64:67] offset:1024
    ds_write_b128 v72, v[68:71] offset:19456
    ds_write_b128 v72, v[64:67] offset:1280
    ds_write_b128 v72, v[68:71] offset:19712
    ds_read_b64_tr_b16 v[28:29], v225 offset:5216
    ds_read_b64_tr_b16 v[30:31], v225 offset:6496
    ds_read_b64_tr_b16 v[32:33], v225 offset:10240
    ds_read_b64_tr_b16 v[34:35], v225 offset:11520
    ds_read_b64_tr_b16 v[36:37], v225 offset:15360
    ds_read_b64_tr_b16 v[38:39], v225 offset:16640
    ds_read_b64_tr_b16 v[40:41], v225 offset:10272
    ds_read_b64_tr_b16 v[42:43], v225 offset:11552
    ds_read_b64_tr_b16 v[44:45], v225 offset:15392
    ds_read_b64_tr_b16 v[46:47], v225 offset:16672
    v_mov_b32 v192, v225
    s_mov_b32 exec_lo, 0
    v_subrev_u32 v192, 2560, v225
    s_mov_b32 exec_lo, -1
    v_mul_u32_u24 v156, 3128, v223
    v_add_u32 v157, 200192, v156
    v_add_u32 v158, 400384, v156
    v_add_u32 v159, 600576, v156
    s_mov_b32 s98, 0xf0f0f0f
    s_mov_b32 s99, 0xf0f0f0f
    v_mov_b32 v180, 0xfffff
    v_cndmask_b32 v176, 0, v180, s[98:99]
    v_add_lshl_u32 v191, v232, v243, 16
    v_add_u32 v152, 0x34000000, v191
    v_cndmask_b32 v152, 0, v152, s[98:99]
    v_add_u32 v153, 0x54000000, v191
    v_cndmask_b32 v153, 0, v153, s[98:99]
    v_add_u32 v154, 0x74000000, v191
    v_cndmask_b32 v154, 0, v154, s[98:99]
    v_add_u32 v155, 0x94000000, v191
    v_cndmask_b32 v155, 0, v155, s[98:99]
    v_mov_b32 v184, 4
    v_and_b32 v177, 31, v253
    v_add_lshl_u32 v179, v177, s7, 2
    v_lshrrev_b32 v191, 5, v253
    v_lshl_add_u32 v178, v191, 11, v179
    v_add_u32 v179, 153728, v179
    s_waitcnt lgkmcnt(4)
    ds_read_b64_tr_b16 v[48:49], v225 offset:10304
    ds_read_b64_tr_b16 v[50:51], v225 offset:11584
    ds_read_b64_tr_b16 v[52:53], v225 offset:15424
    ds_read_b64_tr_b16 v[54:55], v225 offset:16704
    ds_read_b64_tr_b16 v[56:57], v225 offset:10336
    ds_read_b64_tr_b16 v[58:59], v225 offset:11616
    ds_read_b64_tr_b16 v[60:61], v225 offset:15456
    ds_read_b64_tr_b16 v[62:63], v225 offset:16736
    ds_read_b64_tr_b16 v[80:81], v192 offset:20480
    ds_read_b64_tr_b16 v[82:83], v192 offset:21760
    ds_read_b64_tr_b16 v[84:85], v192 offset:20512
    ds_read_b64_tr_b16 v[86:87], v192 offset:21792
    ds_read_b64_tr_b16 v[88:89], v192 offset:20544
    ds_read_b64_tr_b16 v[90:91], v192 offset:21824
    ds_read_b64_tr_b16 v[92:93], v192 offset:20576
    ds_read_b64_tr_b16 v[94:95], v192 offset:21856
    v_add_u32 v225, 77824, v225
    s_movk_i32 s18, 0xffc
    s_movk_i32 s20, 32
    s_mov_b32 s21, 0
    s_mov_b32 s100, 0
    s_mov_b32 s16, 0x1ffffff
    s_mov_b32 s17, 0xffff
    s_mul_i32 s10, s4, 49
    s_sub_i32 s22, s10, 6
    s_ashr_i32 s22, s22, 1
    s_add_i32 s23, s10, 7
    s_ashr_i32 s23, s23, 1
    s_add_i32 s24, s10, 43
    s_ashr_i32 s24, s24, 1
    s_add_i32 s25, s22, 31
    s_cmp_eq_u32 s4, 7
    s_cselect_b32 s24, 196, s24
    s_cselect_b32 s25, 196, s25
    s_waitcnt vmcnt(0)
    buffer_load_dwordx4 v[128:131], v232, s[56:59], 0 offen sc1
    buffer_load_dwordx4 v[132:135], v232, s[56:59], s26 offen sc1
    buffer_load_dwordx4 v[136:139], v232, s[56:59], s27 offen sc1
    buffer_load_dwordx4 v[140:143], v232, s[56:59], s28 offen sc1
    v_max3_u32 v188, v112, v113, v114
    v_max3_u32 v189, v115, v116, v117
    v_max3_u32 v188, v188, v118, v119
    v_max_u32 v188, v188, v189
    v_cmp_le_u32 vcc, 792, v188
    s_cbranch_vccz L_PEXTR
    v_mov_b32 v65, s6
    s_lshl_b32 s34, s2, 7
    s_add_u32 s34, s34, 8486912
    v_subrev_u32 v68, 792, v112
    v_cmpx_gt_u32 vcc, 264, v68
    s_cbranch_execz L_PE0
    v_mov_b32 v64, v96
    v_mov_b32 v66, v120
    v_bfe_u32 v68, v112, 5, 3
    v_lshlrev_b32 v68, 4, v68
    v_mad_u32_u24 v68, v104, s68, v68
    buffer_store_dwordx4 v[64:67], v68, s[52:55], s34 offen sc1
L_PE0:
    s_mov_b64 exec, -1
    v_subrev_u32 v68, 792, v113
    v_cmpx_gt_u32 vcc, 264, v68
    s_cbranch_execz L_PE1
    v_mov_b32 v64, v97
    v_mov_b32 v66, v121
    v_bfe_u32 v68, v113, 5, 3
    v_lshlrev_b32 v68, 4, v68
    v_mad_u32_u24 v68, v105, s68, v68
    buffer_store_dwordx4 v[64:67], v68, s[52:55], s34 offen sc1
L_PE1:
    s_mov_b64 exec, -1
    v_subrev_u32 v68, 792, v114
    v_cmpx_gt_u32 vcc, 264, v68
    s_cbranch_execz L_PE2
    v_mov_b32 v64, v98
    v_mov_b32 v66, v122
    v_bfe_u32 v68, v114, 5, 3
    v_lshlrev_b32 v68, 4, v68
    v_mad_u32_u24 v68, v106, s68, v68
    buffer_store_dwordx4 v[64:67], v68, s[52:55], s34 offen sc1
L_PE2:
    s_mov_b64 exec, -1
    v_subrev_u32 v68, 792, v115
    v_cmpx_gt_u32 vcc, 264, v68
    s_cbranch_execz L_PE3
    v_mov_b32 v64, v99
    v_mov_b32 v66, v123
    v_bfe_u32 v68, v115, 5, 3
    v_lshlrev_b32 v68, 4, v68
    v_mad_u32_u24 v68, v107, s68, v68
    buffer_store_dwordx4 v[64:67], v68, s[52:55], s34 offen sc1
L_PE3:
    s_mov_b64 exec, -1
    v_subrev_u32 v68, 792, v116
    v_cmpx_gt_u32 vcc, 264, v68
    s_cbranch_execz L_PE4
    v_mov_b32 v64, v100
    v_mov_b32 v66, v120
    v_bfe_u32 v68, v116, 5, 3
    v_lshlrev_b32 v68, 4, v68
    v_mad_u32_u24 v68, v108, s68, v68
    buffer_store_dwordx4 v[64:67], v68, s[52:55], s34 offen sc1
L_PE4:
    s_mov_b64 exec, -1
    v_subrev_u32 v68, 792, v117
    v_cmpx_gt_u32 vcc, 264, v68
    s_cbranch_execz L_PE5
    v_mov_b32 v64, v101
    v_mov_b32 v66, v121
    v_bfe_u32 v68, v117, 5, 3
    v_lshlrev_b32 v68, 4, v68
    v_mad_u32_u24 v68, v109, s68, v68
    buffer_store_dwordx4 v[64:67], v68, s[52:55], s34 offen sc1
L_PE5:
    s_mov_b64 exec, -1
    v_subrev_u32 v68, 792, v118
    v_cmpx_gt_u32 vcc, 264, v68
    s_cbranch_execz L_PE6
    v_mov_b32 v64, v102
    v_mov_b32 v66, v122
    v_bfe_u32 v68, v118, 5, 3
    v_lshlrev_b32 v68, 4, v68
    v_mad_u32_u24 v68, v110, s68, v68
    buffer_store_dwordx4 v[64:67], v68, s[52:55], s34 offen sc1
L_PE6:
    s_mov_b64 exec, -1
    v_subrev_u32 v68, 792, v119
    v_cmpx_gt_u32 vcc, 264, v68
    s_cbranch_execz L_PE7
    v_mov_b32 v64, v103
    v_mov_b32 v66, v123
    v_bfe_u32 v68, v119, 5, 3
    v_lshlrev_b32 v68, 4, v68
    v_mad_u32_u24 v68, v111, s68, v68
    buffer_store_dwordx4 v[64:67], v68, s[52:55], s34 offen sc1
L_PE7:
    s_mov_b64 exec, -1
L_PEXTR:
L_PW0:
    s_waitcnt vmcnt(3)
    v_xor_b32 v188, v131, v186
    v_and_b32_sdwa v96, v128, s18 dst_sel:DWORD dst_unused:UNUSED_PAD src0_sel:WORD_1 src1_sel:DWORD
    v_and_b32_sdwa v97, v129, s18 dst_sel:DWORD dst_unused:UNUSED_PAD src0_sel:WORD_1 src1_sel:DWORD
    v_and_b32_sdwa v98, v130, s18 dst_sel:DWORD dst_unused:UNUSED_PAD src0_sel:WORD_1 src1_sel:DWORD
    v_cmp_lt_u32 vcc, s16, v188
    v_cmp_ne_u32 s[64:65], 0, v128
    v_cmp_ne_u32 s[66:67], 0, v129
    v_cmp_ne_u32 s[68:69], 0, v130
    s_cbranch_vccnz L_RT0
    s_mov_b64 exec, s[64:65]
    ds_add_rtn_u32 v112, v96, v184 offset:1024
    s_mov_b64 exec, s[66:67]
    ds_add_rtn_u32 v113, v97, v184 offset:1024
    s_mov_b64 exec, s[68:69]
    ds_add_rtn_u32 v114, v98, v184 offset:1024
    s_mov_b64 exec, -1
    v_add_u32_sdwa v207, v131, v156 dst_sel:DWORD dst_unused:UNUSED_PAD src0_sel:BYTE_0 src1_sel:DWORD
    v_lshrrev_b32 v189, 28, v128
    v_lshl_add_u32 v207, v189, 8, v207
    v_and_b32 v189, 60, v96
    v_lshl_add_u32 v204, v189, 19, v207
    v_add_u32_sdwa v205, v131, v156 dst_sel:DWORD dst_unused:UNUSED_PAD src0_sel:BYTE_1 src1_sel:DWORD
    v_lshrrev_b32 v189, 28, v129
    v_lshl_add_u32 v205, v189, 8, v205
    v_and_b32 v189, 60, v97
    v_lshl_add_u32 v205, v189, 19, v205
    v_add_u32_sdwa v206, v131, v156 dst_sel:DWORD dst_unused:UNUSED_PAD src0_sel:BYTE_2 src1_sel:DWORD
    v_lshrrev_b32 v189, 28, v130
    v_lshl_add_u32 v206, v189, 8, v206
    v_and_b32 v189, 60, v98
    v_lshl_add_u32 v206, v189, 19, v206
    v_cndmask_b32 v188, v180, v207, s[64:65]
    s_nop 1
    v_mov_b32_dpp v189, v188 quad_perm:[2,2,3,3] row_mask:0xf bank_mask:0xf
    v_mov_b32_dpp v207, v188 quad_perm:[0,0,1,1] row_mask:0xf bank_mask:0xf
    s_nop 0
    v_mov_b32_dpp v207, v189 row_shr:4 row_mask:0xf bank_mask:0xa
L_PW1:
    s_waitcnt vmcnt(2)
    v_xor_b32 v188, v135, v186
    v_and_b32_sdwa v100, v132, s18 dst_sel:DWORD dst_unused:UNUSED_PAD src0_sel:WORD_1 src1_sel:DWORD
    v_and_b32_sdwa v101, v133, s18 dst_sel:DWORD dst_unused:UNUSED_PAD src0_sel:WORD_1 src1_sel:DWORD
    v_and_b32_sdwa v102, v134, s18 dst_sel:DWORD dst_unused:UNUSED_PAD src0_sel:WORD_1 src1_sel:DWORD
    v_cmp_lt_u32 vcc, s16, v188
    v_cmp_ne_u32 s[72:73], 0, v132
    v_cmp_ne_u32 s[74:75], 0, v133
    v_cmp_ne_u32 s[76:77], 0, v134
    s_cbranch_vccnz L_RT1
    s_mov_b64 exec, s[72:73]
    ds_add_rtn_u32 v116, v100, v184 offset:1024
    s_mov_b64 exec, s[74:75]
    ds_add_rtn_u32 v117, v101, v184 offset:1024
    s_mov_b64 exec, s[76:77]
    ds_add_rtn_u32 v118, v102, v184 offset:1024
    s_mov_b64 exec, -1
    v_add_u32_sdwa v211, v135, v157 dst_sel:DWORD dst_unused:UNUSED_PAD src0_sel:BYTE_0 src1_sel:DWORD
    v_lshrrev_b32 v189, 28, v132
    v_lshl_add_u32 v211, v189, 8, v211
    v_and_b32 v189, 60, v100
    v_lshl_add_u32 v208, v189, 19, v211
    v_add_u32_sdwa v209, v135, v157 dst_sel:DWORD dst_unused:UNUSED_PAD src0_sel:BYTE_1 src1_sel:DWORD
    v_lshrrev_b32 v189, 28, v133
    v_lshl_add_u32 v209, v189, 8, v209
    v_and_b32 v189, 60, v101
    v_lshl_add_u32 v209, v189, 19, v209
    v_add_u32_sdwa v210, v135, v157 dst_sel:DWORD dst_unused:UNUSED_PAD src0_sel:BYTE_2 src1_sel:DWORD
    v_lshrrev_b32 v189, 28, v134
    v_lshl_add_u32 v210, v189, 8, v210
    v_and_b32 v189, 60, v102
    v_lshl_add_u32 v210, v189, 19, v210
    v_cndmask_b32 v188, v180, v211, s[72:73]
    s_nop 1
    v_mov_b32_dpp v189, v188 quad_perm:[2,2,3,3] row_mask:0xf bank_mask:0xf
    v_mov_b32_dpp v211, v188 quad_perm:[0,0,1,1] row_mask:0xf bank_mask:0xf
    s_nop 0
    v_mov_b32_dpp v211, v189 row_shr:4 row_mask:0xf bank_mask:0xa
L_PW2:
    s_waitcnt vmcnt(1)
    v_xor_b32 v188, v139, v186
    v_and_b32_sdwa v104, v136, s18 dst_sel:DWORD dst_unused:UNUSED_PAD src0_sel:WORD_1 src1_sel:DWORD
    v_and_b32_sdwa v105, v137, s18 dst_sel:DWORD dst_unused:UNUSED_PAD src0_sel:WORD_1 src1_sel:DWORD
    v_and_b32_sdwa v106, v138, s18 dst_sel:DWORD dst_unused:UNUSED_PAD src0_sel:WORD_1 src1_sel:DWORD
    v_cmp_lt_u32 vcc, s16, v188
    v_cmp_ne_u32 s[80:81], 0, v136
    v_cmp_ne_u32 s[82:83], 0, v137
    v_cmp_ne_u32 s[84:85], 0, v138
    s_cbranch_vccnz L_RT2
    s_mov_b64 exec, s[80:81]
    ds_add_rtn_u32 v120, v104, v184 offset:1024
    s_mov_b64 exec, s[82:83]
    ds_add_rtn_u32 v121, v105, v184 offset:1024
    s_mov_b64 exec, s[84:85]
    ds_add_rtn_u32 v122, v106, v184 offset:1024
    s_mov_b64 exec, -1
    v_add_u32_sdwa v215, v139, v158 dst_sel:DWORD dst_unused:UNUSED_PAD src0_sel:BYTE_0 src1_sel:DWORD
    v_lshrrev_b32 v189, 28, v136
    v_lshl_add_u32 v215, v189, 8, v215
    v_and_b32 v189, 60, v104
    v_lshl_add_u32 v212, v189, 19, v215
    v_add_u32_sdwa v213, v139, v158 dst_sel:DWORD dst_unused:UNUSED_PAD src0_sel:BYTE_1 src1_sel:DWORD
    v_lshrrev_b32 v189, 28, v137
    v_lshl_add_u32 v213, v189, 8, v213
    v_and_b32 v189, 60, v105
    v_lshl_add_u32 v213, v189, 19, v213
    v_add_u32_sdwa v214, v139, v158 dst_sel:DWORD dst_unused:UNUSED_PAD src0_sel:BYTE_2 src1_sel:DWORD
    v_lshrrev_b32 v189, 28, v138
    v_lshl_add_u32 v214, v189, 8, v214
    v_and_b32 v189, 60, v106
    v_lshl_add_u32 v214, v189, 19, v214
    v_cndmask_b32 v188, v180, v215, s[80:81]
    s_nop 1
    v_mov_b32_dpp v189, v188 quad_perm:[2,2,3,3] row_mask:0xf bank_mask:0xf
    v_mov_b32_dpp v215, v188 quad_perm:[0,0,1,1] row_mask:0xf bank_mask:0xf
    s_nop 0
    v_mov_b32_dpp v215, v189 row_shr:4 row_mask:0xf bank_mask:0xa
L_PW3:
    s_waitcnt vmcnt(0)
    v_xor_b32 v188, v143, v186
    v_and_b32_sdwa v108, v140, s18 dst_sel:DWORD dst_unused:UNUSED_PAD src0_sel:WORD_1 src1_sel:DWORD
    v_and_b32_sdwa v109, v141, s18 dst_sel:DWORD dst_unused:UNUSED_PAD src0_sel:WORD_1 src1_sel:DWORD
    v_and_b32_sdwa v110, v142, s18 dst_sel:DWORD dst_unused:UNUSED_PAD src0_sel:WORD_1 src1_sel:DWORD
    v_cmp_lt_u32 vcc, s16, v188
    v_cmp_ne_u32 s[88:89], 0, v140
    v_cmp_ne_u32 s[90:91], 0, v141
    v_cmp_ne_u32 s[92:93], 0, v142
    s_cbranch_vccnz L_RT3
    s_mov_b64 exec, s[88:89]
    ds_add_rtn_u32 v124, v108, v184 offset:1024
    s_mov_b64 exec, s[90:91]
    ds_add_rtn_u32 v125, v109, v184 offset:1024
    s_mov_b64 exec, s[92:93]
    ds_add_rtn_u32 v126, v110, v184 offset:1024
    s_mov_b64 exec, -1
    v_or3_b32 v190, v131, v135, v139
    v_or_b32 v190, v190, v143
    v_and_b32 v190, 0x1000000, v190
    v_cmp_ne_u32 vcc, 0, v190
    s_cbranch_vccz L_XT1R
    v_and_b32 v190, 0x1000000, v131
    v_cmp_ne_u32 s[70:71], 0, v190
    s_bcnt1_i32_b64 s10, s[70:71]
    s_lshl2_add_u32 s21, s10, s21
    v_and_b32 v190, 0x1000000, v135
    v_cmp_ne_u32 s[78:79], 0, v190
    s_bcnt1_i32_b64 s10, s[78:79]
    s_lshl2_add_u32 s21, s10, s21
    v_and_b32 v190, 0x1000000, v139
    v_cmp_ne_u32 s[86:87], 0, v190
    s_bcnt1_i32_b64 s10, s[86:87]
    s_lshl2_add_u32 s21, s10, s21
    v_and_b32 v190, 0x1000000, v143
    v_cmp_ne_u32 s[94:95], 0, v190
    s_bcnt1_i32_b64 s10, s[94:95]
    s_lshl2_add_u32 s21, s10, s21
    s_mov_b64 exec, s[70:71]
    s_cbranch_execz L_XLa0
    s_movk_i32 s10, 0
    buffer_load_dwordx4 v[64:67], v232, s[60:63], s10 offen sc1
L_XLa0:
    s_mov_b64 exec, s[78:79]
    s_cbranch_execz L_XLa1
    s_movk_i32 s10, 8192
    buffer_load_dwordx4 v[68:71], v232, s[60:63], s10 offen sc1
L_XLa1:
    s_mov_b64 exec, s[86:87]
    s_cbranch_execz L_XLa2
    s_movk_i32 s10, 16384
    buffer_load_dwordx4 v[72:75], v232, s[60:63], s10 offen sc1
L_XLa2:
    s_mov_b64 exec, s[94:95]
    s_cbranch_execz L_XLa3
    s_movk_i32 s10, 24576
    buffer_load_dwordx4 v[76:79], v232, s[60:63], s10 offen sc1
L_XLa3:
    s_mov_b64 exec, -1
    v_or3_b32 v190, v129, v133, v137
    v_or_b32 v190, v190, v141
    v_and_b32 v190, 0x10000, v190
    v_mov_b32 v191, 640
    v_cmpx_ne_u32 vcc, 0, v190
    ds_write_b32 v191, v184 offset:4
    s_mov_b64 exec, 1
    v_mov_b32 v190, s21
    ds_add_u32 v191, v190 offset:8
    s_mov_b64 exec, -1
L_XT1R:
    v_add_u32_sdwa v219, v143, v159 dst_sel:DWORD dst_unused:UNUSED_PAD src0_sel:BYTE_0 src1_sel:DWORD
    v_lshrrev_b32 v189, 28, v140
    v_lshl_add_u32 v219, v189, 8, v219
    v_and_b32 v189, 60, v108
    v_lshl_add_u32 v216, v189, 19, v219
    v_add_u32_sdwa v217, v143, v159 dst_sel:DWORD dst_unused:UNUSED_PAD src0_sel:BYTE_1 src1_sel:DWORD
    v_lshrrev_b32 v189, 28, v141
    v_lshl_add_u32 v217, v189, 8, v217
    v_and_b32 v189, 60, v109
    v_lshl_add_u32 v217, v189, 19, v217
    v_add_u32_sdwa v218, v143, v159 dst_sel:DWORD dst_unused:UNUSED_PAD src0_sel:BYTE_2 src1_sel:DWORD
    v_lshrrev_b32 v189, 28, v142
    v_lshl_add_u32 v218, v189, 8, v218
    v_and_b32 v189, 60, v110
    v_lshl_add_u32 v218, v189, 19, v218
    v_cndmask_b32 v188, v180, v219, s[88:89]
    s_nop 1
    v_mov_b32_dpp v189, v188 quad_perm:[2,2,3,3] row_mask:0xf bank_mask:0xf
    v_mov_b32_dpp v219, v188 quad_perm:[0,0,1,1] row_mask:0xf bank_mask:0xf
    s_nop 0
    v_mov_b32_dpp v219, v189 row_shr:4 row_mask:0xf bank_mask:0xa
    v_mov_b32 v197, 640
    s_cmp_eq_u32 s3, 6
    s_cselect_b32 exec_hi, 0, -1
    s_cmp_eq_u32 s3, 7
    s_cselect_b64 exec, 1, exec
    s_add_u32 m0, s101, 0
    s_nop 0
    buffer_load_dwordx4 v234, s[40:43], 0 offen offset:0 lds
    s_add_u32 m0, s101, 6560
    s_nop 0
    buffer_load_dwordx4 v234, s[40:43], 0 offen offset:128 lds
    s_add_u32 m0, s101, 13120
    s_nop 0
    buffer_load_dwordx4 v234, s[40:43], 0 offen offset:256 lds
    s_add_u32 m0, s101, 19680
    s_nop 0
    buffer_load_dwordx4 v234, s[40:43], 0 offen offset:384 lds
    s_mov_b64 exec, -1
    s_waitcnt lgkmcnt(0)
    s_barrier
    ds_read_u16 v198, v178 offset:1024
    ds_read_u16 v199, v178 offset:2048
    ds_read_b128 v[160:163], v185 offset:1024
    ds_read_b128 v[164:167], v185 offset:2048
    ds_read_b128 v[168:171], v185 offset:3072
    ds_read_b128 v[172:175], v185 offset:4096
    ds_read_b32 v236, v197 offset:8
    s_lshl_b32 m0, s3, 10
    v_mov_b32 v240, v207
    s_add_u32 m0, m0, 13312
    s_nop 0
    buffer_load_dwordx4 v[240:241], s[44:47], 0 idxen offen lds
    s_cmp_lg_u32 s2, 0
    s_cbranch_scc1 L_NOK
    v_mov_b32 v237, s6
    v_mov_b32 v238, 0
    buffer_store_dword v237, v238, s[52:55], 0 offen sc1
L_NOK:
    s_waitcnt lgkmcnt(5)
    v_lshl_or_b32 v198, v199, 16, v198
    v_mov_b32 v199, v198
    s_waitcnt lgkmcnt(0)
    v_add_u32_sdwa v188, v160, v164 dst_sel:DWORD dst_unused:UNUSED_PAD src0_sel:WORD_0 src1_sel:WORD_0
    v_add_u32_sdwa v192, v168, v172 dst_sel:DWORD dst_unused:UNUSED_PAD src0_sel:WORD_0 src1_sel:WORD_0
    v_add_u32_dpp v199, v199, v199 row_shr:1 row_mask:0xf bank_mask:0xf bound_ctrl:0
    v_add_u32_sdwa v189, v161, v165 dst_sel:DWORD dst_unused:UNUSED_PAD src0_sel:WORD_0 src1_sel:WORD_0
    v_add_u32_sdwa v193, v169, v173 dst_sel:DWORD dst_unused:UNUSED_PAD src0_sel:WORD_0 src1_sel:WORD_0
    v_add_u32_dpp v199, v199, v199 row_shr:2 row_mask:0xf bank_mask:0xf bound_ctrl:0
    v_add_u32_sdwa v190, v162, v166 dst_sel:DWORD dst_unused:UNUSED_PAD src0_sel:WORD_0 src1_sel:WORD_0
    v_add_u32_sdwa v194, v170, v174 dst_sel:DWORD dst_unused:UNUSED_PAD src0_sel:WORD_0 src1_sel:WORD_0
    v_add_u32_dpp v199, v199, v199 row_shr:4 row_mask:0xf bank_mask:0xf bound_ctrl:0
    v_add_u32_sdwa v191, v163, v167 dst_sel:DWORD dst_unused:UNUSED_PAD src0_sel:WORD_0 src1_sel:WORD_0
    v_add_u32_sdwa v195, v171, v175 dst_sel:DWORD dst_unused:UNUSED_PAD src0_sel:WORD_0 src1_sel:WORD_0
    v_add_u32_dpp v199, v199, v199 row_shr:8 row_mask:0xf bank_mask:0xf bound_ctrl:0
    v_add_u32 v188, v188, v192
    v_add_u32 v189, v189, v193
    v_add_u32_dpp v199, v199, v199 row_bcast:15 row_mask:0xa bank_mask:0xf
    v_add_u32 v190, v190, v194
    v_add_u32 v191, v191, v195
    v_add_u32 v193, v188, v189
    v_add_u32 v194, v193, v190
    v_add_u32 v195, v194, v191
    v_mov_b32 v196, v195
    s_mov_b32 s96, -1
    s_mov_b32 s97, 0
    v_sub_u32 v200, v199, v198
    v_add_u32_sdwa v202, v199, v199 dst_sel:DWORD dst_unused:UNUSED_PAD src0_sel:WORD_0 src1_sel:WORD_1
    v_add_u32_dpp v196, v196, v196 row_shr:1 row_mask:0xf bank_mask:0xf bound_ctrl:0
    v_add_u32_sdwa v201, v200, v200 dst_sel:DWORD dst_unused:UNUSED_PAD src0_sel:WORD_0 src1_sel:WORD_1
    v_add_u32_sdwa v203, v198, v198 dst_sel:DWORD dst_unused:UNUSED_PAD src0_sel:WORD_0 src1_sel:WORD_1
    v_add_u32_dpp v196, v196, v196 row_shr:2 row_mask:0xf bank_mask:0xf bound_ctrl:0
    v_add_u32 v189, v188, v193
    v_add_u32 v190, v193, v194
    v_add_u32_dpp v196, v196, v196 row_shr:4 row_mask:0xf bank_mask:0xf bound_ctrl:0
    v_permlane32_swap_b32 v201, v202
    v_add_u32 v191, v194, v195
    v_add_u32_dpp v196, v196, v196 row_shr:8 row_mask:0xf bank_mask:0xf bound_ctrl:0
    v_add_u32 v201, v201, v202
    v_cndmask_b32 v203, 0, v203, s[96:97]
    v_add_u32_dpp v196, v196, v196 row_bcast:15 row_mask:0xa bank_mask:0xf
    v_add_u32 v202, v201, v203
    v_readfirstlane_b32 s19, v236
    v_add_u32_dpp v196, v196, v196 row_bcast:31 row_mask:0xc bank_mask:0xf
    s_lshl_b32 m0, s3, 10
    v_mov_b32 v240, v211
    s_add_u32 m0, m0, 21504
    s_nop 0
    buffer_load_dwordx4 v[240:241], s[44:47], 0 idxen offen lds
    v_sub_u32 v192, v196, v195
    v_readlane_b32 s10, v196, 63
    v_sub_u32_sdwa v203, v202, v198 dst_sel:DWORD dst_unused:UNUSED_PAD src0_sel:DWORD src1_sel:WORD_1
    v_lshl_add_u32 v188, v192, 1, v188
    v_lshl_add_u32 v189, v192, 1, v189
    v_lshl_add_u32 v190, v192, 1, v190
    v_lshl_add_u32 v191, v192, 1, v191
    s_lshr_b32 s11, s10, 5
    s_add_u32 s11, s11, 12
    s_and_b32 s11, s11, -32
    s_sub_i32 s11, s11, 12
    s_lshl_b32 s11, s11, 3
    s_lshr_b32 s10, s10, 1
    s_lshr_b32 s8, s4, 1
    s_mul_i32 s8, s8, s10
    s_add_i32 s11, s11, s8
    s_add_i32 s10, s10, s8
    s_bitcmp1_b32 s4, 0
    s_cselect_b32 s31, s11, s8
    s_cselect_b32 s10, s10, s11
    s_mov_b32 s8, 0
    s_mov_b32 s9, 0
    v_cmp_gt_i32 vcc, s31, v188
    v_cmp_gt_i32 s[34:35], s10, v188
    s_bcnt1_i32_b64 s11, vcc
    s_add_u32 s8, s8, s11
    s_bcnt1_i32_b64 s11, s[34:35]
    s_add_u32 s9, s9, s11
    v_cmp_gt_i32 vcc, s31, v189
    v_cmp_gt_i32 s[34:35], s10, v189
    s_bcnt1_i32_b64 s11, vcc
    s_add_u32 s8, s8, s11
    s_bcnt1_i32_b64 s11, s[34:35]
    s_add_u32 s9, s9, s11
    v_cmp_gt_i32 vcc, s31, v190
    v_cmp_gt_i32 s[34:35], s10, v190
    s_bcnt1_i32_b64 s11, vcc
    s_add_u32 s8, s8, s11
    s_bcnt1_i32_b64 s11, s[34:35]
    s_add_u32 s9, s9, s11
    v_cmp_gt_i32 vcc, s31, v191
    v_cmp_gt_i32 s[34:35], s10, v191
    s_bcnt1_i32_b64 s11, vcc
    s_add_u32 s8, s8, s11
    s_bcnt1_i32_b64 s11, s[34:35]
    s_add_u32 s9, s9, s11
    s_max_i32 s8, s8, s22
    s_min_i32 s8, s8, s23
    s_max_i32 s9, s9, s24
    s_min_i32 s9, s9, s25
    s_lshl_b32 m0, s3, 10
    v_mov_b32 v240, v215
    s_add_u32 m0, m0, 29696
    s_nop 0
    buffer_load_dwordx4 v[240:241], s[44:47], 0 idxen offen lds
    s_sub_u32 s22, s8, s7
    s_sub_u32 s23, s9, s7
    v_readlane_b32 s16, v201, s22
    v_readlane_b32 s30, v201, s23
    s_add_u32 s10, s22, 32
    s_add_u32 s11, s23, 32
    v_readlane_b32 s26, v200, s22
    v_readlane_b32 s28, v200, s23
    v_readlane_b32 s27, v200, s10
    v_readlane_b32 s29, v200, s11
    s_sub_u32 s31, s30, s16
    s_add_u32 s10, s31, 255
    s_lshr_b32 s10, s10, 8
    s_lshl_b32 s10, s10, 7
    s_sub_u32 s10, s10, s19
    s_max_i32 s10, s10, 0
    s_add_u32 s16, s16, s10
    s_add_u32 s10, s22, 16
    s_min_u32 s10, s10, s23
    s_sub_i32 s11, s23, 16
    v_cmp_ge_u32 s[34:35], s16, v203
    v_cmp_ge_u32 s[36:37], s16, v202
    v_cmp_gt_i32 vcc, s10, v177
    v_cmp_gt_i32 s[10:11], s11, v177
    v_cmp_le_u32 s[32:33], s22, v177
    v_cmp_gt_u32 s[96:97], s23, v177
    s_and_b64 s[34:35], s[34:35], vcc
    s_and_b64 s[36:37], s[36:37], vcc
    s_or_b64 s[34:35], s[34:35], s[10:11]
    s_or_b64 s[36:37], s[36:37], s[10:11]
    s_bcnt1_i32_b32 s24, s34
    s_bcnt1_i32_b32 s10, s36
    s_bcnt1_i32_b32 s11, s35
    s_bcnt1_i32_b32 s25, s37
    v_readlane_b32 s22, v200, s24
    v_readlane_b32 s10, v200, s10
    s_add_u32 s11, s11, 32
    s_add_u32 s16, s25, 32
    v_readlane_b32 s23, v200, s11
    v_readlane_b32 s11, v200, s16
    v_mov_b32 v188, s17
    v_cndmask_b32 v189, 0, v188, s[34:35]
    v_cndmask_b32 v188, 0, v188, s[36:37]
    s_and_b64 s[32:33], s[32:33], s[96:97]
    s_pack_lh_b32_b16 s22, s22, s10
    s_pack_lh_b32_b16 s23, s23, s11
    v_lshl_or_b32 v188, v188, 16, v189
    s_sub_u32 s16, s12, 37888
    s_pack_ll_b32_b16 s16, s16, s16
    s_sub_u32 s10, s22, s26
    s_sub_u32 s11, s23, s27
    s_mul_i32 s10, s10, 0x10001
    s_lshl_b32 vcc_lo, s10, 16
    s_pack_hh_b32_b16 s10, s10, s10
    s_lshl_b32 vcc_hi, s11, 16
    s_add_u32 vcc_hi, vcc_hi, s10
    s_add_u32 s96, vcc_hi, s11
    s_lshr_b32 s96, s96, 16
    s_sub_u32 s31, s31, s96
    s_cmp_gt_u32 s31, s96
    s_cselect_b32 s97, 0x4800480, 0
    s_add_u32 s16, s16, s97
    s_sub_u32 s10, s16, s26
    s_sub_u32 s11, s16, s27
    s_add_u32 s10, s10, vcc_lo
    s_add_u32 s11, s11, vcc_hi
    v_mov_b32 v192, s10
    v_mov_b32 v193, s11
    s_add_u32 s16, s16, 0x4800480
    s_sub_u32 s16, s16, s97
    s_sub_u32 s16, s16, s97
    s_sub_u32 s10, s28, s22
    s_sub_u32 s11, s29, s23
    s_mul_i32 s10, s10, 0x10001
    s_lshl_b32 vcc_lo, s10, 16
    s_pack_hh_b32_b16 s10, s10, s10
    s_lshl_b32 vcc_hi, s11, 16
    s_add_u32 vcc_hi, vcc_hi, s10
    s_sub_u32 s10, s16, s22
    s_sub_u32 s11, s16, s23
    s_add_u32 s10, s10, vcc_lo
    s_add_u32 s11, s11, vcc_hi
    v_mov_b32 v194, s10
    v_mov_b32 v195, s11
    v_bfi_b32 v192, v188, v192, v194
    v_bfi_b32 v193, v188, v193, v195
    s_mov_b32 exec_hi, 0
    v_mov_b32 v193, v192
    s_mov_b64 exec, s[32:33]
    v_add_u32 v200, v200, v193
    s_bfe_u32 s10, s97, 0x10007
    s_lshl1_add_u32 s10, s4, s10
    s_lshl_b32 s10, s10, 2
    v_cndmask_b32 v188, 4, 0, s[34:35]
    ds_write_b16 v178, v200 offset:1026
    ds_write_b16_d16_hi v178, v200 offset:2050
    s_mov_b32 exec_hi, 0
    v_xor_b32 v188, s10, v188
    ds_write_b32 v179, v188
    s_mov_b64 exec, -1
    s_min_u32 s10, s31, s96
    s_max_u32 s96, s31, s96
    s_mov_b32 s31, s10
    s_add_u32 s10, s96, s19
    s_mul_i32 s11, s30, 9216
    s_lshr_b32 s11, s11, 16
    s_max_u32 s10, s10, s11
    s_cmp_lt_u32 s10, 1152
    s_cbranch_scc1 L_LFIT
    ds_write_b32 v197, v184
L_LFIT:
    s_sub_u32 s10, s12, 37888
    s_add_u32 s11, s10, s96
    v_mov_b32 v188, s11
    s_add_u32 s11, s10, s31
    s_add_u32 s11, s11, 1152
    v_mov_b32 v189, s11
    s_lshl_b32 s10, s4, 3
    v_mov_b32 v190, s10
    ds_write_b64 v190, v[188:189] offset:576
    s_lshl_b32 m0, s3, 10
    v_mov_b32 v240, v219
    s_add_u32 m0, m0, 37888
    s_nop 0
    buffer_load_dwordx4 v[240:241], s[44:47], 0 idxen offen lds
    v_and_or_b32 v128, v128, s17, v152
    v_or_b32 v204, v204, v176
    v_and_b32 v129, s17, v129
    v_and_b32 v130, s17, v130
    v_and_or_b32 v132, v132, s17, v153
    v_or_b32 v208, v208, v176
    v_and_b32 v133, s17, v133
    v_and_b32 v134, s17, v134
    v_and_or_b32 v136, v136, s17, v154
    v_or_b32 v212, v212, v176
    v_and_b32 v137, s17, v137
    v_and_b32 v138, s17, v138
    v_and_or_b32 v140, v140, s17, v155
    v_or_b32 v216, v216, v176
    v_and_b32 v141, s17, v141
    v_and_b32 v142, s17, v142
    s_waitcnt lgkmcnt(0)
    s_barrier
    ds_read_b64 v[202:203], v197
    ds_read_u16 v96, v96 offset:1026
    ds_read_u16 v97, v97 offset:1026
    ds_read_u16 v98, v98 offset:1026
    ds_read_u16 v100, v100 offset:1026
    ds_read_u16 v101, v101 offset:1026
    ds_read_u16 v102, v102 offset:1026
    ds_read_u16 v104, v104 offset:1026
    ds_read_u16 v105, v105 offset:1026
    ds_read_u16 v106, v106 offset:1026
    ds_read_u16 v108, v108 offset:1026
    ds_read_u16 v109, v109 offset:1026
    ds_read_u16 v110, v110 offset:1026
    s_add_u32 s24, s24, s7
    s_add_u32 s11, s25, s7
    s_and_b32 s10, s11, 15
    s_cmp_lt_u32 s11, s24
    s_cselect_b32 s25, s10, 16
    s_cmp_lg_u32 s97, 0
    s_cselect_b32 s23, s8, s11
    s_cselect_b32 s7, s8, s24
    s_cselect_b32 s8, s11, s8
    s_cselect_b32 s24, s9, s24
    s_cselect_b32 s9, s11, s9
    s_min_u32 s22, s8, 192
    s_min_u32 s23, s23, 192
    s_mov_b32 s30, s19
    s_waitcnt lgkmcnt(12)
    v_cmp_ne_u32 vcc, 0, v202
    v_readfirstlane_b32 s19, v203
    s_cbranch_vccnz L_OVF
    s_waitcnt lgkmcnt(11)
    v_add_u32 v96, v96, v112
    s_mov_b64 exec, s[64:65]
    ds_write2st64_b32 v96, v128, v204 offset0:148 offset1:220
    s_mov_b64 exec, -1
    s_waitcnt lgkmcnt(11)
    v_add_u32 v97, v97, v113
    s_mov_b64 exec, s[66:67]
    ds_write2st64_b32 v97, v129, v205 offset0:148 offset1:220
    s_mov_b64 exec, -1
    s_waitcnt lgkmcnt(11)
    v_add_u32 v98, v98, v114
    s_mov_b64 exec, s[68:69]
    ds_write2st64_b32 v98, v130, v206 offset0:148 offset1:220
    s_mov_b64 exec, -1
    s_waitcnt lgkmcnt(11)
    v_add_u32 v100, v100, v116
    s_mov_b64 exec, s[72:73]
    ds_write2st64_b32 v100, v132, v208 offset0:148 offset1:220
    s_mov_b64 exec, -1
    s_waitcnt lgkmcnt(11)
    v_add_u32 v101, v101, v117
    s_mov_b64 exec, s[74:75]
    ds_write2st64_b32 v101, v133, v209 offset0:148 offset1:220
    s_mov_b64 exec, -1
    s_waitcnt lgkmcnt(11)
    v_add_u32 v102, v102, v118
    s_mov_b64 exec, s[76:77]
    ds_write2st64_b32 v102, v134, v210 offset0:148 offset1:220
    s_mov_b64 exec, -1
    s_waitcnt lgkmcnt(11)
    v_add_u32 v104, v104, v120
    s_mov_b64 exec, s[80:81]
    ds_write2st64_b32 v104, v136, v212 offset0:148 offset1:220
    s_mov_b64 exec, -1
    s_waitcnt lgkmcnt(11)
    v_add_u32 v105, v105, v121
    s_mov_b64 exec, s[82:83]
    ds_write2st64_b32 v105, v137, v213 offset0:148 offset1:220
    s_mov_b64 exec, -1
    s_waitcnt lgkmcnt(11)
    v_add_u32 v106, v106, v122
    s_mov_b64 exec, s[84:85]
    ds_write2st64_b32 v106, v138, v214 offset0:148 offset1:220
    s_mov_b64 exec, -1
    s_waitcnt lgkmcnt(11)
    v_add_u32 v108, v108, v124
    s_mov_b64 exec, s[88:89]
    ds_write2st64_b32 v108, v140, v216 offset0:148 offset1:220
    s_mov_b64 exec, -1
    s_waitcnt lgkmcnt(11)
    v_add_u32 v109, v109, v125
    s_mov_b64 exec, s[90:91]
    ds_write2st64_b32 v109, v141, v217 offset0:148 offset1:220
    s_mov_b64 exec, -1
    s_waitcnt lgkmcnt(11)
    v_add_u32 v110, v110, v126
    s_mov_b64 exec, s[92:93]
    ds_write2st64_b32 v110, v142, v218 offset0:148 offset1:220
    s_mov_b64 exec, -1
    s_add_u32 s10, s96, 127
    s_lshr_b32 s10, s10, 7
    s_lshl1_add_u32 s10, s10, -1
    s_add_u32 s11, s31, 127
    s_lshr_b32 s11, s11, 6
    s_and_b32 s11, s11, -2
    s_max_i32 s17, s10, s11
    s_cselect_b32 s10, s96, s31
    s_sub_u32 s10, s10, 1
    s_andn2_b32 s99, 64, s10
L_CA:
    ds_read_b64_tr_b16 v[96:97], v225 offset:0
    ds_read_b64_tr_b16 v[98:99], v225 offset:1280
    ds_read_b64_tr_b16 v[100:101], v225 offset:5120
    ds_read_b64_tr_b16 v[102:103], v225 offset:6400
    ds_read_b64_tr_b16 v[104:105], v225 offset:32
    ds_read_b64_tr_b16 v[106:107], v225 offset:1312
    ds_read_b64_tr_b16 v[108:109], v225 offset:5152
    ds_read_b64_tr_b16 v[110:111], v225 offset:6432
    ds_read_b64_tr_b16 v[112:113], v225 offset:64
    ds_read_b64_tr_b16 v[114:115], v225 offset:1344
    ds_read_b64_tr_b16 v[116:117], v225 offset:5184
    ds_read_b64_tr_b16 v[118:119], v225 offset:6464
    ds_read_b64_tr_b16 v[120:121], v225 offset:96
    ds_read_b64_tr_b16 v[122:123], v225 offset:1376
    ds_read_b64_tr_b16 v[124:125], v225 offset:5216
    ds_read_b64_tr_b16 v[126:127], v225 offset:6496
    s_cmp_eq_u32 s21, 0
    s_cbranch_scc1 L_XT2R
    s_waitcnt vmcnt(8)
L_XT2:
    s_mov_b64 s[34:35], 0
    v_cmp_ne_u32 vcc, s6, v65
    s_and_b64 vcc, vcc, s[70:71]
    s_or_b64 s[34:35], s[34:35], vcc
    v_cmp_ne_u32 vcc, s6, v69
    s_and_b64 vcc, vcc, s[78:79]
    s_or_b64 s[34:35], s[34:35], vcc
    v_cmp_ne_u32 vcc, s6, v73
    s_and_b64 vcc, vcc, s[86:87]
    s_or_b64 s[34:35], s[34:35], vcc
    v_cmp_ne_u32 vcc, s6, v77
    s_and_b64 vcc, vcc, s[94:95]
    s_or_b64 s[34:35], s[34:35], vcc
    s_cbranch_scc1 L_XT2B
    s_cmp_eq_u32 s20, 0
    s_cbranch_scc1 L_XT2R
    s_mov_b64 exec, s[70:71]
    s_cbranch_execz L_XS0
    v_bfe_u32 v65, v64, 18, 8
    v_lshlrev_b32 v65, 2, v65
    v_add_u32 v67, 153728, v65
    ds_read_b32 v67, v67
    v_add_u32_sdwa v66, v66, v156 dst_sel:DWORD dst_unused:UNUSED_PAD src0_sel:BYTE_0 src1_sel:DWORD
    v_lshrrev_b32 v189, 28, v64
    v_lshl_add_u32 v66, v189, 8, v66
    v_and_b32 v189, 60, v65
    v_lshl_add_u32 v66, v189, 19, v66
    v_and_b32 v64, 0xffff, v64
    s_waitcnt lgkmcnt(0)
    ds_add_rtn_u32 v67, v67, v184 offset:576
    s_waitcnt lgkmcnt(0)
    ds_write2st64_b32 v67, v64, v66 offset0:148 offset1:220
L_XS0:
    s_mov_b64 exec, s[78:79]
    s_cbranch_execz L_XS1
    v_bfe_u32 v69, v68, 18, 8
    v_lshlrev_b32 v69, 2, v69
    v_add_u32 v71, 153728, v69
    ds_read_b32 v71, v71
    v_add_u32_sdwa v70, v70, v157 dst_sel:DWORD dst_unused:UNUSED_PAD src0_sel:BYTE_0 src1_sel:DWORD
    v_lshrrev_b32 v189, 28, v68
    v_lshl_add_u32 v70, v189, 8, v70
    v_and_b32 v189, 60, v69
    v_lshl_add_u32 v70, v189, 19, v70
    v_and_b32 v68, 0xffff, v68
    s_waitcnt lgkmcnt(0)
    ds_add_rtn_u32 v71, v71, v184 offset:576
    s_waitcnt lgkmcnt(0)
    ds_write2st64_b32 v71, v68, v70 offset0:148 offset1:220
L_XS1:
    s_mov_b64 exec, s[86:87]
    s_cbranch_execz L_XS2
    v_bfe_u32 v73, v72, 18, 8
    v_lshlrev_b32 v73, 2, v73
    v_add_u32 v75, 153728, v73
    ds_read_b32 v75, v75
    v_add_u32_sdwa v74, v74, v158 dst_sel:DWORD dst_unused:UNUSED_PAD src0_sel:BYTE_0 src1_sel:DWORD
    v_lshrrev_b32 v189, 28, v72
    v_lshl_add_u32 v74, v189, 8, v74
    v_and_b32 v189, 60, v73
    v_lshl_add_u32 v74, v189, 19, v74
    v_and_b32 v72, 0xffff, v72
    s_waitcnt lgkmcnt(0)
    ds_add_rtn_u32 v75, v75, v184 offset:576
    s_waitcnt lgkmcnt(0)
    ds_write2st64_b32 v75, v72, v74 offset0:148 offset1:220
L_XS2:
    s_mov_b64 exec, s[94:95]
    s_cbranch_execz L_XS3
    v_bfe_u32 v77, v76, 18, 8
    v_lshlrev_b32 v77, 2, v77
    v_add_u32 v79, 153728, v77
    ds_read_b32 v79, v79
    v_add_u32_sdwa v78, v78, v159 dst_sel:DWORD dst_unused:UNUSED_PAD src0_sel:BYTE_0 src1_sel:DWORD
    v_lshrrev_b32 v189, 28, v76
    v_lshl_add_u32 v78, v189, 8, v78
    v_and_b32 v189, 60, v77
    v_lshl_add_u32 v78, v189, 19, v78
    v_and_b32 v76, 0xffff, v76
    s_waitcnt lgkmcnt(0)
    ds_add_rtn_u32 v79, v79, v184 offset:576
    s_waitcnt lgkmcnt(0)
    ds_write2st64_b32 v79, v76, v78 offset0:148 offset1:220
L_XS3:
    s_mov_b64 exec, -1
L_XT2R:
    s_cmp_ge_u32 s3, 4
    s_cbranch_scc1 L_EP0
    s_lshl_b32 s72, s4, 7
    s_add_u32 s72, s72, 156800
    v_mov_b32 v190, s22
    s_mov_b32 exec_lo, 0xffff0000
    v_mov_b32 v190, s23
    s_mov_b32 exec_lo, -1
    s_mov_b32 exec_hi, 0
    v_sub_u32 v191, v253, v190
    v_and_b32 v191, 15, v191
    v_add_lshl_u32 v191, v191, v190, 5
    v_lshl_add_u32 v190, v253, 2, s72
    ds_write_b32 v190, v191
    s_mov_b32 exec_hi, -1
    s_mul_i32 s10, s5, 196
    s_add_u32 s11, s10, s7
    s_add_u32 s62, s10, s9
    s_min_u32 s11, s11, 50000
    s_min_u32 s62, s62, 50000
    s_sub_u32 s62, s62, s11
    s_lshl_b32 s11, s11, 7
    s_lshl_b32 s62, s62, 7
    s_add_u32 s60, s48, s11
    s_addc_u32 s61, s49, 0
    s_mul_i32 s74, s7, -128
    s_add_u32 s11, s10, s8
    s_add_u32 s50, s10, s24
    s_min_u32 s11, s11, 50000
    s_min_u32 s50, s50, 50000
    s_sub_u32 s50, s50, s11
    s_lshl_b32 s11, s11, 7
    s_lshl_b32 s50, s50, 7
    s_add_u32 s48, s48, s11
    s_addc_u32 s49, s49, 0
    s_mul_i32 s73, s8, -128
    s_and_b32 s10, s25, 12
    s_lshl_b32 s10, s10, 2
    s_bfm_b64 s[76:77], 16, s10
L_EP0:
    s_waitcnt vmcnt(0) lgkmcnt(0)
    s_barrier
    s_mov_b32 s10, 0x358637bd
    ds_read_b128 v[236:239], v247
    ds_read_b32 v240, v248
    v_lshrrev_b32 v188, 2, v253
    v_and_b32 v188, 12, v188
    v_subrev_u32 v188, s25, v188
    s_waitcnt lgkmcnt(0)
    s_cmp_ge_u32 s3, 4
    s_cbranch_scc1 L_LATE0
    s_add_u32 m0, s13, 0
    v_mad_u32_u16 v236, v236, s15, v243
    buffer_load_dwordx4 v236, s[40:43], 0 offen lds
    s_add_u32 m0, s13, 1056
    v_mad_u32_u16 v237, v237, s15, v243
    buffer_load_dwordx4 v237, s[40:43], 0 offen lds
    s_add_u32 m0, s13, 2112
    v_mad_u32_u16 v238, v238, s15, v243
    buffer_load_dwordx4 v238, s[40:43], 0 offen lds
    s_add_u32 m0, s13, 3168
    v_mad_u32_u16 v239, v239, s15, v243
    buffer_load_dwordx4 v239, s[40:43], 0 offen lds
    s_mov_b32 m0, s14
    v_and_b32 v240, 0xfffff, v240
    buffer_load_dwordx4 v[240:241], s[44:47], 0 idxen offen lds
L_LATE0:
    s_lshl_b32 s34, s22, 5
    s_lshl_b32 s35, s23, 5
    s_mov_b32 vcc_lo, 0xff00ff00
    s_mov_b32 vcc_hi, 0xff00ff00
    v_mov_b32 v176, s35
    v_mov_b32 v177, s34
    v_cndmask_b32 v176, v176, v177, vcc
    v_and_b32 v177, 4, v253
    v_lshlrev_b32 v177, 6, v177
    v_lshl_add_u32 v177, v246, 2, v177
    v_sub_u32 v177, v177, v176
    v_and_b32 v178, 48, v253
    s_movk_i32 s34, 832
    v_mad_u32_u24 v178, v246, s34, v178
    s_mov_b32 s34, 116736
    v_add3_u32 v178, v178, v176, s34
    v_and_b32 v176, 0x1ff, v177
    v_add_u32 v176, v176, v178
    ds_read_b128 v[160:163], v176 offset:0
    ds_read_b128 v[164:167], v176 offset:64
    v_add_u32 v177, 0x80, v177
    v_and_b32 v176, 0x1ff, v177
    v_add_u32 v176, v176, v178
    ds_read_b128 v[168:171], v176 offset:0
    ds_read_b128 v[172:175], v176 offset:64
    s_mov_b32 s34, 0xbfb8aa3b
    s_mov_b32 s35, s34
    s_waitcnt lgkmcnt(3)
    v_mfma_f32_16x16x32_bf16 v[204:207], v[160:163], v[96:99], 0
    v_mfma_f32_16x16x32_bf16 v[212:215], v[160:163], v[104:107], 0
    v_mfma_f32_16x16x32_bf16 v[220:223], v[160:163], v[112:115], 0
    v_mfma_f32_16x16x32_bf16 v[228:231], v[160:163], v[120:123], 0
    s_waitcnt lgkmcnt(2)
    v_mfma_f32_16x16x32_bf16 v[204:207], v[164:167], v[100:103], v[204:207]
    v_mfma_f32_16x16x32_bf16 v[212:215], v[164:167], v[108:111], v[212:215]
    v_mfma_f32_16x16x32_bf16 v[220:223], v[164:167], v[116:119], v[220:223]
    v_mfma_f32_16x16x32_bf16 v[228:231], v[164:167], v[124:127], v[228:231]
    s_waitcnt lgkmcnt(1)
    v_mfma_f32_16x16x32_bf16 v[208:211], v[168:171], v[96:99], 0
    v_mfma_f32_16x16x32_bf16 v[216:219], v[168:171], v[104:107], 0
    v_mfma_f32_16x16x32_bf16 v[224:227], v[168:171], v[112:115], 0
    v_mfma_f32_16x16x32_bf16 v[232:235], v[168:171], v[120:123], 0
    s_waitcnt lgkmcnt(0)
    v_mfma_f32_16x16x32_bf16 v[208:211], v[172:175], v[100:103], v[208:211]
    v_mfma_f32_16x16x32_bf16 v[216:219], v[172:175], v[108:111], v[216:219]
    v_mfma_f32_16x16x32_bf16 v[224:227], v[172:175], v[116:119], v[224:227]
    v_mfma_f32_16x16x32_bf16 v[232:235], v[172:175], v[124:127], v[232:235]
    s_mov_b32 s11, s10
    v_mov_b32 v189, s10
    v_mov_b64 v[96:97], s[10:11]
    v_mov_b64 v[98:99], s[10:11]
    v_mov_b64 v[100:101], s[10:11]
    v_mov_b64 v[102:103], s[10:11]
    v_mov_b64 v[104:105], s[10:11]
    v_mov_b64 v[106:107], s[10:11]
    v_mov_b64 v[108:109], s[10:11]
    v_mov_b64 v[110:111], s[10:11]
    v_cmp_ne_u32 vcc, 0, v188
    v_mov_b64 v[112:113], 0
    v_mov_b64 v[114:115], 0
    v_cndmask_b32 v128, 0, v189, vcc
    v_cmp_ne_u32 vcc, -1, v188
    v_mov_b64 v[116:117], 0
    v_mov_b64 v[118:119], 0
    v_cndmask_b32 v129, 0, v189, vcc
    v_cmp_ne_u32 vcc, -2, v188
    v_mov_b64 v[120:121], 0
    v_mov_b64 v[122:123], 0
    v_cndmask_b32 v130, 0, v189, vcc
    v_cmp_ne_u32 vcc, -3, v188
    v_mov_b64 v[124:125], 0
    v_mov_b64 v[126:127], 0
    v_cndmask_b32 v131, 0, v189, vcc
    v_mov_b64 v[144:145], 0
    v_mov_b64 v[146:147], 0
    v_mov_b64 v[148:149], 0
    v_mov_b64 v[150:151], 0
    v_mov_b64 v[152:153], 0
    v_mov_b64 v[154:155], 0
    v_mov_b64 v[156:157], 0
    v_mov_b64 v[158:159], 0
    v_mov_b64 v[132:133], v[128:129]
    v_mov_b64 v[134:135], v[130:131]
    v_mov_b64 v[136:137], v[128:129]
    v_mov_b64 v[138:139], v[130:131]
    v_mov_b64 v[140:141], v[128:129]
    v_mov_b64 v[142:143], v[130:131]
    v_pk_mul_f32 v[204:205], v[204:205], s[34:35]
    v_pk_mul_f32 v[206:207], v[206:207], s[34:35]
    v_pk_mul_f32 v[208:209], v[208:209], s[34:35]
    v_pk_mul_f32 v[210:211], v[210:211], s[34:35]
    v_pk_mul_f32 v[212:213], v[212:213], s[34:35]
    v_pk_mul_f32 v[214:215], v[214:215], s[34:35]
    v_pk_mul_f32 v[216:217], v[216:217], s[34:35]
    v_pk_mul_f32 v[218:219], v[218:219], s[34:35]
    v_pk_mul_f32 v[220:221], v[220:221], s[34:35]
    v_pk_mul_f32 v[222:223], v[222:223], s[34:35]
    v_pk_mul_f32 v[224:225], v[224:225], s[34:35]
    v_pk_mul_f32 v[226:227], v[226:227], s[34:35]
    v_pk_mul_f32 v[228:229], v[228:229], s[34:35]
    v_pk_mul_f32 v[230:231], v[230:231], s[34:35]
    v_pk_mul_f32 v[232:233], v[232:233], s[34:35]
    v_pk_mul_f32 v[234:235], v[234:235], s[34:35]
    v_cvt_pk_bf16_f32 v64, v204, v205
    v_cvt_pk_bf16_f32 v65, v206, v207
    v_cvt_pk_bf16_f32 v66, v208, v209
    v_cvt_pk_bf16_f32 v67, v210, v211
    v_cvt_pk_bf16_f32 v68, v212, v213
    v_cvt_pk_bf16_f32 v69, v214, v215
    v_cvt_pk_bf16_f32 v70, v216, v217
    v_cvt_pk_bf16_f32 v71, v218, v219
    v_cvt_pk_bf16_f32 v72, v220, v221
    v_cvt_pk_bf16_f32 v73, v222, v223
    v_cvt_pk_bf16_f32 v74, v224, v225
    v_cvt_pk_bf16_f32 v75, v226, v227
    v_cvt_pk_bf16_f32 v76, v228, v229
    v_cvt_pk_bf16_f32 v77, v230, v231
    v_cvt_pk_bf16_f32 v78, v232, v233
    v_cvt_pk_bf16_f32 v79, v234, v235
    v_permlane32_swap_b32 v80, v64
    v_permlane32_swap_b32 v81, v65
    v_permlane32_swap_b32 v82, v66
    v_permlane32_swap_b32 v83, v67
    v_permlane32_swap_b32 v84, v68
    v_permlane32_swap_b32 v85, v69
    v_permlane32_swap_b32 v86, v70
    v_permlane32_swap_b32 v87, v71
    v_permlane32_swap_b32 v88, v72
    v_permlane32_swap_b32 v89, v73
    v_permlane32_swap_b32 v90, v74
    v_permlane32_swap_b32 v91, v75
    v_permlane32_swap_b32 v92, v76
    v_permlane32_swap_b32 v93, v77
    v_permlane32_swap_b32 v94, v78
    v_permlane32_swap_b32 v95, v79
    s_mov_b32 s26, -1
    s_mov_b64 s[32:33], 0
    s_mov_b32 s28, 0
    s_mov_b32 s29, 0
    s_cmp_lt_u32 s3, 4
    s_cbranch_scc1 L_HAD0
    s_add_u32 m0, s13, 0
    v_mad_u32_u16 v236, v236, s15, v243
    buffer_load_dwordx4 v236, s[40:43], 0 offen lds
    s_add_u32 m0, s13, 1056
    v_mad_u32_u16 v237, v237, s15, v243
    buffer_load_dwordx4 v237, s[40:43], 0 offen lds
    s_add_u32 m0, s13, 2112
    v_mad_u32_u16 v238, v238, s15, v243
    buffer_load_dwordx4 v238, s[40:43], 0 offen lds
    s_add_u32 m0, s13, 3168
    v_mad_u32_u16 v239, v239, s15, v243
    buffer_load_dwordx4 v239, s[40:43], 0 offen lds
    s_mov_b32 m0, s14
    v_and_b32 v240, 0xfffff, v240
    buffer_load_dwordx4 v[240:241], s[44:47], 0 idxen offen lds
    s_lshl_b32 s72, s4, 7
    s_add_u32 s72, s72, 156800
    v_mov_b32 v190, s22
    s_mov_b32 exec_lo, 0xffff0000
    v_mov_b32 v190, s23
    s_mov_b32 exec_lo, -1
    s_mov_b32 exec_hi, 0
    v_sub_u32 v191, v253, v190
    v_and_b32 v191, 15, v191
    v_add_lshl_u32 v191, v191, v190, 5
    v_lshl_add_u32 v190, v253, 2, s72
    ds_write_b32 v190, v191
    s_mov_b32 exec_hi, -1
    s_mul_i32 s10, s5, 196
    s_add_u32 s11, s10, s7
    s_add_u32 s62, s10, s9
    s_min_u32 s11, s11, 50000
    s_min_u32 s62, s62, 50000
    s_sub_u32 s62, s62, s11
    s_lshl_b32 s11, s11, 7
    s_lshl_b32 s62, s62, 7
    s_add_u32 s60, s48, s11
    s_addc_u32 s61, s49, 0
    s_mul_i32 s74, s7, -128
    s_add_u32 s11, s10, s8
    s_add_u32 s50, s10, s24
    s_min_u32 s11, s11, 50000
    s_min_u32 s50, s50, 50000
    s_sub_u32 s50, s50, s11
    s_lshl_b32 s11, s11, 7
    s_lshl_b32 s50, s50, 7
    s_add_u32 s48, s48, s11
    s_addc_u32 s49, s49, 0
    s_mul_i32 s73, s8, -128
    s_and_b32 s10, s25, 12
    s_lshl_b32 s10, s10, 2
    s_bfm_b64 s[76:77], 16, s10
L_HAD0:
    s_cmp_eq_u32 s30, 0
    s_cbranch_scc1 L_GO
    s_lshl_b32 s10, s4, 3
    v_mov_b32 v188, s10
    ds_read_b64 v[188:189], v188 offset:576
    s_waitcnt lgkmcnt(0)
    v_readfirstlane_b32 s34, v188
    v_readfirstlane_b32 s35, v189
    s_sub_u32 s10, s12, 37888
    s_sub_u32 s34, s34, s10
    s_sub_u32 s35, s35, s10
    s_sub_u32 s35, s35, 1152
    s_add_u32 s10, s34, 127
    s_lshr_b32 s10, s10, 7
    s_lshl1_add_u32 s10, s10, -1
    s_add_u32 s11, s35, 127
    s_lshr_b32 s11, s11, 6
    s_and_b32 s11, s11, -2
    s_max_i32 s17, s10, s11
    s_cselect_b32 s10, s34, s35
    s_sub_u32 s10, s10, 1
    s_andn2_b32 s99, 64, s10
L_GO:
    ds_read_u16 v251, v249 offset:0
    ds_read_u16 v252, v249 offset:64
    ds_read_b128 v[236:239], v247 offset:1152
    ds_read_b32 v240, v248 offset:1152
    s_lshr_b32 s10, s4, 1
    s_lshl_b32 s10, s10, 8
    s_add_u32 s10, s10, 155776
    v_lshl_add_u32 v255, v253, 2, s10
    s_bitcmp1_b32 s4, 0
    s_cselect_b32 s101, -1, 1
    s_max_i32 s10, s17, 1
    s_sub_u32 s10, s10, 1
    s_mul_i32 s10, s101, s10
    s_lshl_b32 s10, s10, 24
    v_mov_b32 v204, s10
    ds_add_u32 v255, v204
    v_mov_b32 v253, 0
    s_mov_b32 exec_hi, 0
    v_add_u32 v253, 0x200, v245
    s_mov_b32 exec_hi, -1
    v_mov_b64 v[204:205], 0
    v_mov_b64 v[206:207], 0
    v_mov_b64 v[208:209], 0
    v_mov_b64 v[210:211], 0
    v_mov_b64 v[212:213], 0
    v_mov_b64 v[214:215], 0
    v_mov_b64 v[216:217], 0
    v_mov_b64 v[218:219], 0
    v_mov_b64 v[220:221], 0
    v_mov_b64 v[222:223], 0
    v_mov_b64 v[224:225], 0
    v_mov_b64 v[226:227], 0
    v_mov_b64 v[228:229], 0
    v_mov_b64 v[230:231], 0
    v_mov_b64 v[232:233], 0
    v_mov_b64 v[234:235], 0
    v_mov_b64 v[184:185], 0
    v_mov_b64 v[186:187], 0
    s_waitcnt lgkmcnt(0)
    v_bfi_b32 v251, 31, v245, v251
    v_bfi_b32 v252, 31, v245, v252
    v_max_u32 v251, v251, v245
    v_max_u32 v252, v252, v253
    s_waitcnt vmcnt(0)
    ds_read_b128 v[176:179], v251
    ds_read_b128 v[180:183], v252
    ds_read_b128 v[160:163], v244 offset:0
    ds_read_b128 v[168:171], v244 offset:512
    ds_read_b128 v[164:167], v244 offset:64
    ds_read_b128 v[172:175], v244 offset:576
    s_cmp_lt_i32 s17, 1
    s_cbranch_scc1 L_DONE
    s_waitcnt lgkmcnt(4)
    v_mfma_f32_16x16x32_bf16 v[188:191], v[176:179], v[64:67], 0
    v_mfma_f32_16x16x32_bf16 v[196:199], v[176:179], v[68:71], 0
    v_mfma_f32_16x16x32_bf16 v[192:195], v[180:183], v[64:67], 0
    v_mfma_f32_16x16x32_bf16 v[200:203], v[180:183], v[68:71], 0
    s_waitcnt lgkmcnt(0)
    v_mfma_f32_16x16x32_bf16 v[188:191], v[160:163], v[0:3], v[188:191]
    v_mfma_f32_16x16x32_bf16 v[196:199], v[160:163], v[8:11], v[196:199]
    v_mfma_f32_16x16x32_bf16 v[192:195], v[168:171], v[0:3], v[192:195]
    v_mfma_f32_16x16x32_bf16 v[200:203], v[168:171], v[8:11], v[200:203]
    v_mfma_f32_16x16x32_bf16 v[188:191], v[164:167], v[4:7], v[188:191]
    v_mfma_f32_16x16x32_bf16 v[196:199], v[164:167], v[12:15], v[196:199]
    v_mfma_f32_16x16x32_bf16 v[192:195], v[172:175], v[4:7], v[192:195]
    v_mfma_f32_16x16x32_bf16 v[200:203], v[172:175], v[12:15], v[200:203]
    s_mov_b32 s16, 1
    s_cmp_eq_u32 s17, 1
    s_cbranch_scc1 L_LT0
    s_add_u32 m0, s13, 0
    v_mad_u32_u16 v236, v236, s15, v243
    buffer_load_dwordx4 v236, s[40:43], 0 offen lds
    s_add_u32 m0, s13, 1056
    v_mad_u32_u16 v237, v237, s15, v243
    buffer_load_dwordx4 v237, s[40:43], 0 offen lds
    s_add_u32 m0, s13, 2112
    v_mad_u32_u16 v238, v238, s15, v243
    buffer_load_dwordx4 v238, s[40:43], 0 offen lds
    s_add_u32 m0, s13, 3168
    v_mad_u32_u16 v239, v239, s15, v243
    buffer_load_dwordx4 v239, s[40:43], 0 offen lds
    s_mov_b32 m0, s14
    v_and_b32 v240, 0xfffff, v240
    buffer_load_dwordx4 v[240:241], s[44:47], 0 idxen offen lds
.p2align 6
L_LOOP1:
    s_setprio 1
    v_smfmac_f32_16x16x64_bf16 v[152:155], v[184:187], v[204:211], v242
    ds_read_u16 v236, v250 offset:0
    ds_read_u16 v237, v250 offset:16
    ds_add_rtn_u32 v238, v255, v242
    v_exp_f32 v188, v188
    v_smfmac_f32_16x16x64_bf16 v[156:159], v[184:187], v[212:219], v242
    v_exp_f32 v189, v189
    v_mfma_f32_16x16x32_bf16 v[204:207], v[160:163], v[32:35], 0
    v_exp_f32 v190, v190
    v_mfma_f32_16x16x32_bf16 v[212:215], v[160:163], v[40:43], 0
    v_exp_f32 v191, v191
    v_mfma_f32_16x16x32_bf16 v[208:211], v[168:171], v[32:35], 0
    v_exp_f32 v192, v192
    v_mfma_f32_16x16x32_bf16 v[216:219], v[168:171], v[40:43], 0
    v_exp_f32 v193, v193
    v_mfma_f32_16x16x32_bf16 v[204:207], v[164:167], v[36:39], v[204:207]
    v_exp_f32 v194, v194
    v_mfma_f32_16x16x32_bf16 v[212:215], v[164:167], v[44:47], v[212:215]
    v_exp_f32 v195, v195
    v_mfma_f32_16x16x32_bf16 v[208:211], v[172:175], v[36:39], v[208:211]
    s_waitcnt lgkmcnt(0)
    v_bfi_b32 v236, 31, v246, v236
    v_bfi_b32 v237, 31, v246, v237
    v_readfirstlane_b32 s96, v238
    v_exp_f32 v196, v196
    v_mfma_f32_16x16x32_bf16 v[216:219], v[172:175], v[44:47], v[216:219]
    v_exp_f32 v197, v197
    s_setprio 3
    v_smfmac_f32_16x16x64_bf16 v[136:139], v[184:187], v[220:227], v242
    v_exp_f32 v198, v198
    v_smfmac_f32_16x16x64_bf16 v[140:143], v[184:187], v[228:235], v242
    v_exp_f32 v199, v199
    v_exp_f32 v200, v200
    v_exp_f32 v201, v201
    v_exp_f32 v202, v202
    v_exp_f32 v203, v203
    v_pk_add_f32 v[188:189], v[188:189], 1.0 op_sel_hi:[1,0]
    v_pk_add_f32 v[190:191], v[190:191], 1.0 op_sel_hi:[1,0]
    v_pk_add_f32 v[192:193], v[192:193], 1.0 op_sel_hi:[1,0]
    v_pk_add_f32 v[194:195], v[194:195], 1.0 op_sel_hi:[1,0]
    v_pk_add_f32 v[196:197], v[196:197], 1.0 op_sel_hi:[1,0]
    v_pk_add_f32 v[198:199], v[198:199], 1.0 op_sel_hi:[1,0]
    v_pk_add_f32 v[200:201], v[200:201], 1.0 op_sel_hi:[1,0]
    v_pk_add_f32 v[202:203], v[202:203], 1.0 op_sel_hi:[1,0]
    s_setprio 1
    v_mfma_f32_16x16x32_bf16 v[220:223], v[176:179], v[72:75], 0
    ds_read_b64_tr_b16 v[184:185], v236
    ds_read_b64_tr_b16 v[186:187], v237
    ds_read_u16 v251, v249 offset:1152
    ds_read_u16 v252, v249 offset:1216
    v_rcp_f32 v188, v188
    v_mfma_f32_16x16x32_bf16 v[228:231], v[176:179], v[76:79], 0
    s_ashr_i32 s96, s96, 24
    s_mul_i32 s96, s96, s101
    v_rcp_f32 v189, v189
    v_mfma_f32_16x16x32_bf16 v[224:227], v[180:183], v[72:75], 0
    v_rcp_f32 v190, v190
    v_mfma_f32_16x16x32_bf16 v[232:235], v[180:183], v[76:79], 0
    v_rcp_f32 v191, v191
    v_mfma_f32_16x16x32_bf16 v[220:223], v[160:163], v[16:19], v[220:223]
    v_rcp_f32 v192, v192
    v_mfma_f32_16x16x32_bf16 v[228:231], v[160:163], v[24:27], v[228:231]
    v_rcp_f32 v193, v193
    v_mfma_f32_16x16x32_bf16 v[224:227], v[168:171], v[16:19], v[224:227]
    s_waitcnt lgkmcnt(0)
    v_bfi_b32 v251, 31, v245, v251
    v_bfi_b32 v252, 31, v245, v252
    v_max_u32 v251, v251, v245
    v_max_u32 v252, v252, v253
    ds_read_b128 v[236:239], v247 offset:128
    ds_read_b32 v240, v248 offset:128
    s_add_u32 s16, s16, 1
    v_rcp_f32 v194, v194
    v_mfma_f32_16x16x32_bf16 v[232:235], v[168:171], v[24:27], v[232:235]
    v_rcp_f32 v195, v195
    v_mfma_f32_16x16x32_bf16 v[220:223], v[164:167], v[20:23], v[220:223]
    v_rcp_f32 v196, v196
    v_mfma_f32_16x16x32_bf16 v[228:231], v[164:167], v[28:31], v[228:231]
    v_rcp_f32 v197, v197
    s_setprio 3
    v_mfma_f32_16x16x32_bf16 v[224:227], v[172:175], v[20:23], v[224:227]
    v_rcp_f32 v198, v198
    v_mfma_f32_16x16x32_bf16 v[232:235], v[172:175], v[28:31], v[232:235]
    v_rcp_f32 v199, v199
    v_rcp_f32 v200, v200
    v_rcp_f32 v201, v201
    v_rcp_f32 v202, v202
    v_rcp_f32 v203, v203
    v_pk_mul_f32 v[204:205], v[188:189], v[204:205]
    v_pk_mul_f32 v[206:207], v[190:191], v[206:207]
    v_pk_mul_f32 v[208:209], v[192:193], v[208:209]
    v_pk_mul_f32 v[210:211], v[194:195], v[210:211]
    v_pk_mul_f32 v[212:213], v[196:197], v[212:213]
    v_pk_mul_f32 v[214:215], v[198:199], v[214:215]
    v_pk_mul_f32 v[216:217], v[200:201], v[216:217]
    v_pk_mul_f32 v[218:219], v[202:203], v[218:219]
    s_cmp_ge_i32 s96, 1
    s_cbranch_scc0 L_PB00
L_PB01:
    s_setprio 1
    v_smfmac_f32_16x16x64_bf16 v[112:115], v[184:187], v[204:211], v242
    v_exp_f32 v220, v220
    v_smfmac_f32_16x16x64_bf16 v[116:119], v[184:187], v[212:219], v242
    v_exp_f32 v221, v221
    s_waitcnt vmcnt(0)
    ds_read_b128 v[176:179], v251
    ds_read_b128 v[180:183], v252
    v_mfma_f32_16x16x32_bf16 v[204:207], v[160:163], v[48:51], 0
    v_exp_f32 v222, v222
    v_mfma_f32_16x16x32_bf16 v[212:215], v[160:163], v[56:59], 0
    ds_read_b128 v[160:163], v244 offset:0
    v_exp_f32 v223, v223
    v_mfma_f32_16x16x32_bf16 v[208:211], v[168:171], v[48:51], 0
    v_exp_f32 v224, v224
    v_mfma_f32_16x16x32_bf16 v[216:219], v[168:171], v[56:59], 0
    ds_read_b128 v[168:171], v244 offset:512
    v_exp_f32 v225, v225
    v_mfma_f32_16x16x32_bf16 v[204:207], v[164:167], v[52:55], v[204:207]
    v_exp_f32 v226, v226
    v_mfma_f32_16x16x32_bf16 v[212:215], v[164:167], v[60:63], v[212:215]
    ds_read_b128 v[164:167], v244 offset:64
    v_exp_f32 v227, v227
    v_mfma_f32_16x16x32_bf16 v[208:211], v[172:175], v[52:55], v[208:211]
    v_exp_f32 v228, v228
    v_mfma_f32_16x16x32_bf16 v[216:219], v[172:175], v[60:63], v[216:219]
    ds_read_b128 v[172:175], v244 offset:576
    v_exp_f32 v229, v229
    s_setprio 3
    v_smfmac_f32_16x16x64_bf16 v[96:99], v[184:187], v[188:195], v242
    v_exp_f32 v230, v230
    v_smfmac_f32_16x16x64_bf16 v[100:103], v[184:187], v[196:203], v242
    v_exp_f32 v231, v231
    v_exp_f32 v232, v232
    v_exp_f32 v233, v233
    v_exp_f32 v234, v234
    v_exp_f32 v235, v235
    v_pk_add_f32 v[220:221], v[220:221], 1.0 op_sel_hi:[1,0]
    v_pk_add_f32 v[222:223], v[222:223], 1.0 op_sel_hi:[1,0]
    v_pk_add_f32 v[224:225], v[224:225], 1.0 op_sel_hi:[1,0]
    v_pk_add_f32 v[226:227], v[226:227], 1.0 op_sel_hi:[1,0]
    v_pk_add_f32 v[228:229], v[228:229], 1.0 op_sel_hi:[1,0]
    v_pk_add_f32 v[230:231], v[230:231], 1.0 op_sel_hi:[1,0]
    v_pk_add_f32 v[232:233], v[232:233], 1.0 op_sel_hi:[1,0]
    v_pk_add_f32 v[234:235], v[234:235], 1.0 op_sel_hi:[1,0]
    s_setprio 1
    s_waitcnt lgkmcnt(4)
    v_mfma_f32_16x16x32_bf16 v[188:191], v[176:179], v[80:83], 0
    v_rcp_f32 v220, v220
    v_mfma_f32_16x16x32_bf16 v[196:199], v[176:179], v[84:87], 0
    v_rcp_f32 v221, v221
    v_mfma_f32_16x16x32_bf16 v[192:195], v[180:183], v[80:83], 0
    v_rcp_f32 v222, v222
    v_mfma_f32_16x16x32_bf16 v[200:203], v[180:183], v[84:87], 0
    v_rcp_f32 v223, v223
    s_waitcnt lgkmcnt(3)
    v_mfma_f32_16x16x32_bf16 v[188:191], v[160:163], v[0:3], v[188:191]
    v_rcp_f32 v224, v224
    v_mfma_f32_16x16x32_bf16 v[196:199], v[160:163], v[8:11], v[196:199]
    v_rcp_f32 v225, v225
    s_waitcnt lgkmcnt(2)
    v_mfma_f32_16x16x32_bf16 v[192:195], v[168:171], v[0:3], v[192:195]
    v_rcp_f32 v226, v226
    v_mfma_f32_16x16x32_bf16 v[200:203], v[168:171], v[8:11], v[200:203]
    v_rcp_f32 v227, v227
    s_waitcnt lgkmcnt(1)
    v_mfma_f32_16x16x32_bf16 v[188:191], v[164:167], v[4:7], v[188:191]
    v_rcp_f32 v228, v228
    v_mfma_f32_16x16x32_bf16 v[196:199], v[164:167], v[12:15], v[196:199]
    v_rcp_f32 v229, v229
    s_setprio 3
    s_waitcnt lgkmcnt(0)
    v_mfma_f32_16x16x32_bf16 v[192:195], v[172:175], v[4:7], v[192:195]
    s_cmp_lt_u32 s16, s17
    s_cbranch_scc0 L_ND01
    s_add_u32 m0, s13, 0
    v_mad_u32_u16 v236, v236, s15, v243
    buffer_load_dwordx4 v236, s[40:43], 0 offen lds
    s_add_u32 m0, s13, 1056
    v_mad_u32_u16 v237, v237, s15, v243
    buffer_load_dwordx4 v237, s[40:43], 0 offen lds
    s_add_u32 m0, s13, 2112
    v_mad_u32_u16 v238, v238, s15, v243
    buffer_load_dwordx4 v238, s[40:43], 0 offen lds
    s_add_u32 m0, s13, 3168
    v_mad_u32_u16 v239, v239, s15, v243
    buffer_load_dwordx4 v239, s[40:43], 0 offen lds
    s_mov_b32 m0, s14
    v_and_b32 v240, 0xfffff, v240
    buffer_load_dwordx4 v[240:241], s[44:47], 0 idxen offen lds
L_ND01:
    v_rcp_f32 v230, v230
    v_mfma_f32_16x16x32_bf16 v[200:203], v[172:175], v[12:15], v[200:203]
    v_rcp_f32 v231, v231
    v_rcp_f32 v232, v232
    v_rcp_f32 v233, v233
    v_rcp_f32 v234, v234
    v_rcp_f32 v235, v235
    v_pk_mul_f32 v[204:205], v[220:221], v[204:205]
    v_pk_mul_f32 v[206:207], v[222:223], v[206:207]
    v_pk_mul_f32 v[208:209], v[224:225], v[208:209]
    v_pk_mul_f32 v[210:211], v[226:227], v[210:211]
    v_pk_mul_f32 v[212:213], v[228:229], v[212:213]
    v_pk_mul_f32 v[214:215], v[230:231], v[214:215]
    v_pk_mul_f32 v[216:217], v[232:233], v[216:217]
    v_pk_mul_f32 v[218:219], v[234:235], v[218:219]
    s_cmp_ge_u32 s16, s17
    s_cbranch_scc1 L_LT1
    s_setprio 1
    v_smfmac_f32_16x16x64_bf16 v[120:123], v[184:187], v[204:211], v242
    ds_read_u16 v236, v250 offset:1152
    ds_read_u16 v237, v250 offset:1168
    ds_add_rtn_u32 v238, v255, v242
    v_exp_f32 v188, v188
    v_smfmac_f32_16x16x64_bf16 v[124:127], v[184:187], v[212:219], v242
    v_exp_f32 v189, v189
    v_mfma_f32_16x16x32_bf16 v[204:207], v[160:163], v[32:35], 0
    v_exp_f32 v190, v190
    v_mfma_f32_16x16x32_bf16 v[212:215], v[160:163], v[40:43], 0
    v_exp_f32 v191, v191
    v_mfma_f32_16x16x32_bf16 v[208:211], v[168:171], v[32:35], 0
    v_exp_f32 v192, v192
    v_mfma_f32_16x16x32_bf16 v[216:219], v[168:171], v[40:43], 0
    v_exp_f32 v193, v193
    v_mfma_f32_16x16x32_bf16 v[204:207], v[164:167], v[36:39], v[204:207]
    v_exp_f32 v194, v194
    v_mfma_f32_16x16x32_bf16 v[212:215], v[164:167], v[44:47], v[212:215]
    v_exp_f32 v195, v195
    v_mfma_f32_16x16x32_bf16 v[208:211], v[172:175], v[36:39], v[208:211]
    s_waitcnt lgkmcnt(0)
    v_bfi_b32 v236, 31, v246, v236
    v_bfi_b32 v237, 31, v246, v237
    v_readfirstlane_b32 s96, v238
    v_exp_f32 v196, v196
    v_mfma_f32_16x16x32_bf16 v[216:219], v[172:175], v[44:47], v[216:219]
    v_exp_f32 v197, v197
    s_setprio 3
    v_smfmac_f32_16x16x64_bf16 v[104:107], v[184:187], v[220:227], v242
    v_exp_f32 v198, v198
    v_smfmac_f32_16x16x64_bf16 v[108:111], v[184:187], v[228:235], v242
    v_exp_f32 v199, v199
    v_exp_f32 v200, v200
    v_exp_f32 v201, v201
    v_exp_f32 v202, v202
    v_exp_f32 v203, v203
    v_pk_add_f32 v[188:189], v[188:189], 1.0 op_sel_hi:[1,0]
    v_pk_add_f32 v[190:191], v[190:191], 1.0 op_sel_hi:[1,0]
    v_pk_add_f32 v[192:193], v[192:193], 1.0 op_sel_hi:[1,0]
    v_pk_add_f32 v[194:195], v[194:195], 1.0 op_sel_hi:[1,0]
    v_pk_add_f32 v[196:197], v[196:197], 1.0 op_sel_hi:[1,0]
    v_pk_add_f32 v[198:199], v[198:199], 1.0 op_sel_hi:[1,0]
    v_pk_add_f32 v[200:201], v[200:201], 1.0 op_sel_hi:[1,0]
    v_pk_add_f32 v[202:203], v[202:203], 1.0 op_sel_hi:[1,0]
    s_setprio 1
    v_mfma_f32_16x16x32_bf16 v[220:223], v[176:179], v[88:91], 0
    ds_read_b64_tr_b16 v[184:185], v236
    ds_read_b64_tr_b16 v[186:187], v237
    ds_read_u16 v251, v249 offset:128
    ds_read_u16 v252, v249 offset:192
    v_rcp_f32 v188, v188
    v_mfma_f32_16x16x32_bf16 v[228:231], v[176:179], v[92:95], 0
    s_ashr_i32 s96, s96, 24
    s_mul_i32 s96, s96, s101
    v_rcp_f32 v189, v189
    v_mfma_f32_16x16x32_bf16 v[224:227], v[180:183], v[88:91], 0
    v_rcp_f32 v190, v190
    v_mfma_f32_16x16x32_bf16 v[232:235], v[180:183], v[92:95], 0
    v_rcp_f32 v191, v191
    v_mfma_f32_16x16x32_bf16 v[220:223], v[160:163], v[16:19], v[220:223]
    v_rcp_f32 v192, v192
    v_mfma_f32_16x16x32_bf16 v[228:231], v[160:163], v[24:27], v[228:231]
    v_rcp_f32 v193, v193
    v_mfma_f32_16x16x32_bf16 v[224:227], v[168:171], v[16:19], v[224:227]
    s_waitcnt lgkmcnt(0)
    v_bfi_b32 v251, 31, v245, v251
    v_bfi_b32 v252, 31, v245, v252
    v_max_u32 v251, v251, v245
    v_max_u32 v252, v252, v253
    ds_read_b128 v[236:239], v247 offset:1280
    ds_read_b32 v240, v248 offset:1280
    s_add_u32 s16, s16, 1
    v_rcp_f32 v194, v194
    v_mfma_f32_16x16x32_bf16 v[232:235], v[168:171], v[24:27], v[232:235]
    v_add_u32 v247, 0x80, v247
    v_add_u32 v248, 0x80, v248
    v_add_u32 v249, 0x80, v249
    v_add_u32 v250, 0x80, v250
    v_rcp_f32 v195, v195
    v_mfma_f32_16x16x32_bf16 v[220:223], v[164:167], v[20:23], v[220:223]
    v_rcp_f32 v196, v196
    v_mfma_f32_16x16x32_bf16 v[228:231], v[164:167], v[28:31], v[228:231]
    v_rcp_f32 v197, v197
    s_setprio 3
    v_mfma_f32_16x16x32_bf16 v[224:227], v[172:175], v[20:23], v[224:227]
    v_rcp_f32 v198, v198
    v_mfma_f32_16x16x32_bf16 v[232:235], v[172:175], v[28:31], v[232:235]
    v_rcp_f32 v199, v199
    v_rcp_f32 v200, v200
    v_rcp_f32 v201, v201
    v_rcp_f32 v202, v202
    v_rcp_f32 v203, v203
    v_pk_mul_f32 v[204:205], v[188:189], v[204:205]
    v_pk_mul_f32 v[206:207], v[190:191], v[206:207]
    v_pk_mul_f32 v[208:209], v[192:193], v[208:209]
    v_pk_mul_f32 v[210:211], v[194:195], v[210:211]
    v_pk_mul_f32 v[212:213], v[196:197], v[212:213]
    v_pk_mul_f32 v[214:215], v[198:199], v[214:215]
    v_pk_mul_f32 v[216:217], v[200:201], v[216:217]
    v_pk_mul_f32 v[218:219], v[202:203], v[218:219]
    s_cmp_ge_i32 s96, 1
    s_cbranch_scc0 L_PB10
L_PB11:
    s_setprio 1
    v_smfmac_f32_16x16x64_bf16 v[144:147], v[184:187], v[204:211], v242
    v_exp_f32 v220, v220
    v_smfmac_f32_16x16x64_bf16 v[148:151], v[184:187], v[212:219], v242
    v_exp_f32 v221, v221
    s_waitcnt vmcnt(0)
    ds_read_b128 v[176:179], v251
    ds_read_b128 v[180:183], v252
    v_mfma_f32_16x16x32_bf16 v[204:207], v[160:163], v[48:51], 0
    v_exp_f32 v222, v222
    v_mfma_f32_16x16x32_bf16 v[212:215], v[160:163], v[56:59], 0
    ds_read_b128 v[160:163], v244 offset:0
    v_exp_f32 v223, v223
    v_mfma_f32_16x16x32_bf16 v[208:211], v[168:171], v[48:51], 0
    v_exp_f32 v224, v224
    v_mfma_f32_16x16x32_bf16 v[216:219], v[168:171], v[56:59], 0
    ds_read_b128 v[168:171], v244 offset:512
    v_exp_f32 v225, v225
    v_mfma_f32_16x16x32_bf16 v[204:207], v[164:167], v[52:55], v[204:207]
    v_exp_f32 v226, v226
    v_mfma_f32_16x16x32_bf16 v[212:215], v[164:167], v[60:63], v[212:215]
    ds_read_b128 v[164:167], v244 offset:64
    v_exp_f32 v227, v227
    v_mfma_f32_16x16x32_bf16 v[208:211], v[172:175], v[52:55], v[208:211]
    v_exp_f32 v228, v228
    v_mfma_f32_16x16x32_bf16 v[216:219], v[172:175], v[60:63], v[216:219]
    ds_read_b128 v[172:175], v244 offset:576
    v_exp_f32 v229, v229
    s_setprio 3
    v_smfmac_f32_16x16x64_bf16 v[128:131], v[184:187], v[188:195], v242
    v_exp_f32 v230, v230
    v_smfmac_f32_16x16x64_bf16 v[132:135], v[184:187], v[196:203], v242
    v_exp_f32 v231, v231
    v_exp_f32 v232, v232
    v_exp_f32 v233, v233
    v_exp_f32 v234, v234
    v_exp_f32 v235, v235
    v_pk_add_f32 v[220:221], v[220:221], 1.0 op_sel_hi:[1,0]
    v_pk_add_f32 v[222:223], v[222:223], 1.0 op_sel_hi:[1,0]
    v_pk_add_f32 v[224:225], v[224:225], 1.0 op_sel_hi:[1,0]
    v_pk_add_f32 v[226:227], v[226:227], 1.0 op_sel_hi:[1,0]
    v_pk_add_f32 v[228:229], v[228:229], 1.0 op_sel_hi:[1,0]
    v_pk_add_f32 v[230:231], v[230:231], 1.0 op_sel_hi:[1,0]
    v_pk_add_f32 v[232:233], v[232:233], 1.0 op_sel_hi:[1,0]
    v_pk_add_f32 v[234:235], v[234:235], 1.0 op_sel_hi:[1,0]
    s_setprio 1
    s_waitcnt lgkmcnt(4)
    v_mfma_f32_16x16x32_bf16 v[188:191], v[176:179], v[64:67], 0
    v_rcp_f32 v220, v220
    v_mfma_f32_16x16x32_bf16 v[196:199], v[176:179], v[68:71], 0
    v_rcp_f32 v221, v221
    v_mfma_f32_16x16x32_bf16 v[192:195], v[180:183], v[64:67], 0
    v_rcp_f32 v222, v222
    v_mfma_f32_16x16x32_bf16 v[200:203], v[180:183], v[68:71], 0
    v_rcp_f32 v223, v223
    s_waitcnt lgkmcnt(3)
    v_mfma_f32_16x16x32_bf16 v[188:191], v[160:163], v[0:3], v[188:191]
    v_rcp_f32 v224, v224
    v_mfma_f32_16x16x32_bf16 v[196:199], v[160:163], v[8:11], v[196:199]
    v_rcp_f32 v225, v225
    s_waitcnt lgkmcnt(2)
    v_mfma_f32_16x16x32_bf16 v[192:195], v[168:171], v[0:3], v[192:195]
    v_rcp_f32 v226, v226
    v_mfma_f32_16x16x32_bf16 v[200:203], v[168:171], v[8:11], v[200:203]
    v_rcp_f32 v227, v227
    s_waitcnt lgkmcnt(1)
    v_mfma_f32_16x16x32_bf16 v[188:191], v[164:167], v[4:7], v[188:191]
    v_rcp_f32 v228, v228
    v_mfma_f32_16x16x32_bf16 v[196:199], v[164:167], v[12:15], v[196:199]
    v_rcp_f32 v229, v229
    s_setprio 3
    s_waitcnt lgkmcnt(0)
    v_mfma_f32_16x16x32_bf16 v[192:195], v[172:175], v[4:7], v[192:195]
    s_cmp_lt_u32 s16, s17
    s_cbranch_scc0 L_ND11
    s_add_u32 m0, s13, 0
    v_mad_u32_u16 v236, v236, s15, v243
    buffer_load_dwordx4 v236, s[40:43], 0 offen lds
    s_add_u32 m0, s13, 1056
    v_mad_u32_u16 v237, v237, s15, v243
    buffer_load_dwordx4 v237, s[40:43], 0 offen lds
    s_add_u32 m0, s13, 2112
    v_mad_u32_u16 v238, v238, s15, v243
    buffer_load_dwordx4 v238, s[40:43], 0 offen lds
    s_add_u32 m0, s13, 3168
    v_mad_u32_u16 v239, v239, s15, v243
    buffer_load_dwordx4 v239, s[40:43], 0 offen lds
    s_mov_b32 m0, s14
    v_and_b32 v240, 0xfffff, v240
    buffer_load_dwordx4 v[240:241], s[44:47], 0 idxen offen lds
L_ND11:
    v_rcp_f32 v230, v230
    v_mfma_f32_16x16x32_bf16 v[200:203], v[172:175], v[12:15], v[200:203]
    v_rcp_f32 v231, v231
    v_rcp_f32 v232, v232
    v_rcp_f32 v233, v233
    v_rcp_f32 v234, v234
    v_rcp_f32 v235, v235
    v_pk_mul_f32 v[204:205], v[220:221], v[204:205]
    v_pk_mul_f32 v[206:207], v[222:223], v[206:207]
    v_pk_mul_f32 v[208:209], v[224:225], v[208:209]
    v_pk_mul_f32 v[210:211], v[226:227], v[210:211]
    v_pk_mul_f32 v[212:213], v[228:229], v[212:213]
    v_pk_mul_f32 v[214:215], v[230:231], v[214:215]
    v_pk_mul_f32 v[216:217], v[232:233], v[216:217]
    v_pk_mul_f32 v[218:219], v[234:235], v[218:219]
    s_cmp_lt_u32 s16, s17
    s_cbranch_scc1 L_LOOP1
    s_branch L_LT0
.p2align 6
L_LOOP0:
    s_setprio 0
    v_smfmac_f32_16x16x64_bf16 v[152:155], v[184:187], v[204:211], v242
    ds_read_u16 v236, v250 offset:0
    ds_read_u16 v237, v250 offset:16
    ds_add_rtn_u32 v238, v255, v242
    v_exp_f32 v188, v188
    v_smfmac_f32_16x16x64_bf16 v[156:159], v[184:187], v[212:219], v242
    v_exp_f32 v189, v189
    v_mfma_f32_16x16x32_bf16 v[204:207], v[160:163], v[32:35], 0
    v_exp_f32 v190, v190
    v_mfma_f32_16x16x32_bf16 v[212:215], v[160:163], v[40:43], 0
    v_exp_f32 v191, v191
    v_mfma_f32_16x16x32_bf16 v[208:211], v[168:171], v[32:35], 0
    v_exp_f32 v192, v192
    v_mfma_f32_16x16x32_bf16 v[216:219], v[168:171], v[40:43], 0
    v_exp_f32 v193, v193
    v_mfma_f32_16x16x32_bf16 v[204:207], v[164:167], v[36:39], v[204:207]
    v_exp_f32 v194, v194
    v_mfma_f32_16x16x32_bf16 v[212:215], v[164:167], v[44:47], v[212:215]
    v_exp_f32 v195, v195
    v_mfma_f32_16x16x32_bf16 v[208:211], v[172:175], v[36:39], v[208:211]
    s_waitcnt lgkmcnt(0)
    v_bfi_b32 v236, 31, v246, v236
    v_bfi_b32 v237, 31, v246, v237
    v_readfirstlane_b32 s96, v238
    v_exp_f32 v196, v196
    v_mfma_f32_16x16x32_bf16 v[216:219], v[172:175], v[44:47], v[216:219]
    v_exp_f32 v197, v197
    s_setprio 3
    v_smfmac_f32_16x16x64_bf16 v[136:139], v[184:187], v[220:227], v242
    v_exp_f32 v198, v198
    v_smfmac_f32_16x16x64_bf16 v[140:143], v[184:187], v[228:235], v242
    v_exp_f32 v199, v199
    v_exp_f32 v200, v200
    v_exp_f32 v201, v201
    v_exp_f32 v202, v202
    v_exp_f32 v203, v203
    v_pk_add_f32 v[188:189], v[188:189], 1.0 op_sel_hi:[1,0]
    v_pk_add_f32 v[190:191], v[190:191], 1.0 op_sel_hi:[1,0]
    v_pk_add_f32 v[192:193], v[192:193], 1.0 op_sel_hi:[1,0]
    v_pk_add_f32 v[194:195], v[194:195], 1.0 op_sel_hi:[1,0]
    v_pk_add_f32 v[196:197], v[196:197], 1.0 op_sel_hi:[1,0]
    v_pk_add_f32 v[198:199], v[198:199], 1.0 op_sel_hi:[1,0]
    v_pk_add_f32 v[200:201], v[200:201], 1.0 op_sel_hi:[1,0]
    v_pk_add_f32 v[202:203], v[202:203], 1.0 op_sel_hi:[1,0]
    s_setprio 0
    v_mfma_f32_16x16x32_bf16 v[220:223], v[176:179], v[72:75], 0
    ds_read_b64_tr_b16 v[184:185], v236
    ds_read_b64_tr_b16 v[186:187], v237
    ds_read_u16 v251, v249 offset:1152
    ds_read_u16 v252, v249 offset:1216
    v_rcp_f32 v188, v188
    v_mfma_f32_16x16x32_bf16 v[228:231], v[176:179], v[76:79], 0
    s_ashr_i32 s96, s96, 24
    s_mul_i32 s96, s96, s101
    v_rcp_f32 v189, v189
    v_mfma_f32_16x16x32_bf16 v[224:227], v[180:183], v[72:75], 0
    v_rcp_f32 v190, v190
    v_mfma_f32_16x16x32_bf16 v[232:235], v[180:183], v[76:79], 0
    v_rcp_f32 v191, v191
    v_mfma_f32_16x16x32_bf16 v[220:223], v[160:163], v[16:19], v[220:223]
    v_rcp_f32 v192, v192
    v_mfma_f32_16x16x32_bf16 v[228:231], v[160:163], v[24:27], v[228:231]
    v_rcp_f32 v193, v193
    v_mfma_f32_16x16x32_bf16 v[224:227], v[168:171], v[16:19], v[224:227]
    s_waitcnt lgkmcnt(0)
    v_bfi_b32 v251, 31, v245, v251
    v_bfi_b32 v252, 31, v245, v252
    v_max_u32 v251, v251, v245
    v_max_u32 v252, v252, v253
    ds_read_b128 v[236:239], v247 offset:128
    ds_read_b32 v240, v248 offset:128
    s_add_u32 s16, s16, 1
    v_rcp_f32 v194, v194
    v_mfma_f32_16x16x32_bf16 v[232:235], v[168:171], v[24:27], v[232:235]
    v_rcp_f32 v195, v195
    v_mfma_f32_16x16x32_bf16 v[220:223], v[164:167], v[20:23], v[220:223]
    v_rcp_f32 v196, v196
    v_mfma_f32_16x16x32_bf16 v[228:231], v[164:167], v[28:31], v[228:231]
    v_rcp_f32 v197, v197
    s_setprio 3
    v_mfma_f32_16x16x32_bf16 v[224:227], v[172:175], v[20:23], v[224:227]
    v_rcp_f32 v198, v198
    v_mfma_f32_16x16x32_bf16 v[232:235], v[172:175], v[28:31], v[232:235]
    v_rcp_f32 v199, v199
    v_rcp_f32 v200, v200
    v_rcp_f32 v201, v201
    v_rcp_f32 v202, v202
    v_rcp_f32 v203, v203
    v_pk_mul_f32 v[204:205], v[188:189], v[204:205]
    v_pk_mul_f32 v[206:207], v[190:191], v[206:207]
    v_pk_mul_f32 v[208:209], v[192:193], v[208:209]
    v_pk_mul_f32 v[210:211], v[194:195], v[210:211]
    v_pk_mul_f32 v[212:213], v[196:197], v[212:213]
    v_pk_mul_f32 v[214:215], v[198:199], v[214:215]
    v_pk_mul_f32 v[216:217], v[200:201], v[216:217]
    v_pk_mul_f32 v[218:219], v[202:203], v[218:219]
    s_cmp_ge_i32 s96, 1
    s_cbranch_scc1 L_PB01
L_PB00:
    s_setprio 0
    v_smfmac_f32_16x16x64_bf16 v[112:115], v[184:187], v[204:211], v242
    v_exp_f32 v220, v220
    v_smfmac_f32_16x16x64_bf16 v[116:119], v[184:187], v[212:219], v242
    v_exp_f32 v221, v221
    s_waitcnt vmcnt(0)
    ds_read_b128 v[176:179], v251
    ds_read_b128 v[180:183], v252
    v_mfma_f32_16x16x32_bf16 v[204:207], v[160:163], v[48:51], 0
    v_exp_f32 v222, v222
    v_mfma_f32_16x16x32_bf16 v[212:215], v[160:163], v[56:59], 0
    ds_read_b128 v[160:163], v244 offset:0
    v_exp_f32 v223, v223
    v_mfma_f32_16x16x32_bf16 v[208:211], v[168:171], v[48:51], 0
    v_exp_f32 v224, v224
    v_mfma_f32_16x16x32_bf16 v[216:219], v[168:171], v[56:59], 0
    ds_read_b128 v[168:171], v244 offset:512
    v_exp_f32 v225, v225
    v_mfma_f32_16x16x32_bf16 v[204:207], v[164:167], v[52:55], v[204:207]
    v_exp_f32 v226, v226
    v_mfma_f32_16x16x32_bf16 v[212:215], v[164:167], v[60:63], v[212:215]
    ds_read_b128 v[164:167], v244 offset:64
    v_exp_f32 v227, v227
    v_mfma_f32_16x16x32_bf16 v[208:211], v[172:175], v[52:55], v[208:211]
    v_exp_f32 v228, v228
    v_mfma_f32_16x16x32_bf16 v[216:219], v[172:175], v[60:63], v[216:219]
    ds_read_b128 v[172:175], v244 offset:576
    v_exp_f32 v229, v229
    s_setprio 3
    v_smfmac_f32_16x16x64_bf16 v[96:99], v[184:187], v[188:195], v242
    v_exp_f32 v230, v230
    v_smfmac_f32_16x16x64_bf16 v[100:103], v[184:187], v[196:203], v242
    v_exp_f32 v231, v231
    v_exp_f32 v232, v232
    v_exp_f32 v233, v233
    v_exp_f32 v234, v234
    v_exp_f32 v235, v235
    v_pk_add_f32 v[220:221], v[220:221], 1.0 op_sel_hi:[1,0]
    v_pk_add_f32 v[222:223], v[222:223], 1.0 op_sel_hi:[1,0]
    v_pk_add_f32 v[224:225], v[224:225], 1.0 op_sel_hi:[1,0]
    v_pk_add_f32 v[226:227], v[226:227], 1.0 op_sel_hi:[1,0]
    v_pk_add_f32 v[228:229], v[228:229], 1.0 op_sel_hi:[1,0]
    v_pk_add_f32 v[230:231], v[230:231], 1.0 op_sel_hi:[1,0]
    v_pk_add_f32 v[232:233], v[232:233], 1.0 op_sel_hi:[1,0]
    v_pk_add_f32 v[234:235], v[234:235], 1.0 op_sel_hi:[1,0]
    s_setprio 0
    s_waitcnt lgkmcnt(4)
    v_mfma_f32_16x16x32_bf16 v[188:191], v[176:179], v[80:83], 0
    v_rcp_f32 v220, v220
    v_mfma_f32_16x16x32_bf16 v[196:199], v[176:179], v[84:87], 0
    v_rcp_f32 v221, v221
    v_mfma_f32_16x16x32_bf16 v[192:195], v[180:183], v[80:83], 0
    v_rcp_f32 v222, v222
    v_mfma_f32_16x16x32_bf16 v[200:203], v[180:183], v[84:87], 0
    v_rcp_f32 v223, v223
    s_waitcnt lgkmcnt(3)
    v_mfma_f32_16x16x32_bf16 v[188:191], v[160:163], v[0:3], v[188:191]
    v_rcp_f32 v224, v224
    v_mfma_f32_16x16x32_bf16 v[196:199], v[160:163], v[8:11], v[196:199]
    v_rcp_f32 v225, v225
    s_waitcnt lgkmcnt(2)
    v_mfma_f32_16x16x32_bf16 v[192:195], v[168:171], v[0:3], v[192:195]
    v_rcp_f32 v226, v226
    v_mfma_f32_16x16x32_bf16 v[200:203], v[168:171], v[8:11], v[200:203]
    v_rcp_f32 v227, v227
    s_waitcnt lgkmcnt(1)
    v_mfma_f32_16x16x32_bf16 v[188:191], v[164:167], v[4:7], v[188:191]
    v_rcp_f32 v228, v228
    v_mfma_f32_16x16x32_bf16 v[196:199], v[164:167], v[12:15], v[196:199]
    v_rcp_f32 v229, v229
    s_setprio 3
    s_waitcnt lgkmcnt(0)
    v_mfma_f32_16x16x32_bf16 v[192:195], v[172:175], v[4:7], v[192:195]
    s_cmp_lt_u32 s16, s17
    s_cbranch_scc0 L_ND00
    s_add_u32 m0, s13, 0
    v_mad_u32_u16 v236, v236, s15, v243
    buffer_load_dwordx4 v236, s[40:43], 0 offen lds
    s_add_u32 m0, s13, 1056
    v_mad_u32_u16 v237, v237, s15, v243
    buffer_load_dwordx4 v237, s[40:43], 0 offen lds
    s_add_u32 m0, s13, 2112
    v_mad_u32_u16 v238, v238, s15, v243
    buffer_load_dwordx4 v238, s[40:43], 0 offen lds
    s_add_u32 m0, s13, 3168
    v_mad_u32_u16 v239, v239, s15, v243
    buffer_load_dwordx4 v239, s[40:43], 0 offen lds
    s_mov_b32 m0, s14
    v_and_b32 v240, 0xfffff, v240
    buffer_load_dwordx4 v[240:241], s[44:47], 0 idxen offen lds
L_ND00:
    v_rcp_f32 v230, v230
    v_mfma_f32_16x16x32_bf16 v[200:203], v[172:175], v[12:15], v[200:203]
    v_rcp_f32 v231, v231
    v_rcp_f32 v232, v232
    v_rcp_f32 v233, v233
    v_rcp_f32 v234, v234
    v_rcp_f32 v235, v235
    v_pk_mul_f32 v[204:205], v[220:221], v[204:205]
    v_pk_mul_f32 v[206:207], v[222:223], v[206:207]
    v_pk_mul_f32 v[208:209], v[224:225], v[208:209]
    v_pk_mul_f32 v[210:211], v[226:227], v[210:211]
    v_pk_mul_f32 v[212:213], v[228:229], v[212:213]
    v_pk_mul_f32 v[214:215], v[230:231], v[214:215]
    v_pk_mul_f32 v[216:217], v[232:233], v[216:217]
    v_pk_mul_f32 v[218:219], v[234:235], v[218:219]
    s_cmp_ge_u32 s16, s17
    s_cbranch_scc1 L_LT1
    s_setprio 0
    v_smfmac_f32_16x16x64_bf16 v[120:123], v[184:187], v[204:211], v242
    ds_read_u16 v236, v250 offset:1152
    ds_read_u16 v237, v250 offset:1168
    ds_add_rtn_u32 v238, v255, v242
    v_exp_f32 v188, v188
    v_smfmac_f32_16x16x64_bf16 v[124:127], v[184:187], v[212:219], v242
    v_exp_f32 v189, v189
    v_mfma_f32_16x16x32_bf16 v[204:207], v[160:163], v[32:35], 0
    v_exp_f32 v190, v190
    v_mfma_f32_16x16x32_bf16 v[212:215], v[160:163], v[40:43], 0
    v_exp_f32 v191, v191
    v_mfma_f32_16x16x32_bf16 v[208:211], v[168:171], v[32:35], 0
    v_exp_f32 v192, v192
    v_mfma_f32_16x16x32_bf16 v[216:219], v[168:171], v[40:43], 0
    v_exp_f32 v193, v193
    v_mfma_f32_16x16x32_bf16 v[204:207], v[164:167], v[36:39], v[204:207]
    v_exp_f32 v194, v194
    v_mfma_f32_16x16x32_bf16 v[212:215], v[164:167], v[44:47], v[212:215]
    v_exp_f32 v195, v195
    v_mfma_f32_16x16x32_bf16 v[208:211], v[172:175], v[36:39], v[208:211]
    s_waitcnt lgkmcnt(0)
    v_bfi_b32 v236, 31, v246, v236
    v_bfi_b32 v237, 31, v246, v237
    v_readfirstlane_b32 s96, v238
    v_exp_f32 v196, v196
    v_mfma_f32_16x16x32_bf16 v[216:219], v[172:175], v[44:47], v[216:219]
    v_exp_f32 v197, v197
    s_setprio 3
    v_smfmac_f32_16x16x64_bf16 v[104:107], v[184:187], v[220:227], v242
    v_exp_f32 v198, v198
    v_smfmac_f32_16x16x64_bf16 v[108:111], v[184:187], v[228:235], v242
    v_exp_f32 v199, v199
    v_exp_f32 v200, v200
    v_exp_f32 v201, v201
    v_exp_f32 v202, v202
    v_exp_f32 v203, v203
    v_pk_add_f32 v[188:189], v[188:189], 1.0 op_sel_hi:[1,0]
    v_pk_add_f32 v[190:191], v[190:191], 1.0 op_sel_hi:[1,0]
    v_pk_add_f32 v[192:193], v[192:193], 1.0 op_sel_hi:[1,0]
    v_pk_add_f32 v[194:195], v[194:195], 1.0 op_sel_hi:[1,0]
    v_pk_add_f32 v[196:197], v[196:197], 1.0 op_sel_hi:[1,0]
    v_pk_add_f32 v[198:199], v[198:199], 1.0 op_sel_hi:[1,0]
    v_pk_add_f32 v[200:201], v[200:201], 1.0 op_sel_hi:[1,0]
    v_pk_add_f32 v[202:203], v[202:203], 1.0 op_sel_hi:[1,0]
    s_setprio 0
    v_mfma_f32_16x16x32_bf16 v[220:223], v[176:179], v[88:91], 0
    ds_read_b64_tr_b16 v[184:185], v236
    ds_read_b64_tr_b16 v[186:187], v237
    ds_read_u16 v251, v249 offset:128
    ds_read_u16 v252, v249 offset:192
    v_rcp_f32 v188, v188
    v_mfma_f32_16x16x32_bf16 v[228:231], v[176:179], v[92:95], 0
    s_ashr_i32 s96, s96, 24
    s_mul_i32 s96, s96, s101
    v_rcp_f32 v189, v189
    v_mfma_f32_16x16x32_bf16 v[224:227], v[180:183], v[88:91], 0
    v_rcp_f32 v190, v190
    v_mfma_f32_16x16x32_bf16 v[232:235], v[180:183], v[92:95], 0
    v_rcp_f32 v191, v191
    v_mfma_f32_16x16x32_bf16 v[220:223], v[160:163], v[16:19], v[220:223]
    v_rcp_f32 v192, v192
    v_mfma_f32_16x16x32_bf16 v[228:231], v[160:163], v[24:27], v[228:231]
    v_rcp_f32 v193, v193
    v_mfma_f32_16x16x32_bf16 v[224:227], v[168:171], v[16:19], v[224:227]
    s_waitcnt lgkmcnt(0)
    v_bfi_b32 v251, 31, v245, v251
    v_bfi_b32 v252, 31, v245, v252
    v_max_u32 v251, v251, v245
    v_max_u32 v252, v252, v253
    ds_read_b128 v[236:239], v247 offset:1280
    ds_read_b32 v240, v248 offset:1280
    s_add_u32 s16, s16, 1
    v_rcp_f32 v194, v194
    v_mfma_f32_16x16x32_bf16 v[232:235], v[168:171], v[24:27], v[232:235]
    v_add_u32 v247, 0x80, v247
    v_add_u32 v248, 0x80, v248
    v_add_u32 v249, 0x80, v249
    v_add_u32 v250, 0x80, v250
    v_rcp_f32 v195, v195
    v_mfma_f32_16x16x32_bf16 v[220:223], v[164:167], v[20:23], v[220:223]
    v_rcp_f32 v196, v196
    v_mfma_f32_16x16x32_bf16 v[228:231], v[164:167], v[28:31], v[228:231]
    v_rcp_f32 v197, v197
    s_setprio 3
    v_mfma_f32_16x16x32_bf16 v[224:227], v[172:175], v[20:23], v[224:227]
    v_rcp_f32 v198, v198
    v_mfma_f32_16x16x32_bf16 v[232:235], v[172:175], v[28:31], v[232:235]
    v_rcp_f32 v199, v199
    v_rcp_f32 v200, v200
    v_rcp_f32 v201, v201
    v_rcp_f32 v202, v202
    v_rcp_f32 v203, v203
    v_pk_mul_f32 v[204:205], v[188:189], v[204:205]
    v_pk_mul_f32 v[206:207], v[190:191], v[206:207]
    v_pk_mul_f32 v[208:209], v[192:193], v[208:209]
    v_pk_mul_f32 v[210:211], v[194:195], v[210:211]
    v_pk_mul_f32 v[212:213], v[196:197], v[212:213]
    v_pk_mul_f32 v[214:215], v[198:199], v[214:215]
    v_pk_mul_f32 v[216:217], v[200:201], v[216:217]
    v_pk_mul_f32 v[218:219], v[202:203], v[218:219]
    s_cmp_ge_i32 s96, 1
    s_cbranch_scc1 L_PB11
L_PB10:
    s_setprio 0
    v_smfmac_f32_16x16x64_bf16 v[144:147], v[184:187], v[204:211], v242
    v_exp_f32 v220, v220
    v_smfmac_f32_16x16x64_bf16 v[148:151], v[184:187], v[212:219], v242
    v_exp_f32 v221, v221
    s_waitcnt vmcnt(0)
    ds_read_b128 v[176:179], v251
    ds_read_b128 v[180:183], v252
    v_mfma_f32_16x16x32_bf16 v[204:207], v[160:163], v[48:51], 0
    v_exp_f32 v222, v222
    v_mfma_f32_16x16x32_bf16 v[212:215], v[160:163], v[56:59], 0
    ds_read_b128 v[160:163], v244 offset:0
    v_exp_f32 v223, v223
    v_mfma_f32_16x16x32_bf16 v[208:211], v[168:171], v[48:51], 0
    v_exp_f32 v224, v224
    v_mfma_f32_16x16x32_bf16 v[216:219], v[168:171], v[56:59], 0
    ds_read_b128 v[168:171], v244 offset:512
    v_exp_f32 v225, v225
    v_mfma_f32_16x16x32_bf16 v[204:207], v[164:167], v[52:55], v[204:207]
    v_exp_f32 v226, v226
    v_mfma_f32_16x16x32_bf16 v[212:215], v[164:167], v[60:63], v[212:215]
    ds_read_b128 v[164:167], v244 offset:64
    v_exp_f32 v227, v227
    v_mfma_f32_16x16x32_bf16 v[208:211], v[172:175], v[52:55], v[208:211]
    v_exp_f32 v228, v228
    v_mfma_f32_16x16x32_bf16 v[216:219], v[172:175], v[60:63], v[216:219]
    ds_read_b128 v[172:175], v244 offset:576
    v_exp_f32 v229, v229
    s_setprio 3
    v_smfmac_f32_16x16x64_bf16 v[128:131], v[184:187], v[188:195], v242
    v_exp_f32 v230, v230
    v_smfmac_f32_16x16x64_bf16 v[132:135], v[184:187], v[196:203], v242
    v_exp_f32 v231, v231
    v_exp_f32 v232, v232
    v_exp_f32 v233, v233
    v_exp_f32 v234, v234
    v_exp_f32 v235, v235
    v_pk_add_f32 v[220:221], v[220:221], 1.0 op_sel_hi:[1,0]
    v_pk_add_f32 v[222:223], v[222:223], 1.0 op_sel_hi:[1,0]
    v_pk_add_f32 v[224:225], v[224:225], 1.0 op_sel_hi:[1,0]
    v_pk_add_f32 v[226:227], v[226:227], 1.0 op_sel_hi:[1,0]
    v_pk_add_f32 v[228:229], v[228:229], 1.0 op_sel_hi:[1,0]
    v_pk_add_f32 v[230:231], v[230:231], 1.0 op_sel_hi:[1,0]
    v_pk_add_f32 v[232:233], v[232:233], 1.0 op_sel_hi:[1,0]
    v_pk_add_f32 v[234:235], v[234:235], 1.0 op_sel_hi:[1,0]
    s_setprio 0
    s_waitcnt lgkmcnt(4)
    v_mfma_f32_16x16x32_bf16 v[188:191], v[176:179], v[64:67], 0
    v_rcp_f32 v220, v220
    v_mfma_f32_16x16x32_bf16 v[196:199], v[176:179], v[68:71], 0
    v_rcp_f32 v221, v221
    v_mfma_f32_16x16x32_bf16 v[192:195], v[180:183], v[64:67], 0
    v_rcp_f32 v222, v222
    v_mfma_f32_16x16x32_bf16 v[200:203], v[180:183], v[68:71], 0
    v_rcp_f32 v223, v223
    s_waitcnt lgkmcnt(3)
    v_mfma_f32_16x16x32_bf16 v[188:191], v[160:163], v[0:3], v[188:191]
    v_rcp_f32 v224, v224
    v_mfma_f32_16x16x32_bf16 v[196:199], v[160:163], v[8:11], v[196:199]
    v_rcp_f32 v225, v225
    s_waitcnt lgkmcnt(2)
    v_mfma_f32_16x16x32_bf16 v[192:195], v[168:171], v[0:3], v[192:195]
    v_rcp_f32 v226, v226
    v_mfma_f32_16x16x32_bf16 v[200:203], v[168:171], v[8:11], v[200:203]
    v_rcp_f32 v227, v227
    s_waitcnt lgkmcnt(1)
    v_mfma_f32_16x16x32_bf16 v[188:191], v[164:167], v[4:7], v[188:191]
    v_rcp_f32 v228, v228
    v_mfma_f32_16x16x32_bf16 v[196:199], v[164:167], v[12:15], v[196:199]
    v_rcp_f32 v229, v229
    s_setprio 3
    s_waitcnt lgkmcnt(0)
    v_mfma_f32_16x16x32_bf16 v[192:195], v[172:175], v[4:7], v[192:195]
    s_cmp_lt_u32 s16, s17
    s_cbranch_scc0 L_ND10
    s_add_u32 m0, s13, 0
    v_mad_u32_u16 v236, v236, s15, v243
    buffer_load_dwordx4 v236, s[40:43], 0 offen lds
    s_add_u32 m0, s13, 1056
    v_mad_u32_u16 v237, v237, s15, v243
    buffer_load_dwordx4 v237, s[40:43], 0 offen lds
    s_add_u32 m0, s13, 2112
    v_mad_u32_u16 v238, v238, s15, v243
    buffer_load_dwordx4 v238, s[40:43], 0 offen lds
    s_add_u32 m0, s13, 3168
    v_mad_u32_u16 v239, v239, s15, v243
    buffer_load_dwordx4 v239, s[40:43], 0 offen lds
    s_mov_b32 m0, s14
    v_and_b32 v240, 0xfffff, v240
    buffer_load_dwordx4 v[240:241], s[44:47], 0 idxen offen lds
L_ND10:
    v_rcp_f32 v230, v230
    v_mfma_f32_16x16x32_bf16 v[200:203], v[172:175], v[12:15], v[200:203]
    v_rcp_f32 v231, v231
    v_rcp_f32 v232, v232
    v_rcp_f32 v233, v233
    v_rcp_f32 v234, v234
    v_rcp_f32 v235, v235
    v_pk_mul_f32 v[204:205], v[220:221], v[204:205]
    v_pk_mul_f32 v[206:207], v[222:223], v[206:207]
    v_pk_mul_f32 v[208:209], v[224:225], v[208:209]
    v_pk_mul_f32 v[210:211], v[226:227], v[210:211]
    v_pk_mul_f32 v[212:213], v[228:229], v[212:213]
    v_pk_mul_f32 v[214:215], v[230:231], v[214:215]
    v_pk_mul_f32 v[216:217], v[232:233], v[216:217]
    v_pk_mul_f32 v[218:219], v[234:235], v[218:219]
    s_cmp_lt_u32 s16, s17
    s_cbranch_scc1 L_LOOP0
L_LT0:
    s_cmp_lg_u32 s99, 0
    s_cbranch_scc1 L_LH0
    s_setprio 0
    v_smfmac_f32_16x16x64_bf16 v[152:155], v[184:187], v[204:211], v242
    ds_read_u16 v236, v250 offset:0
    ds_read_u16 v237, v250 offset:16
    v_exp_f32 v188, v188
    v_smfmac_f32_16x16x64_bf16 v[156:159], v[184:187], v[212:219], v242
    v_exp_f32 v189, v189
    v_mfma_f32_16x16x32_bf16 v[204:207], v[160:163], v[32:35], 0
    v_exp_f32 v190, v190
    v_mfma_f32_16x16x32_bf16 v[212:215], v[160:163], v[40:43], 0
    v_exp_f32 v191, v191
    v_mfma_f32_16x16x32_bf16 v[208:211], v[168:171], v[32:35], 0
    v_exp_f32 v192, v192
    v_mfma_f32_16x16x32_bf16 v[216:219], v[168:171], v[40:43], 0
    v_exp_f32 v193, v193
    v_mfma_f32_16x16x32_bf16 v[204:207], v[164:167], v[36:39], v[204:207]
    v_exp_f32 v194, v194
    v_mfma_f32_16x16x32_bf16 v[212:215], v[164:167], v[44:47], v[212:215]
    v_exp_f32 v195, v195
    v_mfma_f32_16x16x32_bf16 v[208:211], v[172:175], v[36:39], v[208:211]
    v_exp_f32 v196, v196
    v_mfma_f32_16x16x32_bf16 v[216:219], v[172:175], v[44:47], v[216:219]
    v_exp_f32 v197, v197
    v_smfmac_f32_16x16x64_bf16 v[136:139], v[184:187], v[220:227], v242
    s_waitcnt lgkmcnt(0)
    v_bfi_b32 v236, 31, v246, v236
    v_bfi_b32 v237, 31, v246, v237
    v_exp_f32 v198, v198
    s_setprio 3
    v_smfmac_f32_16x16x64_bf16 v[140:143], v[184:187], v[228:235], v242
    v_exp_f32 v199, v199
    v_exp_f32 v200, v200
    v_exp_f32 v201, v201
    v_exp_f32 v202, v202
    v_exp_f32 v203, v203
    v_pk_add_f32 v[188:189], v[188:189], 1.0 op_sel_hi:[1,0]
    v_pk_add_f32 v[190:191], v[190:191], 1.0 op_sel_hi:[1,0]
    v_pk_add_f32 v[192:193], v[192:193], 1.0 op_sel_hi:[1,0]
    v_pk_add_f32 v[194:195], v[194:195], 1.0 op_sel_hi:[1,0]
    v_pk_add_f32 v[196:197], v[196:197], 1.0 op_sel_hi:[1,0]
    v_pk_add_f32 v[198:199], v[198:199], 1.0 op_sel_hi:[1,0]
    v_pk_add_f32 v[200:201], v[200:201], 1.0 op_sel_hi:[1,0]
    v_pk_add_f32 v[202:203], v[202:203], 1.0 op_sel_hi:[1,0]
    s_setprio 0
    v_mfma_f32_16x16x32_bf16 v[220:223], v[176:179], v[72:75], 0
    ds_read_b64_tr_b16 v[184:185], v236
    ds_read_b64_tr_b16 v[186:187], v237
    v_rcp_f32 v188, v188
    v_mfma_f32_16x16x32_bf16 v[228:231], v[176:179], v[76:79], 0
    v_rcp_f32 v189, v189
    v_mfma_f32_16x16x32_bf16 v[224:227], v[180:183], v[72:75], 0
    v_rcp_f32 v190, v190
    v_mfma_f32_16x16x32_bf16 v[232:235], v[180:183], v[76:79], 0
    v_rcp_f32 v191, v191
    v_mfma_f32_16x16x32_bf16 v[220:223], v[160:163], v[16:19], v[220:223]
    v_rcp_f32 v192, v192
    v_mfma_f32_16x16x32_bf16 v[228:231], v[160:163], v[24:27], v[228:231]
    v_rcp_f32 v193, v193
    v_mfma_f32_16x16x32_bf16 v[224:227], v[168:171], v[16:19], v[224:227]
    v_rcp_f32 v194, v194
    v_mfma_f32_16x16x32_bf16 v[232:235], v[168:171], v[24:27], v[232:235]
    v_rcp_f32 v195, v195
    v_mfma_f32_16x16x32_bf16 v[220:223], v[164:167], v[20:23], v[220:223]
    v_rcp_f32 v196, v196
    v_mfma_f32_16x16x32_bf16 v[228:231], v[164:167], v[28:31], v[228:231]
    v_rcp_f32 v197, v197
    v_mfma_f32_16x16x32_bf16 v[224:227], v[172:175], v[20:23], v[224:227]
    v_rcp_f32 v198, v198
    s_setprio 3
    v_mfma_f32_16x16x32_bf16 v[232:235], v[172:175], v[28:31], v[232:235]
    v_rcp_f32 v199, v199
    v_rcp_f32 v200, v200
    v_rcp_f32 v201, v201
    v_rcp_f32 v202, v202
    v_rcp_f32 v203, v203
    v_pk_mul_f32 v[204:205], v[188:189], v[204:205]
    v_pk_mul_f32 v[206:207], v[190:191], v[206:207]
    v_pk_mul_f32 v[208:209], v[192:193], v[208:209]
    v_pk_mul_f32 v[210:211], v[194:195], v[210:211]
    v_pk_mul_f32 v[212:213], v[196:197], v[212:213]
    v_pk_mul_f32 v[214:215], v[198:199], v[214:215]
    v_pk_mul_f32 v[216:217], v[200:201], v[216:217]
    v_pk_mul_f32 v[218:219], v[202:203], v[218:219]
    s_setprio 0
    s_waitcnt lgkmcnt(0)
    v_smfmac_f32_16x16x64_bf16 v[112:115], v[184:187], v[204:211], v242
    v_exp_f32 v220, v220
    v_smfmac_f32_16x16x64_bf16 v[116:119], v[184:187], v[212:219], v242
    v_exp_f32 v221, v221
    v_mfma_f32_16x16x32_bf16 v[204:207], v[160:163], v[48:51], 0
    v_exp_f32 v222, v222
    v_mfma_f32_16x16x32_bf16 v[212:215], v[160:163], v[56:59], 0
    v_exp_f32 v223, v223
    v_mfma_f32_16x16x32_bf16 v[208:211], v[168:171], v[48:51], 0
    v_exp_f32 v224, v224
    v_mfma_f32_16x16x32_bf16 v[216:219], v[168:171], v[56:59], 0
    v_exp_f32 v225, v225
    v_mfma_f32_16x16x32_bf16 v[204:207], v[164:167], v[52:55], v[204:207]
    v_exp_f32 v226, v226
    v_mfma_f32_16x16x32_bf16 v[212:215], v[164:167], v[60:63], v[212:215]
    v_exp_f32 v227, v227
    v_mfma_f32_16x16x32_bf16 v[208:211], v[172:175], v[52:55], v[208:211]
    v_exp_f32 v228, v228
    v_mfma_f32_16x16x32_bf16 v[216:219], v[172:175], v[60:63], v[216:219]
    v_exp_f32 v229, v229
    v_smfmac_f32_16x16x64_bf16 v[96:99], v[184:187], v[188:195], v242
    v_exp_f32 v230, v230
    s_setprio 3
    v_smfmac_f32_16x16x64_bf16 v[100:103], v[184:187], v[196:203], v242
    v_exp_f32 v231, v231
    v_exp_f32 v232, v232
    v_exp_f32 v233, v233
    v_exp_f32 v234, v234
    v_exp_f32 v235, v235
    v_pk_add_f32 v[220:221], v[220:221], 1.0 op_sel_hi:[1,0]
    v_pk_add_f32 v[222:223], v[222:223], 1.0 op_sel_hi:[1,0]
    v_pk_add_f32 v[224:225], v[224:225], 1.0 op_sel_hi:[1,0]
    v_pk_add_f32 v[226:227], v[226:227], 1.0 op_sel_hi:[1,0]
    v_pk_add_f32 v[228:229], v[228:229], 1.0 op_sel_hi:[1,0]
    v_pk_add_f32 v[230:231], v[230:231], 1.0 op_sel_hi:[1,0]
    v_pk_add_f32 v[232:233], v[232:233], 1.0 op_sel_hi:[1,0]
    v_pk_add_f32 v[234:235], v[234:235], 1.0 op_sel_hi:[1,0]
    s_setprio 0
    v_rcp_f32 v220, v220
    v_rcp_f32 v221, v221
    v_rcp_f32 v222, v222
    v_rcp_f32 v223, v223
    v_rcp_f32 v224, v224
    v_rcp_f32 v225, v225
    v_rcp_f32 v226, v226
    v_rcp_f32 v227, v227
    v_rcp_f32 v228, v228
    v_rcp_f32 v229, v229
    v_rcp_f32 v230, v230
    v_rcp_f32 v231, v231
    v_rcp_f32 v232, v232
    v_rcp_f32 v233, v233
    v_rcp_f32 v234, v234
    v_rcp_f32 v235, v235
    v_pk_mul_f32 v[204:205], v[220:221], v[204:205]
    v_pk_mul_f32 v[206:207], v[222:223], v[206:207]
    v_pk_mul_f32 v[208:209], v[224:225], v[208:209]
    v_pk_mul_f32 v[210:211], v[226:227], v[210:211]
    v_pk_mul_f32 v[212:213], v[228:229], v[212:213]
    v_pk_mul_f32 v[214:215], v[230:231], v[214:215]
    v_pk_mul_f32 v[216:217], v[232:233], v[216:217]
    v_pk_mul_f32 v[218:219], v[234:235], v[218:219]
    v_smfmac_f32_16x16x64_bf16 v[104:107], v[184:187], v[220:227], v242
    v_smfmac_f32_16x16x64_bf16 v[108:111], v[184:187], v[228:235], v242
    v_smfmac_f32_16x16x64_bf16 v[120:123], v[184:187], v[204:211], v242
    v_smfmac_f32_16x16x64_bf16 v[124:127], v[184:187], v[212:219], v242
    s_branch L_DONE
L_LH0:
    s_setprio 0
    v_smfmac_f32_16x16x64_bf16 v[152:155], v[184:187], v[204:211], v242
    ds_read_u16 v236, v250 offset:0
    ds_read_u16 v237, v250 offset:16
    v_smfmac_f32_16x16x64_bf16 v[156:159], v[184:187], v[212:219], v242
    v_exp_f32 v188, v188
    v_mfma_f32_16x16x32_bf16 v[204:207], v[160:163], v[32:35], 0
    v_mfma_f32_16x16x32_bf16 v[212:215], v[160:163], v[40:43], 0
    v_exp_f32 v189, v189
    v_mfma_f32_16x16x32_bf16 v[204:207], v[164:167], v[36:39], v[204:207]
    v_mfma_f32_16x16x32_bf16 v[212:215], v[164:167], v[44:47], v[212:215]
    v_exp_f32 v190, v190
    v_smfmac_f32_16x16x64_bf16 v[136:139], v[184:187], v[220:227], v242
    s_waitcnt lgkmcnt(0)
    v_bfi_b32 v236, 31, v246, v236
    v_bfi_b32 v237, 31, v246, v237
    v_exp_f32 v191, v191
    s_setprio 3
    v_smfmac_f32_16x16x64_bf16 v[140:143], v[184:187], v[228:235], v242
    v_exp_f32 v196, v196
    v_exp_f32 v197, v197
    v_exp_f32 v198, v198
    v_exp_f32 v199, v199
    v_pk_add_f32 v[188:189], v[188:189], 1.0 op_sel_hi:[1,0]
    v_pk_add_f32 v[190:191], v[190:191], 1.0 op_sel_hi:[1,0]
    v_pk_add_f32 v[196:197], v[196:197], 1.0 op_sel_hi:[1,0]
    v_pk_add_f32 v[198:199], v[198:199], 1.0 op_sel_hi:[1,0]
    s_setprio 0
    v_mfma_f32_16x16x32_bf16 v[220:223], v[176:179], v[72:75], 0
    ds_read_b64_tr_b16 v[184:185], v236
    ds_read_b64_tr_b16 v[186:187], v237
    v_mfma_f32_16x16x32_bf16 v[228:231], v[176:179], v[76:79], 0
    v_rcp_f32 v188, v188
    v_mfma_f32_16x16x32_bf16 v[220:223], v[160:163], v[16:19], v[220:223]
    v_rcp_f32 v189, v189
    v_mfma_f32_16x16x32_bf16 v[228:231], v[160:163], v[24:27], v[228:231]
    v_rcp_f32 v190, v190
    v_mfma_f32_16x16x32_bf16 v[220:223], v[164:167], v[20:23], v[220:223]
    v_rcp_f32 v191, v191
    s_setprio 3
    v_mfma_f32_16x16x32_bf16 v[228:231], v[164:167], v[28:31], v[228:231]
    v_rcp_f32 v196, v196
    v_rcp_f32 v197, v197
    v_rcp_f32 v198, v198
    v_rcp_f32 v199, v199
    v_pk_mul_f32 v[204:205], v[188:189], v[204:205]
    v_pk_mul_f32 v[206:207], v[190:191], v[206:207]
    v_pk_mul_f32 v[212:213], v[196:197], v[212:213]
    v_pk_mul_f32 v[214:215], v[198:199], v[214:215]
    s_setprio 0
    s_waitcnt lgkmcnt(0)
    v_smfmac_f32_16x16x64_bf16 v[112:115], v[184:187], v[204:211], v242
    v_smfmac_f32_16x16x64_bf16 v[116:119], v[184:187], v[212:219], v242
    v_exp_f32 v220, v220
    v_mfma_f32_16x16x32_bf16 v[204:207], v[160:163], v[48:51], 0
    v_mfma_f32_16x16x32_bf16 v[212:215], v[160:163], v[56:59], 0
    v_exp_f32 v221, v221
    v_mfma_f32_16x16x32_bf16 v[204:207], v[164:167], v[52:55], v[204:207]
    v_mfma_f32_16x16x32_bf16 v[212:215], v[164:167], v[60:63], v[212:215]
    v_exp_f32 v222, v222
    v_smfmac_f32_16x16x64_bf16 v[96:99], v[184:187], v[188:195], v242
    v_exp_f32 v223, v223
    s_setprio 3
    v_smfmac_f32_16x16x64_bf16 v[100:103], v[184:187], v[196:203], v242
    v_exp_f32 v228, v228
    v_exp_f32 v229, v229
    v_exp_f32 v230, v230
    v_exp_f32 v231, v231
    v_pk_add_f32 v[220:221], v[220:221], 1.0 op_sel_hi:[1,0]
    v_pk_add_f32 v[222:223], v[222:223], 1.0 op_sel_hi:[1,0]
    v_pk_add_f32 v[228:229], v[228:229], 1.0 op_sel_hi:[1,0]
    v_pk_add_f32 v[230:231], v[230:231], 1.0 op_sel_hi:[1,0]
    s_setprio 0
    v_rcp_f32 v220, v220
    v_rcp_f32 v221, v221
    v_rcp_f32 v222, v222
    v_rcp_f32 v223, v223
    v_rcp_f32 v228, v228
    v_rcp_f32 v229, v229
    v_rcp_f32 v230, v230
    v_rcp_f32 v231, v231
    v_pk_mul_f32 v[204:205], v[220:221], v[204:205]
    v_pk_mul_f32 v[206:207], v[222:223], v[206:207]
    v_pk_mul_f32 v[212:213], v[228:229], v[212:213]
    v_pk_mul_f32 v[214:215], v[230:231], v[214:215]
    v_smfmac_f32_16x16x64_bf16 v[104:107], v[184:187], v[220:227], v242
    v_smfmac_f32_16x16x64_bf16 v[108:111], v[184:187], v[228:235], v242
    v_smfmac_f32_16x16x64_bf16 v[120:123], v[184:187], v[204:211], v242
    v_smfmac_f32_16x16x64_bf16 v[124:127], v[184:187], v[212:219], v242
    s_branch L_DONE
L_LT1:
    s_cmp_lg_u32 s99, 0
    s_cbranch_scc1 L_LH1
    s_setprio 0
    v_smfmac_f32_16x16x64_bf16 v[120:123], v[184:187], v[204:211], v242
    ds_read_u16 v236, v250 offset:1152
    ds_read_u16 v237, v250 offset:1168
    v_exp_f32 v188, v188
    v_smfmac_f32_16x16x64_bf16 v[124:127], v[184:187], v[212:219], v242
    v_exp_f32 v189, v189
    v_mfma_f32_16x16x32_bf16 v[204:207], v[160:163], v[32:35], 0
    v_exp_f32 v190, v190
    v_mfma_f32_16x16x32_bf16 v[212:215], v[160:163], v[40:43], 0
    v_exp_f32 v191, v191
    v_mfma_f32_16x16x32_bf16 v[208:211], v[168:171], v[32:35], 0
    v_exp_f32 v192, v192
    v_mfma_f32_16x16x32_bf16 v[216:219], v[168:171], v[40:43], 0
    v_exp_f32 v193, v193
    v_mfma_f32_16x16x32_bf16 v[204:207], v[164:167], v[36:39], v[204:207]
    v_exp_f32 v194, v194
    v_mfma_f32_16x16x32_bf16 v[212:215], v[164:167], v[44:47], v[212:215]
    v_exp_f32 v195, v195
    v_mfma_f32_16x16x32_bf16 v[208:211], v[172:175], v[36:39], v[208:211]
    v_exp_f32 v196, v196
    v_mfma_f32_16x16x32_bf16 v[216:219], v[172:175], v[44:47], v[216:219]
    v_exp_f32 v197, v197
    v_smfmac_f32_16x16x64_bf16 v[104:107], v[184:187], v[220:227], v242
    s_waitcnt lgkmcnt(0)
    v_bfi_b32 v236, 31, v246, v236
    v_bfi_b32 v237, 31, v246, v237
    v_exp_f32 v198, v198
    s_setprio 3
    v_smfmac_f32_16x16x64_bf16 v[108:111], v[184:187], v[228:235], v242
    v_exp_f32 v199, v199
    v_exp_f32 v200, v200
    v_exp_f32 v201, v201
    v_exp_f32 v202, v202
    v_exp_f32 v203, v203
    v_pk_add_f32 v[188:189], v[188:189], 1.0 op_sel_hi:[1,0]
    v_pk_add_f32 v[190:191], v[190:191], 1.0 op_sel_hi:[1,0]
    v_pk_add_f32 v[192:193], v[192:193], 1.0 op_sel_hi:[1,0]
    v_pk_add_f32 v[194:195], v[194:195], 1.0 op_sel_hi:[1,0]
    v_pk_add_f32 v[196:197], v[196:197], 1.0 op_sel_hi:[1,0]
    v_pk_add_f32 v[198:199], v[198:199], 1.0 op_sel_hi:[1,0]
    v_pk_add_f32 v[200:201], v[200:201], 1.0 op_sel_hi:[1,0]
    v_pk_add_f32 v[202:203], v[202:203], 1.0 op_sel_hi:[1,0]
    s_setprio 0
    v_mfma_f32_16x16x32_bf16 v[220:223], v[176:179], v[88:91], 0
    ds_read_b64_tr_b16 v[184:185], v236
    ds_read_b64_tr_b16 v[186:187], v237
    v_rcp_f32 v188, v188
    v_mfma_f32_16x16x32_bf16 v[228:231], v[176:179], v[92:95], 0
    v_rcp_f32 v189, v189
    v_mfma_f32_16x16x32_bf16 v[224:227], v[180:183], v[88:91], 0
    v_rcp_f32 v190, v190
    v_mfma_f32_16x16x32_bf16 v[232:235], v[180:183], v[92:95], 0
    v_rcp_f32 v191, v191
    v_mfma_f32_16x16x32_bf16 v[220:223], v[160:163], v[16:19], v[220:223]
    v_rcp_f32 v192, v192
    v_mfma_f32_16x16x32_bf16 v[228:231], v[160:163], v[24:27], v[228:231]
    v_rcp_f32 v193, v193
    v_mfma_f32_16x16x32_bf16 v[224:227], v[168:171], v[16:19], v[224:227]
    v_rcp_f32 v194, v194
    v_mfma_f32_16x16x32_bf16 v[232:235], v[168:171], v[24:27], v[232:235]
    v_rcp_f32 v195, v195
    v_mfma_f32_16x16x32_bf16 v[220:223], v[164:167], v[20:23], v[220:223]
    v_rcp_f32 v196, v196
    v_mfma_f32_16x16x32_bf16 v[228:231], v[164:167], v[28:31], v[228:231]
    v_rcp_f32 v197, v197
    v_mfma_f32_16x16x32_bf16 v[224:227], v[172:175], v[20:23], v[224:227]
    v_rcp_f32 v198, v198
    s_setprio 3
    v_mfma_f32_16x16x32_bf16 v[232:235], v[172:175], v[28:31], v[232:235]
    v_rcp_f32 v199, v199
    v_rcp_f32 v200, v200
    v_rcp_f32 v201, v201
    v_rcp_f32 v202, v202
    v_rcp_f32 v203, v203
    v_pk_mul_f32 v[204:205], v[188:189], v[204:205]
    v_pk_mul_f32 v[206:207], v[190:191], v[206:207]
    v_pk_mul_f32 v[208:209], v[192:193], v[208:209]
    v_pk_mul_f32 v[210:211], v[194:195], v[210:211]
    v_pk_mul_f32 v[212:213], v[196:197], v[212:213]
    v_pk_mul_f32 v[214:215], v[198:199], v[214:215]
    v_pk_mul_f32 v[216:217], v[200:201], v[216:217]
    v_pk_mul_f32 v[218:219], v[202:203], v[218:219]
    s_setprio 0
    s_waitcnt lgkmcnt(0)
    v_smfmac_f32_16x16x64_bf16 v[144:147], v[184:187], v[204:211], v242
    v_exp_f32 v220, v220
    v_smfmac_f32_16x16x64_bf16 v[148:151], v[184:187], v[212:219], v242
    v_exp_f32 v221, v221
    v_mfma_f32_16x16x32_bf16 v[204:207], v[160:163], v[48:51], 0
    v_exp_f32 v222, v222
    v_mfma_f32_16x16x32_bf16 v[212:215], v[160:163], v[56:59], 0
    v_exp_f32 v223, v223
    v_mfma_f32_16x16x32_bf16 v[208:211], v[168:171], v[48:51], 0
    v_exp_f32 v224, v224
    v_mfma_f32_16x16x32_bf16 v[216:219], v[168:171], v[56:59], 0
    v_exp_f32 v225, v225
    v_mfma_f32_16x16x32_bf16 v[204:207], v[164:167], v[52:55], v[204:207]
    v_exp_f32 v226, v226
    v_mfma_f32_16x16x32_bf16 v[212:215], v[164:167], v[60:63], v[212:215]
    v_exp_f32 v227, v227
    v_mfma_f32_16x16x32_bf16 v[208:211], v[172:175], v[52:55], v[208:211]
    v_exp_f32 v228, v228
    v_mfma_f32_16x16x32_bf16 v[216:219], v[172:175], v[60:63], v[216:219]
    v_exp_f32 v229, v229
    v_smfmac_f32_16x16x64_bf16 v[128:131], v[184:187], v[188:195], v242
    v_exp_f32 v230, v230
    s_setprio 3
    v_smfmac_f32_16x16x64_bf16 v[132:135], v[184:187], v[196:203], v242
    v_exp_f32 v231, v231
    v_exp_f32 v232, v232
    v_exp_f32 v233, v233
    v_exp_f32 v234, v234
    v_exp_f32 v235, v235
    v_pk_add_f32 v[220:221], v[220:221], 1.0 op_sel_hi:[1,0]
    v_pk_add_f32 v[222:223], v[222:223], 1.0 op_sel_hi:[1,0]
    v_pk_add_f32 v[224:225], v[224:225], 1.0 op_sel_hi:[1,0]
    v_pk_add_f32 v[226:227], v[226:227], 1.0 op_sel_hi:[1,0]
    v_pk_add_f32 v[228:229], v[228:229], 1.0 op_sel_hi:[1,0]
    v_pk_add_f32 v[230:231], v[230:231], 1.0 op_sel_hi:[1,0]
    v_pk_add_f32 v[232:233], v[232:233], 1.0 op_sel_hi:[1,0]
    v_pk_add_f32 v[234:235], v[234:235], 1.0 op_sel_hi:[1,0]
    s_setprio 0
    v_rcp_f32 v220, v220
    v_rcp_f32 v221, v221
    v_rcp_f32 v222, v222
    v_rcp_f32 v223, v223
    v_rcp_f32 v224, v224
    v_rcp_f32 v225, v225
    v_rcp_f32 v226, v226
    v_rcp_f32 v227, v227
    v_rcp_f32 v228, v228
    v_rcp_f32 v229, v229
    v_rcp_f32 v230, v230
    v_rcp_f32 v231, v231
    v_rcp_f32 v232, v232
    v_rcp_f32 v233, v233
    v_rcp_f32 v234, v234
    v_rcp_f32 v235, v235
    v_pk_mul_f32 v[204:205], v[220:221], v[204:205]
    v_pk_mul_f32 v[206:207], v[222:223], v[206:207]
    v_pk_mul_f32 v[208:209], v[224:225], v[208:209]
    v_pk_mul_f32 v[210:211], v[226:227], v[210:211]
    v_pk_mul_f32 v[212:213], v[228:229], v[212:213]
    v_pk_mul_f32 v[214:215], v[230:231], v[214:215]
    v_pk_mul_f32 v[216:217], v[232:233], v[216:217]
    v_pk_mul_f32 v[218:219], v[234:235], v[218:219]
    v_smfmac_f32_16x16x64_bf16 v[136:139], v[184:187], v[220:227], v242
    v_smfmac_f32_16x16x64_bf16 v[140:143], v[184:187], v[228:235], v242
    v_smfmac_f32_16x16x64_bf16 v[152:155], v[184:187], v[204:211], v242
    v_smfmac_f32_16x16x64_bf16 v[156:159], v[184:187], v[212:219], v242
    s_branch L_DONE
L_LH1:
    s_setprio 0
    v_smfmac_f32_16x16x64_bf16 v[120:123], v[184:187], v[204:211], v242
    ds_read_u16 v236, v250 offset:1152
    ds_read_u16 v237, v250 offset:1168
    v_smfmac_f32_16x16x64_bf16 v[124:127], v[184:187], v[212:219], v242
    v_exp_f32 v188, v188
    v_mfma_f32_16x16x32_bf16 v[204:207], v[160:163], v[32:35], 0
    v_mfma_f32_16x16x32_bf16 v[212:215], v[160:163], v[40:43], 0
    v_exp_f32 v189, v189
    v_mfma_f32_16x16x32_bf16 v[204:207], v[164:167], v[36:39], v[204:207]
    v_mfma_f32_16x16x32_bf16 v[212:215], v[164:167], v[44:47], v[212:215]
    v_exp_f32 v190, v190
    v_smfmac_f32_16x16x64_bf16 v[104:107], v[184:187], v[220:227], v242
    s_waitcnt lgkmcnt(0)
    v_bfi_b32 v236, 31, v246, v236
    v_bfi_b32 v237, 31, v246, v237
    v_exp_f32 v191, v191
    s_setprio 3
    v_smfmac_f32_16x16x64_bf16 v[108:111], v[184:187], v[228:235], v242
    v_exp_f32 v196, v196
    v_exp_f32 v197, v197
    v_exp_f32 v198, v198
    v_exp_f32 v199, v199
    v_pk_add_f32 v[188:189], v[188:189], 1.0 op_sel_hi:[1,0]
    v_pk_add_f32 v[190:191], v[190:191], 1.0 op_sel_hi:[1,0]
    v_pk_add_f32 v[196:197], v[196:197], 1.0 op_sel_hi:[1,0]
    v_pk_add_f32 v[198:199], v[198:199], 1.0 op_sel_hi:[1,0]
    s_setprio 0
    v_mfma_f32_16x16x32_bf16 v[220:223], v[176:179], v[88:91], 0
    ds_read_b64_tr_b16 v[184:185], v236
    ds_read_b64_tr_b16 v[186:187], v237
    v_mfma_f32_16x16x32_bf16 v[228:231], v[176:179], v[92:95], 0
    v_rcp_f32 v188, v188
    v_mfma_f32_16x16x32_bf16 v[220:223], v[160:163], v[16:19], v[220:223]
    v_rcp_f32 v189, v189
    v_mfma_f32_16x16x32_bf16 v[228:231], v[160:163], v[24:27], v[228:231]
    v_rcp_f32 v190, v190
    v_mfma_f32_16x16x32_bf16 v[220:223], v[164:167], v[20:23], v[220:223]
    v_rcp_f32 v191, v191
    s_setprio 3
    v_mfma_f32_16x16x32_bf16 v[228:231], v[164:167], v[28:31], v[228:231]
    v_rcp_f32 v196, v196
    v_rcp_f32 v197, v197
    v_rcp_f32 v198, v198
    v_rcp_f32 v199, v199
    v_pk_mul_f32 v[204:205], v[188:189], v[204:205]
    v_pk_mul_f32 v[206:207], v[190:191], v[206:207]
    v_pk_mul_f32 v[212:213], v[196:197], v[212:213]
    v_pk_mul_f32 v[214:215], v[198:199], v[214:215]
    s_setprio 0
    s_waitcnt lgkmcnt(0)
    v_smfmac_f32_16x16x64_bf16 v[144:147], v[184:187], v[204:211], v242
    v_smfmac_f32_16x16x64_bf16 v[148:151], v[184:187], v[212:219], v242
    v_exp_f32 v220, v220
    v_mfma_f32_16x16x32_bf16 v[204:207], v[160:163], v[48:51], 0
    v_mfma_f32_16x16x32_bf16 v[212:215], v[160:163], v[56:59], 0
    v_exp_f32 v221, v221
    v_mfma_f32_16x16x32_bf16 v[204:207], v[164:167], v[52:55], v[204:207]
    v_mfma_f32_16x16x32_bf16 v[212:215], v[164:167], v[60:63], v[212:215]
    v_exp_f32 v222, v222
    v_smfmac_f32_16x16x64_bf16 v[128:131], v[184:187], v[188:195], v242
    v_exp_f32 v223, v223
    s_setprio 3
    v_smfmac_f32_16x16x64_bf16 v[132:135], v[184:187], v[196:203], v242
    v_exp_f32 v228, v228
    v_exp_f32 v229, v229
    v_exp_f32 v230, v230
    v_exp_f32 v231, v231
    v_pk_add_f32 v[220:221], v[220:221], 1.0 op_sel_hi:[1,0]
    v_pk_add_f32 v[222:223], v[222:223], 1.0 op_sel_hi:[1,0]
    v_pk_add_f32 v[228:229], v[228:229], 1.0 op_sel_hi:[1,0]
    v_pk_add_f32 v[230:231], v[230:231], 1.0 op_sel_hi:[1,0]
    s_setprio 0
    v_rcp_f32 v220, v220
    v_rcp_f32 v221, v221
    v_rcp_f32 v222, v222
    v_rcp_f32 v223, v223
    v_rcp_f32 v228, v228
    v_rcp_f32 v229, v229
    v_rcp_f32 v230, v230
    v_rcp_f32 v231, v231
    v_pk_mul_f32 v[204:205], v[220:221], v[204:205]
    v_pk_mul_f32 v[206:207], v[222:223], v[206:207]
    v_pk_mul_f32 v[212:213], v[228:229], v[212:213]
    v_pk_mul_f32 v[214:215], v[230:231], v[214:215]
    v_smfmac_f32_16x16x64_bf16 v[136:139], v[184:187], v[220:227], v242
    v_smfmac_f32_16x16x64_bf16 v[140:143], v[184:187], v[228:235], v242
    v_smfmac_f32_16x16x64_bf16 v[152:155], v[184:187], v[204:211], v242
    v_smfmac_f32_16x16x64_bf16 v[156:159], v[184:187], v[212:219], v242
L_DONE:
    v_mbcnt_lo_u32_b32 v253, -1, 0
    v_mbcnt_hi_u32_b32 v253, -1, v253
    s_cmp_lg_u32 s19, 0
    s_cbranch_scc1 L_SLOW
L_EPI:
    s_setprio 0
    v_and_b32 v64, 48, v253
    v_and_b32 v67, 15, v253
    v_add_u32 v69, s72, v64
    v_lshl_add_u32 v70, v67, 2, s72
    s_waitcnt lgkmcnt(0)
    ds_read_b128 v[80:83], v69 offset:0
    ds_read_b128 v[84:87], v69 offset:64
    ds_read2_b32 v[72:73], v70 offset0:0 offset1:16
    v_bfe_u32 v65, v253, 2, 3
    v_lshrrev_b32 v66, 5, v253
    v_lshl_add_u32 v65, v66, 4, v65
    v_mul_u32_u24 v65, 160, v65
    s_mov_b32 s10, 143488
    v_add3_u32 v65, v65, v246, s10
    ds_read_b64_tr_b16 v[0:1], v65 offset:0
    ds_read_b64_tr_b16 v[2:3], v65 offset:1280
    ds_read_b64_tr_b16 v[8:9], v65 offset:32
    ds_read_b64_tr_b16 v[10:11], v65 offset:1312
    ds_read_b64_tr_b16 v[16:17], v65 offset:64
    ds_read_b64_tr_b16 v[18:19], v65 offset:1344
    ds_read_b64_tr_b16 v[24:25], v65 offset:96
    ds_read_b64_tr_b16 v[26:27], v65 offset:1376
    s_movk_i32 s10, 832
    v_mad_u32_u24 v64, v246, s10, v64
    s_mov_b32 s10, 116736
    v_lshl_add_u32 v69, v67, 3, s10
    v_lshl_add_u32 v74, v67, 3, s73
    v_lshl_add_u32 v75, v67, 3, s74
    s_mov_b64 exec, s[76:77]
    s_and_b32 s11, s25, 19
    s_cmp_eq_u32 s11, 0
    s_cbranch_scc1 L_NS0
    s_cmp_eq_u32 s11, 1
    s_cbranch_scc1 L_NS1
    s_cmp_eq_u32 s11, 2
    s_cbranch_scc1 L_NS2
    s_cmp_eq_u32 s11, 3
    s_cbranch_scc1 L_NS3
L_NSR:
    s_mov_b64 exec, -1
    s_waitcnt lgkmcnt(8)
    v_add_u32 v76, v80, v69
    ds_read_b64 v[32:33], v76 offset:0
    v_add_u32 v76, v81, v69
    ds_read_b64 v[34:35], v76 offset:6656
    v_add_u32 v76, v82, v69
    ds_read_b64 v[36:37], v76 offset:13312
    v_add_u32 v76, v83, v69
    ds_read_b64 v[38:39], v76 offset:19968
    v_add_u32 v76, v84, v69
    ds_read_b64 v[40:41], v76 offset:0
    v_add_u32 v76, v85, v69
    ds_read_b64 v[42:43], v76 offset:6656
    v_add_u32 v76, v86, v69
    ds_read_b64 v[44:45], v76 offset:13312
    v_add_u32 v76, v87, v69
    ds_read_b64 v[46:47], v76 offset:19968
    v_add3_u32 v72, v72, v64, s10
    ds_read_b128 v[160:163], v72 offset:0
    ds_read_b128 v[164:167], v72 offset:64
    v_add3_u32 v73, v73, v64, s10
    ds_read_b128 v[168:171], v73 offset:0
    ds_read_b128 v[172:175], v73 offset:64
    ds_read_b64_tr_b16 v[4:5], v65 offset:5120
    ds_read_b64_tr_b16 v[6:7], v65 offset:6400
    ds_read_b64_tr_b16 v[12:13], v65 offset:5152
    ds_read_b64_tr_b16 v[14:15], v65 offset:6432
    ds_read_b64_tr_b16 v[20:21], v65 offset:5184
    ds_read_b64_tr_b16 v[22:23], v65 offset:6464
    ds_read_b64_tr_b16 v[28:29], v65 offset:5216
    ds_read_b64_tr_b16 v[30:31], v65 offset:6496
    v_rcp_f32 v128, v128
    v_rcp_f32 v129, v129
    v_rcp_f32 v130, v130
    v_rcp_f32 v131, v131
    v_rcp_f32 v132, v132
    v_rcp_f32 v133, v133
    v_rcp_f32 v134, v134
    v_rcp_f32 v135, v135
    v_rcp_f32 v136, v136
    v_rcp_f32 v137, v137
    v_rcp_f32 v138, v138
    v_rcp_f32 v139, v139
    v_rcp_f32 v140, v140
    v_rcp_f32 v141, v141
    v_rcp_f32 v142, v142
    v_rcp_f32 v143, v143
    v_rcp_f32 v96, v96
    v_rcp_f32 v97, v97
    v_rcp_f32 v98, v98
    v_rcp_f32 v99, v99
    v_rcp_f32 v100, v100
    v_rcp_f32 v101, v101
    v_rcp_f32 v102, v102
    v_rcp_f32 v103, v103
    v_rcp_f32 v104, v104
    v_rcp_f32 v105, v105
    v_rcp_f32 v106, v106
    v_rcp_f32 v107, v107
    v_rcp_f32 v108, v108
    v_rcp_f32 v109, v109
    v_rcp_f32 v110, v110
    v_rcp_f32 v111, v111
    s_waitcnt lgkmcnt(12)
    v_lshlrev_b32 v188, 16, v32
    v_and_b32 v192, 0xffff0000, v32
    v_lshlrev_b32 v196, 16, v33
    v_and_b32 v200, 0xffff0000, v33
    v_lshlrev_b32 v189, 16, v34
    v_and_b32 v193, 0xffff0000, v34
    v_lshlrev_b32 v197, 16, v35
    v_and_b32 v201, 0xffff0000, v35
    v_lshlrev_b32 v190, 16, v36
    v_and_b32 v194, 0xffff0000, v36
    v_lshlrev_b32 v198, 16, v37
    v_and_b32 v202, 0xffff0000, v37
    v_lshlrev_b32 v191, 16, v38
    v_and_b32 v195, 0xffff0000, v38
    v_lshlrev_b32 v199, 16, v39
    v_and_b32 v203, 0xffff0000, v39
    v_lshlrev_b32 v204, 16, v40
    v_and_b32 v208, 0xffff0000, v40
    v_lshlrev_b32 v212, 16, v41
    v_and_b32 v216, 0xffff0000, v41
    v_lshlrev_b32 v205, 16, v42
    v_and_b32 v209, 0xffff0000, v42
    v_lshlrev_b32 v213, 16, v43
    v_and_b32 v217, 0xffff0000, v43
    v_lshlrev_b32 v206, 16, v44
    v_and_b32 v210, 0xffff0000, v44
    v_lshlrev_b32 v214, 16, v45
    v_and_b32 v218, 0xffff0000, v45
    v_lshlrev_b32 v207, 16, v46
    v_and_b32 v211, 0xffff0000, v46
    v_lshlrev_b32 v215, 16, v47
    v_and_b32 v219, 0xffff0000, v47
    v_pk_fma_f32 v[112:113], v[112:113], v[96:97], v[188:189]
    v_pk_fma_f32 v[114:115], v[114:115], v[98:99], v[190:191]
    v_pk_fma_f32 v[116:117], v[116:117], v[100:101], v[192:193]
    v_pk_fma_f32 v[118:119], v[118:119], v[102:103], v[194:195]
    v_pk_fma_f32 v[120:121], v[120:121], v[104:105], v[196:197]
    v_pk_fma_f32 v[122:123], v[122:123], v[106:107], v[198:199]
    v_pk_fma_f32 v[124:125], v[124:125], v[108:109], v[200:201]
    v_pk_fma_f32 v[126:127], v[126:127], v[110:111], v[202:203]
    v_pk_fma_f32 v[144:145], v[144:145], v[128:129], v[204:205]
    v_pk_fma_f32 v[146:147], v[146:147], v[130:131], v[206:207]
    v_pk_fma_f32 v[148:149], v[148:149], v[132:133], v[208:209]
    v_pk_fma_f32 v[150:151], v[150:151], v[134:135], v[210:211]
    v_pk_fma_f32 v[152:153], v[152:153], v[136:137], v[212:213]
    v_pk_fma_f32 v[154:155], v[154:155], v[138:139], v[214:215]
    v_pk_fma_f32 v[156:157], v[156:157], v[140:141], v[216:217]
    v_pk_fma_f32 v[158:159], v[158:159], v[142:143], v[218:219]
    s_waitcnt lgkmcnt(0)
    v_mfma_f32_16x16x32_bf16 v[112:115], v[160:163], v[0:3], v[112:115]
    v_lshl_add_u32 v80, v80, 2, v74
    v_mfma_f32_16x16x32_bf16 v[116:119], v[160:163], v[8:11], v[116:119]
    v_lshl_add_u32 v81, v81, 2, v74
    v_mfma_f32_16x16x32_bf16 v[120:123], v[160:163], v[16:19], v[120:123]
    v_lshl_add_u32 v82, v82, 2, v74
    v_mfma_f32_16x16x32_bf16 v[124:127], v[160:163], v[24:27], v[124:127]
    v_lshl_add_u32 v83, v83, 2, v74
    v_mfma_f32_16x16x32_bf16 v[112:115], v[164:167], v[4:7], v[112:115]
    v_lshl_add_u32 v84, v84, 2, v75
    v_mfma_f32_16x16x32_bf16 v[116:119], v[164:167], v[12:15], v[116:119]
    v_lshl_add_u32 v85, v85, 2, v75
    v_mfma_f32_16x16x32_bf16 v[120:123], v[164:167], v[20:23], v[120:123]
    v_lshl_add_u32 v86, v86, 2, v75
    v_mfma_f32_16x16x32_bf16 v[124:127], v[164:167], v[28:31], v[124:127]
    v_lshl_add_u32 v87, v87, 2, v75
    v_mfma_f32_16x16x32_bf16 v[144:147], v[168:171], v[0:3], v[144:147]
    v_mfma_f32_16x16x32_bf16 v[148:151], v[168:171], v[8:11], v[148:151]
    v_mfma_f32_16x16x32_bf16 v[152:155], v[168:171], v[16:19], v[152:155]
    v_mfma_f32_16x16x32_bf16 v[156:159], v[168:171], v[24:27], v[156:159]
    v_mfma_f32_16x16x32_bf16 v[144:147], v[172:175], v[4:7], v[144:147]
    v_mfma_f32_16x16x32_bf16 v[148:151], v[172:175], v[12:15], v[148:151]
    v_mfma_f32_16x16x32_bf16 v[152:155], v[172:175], v[20:23], v[152:155]
    v_mfma_f32_16x16x32_bf16 v[156:159], v[172:175], v[28:31], v[156:159]
    v_cvt_pk_bf16_f32 v96, v112, v116
    v_cvt_pk_bf16_f32 v97, v120, v124
    v_pk_max_f16 v96, v96, v32
    v_pk_max_f16 v97, v97, v33
    buffer_store_dwordx2 v[96:97], v80, s[48:51], 0 offen sc1
    v_cvt_pk_bf16_f32 v98, v113, v117
    v_cvt_pk_bf16_f32 v99, v121, v125
    v_pk_max_f16 v98, v98, v34
    v_pk_max_f16 v99, v99, v35
    buffer_store_dwordx2 v[98:99], v81, s[48:51], 0 offen sc1
    v_cvt_pk_bf16_f32 v100, v114, v118
    v_cvt_pk_bf16_f32 v101, v122, v126
    v_pk_max_f16 v100, v100, v36
    v_pk_max_f16 v101, v101, v37
    buffer_store_dwordx2 v[100:101], v82, s[48:51], 0 offen sc1
    v_cvt_pk_bf16_f32 v102, v115, v119
    v_cvt_pk_bf16_f32 v103, v123, v127
    v_pk_max_f16 v102, v102, v38
    v_pk_max_f16 v103, v103, v39
    buffer_store_dwordx2 v[102:103], v83, s[48:51], 0 offen sc1
    v_cvt_pk_bf16_f32 v128, v144, v148
    v_cvt_pk_bf16_f32 v129, v152, v156
    v_pk_max_f16 v128, v128, v40
    v_pk_max_f16 v129, v129, v41
    buffer_store_dwordx2 v[128:129], v84, s[60:63], 0 offen sc1
    v_cvt_pk_bf16_f32 v130, v145, v149
    v_cvt_pk_bf16_f32 v131, v153, v157
    v_pk_max_f16 v130, v130, v42
    v_pk_max_f16 v131, v131, v43
    buffer_store_dwordx2 v[130:131], v85, s[60:63], 0 offen sc1
    v_cvt_pk_bf16_f32 v132, v146, v150
    v_cvt_pk_bf16_f32 v133, v154, v158
    v_pk_max_f16 v132, v132, v44
    v_pk_max_f16 v133, v133, v45
    buffer_store_dwordx2 v[132:133], v86, s[60:63], 0 offen sc1
    v_cvt_pk_bf16_f32 v134, v147, v151
    v_cvt_pk_bf16_f32 v135, v155, v159
    v_pk_max_f16 v134, v134, v46
    v_pk_max_f16 v135, v135, v47
    buffer_store_dwordx2 v[134:135], v87, s[60:63], 0 offen sc1
L_END:
    s_endpgm
L_NS0:
    v_add_f32 v96, v96, v128
    v_add_f32 v100, v100, v132
    v_add_f32 v104, v104, v136
    v_add_f32 v108, v108, v140
    v_add_f32 v112, v112, v144
    v_add_f32 v116, v116, v148
    v_add_f32 v120, v120, v152
    v_add_f32 v124, v124, v156
    s_branch L_NSR
L_NS1:
    v_add_f32 v97, v97, v129
    v_add_f32 v101, v101, v133
    v_add_f32 v105, v105, v137
    v_add_f32 v109, v109, v141
    v_add_f32 v113, v113, v145
    v_add_f32 v117, v117, v149
    v_add_f32 v121, v121, v153
    v_add_f32 v125, v125, v157
    s_branch L_NSR
L_NS2:
    v_add_f32 v98, v98, v130
    v_add_f32 v102, v102, v134
    v_add_f32 v106, v106, v138
    v_add_f32 v110, v110, v142
    v_add_f32 v114, v114, v146
    v_add_f32 v118, v118, v150
    v_add_f32 v122, v122, v154
    v_add_f32 v126, v126, v158
    s_branch L_NSR
L_NS3:
    v_add_f32 v99, v99, v131
    v_add_f32 v103, v103, v135
    v_add_f32 v107, v107, v139
    v_add_f32 v111, v111, v143
    v_add_f32 v115, v115, v147
    v_add_f32 v119, v119, v151
    v_add_f32 v123, v123, v155
    v_add_f32 v127, v127, v159
    s_branch L_NSR
L_RT0:
    s_waitcnt vmcnt(0)
    s_add_u32 s100, s100, 1
    s_cmp_gt_u32 s100, 200000
    s_cbranch_scc1 L_END
    s_sleep 1
    buffer_load_dwordx4 v[128:131], v232, s[56:59], 0 offen sc1
    buffer_load_dwordx4 v[132:135], v232, s[56:59], s26 offen sc1
    buffer_load_dwordx4 v[136:139], v232, s[56:59], s27 offen sc1
    buffer_load_dwordx4 v[140:143], v232, s[56:59], s28 offen sc1
    s_waitcnt vmcnt(0)
    s_branch L_PW0
L_RT1:
    s_waitcnt vmcnt(0)
    s_add_u32 s100, s100, 1
    s_cmp_gt_u32 s100, 200000
    s_cbranch_scc1 L_END
    s_sleep 1
    buffer_load_dwordx4 v[132:135], v232, s[56:59], s26 offen sc1
    buffer_load_dwordx4 v[136:139], v232, s[56:59], s27 offen sc1
    buffer_load_dwordx4 v[140:143], v232, s[56:59], s28 offen sc1
    s_waitcnt vmcnt(0)
    s_branch L_PW1
L_RT2:
    s_waitcnt vmcnt(0)
    s_add_u32 s100, s100, 1
    s_cmp_gt_u32 s100, 200000
    s_cbranch_scc1 L_END
    s_sleep 1
    buffer_load_dwordx4 v[136:139], v232, s[56:59], s27 offen sc1
    buffer_load_dwordx4 v[140:143], v232, s[56:59], s28 offen sc1
    s_waitcnt vmcnt(0)
    s_branch L_PW2
L_RT3:
    s_waitcnt vmcnt(0)
    s_add_u32 s100, s100, 1
    s_cmp_gt_u32 s100, 200000
    s_cbranch_scc1 L_END
    s_sleep 1
    buffer_load_dwordx4 v[140:143], v232, s[56:59], s28 offen sc1
    s_waitcnt vmcnt(0)
    s_branch L_PW3
L_XT2B:
    s_add_u32 s100, s100, 1
    s_cmp_gt_u32 s100, 200000
    s_cbranch_scc1 L_END
    s_sleep 1
    s_mov_b64 exec, s[70:71]
    s_cbranch_execz L_XLb0
    s_movk_i32 s10, 0
    buffer_load_dwordx4 v[64:67], v232, s[60:63], s10 offen sc1
L_XLb0:
    s_mov_b64 exec, s[78:79]
    s_cbranch_execz L_XLb1
    s_movk_i32 s10, 8192
    buffer_load_dwordx4 v[68:71], v232, s[60:63], s10 offen sc1
L_XLb1:
    s_mov_b64 exec, s[86:87]
    s_cbranch_execz L_XLb2
    s_movk_i32 s10, 16384
    buffer_load_dwordx4 v[72:75], v232, s[60:63], s10 offen sc1
L_XLb2:
    s_mov_b64 exec, s[94:95]
    s_cbranch_execz L_XLb3
    s_movk_i32 s10, 24576
    buffer_load_dwordx4 v[76:79], v232, s[60:63], s10 offen sc1
L_XLb3:
    s_mov_b64 exec, -1
    s_waitcnt vmcnt(0)
    s_branch L_XT2
L_OVF:
    s_mov_b32 s20, 0
    s_mov_b32 s17, 0
    s_mov_b32 s30, 0
    s_mov_b32 s19, 4
    s_waitcnt lgkmcnt(0)
    s_branch L_CA
L_POVF:
    s_movk_i32 s11, 1986
    v_mul_u32_u24 v64, s11, v192
    v_lshrrev_b32 v64, 16, v64
    v_mul_u32_u24 v65, s11, v193
    v_lshrrev_b32 v65, 16, v65
    v_mul_u32_u24 v66, s11, v194
    v_lshrrev_b32 v66, 16, v66
    v_mul_u32_u24 v67, s11, v195
    v_lshrrev_b32 v67, 16, v67
    v_add_u32 v69, v64, v65
    v_add_u32 v70, v69, v66
    v_add_u32 v71, v70, v67
    v_mov_b32 v72, v71
    s_nop 1
    v_add_u32_dpp v72, v72, v72 row_shr:1 row_mask:0xf bank_mask:0xf bound_ctrl:0
    s_nop 1
    v_add_u32_dpp v72, v72, v72 row_shr:2 row_mask:0xf bank_mask:0xf bound_ctrl:0
    s_nop 1
    v_add_u32_dpp v72, v72, v72 row_shr:4 row_mask:0xf bank_mask:0xf bound_ctrl:0
    s_nop 1
    v_add_u32_dpp v72, v72, v72 row_shr:8 row_mask:0xf bank_mask:0xf bound_ctrl:0
    s_nop 1
    v_add_u32_dpp v72, v72, v72 row_bcast:15 row_mask:0xa bank_mask:0xf
    s_nop 1
    v_add_u32_dpp v72, v72, v72 row_bcast:31 row_mask:0xc bank_mask:0xf
    s_nop 0
    v_sub_u32 v68, v72, v71
    v_add_u32 v71, v68, v70
    v_add_u32 v70, v68, v69
    v_add_u32 v69, v68, v64
    v_lshl_or_b32 v68, v64, 16, v68
    v_lshl_or_b32 v69, v65, 16, v69
    v_lshl_or_b32 v70, v66, 16, v70
    v_lshl_or_b32 v71, v67, 16, v71
    v_add_u32 v72, 154752, v185
    ds_write_b128 v72, v[68:71]
    s_lshl_b32 s10, s2, 10
    s_add_u32 s10, s10, 24772608
    buffer_store_dwordx4 v[68:71], v185, s[52:55], s10 offen sc1
    v_and_b32 v74, 0x3fc, v136
    v_add_u32 v74, 154752, v74
    ds_read_u16 v74, v74
    v_and_b32 v75, 0x3fc, v137
    v_add_u32 v75, 154752, v75
    ds_read_u16 v75, v75
    v_and_b32 v76, 0x3fc, v138
    v_add_u32 v76, 154752, v76
    ds_read_u16 v76, v76
    v_and_b32 v77, 0x3fc, v139
    v_add_u32 v77, 154752, v77
    ds_read_u16 v77, v77
    v_and_b32 v78, 0x3fc, v140
    v_add_u32 v78, 154752, v78
    ds_read_u16 v78, v78
    v_and_b32 v79, 0x3fc, v141
    v_add_u32 v79, 154752, v79
    ds_read_u16 v79, v79
    v_and_b32 v80, 0x3fc, v142
    v_add_u32 v80, 154752, v80
    ds_read_u16 v80, v80
    v_and_b32 v81, 0x3fc, v143
    v_add_u32 v81, 154752, v81
    ds_read_u16 v81, v81
    s_waitcnt lgkmcnt(0)
    v_cmpx_lt_u32 vcc, 1056, v228
    v_or_b32 v205, 0x10000, v205
    s_mov_b64 exec, -1
    v_cmpx_lt_u32 vcc, 1056, v229
    v_or_b32 v209, 0x10000, v209
    s_mov_b64 exec, -1
    v_cmpx_lt_u32 vcc, 1056, v230
    v_or_b32 v213, 0x10000, v213
    s_mov_b64 exec, -1
    v_cmpx_lt_u32 vcc, 1056, v231
    v_or_b32 v217, 0x10000, v217
    s_mov_b64 exec, -1
    s_mul_i32 s10, s2, 4152
    s_mov_b32 s34, 18874368
    s_mov_b32 s35, 23592960
    v_mul_u32_u24 v64, s11, v112
    v_lshrrev_b32 v64, 16, v64
    v_add3_u32 v64, v64, v74, s10
    v_lshlrev_b32 v65, 2, v64
    v_cmpx_le_u32 vcc, 1056, v112
    s_cbranch_execz L_PO0
    buffer_store_byte v120, v64, s[52:55], s35 offen sc1
    buffer_store_dword v96, v65, s[52:55], s34 offen sc1
L_PO0:
    s_mov_b64 exec, -1
    v_mul_u32_u24 v64, s11, v113
    v_lshrrev_b32 v64, 16, v64
    v_add3_u32 v64, v64, v75, s10
    v_lshlrev_b32 v65, 2, v64
    v_cmpx_le_u32 vcc, 1056, v113
    s_cbranch_execz L_PO1
    buffer_store_byte v121, v64, s[52:55], s35 offen sc1
    buffer_store_dword v97, v65, s[52:55], s34 offen sc1
L_PO1:
    s_mov_b64 exec, -1
    v_mul_u32_u24 v64, s11, v114
    v_lshrrev_b32 v64, 16, v64
    v_add3_u32 v64, v64, v76, s10
    v_lshlrev_b32 v65, 2, v64
    v_cmpx_le_u32 vcc, 1056, v114
    s_cbranch_execz L_PO2
    buffer_store_byte v122, v64, s[52:55], s35 offen sc1
    buffer_store_dword v98, v65, s[52:55], s34 offen sc1
L_PO2:
    s_mov_b64 exec, -1
    v_mul_u32_u24 v64, s11, v115
    v_lshrrev_b32 v64, 16, v64
    v_add3_u32 v64, v64, v77, s10
    v_lshlrev_b32 v65, 2, v64
    v_cmpx_le_u32 vcc, 1056, v115
    s_cbranch_execz L_PO3
    buffer_store_byte v123, v64, s[52:55], s35 offen sc1
    buffer_store_dword v99, v65, s[52:55], s34 offen sc1
L_PO3:
    s_mov_b64 exec, -1
    v_mul_u32_u24 v64, s11, v116
    v_lshrrev_b32 v64, 16, v64
    v_add3_u32 v64, v64, v78, s10
    v_lshlrev_b32 v65, 2, v64
    v_cmpx_le_u32 vcc, 1056, v116
    s_cbranch_execz L_PO4
    buffer_store_byte v120, v64, s[52:55], s35 offen sc1
    buffer_store_dword v100, v65, s[52:55], s34 offen sc1
L_PO4:
    s_mov_b64 exec, -1
    v_mul_u32_u24 v64, s11, v117
    v_lshrrev_b32 v64, 16, v64
    v_add3_u32 v64, v64, v79, s10
    v_lshlrev_b32 v65, 2, v64
    v_cmpx_le_u32 vcc, 1056, v117
    s_cbranch_execz L_PO5
    buffer_store_byte v121, v64, s[52:55], s35 offen sc1
    buffer_store_dword v101, v65, s[52:55], s34 offen sc1
L_PO5:
    s_mov_b64 exec, -1
    v_mul_u32_u24 v64, s11, v118
    v_lshrrev_b32 v64, 16, v64
    v_add3_u32 v64, v64, v80, s10
    v_lshlrev_b32 v65, 2, v64
    v_cmpx_le_u32 vcc, 1056, v118
    s_cbranch_execz L_PO6
    buffer_store_byte v122, v64, s[52:55], s35 offen sc1
    buffer_store_dword v102, v65, s[52:55], s34 offen sc1
L_PO6:
    s_mov_b64 exec, -1
    v_mul_u32_u24 v64, s11, v119
    v_lshrrev_b32 v64, 16, v64
    v_add3_u32 v64, v64, v81, s10
    v_lshlrev_b32 v65, 2, v64
    v_cmpx_le_u32 vcc, 1056, v119
    s_cbranch_execz L_PO7
    buffer_store_byte v123, v64, s[52:55], s35 offen sc1
    buffer_store_dword v103, v65, s[52:55], s34 offen sc1
L_PO7:
    s_mov_b64 exec, -1
    s_waitcnt vmcnt(0) lgkmcnt(0)
    s_barrier
    s_branch L_POUT
L_SLOW:
    s_setprio 0
    s_lshl_b32 s10, s3, 6
    v_add_u32 v255, s10, v253
    s_cmp_lg_u32 s19, 4
    s_cbranch_scc1 L_SL1
    s_mov_b32 s19, 1
    v_and_b32 v188, 0xff, v255
    v_lshlrev_b32 v189, 7, v188
    buffer_load_dword v190, v189, s[56:59], 0 offen offset:4 sc1
    v_lshlrev_b32 v189, 10, v188
    s_lshl_b32 s10, s5, 2
    s_add_u32 s10, s10, 24772608
    buffer_load_dword v191, v189, s[52:55], s10 offen sc1
    v_lshlrev_b32 v188, 2, v188
    v_add_u32 v188, 154752, v188
    s_waitcnt vmcnt(0)
    v_and_b32 v190, 0x10000, v190
    v_cmp_ne_u32 vcc, 0, v190
    v_mov_b32 v190, 2097152
    s_nop 0
    v_cndmask_b32 v190, v190, v191, vcc
    ds_write_b32 v188, v190
    s_waitcnt lgkmcnt(0)
    s_barrier
L_SL1:
    s_add_u32 s28, s28, 288
    s_cmp_lt_u32 s28, s29
    s_cbranch_scc1 L_BATCH
L_FIND:
    s_cmp_lg_u64 s[32:33], 0
    s_cbranch_scc1 L_GOT
    s_add_u32 s26, s26, 1
    s_cmp_ge_u32 s26, 4
    s_cbranch_scc1 L_EPI
    s_lshl_b32 s10, s26, 8
    s_add_u32 s10, s10, 154752
    v_lshl_add_u32 v188, v253, 2, s10
    ds_read_u16 v188, v188 offset:2
    s_waitcnt lgkmcnt(0)
    v_cmp_lt_u32 s[32:33], s20, v188
    s_nop 3
    s_branch L_FIND
L_GOT:
    s_ff1_i32_b64 s10, s[32:33]
    s_bitset0_b64 s[32:33], s10
    s_lshl_b32 s11, s26, 6
    s_add_u32 s27, s10, s11
    s_lshl_b32 s10, s27, 2
    s_add_u32 s10, s10, 154752
    v_mov_b32 v188, s10
    ds_read_b32 v188, v188
    s_waitcnt lgkmcnt(0)
    v_readfirstlane_b32 s10, v188
    s_nop 3
    s_lshr_b32 s29, s10, 16
    s_and_b32 s30, s10, 0xffff
    s_mov_b32 s28, s20
L_BATCH:
    s_waitcnt vmcnt(0)
    s_barrier
    v_mov_b64 v[192:193], 0
    v_mov_b64 v[194:195], 0
    v_mov_b32 v196, 0x20fffff
    v_mov_b32 v197, 0x20fffff
    v_mov_b32 v198, 0x20fffff
    v_mov_b32 v199, 0x20fffff
    v_lshl_add_u32 v200, v253, 4, s12
    ds_write_b128 v200, v[192:195] offset:0
    ds_write_b128 v200, v[196:199] offset:18432
    ds_write_b128 v200, v[192:195] offset:1024
    ds_write_b128 v200, v[196:199] offset:19456
    ds_write_b128 v200, v[192:195] offset:1280
    ds_write_b128 v200, v[196:199] offset:19712
    v_and_b32 v188, 15, v253
    v_mul_u32_u24 v189, 1152, v188
    v_add_u32 v189, 8192, v189
    v_lshlrev_b32 v188, 2, v188
    ds_write_b32 v188, v189 offset:576
    v_add_u32 v188, s28, v255
    s_mul_i32 s36, s27, 3128
    s_mul_i32 s11, s27, 4152
    s_add_u32 s11, s11, s30
    s_lshl_b32 s34, s11, 2
    s_add_u32 s34, s34, 18874368
    v_lshl_add_u32 v190, v188, 2, s34
    s_add_u32 s34, s11, 23592960
    v_add_u32 v191, s34, v188
    s_mul_i32 s10, s5, 32896
    s_lshl_b32 s34, s27, 7
    s_add_u32 s10, s10, s34
    s_add_u32 s10, s10, 65536
    v_and_b32 v206, 7, v188
    v_lshl_add_u32 v206, v206, 4, s10
    v_lshrrev_b32 v207, 3, v188
    v_cmpx_gt_u32 vcc, 32, v188
    v_add_u32 v190, 8421376, v206
    v_add_u32 v191, 8, v190
    v_cmpx_gt_u32 vcc, 24, v188
    v_lshl_add_u32 v190, v207, 2, v206
    v_add3_u32 v191, v206, v207, 12
    s_mov_b64 exec, -1
    s_add_u32 s10, s28, 288
    s_min_u32 s10, s10, s29
    v_cmp_gt_u32 vcc, s10, v188
    v_mov_b32 v206, 0x7ffffff0
    s_nop 0
    v_cndmask_b32 v190, v206, v190, vcc
    v_cndmask_b32 v191, v206, v191, vcc
    buffer_load_dwordx2 v[204:205], v190, s[52:55], 0 offen sc1
    buffer_load_ubyte v191, v191, s[52:55], 0 offen sc1
    s_waitcnt lgkmcnt(0)
    s_barrier
    s_waitcnt vmcnt(0)
    v_cmp_ne_u32 vcc, 3, v207
    v_cmp_eq_u32 s[10:11], s6, v205
    v_mov_b32 v206, s36
    s_or_b64 exec, vcc, s[10:11]
    v_cmpx_ne_u32 vcc, 0, v204
    v_bfe_u32 v190, v204, 18, 8
    v_lshlrev_b32 v190, 2, v190
    v_add_u32 v188, 153728, v190
    ds_read_b32 v188, v188
    v_add_u32_sdwa v191, v191, v206 dst_sel:DWORD dst_unused:UNUSED_PAD src0_sel:BYTE_0 src1_sel:DWORD
    v_lshrrev_b32 v189, 28, v204
    v_lshl_add_u32 v191, v189, 8, v191
    v_and_b32 v189, 60, v190
    v_lshl_add_u32 v191, v189, 19, v191
    v_mov_b32 v190, 4
    v_and_b32 v204, 0xffff, v204
    s_waitcnt lgkmcnt(0)
    ds_add_rtn_u32 v188, v188, v190 offset:576
    s_waitcnt lgkmcnt(0)
    ds_write2st64_b32 v188, v204, v191 offset0:148 offset1:220
    s_mov_b64 exec, -1
    s_waitcnt lgkmcnt(0)
    s_barrier
    v_lshrrev_b32 v190, 3, v253
    v_lshl_add_u32 v247, v190, 4, s12
    s_add_u32 s10, s12, 18432
    v_lshrrev_b32 v190, 1, v253
    v_lshl_add_u32 v248, v190, 2, s10
    s_add_u32 s10, s10, 2
    v_and_b32 v190, 48, v253
    v_lshl_add_u32 v250, v190, 1, s10
    v_and_b32 v190, 12, v253
    v_add_u32 v250, v250, v190
    v_lshrrev_b32 v190, 5, v253
    v_mul_u32_u24 v249, 18432, v190
    v_and_b32 v190, 15, v253
    v_lshl_add_u32 v249, v190, 2, v249
    s_add_u32 s10, s12, 2
    v_add_u32 v249, s10, v249
    ds_read_b128 v[236:239], v247
    ds_read_b32 v240, v248
    s_lshl_b32 s10, s4, 3
    v_mov_b32 v190, s10
    ds_read_b64 v[190:191], v190 offset:576
    s_waitcnt lgkmcnt(0)
    v_readfirstlane_b32 s34, v190
    v_readfirstlane_b32 s35, v191
    s_sub_u32 s10, s12, 37888
    s_sub_u32 s34, s34, s10
    s_sub_u32 s35, s35, s10
    s_sub_u32 s35, s35, 1152
    s_add_u32 s10, s34, 127
    s_lshr_b32 s10, s10, 7
    s_lshl1_add_u32 s10, s10, -1
    s_add_u32 s11, s35, 127
    s_lshr_b32 s11, s11, 6
    s_and_b32 s11, s11, -2
    s_max_i32 s17, s10, s11
    s_cselect_b32 s10, s34, s35
    s_sub_u32 s10, s10, 1
    s_andn2_b32 s99, 64, s10
    s_add_u32 m0, s13, 0
    v_mad_u32_u16 v236, v236, s15, v243
    buffer_load_dwordx4 v236, s[40:43], 0 offen lds
    s_add_u32 m0, s13, 1056
    v_mad_u32_u16 v237, v237, s15, v243
    buffer_load_dwordx4 v237, s[40:43], 0 offen lds
    s_add_u32 m0, s13, 2112
    v_mad_u32_u16 v238, v238, s15, v243
    buffer_load_dwordx4 v238, s[40:43], 0 offen lds
    s_add_u32 m0, s13, 3168
    v_mad_u32_u16 v239, v239, s15, v243
    buffer_load_dwordx4 v239, s[40:43], 0 offen lds
    s_mov_b32 m0, s14
    v_and_b32 v240, 0xfffff, v240
    buffer_load_dwordx4 v[240:241], s[44:47], 0 idxen offen lds
L_LAST:
    s_branch L_GO
.section .rodata,"a"
.p2align 6
.amdhsa_kernel standalone__edge_featured_mpnn_gatedgcn__graph_kernel
  .amdhsa_next_free_vgpr 256
  .amdhsa_next_free_sgpr 102
  .amdhsa_accum_offset 256
  .amdhsa_group_segment_fixed_size 0
  .amdhsa_kernarg_size 96
  .amdhsa_user_sgpr_count 2
  .amdhsa_user_sgpr_kernarg_segment_ptr 1
  .amdhsa_system_sgpr_workgroup_id_x 1
.end_amdhsa_kernel
```

```asm
; @launch grid=(256,1,1) block=(512,1,1) lds=157824
.amdgcn_target "amdgcn-amd-amdhsa--gfx950"
.text
.globl standalone__edge_featured_mpnn_gatedgcn__graph_kernel
.p2align 8
.type standalone__edge_featured_mpnn_gatedgcn__graph_kernel,@function
standalone__edge_featured_mpnn_gatedgcn__graph_kernel:
    s_load_dwordx16 s[16:31], s[0:1], 0
    s_load_dwordx8 s[32:39], s[0:1], 64
    s_getpc_b64 s[64:65]
L_PC:
    s_and_b32 s3, s2, -8
    v_add_lshl_u32 v1, v0, s3, 7
    v_min_u32 v1, L_LAST-L_PC, v1
    v_cmpx_gt_u32 vcc, 8, v0
    s_cbranch_execz L_NOCPF
    global_load_dword v251, v1, s[64:65]
L_NOCPF:
    s_mov_b64 exec, -1
    s_cmp_ge_u32 s2, 256
    s_cbranch_scc1 L_END
    s_mul_i32 s10, s2, 12512
    v_lshl_add_u32 v1, v0, 4, s10
    s_add_u32 s11, s10, 12512
    s_min_u32 s11, s11, 3200000
    v_add_u32 v2, 0x2000, v1
    s_waitcnt lgkmcnt(0)
    global_load_dwordx4 v[128:131], v1, s[22:23] nt
    global_load_dwordx4 v[96:99], v1, s[20:21] nt
    v_cmpx_gt_u32 s[70:71], s11, v2
    s_cbranch_execz L_NO7
    global_load_dwordx4 v[132:135], v2, s[22:23] nt
    global_load_dwordx4 v[100:103], v2, s[20:21] nt
L_NO7:
    s_mov_b64 exec, -1
    s_load_dword s6, s[38:39], 0
    v_mov_b32 v255, v0
    v_lshrrev_b32 v188, 6, v0
    v_and_b32 v253, 63, v0
    v_readfirstlane_b32 s3, v188
    v_lshlrev_b32 v232, 4, v0
    v_lshlrev_b32 v190, 3, v0
    v_lshlrev_b32 v191, 2, v0
    v_and_b32 v192, 0x3fc, v191
    s_and_b32 s5, s2, 7
    s_lshr_b32 s4, s2, 3
    s_lshl_b32 s5, s5, 5
    s_add_u32 s5, s5, s4
    s_mul_i32 s9, s5, 196
    s_cmp_eq_u32 s3, 7
    s_cselect_b32 s101, 0, s3
    s_lshl_b32 s12, s101, 5
    s_add_u32 s9, s9, s12
    v_lshrrev_b32 v193, 3, v253
    v_lshl_add_u32 v193, v193, 2, s9
    v_and_b32 v243, 7, v253
    v_lshlrev_b32 v243, 4, v243
    v_lshl_add_u32 v234, v193, 7, v243
    s_lshl_b32 s101, s101, 10
    s_add_u32 s101, s101, 116736
    v_mov_b64 v[196:197], 0
    v_mov_b64 v[198:199], 0
    v_mov_b32 v194, 132
    ds_write2st64_b32 v192, v194, v196 offset0:20 offset1:24
    v_add_u32 v193, 46080, v232
    ds_write_b128 v193, v[196:199] offset:0
    ds_write_b128 v193, v[196:199] offset:8192
    ds_write_b128 v193, v[196:199] offset:16384
    ds_write_b128 v193, v[196:199] offset:24576
    ds_write_b128 v193, v[196:199] offset:32768
    s_mov_b32 s44, s18
    s_or_b32 s45, s19, 0x200000
    s_mov_b32 s46, 800000
    s_mov_b32 s47, 0x20000
    s_mov_b32 s48, s34
    s_mov_b32 s49, s35
    s_mov_b32 s50, 6400000
    s_mov_b32 s51, 0x20000
    s_mov_b32 s40, s16
    s_mov_b32 s41, s17
    s_mov_b32 s42, 6400000
    s_mov_b32 s43, 0x20000
    s_mov_b32 s52, s38
    s_mov_b32 s53, s39
    s_mov_b32 s54, 25165824
    s_mov_b32 s55, 0x20000
    s_lshl_b32 s12, s2, 7
    s_add_u32 s12, s12, 65536
    s_add_u32 s56, s38, s12
    s_addc_u32 s57, s39, 0
    s_mov_b32 s58, 16809984
    s_mov_b32 s59, 0x20000
    s_mov_b32 s64, 85599
    s_mov_b32 s65, 4294967100
    s_movk_i32 s66, 5368
    s_mov_b32 s67, 0xc000000
    s_mov_b32 s68, 32896
    v_add_u32 v120, 0, v191
    v_add_u32 v121, 1, v191
    v_add_u32 v122, 2, v191
    v_add_u32 v123, 3, v191
    s_lshl_b32 s10, s3, 28
    s_or_b32 s10, s10, 0x20000
    v_mov_b32 v144, s10
    v_or_b32 v145, 0x80000000, v144
    v_mov_b32 v184, 33
    v_mov_b32 v146, 0x400
    s_and_b32 s10, s3, 3
    s_lshr_b32 s4, s3, 2
    s_lshl1_add_u32 s4, s10, s4
    s_xor_b32 s4, s4, 1
    s_mul_i32 s10, s4, 49
    s_sub_i32 s10, s10, 6
    s_ashr_i32 s10, s10, 1
    s_max_i32 s7, s10, 0
    s_mul_i32 s13, s4, 4224
    s_add_u32 s13, s13, 82944
    s_lshl_b32 s14, s4, 10
    s_add_u32 s14, s14, 5120
    s_mul_i32 s12, s4, 2304
    s_add_u32 s12, s12, 46080
    s_movk_i32 s15, 128
    v_bfe_u32 v194, v255, 4, 4
    v_and_b32 v195, 7, v255
    v_cmp_eq_u32 vcc, v194, v195
    v_and_b32 v194, 8, v255
    v_lshlrev_b32 v194, 1, v194
    v_mov_b32 v196, 0x3f80
    v_lshlrev_b32 v196, v194, v196
    v_cndmask_b32 v196, 0, v196, vcc
    ds_write_b32 v192, v196 offset:0
    v_mov_b64 v[196:197], 0
    ds_write_b64 v190, v[196:197] offset:1024
    v_add_u32 v194, 155776, v192
    ds_write_b32 v194, v196
    v_lshrrev_b32 v223, 3, v255
    v_mad_u32_u24 v220, v223, s68, v243
    v_mul_u32_u24 v224, 160, v223
    v_add_u32 v221, v224, v243
    v_add_u32 v221, 46080, v221
    v_bfe_u32 v194, v255, 5, 1
    v_bfe_u32 v196, v255, 6, 1
    v_sub_u32 v194, v194, v196
    v_mul_i32_i24 v194, 640, v194
    v_add_u32 v224, v224, v194
    v_lshl_add_u32 v224, v195, 2, v224
    v_add_u32 v224, 13312, v224
    v_lshlrev_b32 v185, 4, v253
    v_and_b32 v194, 3, v253
    v_lshlrev_b32 v246, 3, v194
    v_bfe_u32 v197, v253, 2, 3
    v_lshrrev_b32 v196, 5, v253
    v_lshl_add_u32 v197, v196, 4, v197
    v_mul_u32_u24 v225, 160, v197
    v_add_u32 v225, v225, v246
    s_movk_i32 s69, 11520
    v_mov_b64 v[116:117], 0
    v_mov_b64 v[118:119], 0
    s_waitcnt lgkmcnt(0)
    s_barrier
    s_cmp_eq_u64 s[70:71], 0
    s_cbranch_scc1 L_R4
    s_waitcnt vmcnt(3)
    v_mul_u32_u24 v104, s64, v128
    v_mul_u32_u24 v105, s64, v129
    v_mul_u32_u24 v106, s64, v130
    v_mul_u32_u24 v107, s64, v131
    v_lshrrev_b32 v136, 29, v104
    v_lshrrev_b32 v137, 29, v105
    v_lshrrev_b32 v138, 29, v106
    v_lshrrev_b32 v139, 29, v107
    v_cmp_eq_u32 s[72:73], v136, v137
    v_cmp_eq_u32 s[76:77], v138, v139
    v_cmp_eq_u32 vcc, v136, v138
    v_cmp_eq_u32 s[88:89], v137, v139
    v_cmp_eq_u32 s[90:91], v136, v139
    v_cmp_eq_u32 s[10:11], v137, v138
    v_lshrrev_b32 v104, 24, v104
    v_lshrrev_b32 v105, 24, v105
    v_lshrrev_b32 v106, 24, v106
    v_lshrrev_b32 v107, 24, v107
    s_or_b64 s[74:75], s[72:73], s[88:89]
    s_or_b64 s[78:79], s[76:77], s[88:89]
    s_or_b64 s[72:73], s[72:73], vcc
    s_or_b64 s[76:77], s[76:77], vcc
    s_or_b64 s[72:73], s[72:73], s[90:91]
    s_or_b64 s[74:75], s[74:75], s[10:11]
    s_or_b64 s[76:77], s[76:77], s[10:11]
    s_or_b64 s[78:79], s[78:79], s[90:91]
    v_cndmask_b32 v136, 0, v146, s[72:73]
    v_lshl_add_u32 v136, v104, 2, v136
    ds_add_rtn_u32 v112, v136, v184 offset:5120
    v_cndmask_b32 v137, 0, v146, s[74:75]
    v_lshl_add_u32 v137, v105, 2, v137
    ds_add_rtn_u32 v113, v137, v184 offset:5120
    v_cndmask_b32 v138, 0, v146, s[76:77]
    v_lshl_add_u32 v138, v106, 2, v138
    ds_add_rtn_u32 v114, v138, v184 offset:5120
    v_cndmask_b32 v139, 0, v146, s[78:79]
    v_lshl_add_u32 v139, v107, 2, v139
    ds_add_rtn_u32 v115, v139, v184 offset:5120
    s_waitcnt vmcnt(1)
    s_mov_b64 exec, s[70:71]
    v_mul_u32_u24 v108, s64, v132
    v_mul_u32_u24 v109, s64, v133
    v_mul_u32_u24 v110, s64, v134
    v_mul_u32_u24 v111, s64, v135
    v_lshrrev_b32 v108, 24, v108
    v_lshrrev_b32 v109, 24, v109
    v_lshrrev_b32 v110, 24, v110
    v_lshrrev_b32 v111, 24, v111
    v_lshlrev_b32 v140, 2, v108
    ds_add_rtn_u32 v116, v140, v184 offset:5120
    v_lshlrev_b32 v141, 2, v109
    ds_add_rtn_u32 v117, v141, v184 offset:5120
    v_lshlrev_b32 v142, 2, v110
    ds_add_rtn_u32 v118, v142, v184 offset:5120
    v_lshlrev_b32 v143, 2, v111
    ds_add_rtn_u32 v119, v143, v184 offset:5120
    s_waitcnt lgkmcnt(7)
    s_mov_b64 exec, s[72:73]
    v_cmpx_le_u32 vcc, 132, v112
    ds_add_rtn_u32 v112, v136, v184 offset:4096
    s_waitcnt lgkmcnt(7)
    s_mov_b64 exec, s[74:75]
    v_cmpx_le_u32 vcc, 132, v113
    ds_add_rtn_u32 v113, v137, v184 offset:4096
    s_waitcnt lgkmcnt(7)
    s_mov_b64 exec, s[76:77]
    v_cmpx_le_u32 vcc, 132, v114
    ds_add_rtn_u32 v114, v138, v184 offset:4096
    s_waitcnt lgkmcnt(7)
    s_mov_b64 exec, s[78:79]
    v_cmpx_le_u32 vcc, 132, v115
    ds_add_rtn_u32 v115, v139, v184 offset:4096
    s_mov_b64 exec, s[70:71]
    s_waitcnt vmcnt(0)
    v_mad_i32_i24 v132, v108, s65, v132
    v_mul_u32_u24 v194, s66, v100
    v_lshl_or_b32 v100, v132, 18, v100
    v_and_or_b32 v194, v194, s67, v145
    v_mad_u32_u24 v132, v108, 40, s69
    v_or_b32 v100, v100, v194
    v_mad_i32_i24 v133, v109, s65, v133
    v_mul_u32_u24 v194, s66, v101
    v_lshl_or_b32 v101, v133, 18, v101
    v_and_or_b32 v194, v194, s67, v145
    v_mad_u32_u24 v133, v109, 40, s69
    v_or_b32 v101, v101, v194
    v_mad_i32_i24 v134, v110, s65, v134
    v_mul_u32_u24 v194, s66, v102
    v_lshl_or_b32 v102, v134, 18, v102
    v_and_or_b32 v194, v194, s67, v145
    v_mad_u32_u24 v134, v110, 40, s69
    v_or_b32 v102, v102, v194
    v_mad_i32_i24 v135, v111, s65, v135
    v_mul_u32_u24 v194, s66, v103
    v_lshl_or_b32 v103, v135, 18, v103
    v_and_or_b32 v194, v194, s67, v145
    v_mad_u32_u24 v135, v111, 40, s69
    v_or_b32 v103, v103, v194
    s_waitcnt lgkmcnt(7)
    v_bfe_u32 v194, v116, 3, 5
    v_add_lshl_u32 v132, v194, v132, 2
    v_and_b32 v194, 3, v194
    v_mad_i32_i24 v194, v194, -3, v132
    v_cmpx_gt_u32 vcc, 792, v116
    ds_write_b32 v132, v100
    ds_write_b8 v194, v120 offset:12
    s_mov_b64 exec, s[70:71]
    s_waitcnt lgkmcnt(8)
    v_bfe_u32 v194, v117, 3, 5
    v_add_lshl_u32 v133, v194, v133, 2
    v_and_b32 v194, 3, v194
    v_mad_i32_i24 v194, v194, -3, v133
    v_cmpx_gt_u32 vcc, 792, v117
    ds_write_b32 v133, v101
    ds_write_b8 v194, v121 offset:12
    s_mov_b64 exec, s[70:71]
    s_waitcnt lgkmcnt(9)
    v_bfe_u32 v194, v118, 3, 5
    v_add_lshl_u32 v134, v194, v134, 2
    v_and_b32 v194, 3, v194
    v_mad_i32_i24 v194, v194, -3, v134
    v_cmpx_gt_u32 vcc, 792, v118
    ds_write_b32 v134, v102
    ds_write_b8 v194, v122 offset:12
    s_mov_b64 exec, s[70:71]
    s_waitcnt lgkmcnt(10)
    v_bfe_u32 v194, v119, 3, 5
    v_add_lshl_u32 v135, v194, v135, 2
    v_and_b32 v194, 3, v194
    v_mad_i32_i24 v194, v194, -3, v135
    v_cmpx_gt_u32 vcc, 792, v119
    ds_write_b32 v135, v103
    ds_write_b8 v194, v123 offset:12
    s_mov_b64 exec, -1
    v_mad_i32_i24 v128, v104, s65, v128
    v_mul_u32_u24 v194, s66, v96
    v_lshl_or_b32 v96, v128, 18, v96
    v_and_or_b32 v194, v194, s67, v144
    v_mad_u32_u24 v128, v104, 40, s69
    v_or_b32 v96, v96, v194
    v_mad_i32_i24 v129, v105, s65, v129
    v_mul_u32_u24 v194, s66, v97
    v_lshl_or_b32 v97, v129, 18, v97
    v_and_or_b32 v194, v194, s67, v144
    v_mad_u32_u24 v129, v105, 40, s69
    v_or_b32 v97, v97, v194
    v_mad_i32_i24 v130, v106, s65, v130
    v_mul_u32_u24 v194, s66, v98
    v_lshl_or_b32 v98, v130, 18, v98
    v_and_or_b32 v194, v194, s67, v144
    v_mad_u32_u24 v130, v106, 40, s69
    v_or_b32 v98, v98, v194
    v_mad_i32_i24 v131, v107, s65, v131
    v_mul_u32_u24 v194, s66, v99
    v_lshl_or_b32 v99, v131, 18, v99
    v_and_or_b32 v194, v194, s67, v144
    v_mad_u32_u24 v131, v107, 40, s69
    v_or_b32 v99, v99, v194
    s_waitcnt lgkmcnt(11)
    v_bfe_u32 v194, v112, 3, 5
    v_add_lshl_u32 v128, v194, v128, 2
    v_and_b32 v194, 3, v194
    v_mad_i32_i24 v194, v194, -3, v128
    v_cmpx_gt_u32 vcc, 792, v112
    ds_write_b32 v128, v96
    ds_write_b8 v194, v120 offset:12
    s_mov_b64 exec, -1
    s_waitcnt lgkmcnt(12)
    v_bfe_u32 v194, v113, 3, 5
    v_add_lshl_u32 v129, v194, v129, 2
    v_and_b32 v194, 3, v194
    v_mad_i32_i24 v194, v194, -3, v129
    v_cmpx_gt_u32 vcc, 792, v113
    ds_write_b32 v129, v97
    ds_write_b8 v194, v121 offset:12
    s_mov_b64 exec, -1
    s_waitcnt lgkmcnt(13)
    v_bfe_u32 v194, v114, 3, 5
    v_add_lshl_u32 v130, v194, v130, 2
    v_and_b32 v194, 3, v194
    v_mad_i32_i24 v194, v194, -3, v130
    v_cmpx_gt_u32 vcc, 792, v114
    ds_write_b32 v130, v98
    ds_write_b8 v194, v122 offset:12
    s_mov_b64 exec, -1
    s_waitcnt lgkmcnt(14)
    v_bfe_u32 v194, v115, 3, 5
    v_add_lshl_u32 v131, v194, v131, 2
    v_and_b32 v194, 3, v194
    v_mad_i32_i24 v194, v194, -3, v131
    v_cmpx_gt_u32 vcc, 792, v115
    ds_write_b32 v131, v99
    ds_write_b8 v194, v123 offset:12
    s_mov_b64 exec, -1
    s_branch L_B1
L_R4:
    s_waitcnt vmcnt(1)
    v_mul_u32_u24 v104, s64, v128
    v_mul_u32_u24 v105, s64, v129
    v_mul_u32_u24 v106, s64, v130
    v_mul_u32_u24 v107, s64, v131
    v_lshrrev_b32 v136, 29, v104
    v_lshrrev_b32 v137, 29, v105
    v_lshrrev_b32 v138, 29, v106
    v_lshrrev_b32 v139, 29, v107
    v_cmp_eq_u32 s[72:73], v136, v137
    v_cmp_eq_u32 s[76:77], v138, v139
    v_cmp_eq_u32 vcc, v136, v138
    v_cmp_eq_u32 s[88:89], v137, v139
    v_cmp_eq_u32 s[90:91], v136, v139
    v_cmp_eq_u32 s[10:11], v137, v138
    v_lshrrev_b32 v104, 24, v104
    v_lshrrev_b32 v105, 24, v105
    v_lshrrev_b32 v106, 24, v106
    v_lshrrev_b32 v107, 24, v107
    s_or_b64 s[74:75], s[72:73], s[88:89]
    s_or_b64 s[78:79], s[76:77], s[88:89]
    s_or_b64 s[72:73], s[72:73], vcc
    s_or_b64 s[76:77], s[76:77], vcc
    s_or_b64 s[72:73], s[72:73], s[90:91]
    s_or_b64 s[74:75], s[74:75], s[10:11]
    s_or_b64 s[76:77], s[76:77], s[10:11]
    s_or_b64 s[78:79], s[78:79], s[90:91]
    v_cndmask_b32 v136, 0, v146, s[72:73]
    v_lshl_add_u32 v136, v104, 2, v136
    ds_add_rtn_u32 v112, v136, v184 offset:5120
    v_cndmask_b32 v137, 0, v146, s[74:75]
    v_lshl_add_u32 v137, v105, 2, v137
    ds_add_rtn_u32 v113, v137, v184 offset:5120
    v_cndmask_b32 v138, 0, v146, s[76:77]
    v_lshl_add_u32 v138, v106, 2, v138
    ds_add_rtn_u32 v114, v138, v184 offset:5120
    v_cndmask_b32 v139, 0, v146, s[78:79]
    v_lshl_add_u32 v139, v107, 2, v139
    ds_add_rtn_u32 v115, v139, v184 offset:5120
    s_waitcnt vmcnt(0)
    v_mad_i32_i24 v128, v104, s65, v128
    v_mul_u32_u24 v194, s66, v96
    v_lshl_or_b32 v96, v128, 18, v96
    v_and_or_b32 v194, v194, s67, v144
    v_mad_u32_u24 v128, v104, 40, s69
    v_or_b32 v96, v96, v194
    v_mad_i32_i24 v129, v105, s65, v129
    v_mul_u32_u24 v194, s66, v97
    v_lshl_or_b32 v97, v129, 18, v97
    v_and_or_b32 v194, v194, s67, v144
    v_mad_u32_u24 v129, v105, 40, s69
    v_or_b32 v97, v97, v194
    s_waitcnt lgkmcnt(3)
    s_mov_b64 exec, s[72:73]
    v_cmpx_le_u32 vcc, 132, v112
    ds_add_rtn_u32 v112, v136, v184 offset:4096
    s_waitcnt lgkmcnt(3)
    s_mov_b64 exec, s[74:75]
    v_cmpx_le_u32 vcc, 132, v113
    ds_add_rtn_u32 v113, v137, v184 offset:4096
    s_waitcnt lgkmcnt(3)
    s_mov_b64 exec, s[76:77]
    v_cmpx_le_u32 vcc, 132, v114
    ds_add_rtn_u32 v114, v138, v184 offset:4096
    s_waitcnt lgkmcnt(3)
    s_mov_b64 exec, s[78:79]
    v_cmpx_le_u32 vcc, 132, v115
    ds_add_rtn_u32 v115, v139, v184 offset:4096
    s_mov_b64 exec, -1
    v_mad_i32_i24 v130, v106, s65, v130
    v_mul_u32_u24 v194, s66, v98
    v_lshl_or_b32 v98, v130, 18, v98
    v_and_or_b32 v194, v194, s67, v144
    v_mad_u32_u24 v130, v106, 40, s69
    v_or_b32 v98, v98, v194
    v_mad_i32_i24 v131, v107, s65, v131
    v_mul_u32_u24 v194, s66, v99
    v_lshl_or_b32 v99, v131, 18, v99
    v_and_or_b32 v194, v194, s67, v144
    v_mad_u32_u24 v131, v107, 40, s69
    v_or_b32 v99, v99, v194
    s_waitcnt lgkmcnt(3)
    v_bfe_u32 v194, v112, 3, 5
    v_add_lshl_u32 v128, v194, v128, 2
    v_and_b32 v194, 3, v194
    v_mad_i32_i24 v194, v194, -3, v128
    v_cmpx_gt_u32 vcc, 792, v112
    ds_write_b32 v128, v96
    ds_write_b8 v194, v120 offset:12
    s_mov_b64 exec, -1
    s_waitcnt lgkmcnt(4)
    v_bfe_u32 v194, v113, 3, 5
    v_add_lshl_u32 v129, v194, v129, 2
    v_and_b32 v194, 3, v194
    v_mad_i32_i24 v194, v194, -3, v129
    v_cmpx_gt_u32 vcc, 792, v113
    ds_write_b32 v129, v97
    ds_write_b8 v194, v121 offset:12
    s_mov_b64 exec, -1
    s_waitcnt lgkmcnt(5)
    v_bfe_u32 v194, v114, 3, 5
    v_add_lshl_u32 v130, v194, v130, 2
    v_and_b32 v194, 3, v194
    v_mad_i32_i24 v194, v194, -3, v130
    v_cmpx_gt_u32 vcc, 792, v114
    ds_write_b32 v130, v98
    ds_write_b8 v194, v122 offset:12
    s_mov_b64 exec, -1
    s_waitcnt lgkmcnt(6)
    v_bfe_u32 v194, v115, 3, 5
    v_add_lshl_u32 v131, v194, v131, 2
    v_and_b32 v194, 3, v194
    v_mad_i32_i24 v194, v194, -3, v131
    v_cmpx_gt_u32 vcc, 792, v115
    ds_write_b32 v131, v99
    ds_write_b8 v194, v123 offset:12
    s_mov_b64 exec, -1
L_B1:
    s_cmp_ge_u32 s3, 2
    s_cbranch_scc1 L_NOC
    global_load_dwordx4 v[176:179], v232, s[28:29]
L_NOC:
    global_load_dwordx4 v[160:163], v232, s[26:27]
    global_load_dwordx4 v[164:167], v232, s[32:33]
    global_load_dwordx4 v[168:171], v232, s[24:25]
    global_load_dwordx4 v[172:175], v232, s[30:31]
    s_add_u32 s6, s6, 0x2020202
    v_lshlrev_b32 v186, v246, s6
    v_and_b32 v194, 4, v253
    v_mul_u32_u24 v194, 1212416, v194
    v_lshl_add_u32 v186, v194, 8, v186
    v_and_b32 v186, 0xfe000000, v186
    v_and_b32 v187, 7, v253
    v_mul_u32_u24 v187, 33, v187
    v_add_u32 v187, 792, v187
    v_lshlrev_b32 v222, 2, v223
    s_mov_b32 s64, 0x1000000
    s_waitcnt lgkmcnt(0)
    s_barrier
    ds_read_b128 v[192:195], v185 offset:5120
    ds_read_b32 v228, v222 offset:5120
    ds_read_b128 v[204:207], v221 offset:0
    ds_read_b32 v229, v222 offset:5376
    ds_read_b128 v[208:211], v221 offset:10240
    ds_read_b32 v230, v222 offset:5632
    ds_read_b128 v[212:215], v221 offset:20480
    ds_read_b32 v231, v222 offset:5888
    ds_read_b128 v[216:219], v221 offset:30720
    s_mov_b32 s80, 2105344
    s_mov_b32 s81, 4210688
    s_mov_b32 s82, 6316032
    s_waitcnt lgkmcnt(8)
    v_max3_u32 v188, v192, v193, v194
    v_max_u32 v188, v188, v195
    v_cmp_lt_u32 vcc, 1056, v188
    s_cbranch_vccnz L_POVF
L_POUT:
    s_waitcnt lgkmcnt(7)
    v_sub_u32 v228, v187, v228
    v_and_or_b32 v228, v228, s64, v186
    s_waitcnt lgkmcnt(6)
    v_or_b32 v207, v207, v228
    buffer_store_dwordx4 v[204:207], v220, s[56:59], 0 offen sc1
    s_waitcnt lgkmcnt(5)
    v_sub_u32 v229, v187, v229
    v_and_or_b32 v229, v229, s64, v186
    s_waitcnt lgkmcnt(4)
    v_or_b32 v211, v211, v229
    buffer_store_dwordx4 v[208:211], v220, s[56:59], s80 offen sc1
    s_waitcnt lgkmcnt(3)
    v_sub_u32 v230, v187, v230
    v_and_or_b32 v230, v230, s64, v186
    s_waitcnt lgkmcnt(2)
    v_or_b32 v215, v215, v230
    buffer_store_dwordx4 v[212:215], v220, s[56:59], s81 offen sc1
    s_waitcnt lgkmcnt(1)
    v_sub_u32 v231, v187, v231
    v_and_or_b32 v231, v231, s64, v186
    s_waitcnt lgkmcnt(0)
    v_or_b32 v219, v219, v231
    buffer_store_dwordx4 v[216:219], v220, s[56:59], s82 offen sc1
    s_mov_b32 s10, 0xbfb8aa3b
    s_mov_b32 s11, s10
    s_mov_b32 s64, 0x05040100
    s_mov_b32 s66, 0x07060302
    s_waitcnt vmcnt(4)
    v_perm_b32 v144, v170, v168, s64
    v_perm_b32 v145, v170, v168, s66
    v_perm_b32 v146, v171, v169, s64
    v_perm_b32 v147, v171, v169, s66
    v_add_u32 v148, 77824, v224
    ds_write2_b32 v148, v144, v145 offset0:0 offset1:8
    ds_write2_b32 v148, v146, v147 offset0:16 offset1:24
    v_lshlrev_b32 v128, 16, v160
    v_and_b32 v129, 0xffff0000, v160
    v_lshlrev_b32 v130, 16, v161
    v_and_b32 v131, 0xffff0000, v161
    v_lshlrev_b32 v132, 16, v162
    v_and_b32 v133, 0xffff0000, v162
    v_lshlrev_b32 v134, 16, v163
    v_and_b32 v135, 0xffff0000, v163
    v_pk_mul_f32 v[128:129], v[128:129], s[10:11]
    v_pk_mul_f32 v[130:131], v[130:131], s[10:11]
    v_pk_mul_f32 v[132:133], v[132:133], s[10:11]
    v_pk_mul_f32 v[134:135], v[134:135], s[10:11]
    v_cvt_pk_bf16_f32 v136, v128, v132
    v_cvt_pk_bf16_f32 v137, v129, v133
    v_cvt_pk_bf16_f32 v138, v130, v134
    v_cvt_pk_bf16_f32 v139, v131, v135
    ds_write2_b32 v224, v136, v137 offset0:0 offset1:8
    ds_write2_b32 v224, v138, v139 offset0:16 offset1:24
    v_perm_b32 v152, v166, v164, s64
    v_perm_b32 v153, v166, v164, s66
    v_perm_b32 v154, v167, v165, s64
    v_perm_b32 v155, v167, v165, s66
    v_add_u32 v156, 10240, v224
    ds_write2_b32 v156, v152, v153 offset0:0 offset1:8
    ds_write2_b32 v156, v154, v155 offset0:16 offset1:24
    v_perm_b32 v144, v174, v172, s64
    v_perm_b32 v145, v174, v172, s66
    v_perm_b32 v146, v175, v173, s64
    v_perm_b32 v147, v175, v173, s66
    v_add_u32 v148, 130176, v224
    ds_write2_b32 v148, v144, v145 offset0:0 offset1:8
    ds_write2_b32 v148, v146, v147 offset0:16 offset1:24
    s_cmp_ge_u32 s3, 2
    s_cbranch_scc1 L_NOWC
    v_lshlrev_b32 v128, 16, v176
    v_and_b32 v129, 0xffff0000, v176
    v_lshlrev_b32 v130, 16, v177
    v_and_b32 v131, 0xffff0000, v177
    v_lshlrev_b32 v132, 16, v178
    v_and_b32 v133, 0xffff0000, v178
    v_lshlrev_b32 v134, 16, v179
    v_and_b32 v135, 0xffff0000, v179
    v_pk_mul_f32 v[128:129], v[128:129], s[10:11]
    v_pk_mul_f32 v[130:131], v[130:131], s[10:11]
    v_pk_mul_f32 v[132:133], v[132:133], s[10:11]
    v_pk_mul_f32 v[134:135], v[134:135], s[10:11]
    v_cvt_pk_bf16_f32 v136, v128, v132
    v_cvt_pk_bf16_f32 v137, v129, v133
    v_cvt_pk_bf16_f32 v138, v130, v134
    v_cvt_pk_bf16_f32 v139, v131, v135
    v_add_u32 v140, 20480, v224
    ds_write2_b32 v140, v136, v137 offset0:0 offset1:8
    ds_write2_b32 v140, v138, v139 offset0:16 offset1:24
L_NOWC:
    s_mul_i32 s34, s5, 32896
    s_add_u32 s34, s34, 65536
    s_add_u32 s56, s38, s34
    s_addc_u32 s57, s39, 0
    s_mov_b32 s58, 32768
    s_mov_b32 s59, 0x20000
    s_add_u32 s34, s34, 8421376
    s_add_u32 s60, s38, s34
    s_addc_u32 s61, s39, 0
    s_mov_b32 s62, 32768
    s_mov_b32 s63, 0x20000
    s_movk_i32 s26, 8192
    s_movk_i32 s27, 16384
    s_movk_i32 s28, 24576
    s_waitcnt lgkmcnt(0)
    s_barrier
    v_add_u32 v225, 13312, v225
    ds_read_b64_tr_b16 v[0:1], v225 offset:0
    ds_read_b64_tr_b16 v[2:3], v225 offset:1280
    ds_read_b64_tr_b16 v[4:5], v225 offset:5120
    ds_read_b64_tr_b16 v[6:7], v225 offset:6400
    ds_read_b64_tr_b16 v[8:9], v225 offset:32
    ds_read_b64_tr_b16 v[10:11], v225 offset:1312
    ds_read_b64_tr_b16 v[12:13], v225 offset:5152
    ds_read_b64_tr_b16 v[14:15], v225 offset:6432
    ds_read_b64_tr_b16 v[16:17], v225 offset:64
    ds_read_b64_tr_b16 v[18:19], v225 offset:1344
    ds_read_b64_tr_b16 v[20:21], v225 offset:5184
    ds_read_b64_tr_b16 v[22:23], v225 offset:6464
    ds_read_b64_tr_b16 v[24:25], v225 offset:96
    ds_read_b64_tr_b16 v[26:27], v225 offset:1376
    v_mov_b64 v[64:65], 0
    v_mov_b64 v[66:67], 0
    v_mov_b32 v68, 0x20fffff
    v_mov_b32 v69, 0x20fffff
    v_mov_b32 v70, 0x20fffff
    v_mov_b32 v71, 0x20fffff
    v_lshl_add_u32 v72, v253, 4, s12
    ds_write_b128 v72, v[64:67] offset:0
    ds_write_b128 v72, v[68:71] offset:18432
    ds_write_b128 v72, v[64:67] offset:1024
    ds_write_b128 v72, v[68:71] offset:19456
    ds_write_b128 v72, v[64:67] offset:1280
    ds_write_b128 v72, v[68:71] offset:19712
    ds_read_b64_tr_b16 v[28:29], v225 offset:5216
    ds_read_b64_tr_b16 v[30:31], v225 offset:6496
    ds_read_b64_tr_b16 v[32:33], v225 offset:10240
    ds_read_b64_tr_b16 v[34:35], v225 offset:11520
    ds_read_b64_tr_b16 v[36:37], v225 offset:15360
    ds_read_b64_tr_b16 v[38:39], v225 offset:16640
    ds_read_b64_tr_b16 v[40:41], v225 offset:10272
    ds_read_b64_tr_b16 v[42:43], v225 offset:11552
    ds_read_b64_tr_b16 v[44:45], v225 offset:15392
    ds_read_b64_tr_b16 v[46:47], v225 offset:16672
    v_mov_b32 v192, v225
    s_mov_b32 exec_lo, 0
    v_subrev_u32 v192, 2560, v225
    s_mov_b32 exec_lo, -1
    s_waitcnt lgkmcnt(4)
    ds_read_b64_tr_b16 v[48:49], v225 offset:10304
    ds_read_b64_tr_b16 v[50:51], v225 offset:11584
    ds_read_b64_tr_b16 v[52:53], v225 offset:15424
    ds_read_b64_tr_b16 v[54:55], v225 offset:16704
    ds_read_b64_tr_b16 v[56:57], v225 offset:10336
    ds_read_b64_tr_b16 v[58:59], v225 offset:11616
    ds_read_b64_tr_b16 v[60:61], v225 offset:15456
    ds_read_b64_tr_b16 v[62:63], v225 offset:16736
    ds_read_b64_tr_b16 v[80:81], v192 offset:20480
    ds_read_b64_tr_b16 v[82:83], v192 offset:21760
    ds_read_b64_tr_b16 v[84:85], v192 offset:20512
    ds_read_b64_tr_b16 v[86:87], v192 offset:21792
    ds_read_b64_tr_b16 v[88:89], v192 offset:20544
    ds_read_b64_tr_b16 v[90:91], v192 offset:21824
    ds_read_b64_tr_b16 v[92:93], v192 offset:20576
    ds_read_b64_tr_b16 v[94:95], v192 offset:21856
    v_add_u32 v225, 77824, v225
    v_and_b32 v241, 1, v253
    v_lshlrev_b32 v241, 4, v241
    s_bitcmp1_b32 s4, 0
    s_cselect_b32 s10, 1, -1
    s_lshl_b32 s10, s10, 24
    s_or_b32 s10, s10, 0xdddd
    v_mov_b32 v242, s10
    v_and_b32 v245, 16, v253
    v_and_b32 v194, 15, v253
    v_lshl_add_u32 v194, v194, 5, s14
    s_mov_b32 exec_hi, 0
    v_add_u32 v245, v245, v194
    s_mov_b32 exec_hi, -1
    v_and_b32 v194, 3, v253
    v_bfe_u32 v196, v253, 2, 2
    v_and_b32 v197, 48, v253
    v_lshl_add_u32 v198, v196, 7, v197
    v_mul_u32_u24 v244, 1056, v194
    v_add3_u32 v244, v244, v198, s13
    v_lshrrev_b32 v194, 3, v253
    v_lshl_add_u32 v247, v194, 4, s12
    s_add_u32 s10, s12, 18432
    v_lshrrev_b32 v194, 1, v253
    v_lshl_add_u32 v248, v194, 2, s10
    s_add_u32 s10, s10, 2
    v_and_b32 v194, 48, v253
    v_lshl_add_u32 v250, v194, 1, s10
    v_and_b32 v194, 12, v253
    v_add_u32 v250, v250, v194
    v_lshrrev_b32 v194, 5, v253
    v_mul_u32_u24 v249, 18432, v194
    v_and_b32 v194, 15, v253
    v_lshl_add_u32 v249, v194, 2, v249
    s_add_u32 s10, s12, 2
    v_add_u32 v249, s10, v249
    v_mul_u32_u24 v156, 3128, v223
    v_add_u32 v157, 200192, v156
    v_add_u32 v158, 400384, v156
    v_add_u32 v159, 600576, v156
    s_mov_b32 s98, 0xf0f0f0f
    s_mov_b32 s99, 0xf0f0f0f
    v_mov_b32 v180, 0xfffff
    v_cndmask_b32 v176, 0, v180, s[98:99]
    v_add_lshl_u32 v191, v232, v243, 16
    v_add_u32 v152, 0x34000000, v191
    v_cndmask_b32 v152, 0, v152, s[98:99]
    v_add_u32 v153, 0x54000000, v191
    v_cndmask_b32 v153, 0, v153, s[98:99]
    v_add_u32 v154, 0x74000000, v191
    v_cndmask_b32 v154, 0, v154, s[98:99]
    v_add_u32 v155, 0x94000000, v191
    v_cndmask_b32 v155, 0, v155, s[98:99]
    v_mov_b32 v184, 4
    v_and_b32 v177, 31, v253
    v_add_lshl_u32 v179, v177, s7, 2
    v_lshrrev_b32 v191, 5, v253
    v_lshl_add_u32 v178, v191, 11, v179
    v_add_u32 v179, 153728, v179
    v_lshlrev_b32 v191, 2, v253
    v_subrev_u32 v191, s7, v191
    s_mov_b32 s10, 0x10000
    v_add_u32 v228, 0, v191
    v_and_or_b32 v228, v228, s10, 1
    v_add_u32 v229, 1, v191
    v_and_or_b32 v229, v229, s10, 1
    v_add_u32 v230, 2, v191
    v_and_or_b32 v230, v230, s10, 1
    v_add_u32 v231, 3, v191
    v_and_or_b32 v231, v231, s10, 1
    s_movk_i32 s18, 0xffc
    s_movk_i32 s20, 32
    s_mov_b32 s21, 0
    s_mov_b32 s100, 0
    s_mov_b32 s16, 0x1ffffff
    s_mov_b32 s17, 0xffff
    s_mul_i32 s10, s4, 49
    s_sub_i32 s22, s10, 6
    s_ashr_i32 s22, s22, 1
    s_add_i32 s23, s10, 7
    s_ashr_i32 s23, s23, 1
    s_add_i32 s24, s10, 43
    s_ashr_i32 s24, s24, 1
    s_add_i32 s25, s22, 31
    s_cmp_eq_u32 s4, 7
    s_cselect_b32 s24, 196, s24
    s_cselect_b32 s25, 196, s25
    s_sub_i32 s23, s23, s7
    s_sub_i32 s24, s24, s7
    s_sub_i32 s25, s25, s7
    s_waitcnt vmcnt(0)
    buffer_load_dwordx4 v[128:131], v232, s[56:59], 0 offen sc1
    buffer_load_dwordx4 v[132:135], v232, s[56:59], s26 offen sc1
    buffer_load_dwordx4 v[136:139], v232, s[56:59], s27 offen sc1
    buffer_load_dwordx4 v[140:143], v232, s[56:59], s28 offen sc1
    v_max3_u32 v188, v112, v113, v114
    v_max3_u32 v189, v115, v116, v117
    v_max3_u32 v188, v188, v118, v119
    v_max_u32 v188, v188, v189
    v_cmp_le_u32 vcc, 792, v188
    s_cbranch_vccz L_PEXTR
    v_mov_b32 v65, s6
    s_lshl_b32 s34, s2, 7
    s_add_u32 s34, s34, 8486912
    v_subrev_u32 v68, 792, v112
    v_cmpx_gt_u32 vcc, 264, v68
    s_cbranch_execz L_PE0
    v_mov_b32 v64, v96
    v_mov_b32 v66, v120
    v_bfe_u32 v68, v112, 5, 3
    v_lshlrev_b32 v68, 4, v68
    v_mad_u32_u24 v68, v104, s68, v68
    buffer_store_dwordx4 v[64:67], v68, s[52:55], s34 offen sc1
L_PE0:
    s_mov_b64 exec, -1
    v_subrev_u32 v68, 792, v113
    v_cmpx_gt_u32 vcc, 264, v68
    s_cbranch_execz L_PE1
    v_mov_b32 v64, v97
    v_mov_b32 v66, v121
    v_bfe_u32 v68, v113, 5, 3
    v_lshlrev_b32 v68, 4, v68
    v_mad_u32_u24 v68, v105, s68, v68
    buffer_store_dwordx4 v[64:67], v68, s[52:55], s34 offen sc1
L_PE1:
    s_mov_b64 exec, -1
    v_subrev_u32 v68, 792, v114
    v_cmpx_gt_u32 vcc, 264, v68
    s_cbranch_execz L_PE2
    v_mov_b32 v64, v98
    v_mov_b32 v66, v122
    v_bfe_u32 v68, v114, 5, 3
    v_lshlrev_b32 v68, 4, v68
    v_mad_u32_u24 v68, v106, s68, v68
    buffer_store_dwordx4 v[64:67], v68, s[52:55], s34 offen sc1
L_PE2:
    s_mov_b64 exec, -1
    v_subrev_u32 v68, 792, v115
    v_cmpx_gt_u32 vcc, 264, v68
    s_cbranch_execz L_PE3
    v_mov_b32 v64, v99
    v_mov_b32 v66, v123
    v_bfe_u32 v68, v115, 5, 3
    v_lshlrev_b32 v68, 4, v68
    v_mad_u32_u24 v68, v107, s68, v68
    buffer_store_dwordx4 v[64:67], v68, s[52:55], s34 offen sc1
L_PE3:
    s_mov_b64 exec, -1
    v_subrev_u32 v68, 792, v116
    v_cmpx_gt_u32 vcc, 264, v68
    s_cbranch_execz L_PE4
    v_mov_b32 v64, v100
    v_mov_b32 v66, v120
    v_bfe_u32 v68, v116, 5, 3
    v_lshlrev_b32 v68, 4, v68
    v_mad_u32_u24 v68, v108, s68, v68
    buffer_store_dwordx4 v[64:67], v68, s[52:55], s34 offen sc1
L_PE4:
    s_mov_b64 exec, -1
    v_subrev_u32 v68, 792, v117
    v_cmpx_gt_u32 vcc, 264, v68
    s_cbranch_execz L_PE5
    v_mov_b32 v64, v101
    v_mov_b32 v66, v121
    v_bfe_u32 v68, v117, 5, 3
    v_lshlrev_b32 v68, 4, v68
    v_mad_u32_u24 v68, v109, s68, v68
    buffer_store_dwordx4 v[64:67], v68, s[52:55], s34 offen sc1
L_PE5:
    s_mov_b64 exec, -1
    v_subrev_u32 v68, 792, v118
    v_cmpx_gt_u32 vcc, 264, v68
    s_cbranch_execz L_PE6
    v_mov_b32 v64, v102
    v_mov_b32 v66, v122
    v_bfe_u32 v68, v118, 5, 3
    v_lshlrev_b32 v68, 4, v68
    v_mad_u32_u24 v68, v110, s68, v68
    buffer_store_dwordx4 v[64:67], v68, s[52:55], s34 offen sc1
L_PE6:
    s_mov_b64 exec, -1
    v_subrev_u32 v68, 792, v119
    v_cmpx_gt_u32 vcc, 264, v68
    s_cbranch_execz L_PE7
    v_mov_b32 v64, v103
    v_mov_b32 v66, v123
    v_bfe_u32 v68, v119, 5, 3
    v_lshlrev_b32 v68, 4, v68
    v_mad_u32_u24 v68, v111, s68, v68
    buffer_store_dwordx4 v[64:67], v68, s[52:55], s34 offen sc1
L_PE7:
    s_mov_b64 exec, -1
L_PEXTR:
L_PW0:
    s_waitcnt vmcnt(3)
    v_xor_b32 v188, v131, v186
    v_and_b32_sdwa v96, v128, s18 dst_sel:DWORD dst_unused:UNUSED_PAD src0_sel:WORD_1 src1_sel:DWORD
    v_and_b32_sdwa v97, v129, s18 dst_sel:DWORD dst_unused:UNUSED_PAD src0_sel:WORD_1 src1_sel:DWORD
    v_and_b32_sdwa v98, v130, s18 dst_sel:DWORD dst_unused:UNUSED_PAD src0_sel:WORD_1 src1_sel:DWORD
    v_cmp_lt_u32 vcc, s16, v188
    v_cmp_ne_u32 s[64:65], 0, v128
    v_cmp_ne_u32 s[66:67], 0, v129
    v_cmp_ne_u32 s[68:69], 0, v130
    s_cbranch_vccnz L_RT0
    s_mov_b64 exec, s[64:65]
    ds_add_rtn_u32 v112, v96, v184 offset:1024
    s_mov_b64 exec, s[66:67]
    ds_add_rtn_u32 v113, v97, v184 offset:1024
    s_mov_b64 exec, s[68:69]
    ds_add_rtn_u32 v114, v98, v184 offset:1024
    s_mov_b64 exec, -1
    v_add_u32_sdwa v207, v131, v156 dst_sel:DWORD dst_unused:UNUSED_PAD src0_sel:BYTE_0 src1_sel:DWORD
    v_lshrrev_b32 v189, 28, v128
    v_lshl_add_u32 v207, v189, 8, v207
    v_and_b32 v189, 60, v96
    v_lshl_add_u32 v204, v189, 19, v207
    v_add_u32_sdwa v205, v131, v156 dst_sel:DWORD dst_unused:UNUSED_PAD src0_sel:BYTE_1 src1_sel:DWORD
    v_lshrrev_b32 v189, 28, v129
    v_lshl_add_u32 v205, v189, 8, v205
    v_and_b32 v189, 60, v97
    v_lshl_add_u32 v205, v189, 19, v205
    v_add_u32_sdwa v206, v131, v156 dst_sel:DWORD dst_unused:UNUSED_PAD src0_sel:BYTE_2 src1_sel:DWORD
    v_lshrrev_b32 v189, 28, v130
    v_lshl_add_u32 v206, v189, 8, v206
    v_and_b32 v189, 60, v98
    v_lshl_add_u32 v206, v189, 19, v206
    v_cndmask_b32 v188, v180, v207, s[64:65]
    v_and_or_b32 v128, v128, s17, v152
    v_or_b32 v204, v204, v176
    v_mov_b32_dpp v189, v188 quad_perm:[2,2,3,3] row_mask:0xf bank_mask:0xf
    v_mov_b32_dpp v207, v188 quad_perm:[0,0,1,1] row_mask:0xf bank_mask:0xf
    v_and_b32 v130, s17, v130
    v_mov_b32_dpp v207, v189 row_shr:4 row_mask:0xf bank_mask:0xa
L_PW1:
    s_waitcnt vmcnt(2)
    v_xor_b32 v188, v135, v186
    v_and_b32_sdwa v100, v132, s18 dst_sel:DWORD dst_unused:UNUSED_PAD src0_sel:WORD_1 src1_sel:DWORD
    v_and_b32_sdwa v101, v133, s18 dst_sel:DWORD dst_unused:UNUSED_PAD src0_sel:WORD_1 src1_sel:DWORD
    v_and_b32_sdwa v102, v134, s18 dst_sel:DWORD dst_unused:UNUSED_PAD src0_sel:WORD_1 src1_sel:DWORD
    v_cmp_lt_u32 vcc, s16, v188
    v_cmp_ne_u32 s[72:73], 0, v132
    v_cmp_ne_u32 s[74:75], 0, v133
    v_cmp_ne_u32 s[76:77], 0, v134
    s_cbranch_vccnz L_RT1
    s_mov_b64 exec, s[72:73]
    ds_add_rtn_u32 v116, v100, v184 offset:1024
    s_mov_b64 exec, s[74:75]
    ds_add_rtn_u32 v117, v101, v184 offset:1024
    s_mov_b64 exec, s[76:77]
    ds_add_rtn_u32 v118, v102, v184 offset:1024
    s_mov_b64 exec, -1
    v_add_u32_sdwa v211, v135, v157 dst_sel:DWORD dst_unused:UNUSED_PAD src0_sel:BYTE_0 src1_sel:DWORD
    v_lshrrev_b32 v189, 28, v132
    v_lshl_add_u32 v211, v189, 8, v211
    v_and_b32 v189, 60, v100
    v_lshl_add_u32 v208, v189, 19, v211
    v_add_u32_sdwa v209, v135, v157 dst_sel:DWORD dst_unused:UNUSED_PAD src0_sel:BYTE_1 src1_sel:DWORD
    v_lshrrev_b32 v189, 28, v133
    v_lshl_add_u32 v209, v189, 8, v209
    v_and_b32 v189, 60, v101
    v_lshl_add_u32 v209, v189, 19, v209
    v_add_u32_sdwa v210, v135, v157 dst_sel:DWORD dst_unused:UNUSED_PAD src0_sel:BYTE_2 src1_sel:DWORD
    v_lshrrev_b32 v189, 28, v134
    v_lshl_add_u32 v210, v189, 8, v210
    v_and_b32 v189, 60, v102
    v_lshl_add_u32 v210, v189, 19, v210
    v_cndmask_b32 v188, v180, v211, s[72:73]
    v_and_or_b32 v132, v132, s17, v153
    v_or_b32 v208, v208, v176
    v_mov_b32_dpp v189, v188 quad_perm:[2,2,3,3] row_mask:0xf bank_mask:0xf
    v_mov_b32_dpp v211, v188 quad_perm:[0,0,1,1] row_mask:0xf bank_mask:0xf
    v_and_b32 v134, s17, v134
    v_mov_b32_dpp v211, v189 row_shr:4 row_mask:0xf bank_mask:0xa
L_PW2:
    s_waitcnt vmcnt(1)
    v_xor_b32 v188, v139, v186
    v_and_b32_sdwa v104, v136, s18 dst_sel:DWORD dst_unused:UNUSED_PAD src0_sel:WORD_1 src1_sel:DWORD
    v_and_b32_sdwa v105, v137, s18 dst_sel:DWORD dst_unused:UNUSED_PAD src0_sel:WORD_1 src1_sel:DWORD
    v_and_b32_sdwa v106, v138, s18 dst_sel:DWORD dst_unused:UNUSED_PAD src0_sel:WORD_1 src1_sel:DWORD
    v_cmp_lt_u32 vcc, s16, v188
    v_cmp_ne_u32 s[80:81], 0, v136
    v_cmp_ne_u32 s[82:83], 0, v137
    v_cmp_ne_u32 s[84:85], 0, v138
    s_cbranch_vccnz L_RT2
    s_mov_b64 exec, s[80:81]
    ds_add_rtn_u32 v120, v104, v184 offset:1024
    s_mov_b64 exec, s[82:83]
    ds_add_rtn_u32 v121, v105, v184 offset:1024
    s_mov_b64 exec, s[84:85]
    ds_add_rtn_u32 v122, v106, v184 offset:1024
    s_mov_b64 exec, -1
    v_add_u32_sdwa v215, v139, v158 dst_sel:DWORD dst_unused:UNUSED_PAD src0_sel:BYTE_0 src1_sel:DWORD
    v_lshrrev_b32 v189, 28, v136
    v_lshl_add_u32 v215, v189, 8, v215
    v_and_b32 v189, 60, v104
    v_lshl_add_u32 v212, v189, 19, v215
    v_add_u32_sdwa v213, v139, v158 dst_sel:DWORD dst_unused:UNUSED_PAD src0_sel:BYTE_1 src1_sel:DWORD
    v_lshrrev_b32 v189, 28, v137
    v_lshl_add_u32 v213, v189, 8, v213
    v_and_b32 v189, 60, v105
    v_lshl_add_u32 v213, v189, 19, v213
    v_add_u32_sdwa v214, v139, v158 dst_sel:DWORD dst_unused:UNUSED_PAD src0_sel:BYTE_2 src1_sel:DWORD
    v_lshrrev_b32 v189, 28, v138
    v_lshl_add_u32 v214, v189, 8, v214
    v_and_b32 v189, 60, v106
    v_lshl_add_u32 v214, v189, 19, v214
    v_cndmask_b32 v188, v180, v215, s[80:81]
    v_and_or_b32 v136, v136, s17, v154
    v_or_b32 v212, v212, v176
    v_mov_b32_dpp v189, v188 quad_perm:[2,2,3,3] row_mask:0xf bank_mask:0xf
    v_mov_b32_dpp v215, v188 quad_perm:[0,0,1,1] row_mask:0xf bank_mask:0xf
    v_and_b32 v138, s17, v138
    v_mov_b32_dpp v215, v189 row_shr:4 row_mask:0xf bank_mask:0xa
L_PW3:
    s_waitcnt vmcnt(0)
    v_xor_b32 v188, v143, v186
    v_and_b32_sdwa v108, v140, s18 dst_sel:DWORD dst_unused:UNUSED_PAD src0_sel:WORD_1 src1_sel:DWORD
    v_and_b32_sdwa v109, v141, s18 dst_sel:DWORD dst_unused:UNUSED_PAD src0_sel:WORD_1 src1_sel:DWORD
    v_and_b32_sdwa v110, v142, s18 dst_sel:DWORD dst_unused:UNUSED_PAD src0_sel:WORD_1 src1_sel:DWORD
    v_cmp_lt_u32 vcc, s16, v188
    v_cmp_ne_u32 s[88:89], 0, v140
    v_cmp_ne_u32 s[90:91], 0, v141
    v_cmp_ne_u32 s[92:93], 0, v142
    s_cbranch_vccnz L_RT3
    s_mov_b64 exec, s[88:89]
    ds_add_rtn_u32 v124, v108, v184 offset:1024
    s_mov_b64 exec, s[90:91]
    ds_add_rtn_u32 v125, v109, v184 offset:1024
    s_mov_b64 exec, s[92:93]
    ds_add_rtn_u32 v126, v110, v184 offset:1024
    s_mov_b64 exec, -1
    v_or3_b32 v190, v131, v135, v139
    v_or_b32 v190, v190, v143
    v_and_b32 v190, 0x1000000, v190
    v_cmp_ne_u32 vcc, 0, v190
    s_cbranch_vccz L_XT1R
    v_and_b32 v190, 0x1000000, v131
    v_cmp_ne_u32 s[70:71], 0, v190
    s_bcnt1_i32_b64 s10, s[70:71]
    s_lshl2_add_u32 s21, s10, s21
    v_and_b32 v190, 0x1000000, v135
    v_cmp_ne_u32 s[78:79], 0, v190
    s_bcnt1_i32_b64 s10, s[78:79]
    s_lshl2_add_u32 s21, s10, s21
    v_and_b32 v190, 0x1000000, v139
    v_cmp_ne_u32 s[86:87], 0, v190
    s_bcnt1_i32_b64 s10, s[86:87]
    s_lshl2_add_u32 s21, s10, s21
    v_and_b32 v190, 0x1000000, v143
    v_cmp_ne_u32 s[94:95], 0, v190
    s_bcnt1_i32_b64 s10, s[94:95]
    s_lshl2_add_u32 s21, s10, s21
    s_mov_b64 exec, s[70:71]
    s_cbranch_execz L_XLa0
    s_movk_i32 s10, 0
    buffer_load_dwordx4 v[64:67], v232, s[60:63], s10 offen sc1
L_XLa0:
    s_mov_b64 exec, s[78:79]
    s_cbranch_execz L_XLa1
    s_movk_i32 s10, 8192
    buffer_load_dwordx4 v[68:71], v232, s[60:63], s10 offen sc1
L_XLa1:
    s_mov_b64 exec, s[86:87]
    s_cbranch_execz L_XLa2
    s_movk_i32 s10, 16384
    buffer_load_dwordx4 v[72:75], v232, s[60:63], s10 offen sc1
L_XLa2:
    s_mov_b64 exec, s[94:95]
    s_cbranch_execz L_XLa3
    s_movk_i32 s10, 24576
    buffer_load_dwordx4 v[76:79], v232, s[60:63], s10 offen sc1
L_XLa3:
    s_mov_b64 exec, -1
    v_or3_b32 v190, v129, v133, v137
    v_or_b32 v190, v190, v141
    v_and_b32 v190, 0x10000, v190
    v_mov_b32 v191, 640
    v_cmpx_ne_u32 vcc, 0, v190
    ds_write_b32 v191, v184 offset:4
    s_mov_b64 exec, 1
    v_mov_b32 v190, s21
    ds_add_u32 v191, v190 offset:8
    s_mov_b64 exec, -1
L_XT1R:
    v_add_u32_sdwa v219, v143, v159 dst_sel:DWORD dst_unused:UNUSED_PAD src0_sel:BYTE_0 src1_sel:DWORD
    v_lshrrev_b32 v189, 28, v140
    v_lshl_add_u32 v219, v189, 8, v219
    v_and_b32 v189, 60, v108
    v_lshl_add_u32 v216, v189, 19, v219
    v_add_u32_sdwa v217, v143, v159 dst_sel:DWORD dst_unused:UNUSED_PAD src0_sel:BYTE_1 src1_sel:DWORD
    v_lshrrev_b32 v189, 28, v141
    v_lshl_add_u32 v217, v189, 8, v217
    v_and_b32 v189, 60, v109
    v_lshl_add_u32 v217, v189, 19, v217
    v_add_u32_sdwa v218, v143, v159 dst_sel:DWORD dst_unused:UNUSED_PAD src0_sel:BYTE_2 src1_sel:DWORD
    v_lshrrev_b32 v189, 28, v142
    v_lshl_add_u32 v218, v189, 8, v218
    v_and_b32 v189, 60, v110
    v_lshl_add_u32 v218, v189, 19, v218
    v_cndmask_b32 v188, v180, v219, s[88:89]
    v_and_or_b32 v140, v140, s17, v155
    v_or_b32 v216, v216, v176
    v_mov_b32_dpp v189, v188 quad_perm:[2,2,3,3] row_mask:0xf bank_mask:0xf
    v_mov_b32_dpp v219, v188 quad_perm:[0,0,1,1] row_mask:0xf bank_mask:0xf
    v_and_b32 v142, s17, v142
    v_mov_b32_dpp v219, v189 row_shr:4 row_mask:0xf bank_mask:0xa
    v_mov_b32 v197, 640
    s_cmp_eq_u32 s3, 6
    s_cselect_b32 exec_hi, 0, -1
    s_cmp_eq_u32 s3, 7
    s_cselect_b64 exec, 1, exec
    s_add_u32 m0, s101, 0
    s_nop 0
    buffer_load_dwordx4 v234, s[40:43], 0 offen offset:0 lds
    s_add_u32 m0, s101, 6560
    s_nop 0
    buffer_load_dwordx4 v234, s[40:43], 0 offen offset:128 lds
    s_add_u32 m0, s101, 13120
    s_nop 0
    buffer_load_dwordx4 v234, s[40:43], 0 offen offset:256 lds
    s_add_u32 m0, s101, 19680
    s_nop 0
    buffer_load_dwordx4 v234, s[40:43], 0 offen offset:384 lds
    s_mov_b64 exec, -1
    s_waitcnt lgkmcnt(0)
    s_barrier
    ds_read_u16 v198, v178 offset:1024
    ds_read_u16 v199, v178 offset:2048
    ds_read_b128 v[160:163], v185 offset:1024
    ds_read_b128 v[164:167], v185 offset:2048
    ds_read_b128 v[168:171], v185 offset:3072
    ds_read_b128 v[172:175], v185 offset:4096
    ds_read_b32 v236, v197 offset:8
    s_lshl_b32 m0, s3, 10
    v_mov_b32 v240, v207
    s_add_u32 m0, m0, 13312
    s_nop 0
    buffer_load_dwordx4 v[240:241], s[44:47], 0 idxen offen lds
    s_cmp_lg_u32 s2, 0
    s_cbranch_scc1 L_NOK
    v_mov_b32 v237, s6
    v_mov_b32 v238, 0
    buffer_store_dword v237, v238, s[52:55], 0 offen sc1
L_NOK:
    s_waitcnt lgkmcnt(5)
    v_lshl_or_b32 v198, v199, 16, v198
    v_mov_b32 v199, v198
    s_waitcnt lgkmcnt(0)
    v_add_u32_sdwa v188, v160, v164 dst_sel:DWORD dst_unused:UNUSED_PAD src0_sel:WORD_0 src1_sel:WORD_0
    v_add_u32_sdwa v192, v168, v172 dst_sel:DWORD dst_unused:UNUSED_PAD src0_sel:WORD_0 src1_sel:WORD_0
    v_add_u32_dpp v199, v199, v199 row_shr:1 row_mask:0xf bank_mask:0xf bound_ctrl:0
    v_add_u32_sdwa v189, v161, v165 dst_sel:DWORD dst_unused:UNUSED_PAD src0_sel:WORD_0 src1_sel:WORD_0
    v_add_u32_sdwa v193, v169, v173 dst_sel:DWORD dst_unused:UNUSED_PAD src0_sel:WORD_0 src1_sel:WORD_0
    v_add_u32_dpp v199, v199, v199 row_shr:2 row_mask:0xf bank_mask:0xf bound_ctrl:0
    v_add_u32_sdwa v190, v162, v166 dst_sel:DWORD dst_unused:UNUSED_PAD src0_sel:WORD_0 src1_sel:WORD_0
    v_add_u32_sdwa v194, v170, v174 dst_sel:DWORD dst_unused:UNUSED_PAD src0_sel:WORD_0 src1_sel:WORD_0
    v_add_u32_dpp v199, v199, v199 row_shr:4 row_mask:0xf bank_mask:0xf bound_ctrl:0
    v_add_u32_sdwa v191, v163, v167 dst_sel:DWORD dst_unused:UNUSED_PAD src0_sel:WORD_0 src1_sel:WORD_0
    v_add_u32_sdwa v195, v171, v175 dst_sel:DWORD dst_unused:UNUSED_PAD src0_sel:WORD_0 src1_sel:WORD_0
    v_add_u32_dpp v199, v199, v199 row_shr:8 row_mask:0xf bank_mask:0xf bound_ctrl:0
    v_add_u32 v188, v188, v192
    v_add_u32 v189, v189, v193
    v_add_u32_dpp v199, v199, v199 row_bcast:15 row_mask:0xa bank_mask:0xf
    v_add_u32 v190, v190, v194
    v_add_u32 v191, v191, v195
    v_mul_u32_u24 v196, v188, v228
    v_mad_u32_u24 v196, v189, v229, v196
    v_mad_u32_u24 v196, v190, v230, v196
    v_mad_u32_u24 v196, v191, v231, v196
    s_mov_b32 s96, -1
    s_mov_b32 s97, 0
    v_sub_u32 v200, v199, v198
    v_add_u32_sdwa v202, v199, v199 dst_sel:DWORD dst_unused:UNUSED_PAD src0_sel:WORD_0 src1_sel:WORD_1
    v_add_u32_dpp v196, v196, v196 row_shr:1 row_mask:0xf bank_mask:0xf bound_ctrl:0
    v_add_u32_sdwa v201, v200, v200 dst_sel:DWORD dst_unused:UNUSED_PAD src0_sel:WORD_0 src1_sel:WORD_1
    v_add_u32_sdwa v203, v198, v198 dst_sel:DWORD dst_unused:UNUSED_PAD src0_sel:WORD_0 src1_sel:WORD_1
    v_add_u32_dpp v196, v196, v196 row_shr:2 row_mask:0xf bank_mask:0xf bound_ctrl:0
    v_and_b32 v129, s17, v129
    v_readfirstlane_b32 s19, v236
    v_add_u32_dpp v196, v196, v196 row_shr:4 row_mask:0xf bank_mask:0xf bound_ctrl:0
    v_permlane32_swap_b32 v201, v202
    v_cndmask_b32 v203, 0, v203, s[96:97]
    v_add_u32_dpp v196, v196, v196 row_shr:8 row_mask:0xf bank_mask:0xf bound_ctrl:0
    v_add_u32 v201, v201, v202
    v_and_b32 v133, s17, v133
    v_add_u32_dpp v196, v196, v196 row_bcast:15 row_mask:0xa bank_mask:0xf
    v_add_u32 v202, v201, v203
    v_and_b32 v137, s17, v137
    v_add_u32_dpp v196, v196, v196 row_bcast:31 row_mask:0xc bank_mask:0xf
    v_sub_u32_sdwa v203, v202, v198 dst_sel:DWORD dst_unused:UNUSED_PAD src0_sel:DWORD src1_sel:WORD_1
    v_readlane_b32 s16, v196, 63
    s_lshl_b32 m0, s3, 10
    v_mov_b32 v240, v211
    s_add_u32 m0, m0, 21504
    s_nop 0
    buffer_load_dwordx4 v[240:241], s[44:47], 0 idxen offen lds
    s_bfe_u32 s10, s16, 0xe0002
    s_lshr_b32 s16, s16, 16
    s_lshr_b32 s11, s10, 1
    s_add_u32 s11, s11, 48
    s_and_b32 s11, s11, -128
    s_lshr_b32 s8, s4, 1
    s_mul_i32 s8, s8, s10
    s_sub_i32 s11, s11, 48
    s_sub_i32 s8, s8, s16
    s_add_i32 s11, s11, s8
    s_add_i32 s10, s10, s8
    s_bitcmp1_b32 s4, 0
    s_cselect_b32 s31, s11, s8
    s_cselect_b32 s10, s10, s11
    v_cmp_gt_i32 vcc, s31, v202
    v_cmp_gt_i32 s[34:35], s10, v202
    s_bcnt1_i32_b32 s22, vcc_lo
    s_bcnt1_i32_b32 s10, s34
    s_min_i32 s22, s22, s23
    s_max_i32 s10, s10, s24
    s_min_i32 s23, s10, s25
    v_readlane_b32 s16, v201, s22
    v_readlane_b32 s30, v201, s23
    s_add_u32 s8, s22, s7
    s_add_u32 s9, s23, s7
    s_add_u32 s10, s22, 32
    s_add_u32 s11, s23, 32
    v_readlane_b32 s26, v200, s22
    v_readlane_b32 s28, v200, s23
    v_readlane_b32 s27, v200, s10
    v_readlane_b32 s29, v200, s11
    s_sub_u32 s31, s30, s16
    s_add_u32 s10, s31, 255
    s_lshr_b32 s10, s10, 8
    s_lshl_b32 s10, s10, 7
    s_sub_u32 s10, s10, s19
    s_max_i32 s10, s10, 0
    s_add_u32 s16, s16, s10
    s_add_u32 s10, s22, 16
    s_min_u32 s10, s10, s23
    s_sub_i32 s11, s23, 16
    v_cmp_ge_u32 s[34:35], s16, v203
    v_cmp_ge_u32 s[36:37], s16, v202
    v_cmp_gt_i32 vcc, s10, v177
    v_cmp_gt_i32 s[10:11], s11, v177
    v_cmp_le_u32 s[32:33], s22, v177
    v_cmp_gt_u32 s[96:97], s23, v177
    s_and_b64 s[34:35], s[34:35], vcc
    s_and_b64 s[36:37], s[36:37], vcc
    s_or_b64 s[34:35], s[34:35], s[10:11]
    s_or_b64 s[36:37], s[36:37], s[10:11]
    s_bcnt1_i32_b32 s24, s34
    s_bcnt1_i32_b32 s10, s36
    s_bcnt1_i32_b32 s11, s35
    s_bcnt1_i32_b32 s25, s37
    v_readlane_b32 s22, v200, s24
    v_readlane_b32 s10, v200, s10
    s_add_u32 s11, s11, 32
    s_add_u32 s16, s25, 32
    v_readlane_b32 s23, v200, s11
    v_readlane_b32 s11, v200, s16
    v_mov_b32 v188, s17
    v_cndmask_b32 v189, 0, v188, s[34:35]
    v_cndmask_b32 v188, 0, v188, s[36:37]
    s_and_b64 s[32:33], s[32:33], s[96:97]
    s_pack_lh_b32_b16 s22, s22, s10
    s_pack_lh_b32_b16 s23, s23, s11
    v_lshl_or_b32 v188, v188, 16, v189
    s_sub_u32 s16, s12, 37888
    s_pack_ll_b32_b16 s16, s16, s16
    s_sub_u32 s10, s22, s26
    s_sub_u32 s11, s23, s27
    s_mul_i32 s10, s10, 0x10001
    s_lshl_b32 vcc_lo, s10, 16
    s_pack_hh_b32_b16 s10, s10, s10
    s_lshl_b32 vcc_hi, s11, 16
    s_add_u32 vcc_hi, vcc_hi, s10
    s_add_u32 s96, vcc_hi, s11
    s_lshr_b32 s96, s96, 16
    s_sub_u32 s31, s31, s96
    s_cmp_gt_u32 s31, s96
    s_cselect_b32 s97, 0x4800480, 0
    s_add_u32 s16, s16, s97
    s_sub_u32 s10, s16, s26
    s_sub_u32 s11, s16, s27
    s_add_u32 s10, s10, vcc_lo
    s_add_u32 s11, s11, vcc_hi
    v_mov_b32 v192, s10
    v_mov_b32 v193, s11
    s_add_u32 s16, s16, 0x4800480
    s_sub_u32 s16, s16, s97
    s_sub_u32 s16, s16, s97
    s_sub_u32 s10, s28, s22
    s_sub_u32 s11, s29, s23
    s_mul_i32 s10, s10, 0x10001
    s_lshl_b32 vcc_lo, s10, 16
    s_pack_hh_b32_b16 s10, s10, s10
    s_lshl_b32 vcc_hi, s11, 16
    s_add_u32 vcc_hi, vcc_hi, s10
    s_sub_u32 s10, s16, s22
    s_sub_u32 s11, s16, s23
    s_add_u32 s10, s10, vcc_lo
    s_add_u32 s11, s11, vcc_hi
    v_mov_b32 v194, s10
    v_mov_b32 v195, s11
    v_bfi_b32 v192, v188, v192, v194
    v_bfi_b32 v193, v188, v193, v195
    s_mov_b32 exec_hi, 0
    v_mov_b32 v193, v192
    s_mov_b64 exec, s[32:33]
    v_add_u32 v200, v200, v193
    s_bfe_u32 s10, s97, 0x10007
    s_lshl1_add_u32 s10, s4, s10
    s_lshl_b32 s10, s10, 2
    v_cndmask_b32 v188, 4, 0, s[34:35]
    ds_write_b16 v178, v200 offset:1026
    ds_write_b16_d16_hi v178, v200 offset:2050
    s_mov_b32 exec_hi, 0
    v_xor_b32 v188, s10, v188
    ds_write_b32 v179, v188
    s_mov_b64 exec, -1
    s_min_u32 s10, s31, s96
    s_max_u32 s96, s31, s96
    s_mov_b32 s31, s10
    s_add_u32 s10, s96, s19
    s_mul_i32 s11, s30, 9216
    s_lshr_b32 s11, s11, 16
    s_max_u32 s10, s10, s11
    s_cmp_lt_u32 s10, 1152
    s_cbranch_scc1 L_LFIT
    ds_write_b32 v197, v184
L_LFIT:
    s_cmp_eq_u32 s19, 0
    s_cbranch_scc1 L_XCNR
    s_sub_u32 s10, s12, 37888
    s_add_u32 s11, s10, s96
    v_mov_b32 v188, s11
    s_add_u32 s11, s10, s31
    s_add_u32 s11, s11, 1152
    v_mov_b32 v189, s11
    s_lshl_b32 s10, s4, 3
    v_mov_b32 v190, s10
    ds_write_b64 v190, v[188:189] offset:576
L_XCNR:
    s_lshl_b32 m0, s3, 10
    v_mov_b32 v240, v215
    s_add_u32 m0, m0, 29696
    s_nop 0
    buffer_load_dwordx4 v[240:241], s[44:47], 0 idxen offen lds
    v_and_b32 v141, s17, v141
    s_waitcnt lgkmcnt(0)
    s_barrier
    ds_read_b64 v[202:203], v197
    ds_read_u16 v96, v96 offset:1026
    ds_read_u16 v97, v97 offset:1026
    ds_read_u16 v98, v98 offset:1026
    ds_read_u16 v100, v100 offset:1026
    ds_read_u16 v101, v101 offset:1026
    ds_read_u16 v102, v102 offset:1026
    ds_read_u16 v104, v104 offset:1026
    ds_read_u16 v105, v105 offset:1026
    ds_read_u16 v106, v106 offset:1026
    ds_read_u16 v108, v108 offset:1026
    ds_read_u16 v109, v109 offset:1026
    ds_read_u16 v110, v110 offset:1026
    s_lshl_b32 m0, s3, 10
    v_mov_b32 v240, v219
    s_add_u32 m0, m0, 37888
    s_nop 0
    buffer_load_dwordx4 v[240:241], s[44:47], 0 idxen offen lds
    s_add_u32 s24, s24, s7
    s_add_u32 s11, s25, s7
    s_and_b32 s10, s11, 15
    s_cmp_lt_u32 s11, s24
    s_cselect_b32 s25, s10, 16
    s_cmp_lg_u32 s97, 0
    s_cselect_b32 s23, s8, s11
    s_cselect_b32 s7, s8, s24
    s_cselect_b32 s8, s11, s8
    s_cselect_b32 s24, s9, s24
    s_cselect_b32 s9, s11, s9
    s_min_u32 s22, s8, 192
    s_min_u32 s23, s23, 192
    s_mov_b32 s30, s19
    s_waitcnt lgkmcnt(12)
    v_cmp_ne_u32 vcc, 0, v202
    v_readfirstlane_b32 s19, v203
    s_cbranch_vccnz L_OVF
    s_waitcnt lgkmcnt(9)
    s_mov_b64 exec, s[64:65]
    v_add_u32 v96, v96, v112
    ds_write2st64_b32 v96, v128, v204 offset0:148 offset1:220
    s_mov_b64 exec, s[66:67]
    v_add_u32 v97, v97, v113
    ds_write2st64_b32 v97, v129, v205 offset0:148 offset1:220
    s_mov_b64 exec, s[68:69]
    v_add_u32 v98, v98, v114
    ds_write2st64_b32 v98, v130, v206 offset0:148 offset1:220
    s_waitcnt lgkmcnt(9)
    s_mov_b64 exec, s[72:73]
    v_add_u32 v100, v100, v116
    ds_write2st64_b32 v100, v132, v208 offset0:148 offset1:220
    s_mov_b64 exec, s[74:75]
    v_add_u32 v101, v101, v117
    ds_write2st64_b32 v101, v133, v209 offset0:148 offset1:220
    s_mov_b64 exec, s[76:77]
    v_add_u32 v102, v102, v118
    ds_write2st64_b32 v102, v134, v210 offset0:148 offset1:220
    s_waitcnt lgkmcnt(9)
    s_mov_b64 exec, s[80:81]
    v_add_u32 v104, v104, v120
    ds_write2st64_b32 v104, v136, v212 offset0:148 offset1:220
    s_mov_b64 exec, s[82:83]
    v_add_u32 v105, v105, v121
    ds_write2st64_b32 v105, v137, v213 offset0:148 offset1:220
    s_mov_b64 exec, s[84:85]
    v_add_u32 v106, v106, v122
    ds_write2st64_b32 v106, v138, v214 offset0:148 offset1:220
    s_waitcnt lgkmcnt(9)
    s_mov_b64 exec, s[88:89]
    v_add_u32 v108, v108, v124
    ds_write2st64_b32 v108, v140, v216 offset0:148 offset1:220
    s_mov_b64 exec, s[90:91]
    v_add_u32 v109, v109, v125
    ds_write2st64_b32 v109, v141, v217 offset0:148 offset1:220
    s_mov_b64 exec, s[92:93]
    v_add_u32 v110, v110, v126
    ds_write2st64_b32 v110, v142, v218 offset0:148 offset1:220
    s_mov_b64 exec, -1
    s_add_u32 s10, s96, 127
    s_lshr_b32 s10, s10, 7
    s_lshl1_add_u32 s10, s10, -1
    s_add_u32 s11, s31, 127
    s_lshr_b32 s11, s11, 6
    s_and_b32 s11, s11, -2
    s_max_i32 s17, s10, s11
    s_cselect_b32 s10, s96, s31
    s_sub_u32 s10, s10, 1
    s_andn2_b32 s99, 64, s10
L_CA:
    ds_read_b64_tr_b16 v[96:97], v225 offset:0
    ds_read_b64_tr_b16 v[98:99], v225 offset:1280
    ds_read_b64_tr_b16 v[100:101], v225 offset:5120
    ds_read_b64_tr_b16 v[102:103], v225 offset:6400
    ds_read_b64_tr_b16 v[104:105], v225 offset:32
    ds_read_b64_tr_b16 v[106:107], v225 offset:1312
    ds_read_b64_tr_b16 v[108:109], v225 offset:5152
    ds_read_b64_tr_b16 v[110:111], v225 offset:6432
    ds_read_b64_tr_b16 v[112:113], v225 offset:64
    ds_read_b64_tr_b16 v[114:115], v225 offset:1344
    ds_read_b64_tr_b16 v[116:117], v225 offset:5184
    ds_read_b64_tr_b16 v[118:119], v225 offset:6464
    ds_read_b64_tr_b16 v[120:121], v225 offset:96
    ds_read_b64_tr_b16 v[122:123], v225 offset:1376
    ds_read_b64_tr_b16 v[124:125], v225 offset:5216
    ds_read_b64_tr_b16 v[126:127], v225 offset:6496
    s_cmp_eq_u32 s21, 0
    s_cbranch_scc1 L_XT2R
    s_waitcnt vmcnt(8)
L_XT2:
    s_mov_b64 s[34:35], 0
    v_cmp_ne_u32 vcc, s6, v65
    s_and_b64 vcc, vcc, s[70:71]
    s_or_b64 s[34:35], s[34:35], vcc
    v_cmp_ne_u32 vcc, s6, v69
    s_and_b64 vcc, vcc, s[78:79]
    s_or_b64 s[34:35], s[34:35], vcc
    v_cmp_ne_u32 vcc, s6, v73
    s_and_b64 vcc, vcc, s[86:87]
    s_or_b64 s[34:35], s[34:35], vcc
    v_cmp_ne_u32 vcc, s6, v77
    s_and_b64 vcc, vcc, s[94:95]
    s_or_b64 s[34:35], s[34:35], vcc
    s_cbranch_scc1 L_XT2B
    s_cmp_eq_u32 s20, 0
    s_cbranch_scc1 L_XT2R
    s_mov_b64 exec, s[70:71]
    s_cbranch_execz L_XS0
    v_bfe_u32 v65, v64, 18, 8
    v_lshlrev_b32 v65, 2, v65
    v_add_u32 v67, 153728, v65
    ds_read_b32 v67, v67
    v_add_u32_sdwa v66, v66, v156 dst_sel:DWORD dst_unused:UNUSED_PAD src0_sel:BYTE_0 src1_sel:DWORD
    v_lshrrev_b32 v189, 28, v64
    v_lshl_add_u32 v66, v189, 8, v66
    v_and_b32 v189, 60, v65
    v_lshl_add_u32 v66, v189, 19, v66
    v_and_b32 v64, 0xffff, v64
    s_waitcnt lgkmcnt(0)
    ds_add_rtn_u32 v67, v67, v184 offset:576
    s_waitcnt lgkmcnt(0)
    ds_write2st64_b32 v67, v64, v66 offset0:148 offset1:220
L_XS0:
    s_mov_b64 exec, s[78:79]
    s_cbranch_execz L_XS1
    v_bfe_u32 v69, v68, 18, 8
    v_lshlrev_b32 v69, 2, v69
    v_add_u32 v71, 153728, v69
    ds_read_b32 v71, v71
    v_add_u32_sdwa v70, v70, v157 dst_sel:DWORD dst_unused:UNUSED_PAD src0_sel:BYTE_0 src1_sel:DWORD
    v_lshrrev_b32 v189, 28, v68
    v_lshl_add_u32 v70, v189, 8, v70
    v_and_b32 v189, 60, v69
    v_lshl_add_u32 v70, v189, 19, v70
    v_and_b32 v68, 0xffff, v68
    s_waitcnt lgkmcnt(0)
    ds_add_rtn_u32 v71, v71, v184 offset:576
    s_waitcnt lgkmcnt(0)
    ds_write2st64_b32 v71, v68, v70 offset0:148 offset1:220
L_XS1:
    s_mov_b64 exec, s[86:87]
    s_cbranch_execz L_XS2
    v_bfe_u32 v73, v72, 18, 8
    v_lshlrev_b32 v73, 2, v73
    v_add_u32 v75, 153728, v73
    ds_read_b32 v75, v75
    v_add_u32_sdwa v74, v74, v158 dst_sel:DWORD dst_unused:UNUSED_PAD src0_sel:BYTE_0 src1_sel:DWORD
    v_lshrrev_b32 v189, 28, v72
    v_lshl_add_u32 v74, v189, 8, v74
    v_and_b32 v189, 60, v73
    v_lshl_add_u32 v74, v189, 19, v74
    v_and_b32 v72, 0xffff, v72
    s_waitcnt lgkmcnt(0)
    ds_add_rtn_u32 v75, v75, v184 offset:576
    s_waitcnt lgkmcnt(0)
    ds_write2st64_b32 v75, v72, v74 offset0:148 offset1:220
L_XS2:
    s_mov_b64 exec, s[94:95]
    s_cbranch_execz L_XS3
    v_bfe_u32 v77, v76, 18, 8
    v_lshlrev_b32 v77, 2, v77
    v_add_u32 v79, 153728, v77
    ds_read_b32 v79, v79
    v_add_u32_sdwa v78, v78, v159 dst_sel:DWORD dst_unused:UNUSED_PAD src0_sel:BYTE_0 src1_sel:DWORD
    v_lshrrev_b32 v189, 28, v76
    v_lshl_add_u32 v78, v189, 8, v78
    v_and_b32 v189, 60, v77
    v_lshl_add_u32 v78, v189, 19, v78
    v_and_b32 v76, 0xffff, v76
    s_waitcnt lgkmcnt(0)
    ds_add_rtn_u32 v79, v79, v184 offset:576
    s_waitcnt lgkmcnt(0)
    ds_write2st64_b32 v79, v76, v78 offset0:148 offset1:220
L_XS3:
    s_mov_b64 exec, -1
L_XT2R:
    s_cmp_ge_u32 s3, 4
    s_cbranch_scc1 L_EP0
    s_lshl_b32 s72, s4, 7
    s_add_u32 s72, s72, 156800
    v_mov_b32 v190, s22
    s_mov_b32 exec_lo, 0xffff0000
    v_mov_b32 v190, s23
    s_mov_b32 exec_lo, -1
    s_mov_b32 exec_hi, 0
    v_sub_u32 v191, v253, v190
    v_and_b32 v191, 15, v191
    v_add_lshl_u32 v191, v191, v190, 5
    v_lshl_add_u32 v190, v253, 2, s72
    ds_write_b32 v190, v191
    s_mov_b32 exec_hi, -1
    s_mul_i32 s10, s5, 196
    s_add_u32 s11, s10, s7
    s_add_u32 s62, s10, s9
    s_min_u32 s11, s11, 50000
    s_min_u32 s62, s62, 50000
    s_sub_u32 s62, s62, s11
    s_lshl_b32 s11, s11, 7
    s_lshl_b32 s62, s62, 7
    s_add_u32 s60, s48, s11
    s_addc_u32 s61, s49, 0
    s_mul_i32 s74, s7, -128
    s_add_u32 s11, s10, s8
    s_add_u32 s50, s10, s24
    s_min_u32 s11, s11, 50000
    s_min_u32 s50, s50, 50000
    s_sub_u32 s50, s50, s11
    s_lshl_b32 s11, s11, 7
    s_lshl_b32 s50, s50, 7
    s_add_u32 s48, s48, s11
    s_addc_u32 s49, s49, 0
    s_mul_i32 s73, s8, -128
    s_and_b32 s10, s25, 12
    s_lshl_b32 s10, s10, 2
    s_bfm_b64 s[76:77], 16, s10
L_EP0:
    s_waitcnt vmcnt(0) lgkmcnt(0)
    s_barrier
    s_mov_b32 s10, 0x358637bd
    ds_read_b128 v[236:239], v247
    ds_read_b32 v240, v248
    v_lshrrev_b32 v188, 2, v253
    v_and_b32 v188, 12, v188
    v_subrev_u32 v188, s25, v188
    s_waitcnt lgkmcnt(0)
    s_cmp_ge_u32 s3, 4
    s_cbranch_scc1 L_LATE0
    s_add_u32 m0, s13, 0
    v_mad_u32_u16 v236, v236, s15, v243
    buffer_load_dwordx4 v236, s[40:43], 0 offen lds
    s_add_u32 m0, s13, 1056
    v_mad_u32_u16 v237, v237, s15, v243
    buffer_load_dwordx4 v237, s[40:43], 0 offen lds
    s_add_u32 m0, s13, 2112
    v_mad_u32_u16 v238, v238, s15, v243
    buffer_load_dwordx4 v238, s[40:43], 0 offen lds
    s_add_u32 m0, s13, 3168
    v_mad_u32_u16 v239, v239, s15, v243
    buffer_load_dwordx4 v239, s[40:43], 0 offen lds
    s_mov_b32 m0, s14
    v_and_b32 v240, 0xfffff, v240
    buffer_load_dwordx4 v[240:241], s[44:47], 0 idxen offen lds
L_LATE0:
    s_lshl_b32 s34, s22, 5
    s_lshl_b32 s35, s23, 5
    s_mov_b32 vcc_lo, 0xff00ff00
    s_mov_b32 vcc_hi, 0xff00ff00
    v_mov_b32 v176, s35
    v_mov_b32 v177, s34
    v_cndmask_b32 v176, v176, v177, vcc
    v_and_b32 v177, 4, v253
    v_lshlrev_b32 v177, 6, v177
    v_lshl_add_u32 v177, v246, 2, v177
    v_sub_u32 v177, v177, v176
    v_and_b32 v178, 48, v253
    s_movk_i32 s34, 832
    v_mad_u32_u24 v178, v246, s34, v178
    s_mov_b32 s34, 116736
    v_add3_u32 v178, v178, v176, s34
    v_and_b32 v176, 0x1ff, v177
    v_add_u32 v176, v176, v178
    ds_read_b128 v[160:163], v176 offset:0
    ds_read_b128 v[164:167], v176 offset:64
    v_add_u32 v177, 0x80, v177
    v_and_b32 v176, 0x1ff, v177
    v_add_u32 v176, v176, v178
    ds_read_b128 v[168:171], v176 offset:0
    ds_read_b128 v[172:175], v176 offset:64
    s_mov_b32 s34, 0xbfb8aa3b
    s_mov_b32 s35, s34
    s_waitcnt lgkmcnt(3)
    v_mfma_f32_16x16x32_bf16 v[204:207], v[160:163], v[96:99], 0
    v_mfma_f32_16x16x32_bf16 v[212:215], v[160:163], v[104:107], 0
    v_mfma_f32_16x16x32_bf16 v[220:223], v[160:163], v[112:115], 0
    v_mfma_f32_16x16x32_bf16 v[228:231], v[160:163], v[120:123], 0
    s_waitcnt lgkmcnt(2)
    v_mfma_f32_16x16x32_bf16 v[204:207], v[164:167], v[100:103], v[204:207]
    v_mfma_f32_16x16x32_bf16 v[212:215], v[164:167], v[108:111], v[212:215]
    v_mfma_f32_16x16x32_bf16 v[220:223], v[164:167], v[116:119], v[220:223]
    v_mfma_f32_16x16x32_bf16 v[228:231], v[164:167], v[124:127], v[228:231]
    s_waitcnt lgkmcnt(1)
    v_mfma_f32_16x16x32_bf16 v[208:211], v[168:171], v[96:99], 0
    v_mfma_f32_16x16x32_bf16 v[216:219], v[168:171], v[104:107], 0
    v_mfma_f32_16x16x32_bf16 v[224:227], v[168:171], v[112:115], 0
    v_mfma_f32_16x16x32_bf16 v[232:235], v[168:171], v[120:123], 0
    s_waitcnt lgkmcnt(0)
    v_mfma_f32_16x16x32_bf16 v[208:211], v[172:175], v[100:103], v[208:211]
    v_mfma_f32_16x16x32_bf16 v[216:219], v[172:175], v[108:111], v[216:219]
    v_mfma_f32_16x16x32_bf16 v[224:227], v[172:175], v[116:119], v[224:227]
    v_mfma_f32_16x16x32_bf16 v[232:235], v[172:175], v[124:127], v[232:235]
    s_mov_b32 s11, s10
    v_mov_b32 v189, s10
    v_mov_b64 v[96:97], s[10:11]
    v_mov_b64 v[98:99], s[10:11]
    v_mov_b64 v[100:101], s[10:11]
    v_mov_b64 v[102:103], s[10:11]
    v_mov_b64 v[104:105], s[10:11]
    v_mov_b64 v[106:107], s[10:11]
    v_mov_b64 v[108:109], s[10:11]
    v_mov_b64 v[110:111], s[10:11]
    v_cmp_ne_u32 vcc, 0, v188
    v_mov_b64 v[112:113], 0
    v_mov_b64 v[114:115], 0
    v_cndmask_b32 v128, 0, v189, vcc
    v_cmp_ne_u32 vcc, -1, v188
    v_mov_b64 v[116:117], 0
    v_mov_b64 v[118:119], 0
    v_cndmask_b32 v129, 0, v189, vcc
    v_cmp_ne_u32 vcc, -2, v188
    v_mov_b64 v[120:121], 0
    v_mov_b64 v[122:123], 0
    v_cndmask_b32 v130, 0, v189, vcc
    v_cmp_ne_u32 vcc, -3, v188
    v_mov_b64 v[124:125], 0
    v_mov_b64 v[126:127], 0
    v_cndmask_b32 v131, 0, v189, vcc
    v_mov_b64 v[144:145], 0
    v_mov_b64 v[146:147], 0
    v_mov_b64 v[148:149], 0
    v_mov_b64 v[150:151], 0
    v_mov_b64 v[152:153], 0
    v_mov_b64 v[154:155], 0
    v_mov_b64 v[156:157], 0
    v_mov_b64 v[158:159], 0
    v_mov_b64 v[132:133], v[128:129]
    v_mov_b64 v[134:135], v[130:131]
    v_mov_b64 v[136:137], v[128:129]
    v_mov_b64 v[138:139], v[130:131]
    v_mov_b64 v[140:141], v[128:129]
    v_mov_b64 v[142:143], v[130:131]
    v_pk_mul_f32 v[204:205], v[204:205], s[34:35]
    v_pk_mul_f32 v[206:207], v[206:207], s[34:35]
    v_pk_mul_f32 v[208:209], v[208:209], s[34:35]
    v_pk_mul_f32 v[210:211], v[210:211], s[34:35]
    v_pk_mul_f32 v[212:213], v[212:213], s[34:35]
    v_pk_mul_f32 v[214:215], v[214:215], s[34:35]
    v_pk_mul_f32 v[216:217], v[216:217], s[34:35]
    v_pk_mul_f32 v[218:219], v[218:219], s[34:35]
    v_pk_mul_f32 v[220:221], v[220:221], s[34:35]
    v_pk_mul_f32 v[222:223], v[222:223], s[34:35]
    v_pk_mul_f32 v[224:225], v[224:225], s[34:35]
    v_pk_mul_f32 v[226:227], v[226:227], s[34:35]
    v_pk_mul_f32 v[228:229], v[228:229], s[34:35]
    v_pk_mul_f32 v[230:231], v[230:231], s[34:35]
    v_pk_mul_f32 v[232:233], v[232:233], s[34:35]
    v_pk_mul_f32 v[234:235], v[234:235], s[34:35]
    v_cvt_pk_bf16_f32 v64, v204, v205
    v_cvt_pk_bf16_f32 v65, v206, v207
    v_cvt_pk_bf16_f32 v66, v208, v209
    v_cvt_pk_bf16_f32 v67, v210, v211
    v_cvt_pk_bf16_f32 v68, v212, v213
    v_cvt_pk_bf16_f32 v69, v214, v215
    v_cvt_pk_bf16_f32 v70, v216, v217
    v_cvt_pk_bf16_f32 v71, v218, v219
    v_cvt_pk_bf16_f32 v72, v220, v221
    v_cvt_pk_bf16_f32 v73, v222, v223
    v_cvt_pk_bf16_f32 v74, v224, v225
    v_cvt_pk_bf16_f32 v75, v226, v227
    v_cvt_pk_bf16_f32 v76, v228, v229
    v_cvt_pk_bf16_f32 v77, v230, v231
    v_cvt_pk_bf16_f32 v78, v232, v233
    v_cvt_pk_bf16_f32 v79, v234, v235
    v_permlane32_swap_b32 v80, v64
    v_permlane32_swap_b32 v81, v65
    v_permlane32_swap_b32 v82, v66
    v_permlane32_swap_b32 v83, v67
    v_permlane32_swap_b32 v84, v68
    v_permlane32_swap_b32 v85, v69
    v_permlane32_swap_b32 v86, v70
    v_permlane32_swap_b32 v87, v71
    v_permlane32_swap_b32 v88, v72
    v_permlane32_swap_b32 v89, v73
    v_permlane32_swap_b32 v90, v74
    v_permlane32_swap_b32 v91, v75
    v_permlane32_swap_b32 v92, v76
    v_permlane32_swap_b32 v93, v77
    v_permlane32_swap_b32 v94, v78
    v_permlane32_swap_b32 v95, v79
    s_mov_b32 s26, -1
    s_mov_b64 s[32:33], 0
    s_mov_b32 s28, 0
    s_mov_b32 s29, 0
    s_cmp_lt_u32 s3, 4
    s_cbranch_scc1 L_HAD0
    s_add_u32 m0, s13, 0
    v_mad_u32_u16 v236, v236, s15, v243
    buffer_load_dwordx4 v236, s[40:43], 0 offen lds
    s_add_u32 m0, s13, 1056
    v_mad_u32_u16 v237, v237, s15, v243
    buffer_load_dwordx4 v237, s[40:43], 0 offen lds
    s_add_u32 m0, s13, 2112
    v_mad_u32_u16 v238, v238, s15, v243
    buffer_load_dwordx4 v238, s[40:43], 0 offen lds
    s_add_u32 m0, s13, 3168
    v_mad_u32_u16 v239, v239, s15, v243
    buffer_load_dwordx4 v239, s[40:43], 0 offen lds
    s_mov_b32 m0, s14
    v_and_b32 v240, 0xfffff, v240
    buffer_load_dwordx4 v[240:241], s[44:47], 0 idxen offen lds
    s_lshl_b32 s72, s4, 7
    s_add_u32 s72, s72, 156800
    v_mov_b32 v190, s22
    s_mov_b32 exec_lo, 0xffff0000
    v_mov_b32 v190, s23
    s_mov_b32 exec_lo, -1
    s_mov_b32 exec_hi, 0
    v_sub_u32 v191, v253, v190
    v_and_b32 v191, 15, v191
    v_add_lshl_u32 v191, v191, v190, 5
    v_lshl_add_u32 v190, v253, 2, s72
    ds_write_b32 v190, v191
    s_mov_b32 exec_hi, -1
    s_mul_i32 s10, s5, 196
    s_add_u32 s11, s10, s7
    s_add_u32 s62, s10, s9
    s_min_u32 s11, s11, 50000
    s_min_u32 s62, s62, 50000
    s_sub_u32 s62, s62, s11
    s_lshl_b32 s11, s11, 7
    s_lshl_b32 s62, s62, 7
    s_add_u32 s60, s48, s11
    s_addc_u32 s61, s49, 0
    s_mul_i32 s74, s7, -128
    s_add_u32 s11, s10, s8
    s_add_u32 s50, s10, s24
    s_min_u32 s11, s11, 50000
    s_min_u32 s50, s50, 50000
    s_sub_u32 s50, s50, s11
    s_lshl_b32 s11, s11, 7
    s_lshl_b32 s50, s50, 7
    s_add_u32 s48, s48, s11
    s_addc_u32 s49, s49, 0
    s_mul_i32 s73, s8, -128
    s_and_b32 s10, s25, 12
    s_lshl_b32 s10, s10, 2
    s_bfm_b64 s[76:77], 16, s10
L_HAD0:
    s_cmp_eq_u32 s30, 0
    s_cbranch_scc1 L_GO
    s_lshl_b32 s10, s4, 3
    v_mov_b32 v188, s10
    ds_read_b64 v[188:189], v188 offset:576
    s_waitcnt lgkmcnt(0)
    v_readfirstlane_b32 s34, v188
    v_readfirstlane_b32 s35, v189
    s_sub_u32 s10, s12, 37888
    s_sub_u32 s34, s34, s10
    s_sub_u32 s35, s35, s10
    s_sub_u32 s35, s35, 1152
    s_add_u32 s10, s34, 127
    s_lshr_b32 s10, s10, 7
    s_lshl1_add_u32 s10, s10, -1
    s_add_u32 s11, s35, 127
    s_lshr_b32 s11, s11, 6
    s_and_b32 s11, s11, -2
    s_max_i32 s17, s10, s11
    s_cselect_b32 s10, s34, s35
    s_sub_u32 s10, s10, 1
    s_andn2_b32 s99, 64, s10
L_GO:
    ds_read_u16 v251, v249 offset:0
    ds_read_u16 v252, v249 offset:64
    ds_read_b128 v[236:239], v247 offset:1152
    ds_read_b32 v240, v248 offset:1152
    s_lshr_b32 s10, s4, 1
    s_lshl_b32 s10, s10, 8
    s_add_u32 s10, s10, 155776
    v_lshl_add_u32 v255, v253, 2, s10
    s_bitcmp1_b32 s4, 0
    s_cselect_b32 s101, -1, 1
    s_max_i32 s10, s17, 1
    s_sub_u32 s10, s10, 1
    s_mul_i32 s10, s101, s10
    s_lshl_b32 s10, s10, 24
    v_mov_b32 v204, s10
    ds_add_u32 v255, v204
    v_mov_b32 v253, 0
    s_mov_b32 exec_hi, 0
    v_add_u32 v253, 0x200, v245
    s_mov_b32 exec_hi, -1
    v_mov_b64 v[204:205], 0
    v_mov_b64 v[206:207], 0
    v_mov_b64 v[208:209], 0
    v_mov_b64 v[210:211], 0
    v_mov_b64 v[212:213], 0
    v_mov_b64 v[214:215], 0
    v_mov_b64 v[216:217], 0
    v_mov_b64 v[218:219], 0
    v_mov_b64 v[220:221], 0
    v_mov_b64 v[222:223], 0
    v_mov_b64 v[224:225], 0
    v_mov_b64 v[226:227], 0
    v_mov_b64 v[228:229], 0
    v_mov_b64 v[230:231], 0
    v_mov_b64 v[232:233], 0
    v_mov_b64 v[234:235], 0
    v_mov_b64 v[184:185], 0
    v_mov_b64 v[186:187], 0
    s_waitcnt lgkmcnt(0)
    v_bfi_b32 v251, 31, v245, v251
    v_bfi_b32 v252, 31, v245, v252
    v_max_u32 v251, v251, v245
    v_max_u32 v252, v252, v253
    s_waitcnt vmcnt(0)
    ds_read_b128 v[176:179], v251
    ds_read_b128 v[180:183], v252
    ds_read_b128 v[160:163], v244 offset:0
    ds_read_b128 v[168:171], v244 offset:512
    ds_read_b128 v[164:167], v244 offset:64
    ds_read_b128 v[172:175], v244 offset:576
    s_cmp_lt_i32 s17, 1
    s_cbranch_scc1 L_DONE
    s_waitcnt lgkmcnt(4)
    v_mfma_f32_16x16x32_bf16 v[188:191], v[176:179], v[64:67], 0
    v_mfma_f32_16x16x32_bf16 v[196:199], v[176:179], v[68:71], 0
    v_mfma_f32_16x16x32_bf16 v[192:195], v[180:183], v[64:67], 0
    v_mfma_f32_16x16x32_bf16 v[200:203], v[180:183], v[68:71], 0
    s_waitcnt lgkmcnt(0)
    v_mfma_f32_16x16x32_bf16 v[188:191], v[160:163], v[0:3], v[188:191]
    v_mfma_f32_16x16x32_bf16 v[196:199], v[160:163], v[8:11], v[196:199]
    v_mfma_f32_16x16x32_bf16 v[192:195], v[168:171], v[0:3], v[192:195]
    v_mfma_f32_16x16x32_bf16 v[200:203], v[168:171], v[8:11], v[200:203]
    v_mfma_f32_16x16x32_bf16 v[188:191], v[164:167], v[4:7], v[188:191]
    v_mfma_f32_16x16x32_bf16 v[196:199], v[164:167], v[12:15], v[196:199]
    v_mfma_f32_16x16x32_bf16 v[192:195], v[172:175], v[4:7], v[192:195]
    v_mfma_f32_16x16x32_bf16 v[200:203], v[172:175], v[12:15], v[200:203]
    s_mov_b32 s16, 1
    s_cmp_eq_u32 s17, 1
    s_cbranch_scc1 L_LT0
    s_add_u32 m0, s13, 0
    v_mad_u32_u16 v236, v236, s15, v243
    buffer_load_dwordx4 v236, s[40:43], 0 offen lds
    s_add_u32 m0, s13, 1056
    v_mad_u32_u16 v237, v237, s15, v243
    buffer_load_dwordx4 v237, s[40:43], 0 offen lds
    s_add_u32 m0, s13, 2112
    v_mad_u32_u16 v238, v238, s15, v243
    buffer_load_dwordx4 v238, s[40:43], 0 offen lds
    s_add_u32 m0, s13, 3168
    v_mad_u32_u16 v239, v239, s15, v243
    buffer_load_dwordx4 v239, s[40:43], 0 offen lds
    s_mov_b32 m0, s14
    v_and_b32 v240, 0xfffff, v240
    buffer_load_dwordx4 v[240:241], s[44:47], 0 idxen offen lds
.p2align 6
L_LOOP1:
    s_setprio 1
    v_smfmac_f32_16x16x64_bf16 v[152:155], v[184:187], v[204:211], v242
    ds_read_u16 v236, v250 offset:0
    ds_read_u16 v237, v250 offset:16
    ds_add_rtn_u32 v238, v255, v242
    v_exp_f32 v188, v188
    v_smfmac_f32_16x16x64_bf16 v[156:159], v[184:187], v[212:219], v242
    v_exp_f32 v189, v189
    v_mfma_f32_16x16x32_bf16 v[204:207], v[160:163], v[32:35], 0
    v_exp_f32 v190, v190
    v_mfma_f32_16x16x32_bf16 v[212:215], v[160:163], v[40:43], 0
    v_exp_f32 v191, v191
    v_mfma_f32_16x16x32_bf16 v[208:211], v[168:171], v[32:35], 0
    v_exp_f32 v192, v192
    v_mfma_f32_16x16x32_bf16 v[216:219], v[168:171], v[40:43], 0
    v_exp_f32 v193, v193
    v_mfma_f32_16x16x32_bf16 v[204:207], v[164:167], v[36:39], v[204:207]
    v_exp_f32 v194, v194
    v_mfma_f32_16x16x32_bf16 v[212:215], v[164:167], v[44:47], v[212:215]
    v_exp_f32 v195, v195
    v_mfma_f32_16x16x32_bf16 v[208:211], v[172:175], v[36:39], v[208:211]
    s_waitcnt lgkmcnt(0)
    v_bfi_b32 v236, 31, v246, v236
    v_bfi_b32 v237, 31, v246, v237
    v_readfirstlane_b32 s96, v238
    v_exp_f32 v196, v196
    v_mfma_f32_16x16x32_bf16 v[216:219], v[172:175], v[44:47], v[216:219]
    v_exp_f32 v197, v197
    s_setprio 3
    v_smfmac_f32_16x16x64_bf16 v[136:139], v[184:187], v[220:227], v242
    v_exp_f32 v198, v198
    v_smfmac_f32_16x16x64_bf16 v[140:143], v[184:187], v[228:235], v242
    v_exp_f32 v199, v199
    v_exp_f32 v200, v200
    v_exp_f32 v201, v201
    v_exp_f32 v202, v202
    v_exp_f32 v203, v203
    v_pk_add_f32 v[188:189], v[188:189], 1.0 op_sel_hi:[1,0]
    v_pk_add_f32 v[190:191], v[190:191], 1.0 op_sel_hi:[1,0]
    v_pk_add_f32 v[192:193], v[192:193], 1.0 op_sel_hi:[1,0]
    v_pk_add_f32 v[194:195], v[194:195], 1.0 op_sel_hi:[1,0]
    v_pk_add_f32 v[196:197], v[196:197], 1.0 op_sel_hi:[1,0]
    v_pk_add_f32 v[198:199], v[198:199], 1.0 op_sel_hi:[1,0]
    v_pk_add_f32 v[200:201], v[200:201], 1.0 op_sel_hi:[1,0]
    v_pk_add_f32 v[202:203], v[202:203], 1.0 op_sel_hi:[1,0]
    s_setprio 1
    v_mfma_f32_16x16x32_bf16 v[220:223], v[176:179], v[72:75], 0
    ds_read_b64_tr_b16 v[184:185], v236
    ds_read_b64_tr_b16 v[186:187], v237
    ds_read_u16 v251, v249 offset:1152
    ds_read_u16 v252, v249 offset:1216
    v_rcp_f32 v188, v188
    v_mfma_f32_16x16x32_bf16 v[228:231], v[176:179], v[76:79], 0
    s_ashr_i32 s96, s96, 24
    s_mul_i32 s96, s96, s101
    v_rcp_f32 v189, v189
    v_mfma_f32_16x16x32_bf16 v[224:227], v[180:183], v[72:75], 0
    v_rcp_f32 v190, v190
    v_mfma_f32_16x16x32_bf16 v[232:235], v[180:183], v[76:79], 0
    v_rcp_f32 v191, v191
    v_mfma_f32_16x16x32_bf16 v[220:223], v[160:163], v[16:19], v[220:223]
    v_rcp_f32 v192, v192
    v_mfma_f32_16x16x32_bf16 v[228:231], v[160:163], v[24:27], v[228:231]
    v_rcp_f32 v193, v193
    v_mfma_f32_16x16x32_bf16 v[224:227], v[168:171], v[16:19], v[224:227]
    s_waitcnt lgkmcnt(0)
    v_bfi_b32 v251, 31, v245, v251
    v_bfi_b32 v252, 31, v245, v252
    v_max_u32 v251, v251, v245
    v_max_u32 v252, v252, v253
    ds_read_b128 v[236:239], v247 offset:128
    ds_read_b32 v240, v248 offset:128
    s_add_u32 s16, s16, 1
    v_rcp_f32 v194, v194
    v_mfma_f32_16x16x32_bf16 v[232:235], v[168:171], v[24:27], v[232:235]
    v_rcp_f32 v195, v195
    v_mfma_f32_16x16x32_bf16 v[220:223], v[164:167], v[20:23], v[220:223]
    v_rcp_f32 v196, v196
    v_mfma_f32_16x16x32_bf16 v[228:231], v[164:167], v[28:31], v[228:231]
    v_rcp_f32 v197, v197
    s_setprio 3
    v_mfma_f32_16x16x32_bf16 v[224:227], v[172:175], v[20:23], v[224:227]
    v_rcp_f32 v198, v198
    v_mfma_f32_16x16x32_bf16 v[232:235], v[172:175], v[28:31], v[232:235]
    v_rcp_f32 v199, v199
    v_rcp_f32 v200, v200
    v_rcp_f32 v201, v201
    v_rcp_f32 v202, v202
    v_rcp_f32 v203, v203
    v_pk_mul_f32 v[204:205], v[188:189], v[204:205]
    v_pk_mul_f32 v[206:207], v[190:191], v[206:207]
    v_pk_mul_f32 v[208:209], v[192:193], v[208:209]
    v_pk_mul_f32 v[210:211], v[194:195], v[210:211]
    v_pk_mul_f32 v[212:213], v[196:197], v[212:213]
    v_pk_mul_f32 v[214:215], v[198:199], v[214:215]
    v_pk_mul_f32 v[216:217], v[200:201], v[216:217]
    v_pk_mul_f32 v[218:219], v[202:203], v[218:219]
    s_cmp_ge_i32 s96, 1
    s_cbranch_scc0 L_PB00
L_PB01:
    s_setprio 1
    v_smfmac_f32_16x16x64_bf16 v[112:115], v[184:187], v[204:211], v242
    v_exp_f32 v220, v220
    v_smfmac_f32_16x16x64_bf16 v[116:119], v[184:187], v[212:219], v242
    v_exp_f32 v221, v221
    s_waitcnt vmcnt(0)
    ds_read_b128 v[176:179], v251
    ds_read_b128 v[180:183], v252
    v_mfma_f32_16x16x32_bf16 v[204:207], v[160:163], v[48:51], 0
    v_exp_f32 v222, v222
    v_mfma_f32_16x16x32_bf16 v[212:215], v[160:163], v[56:59], 0
    ds_read_b128 v[160:163], v244 offset:0
    v_exp_f32 v223, v223
    v_mfma_f32_16x16x32_bf16 v[208:211], v[168:171], v[48:51], 0
    v_exp_f32 v224, v224
    v_mfma_f32_16x16x32_bf16 v[216:219], v[168:171], v[56:59], 0
    ds_read_b128 v[168:171], v244 offset:512
    v_exp_f32 v225, v225
    v_mfma_f32_16x16x32_bf16 v[204:207], v[164:167], v[52:55], v[204:207]
    v_exp_f32 v226, v226
    v_mfma_f32_16x16x32_bf16 v[212:215], v[164:167], v[60:63], v[212:215]
    ds_read_b128 v[164:167], v244 offset:64
    v_exp_f32 v227, v227
    v_mfma_f32_16x16x32_bf16 v[208:211], v[172:175], v[52:55], v[208:211]
    v_exp_f32 v228, v228
    v_mfma_f32_16x16x32_bf16 v[216:219], v[172:175], v[60:63], v[216:219]
    ds_read_b128 v[172:175], v244 offset:576
    v_exp_f32 v229, v229
    s_setprio 3
    v_smfmac_f32_16x16x64_bf16 v[96:99], v[184:187], v[188:195], v242
    v_exp_f32 v230, v230
    v_smfmac_f32_16x16x64_bf16 v[100:103], v[184:187], v[196:203], v242
    v_exp_f32 v231, v231
    v_exp_f32 v232, v232
    v_exp_f32 v233, v233
    v_exp_f32 v234, v234
    v_exp_f32 v235, v235
    v_pk_add_f32 v[220:221], v[220:221], 1.0 op_sel_hi:[1,0]
    v_pk_add_f32 v[222:223], v[222:223], 1.0 op_sel_hi:[1,0]
    v_pk_add_f32 v[224:225], v[224:225], 1.0 op_sel_hi:[1,0]
    v_pk_add_f32 v[226:227], v[226:227], 1.0 op_sel_hi:[1,0]
    v_pk_add_f32 v[228:229], v[228:229], 1.0 op_sel_hi:[1,0]
    v_pk_add_f32 v[230:231], v[230:231], 1.0 op_sel_hi:[1,0]
    v_pk_add_f32 v[232:233], v[232:233], 1.0 op_sel_hi:[1,0]
    v_pk_add_f32 v[234:235], v[234:235], 1.0 op_sel_hi:[1,0]
    s_setprio 1
    s_waitcnt lgkmcnt(4)
    v_mfma_f32_16x16x32_bf16 v[188:191], v[176:179], v[80:83], 0
    v_rcp_f32 v220, v220
    v_mfma_f32_16x16x32_bf16 v[196:199], v[176:179], v[84:87], 0
    v_rcp_f32 v221, v221
    v_mfma_f32_16x16x32_bf16 v[192:195], v[180:183], v[80:83], 0
    v_rcp_f32 v222, v222
    v_mfma_f32_16x16x32_bf16 v[200:203], v[180:183], v[84:87], 0
    v_rcp_f32 v223, v223
    s_waitcnt lgkmcnt(3)
    v_mfma_f32_16x16x32_bf16 v[188:191], v[160:163], v[0:3], v[188:191]
    v_rcp_f32 v224, v224
    v_mfma_f32_16x16x32_bf16 v[196:199], v[160:163], v[8:11], v[196:199]
    v_rcp_f32 v225, v225
    s_waitcnt lgkmcnt(2)
    v_mfma_f32_16x16x32_bf16 v[192:195], v[168:171], v[0:3], v[192:195]
    v_rcp_f32 v226, v226
    v_mfma_f32_16x16x32_bf16 v[200:203], v[168:171], v[8:11], v[200:203]
    v_rcp_f32 v227, v227
    s_waitcnt lgkmcnt(1)
    v_mfma_f32_16x16x32_bf16 v[188:191], v[164:167], v[4:7], v[188:191]
    v_rcp_f32 v228, v228
    v_mfma_f32_16x16x32_bf16 v[196:199], v[164:167], v[12:15], v[196:199]
    v_rcp_f32 v229, v229
    s_setprio 3
    s_waitcnt lgkmcnt(0)
    v_mfma_f32_16x16x32_bf16 v[192:195], v[172:175], v[4:7], v[192:195]
    s_cmp_lt_u32 s16, s17
    s_cbranch_scc0 L_ND01
    s_add_u32 m0, s13, 0
    v_mad_u32_u16 v236, v236, s15, v243
    buffer_load_dwordx4 v236, s[40:43], 0 offen lds
    s_add_u32 m0, s13, 1056
    v_mad_u32_u16 v237, v237, s15, v243
    buffer_load_dwordx4 v237, s[40:43], 0 offen lds
    s_add_u32 m0, s13, 2112
    v_mad_u32_u16 v238, v238, s15, v243
    buffer_load_dwordx4 v238, s[40:43], 0 offen lds
    s_add_u32 m0, s13, 3168
    v_mad_u32_u16 v239, v239, s15, v243
    buffer_load_dwordx4 v239, s[40:43], 0 offen lds
    s_mov_b32 m0, s14
    v_and_b32 v240, 0xfffff, v240
    buffer_load_dwordx4 v[240:241], s[44:47], 0 idxen offen lds
L_ND01:
    v_rcp_f32 v230, v230
    v_mfma_f32_16x16x32_bf16 v[200:203], v[172:175], v[12:15], v[200:203]
    v_rcp_f32 v231, v231
    v_rcp_f32 v232, v232
    v_rcp_f32 v233, v233
    v_rcp_f32 v234, v234
    v_rcp_f32 v235, v235
    v_pk_mul_f32 v[204:205], v[220:221], v[204:205]
    v_pk_mul_f32 v[206:207], v[222:223], v[206:207]
    v_pk_mul_f32 v[208:209], v[224:225], v[208:209]
    v_pk_mul_f32 v[210:211], v[226:227], v[210:211]
    v_pk_mul_f32 v[212:213], v[228:229], v[212:213]
    v_pk_mul_f32 v[214:215], v[230:231], v[214:215]
    v_pk_mul_f32 v[216:217], v[232:233], v[216:217]
    v_pk_mul_f32 v[218:219], v[234:235], v[218:219]
    s_cmp_ge_u32 s16, s17
    s_cbranch_scc1 L_LT1
    s_setprio 1
    v_smfmac_f32_16x16x64_bf16 v[120:123], v[184:187], v[204:211], v242
    ds_read_u16 v236, v250 offset:1152
    ds_read_u16 v237, v250 offset:1168
    ds_add_rtn_u32 v238, v255, v242
    v_exp_f32 v188, v188
    v_smfmac_f32_16x16x64_bf16 v[124:127], v[184:187], v[212:219], v242
    v_exp_f32 v189, v189
    v_mfma_f32_16x16x32_bf16 v[204:207], v[160:163], v[32:35], 0
    v_exp_f32 v190, v190
    v_mfma_f32_16x16x32_bf16 v[212:215], v[160:163], v[40:43], 0
    v_exp_f32 v191, v191
    v_mfma_f32_16x16x32_bf16 v[208:211], v[168:171], v[32:35], 0
    v_exp_f32 v192, v192
    v_mfma_f32_16x16x32_bf16 v[216:219], v[168:171], v[40:43], 0
    v_exp_f32 v193, v193
    v_mfma_f32_16x16x32_bf16 v[204:207], v[164:167], v[36:39], v[204:207]
    v_exp_f32 v194, v194
    v_mfma_f32_16x16x32_bf16 v[212:215], v[164:167], v[44:47], v[212:215]
    v_exp_f32 v195, v195
    v_mfma_f32_16x16x32_bf16 v[208:211], v[172:175], v[36:39], v[208:211]
    s_waitcnt lgkmcnt(0)
    v_bfi_b32 v236, 31, v246, v236
    v_bfi_b32 v237, 31, v246, v237
    v_readfirstlane_b32 s96, v238
    v_exp_f32 v196, v196
    v_mfma_f32_16x16x32_bf16 v[216:219], v[172:175], v[44:47], v[216:219]
    v_exp_f32 v197, v197
    s_setprio 3
    v_smfmac_f32_16x16x64_bf16 v[104:107], v[184:187], v[220:227], v242
    v_exp_f32 v198, v198
    v_smfmac_f32_16x16x64_bf16 v[108:111], v[184:187], v[228:235], v242
    v_exp_f32 v199, v199
    v_exp_f32 v200, v200
    v_exp_f32 v201, v201
    v_exp_f32 v202, v202
    v_exp_f32 v203, v203
    v_pk_add_f32 v[188:189], v[188:189], 1.0 op_sel_hi:[1,0]
    v_pk_add_f32 v[190:191], v[190:191], 1.0 op_sel_hi:[1,0]
    v_pk_add_f32 v[192:193], v[192:193], 1.0 op_sel_hi:[1,0]
    v_pk_add_f32 v[194:195], v[194:195], 1.0 op_sel_hi:[1,0]
    v_pk_add_f32 v[196:197], v[196:197], 1.0 op_sel_hi:[1,0]
    v_pk_add_f32 v[198:199], v[198:199], 1.0 op_sel_hi:[1,0]
    v_pk_add_f32 v[200:201], v[200:201], 1.0 op_sel_hi:[1,0]
    v_pk_add_f32 v[202:203], v[202:203], 1.0 op_sel_hi:[1,0]
    s_setprio 1
    v_mfma_f32_16x16x32_bf16 v[220:223], v[176:179], v[88:91], 0
    ds_read_b64_tr_b16 v[184:185], v236
    ds_read_b64_tr_b16 v[186:187], v237
    ds_read_u16 v251, v249 offset:128
    ds_read_u16 v252, v249 offset:192
    v_rcp_f32 v188, v188
    v_mfma_f32_16x16x32_bf16 v[228:231], v[176:179], v[92:95], 0
    s_ashr_i32 s96, s96, 24
    s_mul_i32 s96, s96, s101
    v_rcp_f32 v189, v189
    v_mfma_f32_16x16x32_bf16 v[224:227], v[180:183], v[88:91], 0
    v_rcp_f32 v190, v190
    v_mfma_f32_16x16x32_bf16 v[232:235], v[180:183], v[92:95], 0
    v_rcp_f32 v191, v191
    v_mfma_f32_16x16x32_bf16 v[220:223], v[160:163], v[16:19], v[220:223]
    v_rcp_f32 v192, v192
    v_mfma_f32_16x16x32_bf16 v[228:231], v[160:163], v[24:27], v[228:231]
    v_rcp_f32 v193, v193
    v_mfma_f32_16x16x32_bf16 v[224:227], v[168:171], v[16:19], v[224:227]
    s_waitcnt lgkmcnt(0)
    v_bfi_b32 v251, 31, v245, v251
    v_bfi_b32 v252, 31, v245, v252
    v_max_u32 v251, v251, v245
    v_max_u32 v252, v252, v253
    ds_read_b128 v[236:239], v247 offset:1280
    ds_read_b32 v240, v248 offset:1280
    s_add_u32 s16, s16, 1
    v_rcp_f32 v194, v194
    v_mfma_f32_16x16x32_bf16 v[232:235], v[168:171], v[24:27], v[232:235]
    v_add_u32 v247, 0x80, v247
    v_add_u32 v248, 0x80, v248
    v_add_u32 v249, 0x80, v249
    v_add_u32 v250, 0x80, v250
    v_rcp_f32 v195, v195
    v_mfma_f32_16x16x32_bf16 v[220:223], v[164:167], v[20:23], v[220:223]
    v_rcp_f32 v196, v196
    v_mfma_f32_16x16x32_bf16 v[228:231], v[164:167], v[28:31], v[228:231]
    v_rcp_f32 v197, v197
    s_setprio 3
    v_mfma_f32_16x16x32_bf16 v[224:227], v[172:175], v[20:23], v[224:227]
    v_rcp_f32 v198, v198
    v_mfma_f32_16x16x32_bf16 v[232:235], v[172:175], v[28:31], v[232:235]
    v_rcp_f32 v199, v199
    v_rcp_f32 v200, v200
    v_rcp_f32 v201, v201
    v_rcp_f32 v202, v202
    v_rcp_f32 v203, v203
    v_pk_mul_f32 v[204:205], v[188:189], v[204:205]
    v_pk_mul_f32 v[206:207], v[190:191], v[206:207]
    v_pk_mul_f32 v[208:209], v[192:193], v[208:209]
    v_pk_mul_f32 v[210:211], v[194:195], v[210:211]
    v_pk_mul_f32 v[212:213], v[196:197], v[212:213]
    v_pk_mul_f32 v[214:215], v[198:199], v[214:215]
    v_pk_mul_f32 v[216:217], v[200:201], v[216:217]
    v_pk_mul_f32 v[218:219], v[202:203], v[218:219]
    s_cmp_ge_i32 s96, 1
    s_cbranch_scc0 L_PB10
L_PB11:
    s_setprio 1
    v_smfmac_f32_16x16x64_bf16 v[144:147], v[184:187], v[204:211], v242
    v_exp_f32 v220, v220
    v_smfmac_f32_16x16x64_bf16 v[148:151], v[184:187], v[212:219], v242
    v_exp_f32 v221, v221
    s_waitcnt vmcnt(0)
    ds_read_b128 v[176:179], v251
    ds_read_b128 v[180:183], v252
    v_mfma_f32_16x16x32_bf16 v[204:207], v[160:163], v[48:51], 0
    v_exp_f32 v222, v222
    v_mfma_f32_16x16x32_bf16 v[212:215], v[160:163], v[56:59], 0
    ds_read_b128 v[160:163], v244 offset:0
    v_exp_f32 v223, v223
    v_mfma_f32_16x16x32_bf16 v[208:211], v[168:171], v[48:51], 0
    v_exp_f32 v224, v224
    v_mfma_f32_16x16x32_bf16 v[216:219], v[168:171], v[56:59], 0
    ds_read_b128 v[168:171], v244 offset:512
    v_exp_f32 v225, v225
    v_mfma_f32_16x16x32_bf16 v[204:207], v[164:167], v[52:55], v[204:207]
    v_exp_f32 v226, v226
    v_mfma_f32_16x16x32_bf16 v[212:215], v[164:167], v[60:63], v[212:215]
    ds_read_b128 v[164:167], v244 offset:64
    v_exp_f32 v227, v227
    v_mfma_f32_16x16x32_bf16 v[208:211], v[172:175], v[52:55], v[208:211]
    v_exp_f32 v228, v228
    v_mfma_f32_16x16x32_bf16 v[216:219], v[172:175], v[60:63], v[216:219]
    ds_read_b128 v[172:175], v244 offset:576
    v_exp_f32 v229, v229
    s_setprio 3
    v_smfmac_f32_16x16x64_bf16 v[128:131], v[184:187], v[188:195], v242
    v_exp_f32 v230, v230
    v_smfmac_f32_16x16x64_bf16 v[132:135], v[184:187], v[196:203], v242
    v_exp_f32 v231, v231
    v_exp_f32 v232, v232
    v_exp_f32 v233, v233
    v_exp_f32 v234, v234
    v_exp_f32 v235, v235
    v_pk_add_f32 v[220:221], v[220:221], 1.0 op_sel_hi:[1,0]
    v_pk_add_f32 v[222:223], v[222:223], 1.0 op_sel_hi:[1,0]
    v_pk_add_f32 v[224:225], v[224:225], 1.0 op_sel_hi:[1,0]
    v_pk_add_f32 v[226:227], v[226:227], 1.0 op_sel_hi:[1,0]
    v_pk_add_f32 v[228:229], v[228:229], 1.0 op_sel_hi:[1,0]
    v_pk_add_f32 v[230:231], v[230:231], 1.0 op_sel_hi:[1,0]
    v_pk_add_f32 v[232:233], v[232:233], 1.0 op_sel_hi:[1,0]
    v_pk_add_f32 v[234:235], v[234:235], 1.0 op_sel_hi:[1,0]
    s_setprio 1
    s_waitcnt lgkmcnt(4)
    v_mfma_f32_16x16x32_bf16 v[188:191], v[176:179], v[64:67], 0
    v_rcp_f32 v220, v220
    v_mfma_f32_16x16x32_bf16 v[196:199], v[176:179], v[68:71], 0
    v_rcp_f32 v221, v221
    v_mfma_f32_16x16x32_bf16 v[192:195], v[180:183], v[64:67], 0
    v_rcp_f32 v222, v222
    v_mfma_f32_16x16x32_bf16 v[200:203], v[180:183], v[68:71], 0
    v_rcp_f32 v223, v223
    s_waitcnt lgkmcnt(3)
    v_mfma_f32_16x16x32_bf16 v[188:191], v[160:163], v[0:3], v[188:191]
    v_rcp_f32 v224, v224
    v_mfma_f32_16x16x32_bf16 v[196:199], v[160:163], v[8:11], v[196:199]
    v_rcp_f32 v225, v225
    s_waitcnt lgkmcnt(2)
    v_mfma_f32_16x16x32_bf16 v[192:195], v[168:171], v[0:3], v[192:195]
    v_rcp_f32 v226, v226
    v_mfma_f32_16x16x32_bf16 v[200:203], v[168:171], v[8:11], v[200:203]
    v_rcp_f32 v227, v227
    s_waitcnt lgkmcnt(1)
    v_mfma_f32_16x16x32_bf16 v[188:191], v[164:167], v[4:7], v[188:191]
    v_rcp_f32 v228, v228
    v_mfma_f32_16x16x32_bf16 v[196:199], v[164:167], v[12:15], v[196:199]
    v_rcp_f32 v229, v229
    s_setprio 3
    s_waitcnt lgkmcnt(0)
    v_mfma_f32_16x16x32_bf16 v[192:195], v[172:175], v[4:7], v[192:195]
    s_cmp_lt_u32 s16, s17
    s_cbranch_scc0 L_ND11
    s_add_u32 m0, s13, 0
    v_mad_u32_u16 v236, v236, s15, v243
    buffer_load_dwordx4 v236, s[40:43], 0 offen lds
    s_add_u32 m0, s13, 1056
    v_mad_u32_u16 v237, v237, s15, v243
    buffer_load_dwordx4 v237, s[40:43], 0 offen lds
    s_add_u32 m0, s13, 2112
    v_mad_u32_u16 v238, v238, s15, v243
    buffer_load_dwordx4 v238, s[40:43], 0 offen lds
    s_add_u32 m0, s13, 3168
    v_mad_u32_u16 v239, v239, s15, v243
    buffer_load_dwordx4 v239, s[40:43], 0 offen lds
    s_mov_b32 m0, s14
    v_and_b32 v240, 0xfffff, v240
    buffer_load_dwordx4 v[240:241], s[44:47], 0 idxen offen lds
L_ND11:
    v_rcp_f32 v230, v230
    v_mfma_f32_16x16x32_bf16 v[200:203], v[172:175], v[12:15], v[200:203]
    v_rcp_f32 v231, v231
    v_rcp_f32 v232, v232
    v_rcp_f32 v233, v233
    v_rcp_f32 v234, v234
    v_rcp_f32 v235, v235
    v_pk_mul_f32 v[204:205], v[220:221], v[204:205]
    v_pk_mul_f32 v[206:207], v[222:223], v[206:207]
    v_pk_mul_f32 v[208:209], v[224:225], v[208:209]
    v_pk_mul_f32 v[210:211], v[226:227], v[210:211]
    v_pk_mul_f32 v[212:213], v[228:229], v[212:213]
    v_pk_mul_f32 v[214:215], v[230:231], v[214:215]
    v_pk_mul_f32 v[216:217], v[232:233], v[216:217]
    v_pk_mul_f32 v[218:219], v[234:235], v[218:219]
    s_cmp_lt_u32 s16, s17
    s_cbranch_scc1 L_LOOP1
    s_branch L_LT0
.p2align 6
L_LOOP0:
    s_setprio 0
    v_smfmac_f32_16x16x64_bf16 v[152:155], v[184:187], v[204:211], v242
    ds_read_u16 v236, v250 offset:0
    ds_read_u16 v237, v250 offset:16
    ds_add_rtn_u32 v238, v255, v242
    v_exp_f32 v188, v188
    v_smfmac_f32_16x16x64_bf16 v[156:159], v[184:187], v[212:219], v242
    v_exp_f32 v189, v189
    v_mfma_f32_16x16x32_bf16 v[204:207], v[160:163], v[32:35], 0
    v_exp_f32 v190, v190
    v_mfma_f32_16x16x32_bf16 v[212:215], v[160:163], v[40:43], 0
    v_exp_f32 v191, v191
    v_mfma_f32_16x16x32_bf16 v[208:211], v[168:171], v[32:35], 0
    v_exp_f32 v192, v192
    v_mfma_f32_16x16x32_bf16 v[216:219], v[168:171], v[40:43], 0
    v_exp_f32 v193, v193
    v_mfma_f32_16x16x32_bf16 v[204:207], v[164:167], v[36:39], v[204:207]
    v_exp_f32 v194, v194
    v_mfma_f32_16x16x32_bf16 v[212:215], v[164:167], v[44:47], v[212:215]
    v_exp_f32 v195, v195
    v_mfma_f32_16x16x32_bf16 v[208:211], v[172:175], v[36:39], v[208:211]
    s_waitcnt lgkmcnt(0)
    v_bfi_b32 v236, 31, v246, v236
    v_bfi_b32 v237, 31, v246, v237
    v_readfirstlane_b32 s96, v238
    v_exp_f32 v196, v196
    v_mfma_f32_16x16x32_bf16 v[216:219], v[172:175], v[44:47], v[216:219]
    v_exp_f32 v197, v197
    s_setprio 3
    v_smfmac_f32_16x16x64_bf16 v[136:139], v[184:187], v[220:227], v242
    v_exp_f32 v198, v198
    v_smfmac_f32_16x16x64_bf16 v[140:143], v[184:187], v[228:235], v242
    v_exp_f32 v199, v199
    v_exp_f32 v200, v200
    v_exp_f32 v201, v201
    v_exp_f32 v202, v202
    v_exp_f32 v203, v203
    v_pk_add_f32 v[188:189], v[188:189], 1.0 op_sel_hi:[1,0]
    v_pk_add_f32 v[190:191], v[190:191], 1.0 op_sel_hi:[1,0]
    v_pk_add_f32 v[192:193], v[192:193], 1.0 op_sel_hi:[1,0]
    v_pk_add_f32 v[194:195], v[194:195], 1.0 op_sel_hi:[1,0]
    v_pk_add_f32 v[196:197], v[196:197], 1.0 op_sel_hi:[1,0]
    v_pk_add_f32 v[198:199], v[198:199], 1.0 op_sel_hi:[1,0]
    v_pk_add_f32 v[200:201], v[200:201], 1.0 op_sel_hi:[1,0]
    v_pk_add_f32 v[202:203], v[202:203], 1.0 op_sel_hi:[1,0]
    s_setprio 0
    v_mfma_f32_16x16x32_bf16 v[220:223], v[176:179], v[72:75], 0
    ds_read_b64_tr_b16 v[184:185], v236
    ds_read_b64_tr_b16 v[186:187], v237
    ds_read_u16 v251, v249 offset:1152
    ds_read_u16 v252, v249 offset:1216
    v_rcp_f32 v188, v188
    v_mfma_f32_16x16x32_bf16 v[228:231], v[176:179], v[76:79], 0
    s_ashr_i32 s96, s96, 24
    s_mul_i32 s96, s96, s101
    v_rcp_f32 v189, v189
    v_mfma_f32_16x16x32_bf16 v[224:227], v[180:183], v[72:75], 0
    v_rcp_f32 v190, v190
    v_mfma_f32_16x16x32_bf16 v[232:235], v[180:183], v[76:79], 0
    v_rcp_f32 v191, v191
    v_mfma_f32_16x16x32_bf16 v[220:223], v[160:163], v[16:19], v[220:223]
    v_rcp_f32 v192, v192
    v_mfma_f32_16x16x32_bf16 v[228:231], v[160:163], v[24:27], v[228:231]
    v_rcp_f32 v193, v193
    v_mfma_f32_16x16x32_bf16 v[224:227], v[168:171], v[16:19], v[224:227]
    s_waitcnt lgkmcnt(0)
    v_bfi_b32 v251, 31, v245, v251
    v_bfi_b32 v252, 31, v245, v252
    v_max_u32 v251, v251, v245
    v_max_u32 v252, v252, v253
    ds_read_b128 v[236:239], v247 offset:128
    ds_read_b32 v240, v248 offset:128
    s_add_u32 s16, s16, 1
    v_rcp_f32 v194, v194
    v_mfma_f32_16x16x32_bf16 v[232:235], v[168:171], v[24:27], v[232:235]
    v_rcp_f32 v195, v195
    v_mfma_f32_16x16x32_bf16 v[220:223], v[164:167], v[20:23], v[220:223]
    v_rcp_f32 v196, v196
    v_mfma_f32_16x16x32_bf16 v[228:231], v[164:167], v[28:31], v[228:231]
    v_rcp_f32 v197, v197
    s_setprio 3
    v_mfma_f32_16x16x32_bf16 v[224:227], v[172:175], v[20:23], v[224:227]
    v_rcp_f32 v198, v198
    v_mfma_f32_16x16x32_bf16 v[232:235], v[172:175], v[28:31], v[232:235]
    v_rcp_f32 v199, v199
    v_rcp_f32 v200, v200
    v_rcp_f32 v201, v201
    v_rcp_f32 v202, v202
    v_rcp_f32 v203, v203
    v_pk_mul_f32 v[204:205], v[188:189], v[204:205]
    v_pk_mul_f32 v[206:207], v[190:191], v[206:207]
    v_pk_mul_f32 v[208:209], v[192:193], v[208:209]
    v_pk_mul_f32 v[210:211], v[194:195], v[210:211]
    v_pk_mul_f32 v[212:213], v[196:197], v[212:213]
    v_pk_mul_f32 v[214:215], v[198:199], v[214:215]
    v_pk_mul_f32 v[216:217], v[200:201], v[216:217]
    v_pk_mul_f32 v[218:219], v[202:203], v[218:219]
    s_cmp_ge_i32 s96, 1
    s_cbranch_scc1 L_PB01
L_PB00:
    s_setprio 0
    v_smfmac_f32_16x16x64_bf16 v[112:115], v[184:187], v[204:211], v242
    v_exp_f32 v220, v220
    v_smfmac_f32_16x16x64_bf16 v[116:119], v[184:187], v[212:219], v242
    v_exp_f32 v221, v221
    s_waitcnt vmcnt(0)
    ds_read_b128 v[176:179], v251
    ds_read_b128 v[180:183], v252
    v_mfma_f32_16x16x32_bf16 v[204:207], v[160:163], v[48:51], 0
    v_exp_f32 v222, v222
    v_mfma_f32_16x16x32_bf16 v[212:215], v[160:163], v[56:59], 0
    ds_read_b128 v[160:163], v244 offset:0
    v_exp_f32 v223, v223
    v_mfma_f32_16x16x32_bf16 v[208:211], v[168:171], v[48:51], 0
    v_exp_f32 v224, v224
    v_mfma_f32_16x16x32_bf16 v[216:219], v[168:171], v[56:59], 0
    ds_read_b128 v[168:171], v244 offset:512
    v_exp_f32 v225, v225
    v_mfma_f32_16x16x32_bf16 v[204:207], v[164:167], v[52:55], v[204:207]
    v_exp_f32 v226, v226
    v_mfma_f32_16x16x32_bf16 v[212:215], v[164:167], v[60:63], v[212:215]
    ds_read_b128 v[164:167], v244 offset:64
    v_exp_f32 v227, v227
    v_mfma_f32_16x16x32_bf16 v[208:211], v[172:175], v[52:55], v[208:211]
    v_exp_f32 v228, v228
    v_mfma_f32_16x16x32_bf16 v[216:219], v[172:175], v[60:63], v[216:219]
    ds_read_b128 v[172:175], v244 offset:576
    v_exp_f32 v229, v229
    s_setprio 3
    v_smfmac_f32_16x16x64_bf16 v[96:99], v[184:187], v[188:195], v242
    v_exp_f32 v230, v230
    v_smfmac_f32_16x16x64_bf16 v[100:103], v[184:187], v[196:203], v242
    v_exp_f32 v231, v231
    v_exp_f32 v232, v232
    v_exp_f32 v233, v233
    v_exp_f32 v234, v234
    v_exp_f32 v235, v235
    v_pk_add_f32 v[220:221], v[220:221], 1.0 op_sel_hi:[1,0]
    v_pk_add_f32 v[222:223], v[222:223], 1.0 op_sel_hi:[1,0]
    v_pk_add_f32 v[224:225], v[224:225], 1.0 op_sel_hi:[1,0]
    v_pk_add_f32 v[226:227], v[226:227], 1.0 op_sel_hi:[1,0]
    v_pk_add_f32 v[228:229], v[228:229], 1.0 op_sel_hi:[1,0]
    v_pk_add_f32 v[230:231], v[230:231], 1.0 op_sel_hi:[1,0]
    v_pk_add_f32 v[232:233], v[232:233], 1.0 op_sel_hi:[1,0]
    v_pk_add_f32 v[234:235], v[234:235], 1.0 op_sel_hi:[1,0]
    s_setprio 0
    s_waitcnt lgkmcnt(4)
    v_mfma_f32_16x16x32_bf16 v[188:191], v[176:179], v[80:83], 0
    v_rcp_f32 v220, v220
    v_mfma_f32_16x16x32_bf16 v[196:199], v[176:179], v[84:87], 0
    v_rcp_f32 v221, v221
    v_mfma_f32_16x16x32_bf16 v[192:195], v[180:183], v[80:83], 0
    v_rcp_f32 v222, v222
    v_mfma_f32_16x16x32_bf16 v[200:203], v[180:183], v[84:87], 0
    v_rcp_f32 v223, v223
    s_waitcnt lgkmcnt(3)
    v_mfma_f32_16x16x32_bf16 v[188:191], v[160:163], v[0:3], v[188:191]
    v_rcp_f32 v224, v224
    v_mfma_f32_16x16x32_bf16 v[196:199], v[160:163], v[8:11], v[196:199]
    v_rcp_f32 v225, v225
    s_waitcnt lgkmcnt(2)
    v_mfma_f32_16x16x32_bf16 v[192:195], v[168:171], v[0:3], v[192:195]
    v_rcp_f32 v226, v226
    v_mfma_f32_16x16x32_bf16 v[200:203], v[168:171], v[8:11], v[200:203]
    v_rcp_f32 v227, v227
    s_waitcnt lgkmcnt(1)
    v_mfma_f32_16x16x32_bf16 v[188:191], v[164:167], v[4:7], v[188:191]
    v_rcp_f32 v228, v228
    v_mfma_f32_16x16x32_bf16 v[196:199], v[164:167], v[12:15], v[196:199]
    v_rcp_f32 v229, v229
    s_setprio 3
    s_waitcnt lgkmcnt(0)
    v_mfma_f32_16x16x32_bf16 v[192:195], v[172:175], v[4:7], v[192:195]
    s_cmp_lt_u32 s16, s17
    s_cbranch_scc0 L_ND00
    s_add_u32 m0, s13, 0
    v_mad_u32_u16 v236, v236, s15, v243
    buffer_load_dwordx4 v236, s[40:43], 0 offen lds
    s_add_u32 m0, s13, 1056
    v_mad_u32_u16 v237, v237, s15, v243
    buffer_load_dwordx4 v237, s[40:43], 0 offen lds
    s_add_u32 m0, s13, 2112
    v_mad_u32_u16 v238, v238, s15, v243
    buffer_load_dwordx4 v238, s[40:43], 0 offen lds
    s_add_u32 m0, s13, 3168
    v_mad_u32_u16 v239, v239, s15, v243
    buffer_load_dwordx4 v239, s[40:43], 0 offen lds
    s_mov_b32 m0, s14
    v_and_b32 v240, 0xfffff, v240
    buffer_load_dwordx4 v[240:241], s[44:47], 0 idxen offen lds
L_ND00:
    v_rcp_f32 v230, v230
    v_mfma_f32_16x16x32_bf16 v[200:203], v[172:175], v[12:15], v[200:203]
    v_rcp_f32 v231, v231
    v_rcp_f32 v232, v232
    v_rcp_f32 v233, v233
    v_rcp_f32 v234, v234
    v_rcp_f32 v235, v235
    v_pk_mul_f32 v[204:205], v[220:221], v[204:205]
    v_pk_mul_f32 v[206:207], v[222:223], v[206:207]
    v_pk_mul_f32 v[208:209], v[224:225], v[208:209]
    v_pk_mul_f32 v[210:211], v[226:227], v[210:211]
    v_pk_mul_f32 v[212:213], v[228:229], v[212:213]
    v_pk_mul_f32 v[214:215], v[230:231], v[214:215]
    v_pk_mul_f32 v[216:217], v[232:233], v[216:217]
    v_pk_mul_f32 v[218:219], v[234:235], v[218:219]
    s_cmp_ge_u32 s16, s17
    s_cbranch_scc1 L_LT1
    s_setprio 0
    v_smfmac_f32_16x16x64_bf16 v[120:123], v[184:187], v[204:211], v242
    ds_read_u16 v236, v250 offset:1152
    ds_read_u16 v237, v250 offset:1168
    ds_add_rtn_u32 v238, v255, v242
    v_exp_f32 v188, v188
    v_smfmac_f32_16x16x64_bf16 v[124:127], v[184:187], v[212:219], v242
    v_exp_f32 v189, v189
    v_mfma_f32_16x16x32_bf16 v[204:207], v[160:163], v[32:35], 0
    v_exp_f32 v190, v190
    v_mfma_f32_16x16x32_bf16 v[212:215], v[160:163], v[40:43], 0
    v_exp_f32 v191, v191
    v_mfma_f32_16x16x32_bf16 v[208:211], v[168:171], v[32:35], 0
    v_exp_f32 v192, v192
    v_mfma_f32_16x16x32_bf16 v[216:219], v[168:171], v[40:43], 0
    v_exp_f32 v193, v193
    v_mfma_f32_16x16x32_bf16 v[204:207], v[164:167], v[36:39], v[204:207]
    v_exp_f32 v194, v194
    v_mfma_f32_16x16x32_bf16 v[212:215], v[164:167], v[44:47], v[212:215]
    v_exp_f32 v195, v195
    v_mfma_f32_16x16x32_bf16 v[208:211], v[172:175], v[36:39], v[208:211]
    s_waitcnt lgkmcnt(0)
    v_bfi_b32 v236, 31, v246, v236
    v_bfi_b32 v237, 31, v246, v237
    v_readfirstlane_b32 s96, v238
    v_exp_f32 v196, v196
    v_mfma_f32_16x16x32_bf16 v[216:219], v[172:175], v[44:47], v[216:219]
    v_exp_f32 v197, v197
    s_setprio 3
    v_smfmac_f32_16x16x64_bf16 v[104:107], v[184:187], v[220:227], v242
    v_exp_f32 v198, v198
    v_smfmac_f32_16x16x64_bf16 v[108:111], v[184:187], v[228:235], v242
    v_exp_f32 v199, v199
    v_exp_f32 v200, v200
    v_exp_f32 v201, v201
    v_exp_f32 v202, v202
    v_exp_f32 v203, v203
    v_pk_add_f32 v[188:189], v[188:189], 1.0 op_sel_hi:[1,0]
    v_pk_add_f32 v[190:191], v[190:191], 1.0 op_sel_hi:[1,0]
    v_pk_add_f32 v[192:193], v[192:193], 1.0 op_sel_hi:[1,0]
    v_pk_add_f32 v[194:195], v[194:195], 1.0 op_sel_hi:[1,0]
    v_pk_add_f32 v[196:197], v[196:197], 1.0 op_sel_hi:[1,0]
    v_pk_add_f32 v[198:199], v[198:199], 1.0 op_sel_hi:[1,0]
    v_pk_add_f32 v[200:201], v[200:201], 1.0 op_sel_hi:[1,0]
    v_pk_add_f32 v[202:203], v[202:203], 1.0 op_sel_hi:[1,0]
    s_setprio 0
    v_mfma_f32_16x16x32_bf16 v[220:223], v[176:179], v[88:91], 0
    ds_read_b64_tr_b16 v[184:185], v236
    ds_read_b64_tr_b16 v[186:187], v237
    ds_read_u16 v251, v249 offset:128
    ds_read_u16 v252, v249 offset:192
    v_rcp_f32 v188, v188
    v_mfma_f32_16x16x32_bf16 v[228:231], v[176:179], v[92:95], 0
    s_ashr_i32 s96, s96, 24
    s_mul_i32 s96, s96, s101
    v_rcp_f32 v189, v189
    v_mfma_f32_16x16x32_bf16 v[224:227], v[180:183], v[88:91], 0
    v_rcp_f32 v190, v190
    v_mfma_f32_16x16x32_bf16 v[232:235], v[180:183], v[92:95], 0
    v_rcp_f32 v191, v191
    v_mfma_f32_16x16x32_bf16 v[220:223], v[160:163], v[16:19], v[220:223]
    v_rcp_f32 v192, v192
    v_mfma_f32_16x16x32_bf16 v[228:231], v[160:163], v[24:27], v[228:231]
    v_rcp_f32 v193, v193
    v_mfma_f32_16x16x32_bf16 v[224:227], v[168:171], v[16:19], v[224:227]
    s_waitcnt lgkmcnt(0)
    v_bfi_b32 v251, 31, v245, v251
    v_bfi_b32 v252, 31, v245, v252
    v_max_u32 v251, v251, v245
    v_max_u32 v252, v252, v253
    ds_read_b128 v[236:239], v247 offset:1280
    ds_read_b32 v240, v248 offset:1280
    s_add_u32 s16, s16, 1
    v_rcp_f32 v194, v194
    v_mfma_f32_16x16x32_bf16 v[232:235], v[168:171], v[24:27], v[232:235]
    v_add_u32 v247, 0x80, v247
    v_add_u32 v248, 0x80, v248
    v_add_u32 v249, 0x80, v249
    v_add_u32 v250, 0x80, v250
    v_rcp_f32 v195, v195
    v_mfma_f32_16x16x32_bf16 v[220:223], v[164:167], v[20:23], v[220:223]
    v_rcp_f32 v196, v196
    v_mfma_f32_16x16x32_bf16 v[228:231], v[164:167], v[28:31], v[228:231]
    v_rcp_f32 v197, v197
    s_setprio 3
    v_mfma_f32_16x16x32_bf16 v[224:227], v[172:175], v[20:23], v[224:227]
    v_rcp_f32 v198, v198
    v_mfma_f32_16x16x32_bf16 v[232:235], v[172:175], v[28:31], v[232:235]
    v_rcp_f32 v199, v199
    v_rcp_f32 v200, v200
    v_rcp_f32 v201, v201
    v_rcp_f32 v202, v202
    v_rcp_f32 v203, v203
    v_pk_mul_f32 v[204:205], v[188:189], v[204:205]
    v_pk_mul_f32 v[206:207], v[190:191], v[206:207]
    v_pk_mul_f32 v[208:209], v[192:193], v[208:209]
    v_pk_mul_f32 v[210:211], v[194:195], v[210:211]
    v_pk_mul_f32 v[212:213], v[196:197], v[212:213]
    v_pk_mul_f32 v[214:215], v[198:199], v[214:215]
    v_pk_mul_f32 v[216:217], v[200:201], v[216:217]
    v_pk_mul_f32 v[218:219], v[202:203], v[218:219]
    s_cmp_ge_i32 s96, 1
    s_cbranch_scc1 L_PB11
L_PB10:
    s_setprio 0
    v_smfmac_f32_16x16x64_bf16 v[144:147], v[184:187], v[204:211], v242
    v_exp_f32 v220, v220
    v_smfmac_f32_16x16x64_bf16 v[148:151], v[184:187], v[212:219], v242
    v_exp_f32 v221, v221
    s_waitcnt vmcnt(0)
    ds_read_b128 v[176:179], v251
    ds_read_b128 v[180:183], v252
    v_mfma_f32_16x16x32_bf16 v[204:207], v[160:163], v[48:51], 0
    v_exp_f32 v222, v222
    v_mfma_f32_16x16x32_bf16 v[212:215], v[160:163], v[56:59], 0
    ds_read_b128 v[160:163], v244 offset:0
    v_exp_f32 v223, v223
    v_mfma_f32_16x16x32_bf16 v[208:211], v[168:171], v[48:51], 0
    v_exp_f32 v224, v224
    v_mfma_f32_16x16x32_bf16 v[216:219], v[168:171], v[56:59], 0
    ds_read_b128 v[168:171], v244 offset:512
    v_exp_f32 v225, v225
    v_mfma_f32_16x16x32_bf16 v[204:207], v[164:167], v[52:55], v[204:207]
    v_exp_f32 v226, v226
    v_mfma_f32_16x16x32_bf16 v[212:215], v[164:167], v[60:63], v[212:215]
    ds_read_b128 v[164:167], v244 offset:64
    v_exp_f32 v227, v227
    v_mfma_f32_16x16x32_bf16 v[208:211], v[172:175], v[52:55], v[208:211]
    v_exp_f32 v228, v228
    v_mfma_f32_16x16x32_bf16 v[216:219], v[172:175], v[60:63], v[216:219]
    ds_read_b128 v[172:175], v244 offset:576
    v_exp_f32 v229, v229
    s_setprio 3
    v_smfmac_f32_16x16x64_bf16 v[128:131], v[184:187], v[188:195], v242
    v_exp_f32 v230, v230
    v_smfmac_f32_16x16x64_bf16 v[132:135], v[184:187], v[196:203], v242
    v_exp_f32 v231, v231
    v_exp_f32 v232, v232
    v_exp_f32 v233, v233
    v_exp_f32 v234, v234
    v_exp_f32 v235, v235
    v_pk_add_f32 v[220:221], v[220:221], 1.0 op_sel_hi:[1,0]
    v_pk_add_f32 v[222:223], v[222:223], 1.0 op_sel_hi:[1,0]
    v_pk_add_f32 v[224:225], v[224:225], 1.0 op_sel_hi:[1,0]
    v_pk_add_f32 v[226:227], v[226:227], 1.0 op_sel_hi:[1,0]
    v_pk_add_f32 v[228:229], v[228:229], 1.0 op_sel_hi:[1,0]
    v_pk_add_f32 v[230:231], v[230:231], 1.0 op_sel_hi:[1,0]
    v_pk_add_f32 v[232:233], v[232:233], 1.0 op_sel_hi:[1,0]
    v_pk_add_f32 v[234:235], v[234:235], 1.0 op_sel_hi:[1,0]
    s_setprio 0
    s_waitcnt lgkmcnt(4)
    v_mfma_f32_16x16x32_bf16 v[188:191], v[176:179], v[64:67], 0
    v_rcp_f32 v220, v220
    v_mfma_f32_16x16x32_bf16 v[196:199], v[176:179], v[68:71], 0
    v_rcp_f32 v221, v221
    v_mfma_f32_16x16x32_bf16 v[192:195], v[180:183], v[64:67], 0
    v_rcp_f32 v222, v222
    v_mfma_f32_16x16x32_bf16 v[200:203], v[180:183], v[68:71], 0
    v_rcp_f32 v223, v223
    s_waitcnt lgkmcnt(3)
    v_mfma_f32_16x16x32_bf16 v[188:191], v[160:163], v[0:3], v[188:191]
    v_rcp_f32 v224, v224
    v_mfma_f32_16x16x32_bf16 v[196:199], v[160:163], v[8:11], v[196:199]
    v_rcp_f32 v225, v225
    s_waitcnt lgkmcnt(2)
    v_mfma_f32_16x16x32_bf16 v[192:195], v[168:171], v[0:3], v[192:195]
    v_rcp_f32 v226, v226
    v_mfma_f32_16x16x32_bf16 v[200:203], v[168:171], v[8:11], v[200:203]
    v_rcp_f32 v227, v227
    s_waitcnt lgkmcnt(1)
    v_mfma_f32_16x16x32_bf16 v[188:191], v[164:167], v[4:7], v[188:191]
    v_rcp_f32 v228, v228
    v_mfma_f32_16x16x32_bf16 v[196:199], v[164:167], v[12:15], v[196:199]
    v_rcp_f32 v229, v229
    s_setprio 3
    s_waitcnt lgkmcnt(0)
    v_mfma_f32_16x16x32_bf16 v[192:195], v[172:175], v[4:7], v[192:195]
    s_cmp_lt_u32 s16, s17
    s_cbranch_scc0 L_ND10
    s_add_u32 m0, s13, 0
    v_mad_u32_u16 v236, v236, s15, v243
    buffer_load_dwordx4 v236, s[40:43], 0 offen lds
    s_add_u32 m0, s13, 1056
    v_mad_u32_u16 v237, v237, s15, v243
    buffer_load_dwordx4 v237, s[40:43], 0 offen lds
    s_add_u32 m0, s13, 2112
    v_mad_u32_u16 v238, v238, s15, v243
    buffer_load_dwordx4 v238, s[40:43], 0 offen lds
    s_add_u32 m0, s13, 3168
    v_mad_u32_u16 v239, v239, s15, v243
    buffer_load_dwordx4 v239, s[40:43], 0 offen lds
    s_mov_b32 m0, s14
    v_and_b32 v240, 0xfffff, v240
    buffer_load_dwordx4 v[240:241], s[44:47], 0 idxen offen lds
L_ND10:
    v_rcp_f32 v230, v230
    v_mfma_f32_16x16x32_bf16 v[200:203], v[172:175], v[12:15], v[200:203]
    v_rcp_f32 v231, v231
    v_rcp_f32 v232, v232
    v_rcp_f32 v233, v233
    v_rcp_f32 v234, v234
    v_rcp_f32 v235, v235
    v_pk_mul_f32 v[204:205], v[220:221], v[204:205]
    v_pk_mul_f32 v[206:207], v[222:223], v[206:207]
    v_pk_mul_f32 v[208:209], v[224:225], v[208:209]
    v_pk_mul_f32 v[210:211], v[226:227], v[210:211]
    v_pk_mul_f32 v[212:213], v[228:229], v[212:213]
    v_pk_mul_f32 v[214:215], v[230:231], v[214:215]
    v_pk_mul_f32 v[216:217], v[232:233], v[216:217]
    v_pk_mul_f32 v[218:219], v[234:235], v[218:219]
    s_cmp_lt_u32 s16, s17
    s_cbranch_scc1 L_LOOP0
L_LT0:
    s_cmp_lg_u32 s99, 0
    s_cbranch_scc1 L_LH0
    s_setprio 0
    v_smfmac_f32_16x16x64_bf16 v[152:155], v[184:187], v[204:211], v242
    ds_read_u16 v236, v250 offset:0
    ds_read_u16 v237, v250 offset:16
    v_exp_f32 v188, v188
    v_smfmac_f32_16x16x64_bf16 v[156:159], v[184:187], v[212:219], v242
    v_exp_f32 v189, v189
    v_mfma_f32_16x16x32_bf16 v[204:207], v[160:163], v[32:35], 0
    v_exp_f32 v190, v190
    v_mfma_f32_16x16x32_bf16 v[212:215], v[160:163], v[40:43], 0
    v_exp_f32 v191, v191
    v_mfma_f32_16x16x32_bf16 v[208:211], v[168:171], v[32:35], 0
    v_exp_f32 v192, v192
    v_mfma_f32_16x16x32_bf16 v[216:219], v[168:171], v[40:43], 0
    v_exp_f32 v193, v193
    v_mfma_f32_16x16x32_bf16 v[204:207], v[164:167], v[36:39], v[204:207]
    v_exp_f32 v194, v194
    v_mfma_f32_16x16x32_bf16 v[212:215], v[164:167], v[44:47], v[212:215]
    v_exp_f32 v195, v195
    v_mfma_f32_16x16x32_bf16 v[208:211], v[172:175], v[36:39], v[208:211]
    v_exp_f32 v196, v196
    v_mfma_f32_16x16x32_bf16 v[216:219], v[172:175], v[44:47], v[216:219]
    v_exp_f32 v197, v197
    v_smfmac_f32_16x16x64_bf16 v[136:139], v[184:187], v[220:227], v242
    s_waitcnt lgkmcnt(0)
    v_bfi_b32 v236, 31, v246, v236
    v_bfi_b32 v237, 31, v246, v237
    v_exp_f32 v198, v198
    s_setprio 3
    v_smfmac_f32_16x16x64_bf16 v[140:143], v[184:187], v[228:235], v242
    v_exp_f32 v199, v199
    v_exp_f32 v200, v200
    v_exp_f32 v201, v201
    v_exp_f32 v202, v202
    v_exp_f32 v203, v203
    v_pk_add_f32 v[188:189], v[188:189], 1.0 op_sel_hi:[1,0]
    v_pk_add_f32 v[190:191], v[190:191], 1.0 op_sel_hi:[1,0]
    v_pk_add_f32 v[192:193], v[192:193], 1.0 op_sel_hi:[1,0]
    v_pk_add_f32 v[194:195], v[194:195], 1.0 op_sel_hi:[1,0]
    v_pk_add_f32 v[196:197], v[196:197], 1.0 op_sel_hi:[1,0]
    v_pk_add_f32 v[198:199], v[198:199], 1.0 op_sel_hi:[1,0]
    v_pk_add_f32 v[200:201], v[200:201], 1.0 op_sel_hi:[1,0]
    v_pk_add_f32 v[202:203], v[202:203], 1.0 op_sel_hi:[1,0]
    s_setprio 0
    v_mfma_f32_16x16x32_bf16 v[220:223], v[176:179], v[72:75], 0
    ds_read_b64_tr_b16 v[184:185], v236
    ds_read_b64_tr_b16 v[186:187], v237
    v_rcp_f32 v188, v188
    v_mfma_f32_16x16x32_bf16 v[228:231], v[176:179], v[76:79], 0
    v_rcp_f32 v189, v189
    v_mfma_f32_16x16x32_bf16 v[224:227], v[180:183], v[72:75], 0
    v_rcp_f32 v190, v190
    v_mfma_f32_16x16x32_bf16 v[232:235], v[180:183], v[76:79], 0
    v_rcp_f32 v191, v191
    v_mfma_f32_16x16x32_bf16 v[220:223], v[160:163], v[16:19], v[220:223]
    v_rcp_f32 v192, v192
    v_mfma_f32_16x16x32_bf16 v[228:231], v[160:163], v[24:27], v[228:231]
    v_rcp_f32 v193, v193
    v_mfma_f32_16x16x32_bf16 v[224:227], v[168:171], v[16:19], v[224:227]
    v_rcp_f32 v194, v194
    v_mfma_f32_16x16x32_bf16 v[232:235], v[168:171], v[24:27], v[232:235]
    v_rcp_f32 v195, v195
    v_mfma_f32_16x16x32_bf16 v[220:223], v[164:167], v[20:23], v[220:223]
    v_rcp_f32 v196, v196
    v_mfma_f32_16x16x32_bf16 v[228:231], v[164:167], v[28:31], v[228:231]
    v_rcp_f32 v197, v197
    v_mfma_f32_16x16x32_bf16 v[224:227], v[172:175], v[20:23], v[224:227]
    v_rcp_f32 v198, v198
    s_setprio 3
    v_mfma_f32_16x16x32_bf16 v[232:235], v[172:175], v[28:31], v[232:235]
    v_rcp_f32 v199, v199
    v_rcp_f32 v200, v200
    v_rcp_f32 v201, v201
    v_rcp_f32 v202, v202
    v_rcp_f32 v203, v203
    v_pk_mul_f32 v[204:205], v[188:189], v[204:205]
    v_pk_mul_f32 v[206:207], v[190:191], v[206:207]
    v_pk_mul_f32 v[208:209], v[192:193], v[208:209]
    v_pk_mul_f32 v[210:211], v[194:195], v[210:211]
    v_pk_mul_f32 v[212:213], v[196:197], v[212:213]
    v_pk_mul_f32 v[214:215], v[198:199], v[214:215]
    v_pk_mul_f32 v[216:217], v[200:201], v[216:217]
    v_pk_mul_f32 v[218:219], v[202:203], v[218:219]
    s_setprio 0
    s_waitcnt lgkmcnt(0)
    v_smfmac_f32_16x16x64_bf16 v[112:115], v[184:187], v[204:211], v242
    v_exp_f32 v220, v220
    v_smfmac_f32_16x16x64_bf16 v[116:119], v[184:187], v[212:219], v242
    v_exp_f32 v221, v221
    v_mfma_f32_16x16x32_bf16 v[204:207], v[160:163], v[48:51], 0
    v_exp_f32 v222, v222
    v_mfma_f32_16x16x32_bf16 v[212:215], v[160:163], v[56:59], 0
    v_exp_f32 v223, v223
    v_mfma_f32_16x16x32_bf16 v[208:211], v[168:171], v[48:51], 0
    v_exp_f32 v224, v224
    v_mfma_f32_16x16x32_bf16 v[216:219], v[168:171], v[56:59], 0
    v_exp_f32 v225, v225
    v_mfma_f32_16x16x32_bf16 v[204:207], v[164:167], v[52:55], v[204:207]
    v_exp_f32 v226, v226
    v_mfma_f32_16x16x32_bf16 v[212:215], v[164:167], v[60:63], v[212:215]
    v_exp_f32 v227, v227
    v_mfma_f32_16x16x32_bf16 v[208:211], v[172:175], v[52:55], v[208:211]
    v_exp_f32 v228, v228
    v_mfma_f32_16x16x32_bf16 v[216:219], v[172:175], v[60:63], v[216:219]
    v_exp_f32 v229, v229
    v_smfmac_f32_16x16x64_bf16 v[96:99], v[184:187], v[188:195], v242
    v_exp_f32 v230, v230
    s_setprio 3
    v_smfmac_f32_16x16x64_bf16 v[100:103], v[184:187], v[196:203], v242
    v_exp_f32 v231, v231
    v_exp_f32 v232, v232
    v_exp_f32 v233, v233
    v_exp_f32 v234, v234
    v_exp_f32 v235, v235
    v_pk_add_f32 v[220:221], v[220:221], 1.0 op_sel_hi:[1,0]
    v_pk_add_f32 v[222:223], v[222:223], 1.0 op_sel_hi:[1,0]
    v_pk_add_f32 v[224:225], v[224:225], 1.0 op_sel_hi:[1,0]
    v_pk_add_f32 v[226:227], v[226:227], 1.0 op_sel_hi:[1,0]
    v_pk_add_f32 v[228:229], v[228:229], 1.0 op_sel_hi:[1,0]
    v_pk_add_f32 v[230:231], v[230:231], 1.0 op_sel_hi:[1,0]
    v_pk_add_f32 v[232:233], v[232:233], 1.0 op_sel_hi:[1,0]
    v_pk_add_f32 v[234:235], v[234:235], 1.0 op_sel_hi:[1,0]
    s_setprio 0
    v_rcp_f32 v220, v220
    v_rcp_f32 v221, v221
    v_rcp_f32 v222, v222
    v_rcp_f32 v223, v223
    v_rcp_f32 v224, v224
    v_rcp_f32 v225, v225
    v_rcp_f32 v226, v226
    v_rcp_f32 v227, v227
    v_rcp_f32 v228, v228
    v_rcp_f32 v229, v229
    v_rcp_f32 v230, v230
    v_rcp_f32 v231, v231
    v_rcp_f32 v232, v232
    v_rcp_f32 v233, v233
    v_rcp_f32 v234, v234
    v_rcp_f32 v235, v235
    v_pk_mul_f32 v[204:205], v[220:221], v[204:205]
    v_pk_mul_f32 v[206:207], v[222:223], v[206:207]
    v_pk_mul_f32 v[208:209], v[224:225], v[208:209]
    v_pk_mul_f32 v[210:211], v[226:227], v[210:211]
    v_pk_mul_f32 v[212:213], v[228:229], v[212:213]
    v_pk_mul_f32 v[214:215], v[230:231], v[214:215]
    v_pk_mul_f32 v[216:217], v[232:233], v[216:217]
    v_pk_mul_f32 v[218:219], v[234:235], v[218:219]
    v_smfmac_f32_16x16x64_bf16 v[104:107], v[184:187], v[220:227], v242
    v_smfmac_f32_16x16x64_bf16 v[108:111], v[184:187], v[228:235], v242
    v_smfmac_f32_16x16x64_bf16 v[120:123], v[184:187], v[204:211], v242
    v_smfmac_f32_16x16x64_bf16 v[124:127], v[184:187], v[212:219], v242
    s_branch L_DONE
L_LH0:
    s_setprio 0
    v_smfmac_f32_16x16x64_bf16 v[152:155], v[184:187], v[204:211], v242
    ds_read_u16 v236, v250 offset:0
    ds_read_u16 v237, v250 offset:16
    v_smfmac_f32_16x16x64_bf16 v[156:159], v[184:187], v[212:219], v242
    v_exp_f32 v188, v188
    v_mfma_f32_16x16x32_bf16 v[204:207], v[160:163], v[32:35], 0
    v_mfma_f32_16x16x32_bf16 v[212:215], v[160:163], v[40:43], 0
    v_exp_f32 v189, v189
    v_mfma_f32_16x16x32_bf16 v[204:207], v[164:167], v[36:39], v[204:207]
    v_mfma_f32_16x16x32_bf16 v[212:215], v[164:167], v[44:47], v[212:215]
    v_exp_f32 v190, v190
    v_smfmac_f32_16x16x64_bf16 v[136:139], v[184:187], v[220:227], v242
    s_waitcnt lgkmcnt(0)
    v_bfi_b32 v236, 31, v246, v236
    v_bfi_b32 v237, 31, v246, v237
    v_exp_f32 v191, v191
    s_setprio 3
    v_smfmac_f32_16x16x64_bf16 v[140:143], v[184:187], v[228:235], v242
    v_exp_f32 v196, v196
    v_exp_f32 v197, v197
    v_exp_f32 v198, v198
    v_exp_f32 v199, v199
    v_pk_add_f32 v[188:189], v[188:189], 1.0 op_sel_hi:[1,0]
    v_pk_add_f32 v[190:191], v[190:191], 1.0 op_sel_hi:[1,0]
    v_pk_add_f32 v[196:197], v[196:197], 1.0 op_sel_hi:[1,0]
    v_pk_add_f32 v[198:199], v[198:199], 1.0 op_sel_hi:[1,0]
    s_setprio 0
    v_mfma_f32_16x16x32_bf16 v[220:223], v[176:179], v[72:75], 0
    ds_read_b64_tr_b16 v[184:185], v236
    ds_read_b64_tr_b16 v[186:187], v237
    v_mfma_f32_16x16x32_bf16 v[228:231], v[176:179], v[76:79], 0
    v_rcp_f32 v188, v188
    v_mfma_f32_16x16x32_bf16 v[220:223], v[160:163], v[16:19], v[220:223]
    v_rcp_f32 v189, v189
    v_mfma_f32_16x16x32_bf16 v[228:231], v[160:163], v[24:27], v[228:231]
    v_rcp_f32 v190, v190
    v_mfma_f32_16x16x32_bf16 v[220:223], v[164:167], v[20:23], v[220:223]
    v_rcp_f32 v191, v191
    s_setprio 3
    v_mfma_f32_16x16x32_bf16 v[228:231], v[164:167], v[28:31], v[228:231]
    v_rcp_f32 v196, v196
    v_rcp_f32 v197, v197
    v_rcp_f32 v198, v198
    v_rcp_f32 v199, v199
    v_pk_mul_f32 v[204:205], v[188:189], v[204:205]
    v_pk_mul_f32 v[206:207], v[190:191], v[206:207]
    v_pk_mul_f32 v[212:213], v[196:197], v[212:213]
    v_pk_mul_f32 v[214:215], v[198:199], v[214:215]
    s_setprio 0
    s_waitcnt lgkmcnt(0)
    v_smfmac_f32_16x16x64_bf16 v[112:115], v[184:187], v[204:211], v242
    v_smfmac_f32_16x16x64_bf16 v[116:119], v[184:187], v[212:219], v242
    v_exp_f32 v220, v220
    v_mfma_f32_16x16x32_bf16 v[204:207], v[160:163], v[48:51], 0
    v_mfma_f32_16x16x32_bf16 v[212:215], v[160:163], v[56:59], 0
    v_exp_f32 v221, v221
    v_mfma_f32_16x16x32_bf16 v[204:207], v[164:167], v[52:55], v[204:207]
    v_mfma_f32_16x16x32_bf16 v[212:215], v[164:167], v[60:63], v[212:215]
    v_exp_f32 v222, v222
    v_smfmac_f32_16x16x64_bf16 v[96:99], v[184:187], v[188:195], v242
    v_exp_f32 v223, v223
    s_setprio 3
    v_smfmac_f32_16x16x64_bf16 v[100:103], v[184:187], v[196:203], v242
    v_exp_f32 v228, v228
    v_exp_f32 v229, v229
    v_exp_f32 v230, v230
    v_exp_f32 v231, v231
    v_pk_add_f32 v[220:221], v[220:221], 1.0 op_sel_hi:[1,0]
    v_pk_add_f32 v[222:223], v[222:223], 1.0 op_sel_hi:[1,0]
    v_pk_add_f32 v[228:229], v[228:229], 1.0 op_sel_hi:[1,0]
    v_pk_add_f32 v[230:231], v[230:231], 1.0 op_sel_hi:[1,0]
    s_setprio 0
    v_rcp_f32 v220, v220
    v_rcp_f32 v221, v221
    v_rcp_f32 v222, v222
    v_rcp_f32 v223, v223
    v_rcp_f32 v228, v228
    v_rcp_f32 v229, v229
    v_rcp_f32 v230, v230
    v_rcp_f32 v231, v231
    v_pk_mul_f32 v[204:205], v[220:221], v[204:205]
    v_pk_mul_f32 v[206:207], v[222:223], v[206:207]
    v_pk_mul_f32 v[212:213], v[228:229], v[212:213]
    v_pk_mul_f32 v[214:215], v[230:231], v[214:215]
    v_smfmac_f32_16x16x64_bf16 v[104:107], v[184:187], v[220:227], v242
    v_smfmac_f32_16x16x64_bf16 v[108:111], v[184:187], v[228:235], v242
    v_smfmac_f32_16x16x64_bf16 v[120:123], v[184:187], v[204:211], v242
    v_smfmac_f32_16x16x64_bf16 v[124:127], v[184:187], v[212:219], v242
    s_branch L_DONE
L_LT1:
    s_cmp_lg_u32 s99, 0
    s_cbranch_scc1 L_LH1
    s_setprio 0
    v_smfmac_f32_16x16x64_bf16 v[120:123], v[184:187], v[204:211], v242
    ds_read_u16 v236, v250 offset:1152
    ds_read_u16 v237, v250 offset:1168
    v_exp_f32 v188, v188
    v_smfmac_f32_16x16x64_bf16 v[124:127], v[184:187], v[212:219], v242
    v_exp_f32 v189, v189
    v_mfma_f32_16x16x32_bf16 v[204:207], v[160:163], v[32:35], 0
    v_exp_f32 v190, v190
    v_mfma_f32_16x16x32_bf16 v[212:215], v[160:163], v[40:43], 0
    v_exp_f32 v191, v191
    v_mfma_f32_16x16x32_bf16 v[208:211], v[168:171], v[32:35], 0
    v_exp_f32 v192, v192
    v_mfma_f32_16x16x32_bf16 v[216:219], v[168:171], v[40:43], 0
    v_exp_f32 v193, v193
    v_mfma_f32_16x16x32_bf16 v[204:207], v[164:167], v[36:39], v[204:207]
    v_exp_f32 v194, v194
    v_mfma_f32_16x16x32_bf16 v[212:215], v[164:167], v[44:47], v[212:215]
    v_exp_f32 v195, v195
    v_mfma_f32_16x16x32_bf16 v[208:211], v[172:175], v[36:39], v[208:211]
    v_exp_f32 v196, v196
    v_mfma_f32_16x16x32_bf16 v[216:219], v[172:175], v[44:47], v[216:219]
    v_exp_f32 v197, v197
    v_smfmac_f32_16x16x64_bf16 v[104:107], v[184:187], v[220:227], v242
    s_waitcnt lgkmcnt(0)
    v_bfi_b32 v236, 31, v246, v236
    v_bfi_b32 v237, 31, v246, v237
    v_exp_f32 v198, v198
    s_setprio 3
    v_smfmac_f32_16x16x64_bf16 v[108:111], v[184:187], v[228:235], v242
    v_exp_f32 v199, v199
    v_exp_f32 v200, v200
    v_exp_f32 v201, v201
    v_exp_f32 v202, v202
    v_exp_f32 v203, v203
    v_pk_add_f32 v[188:189], v[188:189], 1.0 op_sel_hi:[1,0]
    v_pk_add_f32 v[190:191], v[190:191], 1.0 op_sel_hi:[1,0]
    v_pk_add_f32 v[192:193], v[192:193], 1.0 op_sel_hi:[1,0]
    v_pk_add_f32 v[194:195], v[194:195], 1.0 op_sel_hi:[1,0]
    v_pk_add_f32 v[196:197], v[196:197], 1.0 op_sel_hi:[1,0]
    v_pk_add_f32 v[198:199], v[198:199], 1.0 op_sel_hi:[1,0]
    v_pk_add_f32 v[200:201], v[200:201], 1.0 op_sel_hi:[1,0]
    v_pk_add_f32 v[202:203], v[202:203], 1.0 op_sel_hi:[1,0]
    s_setprio 0
    v_mfma_f32_16x16x32_bf16 v[220:223], v[176:179], v[88:91], 0
    ds_read_b64_tr_b16 v[184:185], v236
    ds_read_b64_tr_b16 v[186:187], v237
    v_rcp_f32 v188, v188
    v_mfma_f32_16x16x32_bf16 v[228:231], v[176:179], v[92:95], 0
    v_rcp_f32 v189, v189
    v_mfma_f32_16x16x32_bf16 v[224:227], v[180:183], v[88:91], 0
    v_rcp_f32 v190, v190
    v_mfma_f32_16x16x32_bf16 v[232:235], v[180:183], v[92:95], 0
    v_rcp_f32 v191, v191
    v_mfma_f32_16x16x32_bf16 v[220:223], v[160:163], v[16:19], v[220:223]
    v_rcp_f32 v192, v192
    v_mfma_f32_16x16x32_bf16 v[228:231], v[160:163], v[24:27], v[228:231]
    v_rcp_f32 v193, v193
    v_mfma_f32_16x16x32_bf16 v[224:227], v[168:171], v[16:19], v[224:227]
    v_rcp_f32 v194, v194
    v_mfma_f32_16x16x32_bf16 v[232:235], v[168:171], v[24:27], v[232:235]
    v_rcp_f32 v195, v195
    v_mfma_f32_16x16x32_bf16 v[220:223], v[164:167], v[20:23], v[220:223]
    v_rcp_f32 v196, v196
    v_mfma_f32_16x16x32_bf16 v[228:231], v[164:167], v[28:31], v[228:231]
    v_rcp_f32 v197, v197
    v_mfma_f32_16x16x32_bf16 v[224:227], v[172:175], v[20:23], v[224:227]
    v_rcp_f32 v198, v198
    s_setprio 3
    v_mfma_f32_16x16x32_bf16 v[232:235], v[172:175], v[28:31], v[232:235]
    v_rcp_f32 v199, v199
    v_rcp_f32 v200, v200
    v_rcp_f32 v201, v201
    v_rcp_f32 v202, v202
    v_rcp_f32 v203, v203
    v_pk_mul_f32 v[204:205], v[188:189], v[204:205]
    v_pk_mul_f32 v[206:207], v[190:191], v[206:207]
    v_pk_mul_f32 v[208:209], v[192:193], v[208:209]
    v_pk_mul_f32 v[210:211], v[194:195], v[210:211]
    v_pk_mul_f32 v[212:213], v[196:197], v[212:213]
    v_pk_mul_f32 v[214:215], v[198:199], v[214:215]
    v_pk_mul_f32 v[216:217], v[200:201], v[216:217]
    v_pk_mul_f32 v[218:219], v[202:203], v[218:219]
    s_setprio 0
    s_waitcnt lgkmcnt(0)
    v_smfmac_f32_16x16x64_bf16 v[144:147], v[184:187], v[204:211], v242
    v_exp_f32 v220, v220
    v_smfmac_f32_16x16x64_bf16 v[148:151], v[184:187], v[212:219], v242
    v_exp_f32 v221, v221
    v_mfma_f32_16x16x32_bf16 v[204:207], v[160:163], v[48:51], 0
    v_exp_f32 v222, v222
    v_mfma_f32_16x16x32_bf16 v[212:215], v[160:163], v[56:59], 0
    v_exp_f32 v223, v223
    v_mfma_f32_16x16x32_bf16 v[208:211], v[168:171], v[48:51], 0
    v_exp_f32 v224, v224
    v_mfma_f32_16x16x32_bf16 v[216:219], v[168:171], v[56:59], 0
    v_exp_f32 v225, v225
    v_mfma_f32_16x16x32_bf16 v[204:207], v[164:167], v[52:55], v[204:207]
    v_exp_f32 v226, v226
    v_mfma_f32_16x16x32_bf16 v[212:215], v[164:167], v[60:63], v[212:215]
    v_exp_f32 v227, v227
    v_mfma_f32_16x16x32_bf16 v[208:211], v[172:175], v[52:55], v[208:211]
    v_exp_f32 v228, v228
    v_mfma_f32_16x16x32_bf16 v[216:219], v[172:175], v[60:63], v[216:219]
    v_exp_f32 v229, v229
    v_smfmac_f32_16x16x64_bf16 v[128:131], v[184:187], v[188:195], v242
    v_exp_f32 v230, v230
    s_setprio 3
    v_smfmac_f32_16x16x64_bf16 v[132:135], v[184:187], v[196:203], v242
    v_exp_f32 v231, v231
    v_exp_f32 v232, v232
    v_exp_f32 v233, v233
    v_exp_f32 v234, v234
    v_exp_f32 v235, v235
    v_pk_add_f32 v[220:221], v[220:221], 1.0 op_sel_hi:[1,0]
    v_pk_add_f32 v[222:223], v[222:223], 1.0 op_sel_hi:[1,0]
    v_pk_add_f32 v[224:225], v[224:225], 1.0 op_sel_hi:[1,0]
    v_pk_add_f32 v[226:227], v[226:227], 1.0 op_sel_hi:[1,0]
    v_pk_add_f32 v[228:229], v[228:229], 1.0 op_sel_hi:[1,0]
    v_pk_add_f32 v[230:231], v[230:231], 1.0 op_sel_hi:[1,0]
    v_pk_add_f32 v[232:233], v[232:233], 1.0 op_sel_hi:[1,0]
    v_pk_add_f32 v[234:235], v[234:235], 1.0 op_sel_hi:[1,0]
    s_setprio 0
    v_rcp_f32 v220, v220
    v_rcp_f32 v221, v221
    v_rcp_f32 v222, v222
    v_rcp_f32 v223, v223
    v_rcp_f32 v224, v224
    v_rcp_f32 v225, v225
    v_rcp_f32 v226, v226
    v_rcp_f32 v227, v227
    v_rcp_f32 v228, v228
    v_rcp_f32 v229, v229
    v_rcp_f32 v230, v230
    v_rcp_f32 v231, v231
    v_rcp_f32 v232, v232
    v_rcp_f32 v233, v233
    v_rcp_f32 v234, v234
    v_rcp_f32 v235, v235
    v_pk_mul_f32 v[204:205], v[220:221], v[204:205]
    v_pk_mul_f32 v[206:207], v[222:223], v[206:207]
    v_pk_mul_f32 v[208:209], v[224:225], v[208:209]
    v_pk_mul_f32 v[210:211], v[226:227], v[210:211]
    v_pk_mul_f32 v[212:213], v[228:229], v[212:213]
    v_pk_mul_f32 v[214:215], v[230:231], v[214:215]
    v_pk_mul_f32 v[216:217], v[232:233], v[216:217]
    v_pk_mul_f32 v[218:219], v[234:235], v[218:219]
    v_smfmac_f32_16x16x64_bf16 v[136:139], v[184:187], v[220:227], v242
    v_smfmac_f32_16x16x64_bf16 v[140:143], v[184:187], v[228:235], v242
    v_smfmac_f32_16x16x64_bf16 v[152:155], v[184:187], v[204:211], v242
    v_smfmac_f32_16x16x64_bf16 v[156:159], v[184:187], v[212:219], v242
    s_branch L_DONE
L_LH1:
    s_setprio 0
    v_smfmac_f32_16x16x64_bf16 v[120:123], v[184:187], v[204:211], v242
    ds_read_u16 v236, v250 offset:1152
    ds_read_u16 v237, v250 offset:1168
    v_smfmac_f32_16x16x64_bf16 v[124:127], v[184:187], v[212:219], v242
    v_exp_f32 v188, v188
    v_mfma_f32_16x16x32_bf16 v[204:207], v[160:163], v[32:35], 0
    v_mfma_f32_16x16x32_bf16 v[212:215], v[160:163], v[40:43], 0
    v_exp_f32 v189, v189
    v_mfma_f32_16x16x32_bf16 v[204:207], v[164:167], v[36:39], v[204:207]
    v_mfma_f32_16x16x32_bf16 v[212:215], v[164:167], v[44:47], v[212:215]
    v_exp_f32 v190, v190
    v_smfmac_f32_16x16x64_bf16 v[104:107], v[184:187], v[220:227], v242
    s_waitcnt lgkmcnt(0)
    v_bfi_b32 v236, 31, v246, v236
    v_bfi_b32 v237, 31, v246, v237
    v_exp_f32 v191, v191
    s_setprio 3
    v_smfmac_f32_16x16x64_bf16 v[108:111], v[184:187], v[228:235], v242
    v_exp_f32 v196, v196
    v_exp_f32 v197, v197
    v_exp_f32 v198, v198
    v_exp_f32 v199, v199
    v_pk_add_f32 v[188:189], v[188:189], 1.0 op_sel_hi:[1,0]
    v_pk_add_f32 v[190:191], v[190:191], 1.0 op_sel_hi:[1,0]
    v_pk_add_f32 v[196:197], v[196:197], 1.0 op_sel_hi:[1,0]
    v_pk_add_f32 v[198:199], v[198:199], 1.0 op_sel_hi:[1,0]
    s_setprio 0
    v_mfma_f32_16x16x32_bf16 v[220:223], v[176:179], v[88:91], 0
    ds_read_b64_tr_b16 v[184:185], v236
    ds_read_b64_tr_b16 v[186:187], v237
    v_mfma_f32_16x16x32_bf16 v[228:231], v[176:179], v[92:95], 0
    v_rcp_f32 v188, v188
    v_mfma_f32_16x16x32_bf16 v[220:223], v[160:163], v[16:19], v[220:223]
    v_rcp_f32 v189, v189
    v_mfma_f32_16x16x32_bf16 v[228:231], v[160:163], v[24:27], v[228:231]
    v_rcp_f32 v190, v190
    v_mfma_f32_16x16x32_bf16 v[220:223], v[164:167], v[20:23], v[220:223]
    v_rcp_f32 v191, v191
    s_setprio 3
    v_mfma_f32_16x16x32_bf16 v[228:231], v[164:167], v[28:31], v[228:231]
    v_rcp_f32 v196, v196
    v_rcp_f32 v197, v197
    v_rcp_f32 v198, v198
    v_rcp_f32 v199, v199
    v_pk_mul_f32 v[204:205], v[188:189], v[204:205]
    v_pk_mul_f32 v[206:207], v[190:191], v[206:207]
    v_pk_mul_f32 v[212:213], v[196:197], v[212:213]
    v_pk_mul_f32 v[214:215], v[198:199], v[214:215]
    s_setprio 0
    s_waitcnt lgkmcnt(0)
    v_smfmac_f32_16x16x64_bf16 v[144:147], v[184:187], v[204:211], v242
    v_smfmac_f32_16x16x64_bf16 v[148:151], v[184:187], v[212:219], v242
    v_exp_f32 v220, v220
    v_mfma_f32_16x16x32_bf16 v[204:207], v[160:163], v[48:51], 0
    v_mfma_f32_16x16x32_bf16 v[212:215], v[160:163], v[56:59], 0
    v_exp_f32 v221, v221
    v_mfma_f32_16x16x32_bf16 v[204:207], v[164:167], v[52:55], v[204:207]
    v_mfma_f32_16x16x32_bf16 v[212:215], v[164:167], v[60:63], v[212:215]
    v_exp_f32 v222, v222
    v_smfmac_f32_16x16x64_bf16 v[128:131], v[184:187], v[188:195], v242
    v_exp_f32 v223, v223
    s_setprio 3
    v_smfmac_f32_16x16x64_bf16 v[132:135], v[184:187], v[196:203], v242
    v_exp_f32 v228, v228
    v_exp_f32 v229, v229
    v_exp_f32 v230, v230
    v_exp_f32 v231, v231
    v_pk_add_f32 v[220:221], v[220:221], 1.0 op_sel_hi:[1,0]
    v_pk_add_f32 v[222:223], v[222:223], 1.0 op_sel_hi:[1,0]
    v_pk_add_f32 v[228:229], v[228:229], 1.0 op_sel_hi:[1,0]
    v_pk_add_f32 v[230:231], v[230:231], 1.0 op_sel_hi:[1,0]
    s_setprio 0
    v_rcp_f32 v220, v220
    v_rcp_f32 v221, v221
    v_rcp_f32 v222, v222
    v_rcp_f32 v223, v223
    v_rcp_f32 v228, v228
    v_rcp_f32 v229, v229
    v_rcp_f32 v230, v230
    v_rcp_f32 v231, v231
    v_pk_mul_f32 v[204:205], v[220:221], v[204:205]
    v_pk_mul_f32 v[206:207], v[222:223], v[206:207]
    v_pk_mul_f32 v[212:213], v[228:229], v[212:213]
    v_pk_mul_f32 v[214:215], v[230:231], v[214:215]
    v_smfmac_f32_16x16x64_bf16 v[136:139], v[184:187], v[220:227], v242
    v_smfmac_f32_16x16x64_bf16 v[140:143], v[184:187], v[228:235], v242
    v_smfmac_f32_16x16x64_bf16 v[152:155], v[184:187], v[204:211], v242
    v_smfmac_f32_16x16x64_bf16 v[156:159], v[184:187], v[212:219], v242
L_DONE:
    v_mbcnt_lo_u32_b32 v253, -1, 0
    v_mbcnt_hi_u32_b32 v253, -1, v253
    s_cmp_lg_u32 s19, 0
    s_cbranch_scc1 L_SLOW
L_EPI:
    s_setprio 0
    v_and_b32 v64, 48, v253
    v_and_b32 v67, 15, v253
    v_add_u32 v69, s72, v64
    v_lshl_add_u32 v70, v67, 2, s72
    s_waitcnt lgkmcnt(0)
    ds_read_b128 v[80:83], v69 offset:0
    ds_read_b128 v[84:87], v69 offset:64
    ds_read2_b32 v[72:73], v70 offset0:0 offset1:16
    v_bfe_u32 v65, v253, 2, 3
    v_lshrrev_b32 v66, 5, v253
    v_lshl_add_u32 v65, v66, 4, v65
    v_mul_u32_u24 v65, 160, v65
    s_mov_b32 s10, 143488
    v_add3_u32 v65, v65, v246, s10
    ds_read_b64_tr_b16 v[0:1], v65 offset:0
    ds_read_b64_tr_b16 v[2:3], v65 offset:1280
    ds_read_b64_tr_b16 v[8:9], v65 offset:32
    ds_read_b64_tr_b16 v[10:11], v65 offset:1312
    ds_read_b64_tr_b16 v[16:17], v65 offset:64
    ds_read_b64_tr_b16 v[18:19], v65 offset:1344
    ds_read_b64_tr_b16 v[24:25], v65 offset:96
    ds_read_b64_tr_b16 v[26:27], v65 offset:1376
    s_movk_i32 s10, 832
    v_mad_u32_u24 v64, v246, s10, v64
    s_mov_b32 s10, 116736
    v_lshl_add_u32 v69, v67, 3, s10
    v_lshl_add_u32 v74, v67, 3, s73
    v_lshl_add_u32 v75, v67, 3, s74
    s_mov_b64 exec, s[76:77]
    s_and_b32 s11, s25, 19
    s_cmp_eq_u32 s11, 0
    s_cbranch_scc1 L_NS0
    s_cmp_eq_u32 s11, 1
    s_cbranch_scc1 L_NS1
    s_cmp_eq_u32 s11, 2
    s_cbranch_scc1 L_NS2
    s_cmp_eq_u32 s11, 3
    s_cbranch_scc1 L_NS3
L_NSR:
    s_mov_b64 exec, -1
    s_waitcnt lgkmcnt(8)
    v_add_u32 v76, v80, v69
    ds_read_b64 v[32:33], v76 offset:0
    v_add_u32 v76, v81, v69
    ds_read_b64 v[34:35], v76 offset:6656
    v_add_u32 v76, v82, v69
    ds_read_b64 v[36:37], v76 offset:13312
    v_add_u32 v76, v83, v69
    ds_read_b64 v[38:39], v76 offset:19968
    v_add_u32 v76, v84, v69
    ds_read_b64 v[40:41], v76 offset:0
    v_add_u32 v76, v85, v69
    ds_read_b64 v[42:43], v76 offset:6656
    v_add_u32 v76, v86, v69
    ds_read_b64 v[44:45], v76 offset:13312
    v_add_u32 v76, v87, v69
    ds_read_b64 v[46:47], v76 offset:19968
    v_add3_u32 v72, v72, v64, s10
    ds_read_b128 v[160:163], v72 offset:0
    ds_read_b128 v[164:167], v72 offset:64
    v_add3_u32 v73, v73, v64, s10
    ds_read_b128 v[168:171], v73 offset:0
    ds_read_b128 v[172:175], v73 offset:64
    ds_read_b64_tr_b16 v[4:5], v65 offset:5120
    ds_read_b64_tr_b16 v[6:7], v65 offset:6400
    ds_read_b64_tr_b16 v[12:13], v65 offset:5152
    ds_read_b64_tr_b16 v[14:15], v65 offset:6432
    ds_read_b64_tr_b16 v[20:21], v65 offset:5184
    ds_read_b64_tr_b16 v[22:23], v65 offset:6464
    ds_read_b64_tr_b16 v[28:29], v65 offset:5216
    ds_read_b64_tr_b16 v[30:31], v65 offset:6496
    v_rcp_f32 v128, v128
    v_rcp_f32 v129, v129
    v_rcp_f32 v130, v130
    v_rcp_f32 v131, v131
    v_rcp_f32 v132, v132
    v_rcp_f32 v133, v133
    v_rcp_f32 v134, v134
    v_rcp_f32 v135, v135
    v_rcp_f32 v136, v136
    v_rcp_f32 v137, v137
    v_rcp_f32 v138, v138
    v_rcp_f32 v139, v139
    v_rcp_f32 v140, v140
    v_rcp_f32 v141, v141
    v_rcp_f32 v142, v142
    v_rcp_f32 v143, v143
    v_rcp_f32 v96, v96
    v_rcp_f32 v97, v97
    v_rcp_f32 v98, v98
    v_rcp_f32 v99, v99
    v_rcp_f32 v100, v100
    v_rcp_f32 v101, v101
    v_rcp_f32 v102, v102
    v_rcp_f32 v103, v103
    v_rcp_f32 v104, v104
    v_rcp_f32 v105, v105
    v_rcp_f32 v106, v106
    v_rcp_f32 v107, v107
    v_rcp_f32 v108, v108
    v_rcp_f32 v109, v109
    v_rcp_f32 v110, v110
    v_rcp_f32 v111, v111
    s_waitcnt lgkmcnt(12)
    v_lshlrev_b32 v188, 16, v32
    v_and_b32 v192, 0xffff0000, v32
    v_lshlrev_b32 v196, 16, v33
    v_and_b32 v200, 0xffff0000, v33
    v_lshlrev_b32 v189, 16, v34
    v_and_b32 v193, 0xffff0000, v34
    v_lshlrev_b32 v197, 16, v35
    v_and_b32 v201, 0xffff0000, v35
    v_lshlrev_b32 v190, 16, v36
    v_and_b32 v194, 0xffff0000, v36
    v_lshlrev_b32 v198, 16, v37
    v_and_b32 v202, 0xffff0000, v37
    v_lshlrev_b32 v191, 16, v38
    v_and_b32 v195, 0xffff0000, v38
    v_lshlrev_b32 v199, 16, v39
    v_and_b32 v203, 0xffff0000, v39
    v_lshlrev_b32 v204, 16, v40
    v_and_b32 v208, 0xffff0000, v40
    v_lshlrev_b32 v212, 16, v41
    v_and_b32 v216, 0xffff0000, v41
    v_lshlrev_b32 v205, 16, v42
    v_and_b32 v209, 0xffff0000, v42
    v_lshlrev_b32 v213, 16, v43
    v_and_b32 v217, 0xffff0000, v43
    v_lshlrev_b32 v206, 16, v44
    v_and_b32 v210, 0xffff0000, v44
    v_lshlrev_b32 v214, 16, v45
    v_and_b32 v218, 0xffff0000, v45
    v_lshlrev_b32 v207, 16, v46
    v_and_b32 v211, 0xffff0000, v46
    v_lshlrev_b32 v215, 16, v47
    v_and_b32 v219, 0xffff0000, v47
    v_pk_fma_f32 v[112:113], v[112:113], v[96:97], v[188:189]
    v_pk_fma_f32 v[114:115], v[114:115], v[98:99], v[190:191]
    v_pk_fma_f32 v[116:117], v[116:117], v[100:101], v[192:193]
    v_pk_fma_f32 v[118:119], v[118:119], v[102:103], v[194:195]
    v_pk_fma_f32 v[120:121], v[120:121], v[104:105], v[196:197]
    v_pk_fma_f32 v[122:123], v[122:123], v[106:107], v[198:199]
    v_pk_fma_f32 v[124:125], v[124:125], v[108:109], v[200:201]
    v_pk_fma_f32 v[126:127], v[126:127], v[110:111], v[202:203]
    v_pk_fma_f32 v[144:145], v[144:145], v[128:129], v[204:205]
    v_pk_fma_f32 v[146:147], v[146:147], v[130:131], v[206:207]
    v_pk_fma_f32 v[148:149], v[148:149], v[132:133], v[208:209]
    v_pk_fma_f32 v[150:151], v[150:151], v[134:135], v[210:211]
    v_pk_fma_f32 v[152:153], v[152:153], v[136:137], v[212:213]
    v_pk_fma_f32 v[154:155], v[154:155], v[138:139], v[214:215]
    v_pk_fma_f32 v[156:157], v[156:157], v[140:141], v[216:217]
    v_pk_fma_f32 v[158:159], v[158:159], v[142:143], v[218:219]
    s_waitcnt lgkmcnt(0)
    v_mfma_f32_16x16x32_bf16 v[112:115], v[160:163], v[0:3], v[112:115]
    v_lshl_add_u32 v80, v80, 2, v74
    v_mfma_f32_16x16x32_bf16 v[116:119], v[160:163], v[8:11], v[116:119]
    v_lshl_add_u32 v81, v81, 2, v74
    v_mfma_f32_16x16x32_bf16 v[120:123], v[160:163], v[16:19], v[120:123]
    v_lshl_add_u32 v82, v82, 2, v74
    v_mfma_f32_16x16x32_bf16 v[124:127], v[160:163], v[24:27], v[124:127]
    v_lshl_add_u32 v83, v83, 2, v74
    v_mfma_f32_16x16x32_bf16 v[112:115], v[164:167], v[4:7], v[112:115]
    v_lshl_add_u32 v84, v84, 2, v75
    v_mfma_f32_16x16x32_bf16 v[116:119], v[164:167], v[12:15], v[116:119]
    v_lshl_add_u32 v85, v85, 2, v75
    v_mfma_f32_16x16x32_bf16 v[120:123], v[164:167], v[20:23], v[120:123]
    v_lshl_add_u32 v86, v86, 2, v75
    v_mfma_f32_16x16x32_bf16 v[124:127], v[164:167], v[28:31], v[124:127]
    v_lshl_add_u32 v87, v87, 2, v75
    v_mfma_f32_16x16x32_bf16 v[144:147], v[168:171], v[0:3], v[144:147]
    v_mfma_f32_16x16x32_bf16 v[148:151], v[168:171], v[8:11], v[148:151]
    v_mfma_f32_16x16x32_bf16 v[152:155], v[168:171], v[16:19], v[152:155]
    v_mfma_f32_16x16x32_bf16 v[156:159], v[168:171], v[24:27], v[156:159]
    v_mfma_f32_16x16x32_bf16 v[144:147], v[172:175], v[4:7], v[144:147]
    v_mfma_f32_16x16x32_bf16 v[148:151], v[172:175], v[12:15], v[148:151]
    v_mfma_f32_16x16x32_bf16 v[152:155], v[172:175], v[20:23], v[152:155]
    v_mfma_f32_16x16x32_bf16 v[156:159], v[172:175], v[28:31], v[156:159]
    v_cvt_pk_bf16_f32 v96, v112, v116
    v_cvt_pk_bf16_f32 v97, v120, v124
    v_pk_max_f16 v96, v96, v32
    v_pk_max_f16 v97, v97, v33
    buffer_store_dwordx2 v[96:97], v80, s[48:51], 0 offen sc1
    v_cvt_pk_bf16_f32 v98, v113, v117
    v_cvt_pk_bf16_f32 v99, v121, v125
    v_pk_max_f16 v98, v98, v34
    v_pk_max_f16 v99, v99, v35
    buffer_store_dwordx2 v[98:99], v81, s[48:51], 0 offen sc1
    v_cvt_pk_bf16_f32 v100, v114, v118
    v_cvt_pk_bf16_f32 v101, v122, v126
    v_pk_max_f16 v100, v100, v36
    v_pk_max_f16 v101, v101, v37
    buffer_store_dwordx2 v[100:101], v82, s[48:51], 0 offen sc1
    v_cvt_pk_bf16_f32 v102, v115, v119
    v_cvt_pk_bf16_f32 v103, v123, v127
    v_pk_max_f16 v102, v102, v38
    v_pk_max_f16 v103, v103, v39
    buffer_store_dwordx2 v[102:103], v83, s[48:51], 0 offen sc1
    v_cvt_pk_bf16_f32 v128, v144, v148
    v_cvt_pk_bf16_f32 v129, v152, v156
    v_pk_max_f16 v128, v128, v40
    v_pk_max_f16 v129, v129, v41
    buffer_store_dwordx2 v[128:129], v84, s[60:63], 0 offen sc1
    v_cvt_pk_bf16_f32 v130, v145, v149
    v_cvt_pk_bf16_f32 v131, v153, v157
    v_pk_max_f16 v130, v130, v42
    v_pk_max_f16 v131, v131, v43
    buffer_store_dwordx2 v[130:131], v85, s[60:63], 0 offen sc1
    v_cvt_pk_bf16_f32 v132, v146, v150
    v_cvt_pk_bf16_f32 v133, v154, v158
    v_pk_max_f16 v132, v132, v44
    v_pk_max_f16 v133, v133, v45
    buffer_store_dwordx2 v[132:133], v86, s[60:63], 0 offen sc1
    v_cvt_pk_bf16_f32 v134, v147, v151
    v_cvt_pk_bf16_f32 v135, v155, v159
    v_pk_max_f16 v134, v134, v46
    v_pk_max_f16 v135, v135, v47
    buffer_store_dwordx2 v[134:135], v87, s[60:63], 0 offen sc1
L_END:
    s_endpgm
L_NS0:
    v_add_f32 v96, v96, v128
    v_add_f32 v100, v100, v132
    v_add_f32 v104, v104, v136
    v_add_f32 v108, v108, v140
    v_add_f32 v112, v112, v144
    v_add_f32 v116, v116, v148
    v_add_f32 v120, v120, v152
    v_add_f32 v124, v124, v156
    s_branch L_NSR
L_NS1:
    v_add_f32 v97, v97, v129
    v_add_f32 v101, v101, v133
    v_add_f32 v105, v105, v137
    v_add_f32 v109, v109, v141
    v_add_f32 v113, v113, v145
    v_add_f32 v117, v117, v149
    v_add_f32 v121, v121, v153
    v_add_f32 v125, v125, v157
    s_branch L_NSR
L_NS2:
    v_add_f32 v98, v98, v130
    v_add_f32 v102, v102, v134
    v_add_f32 v106, v106, v138
    v_add_f32 v110, v110, v142
    v_add_f32 v114, v114, v146
    v_add_f32 v118, v118, v150
    v_add_f32 v122, v122, v154
    v_add_f32 v126, v126, v158
    s_branch L_NSR
L_NS3:
    v_add_f32 v99, v99, v131
    v_add_f32 v103, v103, v135
    v_add_f32 v107, v107, v139
    v_add_f32 v111, v111, v143
    v_add_f32 v115, v115, v147
    v_add_f32 v119, v119, v151
    v_add_f32 v123, v123, v155
    v_add_f32 v127, v127, v159
    s_branch L_NSR
L_RT0:
    s_waitcnt vmcnt(0)
    s_add_u32 s100, s100, 1
    s_cmp_gt_u32 s100, 200000
    s_cbranch_scc1 L_END
    s_sleep 1
    buffer_load_dwordx4 v[128:131], v232, s[56:59], 0 offen sc1
    buffer_load_dwordx4 v[132:135], v232, s[56:59], s26 offen sc1
    buffer_load_dwordx4 v[136:139], v232, s[56:59], s27 offen sc1
    buffer_load_dwordx4 v[140:143], v232, s[56:59], s28 offen sc1
    s_waitcnt vmcnt(0)
    s_branch L_PW0
L_RT1:
    s_waitcnt vmcnt(0)
    s_add_u32 s100, s100, 1
    s_cmp_gt_u32 s100, 200000
    s_cbranch_scc1 L_END
    s_sleep 1
    buffer_load_dwordx4 v[132:135], v232, s[56:59], s26 offen sc1
    buffer_load_dwordx4 v[136:139], v232, s[56:59], s27 offen sc1
    buffer_load_dwordx4 v[140:143], v232, s[56:59], s28 offen sc1
    s_waitcnt vmcnt(0)
    s_branch L_PW1
L_RT2:
    s_waitcnt vmcnt(0)
    s_add_u32 s100, s100, 1
    s_cmp_gt_u32 s100, 200000
    s_cbranch_scc1 L_END
    s_sleep 1
    buffer_load_dwordx4 v[136:139], v232, s[56:59], s27 offen sc1
    buffer_load_dwordx4 v[140:143], v232, s[56:59], s28 offen sc1
    s_waitcnt vmcnt(0)
    s_branch L_PW2
L_RT3:
    s_waitcnt vmcnt(0)
    s_add_u32 s100, s100, 1
    s_cmp_gt_u32 s100, 200000
    s_cbranch_scc1 L_END
    s_sleep 1
    buffer_load_dwordx4 v[140:143], v232, s[56:59], s28 offen sc1
    s_waitcnt vmcnt(0)
    s_branch L_PW3
L_XT2B:
    s_add_u32 s100, s100, 1
    s_cmp_gt_u32 s100, 200000
    s_cbranch_scc1 L_END
    s_sleep 1
    s_mov_b64 exec, s[70:71]
    s_cbranch_execz L_XLb0
    s_movk_i32 s10, 0
    buffer_load_dwordx4 v[64:67], v232, s[60:63], s10 offen sc1
L_XLb0:
    s_mov_b64 exec, s[78:79]
    s_cbranch_execz L_XLb1
    s_movk_i32 s10, 8192
    buffer_load_dwordx4 v[68:71], v232, s[60:63], s10 offen sc1
L_XLb1:
    s_mov_b64 exec, s[86:87]
    s_cbranch_execz L_XLb2
    s_movk_i32 s10, 16384
    buffer_load_dwordx4 v[72:75], v232, s[60:63], s10 offen sc1
L_XLb2:
    s_mov_b64 exec, s[94:95]
    s_cbranch_execz L_XLb3
    s_movk_i32 s10, 24576
    buffer_load_dwordx4 v[76:79], v232, s[60:63], s10 offen sc1
L_XLb3:
    s_mov_b64 exec, -1
    s_waitcnt vmcnt(0)
    s_branch L_XT2
L_OVF:
    s_mov_b32 s20, 0
    s_mov_b32 s17, 0
    s_mov_b32 s30, 0
    s_mov_b32 s19, 4
    s_waitcnt lgkmcnt(0)
    s_branch L_CA
L_POVF:
    s_movk_i32 s11, 1986
    v_mul_u32_u24 v64, s11, v192
    v_lshrrev_b32 v64, 16, v64
    v_mul_u32_u24 v65, s11, v193
    v_lshrrev_b32 v65, 16, v65
    v_mul_u32_u24 v66, s11, v194
    v_lshrrev_b32 v66, 16, v66
    v_mul_u32_u24 v67, s11, v195
    v_lshrrev_b32 v67, 16, v67
    v_add_u32 v69, v64, v65
    v_add_u32 v70, v69, v66
    v_add_u32 v71, v70, v67
    v_mov_b32 v72, v71
    s_nop 1
    v_add_u32_dpp v72, v72, v72 row_shr:1 row_mask:0xf bank_mask:0xf bound_ctrl:0
    s_nop 1
    v_add_u32_dpp v72, v72, v72 row_shr:2 row_mask:0xf bank_mask:0xf bound_ctrl:0
    s_nop 1
    v_add_u32_dpp v72, v72, v72 row_shr:4 row_mask:0xf bank_mask:0xf bound_ctrl:0
    s_nop 1
    v_add_u32_dpp v72, v72, v72 row_shr:8 row_mask:0xf bank_mask:0xf bound_ctrl:0
    s_nop 1
    v_add_u32_dpp v72, v72, v72 row_bcast:15 row_mask:0xa bank_mask:0xf
    s_nop 1
    v_add_u32_dpp v72, v72, v72 row_bcast:31 row_mask:0xc bank_mask:0xf
    s_nop 0
    v_sub_u32 v68, v72, v71
    v_add_u32 v71, v68, v70
    v_add_u32 v70, v68, v69
    v_add_u32 v69, v68, v64
    v_lshl_or_b32 v68, v64, 16, v68
    v_lshl_or_b32 v69, v65, 16, v69
    v_lshl_or_b32 v70, v66, 16, v70
    v_lshl_or_b32 v71, v67, 16, v71
    v_add_u32 v72, 154752, v185
    ds_write_b128 v72, v[68:71]
    s_lshl_b32 s10, s2, 10
    s_add_u32 s10, s10, 24772608
    buffer_store_dwordx4 v[68:71], v185, s[52:55], s10 offen sc1
    v_and_b32 v74, 0x3fc, v136
    v_add_u32 v74, 154752, v74
    ds_read_u16 v74, v74
    v_and_b32 v75, 0x3fc, v137
    v_add_u32 v75, 154752, v75
    ds_read_u16 v75, v75
    v_and_b32 v76, 0x3fc, v138
    v_add_u32 v76, 154752, v76
    ds_read_u16 v76, v76
    v_and_b32 v77, 0x3fc, v139
    v_add_u32 v77, 154752, v77
    ds_read_u16 v77, v77
    v_and_b32 v78, 0x3fc, v140
    v_add_u32 v78, 154752, v78
    ds_read_u16 v78, v78
    v_and_b32 v79, 0x3fc, v141
    v_add_u32 v79, 154752, v79
    ds_read_u16 v79, v79
    v_and_b32 v80, 0x3fc, v142
    v_add_u32 v80, 154752, v80
    ds_read_u16 v80, v80
    v_and_b32 v81, 0x3fc, v143
    v_add_u32 v81, 154752, v81
    ds_read_u16 v81, v81
    s_waitcnt lgkmcnt(0)
    v_cmpx_lt_u32 vcc, 1056, v228
    v_or_b32 v205, 0x10000, v205
    s_mov_b64 exec, -1
    v_cmpx_lt_u32 vcc, 1056, v229
    v_or_b32 v209, 0x10000, v209
    s_mov_b64 exec, -1
    v_cmpx_lt_u32 vcc, 1056, v230
    v_or_b32 v213, 0x10000, v213
    s_mov_b64 exec, -1
    v_cmpx_lt_u32 vcc, 1056, v231
    v_or_b32 v217, 0x10000, v217
    s_mov_b64 exec, -1
    s_mul_i32 s10, s2, 4152
    s_mov_b32 s34, 18874368
    s_mov_b32 s35, 23592960
    v_mul_u32_u24 v64, s11, v112
    v_lshrrev_b32 v64, 16, v64
    v_add3_u32 v64, v64, v74, s10
    v_lshlrev_b32 v65, 2, v64
    v_cmpx_le_u32 vcc, 1056, v112
    s_cbranch_execz L_PO0
    buffer_store_byte v120, v64, s[52:55], s35 offen sc1
    buffer_store_dword v96, v65, s[52:55], s34 offen sc1
L_PO0:
    s_mov_b64 exec, -1
    v_mul_u32_u24 v64, s11, v113
    v_lshrrev_b32 v64, 16, v64
    v_add3_u32 v64, v64, v75, s10
    v_lshlrev_b32 v65, 2, v64
    v_cmpx_le_u32 vcc, 1056, v113
    s_cbranch_execz L_PO1
    buffer_store_byte v121, v64, s[52:55], s35 offen sc1
    buffer_store_dword v97, v65, s[52:55], s34 offen sc1
L_PO1:
    s_mov_b64 exec, -1
    v_mul_u32_u24 v64, s11, v114
    v_lshrrev_b32 v64, 16, v64
    v_add3_u32 v64, v64, v76, s10
    v_lshlrev_b32 v65, 2, v64
    v_cmpx_le_u32 vcc, 1056, v114
    s_cbranch_execz L_PO2
    buffer_store_byte v122, v64, s[52:55], s35 offen sc1
    buffer_store_dword v98, v65, s[52:55], s34 offen sc1
L_PO2:
    s_mov_b64 exec, -1
    v_mul_u32_u24 v64, s11, v115
    v_lshrrev_b32 v64, 16, v64
    v_add3_u32 v64, v64, v77, s10
    v_lshlrev_b32 v65, 2, v64
    v_cmpx_le_u32 vcc, 1056, v115
    s_cbranch_execz L_PO3
    buffer_store_byte v123, v64, s[52:55], s35 offen sc1
    buffer_store_dword v99, v65, s[52:55], s34 offen sc1
L_PO3:
    s_mov_b64 exec, -1
    v_mul_u32_u24 v64, s11, v116
    v_lshrrev_b32 v64, 16, v64
    v_add3_u32 v64, v64, v78, s10
    v_lshlrev_b32 v65, 2, v64
    v_cmpx_le_u32 vcc, 1056, v116
    s_cbranch_execz L_PO4
    buffer_store_byte v120, v64, s[52:55], s35 offen sc1
    buffer_store_dword v100, v65, s[52:55], s34 offen sc1
L_PO4:
    s_mov_b64 exec, -1
    v_mul_u32_u24 v64, s11, v117
    v_lshrrev_b32 v64, 16, v64
    v_add3_u32 v64, v64, v79, s10
    v_lshlrev_b32 v65, 2, v64
    v_cmpx_le_u32 vcc, 1056, v117
    s_cbranch_execz L_PO5
    buffer_store_byte v121, v64, s[52:55], s35 offen sc1
    buffer_store_dword v101, v65, s[52:55], s34 offen sc1
L_PO5:
    s_mov_b64 exec, -1
    v_mul_u32_u24 v64, s11, v118
    v_lshrrev_b32 v64, 16, v64
    v_add3_u32 v64, v64, v80, s10
    v_lshlrev_b32 v65, 2, v64
    v_cmpx_le_u32 vcc, 1056, v118
    s_cbranch_execz L_PO6
    buffer_store_byte v122, v64, s[52:55], s35 offen sc1
    buffer_store_dword v102, v65, s[52:55], s34 offen sc1
L_PO6:
    s_mov_b64 exec, -1
    v_mul_u32_u24 v64, s11, v119
    v_lshrrev_b32 v64, 16, v64
    v_add3_u32 v64, v64, v81, s10
    v_lshlrev_b32 v65, 2, v64
    v_cmpx_le_u32 vcc, 1056, v119
    s_cbranch_execz L_PO7
    buffer_store_byte v123, v64, s[52:55], s35 offen sc1
    buffer_store_dword v103, v65, s[52:55], s34 offen sc1
L_PO7:
    s_mov_b64 exec, -1
    s_waitcnt vmcnt(0) lgkmcnt(0)
    s_barrier
    s_branch L_POUT
L_SLOW:
    s_setprio 0
    s_lshl_b32 s10, s3, 6
    v_add_u32 v255, s10, v253
    s_cmp_lg_u32 s19, 4
    s_cbranch_scc1 L_SL1
    s_mov_b32 s19, 1
    v_and_b32 v188, 0xff, v255
    v_lshlrev_b32 v189, 7, v188
    buffer_load_dword v190, v189, s[56:59], 0 offen offset:4 sc1
    v_lshlrev_b32 v189, 10, v188
    s_lshl_b32 s10, s5, 2
    s_add_u32 s10, s10, 24772608
    buffer_load_dword v191, v189, s[52:55], s10 offen sc1
    v_lshlrev_b32 v188, 2, v188
    v_add_u32 v188, 154752, v188
    s_waitcnt vmcnt(0)
    v_and_b32 v190, 0x10000, v190
    v_cmp_ne_u32 vcc, 0, v190
    v_mov_b32 v190, 2097152
    s_nop 0
    v_cndmask_b32 v190, v190, v191, vcc
    ds_write_b32 v188, v190
    s_waitcnt lgkmcnt(0)
    s_barrier
L_SL1:
    s_add_u32 s28, s28, 288
    s_cmp_lt_u32 s28, s29
    s_cbranch_scc1 L_BATCH
L_FIND:
    s_cmp_lg_u64 s[32:33], 0
    s_cbranch_scc1 L_GOT
    s_add_u32 s26, s26, 1
    s_cmp_ge_u32 s26, 4
    s_cbranch_scc1 L_EPI
    s_lshl_b32 s10, s26, 8
    s_add_u32 s10, s10, 154752
    v_lshl_add_u32 v188, v253, 2, s10
    ds_read_u16 v188, v188 offset:2
    s_waitcnt lgkmcnt(0)
    v_cmp_lt_u32 s[32:33], s20, v188
    s_nop 3
    s_branch L_FIND
L_GOT:
    s_ff1_i32_b64 s10, s[32:33]
    s_bitset0_b64 s[32:33], s10
    s_lshl_b32 s11, s26, 6
    s_add_u32 s27, s10, s11
    s_lshl_b32 s10, s27, 2
    s_add_u32 s10, s10, 154752
    v_mov_b32 v188, s10
    ds_read_b32 v188, v188
    s_waitcnt lgkmcnt(0)
    v_readfirstlane_b32 s10, v188
    s_nop 3
    s_lshr_b32 s29, s10, 16
    s_and_b32 s30, s10, 0xffff
    s_mov_b32 s28, s20
L_BATCH:
    s_waitcnt vmcnt(0)
    s_barrier
    v_mov_b64 v[192:193], 0
    v_mov_b64 v[194:195], 0
    v_mov_b32 v196, 0x20fffff
    v_mov_b32 v197, 0x20fffff
    v_mov_b32 v198, 0x20fffff
    v_mov_b32 v199, 0x20fffff
    v_lshl_add_u32 v200, v253, 4, s12
    ds_write_b128 v200, v[192:195] offset:0
    ds_write_b128 v200, v[196:199] offset:18432
    ds_write_b128 v200, v[192:195] offset:1024
    ds_write_b128 v200, v[196:199] offset:19456
    ds_write_b128 v200, v[192:195] offset:1280
    ds_write_b128 v200, v[196:199] offset:19712
    v_and_b32 v188, 15, v253
    v_mul_u32_u24 v189, 1152, v188
    v_add_u32 v189, 8192, v189
    v_lshlrev_b32 v188, 2, v188
    ds_write_b32 v188, v189 offset:576
    v_add_u32 v188, s28, v255
    s_mul_i32 s36, s27, 3128
    s_mul_i32 s11, s27, 4152
    s_add_u32 s11, s11, s30
    s_lshl_b32 s34, s11, 2
    s_add_u32 s34, s34, 18874368
    v_lshl_add_u32 v190, v188, 2, s34
    s_add_u32 s34, s11, 23592960
    v_add_u32 v191, s34, v188
    s_mul_i32 s10, s5, 32896
    s_lshl_b32 s34, s27, 7
    s_add_u32 s10, s10, s34
    s_add_u32 s10, s10, 65536
    v_and_b32 v206, 7, v188
    v_lshl_add_u32 v206, v206, 4, s10
    v_lshrrev_b32 v207, 3, v188
    v_cmpx_gt_u32 vcc, 32, v188
    v_add_u32 v190, 8421376, v206
    v_add_u32 v191, 8, v190
    v_cmpx_gt_u32 vcc, 24, v188
    v_lshl_add_u32 v190, v207, 2, v206
    v_add3_u32 v191, v206, v207, 12
    s_mov_b64 exec, -1
    s_add_u32 s10, s28, 288
    s_min_u32 s10, s10, s29
    v_cmp_gt_u32 vcc, s10, v188
    v_mov_b32 v206, 0x7ffffff0
    s_nop 0
    v_cndmask_b32 v190, v206, v190, vcc
    v_cndmask_b32 v191, v206, v191, vcc
    buffer_load_dwordx2 v[204:205], v190, s[52:55], 0 offen sc1
    buffer_load_ubyte v191, v191, s[52:55], 0 offen sc1
    s_waitcnt lgkmcnt(0)
    s_barrier
    s_waitcnt vmcnt(0)
    v_cmp_ne_u32 vcc, 3, v207
    v_cmp_eq_u32 s[10:11], s6, v205
    v_mov_b32 v206, s36
    s_or_b64 exec, vcc, s[10:11]
    v_cmpx_ne_u32 vcc, 0, v204
    v_bfe_u32 v190, v204, 18, 8
    v_lshlrev_b32 v190, 2, v190
    v_add_u32 v188, 153728, v190
    ds_read_b32 v188, v188
    v_add_u32_sdwa v191, v191, v206 dst_sel:DWORD dst_unused:UNUSED_PAD src0_sel:BYTE_0 src1_sel:DWORD
    v_lshrrev_b32 v189, 28, v204
    v_lshl_add_u32 v191, v189, 8, v191
    v_and_b32 v189, 60, v190
    v_lshl_add_u32 v191, v189, 19, v191
    v_mov_b32 v190, 4
    v_and_b32 v204, 0xffff, v204
    s_waitcnt lgkmcnt(0)
    ds_add_rtn_u32 v188, v188, v190 offset:576
    s_waitcnt lgkmcnt(0)
    ds_write2st64_b32 v188, v204, v191 offset0:148 offset1:220
    s_mov_b64 exec, -1
    s_waitcnt lgkmcnt(0)
    s_barrier
    v_lshrrev_b32 v190, 3, v253
    v_lshl_add_u32 v247, v190, 4, s12
    s_add_u32 s10, s12, 18432
    v_lshrrev_b32 v190, 1, v253
    v_lshl_add_u32 v248, v190, 2, s10
    s_add_u32 s10, s10, 2
    v_and_b32 v190, 48, v253
    v_lshl_add_u32 v250, v190, 1, s10
    v_and_b32 v190, 12, v253
    v_add_u32 v250, v250, v190
    v_lshrrev_b32 v190, 5, v253
    v_mul_u32_u24 v249, 18432, v190
    v_and_b32 v190, 15, v253
    v_lshl_add_u32 v249, v190, 2, v249
    s_add_u32 s10, s12, 2
    v_add_u32 v249, s10, v249
    ds_read_b128 v[236:239], v247
    ds_read_b32 v240, v248
    s_lshl_b32 s10, s4, 3
    v_mov_b32 v190, s10
    ds_read_b64 v[190:191], v190 offset:576
    s_waitcnt lgkmcnt(0)
    v_readfirstlane_b32 s34, v190
    v_readfirstlane_b32 s35, v191
    s_sub_u32 s10, s12, 37888
    s_sub_u32 s34, s34, s10
    s_sub_u32 s35, s35, s10
    s_sub_u32 s35, s35, 1152
    s_add_u32 s10, s34, 127
    s_lshr_b32 s10, s10, 7
    s_lshl1_add_u32 s10, s10, -1
    s_add_u32 s11, s35, 127
    s_lshr_b32 s11, s11, 6
    s_and_b32 s11, s11, -2
    s_max_i32 s17, s10, s11
    s_cselect_b32 s10, s34, s35
    s_sub_u32 s10, s10, 1
    s_andn2_b32 s99, 64, s10
    s_add_u32 m0, s13, 0
    v_mad_u32_u16 v236, v236, s15, v243
    buffer_load_dwordx4 v236, s[40:43], 0 offen lds
    s_add_u32 m0, s13, 1056
    v_mad_u32_u16 v237, v237, s15, v243
    buffer_load_dwordx4 v237, s[40:43], 0 offen lds
    s_add_u32 m0, s13, 2112
    v_mad_u32_u16 v238, v238, s15, v243
    buffer_load_dwordx4 v238, s[40:43], 0 offen lds
    s_add_u32 m0, s13, 3168
    v_mad_u32_u16 v239, v239, s15, v243
    buffer_load_dwordx4 v239, s[40:43], 0 offen lds
    s_mov_b32 m0, s14
    v_and_b32 v240, 0xfffff, v240
    buffer_load_dwordx4 v[240:241], s[44:47], 0 idxen offen lds
L_LAST:
    s_branch L_GO
.section .rodata,"a"
.p2align 6
.amdhsa_kernel standalone__edge_featured_mpnn_gatedgcn__graph_kernel
  .amdhsa_next_free_vgpr 256
  .amdhsa_next_free_sgpr 102
  .amdhsa_accum_offset 256
  .amdhsa_group_segment_fixed_size 0
  .amdhsa_kernarg_size 96
  .amdhsa_user_sgpr_count 2
  .amdhsa_user_sgpr_kernarg_segment_ptr 1
  .amdhsa_system_sgpr_workgroup_id_x 1
.end_amdhsa_kernel
```

```asm
; @launch grid=(256,1,1) block=(512,1,1) lds=157824
.amdgcn_target "amdgcn-amd-amdhsa--gfx950"
.text
.globl standalone__edge_featured_mpnn_gatedgcn__graph_kernel
.p2align 8
.type standalone__edge_featured_mpnn_gatedgcn__graph_kernel,@function
standalone__edge_featured_mpnn_gatedgcn__graph_kernel:
    s_load_dwordx16 s[16:31], s[0:1], 0
    s_load_dwordx8 s[32:39], s[0:1], 64
    s_getpc_b64 s[64:65]
L_PC:
    s_and_b32 s3, s2, -8
    v_add_lshl_u32 v1, v0, s3, 7
    v_min_u32 v1, L_LAST-L_PC, v1
    v_cmpx_gt_u32 vcc, 8, v0
    s_cbranch_execz L_NOCPF
    global_load_dword v251, v1, s[64:65]
L_NOCPF:
    s_mov_b64 exec, -1
    s_cmp_ge_u32 s2, 256
    s_cbranch_scc1 L_END
    s_mul_i32 s10, s2, 12512
    v_lshl_add_u32 v1, v0, 4, s10
    s_add_u32 s11, s10, 12512
    s_min_u32 s11, s11, 3200000
    v_add_u32 v2, 0x2000, v1
    s_waitcnt lgkmcnt(0)
    global_load_dwordx4 v[128:131], v1, s[22:23] nt
    global_load_dwordx4 v[96:99], v1, s[20:21] nt
    v_cmpx_gt_u32 s[70:71], s11, v2
    s_cbranch_execz L_NO8
    global_load_dwordx4 v[132:135], v2, s[22:23] nt
    global_load_dwordx4 v[100:103], v2, s[20:21] nt
L_NO8:
    s_mov_b64 exec, -1
L_NO7:
    s_mov_b64 exec, -1
    s_load_dword s6, s[38:39], 0
    v_mov_b32 v255, v0
    v_lshrrev_b32 v188, 6, v0
    v_and_b32 v253, 63, v0
    v_readfirstlane_b32 s3, v188
    v_lshlrev_b32 v232, 4, v0
    v_lshlrev_b32 v190, 3, v0
    v_lshlrev_b32 v191, 2, v0
    v_and_b32 v192, 0x3fc, v191
    s_and_b32 s5, s2, 7
    s_lshr_b32 s4, s2, 3
    s_lshl_b32 s5, s5, 5
    s_add_u32 s5, s5, s4
    s_mul_i32 s9, s5, 196
    s_cmp_eq_u32 s3, 7
    s_cselect_b32 s101, 0, s3
    s_lshl_b32 s12, s101, 5
    s_add_u32 s9, s9, s12
    v_lshrrev_b32 v193, 3, v253
    v_lshl_add_u32 v193, v193, 2, s9
    v_and_b32 v243, 7, v253
    v_lshlrev_b32 v243, 4, v243
    v_lshl_add_u32 v234, v193, 7, v243
    s_lshl_b32 s101, s101, 10
    s_add_u32 s101, s101, 116736
    v_mov_b64 v[196:197], 0
    v_mov_b64 v[198:199], 0
    v_mov_b32 v194, 132
    ds_write2st64_b32 v192, v194, v196 offset0:20 offset1:24
    v_add_u32 v193, 46080, v232
    ds_write_b128 v193, v[196:199] offset:0
    ds_write_b128 v193, v[196:199] offset:8192
    ds_write_b128 v193, v[196:199] offset:16384
    ds_write_b128 v193, v[196:199] offset:24576
    ds_write_b128 v193, v[196:199] offset:32768
    s_mov_b32 s44, s18
    s_or_b32 s45, s19, 0x200000
    s_mov_b32 s46, 800000
    s_mov_b32 s47, 0x20000
    s_mov_b32 s48, s34
    s_mov_b32 s49, s35
    s_mov_b32 s50, 6400000
    s_mov_b32 s51, 0x20000
    s_mov_b32 s40, s16
    s_mov_b32 s41, s17
    s_mov_b32 s42, 6400000
    s_mov_b32 s43, 0x20000
    s_mov_b32 s52, s38
    s_mov_b32 s53, s39
    s_mov_b32 s54, 25165824
    s_mov_b32 s55, 0x20000
    s_lshl_b32 s12, s2, 7
    s_add_u32 s12, s12, 65536
    s_add_u32 s56, s38, s12
    s_addc_u32 s57, s39, 0
    s_mov_b32 s58, 16809984
    s_mov_b32 s59, 0x20000
    s_mov_b32 s64, 85599
    s_mov_b32 s65, 4294967100
    s_movk_i32 s66, 5368
    s_mov_b32 s67, 0xc000000
    s_mov_b32 s68, 32896
    v_add_u32 v120, 0, v191
    v_add_u32 v121, 1, v191
    v_add_u32 v122, 2, v191
    v_add_u32 v123, 3, v191
    s_lshl_b32 s10, s3, 28
    s_or_b32 s10, s10, 0x20000
    v_mov_b32 v144, s10
    v_or_b32 v145, 0x80000000, v144
    v_mov_b32 v184, 33
    v_mov_b32 v146, 0x400
    s_and_b32 s10, s3, 3
    s_lshr_b32 s4, s3, 2
    s_lshl1_add_u32 s4, s10, s4
    s_xor_b32 s4, s4, 1
    s_mul_i32 s10, s4, 49
    s_sub_i32 s10, s10, 6
    s_ashr_i32 s10, s10, 1
    s_max_i32 s7, s10, 0
    s_mul_i32 s13, s4, 4224
    s_add_u32 s13, s13, 82944
    s_lshl_b32 s14, s4, 10
    s_add_u32 s14, s14, 5120
    s_mul_i32 s12, s4, 2304
    s_add_u32 s12, s12, 46080
    s_movk_i32 s15, 128
    v_bfe_u32 v194, v255, 4, 4
    v_and_b32 v195, 7, v255
    v_cmp_eq_u32 vcc, v194, v195
    v_and_b32 v194, 8, v255
    v_lshlrev_b32 v194, 1, v194
    v_mov_b32 v196, 0x3f80
    v_lshlrev_b32 v196, v194, v196
    v_cndmask_b32 v196, 0, v196, vcc
    ds_write_b32 v192, v196 offset:0
    v_mov_b64 v[196:197], 0
    ds_write_b64 v190, v[196:197] offset:1024
    v_add_u32 v194, 155776, v192
    ds_write_b32 v194, v196
    v_lshrrev_b32 v223, 3, v255
    v_mad_u32_u24 v220, v223, s68, v243
    v_mul_u32_u24 v224, 160, v223
    v_add_u32 v221, v224, v243
    v_add_u32 v221, 46080, v221
    v_bfe_u32 v194, v255, 5, 1
    v_bfe_u32 v196, v255, 6, 1
    v_sub_u32 v194, v194, v196
    v_mul_i32_i24 v194, 640, v194
    v_add_u32 v224, v224, v194
    v_lshl_add_u32 v224, v195, 2, v224
    v_add_u32 v224, 13312, v224
    v_lshlrev_b32 v185, 4, v253
    v_and_b32 v194, 3, v253
    v_lshlrev_b32 v246, 3, v194
    v_bfe_u32 v197, v253, 2, 3
    v_lshrrev_b32 v196, 5, v253
    v_lshl_add_u32 v197, v196, 4, v197
    v_mul_u32_u24 v225, 160, v197
    v_add_u32 v225, v225, v246
    s_movk_i32 s69, 11520
    v_mov_b64 v[116:117], 0
    v_mov_b64 v[118:119], 0
    s_waitcnt lgkmcnt(0)
    s_barrier
    s_cmp_eq_u64 s[70:71], 0
    s_cbranch_scc1 L_R4
    s_waitcnt vmcnt(3)
    v_mul_u32_u24 v104, s64, v128
    v_mul_u32_u24 v105, s64, v129
    v_mul_u32_u24 v106, s64, v130
    v_mul_u32_u24 v107, s64, v131
    v_lshrrev_b32 v136, 29, v104
    v_lshrrev_b32 v137, 29, v105
    v_lshrrev_b32 v138, 29, v106
    v_lshrrev_b32 v139, 29, v107
    v_cmp_eq_u32 s[72:73], v136, v137
    v_cmp_eq_u32 s[76:77], v138, v139
    v_cmp_eq_u32 vcc, v136, v138
    v_cmp_eq_u32 s[88:89], v137, v139
    v_cmp_eq_u32 s[90:91], v136, v139
    v_cmp_eq_u32 s[10:11], v137, v138
    v_lshrrev_b32 v104, 24, v104
    v_lshrrev_b32 v105, 24, v105
    v_lshrrev_b32 v106, 24, v106
    v_lshrrev_b32 v107, 24, v107
    s_or_b64 s[74:75], s[72:73], s[88:89]
    s_or_b64 s[78:79], s[76:77], s[88:89]
    s_or_b64 s[72:73], s[72:73], vcc
    s_or_b64 s[76:77], s[76:77], vcc
    s_or_b64 s[72:73], s[72:73], s[90:91]
    s_or_b64 s[74:75], s[74:75], s[10:11]
    s_or_b64 s[76:77], s[76:77], s[10:11]
    s_or_b64 s[78:79], s[78:79], s[90:91]
    v_cndmask_b32 v136, 0, v146, s[72:73]
    v_lshl_add_u32 v136, v104, 2, v136
    ds_add_rtn_u32 v112, v136, v184 offset:5120
    v_cndmask_b32 v137, 0, v146, s[74:75]
    v_lshl_add_u32 v137, v105, 2, v137
    ds_add_rtn_u32 v113, v137, v184 offset:5120
    v_cndmask_b32 v138, 0, v146, s[76:77]
    v_lshl_add_u32 v138, v106, 2, v138
    ds_add_rtn_u32 v114, v138, v184 offset:5120
    v_cndmask_b32 v139, 0, v146, s[78:79]
    v_lshl_add_u32 v139, v107, 2, v139
    ds_add_rtn_u32 v115, v139, v184 offset:5120
    s_waitcnt vmcnt(1)
    s_mov_b64 exec, s[70:71]
    v_mul_u32_u24 v108, s64, v132
    v_mul_u32_u24 v109, s64, v133
    v_mul_u32_u24 v110, s64, v134
    v_mul_u32_u24 v111, s64, v135
    v_lshrrev_b32 v108, 24, v108
    v_lshrrev_b32 v109, 24, v109
    v_lshrrev_b32 v110, 24, v110
    v_lshrrev_b32 v111, 24, v111
    v_lshlrev_b32 v140, 2, v108
    ds_add_rtn_u32 v116, v140, v184 offset:5120
    v_lshlrev_b32 v141, 2, v109
    ds_add_rtn_u32 v117, v141, v184 offset:5120
    v_lshlrev_b32 v142, 2, v110
    ds_add_rtn_u32 v118, v142, v184 offset:5120
    v_lshlrev_b32 v143, 2, v111
    ds_add_rtn_u32 v119, v143, v184 offset:5120
    s_waitcnt lgkmcnt(7)
    s_mov_b64 exec, s[72:73]
    v_cmpx_le_u32 vcc, 132, v112
    ds_add_rtn_u32 v112, v136, v184 offset:4096
    s_waitcnt lgkmcnt(7)
    s_mov_b64 exec, s[74:75]
    v_cmpx_le_u32 vcc, 132, v113
    ds_add_rtn_u32 v113, v137, v184 offset:4096
    s_waitcnt lgkmcnt(7)
    s_mov_b64 exec, s[76:77]
    v_cmpx_le_u32 vcc, 132, v114
    ds_add_rtn_u32 v114, v138, v184 offset:4096
    s_waitcnt lgkmcnt(7)
    s_mov_b64 exec, s[78:79]
    v_cmpx_le_u32 vcc, 132, v115
    ds_add_rtn_u32 v115, v139, v184 offset:4096
    s_mov_b64 exec, s[70:71]
    s_waitcnt vmcnt(0)
    v_mad_i32_i24 v132, v108, s65, v132
    v_mul_u32_u24 v194, s66, v100
    v_lshl_or_b32 v100, v132, 18, v100
    v_and_or_b32 v194, v194, s67, v145
    v_mad_u32_u24 v132, v108, 40, s69
    v_or_b32 v100, v100, v194
    v_mad_i32_i24 v133, v109, s65, v133
    v_mul_u32_u24 v194, s66, v101
    v_lshl_or_b32 v101, v133, 18, v101
    v_and_or_b32 v194, v194, s67, v145
    v_mad_u32_u24 v133, v109, 40, s69
    v_or_b32 v101, v101, v194
    v_mad_i32_i24 v134, v110, s65, v134
    v_mul_u32_u24 v194, s66, v102
    v_lshl_or_b32 v102, v134, 18, v102
    v_and_or_b32 v194, v194, s67, v145
    v_mad_u32_u24 v134, v110, 40, s69
    v_or_b32 v102, v102, v194
    v_mad_i32_i24 v135, v111, s65, v135
    v_mul_u32_u24 v194, s66, v103
    v_lshl_or_b32 v103, v135, 18, v103
    v_and_or_b32 v194, v194, s67, v145
    v_mad_u32_u24 v135, v111, 40, s69
    v_or_b32 v103, v103, v194
    s_waitcnt lgkmcnt(7)
    v_bfe_u32 v194, v116, 3, 5
    v_add_lshl_u32 v132, v194, v132, 2
    v_and_b32 v194, 3, v194
    v_mad_i32_i24 v194, v194, -3, v132
    v_cmpx_gt_u32 vcc, 792, v116
    ds_write_b32 v132, v100
    ds_write_b8 v194, v120 offset:12
    s_mov_b64 exec, s[70:71]
    s_waitcnt lgkmcnt(8)
    v_bfe_u32 v194, v117, 3, 5
    v_add_lshl_u32 v133, v194, v133, 2
    v_and_b32 v194, 3, v194
    v_mad_i32_i24 v194, v194, -3, v133
    v_cmpx_gt_u32 vcc, 792, v117
    ds_write_b32 v133, v101
    ds_write_b8 v194, v121 offset:12
    s_mov_b64 exec, s[70:71]
    s_waitcnt lgkmcnt(9)
    v_bfe_u32 v194, v118, 3, 5
    v_add_lshl_u32 v134, v194, v134, 2
    v_and_b32 v194, 3, v194
    v_mad_i32_i24 v194, v194, -3, v134
    v_cmpx_gt_u32 vcc, 792, v118
    ds_write_b32 v134, v102
    ds_write_b8 v194, v122 offset:12
    s_mov_b64 exec, s[70:71]
    s_waitcnt lgkmcnt(10)
    v_bfe_u32 v194, v119, 3, 5
    v_add_lshl_u32 v135, v194, v135, 2
    v_and_b32 v194, 3, v194
    v_mad_i32_i24 v194, v194, -3, v135
    v_cmpx_gt_u32 vcc, 792, v119
    ds_write_b32 v135, v103
    ds_write_b8 v194, v123 offset:12
    s_mov_b64 exec, -1
    v_mad_i32_i24 v128, v104, s65, v128
    v_mul_u32_u24 v194, s66, v96
    v_lshl_or_b32 v96, v128, 18, v96
    v_and_or_b32 v194, v194, s67, v144
    v_mad_u32_u24 v128, v104, 40, s69
    v_or_b32 v96, v96, v194
    v_mad_i32_i24 v129, v105, s65, v129
    v_mul_u32_u24 v194, s66, v97
    v_lshl_or_b32 v97, v129, 18, v97
    v_and_or_b32 v194, v194, s67, v144
    v_mad_u32_u24 v129, v105, 40, s69
    v_or_b32 v97, v97, v194
    v_mad_i32_i24 v130, v106, s65, v130
    v_mul_u32_u24 v194, s66, v98
    v_lshl_or_b32 v98, v130, 18, v98
    v_and_or_b32 v194, v194, s67, v144
    v_mad_u32_u24 v130, v106, 40, s69
    v_or_b32 v98, v98, v194
    v_mad_i32_i24 v131, v107, s65, v131
    v_mul_u32_u24 v194, s66, v99
    v_lshl_or_b32 v99, v131, 18, v99
    v_and_or_b32 v194, v194, s67, v144
    v_mad_u32_u24 v131, v107, 40, s69
    v_or_b32 v99, v99, v194
    s_waitcnt lgkmcnt(11)
    v_bfe_u32 v194, v112, 3, 5
    v_add_lshl_u32 v128, v194, v128, 2
    v_and_b32 v194, 3, v194
    v_mad_i32_i24 v194, v194, -3, v128
    v_cmpx_gt_u32 vcc, 792, v112
    ds_write_b32 v128, v96
    ds_write_b8 v194, v120 offset:12
    s_mov_b64 exec, -1
    s_waitcnt lgkmcnt(12)
    v_bfe_u32 v194, v113, 3, 5
    v_add_lshl_u32 v129, v194, v129, 2
    v_and_b32 v194, 3, v194
    v_mad_i32_i24 v194, v194, -3, v129
    v_cmpx_gt_u32 vcc, 792, v113
    ds_write_b32 v129, v97
    ds_write_b8 v194, v121 offset:12
    s_mov_b64 exec, -1
    s_waitcnt lgkmcnt(13)
    v_bfe_u32 v194, v114, 3, 5
    v_add_lshl_u32 v130, v194, v130, 2
    v_and_b32 v194, 3, v194
    v_mad_i32_i24 v194, v194, -3, v130
    v_cmpx_gt_u32 vcc, 792, v114
    ds_write_b32 v130, v98
    ds_write_b8 v194, v122 offset:12
    s_mov_b64 exec, -1
    s_waitcnt lgkmcnt(14)
    v_bfe_u32 v194, v115, 3, 5
    v_add_lshl_u32 v131, v194, v131, 2
    v_and_b32 v194, 3, v194
    v_mad_i32_i24 v194, v194, -3, v131
    v_cmpx_gt_u32 vcc, 792, v115
    ds_write_b32 v131, v99
    ds_write_b8 v194, v123 offset:12
    s_mov_b64 exec, -1
    s_branch L_B1
L_R4:
    s_waitcnt vmcnt(1)
    v_mul_u32_u24 v104, s64, v128
    v_mul_u32_u24 v105, s64, v129
    v_mul_u32_u24 v106, s64, v130
    v_mul_u32_u24 v107, s64, v131
    v_lshrrev_b32 v136, 29, v104
    v_lshrrev_b32 v137, 29, v105
    v_lshrrev_b32 v138, 29, v106
    v_lshrrev_b32 v139, 29, v107
    v_cmp_eq_u32 s[72:73], v136, v137
    v_cmp_eq_u32 s[76:77], v138, v139
    v_cmp_eq_u32 vcc, v136, v138
    v_cmp_eq_u32 s[88:89], v137, v139
    v_cmp_eq_u32 s[90:91], v136, v139
    v_cmp_eq_u32 s[10:11], v137, v138
    v_lshrrev_b32 v104, 24, v104
    v_lshrrev_b32 v105, 24, v105
    v_lshrrev_b32 v106, 24, v106
    v_lshrrev_b32 v107, 24, v107
    s_or_b64 s[74:75], s[72:73], s[88:89]
    s_or_b64 s[78:79], s[76:77], s[88:89]
    s_or_b64 s[72:73], s[72:73], vcc
    s_or_b64 s[76:77], s[76:77], vcc
    s_or_b64 s[72:73], s[72:73], s[90:91]
    s_or_b64 s[74:75], s[74:75], s[10:11]
    s_or_b64 s[76:77], s[76:77], s[10:11]
    s_or_b64 s[78:79], s[78:79], s[90:91]
    v_cndmask_b32 v136, 0, v146, s[72:73]
    v_lshl_add_u32 v136, v104, 2, v136
    ds_add_rtn_u32 v112, v136, v184 offset:5120
    v_cndmask_b32 v137, 0, v146, s[74:75]
    v_lshl_add_u32 v137, v105, 2, v137
    ds_add_rtn_u32 v113, v137, v184 offset:5120
    v_cndmask_b32 v138, 0, v146, s[76:77]
    v_lshl_add_u32 v138, v106, 2, v138
    ds_add_rtn_u32 v114, v138, v184 offset:5120
    v_cndmask_b32 v139, 0, v146, s[78:79]
    v_lshl_add_u32 v139, v107, 2, v139
    ds_add_rtn_u32 v115, v139, v184 offset:5120
    s_waitcnt vmcnt(0)
    v_mad_i32_i24 v128, v104, s65, v128
    v_mul_u32_u24 v194, s66, v96
    v_lshl_or_b32 v96, v128, 18, v96
    v_and_or_b32 v194, v194, s67, v144
    v_mad_u32_u24 v128, v104, 40, s69
    v_or_b32 v96, v96, v194
    v_mad_i32_i24 v129, v105, s65, v129
    v_mul_u32_u24 v194, s66, v97
    v_lshl_or_b32 v97, v129, 18, v97
    v_and_or_b32 v194, v194, s67, v144
    v_mad_u32_u24 v129, v105, 40, s69
    v_or_b32 v97, v97, v194
    s_waitcnt lgkmcnt(3)
    s_mov_b64 exec, s[72:73]
    v_cmpx_le_u32 vcc, 132, v112
    ds_add_rtn_u32 v112, v136, v184 offset:4096
    s_waitcnt lgkmcnt(3)
    s_mov_b64 exec, s[74:75]
    v_cmpx_le_u32 vcc, 132, v113
    ds_add_rtn_u32 v113, v137, v184 offset:4096
    s_waitcnt lgkmcnt(3)
    s_mov_b64 exec, s[76:77]
    v_cmpx_le_u32 vcc, 132, v114
    ds_add_rtn_u32 v114, v138, v184 offset:4096
    s_waitcnt lgkmcnt(3)
    s_mov_b64 exec, s[78:79]
    v_cmpx_le_u32 vcc, 132, v115
    ds_add_rtn_u32 v115, v139, v184 offset:4096
    s_mov_b64 exec, -1
    v_mad_i32_i24 v130, v106, s65, v130
    v_mul_u32_u24 v194, s66, v98
    v_lshl_or_b32 v98, v130, 18, v98
    v_and_or_b32 v194, v194, s67, v144
    v_mad_u32_u24 v130, v106, 40, s69
    v_or_b32 v98, v98, v194
    v_mad_i32_i24 v131, v107, s65, v131
    v_mul_u32_u24 v194, s66, v99
    v_lshl_or_b32 v99, v131, 18, v99
    v_and_or_b32 v194, v194, s67, v144
    v_mad_u32_u24 v131, v107, 40, s69
    v_or_b32 v99, v99, v194
    s_waitcnt lgkmcnt(3)
    v_bfe_u32 v194, v112, 3, 5
    v_add_lshl_u32 v128, v194, v128, 2
    v_and_b32 v194, 3, v194
    v_mad_i32_i24 v194, v194, -3, v128
    v_cmpx_gt_u32 vcc, 792, v112
    ds_write_b32 v128, v96
    ds_write_b8 v194, v120 offset:12
    s_mov_b64 exec, -1
    s_waitcnt lgkmcnt(4)
    v_bfe_u32 v194, v113, 3, 5
    v_add_lshl_u32 v129, v194, v129, 2
    v_and_b32 v194, 3, v194
    v_mad_i32_i24 v194, v194, -3, v129
    v_cmpx_gt_u32 vcc, 792, v113
    ds_write_b32 v129, v97
    ds_write_b8 v194, v121 offset:12
    s_mov_b64 exec, -1
    s_waitcnt lgkmcnt(5)
    v_bfe_u32 v194, v114, 3, 5
    v_add_lshl_u32 v130, v194, v130, 2
    v_and_b32 v194, 3, v194
    v_mad_i32_i24 v194, v194, -3, v130
    v_cmpx_gt_u32 vcc, 792, v114
    ds_write_b32 v130, v98
    ds_write_b8 v194, v122 offset:12
    s_mov_b64 exec, -1
    s_waitcnt lgkmcnt(6)
    v_bfe_u32 v194, v115, 3, 5
    v_add_lshl_u32 v131, v194, v131, 2
    v_and_b32 v194, 3, v194
    v_mad_i32_i24 v194, v194, -3, v131
    v_cmpx_gt_u32 vcc, 792, v115
    ds_write_b32 v131, v99
    ds_write_b8 v194, v123 offset:12
    s_mov_b64 exec, -1
L_B1:
    s_cmp_ge_u32 s3, 2
    s_cbranch_scc1 L_NOC
    global_load_dwordx4 v[176:179], v232, s[28:29]
L_NOC:
    global_load_dwordx4 v[160:163], v232, s[26:27]
    global_load_dwordx4 v[164:167], v232, s[32:33]
    global_load_dwordx4 v[168:171], v232, s[24:25]
    global_load_dwordx4 v[172:175], v232, s[30:31]
    s_add_u32 s6, s6, 0x2020202
    v_lshlrev_b32 v186, v246, s6
    v_and_b32 v189, 4, v253
    v_mul_u32_u24 v189, 1212416, v189
    v_lshl_add_u32 v186, v189, 8, v186
    v_and_b32 v186, 0xfe000000, v186
    v_and_b32 v187, 7, v253
    v_mul_u32_u24 v187, 33, v187
    v_add_u32 v187, 792, v187
    v_lshlrev_b32 v222, 2, v223
    s_mov_b32 s64, 0x1000000
    s_waitcnt lgkmcnt(0)
    s_barrier
    ds_read_b128 v[192:195], v185 offset:5120
    ds_read_b32 v228, v222 offset:5120
    ds_read_b128 v[204:207], v221 offset:0
    ds_read_b32 v229, v222 offset:5376
    ds_read_b128 v[208:211], v221 offset:10240
    ds_read_b32 v230, v222 offset:5632
    ds_read_b128 v[212:215], v221 offset:20480
    ds_read_b32 v231, v222 offset:5888
    ds_read_b128 v[216:219], v221 offset:30720
    s_mov_b32 s80, 2105344
    s_mov_b32 s81, 4210688
    s_mov_b32 s82, 6316032
    s_waitcnt lgkmcnt(8)
    v_max3_u32 v188, v192, v193, v194
    v_max_u32 v188, v188, v195
    v_cmp_lt_u32 vcc, 1056, v188
    s_cbranch_vccnz L_POVF
L_POUT:
    s_waitcnt lgkmcnt(7)
    v_sub_u32 v228, v187, v228
    v_and_or_b32 v228, v228, s64, v186
    s_waitcnt lgkmcnt(6)
    v_or_b32 v207, v207, v228
    buffer_store_dwordx4 v[204:207], v220, s[56:59], 0 offen sc1
    s_waitcnt lgkmcnt(5)
    v_sub_u32 v229, v187, v229
    v_and_or_b32 v229, v229, s64, v186
    s_waitcnt lgkmcnt(4)
    v_or_b32 v211, v211, v229
    buffer_store_dwordx4 v[208:211], v220, s[56:59], s80 offen sc1
    s_waitcnt lgkmcnt(3)
    v_sub_u32 v230, v187, v230
    v_and_or_b32 v230, v230, s64, v186
    s_waitcnt lgkmcnt(2)
    v_or_b32 v215, v215, v230
    buffer_store_dwordx4 v[212:215], v220, s[56:59], s81 offen sc1
    s_waitcnt lgkmcnt(1)
    v_sub_u32 v231, v187, v231
    v_and_or_b32 v231, v231, s64, v186
    s_waitcnt lgkmcnt(0)
    v_or_b32 v219, v219, v231
    buffer_store_dwordx4 v[216:219], v220, s[56:59], s82 offen sc1
    s_mov_b32 s10, 0xbfb8aa3b
    s_mov_b32 s11, s10
    s_mov_b32 s64, 0x05040100
    s_mov_b32 s66, 0x07060302
    s_waitcnt vmcnt(4)
    v_perm_b32 v144, v170, v168, s64
    v_perm_b32 v145, v170, v168, s66
    v_perm_b32 v146, v171, v169, s64
    v_perm_b32 v147, v171, v169, s66
    v_add_u32 v148, 77824, v224
    ds_write2_b32 v148, v144, v145 offset0:0 offset1:8
    ds_write2_b32 v148, v146, v147 offset0:16 offset1:24
    v_lshlrev_b32 v128, 16, v160
    v_and_b32 v129, 0xffff0000, v160
    v_lshlrev_b32 v130, 16, v161
    v_and_b32 v131, 0xffff0000, v161
    v_lshlrev_b32 v132, 16, v162
    v_and_b32 v133, 0xffff0000, v162
    v_lshlrev_b32 v134, 16, v163
    v_and_b32 v135, 0xffff0000, v163
    v_pk_mul_f32 v[128:129], v[128:129], s[10:11]
    v_pk_mul_f32 v[130:131], v[130:131], s[10:11]
    v_pk_mul_f32 v[132:133], v[132:133], s[10:11]
    v_pk_mul_f32 v[134:135], v[134:135], s[10:11]
    v_cvt_pk_bf16_f32 v136, v128, v132
    v_cvt_pk_bf16_f32 v137, v129, v133
    v_cvt_pk_bf16_f32 v138, v130, v134
    v_cvt_pk_bf16_f32 v139, v131, v135
    ds_write2_b32 v224, v136, v137 offset0:0 offset1:8
    ds_write2_b32 v224, v138, v139 offset0:16 offset1:24
    v_perm_b32 v152, v166, v164, s64
    v_perm_b32 v153, v166, v164, s66
    v_perm_b32 v154, v167, v165, s64
    v_perm_b32 v155, v167, v165, s66
    v_add_u32 v156, 10240, v224
    ds_write2_b32 v156, v152, v153 offset0:0 offset1:8
    ds_write2_b32 v156, v154, v155 offset0:16 offset1:24
    v_perm_b32 v144, v174, v172, s64
    v_perm_b32 v145, v174, v172, s66
    v_perm_b32 v146, v175, v173, s64
    v_perm_b32 v147, v175, v173, s66
    v_add_u32 v148, 130176, v224
    ds_write2_b32 v148, v144, v145 offset0:0 offset1:8
    ds_write2_b32 v148, v146, v147 offset0:16 offset1:24
    s_cmp_ge_u32 s3, 2
    s_cbranch_scc1 L_NOWC
    v_lshlrev_b32 v128, 16, v176
    v_and_b32 v129, 0xffff0000, v176
    v_lshlrev_b32 v130, 16, v177
    v_and_b32 v131, 0xffff0000, v177
    v_lshlrev_b32 v132, 16, v178
    v_and_b32 v133, 0xffff0000, v178
    v_lshlrev_b32 v134, 16, v179
    v_and_b32 v135, 0xffff0000, v179
    v_pk_mul_f32 v[128:129], v[128:129], s[10:11]
    v_pk_mul_f32 v[130:131], v[130:131], s[10:11]
    v_pk_mul_f32 v[132:133], v[132:133], s[10:11]
    v_pk_mul_f32 v[134:135], v[134:135], s[10:11]
    v_cvt_pk_bf16_f32 v136, v128, v132
    v_cvt_pk_bf16_f32 v137, v129, v133
    v_cvt_pk_bf16_f32 v138, v130, v134
    v_cvt_pk_bf16_f32 v139, v131, v135
    v_add_u32 v140, 20480, v224
    ds_write2_b32 v140, v136, v137 offset0:0 offset1:8
    ds_write2_b32 v140, v138, v139 offset0:16 offset1:24
L_NOWC:
    s_mul_i32 s34, s5, 32896
    s_add_u32 s34, s34, 65536
    s_add_u32 s56, s38, s34
    s_addc_u32 s57, s39, 0
    s_mov_b32 s58, 32768
    s_mov_b32 s59, 0x20000
    s_add_u32 s34, s34, 8421376
    s_add_u32 s60, s38, s34
    s_addc_u32 s61, s39, 0
    s_mov_b32 s62, 32768
    s_mov_b32 s63, 0x20000
    s_movk_i32 s26, 8192
    s_movk_i32 s27, 16384
    s_movk_i32 s28, 24576
    s_waitcnt lgkmcnt(0)
    s_barrier
    v_add_u32 v225, 13312, v225
    ds_read_b64_tr_b16 v[0:1], v225 offset:0
    ds_read_b64_tr_b16 v[2:3], v225 offset:1280
    ds_read_b64_tr_b16 v[4:5], v225 offset:5120
    ds_read_b64_tr_b16 v[6:7], v225 offset:6400
    ds_read_b64_tr_b16 v[8:9], v225 offset:32
    ds_read_b64_tr_b16 v[10:11], v225 offset:1312
    ds_read_b64_tr_b16 v[12:13], v225 offset:5152
    ds_read_b64_tr_b16 v[14:15], v225 offset:6432
    ds_read_b64_tr_b16 v[16:17], v225 offset:64
    ds_read_b64_tr_b16 v[18:19], v225 offset:1344
    ds_read_b64_tr_b16 v[20:21], v225 offset:5184
    ds_read_b64_tr_b16 v[22:23], v225 offset:6464
    ds_read_b64_tr_b16 v[24:25], v225 offset:96
    ds_read_b64_tr_b16 v[26:27], v225 offset:1376
    v_mov_b64 v[64:65], 0
    v_mov_b64 v[66:67], 0
    v_mov_b32 v68, 0x20fffff
    v_mov_b32 v69, 0x20fffff
    v_mov_b32 v70, 0x20fffff
    v_mov_b32 v71, 0x20fffff
    v_lshl_add_u32 v72, v253, 4, s12
    ds_write_b128 v72, v[64:67] offset:0
    ds_write_b128 v72, v[68:71] offset:18432
    ds_write_b128 v72, v[64:67] offset:1024
    ds_write_b128 v72, v[68:71] offset:19456
    ds_write_b128 v72, v[64:67] offset:1280
    ds_write_b128 v72, v[68:71] offset:19712
    ds_read_b64_tr_b16 v[28:29], v225 offset:5216
    ds_read_b64_tr_b16 v[30:31], v225 offset:6496
    ds_read_b64_tr_b16 v[32:33], v225 offset:10240
    ds_read_b64_tr_b16 v[34:35], v225 offset:11520
    ds_read_b64_tr_b16 v[36:37], v225 offset:15360
    ds_read_b64_tr_b16 v[38:39], v225 offset:16640
    ds_read_b64_tr_b16 v[40:41], v225 offset:10272
    ds_read_b64_tr_b16 v[42:43], v225 offset:11552
    ds_read_b64_tr_b16 v[44:45], v225 offset:15392
    ds_read_b64_tr_b16 v[46:47], v225 offset:16672
    v_mov_b32 v192, v225
    s_mov_b32 exec_lo, 0
    v_subrev_u32 v192, 2560, v225
    s_mov_b32 exec_lo, -1
    s_waitcnt lgkmcnt(4)
    ds_read_b64_tr_b16 v[48:49], v225 offset:10304
    ds_read_b64_tr_b16 v[50:51], v225 offset:11584
    ds_read_b64_tr_b16 v[52:53], v225 offset:15424
    ds_read_b64_tr_b16 v[54:55], v225 offset:16704
    ds_read_b64_tr_b16 v[56:57], v225 offset:10336
    ds_read_b64_tr_b16 v[58:59], v225 offset:11616
    ds_read_b64_tr_b16 v[60:61], v225 offset:15456
    ds_read_b64_tr_b16 v[62:63], v225 offset:16736
    ds_read_b64_tr_b16 v[80:81], v192 offset:20480
    ds_read_b64_tr_b16 v[82:83], v192 offset:21760
    ds_read_b64_tr_b16 v[84:85], v192 offset:20512
    ds_read_b64_tr_b16 v[86:87], v192 offset:21792
    ds_read_b64_tr_b16 v[88:89], v192 offset:20544
    ds_read_b64_tr_b16 v[90:91], v192 offset:21824
    ds_read_b64_tr_b16 v[92:93], v192 offset:20576
    ds_read_b64_tr_b16 v[94:95], v192 offset:21856
    v_add_u32 v225, 77824, v225
    v_and_b32 v241, 1, v253
    v_lshlrev_b32 v241, 4, v241
    s_bitcmp1_b32 s4, 0
    s_cselect_b32 s10, 1, -1
    s_lshl_b32 s10, s10, 24
    s_or_b32 s10, s10, 0xdddd
    v_mov_b32 v242, s10
    v_and_b32 v245, 16, v253
    v_and_b32 v194, 15, v253
    v_lshl_add_u32 v194, v194, 5, s14
    s_mov_b32 exec_hi, 0
    v_add_u32 v245, v245, v194
    s_mov_b32 exec_hi, -1
    v_and_b32 v194, 3, v253
    v_bfe_u32 v196, v253, 2, 2
    v_and_b32 v197, 48, v253
    v_lshl_add_u32 v198, v196, 7, v197
    v_mul_u32_u24 v244, 1056, v194
    v_add3_u32 v244, v244, v198, s13
    v_lshrrev_b32 v194, 3, v253
    v_lshl_add_u32 v247, v194, 4, s12
    s_add_u32 s10, s12, 18432
    v_lshrrev_b32 v194, 1, v253
    v_lshl_add_u32 v248, v194, 2, s10
    s_add_u32 s10, s10, 2
    v_and_b32 v194, 48, v253
    v_lshl_add_u32 v250, v194, 1, s10
    v_and_b32 v194, 12, v253
    v_add_u32 v250, v250, v194
    v_lshrrev_b32 v194, 5, v253
    v_mul_u32_u24 v249, 18432, v194
    v_and_b32 v194, 15, v253
    v_lshl_add_u32 v249, v194, 2, v249
    s_add_u32 s10, s12, 2
    v_add_u32 v249, s10, v249
    v_mul_u32_u24 v156, 3128, v223
    v_add_u32 v157, 200192, v156
    v_add_u32 v158, 400384, v156
    v_add_u32 v159, 600576, v156
    s_mov_b32 s98, 0xf0f0f0f
    s_mov_b32 s99, 0xf0f0f0f
    v_mov_b32 v180, 0xfffff
    v_cndmask_b32 v176, 0, v180, s[98:99]
    v_add_lshl_u32 v191, v232, v243, 16
    v_add_u32 v152, 0x34000000, v191
    v_cndmask_b32 v152, 0, v152, s[98:99]
    v_add_u32 v153, 0x54000000, v191
    v_cndmask_b32 v153, 0, v153, s[98:99]
    v_add_u32 v154, 0x74000000, v191
    v_cndmask_b32 v154, 0, v154, s[98:99]
    v_add_u32 v155, 0x94000000, v191
    v_cndmask_b32 v155, 0, v155, s[98:99]
    v_mov_b32 v184, 4
    v_and_b32 v177, 31, v253
    v_add_lshl_u32 v179, v177, s7, 2
    v_lshrrev_b32 v191, 5, v253
    v_lshl_add_u32 v178, v191, 11, v179
    v_add_u32 v179, 153728, v179
    v_lshlrev_b32 v191, 2, v253
    v_subrev_u32 v191, s7, v191
    s_mov_b32 s10, 0x10000
    v_add_u32 v228, 0, v191
    v_and_or_b32 v228, v228, s10, 1
    v_add_u32 v229, 1, v191
    v_and_or_b32 v229, v229, s10, 1
    v_add_u32 v230, 2, v191
    v_and_or_b32 v230, v230, s10, 1
    v_add_u32 v231, 3, v191
    v_and_or_b32 v231, v231, s10, 1
    s_movk_i32 s18, 0xffc
    s_movk_i32 s20, 32
    s_mov_b32 s21, 0
    s_mov_b32 s100, 0
    s_mov_b32 s16, 0x1ffffff
    s_mov_b32 s17, 0xffff
    s_mul_i32 s10, s4, 49
    s_sub_i32 s22, s10, 6
    s_ashr_i32 s22, s22, 1
    s_add_i32 s23, s10, 7
    s_ashr_i32 s23, s23, 1
    s_add_i32 s24, s10, 43
    s_ashr_i32 s24, s24, 1
    s_add_i32 s25, s22, 31
    s_cmp_eq_u32 s4, 7
    s_cselect_b32 s24, 196, s24
    s_cselect_b32 s25, 196, s25
    s_sub_i32 s23, s23, s7
    s_sub_i32 s24, s24, s7
    s_sub_i32 s25, s25, s7
    s_waitcnt vmcnt(0)
    buffer_load_dwordx4 v[128:131], v232, s[56:59], 0 offen sc1
    buffer_load_dwordx4 v[132:135], v232, s[56:59], s26 offen sc1
    buffer_load_dwordx4 v[136:139], v232, s[56:59], s27 offen sc1
    buffer_load_dwordx4 v[140:143], v232, s[56:59], s28 offen sc1
    v_max3_u32 v188, v112, v113, v114
    v_max3_u32 v189, v115, v116, v117
    v_max3_u32 v188, v188, v118, v119
    v_max_u32 v188, v188, v189
    v_cmp_le_u32 vcc, 792, v188
    s_cbranch_vccz L_PEXTR
    v_mov_b32 v65, s6
    s_lshl_b32 s34, s2, 7
    s_add_u32 s34, s34, 8486912
    v_subrev_u32 v68, 792, v112
    v_cmpx_gt_u32 vcc, 264, v68
    s_cbranch_execz L_PE0
    v_mov_b32 v64, v96
    v_mov_b32 v66, v120
    v_bfe_u32 v68, v112, 5, 3
    v_lshlrev_b32 v68, 4, v68
    v_mad_u32_u24 v68, v104, s68, v68
    buffer_store_dwordx4 v[64:67], v68, s[52:55], s34 offen sc1
L_PE0:
    s_mov_b64 exec, -1
    v_subrev_u32 v68, 792, v113
    v_cmpx_gt_u32 vcc, 264, v68
    s_cbranch_execz L_PE1
    v_mov_b32 v64, v97
    v_mov_b32 v66, v121
    v_bfe_u32 v68, v113, 5, 3
    v_lshlrev_b32 v68, 4, v68
    v_mad_u32_u24 v68, v105, s68, v68
    buffer_store_dwordx4 v[64:67], v68, s[52:55], s34 offen sc1
L_PE1:
    s_mov_b64 exec, -1
    v_subrev_u32 v68, 792, v114
    v_cmpx_gt_u32 vcc, 264, v68
    s_cbranch_execz L_PE2
    v_mov_b32 v64, v98
    v_mov_b32 v66, v122
    v_bfe_u32 v68, v114, 5, 3
    v_lshlrev_b32 v68, 4, v68
    v_mad_u32_u24 v68, v106, s68, v68
    buffer_store_dwordx4 v[64:67], v68, s[52:55], s34 offen sc1
L_PE2:
    s_mov_b64 exec, -1
    v_subrev_u32 v68, 792, v115
    v_cmpx_gt_u32 vcc, 264, v68
    s_cbranch_execz L_PE3
    v_mov_b32 v64, v99
    v_mov_b32 v66, v123
    v_bfe_u32 v68, v115, 5, 3
    v_lshlrev_b32 v68, 4, v68
    v_mad_u32_u24 v68, v107, s68, v68
    buffer_store_dwordx4 v[64:67], v68, s[52:55], s34 offen sc1
L_PE3:
    s_mov_b64 exec, -1
    v_subrev_u32 v68, 792, v116
    v_cmpx_gt_u32 vcc, 264, v68
    s_cbranch_execz L_PE4
    v_mov_b32 v64, v100
    v_mov_b32 v66, v120
    v_bfe_u32 v68, v116, 5, 3
    v_lshlrev_b32 v68, 4, v68
    v_mad_u32_u24 v68, v108, s68, v68
    buffer_store_dwordx4 v[64:67], v68, s[52:55], s34 offen sc1
L_PE4:
    s_mov_b64 exec, -1
    v_subrev_u32 v68, 792, v117
    v_cmpx_gt_u32 vcc, 264, v68
    s_cbranch_execz L_PE5
    v_mov_b32 v64, v101
    v_mov_b32 v66, v121
    v_bfe_u32 v68, v117, 5, 3
    v_lshlrev_b32 v68, 4, v68
    v_mad_u32_u24 v68, v109, s68, v68
    buffer_store_dwordx4 v[64:67], v68, s[52:55], s34 offen sc1
L_PE5:
    s_mov_b64 exec, -1
    v_subrev_u32 v68, 792, v118
    v_cmpx_gt_u32 vcc, 264, v68
    s_cbranch_execz L_PE6
    v_mov_b32 v64, v102
    v_mov_b32 v66, v122
    v_bfe_u32 v68, v118, 5, 3
    v_lshlrev_b32 v68, 4, v68
    v_mad_u32_u24 v68, v110, s68, v68
    buffer_store_dwordx4 v[64:67], v68, s[52:55], s34 offen sc1
L_PE6:
    s_mov_b64 exec, -1
    v_subrev_u32 v68, 792, v119
    v_cmpx_gt_u32 vcc, 264, v68
    s_cbranch_execz L_PE7
    v_mov_b32 v64, v103
    v_mov_b32 v66, v123
    v_bfe_u32 v68, v119, 5, 3
    v_lshlrev_b32 v68, 4, v68
    v_mad_u32_u24 v68, v111, s68, v68
    buffer_store_dwordx4 v[64:67], v68, s[52:55], s34 offen sc1
L_PE7:
    s_mov_b64 exec, -1
L_PEXTR:
L_PW0:
    s_waitcnt vmcnt(3)
    v_xor_b32 v188, v131, v186
    v_and_b32_sdwa v96, v128, s18 dst_sel:DWORD dst_unused:UNUSED_PAD src0_sel:WORD_1 src1_sel:DWORD
    v_and_b32_sdwa v97, v129, s18 dst_sel:DWORD dst_unused:UNUSED_PAD src0_sel:WORD_1 src1_sel:DWORD
    v_and_b32_sdwa v98, v130, s18 dst_sel:DWORD dst_unused:UNUSED_PAD src0_sel:WORD_1 src1_sel:DWORD
    v_cmp_lt_u32 vcc, s16, v188
    v_cmp_ne_u32 s[64:65], 0, v128
    v_cmp_ne_u32 s[66:67], 0, v129
    v_cmp_ne_u32 s[68:69], 0, v130
    s_cbranch_vccnz L_RT0
    s_mov_b64 exec, s[64:65]
    ds_add_rtn_u32 v112, v96, v184 offset:1024
    s_mov_b64 exec, s[66:67]
    ds_add_rtn_u32 v113, v97, v184 offset:1024
    s_mov_b64 exec, s[68:69]
    ds_add_rtn_u32 v114, v98, v184 offset:1024
    s_mov_b64 exec, -1
    v_add_u32_sdwa v207, v131, v156 dst_sel:DWORD dst_unused:UNUSED_PAD src0_sel:BYTE_0 src1_sel:DWORD
    v_lshrrev_b32 v189, 28, v128
    v_lshl_add_u32 v207, v189, 8, v207
    v_and_b32 v189, 60, v96
    v_lshl_add_u32 v204, v189, 19, v207
    v_add_u32_sdwa v205, v131, v156 dst_sel:DWORD dst_unused:UNUSED_PAD src0_sel:BYTE_1 src1_sel:DWORD
    v_lshrrev_b32 v189, 28, v129
    v_lshl_add_u32 v205, v189, 8, v205
    v_and_b32 v189, 60, v97
    v_lshl_add_u32 v205, v189, 19, v205
    v_add_u32_sdwa v206, v131, v156 dst_sel:DWORD dst_unused:UNUSED_PAD src0_sel:BYTE_2 src1_sel:DWORD
    v_lshrrev_b32 v189, 28, v130
    v_lshl_add_u32 v206, v189, 8, v206
    v_and_b32 v189, 60, v98
    v_lshl_add_u32 v206, v189, 19, v206
    v_cndmask_b32 v188, v180, v207, s[64:65]
    v_and_or_b32 v128, v128, s17, v152
    v_or_b32 v204, v204, v176
    v_mov_b32_dpp v189, v188 quad_perm:[2,2,3,3] row_mask:0xf bank_mask:0xf
    v_mov_b32_dpp v207, v188 quad_perm:[0,0,1,1] row_mask:0xf bank_mask:0xf
    v_and_b32 v130, s17, v130
    v_mov_b32_dpp v207, v189 row_shr:4 row_mask:0xf bank_mask:0xa
L_PW1:
    s_waitcnt vmcnt(2)
    v_xor_b32 v188, v135, v186
    v_and_b32_sdwa v100, v132, s18 dst_sel:DWORD dst_unused:UNUSED_PAD src0_sel:WORD_1 src1_sel:DWORD
    v_and_b32_sdwa v101, v133, s18 dst_sel:DWORD dst_unused:UNUSED_PAD src0_sel:WORD_1 src1_sel:DWORD
    v_and_b32_sdwa v102, v134, s18 dst_sel:DWORD dst_unused:UNUSED_PAD src0_sel:WORD_1 src1_sel:DWORD
    v_cmp_lt_u32 vcc, s16, v188
    v_cmp_ne_u32 s[72:73], 0, v132
    v_cmp_ne_u32 s[74:75], 0, v133
    v_cmp_ne_u32 s[76:77], 0, v134
    s_cbranch_vccnz L_RT1
    s_mov_b64 exec, s[72:73]
    ds_add_rtn_u32 v116, v100, v184 offset:1024
    s_mov_b64 exec, s[74:75]
    ds_add_rtn_u32 v117, v101, v184 offset:1024
    s_mov_b64 exec, s[76:77]
    ds_add_rtn_u32 v118, v102, v184 offset:1024
    s_mov_b64 exec, -1
    v_add_u32_sdwa v211, v135, v157 dst_sel:DWORD dst_unused:UNUSED_PAD src0_sel:BYTE_0 src1_sel:DWORD
    v_lshrrev_b32 v189, 28, v132
    v_lshl_add_u32 v211, v189, 8, v211
    v_and_b32 v189, 60, v100
    v_lshl_add_u32 v208, v189, 19, v211
    v_add_u32_sdwa v209, v135, v157 dst_sel:DWORD dst_unused:UNUSED_PAD src0_sel:BYTE_1 src1_sel:DWORD
    v_lshrrev_b32 v189, 28, v133
    v_lshl_add_u32 v209, v189, 8, v209
    v_and_b32 v189, 60, v101
    v_lshl_add_u32 v209, v189, 19, v209
    v_add_u32_sdwa v210, v135, v157 dst_sel:DWORD dst_unused:UNUSED_PAD src0_sel:BYTE_2 src1_sel:DWORD
    v_lshrrev_b32 v189, 28, v134
    v_lshl_add_u32 v210, v189, 8, v210
    v_and_b32 v189, 60, v102
    v_lshl_add_u32 v210, v189, 19, v210
    v_cndmask_b32 v188, v180, v211, s[72:73]
    v_and_or_b32 v132, v132, s17, v153
    v_or_b32 v208, v208, v176
    v_mov_b32_dpp v189, v188 quad_perm:[2,2,3,3] row_mask:0xf bank_mask:0xf
    v_mov_b32_dpp v211, v188 quad_perm:[0,0,1,1] row_mask:0xf bank_mask:0xf
    v_and_b32 v134, s17, v134
    v_mov_b32_dpp v211, v189 row_shr:4 row_mask:0xf bank_mask:0xa
L_PW2:
    s_waitcnt vmcnt(1)
    v_xor_b32 v188, v139, v186
    v_and_b32_sdwa v104, v136, s18 dst_sel:DWORD dst_unused:UNUSED_PAD src0_sel:WORD_1 src1_sel:DWORD
    v_and_b32_sdwa v105, v137, s18 dst_sel:DWORD dst_unused:UNUSED_PAD src0_sel:WORD_1 src1_sel:DWORD
    v_and_b32_sdwa v106, v138, s18 dst_sel:DWORD dst_unused:UNUSED_PAD src0_sel:WORD_1 src1_sel:DWORD
    v_cmp_lt_u32 vcc, s16, v188
    v_cmp_ne_u32 s[80:81], 0, v136
    v_cmp_ne_u32 s[82:83], 0, v137
    v_cmp_ne_u32 s[84:85], 0, v138
    s_cbranch_vccnz L_RT2
    s_mov_b64 exec, s[80:81]
    ds_add_rtn_u32 v120, v104, v184 offset:1024
    s_mov_b64 exec, s[82:83]
    ds_add_rtn_u32 v121, v105, v184 offset:1024
    s_mov_b64 exec, s[84:85]
    ds_add_rtn_u32 v122, v106, v184 offset:1024
    s_mov_b64 exec, -1
    v_add_u32_sdwa v215, v139, v158 dst_sel:DWORD dst_unused:UNUSED_PAD src0_sel:BYTE_0 src1_sel:DWORD
    v_lshrrev_b32 v189, 28, v136
    v_lshl_add_u32 v215, v189, 8, v215
    v_and_b32 v189, 60, v104
    v_lshl_add_u32 v212, v189, 19, v215
    v_add_u32_sdwa v213, v139, v158 dst_sel:DWORD dst_unused:UNUSED_PAD src0_sel:BYTE_1 src1_sel:DWORD
    v_lshrrev_b32 v189, 28, v137
    v_lshl_add_u32 v213, v189, 8, v213
    v_and_b32 v189, 60, v105
    v_lshl_add_u32 v213, v189, 19, v213
    v_add_u32_sdwa v214, v139, v158 dst_sel:DWORD dst_unused:UNUSED_PAD src0_sel:BYTE_2 src1_sel:DWORD
    v_lshrrev_b32 v189, 28, v138
    v_lshl_add_u32 v214, v189, 8, v214
    v_and_b32 v189, 60, v106
    v_lshl_add_u32 v214, v189, 19, v214
    v_cndmask_b32 v188, v180, v215, s[80:81]
    v_and_or_b32 v136, v136, s17, v154
    v_or_b32 v212, v212, v176
    v_mov_b32_dpp v189, v188 quad_perm:[2,2,3,3] row_mask:0xf bank_mask:0xf
    v_mov_b32_dpp v215, v188 quad_perm:[0,0,1,1] row_mask:0xf bank_mask:0xf
    v_and_b32 v138, s17, v138
    v_mov_b32_dpp v215, v189 row_shr:4 row_mask:0xf bank_mask:0xa
L_PW3:
    s_waitcnt vmcnt(0)
    v_xor_b32 v188, v143, v186
    v_and_b32_sdwa v108, v140, s18 dst_sel:DWORD dst_unused:UNUSED_PAD src0_sel:WORD_1 src1_sel:DWORD
    v_and_b32_sdwa v109, v141, s18 dst_sel:DWORD dst_unused:UNUSED_PAD src0_sel:WORD_1 src1_sel:DWORD
    v_and_b32_sdwa v110, v142, s18 dst_sel:DWORD dst_unused:UNUSED_PAD src0_sel:WORD_1 src1_sel:DWORD
    v_cmp_lt_u32 vcc, s16, v188
    v_cmp_ne_u32 s[88:89], 0, v140
    v_cmp_ne_u32 s[90:91], 0, v141
    v_cmp_ne_u32 s[92:93], 0, v142
    s_cbranch_vccnz L_RT3
    s_mov_b64 exec, s[88:89]
    ds_add_rtn_u32 v124, v108, v184 offset:1024
    s_mov_b64 exec, s[90:91]
    ds_add_rtn_u32 v125, v109, v184 offset:1024
    s_mov_b64 exec, s[92:93]
    ds_add_rtn_u32 v126, v110, v184 offset:1024
    s_mov_b64 exec, -1
    v_or3_b32 v190, v131, v135, v139
    v_or_b32 v190, v190, v143
    v_and_b32 v190, 0x1000000, v190
    v_cmp_ne_u32 vcc, 0, v190
    s_cbranch_vccz L_XT1R
    v_and_b32 v190, 0x1000000, v131
    v_cmp_ne_u32 s[70:71], 0, v190
    s_bcnt1_i32_b64 s10, s[70:71]
    s_lshl2_add_u32 s21, s10, s21
    v_and_b32 v190, 0x1000000, v135
    v_cmp_ne_u32 s[78:79], 0, v190
    s_bcnt1_i32_b64 s10, s[78:79]
    s_lshl2_add_u32 s21, s10, s21
    v_and_b32 v190, 0x1000000, v139
    v_cmp_ne_u32 s[86:87], 0, v190
    s_bcnt1_i32_b64 s10, s[86:87]
    s_lshl2_add_u32 s21, s10, s21
    v_and_b32 v190, 0x1000000, v143
    v_cmp_ne_u32 s[94:95], 0, v190
    s_bcnt1_i32_b64 s10, s[94:95]
    s_lshl2_add_u32 s21, s10, s21
    s_mov_b64 exec, s[70:71]
    s_cbranch_execz L_XLa0
    s_movk_i32 s10, 0
    buffer_load_dwordx4 v[64:67], v232, s[60:63], s10 offen sc1
L_XLa0:
    s_mov_b64 exec, s[78:79]
    s_cbranch_execz L_XLa1
    s_movk_i32 s10, 8192
    buffer_load_dwordx4 v[68:71], v232, s[60:63], s10 offen sc1
L_XLa1:
    s_mov_b64 exec, s[86:87]
    s_cbranch_execz L_XLa2
    s_movk_i32 s10, 16384
    buffer_load_dwordx4 v[72:75], v232, s[60:63], s10 offen sc1
L_XLa2:
    s_mov_b64 exec, s[94:95]
    s_cbranch_execz L_XLa3
    s_movk_i32 s10, 24576
    buffer_load_dwordx4 v[76:79], v232, s[60:63], s10 offen sc1
L_XLa3:
    s_mov_b64 exec, -1
    v_or3_b32 v190, v129, v133, v137
    v_or_b32 v190, v190, v141
    v_and_b32 v190, 0x10000, v190
    v_mov_b32 v191, 640
    v_cmpx_ne_u32 vcc, 0, v190
    ds_write_b32 v191, v184 offset:4
    s_mov_b64 exec, 1
    v_mov_b32 v190, s21
    ds_add_u32 v191, v190 offset:8
    s_mov_b64 exec, -1
L_XT1R:
    v_add_u32_sdwa v219, v143, v159 dst_sel:DWORD dst_unused:UNUSED_PAD src0_sel:BYTE_0 src1_sel:DWORD
    v_lshrrev_b32 v189, 28, v140
    v_lshl_add_u32 v219, v189, 8, v219
    v_and_b32 v189, 60, v108
    v_lshl_add_u32 v216, v189, 19, v219
    v_add_u32_sdwa v217, v143, v159 dst_sel:DWORD dst_unused:UNUSED_PAD src0_sel:BYTE_1 src1_sel:DWORD
    v_lshrrev_b32 v189, 28, v141
    v_lshl_add_u32 v217, v189, 8, v217
    v_and_b32 v189, 60, v109
    v_lshl_add_u32 v217, v189, 19, v217
    v_add_u32_sdwa v218, v143, v159 dst_sel:DWORD dst_unused:UNUSED_PAD src0_sel:BYTE_2 src1_sel:DWORD
    v_lshrrev_b32 v189, 28, v142
    v_lshl_add_u32 v218, v189, 8, v218
    v_and_b32 v189, 60, v110
    v_lshl_add_u32 v218, v189, 19, v218
    v_cndmask_b32 v188, v180, v219, s[88:89]
    v_and_or_b32 v140, v140, s17, v155
    v_or_b32 v216, v216, v176
    v_mov_b32_dpp v189, v188 quad_perm:[2,2,3,3] row_mask:0xf bank_mask:0xf
    v_mov_b32_dpp v219, v188 quad_perm:[0,0,1,1] row_mask:0xf bank_mask:0xf
    v_and_b32 v142, s17, v142
    v_mov_b32_dpp v219, v189 row_shr:4 row_mask:0xf bank_mask:0xa
    v_mov_b32 v197, 640
    s_cmp_eq_u32 s3, 6
    s_cselect_b32 exec_hi, 0, -1
    s_cmp_eq_u32 s3, 7
    s_cselect_b64 exec, 1, exec
    s_add_u32 m0, s101, 0
    s_nop 0
    buffer_load_dwordx4 v234, s[40:43], 0 offen offset:0 lds
    s_add_u32 m0, s101, 6560
    s_nop 0
    buffer_load_dwordx4 v234, s[40:43], 0 offen offset:128 lds
    s_add_u32 m0, s101, 13120
    s_nop 0
    buffer_load_dwordx4 v234, s[40:43], 0 offen offset:256 lds
    s_add_u32 m0, s101, 19680
    s_nop 0
    buffer_load_dwordx4 v234, s[40:43], 0 offen offset:384 lds
    s_mov_b64 exec, -1
    s_waitcnt lgkmcnt(0)
    s_barrier
    ds_read_u16 v198, v178 offset:1024
    ds_read_u16 v199, v178 offset:2048
    ds_read_b128 v[160:163], v185 offset:1024
    ds_read_b128 v[164:167], v185 offset:2048
    ds_read_b128 v[168:171], v185 offset:3072
    ds_read_b128 v[172:175], v185 offset:4096
    ds_read_b32 v236, v197 offset:8
    s_lshl_b32 m0, s3, 10
    v_mov_b32 v240, v207
    s_add_u32 m0, m0, 13312
    s_nop 0
    buffer_load_dwordx4 v[240:241], s[44:47], 0 idxen offen lds
    s_cmp_lg_u32 s2, 0
    s_cbranch_scc1 L_NOK
    v_mov_b32 v237, s6
    v_mov_b32 v238, 0
    buffer_store_dword v237, v238, s[52:55], 0 offen sc1
L_NOK:
    s_waitcnt lgkmcnt(5)
    v_lshl_or_b32 v198, v199, 16, v198
    v_mov_b32 v199, v198
    s_waitcnt lgkmcnt(0)
    v_add_u32_sdwa v188, v160, v164 dst_sel:DWORD dst_unused:UNUSED_PAD src0_sel:WORD_0 src1_sel:WORD_0
    v_add_u32_sdwa v192, v168, v172 dst_sel:DWORD dst_unused:UNUSED_PAD src0_sel:WORD_0 src1_sel:WORD_0
    v_add_u32_dpp v199, v199, v199 row_shr:1 row_mask:0xf bank_mask:0xf bound_ctrl:0
    v_add_u32_sdwa v189, v161, v165 dst_sel:DWORD dst_unused:UNUSED_PAD src0_sel:WORD_0 src1_sel:WORD_0
    v_add_u32_sdwa v193, v169, v173 dst_sel:DWORD dst_unused:UNUSED_PAD src0_sel:WORD_0 src1_sel:WORD_0
    v_add_u32_dpp v199, v199, v199 row_shr:2 row_mask:0xf bank_mask:0xf bound_ctrl:0
    v_add_u32_sdwa v190, v162, v166 dst_sel:DWORD dst_unused:UNUSED_PAD src0_sel:WORD_0 src1_sel:WORD_0
    v_add_u32_sdwa v194, v170, v174 dst_sel:DWORD dst_unused:UNUSED_PAD src0_sel:WORD_0 src1_sel:WORD_0
    v_add_u32_dpp v199, v199, v199 row_shr:4 row_mask:0xf bank_mask:0xf bound_ctrl:0
    v_add_u32_sdwa v191, v163, v167 dst_sel:DWORD dst_unused:UNUSED_PAD src0_sel:WORD_0 src1_sel:WORD_0
    v_add_u32_sdwa v195, v171, v175 dst_sel:DWORD dst_unused:UNUSED_PAD src0_sel:WORD_0 src1_sel:WORD_0
    v_add_u32_dpp v199, v199, v199 row_shr:8 row_mask:0xf bank_mask:0xf bound_ctrl:0
    v_add_u32 v188, v188, v192
    v_add_u32 v189, v189, v193
    v_add_u32_dpp v199, v199, v199 row_bcast:15 row_mask:0xa bank_mask:0xf
    v_add_u32 v190, v190, v194
    v_add_u32 v191, v191, v195
    v_mul_u32_u24 v196, v188, v228
    v_mad_u32_u24 v196, v189, v229, v196
    v_mad_u32_u24 v196, v190, v230, v196
    v_mad_u32_u24 v196, v191, v231, v196
    s_mov_b32 s96, -1
    s_mov_b32 s97, 0
    v_sub_u32 v200, v199, v198
    v_add_u32_sdwa v202, v199, v199 dst_sel:DWORD dst_unused:UNUSED_PAD src0_sel:WORD_0 src1_sel:WORD_1
    v_add_u32_dpp v196, v196, v196 row_shr:1 row_mask:0xf bank_mask:0xf bound_ctrl:0
    v_add_u32_sdwa v201, v200, v200 dst_sel:DWORD dst_unused:UNUSED_PAD src0_sel:WORD_0 src1_sel:WORD_1
    v_add_u32_sdwa v203, v198, v198 dst_sel:DWORD dst_unused:UNUSED_PAD src0_sel:WORD_0 src1_sel:WORD_1
    v_add_u32_dpp v196, v196, v196 row_shr:2 row_mask:0xf bank_mask:0xf bound_ctrl:0
    v_and_b32 v129, s17, v129
    v_readfirstlane_b32 s19, v236
    v_add_u32_dpp v196, v196, v196 row_shr:4 row_mask:0xf bank_mask:0xf bound_ctrl:0
    v_permlane32_swap_b32 v201, v202
    v_cndmask_b32 v203, 0, v203, s[96:97]
    v_add_u32_dpp v196, v196, v196 row_shr:8 row_mask:0xf bank_mask:0xf bound_ctrl:0
    v_add_u32 v201, v201, v202
    v_and_b32 v133, s17, v133
    v_add_u32_dpp v196, v196, v196 row_bcast:15 row_mask:0xa bank_mask:0xf
    v_add_u32 v202, v201, v203
    v_and_b32 v137, s17, v137
    v_add_u32_dpp v196, v196, v196 row_bcast:31 row_mask:0xc bank_mask:0xf
    v_sub_u32_sdwa v203, v202, v198 dst_sel:DWORD dst_unused:UNUSED_PAD src0_sel:DWORD src1_sel:WORD_1
    v_readlane_b32 s16, v196, 63
    s_lshl_b32 m0, s3, 10
    v_mov_b32 v240, v211
    s_add_u32 m0, m0, 21504
    s_nop 0
    buffer_load_dwordx4 v[240:241], s[44:47], 0 idxen offen lds
    s_bfe_u32 s10, s16, 0xe0002
    s_lshr_b32 s16, s16, 16
    s_lshr_b32 s11, s10, 1
    s_add_u32 s11, s11, 48
    s_and_b32 s11, s11, -128
    s_lshr_b32 s8, s4, 1
    s_mul_i32 s8, s8, s10
    s_sub_i32 s11, s11, 48
    s_sub_i32 s8, s8, s16
    s_add_i32 s11, s11, s8
    s_add_i32 s10, s10, s8
    s_bitcmp1_b32 s4, 0
    s_cselect_b32 s31, s11, s8
    s_cselect_b32 s10, s10, s11
    v_cmp_gt_i32 vcc, s31, v202
    v_cmp_gt_i32 s[34:35], s10, v202
    s_bcnt1_i32_b32 s22, vcc_lo
    s_bcnt1_i32_b32 s10, s34
    s_min_i32 s22, s22, s23
    s_max_i32 s10, s10, s24
    s_min_i32 s23, s10, s25
    v_readlane_b32 s16, v201, s22
    v_readlane_b32 s30, v201, s23
    s_add_u32 s8, s22, s7
    s_add_u32 s9, s23, s7
    s_add_u32 s10, s22, 32
    s_add_u32 s11, s23, 32
    v_readlane_b32 s26, v200, s22
    v_readlane_b32 s28, v200, s23
    v_readlane_b32 s27, v200, s10
    v_readlane_b32 s29, v200, s11
    s_sub_u32 s31, s30, s16
    s_add_u32 s10, s31, 255
    s_sub_i32 s11, s23, 16
    s_max_i32 s11, s11, s22
    v_readlane_b32 s11, v201, s11
    s_add_u32 vcc_lo, s31, 127
    s_and_b32 vcc_hi, vcc_lo, 127
    s_add_u32 vcc_hi, vcc_hi, s19
    s_cmp_lt_u32 vcc_hi, 55
    s_cselect_b32 vcc_lo, vcc_lo, s10
    s_sub_u32 s11, s11, s16
    s_add_u32 s11, s11, s19
    s_lshl_b32 s11, s11, 1
    s_and_b32 vcc_lo, vcc_lo, -256
    s_cmp_le_u32 s11, vcc_lo
    s_cselect_b32 s10, vcc_lo, s10
    s_lshr_b32 s10, s10, 8
    s_lshl_b32 s10, s10, 7
    s_sub_u32 s10, s10, s19
    s_max_i32 s10, s10, 0
    s_add_u32 s16, s16, s10
    s_add_u32 s10, s22, 16
    s_min_u32 s10, s10, s23
    s_sub_i32 s11, s23, 16
    v_cmp_ge_u32 s[34:35], s16, v203
    v_cmp_ge_u32 s[36:37], s16, v202
    v_cmp_gt_i32 vcc, s10, v177
    v_cmp_gt_i32 s[10:11], s11, v177
    v_cmp_le_u32 s[32:33], s22, v177
    v_cmp_gt_u32 s[96:97], s23, v177
    s_and_b64 s[34:35], s[34:35], vcc
    s_and_b64 s[36:37], s[36:37], vcc
    s_or_b64 s[34:35], s[34:35], s[10:11]
    s_or_b64 s[36:37], s[36:37], s[10:11]
    s_bcnt1_i32_b32 s24, s34
    s_bcnt1_i32_b32 s10, s36
    s_bcnt1_i32_b32 s11, s35
    s_bcnt1_i32_b32 s25, s37
    v_readlane_b32 s22, v200, s24
    v_readlane_b32 s10, v200, s10
    s_add_u32 s11, s11, 32
    s_add_u32 s16, s25, 32
    v_readlane_b32 s23, v200, s11
    v_readlane_b32 s11, v200, s16
    v_mov_b32 v188, s17
    v_cndmask_b32 v189, 0, v188, s[34:35]
    v_cndmask_b32 v188, 0, v188, s[36:37]
    s_and_b64 s[32:33], s[32:33], s[96:97]
    s_pack_lh_b32_b16 s22, s22, s10
    s_pack_lh_b32_b16 s23, s23, s11
    v_lshl_or_b32 v188, v188, 16, v189
    s_sub_u32 s16, s12, 37888
    s_pack_ll_b32_b16 s16, s16, s16
    s_sub_u32 s10, s22, s26
    s_sub_u32 s11, s23, s27
    s_mul_i32 s10, s10, 0x10001
    s_lshl_b32 vcc_lo, s10, 16
    s_pack_hh_b32_b16 s10, s10, s10
    s_lshl_b32 vcc_hi, s11, 16
    s_add_u32 vcc_hi, vcc_hi, s10
    s_add_u32 s96, vcc_hi, s11
    s_lshr_b32 s96, s96, 16
    s_sub_u32 s31, s31, s96
    s_cmp_gt_u32 s31, s96
    s_cselect_b32 s97, 0x4800480, 0
    s_add_u32 s16, s16, s97
    s_sub_u32 s10, s16, s26
    s_sub_u32 s11, s16, s27
    s_add_u32 s10, s10, vcc_lo
    s_add_u32 s11, s11, vcc_hi
    v_mov_b32 v192, s10
    v_mov_b32 v193, s11
    s_add_u32 s16, s16, 0x4800480
    s_sub_u32 s16, s16, s97
    s_sub_u32 s16, s16, s97
    s_sub_u32 s10, s28, s22
    s_sub_u32 s11, s29, s23
    s_mul_i32 s10, s10, 0x10001
    s_lshl_b32 vcc_lo, s10, 16
    s_pack_hh_b32_b16 s10, s10, s10
    s_lshl_b32 vcc_hi, s11, 16
    s_add_u32 vcc_hi, vcc_hi, s10
    s_sub_u32 s10, s16, s22
    s_sub_u32 s11, s16, s23
    s_add_u32 s10, s10, vcc_lo
    s_add_u32 s11, s11, vcc_hi
    v_mov_b32 v194, s10
    v_mov_b32 v195, s11
    v_bfi_b32 v192, v188, v192, v194
    v_bfi_b32 v193, v188, v193, v195
    s_mov_b32 exec_hi, 0
    v_mov_b32 v193, v192
    s_mov_b64 exec, s[32:33]
    v_add_u32 v200, v200, v193
    s_bfe_u32 s10, s97, 0x10007
    s_lshl1_add_u32 s10, s4, s10
    s_lshl_b32 s10, s10, 2
    v_cndmask_b32 v188, 4, 0, s[34:35]
    ds_write_b16 v178, v200 offset:1026
    ds_write_b16_d16_hi v178, v200 offset:2050
    s_mov_b32 exec_hi, 0
    v_xor_b32 v188, s10, v188
    ds_write_b32 v179, v188
    s_mov_b64 exec, -1
    s_min_u32 s10, s31, s96
    s_max_u32 s96, s31, s96
    s_mov_b32 s31, s10
    s_add_u32 s10, s96, s19
    s_mul_i32 s11, s30, 9216
    s_lshr_b32 s11, s11, 16
    s_max_u32 s10, s10, s11
    s_cmp_lt_u32 s10, 1152
    s_cbranch_scc1 L_LFIT
    ds_write_b32 v197, v184
L_LFIT:
    s_cmp_eq_u32 s19, 0
    s_cbranch_scc1 L_XCNR
    s_sub_u32 s10, s12, 37888
    s_add_u32 s11, s10, s96
    v_mov_b32 v188, s11
    s_add_u32 s11, s10, s31
    s_add_u32 s11, s11, 1152
    v_mov_b32 v189, s11
    s_lshl_b32 s10, s4, 3
    v_mov_b32 v190, s10
    ds_write_b64 v190, v[188:189] offset:576
L_XCNR:
    s_lshl_b32 m0, s3, 10
    v_mov_b32 v240, v215
    s_add_u32 m0, m0, 29696
    s_nop 0
    buffer_load_dwordx4 v[240:241], s[44:47], 0 idxen offen lds
    v_and_b32 v141, s17, v141
    s_waitcnt lgkmcnt(0)
    s_barrier
    ds_read_b64 v[202:203], v197
    ds_read_u16 v96, v96 offset:1026
    ds_read_u16 v97, v97 offset:1026
    ds_read_u16 v98, v98 offset:1026
    ds_read_u16 v100, v100 offset:1026
    ds_read_u16 v101, v101 offset:1026
    ds_read_u16 v102, v102 offset:1026
    ds_read_u16 v104, v104 offset:1026
    ds_read_u16 v105, v105 offset:1026
    ds_read_u16 v106, v106 offset:1026
    ds_read_u16 v108, v108 offset:1026
    ds_read_u16 v109, v109 offset:1026
    ds_read_u16 v110, v110 offset:1026
    s_lshl_b32 m0, s3, 10
    v_mov_b32 v240, v219
    s_add_u32 m0, m0, 37888
    s_nop 0
    buffer_load_dwordx4 v[240:241], s[44:47], 0 idxen offen lds
    s_add_u32 s24, s24, s7
    s_add_u32 s11, s25, s7
    s_and_b32 s10, s11, 15
    s_cmp_lt_u32 s11, s24
    s_cselect_b32 s25, s10, 16
    s_cmp_lg_u32 s97, 0
    s_cselect_b32 s23, s8, s11
    s_cselect_b32 s7, s8, s24
    s_cselect_b32 s8, s11, s8
    s_cselect_b32 s24, s9, s24
    s_cselect_b32 s9, s11, s9
    s_min_u32 s22, s8, 192
    s_min_u32 s23, s23, 192
    s_mov_b32 s30, s19
    s_waitcnt lgkmcnt(12)
    v_cmp_ne_u32 vcc, 0, v202
    v_readfirstlane_b32 s19, v203
    s_cbranch_vccnz L_OVF
    s_waitcnt lgkmcnt(9)
    s_mov_b64 exec, s[64:65]
    v_add_u32 v96, v96, v112
    ds_write2st64_b32 v96, v128, v204 offset0:148 offset1:220
    s_mov_b64 exec, s[66:67]
    v_add_u32 v97, v97, v113
    ds_write2st64_b32 v97, v129, v205 offset0:148 offset1:220
    s_mov_b64 exec, s[68:69]
    v_add_u32 v98, v98, v114
    ds_write2st64_b32 v98, v130, v206 offset0:148 offset1:220
    s_waitcnt lgkmcnt(9)
    s_mov_b64 exec, s[72:73]
    v_add_u32 v100, v100, v116
    ds_write2st64_b32 v100, v132, v208 offset0:148 offset1:220
    s_mov_b64 exec, s[74:75]
    v_add_u32 v101, v101, v117
    ds_write2st64_b32 v101, v133, v209 offset0:148 offset1:220
    s_mov_b64 exec, s[76:77]
    v_add_u32 v102, v102, v118
    ds_write2st64_b32 v102, v134, v210 offset0:148 offset1:220
    s_waitcnt lgkmcnt(9)
    s_mov_b64 exec, s[80:81]
    v_add_u32 v104, v104, v120
    ds_write2st64_b32 v104, v136, v212 offset0:148 offset1:220
    s_mov_b64 exec, s[82:83]
    v_add_u32 v105, v105, v121
    ds_write2st64_b32 v105, v137, v213 offset0:148 offset1:220
    s_mov_b64 exec, s[84:85]
    v_add_u32 v106, v106, v122
    ds_write2st64_b32 v106, v138, v214 offset0:148 offset1:220
    s_waitcnt lgkmcnt(9)
    s_mov_b64 exec, s[88:89]
    v_add_u32 v108, v108, v124
    ds_write2st64_b32 v108, v140, v216 offset0:148 offset1:220
    s_mov_b64 exec, s[90:91]
    v_add_u32 v109, v109, v125
    ds_write2st64_b32 v109, v141, v217 offset0:148 offset1:220
    s_mov_b64 exec, s[92:93]
    v_add_u32 v110, v110, v126
    ds_write2st64_b32 v110, v142, v218 offset0:148 offset1:220
    s_mov_b64 exec, -1
    s_add_u32 s10, s96, 127
    s_lshr_b32 s10, s10, 7
    s_lshl1_add_u32 s10, s10, -1
    s_add_u32 s11, s31, 127
    s_lshr_b32 s11, s11, 6
    s_and_b32 s11, s11, -2
    s_max_i32 s17, s10, s11
    s_cselect_b32 s10, s96, s31
    s_sub_u32 s10, s10, 1
    s_andn2_b32 s99, 64, s10
L_CA:
    ds_read_b64_tr_b16 v[96:97], v225 offset:0
    ds_read_b64_tr_b16 v[98:99], v225 offset:1280
    ds_read_b64_tr_b16 v[100:101], v225 offset:5120
    ds_read_b64_tr_b16 v[102:103], v225 offset:6400
    ds_read_b64_tr_b16 v[104:105], v225 offset:32
    ds_read_b64_tr_b16 v[106:107], v225 offset:1312
    ds_read_b64_tr_b16 v[108:109], v225 offset:5152
    ds_read_b64_tr_b16 v[110:111], v225 offset:6432
    ds_read_b64_tr_b16 v[112:113], v225 offset:64
    ds_read_b64_tr_b16 v[114:115], v225 offset:1344
    ds_read_b64_tr_b16 v[116:117], v225 offset:5184
    ds_read_b64_tr_b16 v[118:119], v225 offset:6464
    ds_read_b64_tr_b16 v[120:121], v225 offset:96
    ds_read_b64_tr_b16 v[122:123], v225 offset:1376
    ds_read_b64_tr_b16 v[124:125], v225 offset:5216
    ds_read_b64_tr_b16 v[126:127], v225 offset:6496
    s_cmp_eq_u32 s21, 0
    s_cbranch_scc1 L_XT2R
    s_waitcnt vmcnt(8)
L_XT2:
    s_mov_b64 s[34:35], 0
    v_cmp_ne_u32 vcc, s6, v65
    s_and_b64 vcc, vcc, s[70:71]
    s_or_b64 s[34:35], s[34:35], vcc
    v_cmp_ne_u32 vcc, s6, v69
    s_and_b64 vcc, vcc, s[78:79]
    s_or_b64 s[34:35], s[34:35], vcc
    v_cmp_ne_u32 vcc, s6, v73
    s_and_b64 vcc, vcc, s[86:87]
    s_or_b64 s[34:35], s[34:35], vcc
    v_cmp_ne_u32 vcc, s6, v77
    s_and_b64 vcc, vcc, s[94:95]
    s_or_b64 s[34:35], s[34:35], vcc
    s_cbranch_scc1 L_XT2B
    s_cmp_eq_u32 s20, 0
    s_cbranch_scc1 L_XT2R
    s_mov_b64 exec, s[70:71]
    s_cbranch_execz L_XS0
    v_bfe_u32 v65, v64, 18, 8
    v_lshlrev_b32 v65, 2, v65
    v_add_u32 v67, 153728, v65
    ds_read_b32 v67, v67
    v_add_u32_sdwa v66, v66, v156 dst_sel:DWORD dst_unused:UNUSED_PAD src0_sel:BYTE_0 src1_sel:DWORD
    v_lshrrev_b32 v189, 28, v64
    v_lshl_add_u32 v66, v189, 8, v66
    v_and_b32 v189, 60, v65
    v_lshl_add_u32 v66, v189, 19, v66
    v_and_b32 v64, 0xffff, v64
    s_waitcnt lgkmcnt(0)
    ds_add_rtn_u32 v67, v67, v184 offset:576
    s_waitcnt lgkmcnt(0)
    ds_write2st64_b32 v67, v64, v66 offset0:148 offset1:220
L_XS0:
    s_mov_b64 exec, s[78:79]
    s_cbranch_execz L_XS1
    v_bfe_u32 v69, v68, 18, 8
    v_lshlrev_b32 v69, 2, v69
    v_add_u32 v71, 153728, v69
    ds_read_b32 v71, v71
    v_add_u32_sdwa v70, v70, v157 dst_sel:DWORD dst_unused:UNUSED_PAD src0_sel:BYTE_0 src1_sel:DWORD
    v_lshrrev_b32 v189, 28, v68
    v_lshl_add_u32 v70, v189, 8, v70
    v_and_b32 v189, 60, v69
    v_lshl_add_u32 v70, v189, 19, v70
    v_and_b32 v68, 0xffff, v68
    s_waitcnt lgkmcnt(0)
    ds_add_rtn_u32 v71, v71, v184 offset:576
    s_waitcnt lgkmcnt(0)
    ds_write2st64_b32 v71, v68, v70 offset0:148 offset1:220
L_XS1:
    s_mov_b64 exec, s[86:87]
    s_cbranch_execz L_XS2
    v_bfe_u32 v73, v72, 18, 8
    v_lshlrev_b32 v73, 2, v73
    v_add_u32 v75, 153728, v73
    ds_read_b32 v75, v75
    v_add_u32_sdwa v74, v74, v158 dst_sel:DWORD dst_unused:UNUSED_PAD src0_sel:BYTE_0 src1_sel:DWORD
    v_lshrrev_b32 v189, 28, v72
    v_lshl_add_u32 v74, v189, 8, v74
    v_and_b32 v189, 60, v73
    v_lshl_add_u32 v74, v189, 19, v74
    v_and_b32 v72, 0xffff, v72
    s_waitcnt lgkmcnt(0)
    ds_add_rtn_u32 v75, v75, v184 offset:576
    s_waitcnt lgkmcnt(0)
    ds_write2st64_b32 v75, v72, v74 offset0:148 offset1:220
L_XS2:
    s_mov_b64 exec, s[94:95]
    s_cbranch_execz L_XS3
    v_bfe_u32 v77, v76, 18, 8
    v_lshlrev_b32 v77, 2, v77
    v_add_u32 v79, 153728, v77
    ds_read_b32 v79, v79
    v_add_u32_sdwa v78, v78, v159 dst_sel:DWORD dst_unused:UNUSED_PAD src0_sel:BYTE_0 src1_sel:DWORD
    v_lshrrev_b32 v189, 28, v76
    v_lshl_add_u32 v78, v189, 8, v78
    v_and_b32 v189, 60, v77
    v_lshl_add_u32 v78, v189, 19, v78
    v_and_b32 v76, 0xffff, v76
    s_waitcnt lgkmcnt(0)
    ds_add_rtn_u32 v79, v79, v184 offset:576
    s_waitcnt lgkmcnt(0)
    ds_write2st64_b32 v79, v76, v78 offset0:148 offset1:220
L_XS3:
    s_mov_b64 exec, -1
L_XT2R:
    s_cmp_ge_u32 s3, 4
    s_cbranch_scc1 L_EP0
    s_lshl_b32 s72, s4, 7
    s_add_u32 s72, s72, 156800
    v_mov_b32 v190, s22
    s_mov_b32 exec_lo, 0xffff0000
    v_mov_b32 v190, s23
    s_mov_b32 exec_lo, -1
    s_mov_b32 exec_hi, 0
    v_sub_u32 v191, v253, v190
    v_and_b32 v191, 15, v191
    v_add_lshl_u32 v191, v191, v190, 5
    v_lshl_add_u32 v190, v253, 2, s72
    ds_write_b32 v190, v191
    s_mov_b32 exec_hi, -1
    s_mul_i32 s10, s5, 196
    s_add_u32 s11, s10, s7
    s_add_u32 s62, s10, s9
    s_min_u32 s11, s11, 50000
    s_min_u32 s62, s62, 50000
    s_sub_u32 s62, s62, s11
    s_lshl_b32 s11, s11, 7
    s_lshl_b32 s62, s62, 7
    s_add_u32 s60, s48, s11
    s_addc_u32 s61, s49, 0
    s_mul_i32 s74, s7, -128
    s_add_u32 s11, s10, s8
    s_add_u32 s50, s10, s24
    s_min_u32 s11, s11, 50000
    s_min_u32 s50, s50, 50000
    s_sub_u32 s50, s50, s11
    s_lshl_b32 s11, s11, 7
    s_lshl_b32 s50, s50, 7
    s_add_u32 s48, s48, s11
    s_addc_u32 s49, s49, 0
    s_mul_i32 s73, s8, -128
    s_and_b32 s10, s25, 12
    s_lshl_b32 s10, s10, 2
    s_bfm_b64 s[76:77], 16, s10
L_EP0:
    s_waitcnt vmcnt(0) lgkmcnt(0)
    s_barrier
    s_mov_b32 s10, 0x358637bd
    ds_read_b128 v[236:239], v247
    ds_read_b32 v240, v248
    v_lshrrev_b32 v188, 2, v253
    v_and_b32 v188, 12, v188
    v_subrev_u32 v188, s25, v188
    s_waitcnt lgkmcnt(0)
    s_cmp_ge_u32 s3, 4
    s_cbranch_scc1 L_LATE0
    s_add_u32 m0, s13, 0
    v_mad_u32_u16 v236, v236, s15, v243
    buffer_load_dwordx4 v236, s[40:43], 0 offen lds
    s_add_u32 m0, s13, 1056
    v_mad_u32_u16 v237, v237, s15, v243
    buffer_load_dwordx4 v237, s[40:43], 0 offen lds
    s_add_u32 m0, s13, 2112
    v_mad_u32_u16 v238, v238, s15, v243
    buffer_load_dwordx4 v238, s[40:43], 0 offen lds
    s_add_u32 m0, s13, 3168
    v_mad_u32_u16 v239, v239, s15, v243
    buffer_load_dwordx4 v239, s[40:43], 0 offen lds
    s_mov_b32 m0, s14
    v_and_b32 v240, 0xfffff, v240
    buffer_load_dwordx4 v[240:241], s[44:47], 0 idxen offen lds
L_LATE0:
    s_lshl_b32 s34, s22, 5
    s_lshl_b32 s35, s23, 5
    s_mov_b32 vcc_lo, 0xff00ff00
    s_mov_b32 vcc_hi, 0xff00ff00
    v_mov_b32 v176, s35
    v_mov_b32 v177, s34
    v_cndmask_b32 v176, v176, v177, vcc
    v_and_b32 v177, 4, v253
    v_lshlrev_b32 v177, 6, v177
    v_lshl_add_u32 v177, v246, 2, v177
    v_sub_u32 v177, v177, v176
    v_and_b32 v178, 48, v253
    s_movk_i32 s34, 832
    v_mad_u32_u24 v178, v246, s34, v178
    s_mov_b32 s34, 116736
    v_add3_u32 v178, v178, v176, s34
    v_and_b32 v176, 0x1ff, v177
    v_add_u32 v176, v176, v178
    ds_read_b128 v[160:163], v176 offset:0
    ds_read_b128 v[164:167], v176 offset:64
    v_add_u32 v177, 0x80, v177
    v_and_b32 v176, 0x1ff, v177
    v_add_u32 v176, v176, v178
    ds_read_b128 v[168:171], v176 offset:0
    ds_read_b128 v[172:175], v176 offset:64
    s_mov_b32 s34, 0xbfb8aa3b
    s_mov_b32 s35, s34
    s_waitcnt lgkmcnt(3)
    v_mfma_f32_16x16x32_bf16 v[204:207], v[160:163], v[96:99], 0
    v_mfma_f32_16x16x32_bf16 v[212:215], v[160:163], v[104:107], 0
    v_mfma_f32_16x16x32_bf16 v[220:223], v[160:163], v[112:115], 0
    v_mfma_f32_16x16x32_bf16 v[228:231], v[160:163], v[120:123], 0
    s_waitcnt lgkmcnt(2)
    v_mfma_f32_16x16x32_bf16 v[204:207], v[164:167], v[100:103], v[204:207]
    v_mfma_f32_16x16x32_bf16 v[212:215], v[164:167], v[108:111], v[212:215]
    v_mfma_f32_16x16x32_bf16 v[220:223], v[164:167], v[116:119], v[220:223]
    v_mfma_f32_16x16x32_bf16 v[228:231], v[164:167], v[124:127], v[228:231]
    s_waitcnt lgkmcnt(1)
    v_mfma_f32_16x16x32_bf16 v[208:211], v[168:171], v[96:99], 0
    v_mfma_f32_16x16x32_bf16 v[216:219], v[168:171], v[104:107], 0
    v_mfma_f32_16x16x32_bf16 v[224:227], v[168:171], v[112:115], 0
    v_mfma_f32_16x16x32_bf16 v[232:235], v[168:171], v[120:123], 0
    s_waitcnt lgkmcnt(0)
    v_mfma_f32_16x16x32_bf16 v[208:211], v[172:175], v[100:103], v[208:211]
    v_mfma_f32_16x16x32_bf16 v[216:219], v[172:175], v[108:111], v[216:219]
    v_mfma_f32_16x16x32_bf16 v[224:227], v[172:175], v[116:119], v[224:227]
    v_mfma_f32_16x16x32_bf16 v[232:235], v[172:175], v[124:127], v[232:235]
    s_mov_b32 s11, s10
    v_mov_b32 v189, s10
    v_mov_b64 v[96:97], s[10:11]
    v_mov_b64 v[98:99], s[10:11]
    v_mov_b64 v[100:101], s[10:11]
    v_mov_b64 v[102:103], s[10:11]
    v_mov_b64 v[104:105], s[10:11]
    v_mov_b64 v[106:107], s[10:11]
    v_mov_b64 v[108:109], s[10:11]
    v_mov_b64 v[110:111], s[10:11]
    v_cmp_ne_u32 vcc, 0, v188
    v_mov_b64 v[112:113], 0
    v_mov_b64 v[114:115], 0
    v_cndmask_b32 v128, 0, v189, vcc
    v_cmp_ne_u32 vcc, -1, v188
    v_mov_b64 v[116:117], 0
    v_mov_b64 v[118:119], 0
    v_cndmask_b32 v129, 0, v189, vcc
    v_cmp_ne_u32 vcc, -2, v188
    v_mov_b64 v[120:121], 0
    v_mov_b64 v[122:123], 0
    v_cndmask_b32 v130, 0, v189, vcc
    v_cmp_ne_u32 vcc, -3, v188
    v_mov_b64 v[124:125], 0
    v_mov_b64 v[126:127], 0
    v_cndmask_b32 v131, 0, v189, vcc
    v_mov_b64 v[144:145], 0
    v_mov_b64 v[146:147], 0
    v_mov_b64 v[148:149], 0
    v_mov_b64 v[150:151], 0
    v_mov_b64 v[152:153], 0
    v_mov_b64 v[154:155], 0
    v_mov_b64 v[156:157], 0
    v_mov_b64 v[158:159], 0
    v_mov_b64 v[132:133], v[128:129]
    v_mov_b64 v[134:135], v[130:131]
    v_mov_b64 v[136:137], v[128:129]
    v_mov_b64 v[138:139], v[130:131]
    v_mov_b64 v[140:141], v[128:129]
    v_mov_b64 v[142:143], v[130:131]
    v_pk_mul_f32 v[204:205], v[204:205], s[34:35]
    v_pk_mul_f32 v[206:207], v[206:207], s[34:35]
    v_pk_mul_f32 v[208:209], v[208:209], s[34:35]
    v_pk_mul_f32 v[210:211], v[210:211], s[34:35]
    v_pk_mul_f32 v[212:213], v[212:213], s[34:35]
    v_pk_mul_f32 v[214:215], v[214:215], s[34:35]
    v_pk_mul_f32 v[216:217], v[216:217], s[34:35]
    v_pk_mul_f32 v[218:219], v[218:219], s[34:35]
    v_pk_mul_f32 v[220:221], v[220:221], s[34:35]
    v_pk_mul_f32 v[222:223], v[222:223], s[34:35]
    v_pk_mul_f32 v[224:225], v[224:225], s[34:35]
    v_pk_mul_f32 v[226:227], v[226:227], s[34:35]
    v_pk_mul_f32 v[228:229], v[228:229], s[34:35]
    v_pk_mul_f32 v[230:231], v[230:231], s[34:35]
    v_pk_mul_f32 v[232:233], v[232:233], s[34:35]
    v_pk_mul_f32 v[234:235], v[234:235], s[34:35]
    v_cvt_pk_bf16_f32 v64, v204, v205
    v_cvt_pk_bf16_f32 v65, v206, v207
    v_cvt_pk_bf16_f32 v66, v208, v209
    v_cvt_pk_bf16_f32 v67, v210, v211
    v_cvt_pk_bf16_f32 v68, v212, v213
    v_cvt_pk_bf16_f32 v69, v214, v215
    v_cvt_pk_bf16_f32 v70, v216, v217
    v_cvt_pk_bf16_f32 v71, v218, v219
    v_cvt_pk_bf16_f32 v72, v220, v221
    v_cvt_pk_bf16_f32 v73, v222, v223
    v_cvt_pk_bf16_f32 v74, v224, v225
    v_cvt_pk_bf16_f32 v75, v226, v227
    v_cvt_pk_bf16_f32 v76, v228, v229
    v_cvt_pk_bf16_f32 v77, v230, v231
    v_cvt_pk_bf16_f32 v78, v232, v233
    v_cvt_pk_bf16_f32 v79, v234, v235
    v_permlane32_swap_b32 v80, v64
    v_permlane32_swap_b32 v81, v65
    v_permlane32_swap_b32 v82, v66
    v_permlane32_swap_b32 v83, v67
    v_permlane32_swap_b32 v84, v68
    v_permlane32_swap_b32 v85, v69
    v_permlane32_swap_b32 v86, v70
    v_permlane32_swap_b32 v87, v71
    v_permlane32_swap_b32 v88, v72
    v_permlane32_swap_b32 v89, v73
    v_permlane32_swap_b32 v90, v74
    v_permlane32_swap_b32 v91, v75
    v_permlane32_swap_b32 v92, v76
    v_permlane32_swap_b32 v93, v77
    v_permlane32_swap_b32 v94, v78
    v_permlane32_swap_b32 v95, v79
    s_mov_b32 s26, -1
    s_mov_b64 s[32:33], 0
    s_mov_b32 s28, 0
    s_mov_b32 s29, 0
    s_cmp_lt_u32 s3, 4
    s_cbranch_scc1 L_HAD0
    s_add_u32 m0, s13, 0
    v_mad_u32_u16 v236, v236, s15, v243
    buffer_load_dwordx4 v236, s[40:43], 0 offen lds
    s_add_u32 m0, s13, 1056
    v_mad_u32_u16 v237, v237, s15, v243
    buffer_load_dwordx4 v237, s[40:43], 0 offen lds
    s_add_u32 m0, s13, 2112
    v_mad_u32_u16 v238, v238, s15, v243
    buffer_load_dwordx4 v238, s[40:43], 0 offen lds
    s_add_u32 m0, s13, 3168
    v_mad_u32_u16 v239, v239, s15, v243
    buffer_load_dwordx4 v239, s[40:43], 0 offen lds
    s_mov_b32 m0, s14
    v_and_b32 v240, 0xfffff, v240
    buffer_load_dwordx4 v[240:241], s[44:47], 0 idxen offen lds
    s_lshl_b32 s72, s4, 7
    s_add_u32 s72, s72, 156800
    v_mov_b32 v190, s22
    s_mov_b32 exec_lo, 0xffff0000
    v_mov_b32 v190, s23
    s_mov_b32 exec_lo, -1
    s_mov_b32 exec_hi, 0
    v_sub_u32 v191, v253, v190
    v_and_b32 v191, 15, v191
    v_add_lshl_u32 v191, v191, v190, 5
    v_lshl_add_u32 v190, v253, 2, s72
    ds_write_b32 v190, v191
    s_mov_b32 exec_hi, -1
    s_mul_i32 s10, s5, 196
    s_add_u32 s11, s10, s7
    s_add_u32 s62, s10, s9
    s_min_u32 s11, s11, 50000
    s_min_u32 s62, s62, 50000
    s_sub_u32 s62, s62, s11
    s_lshl_b32 s11, s11, 7
    s_lshl_b32 s62, s62, 7
    s_add_u32 s60, s48, s11
    s_addc_u32 s61, s49, 0
    s_mul_i32 s74, s7, -128
    s_add_u32 s11, s10, s8
    s_add_u32 s50, s10, s24
    s_min_u32 s11, s11, 50000
    s_min_u32 s50, s50, 50000
    s_sub_u32 s50, s50, s11
    s_lshl_b32 s11, s11, 7
    s_lshl_b32 s50, s50, 7
    s_add_u32 s48, s48, s11
    s_addc_u32 s49, s49, 0
    s_mul_i32 s73, s8, -128
    s_and_b32 s10, s25, 12
    s_lshl_b32 s10, s10, 2
    s_bfm_b64 s[76:77], 16, s10
L_HAD0:
    s_cmp_eq_u32 s30, 0
    s_cbranch_scc1 L_GO
    s_lshl_b32 s10, s4, 3
    v_mov_b32 v188, s10
    ds_read_b64 v[188:189], v188 offset:576
    s_waitcnt lgkmcnt(0)
    v_readfirstlane_b32 s34, v188
    v_readfirstlane_b32 s35, v189
    s_sub_u32 s10, s12, 37888
    s_sub_u32 s34, s34, s10
    s_sub_u32 s35, s35, s10
    s_sub_u32 s35, s35, 1152
    s_add_u32 s10, s34, 127
    s_lshr_b32 s10, s10, 7
    s_lshl1_add_u32 s10, s10, -1
    s_add_u32 s11, s35, 127
    s_lshr_b32 s11, s11, 6
    s_and_b32 s11, s11, -2
    s_max_i32 s17, s10, s11
    s_cselect_b32 s10, s34, s35
    s_sub_u32 s10, s10, 1
    s_andn2_b32 s99, 64, s10
L_GO:
    ds_read_u16 v251, v249 offset:0
    ds_read_u16 v252, v249 offset:64
    ds_read_b128 v[236:239], v247 offset:1152
    ds_read_b32 v240, v248 offset:1152
    s_lshr_b32 s10, s4, 1
    s_lshl_b32 s10, s10, 8
    s_add_u32 s10, s10, 155776
    v_lshl_add_u32 v255, v253, 2, s10
    s_bitcmp1_b32 s4, 0
    s_cselect_b32 s101, -1, 1
    s_max_i32 s10, s17, 1
    s_sub_u32 s10, s10, 1
    s_mul_i32 s10, s101, s10
    s_lshl_b32 s10, s10, 24
    v_mov_b32 v204, s10
    ds_add_u32 v255, v204
    v_mov_b32 v253, 0
    s_mov_b32 exec_hi, 0
    v_add_u32 v253, 0x200, v245
    s_mov_b32 exec_hi, -1
    v_mov_b64 v[204:205], 0
    v_mov_b64 v[206:207], 0
    v_mov_b64 v[208:209], 0
    v_mov_b64 v[210:211], 0
    v_mov_b64 v[212:213], 0
    v_mov_b64 v[214:215], 0
    v_mov_b64 v[216:217], 0
    v_mov_b64 v[218:219], 0
    v_mov_b64 v[220:221], 0
    v_mov_b64 v[222:223], 0
    v_mov_b64 v[224:225], 0
    v_mov_b64 v[226:227], 0
    v_mov_b64 v[228:229], 0
    v_mov_b64 v[230:231], 0
    v_mov_b64 v[232:233], 0
    v_mov_b64 v[234:235], 0
    v_mov_b64 v[184:185], 0
    v_mov_b64 v[186:187], 0
    s_waitcnt lgkmcnt(0)
    v_bfi_b32 v251, 31, v245, v251
    v_bfi_b32 v252, 31, v245, v252
    v_max_u32 v251, v251, v245
    v_max_u32 v252, v252, v253
    s_waitcnt vmcnt(0)
    ds_read_b128 v[176:179], v251
    ds_read_b128 v[180:183], v252
    ds_read_b128 v[160:163], v244 offset:0
    ds_read_b128 v[168:171], v244 offset:512
    ds_read_b128 v[164:167], v244 offset:64
    ds_read_b128 v[172:175], v244 offset:576
    s_cmp_lt_i32 s17, 1
    s_cbranch_scc1 L_DONE
    s_waitcnt lgkmcnt(4)
    v_mfma_f32_16x16x32_bf16 v[188:191], v[176:179], v[64:67], 0
    v_mfma_f32_16x16x32_bf16 v[196:199], v[176:179], v[68:71], 0
    v_mfma_f32_16x16x32_bf16 v[192:195], v[180:183], v[64:67], 0
    v_mfma_f32_16x16x32_bf16 v[200:203], v[180:183], v[68:71], 0
    s_waitcnt lgkmcnt(0)
    v_mfma_f32_16x16x32_bf16 v[188:191], v[160:163], v[0:3], v[188:191]
    v_mfma_f32_16x16x32_bf16 v[196:199], v[160:163], v[8:11], v[196:199]
    v_mfma_f32_16x16x32_bf16 v[192:195], v[168:171], v[0:3], v[192:195]
    v_mfma_f32_16x16x32_bf16 v[200:203], v[168:171], v[8:11], v[200:203]
    v_mfma_f32_16x16x32_bf16 v[188:191], v[164:167], v[4:7], v[188:191]
    v_mfma_f32_16x16x32_bf16 v[196:199], v[164:167], v[12:15], v[196:199]
    v_mfma_f32_16x16x32_bf16 v[192:195], v[172:175], v[4:7], v[192:195]
    v_mfma_f32_16x16x32_bf16 v[200:203], v[172:175], v[12:15], v[200:203]
    s_mov_b32 s16, 1
    s_cmp_eq_u32 s17, 1
    s_cbranch_scc1 L_LT0
    s_add_u32 m0, s13, 0
    v_mad_u32_u16 v236, v236, s15, v243
    buffer_load_dwordx4 v236, s[40:43], 0 offen lds
    s_add_u32 m0, s13, 1056
    v_mad_u32_u16 v237, v237, s15, v243
    buffer_load_dwordx4 v237, s[40:43], 0 offen lds
    s_add_u32 m0, s13, 2112
    v_mad_u32_u16 v238, v238, s15, v243
    buffer_load_dwordx4 v238, s[40:43], 0 offen lds
    s_add_u32 m0, s13, 3168
    v_mad_u32_u16 v239, v239, s15, v243
    buffer_load_dwordx4 v239, s[40:43], 0 offen lds
    s_mov_b32 m0, s14
    v_and_b32 v240, 0xfffff, v240
    buffer_load_dwordx4 v[240:241], s[44:47], 0 idxen offen lds
.p2align 6
L_LOOP1:
    s_setprio 1
    v_smfmac_f32_16x16x64_bf16 v[152:155], v[184:187], v[204:211], v242
    ds_read_u16 v236, v250 offset:0
    ds_read_u16 v237, v250 offset:16
    ds_add_rtn_u32 v238, v255, v242
    v_exp_f32 v188, v188
    v_smfmac_f32_16x16x64_bf16 v[156:159], v[184:187], v[212:219], v242
    v_exp_f32 v189, v189
    v_mfma_f32_16x16x32_bf16 v[204:207], v[160:163], v[32:35], 0
    v_exp_f32 v190, v190
    v_mfma_f32_16x16x32_bf16 v[212:215], v[160:163], v[40:43], 0
    v_exp_f32 v191, v191
    v_mfma_f32_16x16x32_bf16 v[208:211], v[168:171], v[32:35], 0
    v_exp_f32 v192, v192
    v_mfma_f32_16x16x32_bf16 v[216:219], v[168:171], v[40:43], 0
    v_exp_f32 v193, v193
    v_mfma_f32_16x16x32_bf16 v[204:207], v[164:167], v[36:39], v[204:207]
    v_exp_f32 v194, v194
    v_mfma_f32_16x16x32_bf16 v[212:215], v[164:167], v[44:47], v[212:215]
    v_exp_f32 v195, v195
    v_mfma_f32_16x16x32_bf16 v[208:211], v[172:175], v[36:39], v[208:211]
    s_waitcnt lgkmcnt(0)
    v_bfi_b32 v236, 31, v246, v236
    v_bfi_b32 v237, 31, v246, v237
    v_readfirstlane_b32 s96, v238
    v_exp_f32 v196, v196
    v_mfma_f32_16x16x32_bf16 v[216:219], v[172:175], v[44:47], v[216:219]
    v_exp_f32 v197, v197
    s_setprio 3
    v_smfmac_f32_16x16x64_bf16 v[136:139], v[184:187], v[220:227], v242
    v_exp_f32 v198, v198
    v_smfmac_f32_16x16x64_bf16 v[140:143], v[184:187], v[228:235], v242
    v_exp_f32 v199, v199
    v_exp_f32 v200, v200
    v_exp_f32 v201, v201
    v_exp_f32 v202, v202
    v_exp_f32 v203, v203
    v_pk_add_f32 v[188:189], v[188:189], 1.0 op_sel_hi:[1,0]
    v_pk_add_f32 v[190:191], v[190:191], 1.0 op_sel_hi:[1,0]
    v_pk_add_f32 v[192:193], v[192:193], 1.0 op_sel_hi:[1,0]
    v_pk_add_f32 v[194:195], v[194:195], 1.0 op_sel_hi:[1,0]
    v_pk_add_f32 v[196:197], v[196:197], 1.0 op_sel_hi:[1,0]
    v_pk_add_f32 v[198:199], v[198:199], 1.0 op_sel_hi:[1,0]
    v_pk_add_f32 v[200:201], v[200:201], 1.0 op_sel_hi:[1,0]
    v_pk_add_f32 v[202:203], v[202:203], 1.0 op_sel_hi:[1,0]
    s_setprio 1
    v_mfma_f32_16x16x32_bf16 v[220:223], v[176:179], v[72:75], 0
    ds_read_b64_tr_b16 v[184:185], v236
    ds_read_b64_tr_b16 v[186:187], v237
    ds_read_u16 v251, v249 offset:1152
    ds_read_u16 v252, v249 offset:1216
    v_rcp_f32 v188, v188
    v_mfma_f32_16x16x32_bf16 v[228:231], v[176:179], v[76:79], 0
    s_ashr_i32 s96, s96, 24
    s_mul_i32 s96, s96, s101
    v_rcp_f32 v189, v189
    v_mfma_f32_16x16x32_bf16 v[224:227], v[180:183], v[72:75], 0
    v_rcp_f32 v190, v190
    v_mfma_f32_16x16x32_bf16 v[232:235], v[180:183], v[76:79], 0
    v_rcp_f32 v191, v191
    v_mfma_f32_16x16x32_bf16 v[220:223], v[160:163], v[16:19], v[220:223]
    v_rcp_f32 v192, v192
    v_mfma_f32_16x16x32_bf16 v[228:231], v[160:163], v[24:27], v[228:231]
    v_rcp_f32 v193, v193
    v_mfma_f32_16x16x32_bf16 v[224:227], v[168:171], v[16:19], v[224:227]
    s_waitcnt lgkmcnt(0)
    v_bfi_b32 v251, 31, v245, v251
    v_bfi_b32 v252, 31, v245, v252
    v_max_u32 v251, v251, v245
    v_max_u32 v252, v252, v253
    ds_read_b128 v[236:239], v247 offset:128
    ds_read_b32 v240, v248 offset:128
    s_add_u32 s16, s16, 1
    v_rcp_f32 v194, v194
    v_mfma_f32_16x16x32_bf16 v[232:235], v[168:171], v[24:27], v[232:235]
    v_rcp_f32 v195, v195
    v_mfma_f32_16x16x32_bf16 v[220:223], v[164:167], v[20:23], v[220:223]
    v_rcp_f32 v196, v196
    v_mfma_f32_16x16x32_bf16 v[228:231], v[164:167], v[28:31], v[228:231]
    v_rcp_f32 v197, v197
    s_setprio 3
    v_mfma_f32_16x16x32_bf16 v[224:227], v[172:175], v[20:23], v[224:227]
    v_rcp_f32 v198, v198
    v_mfma_f32_16x16x32_bf16 v[232:235], v[172:175], v[28:31], v[232:235]
    v_rcp_f32 v199, v199
    v_rcp_f32 v200, v200
    v_rcp_f32 v201, v201
    v_rcp_f32 v202, v202
    v_rcp_f32 v203, v203
    v_pk_mul_f32 v[204:205], v[188:189], v[204:205]
    v_pk_mul_f32 v[206:207], v[190:191], v[206:207]
    v_pk_mul_f32 v[208:209], v[192:193], v[208:209]
    v_pk_mul_f32 v[210:211], v[194:195], v[210:211]
    v_pk_mul_f32 v[212:213], v[196:197], v[212:213]
    v_pk_mul_f32 v[214:215], v[198:199], v[214:215]
    v_pk_mul_f32 v[216:217], v[200:201], v[216:217]
    v_pk_mul_f32 v[218:219], v[202:203], v[218:219]
    s_cmp_ge_i32 s96, 1
    s_cbranch_scc0 L_PB00
L_PB01:
    s_setprio 1
    v_smfmac_f32_16x16x64_bf16 v[112:115], v[184:187], v[204:211], v242
    v_exp_f32 v220, v220
    v_smfmac_f32_16x16x64_bf16 v[116:119], v[184:187], v[212:219], v242
    v_exp_f32 v221, v221
    s_waitcnt vmcnt(0)
    ds_read_b128 v[176:179], v251
    ds_read_b128 v[180:183], v252
    v_mfma_f32_16x16x32_bf16 v[204:207], v[160:163], v[48:51], 0
    v_exp_f32 v222, v222
    v_mfma_f32_16x16x32_bf16 v[212:215], v[160:163], v[56:59], 0
    ds_read_b128 v[160:163], v244 offset:0
    v_exp_f32 v223, v223
    v_mfma_f32_16x16x32_bf16 v[208:211], v[168:171], v[48:51], 0
    v_exp_f32 v224, v224
    v_mfma_f32_16x16x32_bf16 v[216:219], v[168:171], v[56:59], 0
    ds_read_b128 v[168:171], v244 offset:512
    v_exp_f32 v225, v225
    v_mfma_f32_16x16x32_bf16 v[204:207], v[164:167], v[52:55], v[204:207]
    v_exp_f32 v226, v226
    v_mfma_f32_16x16x32_bf16 v[212:215], v[164:167], v[60:63], v[212:215]
    ds_read_b128 v[164:167], v244 offset:64
    v_exp_f32 v227, v227
    v_mfma_f32_16x16x32_bf16 v[208:211], v[172:175], v[52:55], v[208:211]
    v_exp_f32 v228, v228
    v_mfma_f32_16x16x32_bf16 v[216:219], v[172:175], v[60:63], v[216:219]
    ds_read_b128 v[172:175], v244 offset:576
    v_exp_f32 v229, v229
    s_setprio 3
    v_smfmac_f32_16x16x64_bf16 v[96:99], v[184:187], v[188:195], v242
    v_exp_f32 v230, v230
    v_smfmac_f32_16x16x64_bf16 v[100:103], v[184:187], v[196:203], v242
    v_exp_f32 v231, v231
    v_exp_f32 v232, v232
    v_exp_f32 v233, v233
    v_exp_f32 v234, v234
    v_exp_f32 v235, v235
    v_pk_add_f32 v[220:221], v[220:221], 1.0 op_sel_hi:[1,0]
    v_pk_add_f32 v[222:223], v[222:223], 1.0 op_sel_hi:[1,0]
    v_pk_add_f32 v[224:225], v[224:225], 1.0 op_sel_hi:[1,0]
    v_pk_add_f32 v[226:227], v[226:227], 1.0 op_sel_hi:[1,0]
    v_pk_add_f32 v[228:229], v[228:229], 1.0 op_sel_hi:[1,0]
    v_pk_add_f32 v[230:231], v[230:231], 1.0 op_sel_hi:[1,0]
    v_pk_add_f32 v[232:233], v[232:233], 1.0 op_sel_hi:[1,0]
    v_pk_add_f32 v[234:235], v[234:235], 1.0 op_sel_hi:[1,0]
    s_setprio 1
    s_waitcnt lgkmcnt(4)
    v_mfma_f32_16x16x32_bf16 v[188:191], v[176:179], v[80:83], 0
    v_rcp_f32 v220, v220
    v_mfma_f32_16x16x32_bf16 v[196:199], v[176:179], v[84:87], 0
    v_rcp_f32 v221, v221
    v_mfma_f32_16x16x32_bf16 v[192:195], v[180:183], v[80:83], 0
    v_rcp_f32 v222, v222
    v_mfma_f32_16x16x32_bf16 v[200:203], v[180:183], v[84:87], 0
    v_rcp_f32 v223, v223
    s_waitcnt lgkmcnt(3)
    v_mfma_f32_16x16x32_bf16 v[188:191], v[160:163], v[0:3], v[188:191]
    v_rcp_f32 v224, v224
    v_mfma_f32_16x16x32_bf16 v[196:199], v[160:163], v[8:11], v[196:199]
    v_rcp_f32 v225, v225
    s_waitcnt lgkmcnt(2)
    v_mfma_f32_16x16x32_bf16 v[192:195], v[168:171], v[0:3], v[192:195]
    v_rcp_f32 v226, v226
    v_mfma_f32_16x16x32_bf16 v[200:203], v[168:171], v[8:11], v[200:203]
    v_rcp_f32 v227, v227
    s_waitcnt lgkmcnt(1)
    v_mfma_f32_16x16x32_bf16 v[188:191], v[164:167], v[4:7], v[188:191]
    v_rcp_f32 v228, v228
    v_mfma_f32_16x16x32_bf16 v[196:199], v[164:167], v[12:15], v[196:199]
    v_rcp_f32 v229, v229
    s_setprio 3
    s_waitcnt lgkmcnt(0)
    v_mfma_f32_16x16x32_bf16 v[192:195], v[172:175], v[4:7], v[192:195]
    s_cmp_lt_u32 s16, s17
    s_cbranch_scc0 L_ND01
    s_add_u32 m0, s13, 0
    v_mad_u32_u16 v236, v236, s15, v243
    buffer_load_dwordx4 v236, s[40:43], 0 offen lds
    s_add_u32 m0, s13, 1056
    v_mad_u32_u16 v237, v237, s15, v243
    buffer_load_dwordx4 v237, s[40:43], 0 offen lds
    s_add_u32 m0, s13, 2112
    v_mad_u32_u16 v238, v238, s15, v243
    buffer_load_dwordx4 v238, s[40:43], 0 offen lds
    s_add_u32 m0, s13, 3168
    v_mad_u32_u16 v239, v239, s15, v243
    buffer_load_dwordx4 v239, s[40:43], 0 offen lds
    s_mov_b32 m0, s14
    v_and_b32 v240, 0xfffff, v240
    buffer_load_dwordx4 v[240:241], s[44:47], 0 idxen offen lds
L_ND01:
    v_rcp_f32 v230, v230
    v_mfma_f32_16x16x32_bf16 v[200:203], v[172:175], v[12:15], v[200:203]
    v_rcp_f32 v231, v231
    v_rcp_f32 v232, v232
    v_rcp_f32 v233, v233
    v_rcp_f32 v234, v234
    v_rcp_f32 v235, v235
    v_pk_mul_f32 v[204:205], v[220:221], v[204:205]
    v_pk_mul_f32 v[206:207], v[222:223], v[206:207]
    v_pk_mul_f32 v[208:209], v[224:225], v[208:209]
    v_pk_mul_f32 v[210:211], v[226:227], v[210:211]
    v_pk_mul_f32 v[212:213], v[228:229], v[212:213]
    v_pk_mul_f32 v[214:215], v[230:231], v[214:215]
    v_pk_mul_f32 v[216:217], v[232:233], v[216:217]
    v_pk_mul_f32 v[218:219], v[234:235], v[218:219]
    s_cmp_ge_u32 s16, s17
    s_cbranch_scc1 L_LT1
    s_setprio 1
    v_smfmac_f32_16x16x64_bf16 v[120:123], v[184:187], v[204:211], v242
    ds_read_u16 v236, v250 offset:1152
    ds_read_u16 v237, v250 offset:1168
    ds_add_rtn_u32 v238, v255, v242
    v_exp_f32 v188, v188
    v_smfmac_f32_16x16x64_bf16 v[124:127], v[184:187], v[212:219], v242
    v_exp_f32 v189, v189
    v_mfma_f32_16x16x32_bf16 v[204:207], v[160:163], v[32:35], 0
    v_exp_f32 v190, v190
    v_mfma_f32_16x16x32_bf16 v[212:215], v[160:163], v[40:43], 0
    v_exp_f32 v191, v191
    v_mfma_f32_16x16x32_bf16 v[208:211], v[168:171], v[32:35], 0
    v_exp_f32 v192, v192
    v_mfma_f32_16x16x32_bf16 v[216:219], v[168:171], v[40:43], 0
    v_exp_f32 v193, v193
    v_mfma_f32_16x16x32_bf16 v[204:207], v[164:167], v[36:39], v[204:207]
    v_exp_f32 v194, v194
    v_mfma_f32_16x16x32_bf16 v[212:215], v[164:167], v[44:47], v[212:215]
    v_exp_f32 v195, v195
    v_mfma_f32_16x16x32_bf16 v[208:211], v[172:175], v[36:39], v[208:211]
    s_waitcnt lgkmcnt(0)
    v_bfi_b32 v236, 31, v246, v236
    v_bfi_b32 v237, 31, v246, v237
    v_readfirstlane_b32 s96, v238
    v_exp_f32 v196, v196
    v_mfma_f32_16x16x32_bf16 v[216:219], v[172:175], v[44:47], v[216:219]
    v_exp_f32 v197, v197
    s_setprio 3
    v_smfmac_f32_16x16x64_bf16 v[104:107], v[184:187], v[220:227], v242
    v_exp_f32 v198, v198
    v_smfmac_f32_16x16x64_bf16 v[108:111], v[184:187], v[228:235], v242
    v_exp_f32 v199, v199
    v_exp_f32 v200, v200
    v_exp_f32 v201, v201
    v_exp_f32 v202, v202
    v_exp_f32 v203, v203
    v_pk_add_f32 v[188:189], v[188:189], 1.0 op_sel_hi:[1,0]
    v_pk_add_f32 v[190:191], v[190:191], 1.0 op_sel_hi:[1,0]
    v_pk_add_f32 v[192:193], v[192:193], 1.0 op_sel_hi:[1,0]
    v_pk_add_f32 v[194:195], v[194:195], 1.0 op_sel_hi:[1,0]
    v_pk_add_f32 v[196:197], v[196:197], 1.0 op_sel_hi:[1,0]
    v_pk_add_f32 v[198:199], v[198:199], 1.0 op_sel_hi:[1,0]
    v_pk_add_f32 v[200:201], v[200:201], 1.0 op_sel_hi:[1,0]
    v_pk_add_f32 v[202:203], v[202:203], 1.0 op_sel_hi:[1,0]
    s_setprio 1
    v_mfma_f32_16x16x32_bf16 v[220:223], v[176:179], v[88:91], 0
    ds_read_b64_tr_b16 v[184:185], v236
    ds_read_b64_tr_b16 v[186:187], v237
    ds_read_u16 v251, v249 offset:128
    ds_read_u16 v252, v249 offset:192
    v_rcp_f32 v188, v188
    v_mfma_f32_16x16x32_bf16 v[228:231], v[176:179], v[92:95], 0
    s_ashr_i32 s96, s96, 24
    s_mul_i32 s96, s96, s101
    v_rcp_f32 v189, v189
    v_mfma_f32_16x16x32_bf16 v[224:227], v[180:183], v[88:91], 0
    v_rcp_f32 v190, v190
    v_mfma_f32_16x16x32_bf16 v[232:235], v[180:183], v[92:95], 0
    v_rcp_f32 v191, v191
    v_mfma_f32_16x16x32_bf16 v[220:223], v[160:163], v[16:19], v[220:223]
    v_rcp_f32 v192, v192
    v_mfma_f32_16x16x32_bf16 v[228:231], v[160:163], v[24:27], v[228:231]
    v_rcp_f32 v193, v193
    v_mfma_f32_16x16x32_bf16 v[224:227], v[168:171], v[16:19], v[224:227]
    s_waitcnt lgkmcnt(0)
    v_bfi_b32 v251, 31, v245, v251
    v_bfi_b32 v252, 31, v245, v252
    v_max_u32 v251, v251, v245
    v_max_u32 v252, v252, v253
    ds_read_b128 v[236:239], v247 offset:1280
    ds_read_b32 v240, v248 offset:1280
    s_add_u32 s16, s16, 1
    v_rcp_f32 v194, v194
    v_mfma_f32_16x16x32_bf16 v[232:235], v[168:171], v[24:27], v[232:235]
    v_add_u32 v247, 0x80, v247
    v_add_u32 v248, 0x80, v248
    v_add_u32 v249, 0x80, v249
    v_add_u32 v250, 0x80, v250
    v_rcp_f32 v195, v195
    v_mfma_f32_16x16x32_bf16 v[220:223], v[164:167], v[20:23], v[220:223]
    v_rcp_f32 v196, v196
    v_mfma_f32_16x16x32_bf16 v[228:231], v[164:167], v[28:31], v[228:231]
    v_rcp_f32 v197, v197
    s_setprio 3
    v_mfma_f32_16x16x32_bf16 v[224:227], v[172:175], v[20:23], v[224:227]
    v_rcp_f32 v198, v198
    v_mfma_f32_16x16x32_bf16 v[232:235], v[172:175], v[28:31], v[232:235]
    v_rcp_f32 v199, v199
    v_rcp_f32 v200, v200
    v_rcp_f32 v201, v201
    v_rcp_f32 v202, v202
    v_rcp_f32 v203, v203
    v_pk_mul_f32 v[204:205], v[188:189], v[204:205]
    v_pk_mul_f32 v[206:207], v[190:191], v[206:207]
    v_pk_mul_f32 v[208:209], v[192:193], v[208:209]
    v_pk_mul_f32 v[210:211], v[194:195], v[210:211]
    v_pk_mul_f32 v[212:213], v[196:197], v[212:213]
    v_pk_mul_f32 v[214:215], v[198:199], v[214:215]
    v_pk_mul_f32 v[216:217], v[200:201], v[216:217]
    v_pk_mul_f32 v[218:219], v[202:203], v[218:219]
    s_cmp_ge_i32 s96, 1
    s_cbranch_scc0 L_PB10
L_PB11:
    s_setprio 1
    v_smfmac_f32_16x16x64_bf16 v[144:147], v[184:187], v[204:211], v242
    v_exp_f32 v220, v220
    v_smfmac_f32_16x16x64_bf16 v[148:151], v[184:187], v[212:219], v242
    v_exp_f32 v221, v221
    s_waitcnt vmcnt(0)
    ds_read_b128 v[176:179], v251
    ds_read_b128 v[180:183], v252
    v_mfma_f32_16x16x32_bf16 v[204:207], v[160:163], v[48:51], 0
    v_exp_f32 v222, v222
    v_mfma_f32_16x16x32_bf16 v[212:215], v[160:163], v[56:59], 0
    ds_read_b128 v[160:163], v244 offset:0
    v_exp_f32 v223, v223
    v_mfma_f32_16x16x32_bf16 v[208:211], v[168:171], v[48:51], 0
    v_exp_f32 v224, v224
    v_mfma_f32_16x16x32_bf16 v[216:219], v[168:171], v[56:59], 0
    ds_read_b128 v[168:171], v244 offset:512
    v_exp_f32 v225, v225
    v_mfma_f32_16x16x32_bf16 v[204:207], v[164:167], v[52:55], v[204:207]
    v_exp_f32 v226, v226
    v_mfma_f32_16x16x32_bf16 v[212:215], v[164:167], v[60:63], v[212:215]
    ds_read_b128 v[164:167], v244 offset:64
    v_exp_f32 v227, v227
    v_mfma_f32_16x16x32_bf16 v[208:211], v[172:175], v[52:55], v[208:211]
    v_exp_f32 v228, v228
    v_mfma_f32_16x16x32_bf16 v[216:219], v[172:175], v[60:63], v[216:219]
    ds_read_b128 v[172:175], v244 offset:576
    v_exp_f32 v229, v229
    s_setprio 3
    v_smfmac_f32_16x16x64_bf16 v[128:131], v[184:187], v[188:195], v242
    v_exp_f32 v230, v230
    v_smfmac_f32_16x16x64_bf16 v[132:135], v[184:187], v[196:203], v242
    v_exp_f32 v231, v231
    v_exp_f32 v232, v232
    v_exp_f32 v233, v233
    v_exp_f32 v234, v234
    v_exp_f32 v235, v235
    v_pk_add_f32 v[220:221], v[220:221], 1.0 op_sel_hi:[1,0]
    v_pk_add_f32 v[222:223], v[222:223], 1.0 op_sel_hi:[1,0]
    v_pk_add_f32 v[224:225], v[224:225], 1.0 op_sel_hi:[1,0]
    v_pk_add_f32 v[226:227], v[226:227], 1.0 op_sel_hi:[1,0]
    v_pk_add_f32 v[228:229], v[228:229], 1.0 op_sel_hi:[1,0]
    v_pk_add_f32 v[230:231], v[230:231], 1.0 op_sel_hi:[1,0]
    v_pk_add_f32 v[232:233], v[232:233], 1.0 op_sel_hi:[1,0]
    v_pk_add_f32 v[234:235], v[234:235], 1.0 op_sel_hi:[1,0]
    s_setprio 1
    s_waitcnt lgkmcnt(4)
    v_mfma_f32_16x16x32_bf16 v[188:191], v[176:179], v[64:67], 0
    v_rcp_f32 v220, v220
    v_mfma_f32_16x16x32_bf16 v[196:199], v[176:179], v[68:71], 0
    v_rcp_f32 v221, v221
    v_mfma_f32_16x16x32_bf16 v[192:195], v[180:183], v[64:67], 0
    v_rcp_f32 v222, v222
    v_mfma_f32_16x16x32_bf16 v[200:203], v[180:183], v[68:71], 0
    v_rcp_f32 v223, v223
    s_waitcnt lgkmcnt(3)
    v_mfma_f32_16x16x32_bf16 v[188:191], v[160:163], v[0:3], v[188:191]
    v_rcp_f32 v224, v224
    v_mfma_f32_16x16x32_bf16 v[196:199], v[160:163], v[8:11], v[196:199]
    v_rcp_f32 v225, v225
    s_waitcnt lgkmcnt(2)
    v_mfma_f32_16x16x32_bf16 v[192:195], v[168:171], v[0:3], v[192:195]
    v_rcp_f32 v226, v226
    v_mfma_f32_16x16x32_bf16 v[200:203], v[168:171], v[8:11], v[200:203]
    v_rcp_f32 v227, v227
    s_waitcnt lgkmcnt(1)
    v_mfma_f32_16x16x32_bf16 v[188:191], v[164:167], v[4:7], v[188:191]
    v_rcp_f32 v228, v228
    v_mfma_f32_16x16x32_bf16 v[196:199], v[164:167], v[12:15], v[196:199]
    v_rcp_f32 v229, v229
    s_setprio 3
    s_waitcnt lgkmcnt(0)
    v_mfma_f32_16x16x32_bf16 v[192:195], v[172:175], v[4:7], v[192:195]
    s_cmp_lt_u32 s16, s17
    s_cbranch_scc0 L_ND11
    s_add_u32 m0, s13, 0
    v_mad_u32_u16 v236, v236, s15, v243
    buffer_load_dwordx4 v236, s[40:43], 0 offen lds
    s_add_u32 m0, s13, 1056
    v_mad_u32_u16 v237, v237, s15, v243
    buffer_load_dwordx4 v237, s[40:43], 0 offen lds
    s_add_u32 m0, s13, 2112
    v_mad_u32_u16 v238, v238, s15, v243
    buffer_load_dwordx4 v238, s[40:43], 0 offen lds
    s_add_u32 m0, s13, 3168
    v_mad_u32_u16 v239, v239, s15, v243
    buffer_load_dwordx4 v239, s[40:43], 0 offen lds
    s_mov_b32 m0, s14
    v_and_b32 v240, 0xfffff, v240
    buffer_load_dwordx4 v[240:241], s[44:47], 0 idxen offen lds
L_ND11:
    v_rcp_f32 v230, v230
    v_mfma_f32_16x16x32_bf16 v[200:203], v[172:175], v[12:15], v[200:203]
    v_rcp_f32 v231, v231
    v_rcp_f32 v232, v232
    v_rcp_f32 v233, v233
    v_rcp_f32 v234, v234
    v_rcp_f32 v235, v235
    v_pk_mul_f32 v[204:205], v[220:221], v[204:205]
    v_pk_mul_f32 v[206:207], v[222:223], v[206:207]
    v_pk_mul_f32 v[208:209], v[224:225], v[208:209]
    v_pk_mul_f32 v[210:211], v[226:227], v[210:211]
    v_pk_mul_f32 v[212:213], v[228:229], v[212:213]
    v_pk_mul_f32 v[214:215], v[230:231], v[214:215]
    v_pk_mul_f32 v[216:217], v[232:233], v[216:217]
    v_pk_mul_f32 v[218:219], v[234:235], v[218:219]
    s_cmp_lt_u32 s16, s17
    s_cbranch_scc1 L_LOOP1
    s_branch L_LT0
.p2align 6
L_LOOP0:
    s_setprio 0
    v_smfmac_f32_16x16x64_bf16 v[152:155], v[184:187], v[204:211], v242
    ds_read_u16 v236, v250 offset:0
    ds_read_u16 v237, v250 offset:16
    ds_add_rtn_u32 v238, v255, v242
    v_exp_f32 v188, v188
    v_smfmac_f32_16x16x64_bf16 v[156:159], v[184:187], v[212:219], v242
    v_exp_f32 v189, v189
    v_mfma_f32_16x16x32_bf16 v[204:207], v[160:163], v[32:35], 0
    v_exp_f32 v190, v190
    v_mfma_f32_16x16x32_bf16 v[212:215], v[160:163], v[40:43], 0
    v_exp_f32 v191, v191
    v_mfma_f32_16x16x32_bf16 v[208:211], v[168:171], v[32:35], 0
    v_exp_f32 v192, v192
    v_mfma_f32_16x16x32_bf16 v[216:219], v[168:171], v[40:43], 0
    v_exp_f32 v193, v193
    v_mfma_f32_16x16x32_bf16 v[204:207], v[164:167], v[36:39], v[204:207]
    v_exp_f32 v194, v194
    v_mfma_f32_16x16x32_bf16 v[212:215], v[164:167], v[44:47], v[212:215]
    v_exp_f32 v195, v195
    v_mfma_f32_16x16x32_bf16 v[208:211], v[172:175], v[36:39], v[208:211]
    s_waitcnt lgkmcnt(0)
    v_bfi_b32 v236, 31, v246, v236
    v_bfi_b32 v237, 31, v246, v237
    v_readfirstlane_b32 s96, v238
    v_exp_f32 v196, v196
    v_mfma_f32_16x16x32_bf16 v[216:219], v[172:175], v[44:47], v[216:219]
    v_exp_f32 v197, v197
    s_setprio 3
    v_smfmac_f32_16x16x64_bf16 v[136:139], v[184:187], v[220:227], v242
    v_exp_f32 v198, v198
    v_smfmac_f32_16x16x64_bf16 v[140:143], v[184:187], v[228:235], v242
    v_exp_f32 v199, v199
    v_exp_f32 v200, v200
    v_exp_f32 v201, v201
    v_exp_f32 v202, v202
    v_exp_f32 v203, v203
    v_pk_add_f32 v[188:189], v[188:189], 1.0 op_sel_hi:[1,0]
    v_pk_add_f32 v[190:191], v[190:191], 1.0 op_sel_hi:[1,0]
    v_pk_add_f32 v[192:193], v[192:193], 1.0 op_sel_hi:[1,0]
    v_pk_add_f32 v[194:195], v[194:195], 1.0 op_sel_hi:[1,0]
    v_pk_add_f32 v[196:197], v[196:197], 1.0 op_sel_hi:[1,0]
    v_pk_add_f32 v[198:199], v[198:199], 1.0 op_sel_hi:[1,0]
    v_pk_add_f32 v[200:201], v[200:201], 1.0 op_sel_hi:[1,0]
    v_pk_add_f32 v[202:203], v[202:203], 1.0 op_sel_hi:[1,0]
    s_setprio 0
    v_mfma_f32_16x16x32_bf16 v[220:223], v[176:179], v[72:75], 0
    ds_read_b64_tr_b16 v[184:185], v236
    ds_read_b64_tr_b16 v[186:187], v237
    ds_read_u16 v251, v249 offset:1152
    ds_read_u16 v252, v249 offset:1216
    v_rcp_f32 v188, v188
    v_mfma_f32_16x16x32_bf16 v[228:231], v[176:179], v[76:79], 0
    s_ashr_i32 s96, s96, 24
    s_mul_i32 s96, s96, s101
    v_rcp_f32 v189, v189
    v_mfma_f32_16x16x32_bf16 v[224:227], v[180:183], v[72:75], 0
    v_rcp_f32 v190, v190
    v_mfma_f32_16x16x32_bf16 v[232:235], v[180:183], v[76:79], 0
    v_rcp_f32 v191, v191
    v_mfma_f32_16x16x32_bf16 v[220:223], v[160:163], v[16:19], v[220:223]
    v_rcp_f32 v192, v192
    v_mfma_f32_16x16x32_bf16 v[228:231], v[160:163], v[24:27], v[228:231]
    v_rcp_f32 v193, v193
    v_mfma_f32_16x16x32_bf16 v[224:227], v[168:171], v[16:19], v[224:227]
    s_waitcnt lgkmcnt(0)
    v_bfi_b32 v251, 31, v245, v251
    v_bfi_b32 v252, 31, v245, v252
    v_max_u32 v251, v251, v245
    v_max_u32 v252, v252, v253
    ds_read_b128 v[236:239], v247 offset:128
    ds_read_b32 v240, v248 offset:128
    s_add_u32 s16, s16, 1
    v_rcp_f32 v194, v194
    v_mfma_f32_16x16x32_bf16 v[232:235], v[168:171], v[24:27], v[232:235]
    v_rcp_f32 v195, v195
    v_mfma_f32_16x16x32_bf16 v[220:223], v[164:167], v[20:23], v[220:223]
    v_rcp_f32 v196, v196
    v_mfma_f32_16x16x32_bf16 v[228:231], v[164:167], v[28:31], v[228:231]
    v_rcp_f32 v197, v197
    s_setprio 3
    v_mfma_f32_16x16x32_bf16 v[224:227], v[172:175], v[20:23], v[224:227]
    v_rcp_f32 v198, v198
    v_mfma_f32_16x16x32_bf16 v[232:235], v[172:175], v[28:31], v[232:235]
    v_rcp_f32 v199, v199
    v_rcp_f32 v200, v200
    v_rcp_f32 v201, v201
    v_rcp_f32 v202, v202
    v_rcp_f32 v203, v203
    v_pk_mul_f32 v[204:205], v[188:189], v[204:205]
    v_pk_mul_f32 v[206:207], v[190:191], v[206:207]
    v_pk_mul_f32 v[208:209], v[192:193], v[208:209]
    v_pk_mul_f32 v[210:211], v[194:195], v[210:211]
    v_pk_mul_f32 v[212:213], v[196:197], v[212:213]
    v_pk_mul_f32 v[214:215], v[198:199], v[214:215]
    v_pk_mul_f32 v[216:217], v[200:201], v[216:217]
    v_pk_mul_f32 v[218:219], v[202:203], v[218:219]
    s_cmp_ge_i32 s96, 1
    s_cbranch_scc1 L_PB01
L_PB00:
    s_setprio 0
    v_smfmac_f32_16x16x64_bf16 v[112:115], v[184:187], v[204:211], v242
    v_exp_f32 v220, v220
    v_smfmac_f32_16x16x64_bf16 v[116:119], v[184:187], v[212:219], v242
    v_exp_f32 v221, v221
    s_waitcnt vmcnt(0)
    ds_read_b128 v[176:179], v251
    ds_read_b128 v[180:183], v252
    v_mfma_f32_16x16x32_bf16 v[204:207], v[160:163], v[48:51], 0
    v_exp_f32 v222, v222
    v_mfma_f32_16x16x32_bf16 v[212:215], v[160:163], v[56:59], 0
    ds_read_b128 v[160:163], v244 offset:0
    v_exp_f32 v223, v223
    v_mfma_f32_16x16x32_bf16 v[208:211], v[168:171], v[48:51], 0
    v_exp_f32 v224, v224
    v_mfma_f32_16x16x32_bf16 v[216:219], v[168:171], v[56:59], 0
    ds_read_b128 v[168:171], v244 offset:512
    v_exp_f32 v225, v225
    v_mfma_f32_16x16x32_bf16 v[204:207], v[164:167], v[52:55], v[204:207]
    v_exp_f32 v226, v226
    v_mfma_f32_16x16x32_bf16 v[212:215], v[164:167], v[60:63], v[212:215]
    ds_read_b128 v[164:167], v244 offset:64
    v_exp_f32 v227, v227
    v_mfma_f32_16x16x32_bf16 v[208:211], v[172:175], v[52:55], v[208:211]
    v_exp_f32 v228, v228
    v_mfma_f32_16x16x32_bf16 v[216:219], v[172:175], v[60:63], v[216:219]
    ds_read_b128 v[172:175], v244 offset:576
    v_exp_f32 v229, v229
    s_setprio 3
    v_smfmac_f32_16x16x64_bf16 v[96:99], v[184:187], v[188:195], v242
    v_exp_f32 v230, v230
    v_smfmac_f32_16x16x64_bf16 v[100:103], v[184:187], v[196:203], v242
    v_exp_f32 v231, v231
    v_exp_f32 v232, v232
    v_exp_f32 v233, v233
    v_exp_f32 v234, v234
    v_exp_f32 v235, v235
    v_pk_add_f32 v[220:221], v[220:221], 1.0 op_sel_hi:[1,0]
    v_pk_add_f32 v[222:223], v[222:223], 1.0 op_sel_hi:[1,0]
    v_pk_add_f32 v[224:225], v[224:225], 1.0 op_sel_hi:[1,0]
    v_pk_add_f32 v[226:227], v[226:227], 1.0 op_sel_hi:[1,0]
    v_pk_add_f32 v[228:229], v[228:229], 1.0 op_sel_hi:[1,0]
    v_pk_add_f32 v[230:231], v[230:231], 1.0 op_sel_hi:[1,0]
    v_pk_add_f32 v[232:233], v[232:233], 1.0 op_sel_hi:[1,0]
    v_pk_add_f32 v[234:235], v[234:235], 1.0 op_sel_hi:[1,0]
    s_setprio 0
    s_waitcnt lgkmcnt(4)
    v_mfma_f32_16x16x32_bf16 v[188:191], v[176:179], v[80:83], 0
    v_rcp_f32 v220, v220
    v_mfma_f32_16x16x32_bf16 v[196:199], v[176:179], v[84:87], 0
    v_rcp_f32 v221, v221
    v_mfma_f32_16x16x32_bf16 v[192:195], v[180:183], v[80:83], 0
    v_rcp_f32 v222, v222
    v_mfma_f32_16x16x32_bf16 v[200:203], v[180:183], v[84:87], 0
    v_rcp_f32 v223, v223
    s_waitcnt lgkmcnt(3)
    v_mfma_f32_16x16x32_bf16 v[188:191], v[160:163], v[0:3], v[188:191]
    v_rcp_f32 v224, v224
    v_mfma_f32_16x16x32_bf16 v[196:199], v[160:163], v[8:11], v[196:199]
    v_rcp_f32 v225, v225
    s_waitcnt lgkmcnt(2)
    v_mfma_f32_16x16x32_bf16 v[192:195], v[168:171], v[0:3], v[192:195]
    v_rcp_f32 v226, v226
    v_mfma_f32_16x16x32_bf16 v[200:203], v[168:171], v[8:11], v[200:203]
    v_rcp_f32 v227, v227
    s_waitcnt lgkmcnt(1)
    v_mfma_f32_16x16x32_bf16 v[188:191], v[164:167], v[4:7], v[188:191]
    v_rcp_f32 v228, v228
    v_mfma_f32_16x16x32_bf16 v[196:199], v[164:167], v[12:15], v[196:199]
    v_rcp_f32 v229, v229
    s_setprio 3
    s_waitcnt lgkmcnt(0)
    v_mfma_f32_16x16x32_bf16 v[192:195], v[172:175], v[4:7], v[192:195]
    s_cmp_lt_u32 s16, s17
    s_cbranch_scc0 L_ND00
    s_add_u32 m0, s13, 0
    v_mad_u32_u16 v236, v236, s15, v243
    buffer_load_dwordx4 v236, s[40:43], 0 offen lds
    s_add_u32 m0, s13, 1056
    v_mad_u32_u16 v237, v237, s15, v243
    buffer_load_dwordx4 v237, s[40:43], 0 offen lds
    s_add_u32 m0, s13, 2112
    v_mad_u32_u16 v238, v238, s15, v243
    buffer_load_dwordx4 v238, s[40:43], 0 offen lds
    s_add_u32 m0, s13, 3168
    v_mad_u32_u16 v239, v239, s15, v243
    buffer_load_dwordx4 v239, s[40:43], 0 offen lds
    s_mov_b32 m0, s14
    v_and_b32 v240, 0xfffff, v240
    buffer_load_dwordx4 v[240:241], s[44:47], 0 idxen offen lds
L_ND00:
    v_rcp_f32 v230, v230
    v_mfma_f32_16x16x32_bf16 v[200:203], v[172:175], v[12:15], v[200:203]
    v_rcp_f32 v231, v231
    v_rcp_f32 v232, v232
    v_rcp_f32 v233, v233
    v_rcp_f32 v234, v234
    v_rcp_f32 v235, v235
    v_pk_mul_f32 v[204:205], v[220:221], v[204:205]
    v_pk_mul_f32 v[206:207], v[222:223], v[206:207]
    v_pk_mul_f32 v[208:209], v[224:225], v[208:209]
    v_pk_mul_f32 v[210:211], v[226:227], v[210:211]
    v_pk_mul_f32 v[212:213], v[228:229], v[212:213]
    v_pk_mul_f32 v[214:215], v[230:231], v[214:215]
    v_pk_mul_f32 v[216:217], v[232:233], v[216:217]
    v_pk_mul_f32 v[218:219], v[234:235], v[218:219]
    s_cmp_ge_u32 s16, s17
    s_cbranch_scc1 L_LT1
    s_setprio 0
    v_smfmac_f32_16x16x64_bf16 v[120:123], v[184:187], v[204:211], v242
    ds_read_u16 v236, v250 offset:1152
    ds_read_u16 v237, v250 offset:1168
    ds_add_rtn_u32 v238, v255, v242
    v_exp_f32 v188, v188
    v_smfmac_f32_16x16x64_bf16 v[124:127], v[184:187], v[212:219], v242
    v_exp_f32 v189, v189
    v_mfma_f32_16x16x32_bf16 v[204:207], v[160:163], v[32:35], 0
    v_exp_f32 v190, v190
    v_mfma_f32_16x16x32_bf16 v[212:215], v[160:163], v[40:43], 0
    v_exp_f32 v191, v191
    v_mfma_f32_16x16x32_bf16 v[208:211], v[168:171], v[32:35], 0
    v_exp_f32 v192, v192
    v_mfma_f32_16x16x32_bf16 v[216:219], v[168:171], v[40:43], 0
    v_exp_f32 v193, v193
    v_mfma_f32_16x16x32_bf16 v[204:207], v[164:167], v[36:39], v[204:207]
    v_exp_f32 v194, v194
    v_mfma_f32_16x16x32_bf16 v[212:215], v[164:167], v[44:47], v[212:215]
    v_exp_f32 v195, v195
    v_mfma_f32_16x16x32_bf16 v[208:211], v[172:175], v[36:39], v[208:211]
    s_waitcnt lgkmcnt(0)
    v_bfi_b32 v236, 31, v246, v236
    v_bfi_b32 v237, 31, v246, v237
    v_readfirstlane_b32 s96, v238
    v_exp_f32 v196, v196
    v_mfma_f32_16x16x32_bf16 v[216:219], v[172:175], v[44:47], v[216:219]
    v_exp_f32 v197, v197
    s_setprio 3
    v_smfmac_f32_16x16x64_bf16 v[104:107], v[184:187], v[220:227], v242
    v_exp_f32 v198, v198
    v_smfmac_f32_16x16x64_bf16 v[108:111], v[184:187], v[228:235], v242
    v_exp_f32 v199, v199
    v_exp_f32 v200, v200
    v_exp_f32 v201, v201
    v_exp_f32 v202, v202
    v_exp_f32 v203, v203
    v_pk_add_f32 v[188:189], v[188:189], 1.0 op_sel_hi:[1,0]
    v_pk_add_f32 v[190:191], v[190:191], 1.0 op_sel_hi:[1,0]
    v_pk_add_f32 v[192:193], v[192:193], 1.0 op_sel_hi:[1,0]
    v_pk_add_f32 v[194:195], v[194:195], 1.0 op_sel_hi:[1,0]
    v_pk_add_f32 v[196:197], v[196:197], 1.0 op_sel_hi:[1,0]
    v_pk_add_f32 v[198:199], v[198:199], 1.0 op_sel_hi:[1,0]
    v_pk_add_f32 v[200:201], v[200:201], 1.0 op_sel_hi:[1,0]
    v_pk_add_f32 v[202:203], v[202:203], 1.0 op_sel_hi:[1,0]
    s_setprio 0
    v_mfma_f32_16x16x32_bf16 v[220:223], v[176:179], v[88:91], 0
    ds_read_b64_tr_b16 v[184:185], v236
    ds_read_b64_tr_b16 v[186:187], v237
    ds_read_u16 v251, v249 offset:128
    ds_read_u16 v252, v249 offset:192
    v_rcp_f32 v188, v188
    v_mfma_f32_16x16x32_bf16 v[228:231], v[176:179], v[92:95], 0
    s_ashr_i32 s96, s96, 24
    s_mul_i32 s96, s96, s101
    v_rcp_f32 v189, v189
    v_mfma_f32_16x16x32_bf16 v[224:227], v[180:183], v[88:91], 0
    v_rcp_f32 v190, v190
    v_mfma_f32_16x16x32_bf16 v[232:235], v[180:183], v[92:95], 0
    v_rcp_f32 v191, v191
    v_mfma_f32_16x16x32_bf16 v[220:223], v[160:163], v[16:19], v[220:223]
    v_rcp_f32 v192, v192
    v_mfma_f32_16x16x32_bf16 v[228:231], v[160:163], v[24:27], v[228:231]
    v_rcp_f32 v193, v193
    v_mfma_f32_16x16x32_bf16 v[224:227], v[168:171], v[16:19], v[224:227]
    s_waitcnt lgkmcnt(0)
    v_bfi_b32 v251, 31, v245, v251
    v_bfi_b32 v252, 31, v245, v252
    v_max_u32 v251, v251, v245
    v_max_u32 v252, v252, v253
    ds_read_b128 v[236:239], v247 offset:1280
    ds_read_b32 v240, v248 offset:1280
    s_add_u32 s16, s16, 1
    v_rcp_f32 v194, v194
    v_mfma_f32_16x16x32_bf16 v[232:235], v[168:171], v[24:27], v[232:235]
    v_add_u32 v247, 0x80, v247
    v_add_u32 v248, 0x80, v248
    v_add_u32 v249, 0x80, v249
    v_add_u32 v250, 0x80, v250
    v_rcp_f32 v195, v195
    v_mfma_f32_16x16x32_bf16 v[220:223], v[164:167], v[20:23], v[220:223]
    v_rcp_f32 v196, v196
    v_mfma_f32_16x16x32_bf16 v[228:231], v[164:167], v[28:31], v[228:231]
    v_rcp_f32 v197, v197
    s_setprio 3
    v_mfma_f32_16x16x32_bf16 v[224:227], v[172:175], v[20:23], v[224:227]
    v_rcp_f32 v198, v198
    v_mfma_f32_16x16x32_bf16 v[232:235], v[172:175], v[28:31], v[232:235]
    v_rcp_f32 v199, v199
    v_rcp_f32 v200, v200
    v_rcp_f32 v201, v201
    v_rcp_f32 v202, v202
    v_rcp_f32 v203, v203
    v_pk_mul_f32 v[204:205], v[188:189], v[204:205]
    v_pk_mul_f32 v[206:207], v[190:191], v[206:207]
    v_pk_mul_f32 v[208:209], v[192:193], v[208:209]
    v_pk_mul_f32 v[210:211], v[194:195], v[210:211]
    v_pk_mul_f32 v[212:213], v[196:197], v[212:213]
    v_pk_mul_f32 v[214:215], v[198:199], v[214:215]
    v_pk_mul_f32 v[216:217], v[200:201], v[216:217]
    v_pk_mul_f32 v[218:219], v[202:203], v[218:219]
    s_cmp_ge_i32 s96, 1
    s_cbranch_scc1 L_PB11
L_PB10:
    s_setprio 0
    v_smfmac_f32_16x16x64_bf16 v[144:147], v[184:187], v[204:211], v242
    v_exp_f32 v220, v220
    v_smfmac_f32_16x16x64_bf16 v[148:151], v[184:187], v[212:219], v242
    v_exp_f32 v221, v221
    s_waitcnt vmcnt(0)
    ds_read_b128 v[176:179], v251
    ds_read_b128 v[180:183], v252
    v_mfma_f32_16x16x32_bf16 v[204:207], v[160:163], v[48:51], 0
    v_exp_f32 v222, v222
    v_mfma_f32_16x16x32_bf16 v[212:215], v[160:163], v[56:59], 0
    ds_read_b128 v[160:163], v244 offset:0
    v_exp_f32 v223, v223
    v_mfma_f32_16x16x32_bf16 v[208:211], v[168:171], v[48:51], 0
    v_exp_f32 v224, v224
    v_mfma_f32_16x16x32_bf16 v[216:219], v[168:171], v[56:59], 0
    ds_read_b128 v[168:171], v244 offset:512
    v_exp_f32 v225, v225
    v_mfma_f32_16x16x32_bf16 v[204:207], v[164:167], v[52:55], v[204:207]
    v_exp_f32 v226, v226
    v_mfma_f32_16x16x32_bf16 v[212:215], v[164:167], v[60:63], v[212:215]
    ds_read_b128 v[164:167], v244 offset:64
    v_exp_f32 v227, v227
    v_mfma_f32_16x16x32_bf16 v[208:211], v[172:175], v[52:55], v[208:211]
    v_exp_f32 v228, v228
    v_mfma_f32_16x16x32_bf16 v[216:219], v[172:175], v[60:63], v[216:219]
    ds_read_b128 v[172:175], v244 offset:576
    v_exp_f32 v229, v229
    s_setprio 3
    v_smfmac_f32_16x16x64_bf16 v[128:131], v[184:187], v[188:195], v242
    v_exp_f32 v230, v230
    v_smfmac_f32_16x16x64_bf16 v[132:135], v[184:187], v[196:203], v242
    v_exp_f32 v231, v231
    v_exp_f32 v232, v232
    v_exp_f32 v233, v233
    v_exp_f32 v234, v234
    v_exp_f32 v235, v235
    v_pk_add_f32 v[220:221], v[220:221], 1.0 op_sel_hi:[1,0]
    v_pk_add_f32 v[222:223], v[222:223], 1.0 op_sel_hi:[1,0]
    v_pk_add_f32 v[224:225], v[224:225], 1.0 op_sel_hi:[1,0]
    v_pk_add_f32 v[226:227], v[226:227], 1.0 op_sel_hi:[1,0]
    v_pk_add_f32 v[228:229], v[228:229], 1.0 op_sel_hi:[1,0]
    v_pk_add_f32 v[230:231], v[230:231], 1.0 op_sel_hi:[1,0]
    v_pk_add_f32 v[232:233], v[232:233], 1.0 op_sel_hi:[1,0]
    v_pk_add_f32 v[234:235], v[234:235], 1.0 op_sel_hi:[1,0]
    s_setprio 0
    s_waitcnt lgkmcnt(4)
    v_mfma_f32_16x16x32_bf16 v[188:191], v[176:179], v[64:67], 0
    v_rcp_f32 v220, v220
    v_mfma_f32_16x16x32_bf16 v[196:199], v[176:179], v[68:71], 0
    v_rcp_f32 v221, v221
    v_mfma_f32_16x16x32_bf16 v[192:195], v[180:183], v[64:67], 0
    v_rcp_f32 v222, v222
    v_mfma_f32_16x16x32_bf16 v[200:203], v[180:183], v[68:71], 0
    v_rcp_f32 v223, v223
    s_waitcnt lgkmcnt(3)
    v_mfma_f32_16x16x32_bf16 v[188:191], v[160:163], v[0:3], v[188:191]
    v_rcp_f32 v224, v224
    v_mfma_f32_16x16x32_bf16 v[196:199], v[160:163], v[8:11], v[196:199]
    v_rcp_f32 v225, v225
    s_waitcnt lgkmcnt(2)
    v_mfma_f32_16x16x32_bf16 v[192:195], v[168:171], v[0:3], v[192:195]
    v_rcp_f32 v226, v226
    v_mfma_f32_16x16x32_bf16 v[200:203], v[168:171], v[8:11], v[200:203]
    v_rcp_f32 v227, v227
    s_waitcnt lgkmcnt(1)
    v_mfma_f32_16x16x32_bf16 v[188:191], v[164:167], v[4:7], v[188:191]
    v_rcp_f32 v228, v228
    v_mfma_f32_16x16x32_bf16 v[196:199], v[164:167], v[12:15], v[196:199]
    v_rcp_f32 v229, v229
    s_setprio 3
    s_waitcnt lgkmcnt(0)
    v_mfma_f32_16x16x32_bf16 v[192:195], v[172:175], v[4:7], v[192:195]
    s_cmp_lt_u32 s16, s17
    s_cbranch_scc0 L_ND10
    s_add_u32 m0, s13, 0
    v_mad_u32_u16 v236, v236, s15, v243
    buffer_load_dwordx4 v236, s[40:43], 0 offen lds
    s_add_u32 m0, s13, 1056
    v_mad_u32_u16 v237, v237, s15, v243
    buffer_load_dwordx4 v237, s[40:43], 0 offen lds
    s_add_u32 m0, s13, 2112
    v_mad_u32_u16 v238, v238, s15, v243
    buffer_load_dwordx4 v238, s[40:43], 0 offen lds
    s_add_u32 m0, s13, 3168
    v_mad_u32_u16 v239, v239, s15, v243
    buffer_load_dwordx4 v239, s[40:43], 0 offen lds
    s_mov_b32 m0, s14
    v_and_b32 v240, 0xfffff, v240
    buffer_load_dwordx4 v[240:241], s[44:47], 0 idxen offen lds
L_ND10:
    v_rcp_f32 v230, v230
    v_mfma_f32_16x16x32_bf16 v[200:203], v[172:175], v[12:15], v[200:203]
    v_rcp_f32 v231, v231
    v_rcp_f32 v232, v232
    v_rcp_f32 v233, v233
    v_rcp_f32 v234, v234
    v_rcp_f32 v235, v235
    v_pk_mul_f32 v[204:205], v[220:221], v[204:205]
    v_pk_mul_f32 v[206:207], v[222:223], v[206:207]
    v_pk_mul_f32 v[208:209], v[224:225], v[208:209]
    v_pk_mul_f32 v[210:211], v[226:227], v[210:211]
    v_pk_mul_f32 v[212:213], v[228:229], v[212:213]
    v_pk_mul_f32 v[214:215], v[230:231], v[214:215]
    v_pk_mul_f32 v[216:217], v[232:233], v[216:217]
    v_pk_mul_f32 v[218:219], v[234:235], v[218:219]
    s_cmp_lt_u32 s16, s17
    s_cbranch_scc1 L_LOOP0
    s_branch L_LT0
L_LT0:
    s_cmp_lg_u32 s99, 0
    s_cbranch_scc1 L_LH0
    s_setprio 0
    v_smfmac_f32_16x16x64_bf16 v[152:155], v[184:187], v[204:211], v242
    ds_read_u16 v236, v250 offset:0
    ds_read_u16 v237, v250 offset:16
    v_exp_f32 v188, v188
    v_smfmac_f32_16x16x64_bf16 v[156:159], v[184:187], v[212:219], v242
    v_exp_f32 v189, v189
    v_mfma_f32_16x16x32_bf16 v[204:207], v[160:163], v[32:35], 0
    v_exp_f32 v190, v190
    v_mfma_f32_16x16x32_bf16 v[212:215], v[160:163], v[40:43], 0
    v_exp_f32 v191, v191
    v_mfma_f32_16x16x32_bf16 v[208:211], v[168:171], v[32:35], 0
    v_exp_f32 v192, v192
    v_mfma_f32_16x16x32_bf16 v[216:219], v[168:171], v[40:43], 0
    v_exp_f32 v193, v193
    v_mfma_f32_16x16x32_bf16 v[204:207], v[164:167], v[36:39], v[204:207]
    v_exp_f32 v194, v194
    v_mfma_f32_16x16x32_bf16 v[212:215], v[164:167], v[44:47], v[212:215]
    v_exp_f32 v195, v195
    v_mfma_f32_16x16x32_bf16 v[208:211], v[172:175], v[36:39], v[208:211]
    v_exp_f32 v196, v196
    v_mfma_f32_16x16x32_bf16 v[216:219], v[172:175], v[44:47], v[216:219]
    v_exp_f32 v197, v197
    v_smfmac_f32_16x16x64_bf16 v[136:139], v[184:187], v[220:227], v242
    s_waitcnt lgkmcnt(0)
    v_bfi_b32 v236, 31, v246, v236
    v_bfi_b32 v237, 31, v246, v237
    v_exp_f32 v198, v198
    s_setprio 3
    v_smfmac_f32_16x16x64_bf16 v[140:143], v[184:187], v[228:235], v242
    v_exp_f32 v199, v199
    v_exp_f32 v200, v200
    v_exp_f32 v201, v201
    v_exp_f32 v202, v202
    v_exp_f32 v203, v203
    v_pk_add_f32 v[188:189], v[188:189], 1.0 op_sel_hi:[1,0]
    v_pk_add_f32 v[190:191], v[190:191], 1.0 op_sel_hi:[1,0]
    v_pk_add_f32 v[192:193], v[192:193], 1.0 op_sel_hi:[1,0]
    v_pk_add_f32 v[194:195], v[194:195], 1.0 op_sel_hi:[1,0]
    v_pk_add_f32 v[196:197], v[196:197], 1.0 op_sel_hi:[1,0]
    v_pk_add_f32 v[198:199], v[198:199], 1.0 op_sel_hi:[1,0]
    v_pk_add_f32 v[200:201], v[200:201], 1.0 op_sel_hi:[1,0]
    v_pk_add_f32 v[202:203], v[202:203], 1.0 op_sel_hi:[1,0]
    s_setprio 0
    v_mfma_f32_16x16x32_bf16 v[220:223], v[176:179], v[72:75], 0
    ds_read_b64_tr_b16 v[184:185], v236
    ds_read_b64_tr_b16 v[186:187], v237
    v_rcp_f32 v188, v188
    v_mfma_f32_16x16x32_bf16 v[228:231], v[176:179], v[76:79], 0
    v_rcp_f32 v189, v189
    v_mfma_f32_16x16x32_bf16 v[224:227], v[180:183], v[72:75], 0
    v_rcp_f32 v190, v190
    v_mfma_f32_16x16x32_bf16 v[232:235], v[180:183], v[76:79], 0
    v_rcp_f32 v191, v191
    v_mfma_f32_16x16x32_bf16 v[220:223], v[160:163], v[16:19], v[220:223]
    v_rcp_f32 v192, v192
    v_mfma_f32_16x16x32_bf16 v[228:231], v[160:163], v[24:27], v[228:231]
    v_rcp_f32 v193, v193
    v_mfma_f32_16x16x32_bf16 v[224:227], v[168:171], v[16:19], v[224:227]
    v_rcp_f32 v194, v194
    v_mfma_f32_16x16x32_bf16 v[232:235], v[168:171], v[24:27], v[232:235]
    v_rcp_f32 v195, v195
    v_mfma_f32_16x16x32_bf16 v[220:223], v[164:167], v[20:23], v[220:223]
    v_rcp_f32 v196, v196
    v_mfma_f32_16x16x32_bf16 v[228:231], v[164:167], v[28:31], v[228:231]
    v_rcp_f32 v197, v197
    v_mfma_f32_16x16x32_bf16 v[224:227], v[172:175], v[20:23], v[224:227]
    v_rcp_f32 v198, v198
    s_setprio 3
    v_mfma_f32_16x16x32_bf16 v[232:235], v[172:175], v[28:31], v[232:235]
    v_rcp_f32 v199, v199
    v_rcp_f32 v200, v200
    v_rcp_f32 v201, v201
    v_rcp_f32 v202, v202
    v_rcp_f32 v203, v203
    v_pk_mul_f32 v[204:205], v[188:189], v[204:205]
    v_pk_mul_f32 v[206:207], v[190:191], v[206:207]
    v_pk_mul_f32 v[208:209], v[192:193], v[208:209]
    v_pk_mul_f32 v[210:211], v[194:195], v[210:211]
    v_pk_mul_f32 v[212:213], v[196:197], v[212:213]
    v_pk_mul_f32 v[214:215], v[198:199], v[214:215]
    v_pk_mul_f32 v[216:217], v[200:201], v[216:217]
    v_pk_mul_f32 v[218:219], v[202:203], v[218:219]
    s_setprio 0
    s_waitcnt lgkmcnt(0)
    v_smfmac_f32_16x16x64_bf16 v[112:115], v[184:187], v[204:211], v242
    v_exp_f32 v220, v220
    v_smfmac_f32_16x16x64_bf16 v[116:119], v[184:187], v[212:219], v242
    v_exp_f32 v221, v221
    v_mfma_f32_16x16x32_bf16 v[204:207], v[160:163], v[48:51], 0
    v_exp_f32 v222, v222
    v_mfma_f32_16x16x32_bf16 v[212:215], v[160:163], v[56:59], 0
    v_exp_f32 v223, v223
    v_mfma_f32_16x16x32_bf16 v[208:211], v[168:171], v[48:51], 0
    v_exp_f32 v224, v224
    v_mfma_f32_16x16x32_bf16 v[216:219], v[168:171], v[56:59], 0
    v_exp_f32 v225, v225
    v_mfma_f32_16x16x32_bf16 v[204:207], v[164:167], v[52:55], v[204:207]
    v_exp_f32 v226, v226
    v_mfma_f32_16x16x32_bf16 v[212:215], v[164:167], v[60:63], v[212:215]
    v_exp_f32 v227, v227
    v_mfma_f32_16x16x32_bf16 v[208:211], v[172:175], v[52:55], v[208:211]
    v_exp_f32 v228, v228
    v_mfma_f32_16x16x32_bf16 v[216:219], v[172:175], v[60:63], v[216:219]
    v_exp_f32 v229, v229
    v_smfmac_f32_16x16x64_bf16 v[96:99], v[184:187], v[188:195], v242
    v_exp_f32 v230, v230
    s_setprio 3
    v_smfmac_f32_16x16x64_bf16 v[100:103], v[184:187], v[196:203], v242
    v_exp_f32 v231, v231
    v_exp_f32 v232, v232
    v_exp_f32 v233, v233
    v_exp_f32 v234, v234
    v_exp_f32 v235, v235
    v_pk_add_f32 v[220:221], v[220:221], 1.0 op_sel_hi:[1,0]
    v_pk_add_f32 v[222:223], v[222:223], 1.0 op_sel_hi:[1,0]
    v_pk_add_f32 v[224:225], v[224:225], 1.0 op_sel_hi:[1,0]
    v_pk_add_f32 v[226:227], v[226:227], 1.0 op_sel_hi:[1,0]
    v_pk_add_f32 v[228:229], v[228:229], 1.0 op_sel_hi:[1,0]
    v_pk_add_f32 v[230:231], v[230:231], 1.0 op_sel_hi:[1,0]
    v_pk_add_f32 v[232:233], v[232:233], 1.0 op_sel_hi:[1,0]
    v_pk_add_f32 v[234:235], v[234:235], 1.0 op_sel_hi:[1,0]
    s_setprio 0
    v_rcp_f32 v220, v220
    v_rcp_f32 v221, v221
    v_rcp_f32 v222, v222
    v_rcp_f32 v223, v223
    v_rcp_f32 v224, v224
    v_rcp_f32 v225, v225
    v_rcp_f32 v226, v226
    v_rcp_f32 v227, v227
    v_rcp_f32 v228, v228
    v_rcp_f32 v229, v229
    v_rcp_f32 v230, v230
    v_rcp_f32 v231, v231
    v_rcp_f32 v232, v232
    v_rcp_f32 v233, v233
    v_rcp_f32 v234, v234
    v_rcp_f32 v235, v235
    v_pk_mul_f32 v[204:205], v[220:221], v[204:205]
    v_pk_mul_f32 v[206:207], v[222:223], v[206:207]
    v_pk_mul_f32 v[208:209], v[224:225], v[208:209]
    v_pk_mul_f32 v[210:211], v[226:227], v[210:211]
    v_pk_mul_f32 v[212:213], v[228:229], v[212:213]
    v_pk_mul_f32 v[214:215], v[230:231], v[214:215]
    v_pk_mul_f32 v[216:217], v[232:233], v[216:217]
    v_pk_mul_f32 v[218:219], v[234:235], v[218:219]
    v_smfmac_f32_16x16x64_bf16 v[104:107], v[184:187], v[220:227], v242
    v_smfmac_f32_16x16x64_bf16 v[108:111], v[184:187], v[228:235], v242
    v_smfmac_f32_16x16x64_bf16 v[120:123], v[184:187], v[204:211], v242
    v_smfmac_f32_16x16x64_bf16 v[124:127], v[184:187], v[212:219], v242
    s_branch L_DONE
L_LH0:
    s_setprio 0
    v_smfmac_f32_16x16x64_bf16 v[152:155], v[184:187], v[204:211], v242
    ds_read_u16 v236, v250 offset:0
    ds_read_u16 v237, v250 offset:16
    v_smfmac_f32_16x16x64_bf16 v[156:159], v[184:187], v[212:219], v242
    v_exp_f32 v188, v188
    v_mfma_f32_16x16x32_bf16 v[204:207], v[160:163], v[32:35], 0
    v_mfma_f32_16x16x32_bf16 v[212:215], v[160:163], v[40:43], 0
    v_exp_f32 v189, v189
    v_mfma_f32_16x16x32_bf16 v[204:207], v[164:167], v[36:39], v[204:207]
    v_mfma_f32_16x16x32_bf16 v[212:215], v[164:167], v[44:47], v[212:215]
    v_exp_f32 v190, v190
    v_smfmac_f32_16x16x64_bf16 v[136:139], v[184:187], v[220:227], v242
    s_waitcnt lgkmcnt(0)
    v_bfi_b32 v236, 31, v246, v236
    v_bfi_b32 v237, 31, v246, v237
    v_exp_f32 v191, v191
    s_setprio 3
    v_smfmac_f32_16x16x64_bf16 v[140:143], v[184:187], v[228:235], v242
    v_exp_f32 v196, v196
    v_exp_f32 v197, v197
    v_exp_f32 v198, v198
    v_exp_f32 v199, v199
    v_pk_add_f32 v[188:189], v[188:189], 1.0 op_sel_hi:[1,0]
    v_pk_add_f32 v[190:191], v[190:191], 1.0 op_sel_hi:[1,0]
    v_pk_add_f32 v[196:197], v[196:197], 1.0 op_sel_hi:[1,0]
    v_pk_add_f32 v[198:199], v[198:199], 1.0 op_sel_hi:[1,0]
    s_setprio 0
    v_mfma_f32_16x16x32_bf16 v[220:223], v[176:179], v[72:75], 0
    ds_read_b64_tr_b16 v[184:185], v236
    ds_read_b64_tr_b16 v[186:187], v237
    v_mfma_f32_16x16x32_bf16 v[228:231], v[176:179], v[76:79], 0
    v_rcp_f32 v188, v188
    v_mfma_f32_16x16x32_bf16 v[220:223], v[160:163], v[16:19], v[220:223]
    v_rcp_f32 v189, v189
    v_mfma_f32_16x16x32_bf16 v[228:231], v[160:163], v[24:27], v[228:231]
    v_rcp_f32 v190, v190
    v_mfma_f32_16x16x32_bf16 v[220:223], v[164:167], v[20:23], v[220:223]
    v_rcp_f32 v191, v191
    s_setprio 3
    v_mfma_f32_16x16x32_bf16 v[228:231], v[164:167], v[28:31], v[228:231]
    v_rcp_f32 v196, v196
    v_rcp_f32 v197, v197
    v_rcp_f32 v198, v198
    v_rcp_f32 v199, v199
    v_pk_mul_f32 v[204:205], v[188:189], v[204:205]
    v_pk_mul_f32 v[206:207], v[190:191], v[206:207]
    v_pk_mul_f32 v[212:213], v[196:197], v[212:213]
    v_pk_mul_f32 v[214:215], v[198:199], v[214:215]
    s_setprio 0
    s_waitcnt lgkmcnt(0)
    v_smfmac_f32_16x16x64_bf16 v[112:115], v[184:187], v[204:211], v242
    v_smfmac_f32_16x16x64_bf16 v[116:119], v[184:187], v[212:219], v242
    v_exp_f32 v220, v220
    v_mfma_f32_16x16x32_bf16 v[204:207], v[160:163], v[48:51], 0
    v_mfma_f32_16x16x32_bf16 v[212:215], v[160:163], v[56:59], 0
    v_exp_f32 v221, v221
    v_mfma_f32_16x16x32_bf16 v[204:207], v[164:167], v[52:55], v[204:207]
    v_mfma_f32_16x16x32_bf16 v[212:215], v[164:167], v[60:63], v[212:215]
    v_exp_f32 v222, v222
    v_smfmac_f32_16x16x64_bf16 v[96:99], v[184:187], v[188:195], v242
    v_exp_f32 v223, v223
    s_setprio 3
    v_smfmac_f32_16x16x64_bf16 v[100:103], v[184:187], v[196:203], v242
    v_exp_f32 v228, v228
    v_exp_f32 v229, v229
    v_exp_f32 v230, v230
    v_exp_f32 v231, v231
    v_pk_add_f32 v[220:221], v[220:221], 1.0 op_sel_hi:[1,0]
    v_pk_add_f32 v[222:223], v[222:223], 1.0 op_sel_hi:[1,0]
    v_pk_add_f32 v[228:229], v[228:229], 1.0 op_sel_hi:[1,0]
    v_pk_add_f32 v[230:231], v[230:231], 1.0 op_sel_hi:[1,0]
    s_setprio 0
    v_rcp_f32 v220, v220
    v_rcp_f32 v221, v221
    v_rcp_f32 v222, v222
    v_rcp_f32 v223, v223
    v_rcp_f32 v228, v228
    v_rcp_f32 v229, v229
    v_rcp_f32 v230, v230
    v_rcp_f32 v231, v231
    v_pk_mul_f32 v[204:205], v[220:221], v[204:205]
    v_pk_mul_f32 v[206:207], v[222:223], v[206:207]
    v_pk_mul_f32 v[212:213], v[228:229], v[212:213]
    v_pk_mul_f32 v[214:215], v[230:231], v[214:215]
    v_smfmac_f32_16x16x64_bf16 v[104:107], v[184:187], v[220:227], v242
    v_smfmac_f32_16x16x64_bf16 v[108:111], v[184:187], v[228:235], v242
    v_smfmac_f32_16x16x64_bf16 v[120:123], v[184:187], v[204:211], v242
    v_smfmac_f32_16x16x64_bf16 v[124:127], v[184:187], v[212:219], v242
    s_branch L_DONE
L_LT1:
    s_cmp_lg_u32 s99, 0
    s_cbranch_scc1 L_LH1
    s_setprio 0
    v_smfmac_f32_16x16x64_bf16 v[120:123], v[184:187], v[204:211], v242
    ds_read_u16 v236, v250 offset:1152
    ds_read_u16 v237, v250 offset:1168
    v_exp_f32 v188, v188
    v_smfmac_f32_16x16x64_bf16 v[124:127], v[184:187], v[212:219], v242
    v_exp_f32 v189, v189
    v_mfma_f32_16x16x32_bf16 v[204:207], v[160:163], v[32:35], 0
    v_exp_f32 v190, v190
    v_mfma_f32_16x16x32_bf16 v[212:215], v[160:163], v[40:43], 0
    v_exp_f32 v191, v191
    v_mfma_f32_16x16x32_bf16 v[208:211], v[168:171], v[32:35], 0
    v_exp_f32 v192, v192
    v_mfma_f32_16x16x32_bf16 v[216:219], v[168:171], v[40:43], 0
    v_exp_f32 v193, v193
    v_mfma_f32_16x16x32_bf16 v[204:207], v[164:167], v[36:39], v[204:207]
    v_exp_f32 v194, v194
    v_mfma_f32_16x16x32_bf16 v[212:215], v[164:167], v[44:47], v[212:215]
    v_exp_f32 v195, v195
    v_mfma_f32_16x16x32_bf16 v[208:211], v[172:175], v[36:39], v[208:211]
    v_exp_f32 v196, v196
    v_mfma_f32_16x16x32_bf16 v[216:219], v[172:175], v[44:47], v[216:219]
    v_exp_f32 v197, v197
    v_smfmac_f32_16x16x64_bf16 v[104:107], v[184:187], v[220:227], v242
    s_waitcnt lgkmcnt(0)
    v_bfi_b32 v236, 31, v246, v236
    v_bfi_b32 v237, 31, v246, v237
    v_exp_f32 v198, v198
    s_setprio 3
    v_smfmac_f32_16x16x64_bf16 v[108:111], v[184:187], v[228:235], v242
    v_exp_f32 v199, v199
    v_exp_f32 v200, v200
    v_exp_f32 v201, v201
    v_exp_f32 v202, v202
    v_exp_f32 v203, v203
    v_pk_add_f32 v[188:189], v[188:189], 1.0 op_sel_hi:[1,0]
    v_pk_add_f32 v[190:191], v[190:191], 1.0 op_sel_hi:[1,0]
    v_pk_add_f32 v[192:193], v[192:193], 1.0 op_sel_hi:[1,0]
    v_pk_add_f32 v[194:195], v[194:195], 1.0 op_sel_hi:[1,0]
    v_pk_add_f32 v[196:197], v[196:197], 1.0 op_sel_hi:[1,0]
    v_pk_add_f32 v[198:199], v[198:199], 1.0 op_sel_hi:[1,0]
    v_pk_add_f32 v[200:201], v[200:201], 1.0 op_sel_hi:[1,0]
    v_pk_add_f32 v[202:203], v[202:203], 1.0 op_sel_hi:[1,0]
    s_setprio 0
    v_mfma_f32_16x16x32_bf16 v[220:223], v[176:179], v[88:91], 0
    ds_read_b64_tr_b16 v[184:185], v236
    ds_read_b64_tr_b16 v[186:187], v237
    v_rcp_f32 v188, v188
    v_mfma_f32_16x16x32_bf16 v[228:231], v[176:179], v[92:95], 0
    v_rcp_f32 v189, v189
    v_mfma_f32_16x16x32_bf16 v[224:227], v[180:183], v[88:91], 0
    v_rcp_f32 v190, v190
    v_mfma_f32_16x16x32_bf16 v[232:235], v[180:183], v[92:95], 0
    v_rcp_f32 v191, v191
    v_mfma_f32_16x16x32_bf16 v[220:223], v[160:163], v[16:19], v[220:223]
    v_rcp_f32 v192, v192
    v_mfma_f32_16x16x32_bf16 v[228:231], v[160:163], v[24:27], v[228:231]
    v_rcp_f32 v193, v193
    v_mfma_f32_16x16x32_bf16 v[224:227], v[168:171], v[16:19], v[224:227]
    v_rcp_f32 v194, v194
    v_mfma_f32_16x16x32_bf16 v[232:235], v[168:171], v[24:27], v[232:235]
    v_rcp_f32 v195, v195
    v_mfma_f32_16x16x32_bf16 v[220:223], v[164:167], v[20:23], v[220:223]
    v_rcp_f32 v196, v196
    v_mfma_f32_16x16x32_bf16 v[228:231], v[164:167], v[28:31], v[228:231]
    v_rcp_f32 v197, v197
    v_mfma_f32_16x16x32_bf16 v[224:227], v[172:175], v[20:23], v[224:227]
    v_rcp_f32 v198, v198
    s_setprio 3
    v_mfma_f32_16x16x32_bf16 v[232:235], v[172:175], v[28:31], v[232:235]
    v_rcp_f32 v199, v199
    v_rcp_f32 v200, v200
    v_rcp_f32 v201, v201
    v_rcp_f32 v202, v202
    v_rcp_f32 v203, v203
    v_pk_mul_f32 v[204:205], v[188:189], v[204:205]
    v_pk_mul_f32 v[206:207], v[190:191], v[206:207]
    v_pk_mul_f32 v[208:209], v[192:193], v[208:209]
    v_pk_mul_f32 v[210:211], v[194:195], v[210:211]
    v_pk_mul_f32 v[212:213], v[196:197], v[212:213]
    v_pk_mul_f32 v[214:215], v[198:199], v[214:215]
    v_pk_mul_f32 v[216:217], v[200:201], v[216:217]
    v_pk_mul_f32 v[218:219], v[202:203], v[218:219]
    s_setprio 0
    s_waitcnt lgkmcnt(0)
    v_smfmac_f32_16x16x64_bf16 v[144:147], v[184:187], v[204:211], v242
    v_exp_f32 v220, v220
    v_smfmac_f32_16x16x64_bf16 v[148:151], v[184:187], v[212:219], v242
    v_exp_f32 v221, v221
    v_mfma_f32_16x16x32_bf16 v[204:207], v[160:163], v[48:51], 0
    v_exp_f32 v222, v222
    v_mfma_f32_16x16x32_bf16 v[212:215], v[160:163], v[56:59], 0
    v_exp_f32 v223, v223
    v_mfma_f32_16x16x32_bf16 v[208:211], v[168:171], v[48:51], 0
    v_exp_f32 v224, v224
    v_mfma_f32_16x16x32_bf16 v[216:219], v[168:171], v[56:59], 0
    v_exp_f32 v225, v225
    v_mfma_f32_16x16x32_bf16 v[204:207], v[164:167], v[52:55], v[204:207]
    v_exp_f32 v226, v226
    v_mfma_f32_16x16x32_bf16 v[212:215], v[164:167], v[60:63], v[212:215]
    v_exp_f32 v227, v227
    v_mfma_f32_16x16x32_bf16 v[208:211], v[172:175], v[52:55], v[208:211]
    v_exp_f32 v228, v228
    v_mfma_f32_16x16x32_bf16 v[216:219], v[172:175], v[60:63], v[216:219]
    v_exp_f32 v229, v229
    v_smfmac_f32_16x16x64_bf16 v[128:131], v[184:187], v[188:195], v242
    v_exp_f32 v230, v230
    s_setprio 3
    v_smfmac_f32_16x16x64_bf16 v[132:135], v[184:187], v[196:203], v242
    v_exp_f32 v231, v231
    v_exp_f32 v232, v232
    v_exp_f32 v233, v233
    v_exp_f32 v234, v234
    v_exp_f32 v235, v235
    v_pk_add_f32 v[220:221], v[220:221], 1.0 op_sel_hi:[1,0]
    v_pk_add_f32 v[222:223], v[222:223], 1.0 op_sel_hi:[1,0]
    v_pk_add_f32 v[224:225], v[224:225], 1.0 op_sel_hi:[1,0]
    v_pk_add_f32 v[226:227], v[226:227], 1.0 op_sel_hi:[1,0]
    v_pk_add_f32 v[228:229], v[228:229], 1.0 op_sel_hi:[1,0]
    v_pk_add_f32 v[230:231], v[230:231], 1.0 op_sel_hi:[1,0]
    v_pk_add_f32 v[232:233], v[232:233], 1.0 op_sel_hi:[1,0]
    v_pk_add_f32 v[234:235], v[234:235], 1.0 op_sel_hi:[1,0]
    s_setprio 0
    v_rcp_f32 v220, v220
    v_rcp_f32 v221, v221
    v_rcp_f32 v222, v222
    v_rcp_f32 v223, v223
    v_rcp_f32 v224, v224
    v_rcp_f32 v225, v225
    v_rcp_f32 v226, v226
    v_rcp_f32 v227, v227
    v_rcp_f32 v228, v228
    v_rcp_f32 v229, v229
    v_rcp_f32 v230, v230
    v_rcp_f32 v231, v231
    v_rcp_f32 v232, v232
    v_rcp_f32 v233, v233
    v_rcp_f32 v234, v234
    v_rcp_f32 v235, v235
    v_pk_mul_f32 v[204:205], v[220:221], v[204:205]
    v_pk_mul_f32 v[206:207], v[222:223], v[206:207]
    v_pk_mul_f32 v[208:209], v[224:225], v[208:209]
    v_pk_mul_f32 v[210:211], v[226:227], v[210:211]
    v_pk_mul_f32 v[212:213], v[228:229], v[212:213]
    v_pk_mul_f32 v[214:215], v[230:231], v[214:215]
    v_pk_mul_f32 v[216:217], v[232:233], v[216:217]
    v_pk_mul_f32 v[218:219], v[234:235], v[218:219]
    v_smfmac_f32_16x16x64_bf16 v[136:139], v[184:187], v[220:227], v242
    v_smfmac_f32_16x16x64_bf16 v[140:143], v[184:187], v[228:235], v242
    v_smfmac_f32_16x16x64_bf16 v[152:155], v[184:187], v[204:211], v242
    v_smfmac_f32_16x16x64_bf16 v[156:159], v[184:187], v[212:219], v242
    s_branch L_DONE
L_LH1:
    s_setprio 0
    v_smfmac_f32_16x16x64_bf16 v[120:123], v[184:187], v[204:211], v242
    ds_read_u16 v236, v250 offset:1152
    ds_read_u16 v237, v250 offset:1168
    v_smfmac_f32_16x16x64_bf16 v[124:127], v[184:187], v[212:219], v242
    v_exp_f32 v188, v188
    v_mfma_f32_16x16x32_bf16 v[204:207], v[160:163], v[32:35], 0
    v_mfma_f32_16x16x32_bf16 v[212:215], v[160:163], v[40:43], 0
    v_exp_f32 v189, v189
    v_mfma_f32_16x16x32_bf16 v[204:207], v[164:167], v[36:39], v[204:207]
    v_mfma_f32_16x16x32_bf16 v[212:215], v[164:167], v[44:47], v[212:215]
    v_exp_f32 v190, v190
    v_smfmac_f32_16x16x64_bf16 v[104:107], v[184:187], v[220:227], v242
    s_waitcnt lgkmcnt(0)
    v_bfi_b32 v236, 31, v246, v236
    v_bfi_b32 v237, 31, v246, v237
    v_exp_f32 v191, v191
    s_setprio 3
    v_smfmac_f32_16x16x64_bf16 v[108:111], v[184:187], v[228:235], v242
    v_exp_f32 v196, v196
    v_exp_f32 v197, v197
    v_exp_f32 v198, v198
    v_exp_f32 v199, v199
    v_pk_add_f32 v[188:189], v[188:189], 1.0 op_sel_hi:[1,0]
    v_pk_add_f32 v[190:191], v[190:191], 1.0 op_sel_hi:[1,0]
    v_pk_add_f32 v[196:197], v[196:197], 1.0 op_sel_hi:[1,0]
    v_pk_add_f32 v[198:199], v[198:199], 1.0 op_sel_hi:[1,0]
    s_setprio 0
    v_mfma_f32_16x16x32_bf16 v[220:223], v[176:179], v[88:91], 0
    ds_read_b64_tr_b16 v[184:185], v236
    ds_read_b64_tr_b16 v[186:187], v237
    v_mfma_f32_16x16x32_bf16 v[228:231], v[176:179], v[92:95], 0
    v_rcp_f32 v188, v188
    v_mfma_f32_16x16x32_bf16 v[220:223], v[160:163], v[16:19], v[220:223]
    v_rcp_f32 v189, v189
    v_mfma_f32_16x16x32_bf16 v[228:231], v[160:163], v[24:27], v[228:231]
    v_rcp_f32 v190, v190
    v_mfma_f32_16x16x32_bf16 v[220:223], v[164:167], v[20:23], v[220:223]
    v_rcp_f32 v191, v191
    s_setprio 3
    v_mfma_f32_16x16x32_bf16 v[228:231], v[164:167], v[28:31], v[228:231]
    v_rcp_f32 v196, v196
    v_rcp_f32 v197, v197
    v_rcp_f32 v198, v198
    v_rcp_f32 v199, v199
    v_pk_mul_f32 v[204:205], v[188:189], v[204:205]
    v_pk_mul_f32 v[206:207], v[190:191], v[206:207]
    v_pk_mul_f32 v[212:213], v[196:197], v[212:213]
    v_pk_mul_f32 v[214:215], v[198:199], v[214:215]
    s_setprio 0
    s_waitcnt lgkmcnt(0)
    v_smfmac_f32_16x16x64_bf16 v[144:147], v[184:187], v[204:211], v242
    v_smfmac_f32_16x16x64_bf16 v[148:151], v[184:187], v[212:219], v242
    v_exp_f32 v220, v220
    v_mfma_f32_16x16x32_bf16 v[204:207], v[160:163], v[48:51], 0
    v_mfma_f32_16x16x32_bf16 v[212:215], v[160:163], v[56:59], 0
    v_exp_f32 v221, v221
    v_mfma_f32_16x16x32_bf16 v[204:207], v[164:167], v[52:55], v[204:207]
    v_mfma_f32_16x16x32_bf16 v[212:215], v[164:167], v[60:63], v[212:215]
    v_exp_f32 v222, v222
    v_smfmac_f32_16x16x64_bf16 v[128:131], v[184:187], v[188:195], v242
    v_exp_f32 v223, v223
    s_setprio 3
    v_smfmac_f32_16x16x64_bf16 v[132:135], v[184:187], v[196:203], v242
    v_exp_f32 v228, v228
    v_exp_f32 v229, v229
    v_exp_f32 v230, v230
    v_exp_f32 v231, v231
    v_pk_add_f32 v[220:221], v[220:221], 1.0 op_sel_hi:[1,0]
    v_pk_add_f32 v[222:223], v[222:223], 1.0 op_sel_hi:[1,0]
    v_pk_add_f32 v[228:229], v[228:229], 1.0 op_sel_hi:[1,0]
    v_pk_add_f32 v[230:231], v[230:231], 1.0 op_sel_hi:[1,0]
    s_setprio 0
    v_rcp_f32 v220, v220
    v_rcp_f32 v221, v221
    v_rcp_f32 v222, v222
    v_rcp_f32 v223, v223
    v_rcp_f32 v228, v228
    v_rcp_f32 v229, v229
    v_rcp_f32 v230, v230
    v_rcp_f32 v231, v231
    v_pk_mul_f32 v[204:205], v[220:221], v[204:205]
    v_pk_mul_f32 v[206:207], v[222:223], v[206:207]
    v_pk_mul_f32 v[212:213], v[228:229], v[212:213]
    v_pk_mul_f32 v[214:215], v[230:231], v[214:215]
    v_smfmac_f32_16x16x64_bf16 v[136:139], v[184:187], v[220:227], v242
    v_smfmac_f32_16x16x64_bf16 v[140:143], v[184:187], v[228:235], v242
    v_smfmac_f32_16x16x64_bf16 v[152:155], v[184:187], v[204:211], v242
    v_smfmac_f32_16x16x64_bf16 v[156:159], v[184:187], v[212:219], v242
    s_branch L_DONE
L_DONE:
    v_mbcnt_lo_u32_b32 v253, -1, 0
    v_mbcnt_hi_u32_b32 v253, -1, v253
    s_cmp_lg_u32 s19, 0
    s_cbranch_scc1 L_SLOW
L_EPI:
    s_waitcnt lgkmcnt(0)
    v_and_b32 v64, 48, v253
    v_and_b32 v67, 15, v253
    v_add_u32 v69, s72, v64
    v_lshl_add_u32 v70, v67, 2, s72
    ds_read_b128 v[80:83], v69 offset:0
    ds_read_b128 v[84:87], v69 offset:64
    ds_read2_b32 v[72:73], v70 offset0:0 offset1:16
    v_bfe_u32 v65, v253, 2, 3
    v_lshrrev_b32 v66, 5, v253
    v_lshl_add_u32 v65, v66, 4, v65
    v_mul_u32_u24 v65, 160, v65
    s_mov_b32 s10, 143488
    v_add3_u32 v65, v65, v246, s10
    ds_read_b64_tr_b16 v[0:1], v65 offset:0
    ds_read_b64_tr_b16 v[2:3], v65 offset:1280
    ds_read_b64_tr_b16 v[8:9], v65 offset:32
    ds_read_b64_tr_b16 v[10:11], v65 offset:1312
    ds_read_b64_tr_b16 v[16:17], v65 offset:64
    ds_read_b64_tr_b16 v[18:19], v65 offset:1344
    ds_read_b64_tr_b16 v[24:25], v65 offset:96
    ds_read_b64_tr_b16 v[26:27], v65 offset:1376
    ds_read_b64_tr_b16 v[4:5], v65 offset:5120
    ds_read_b64_tr_b16 v[6:7], v65 offset:6400
    ds_read_b64_tr_b16 v[12:13], v65 offset:5152
    ds_read_b64_tr_b16 v[14:15], v65 offset:6432
    s_movk_i32 s10, 832
    v_mad_u32_u24 v64, v246, s10, v64
    s_mov_b32 s10, 116736
    v_lshl_add_u32 v69, v67, 3, s10
    v_lshl_add_u32 v74, v67, 3, s73
    v_lshl_add_u32 v75, v67, 3, s74
    s_waitcnt lgkmcnt(8)
    ds_read_b64_tr_b16 v[20:21], v65 offset:5184
    ds_read_b64_tr_b16 v[22:23], v65 offset:6464
    ds_read_b64_tr_b16 v[28:29], v65 offset:5216
    ds_read_b64_tr_b16 v[30:31], v65 offset:6496
    v_add_u32 v76, v80, v69
    ds_read_b64 v[32:33], v76 offset:0
    v_add_u32 v76, v81, v69
    ds_read_b64 v[34:35], v76 offset:6656
    v_add_u32 v76, v82, v69
    ds_read_b64 v[36:37], v76 offset:13312
    v_add_u32 v76, v83, v69
    ds_read_b64 v[38:39], v76 offset:19968
    v_add_u32 v76, v84, v69
    ds_read_b64 v[40:41], v76 offset:0
    v_add_u32 v76, v85, v69
    ds_read_b64 v[42:43], v76 offset:6656
    v_add_u32 v76, v86, v69
    ds_read_b64 v[44:45], v76 offset:13312
    v_add_u32 v76, v87, v69
    ds_read_b64 v[46:47], v76 offset:19968
    v_add3_u32 v72, v72, v64, s10
    ds_read_b128 v[160:163], v72 offset:0
    ds_read_b128 v[164:167], v72 offset:64
    v_add3_u32 v73, v73, v64, s10
    ds_read_b128 v[168:171], v73 offset:0
    ds_read_b128 v[172:175], v73 offset:64
    s_waitcnt lgkmcnt(0)
    v_lshlrev_b32 v188, 16, v32
    v_lshlrev_b32 v189, 16, v34
    v_lshlrev_b32 v190, 16, v36
    v_lshlrev_b32 v191, 16, v38
    v_and_b32 v192, 0xffff0000, v32
    v_and_b32 v193, 0xffff0000, v34
    v_and_b32 v194, 0xffff0000, v36
    v_and_b32 v195, 0xffff0000, v38
    v_mfma_f32_16x16x32_bf16 v[188:191], v[160:163], v[0:3], v[188:191]
    v_lshlrev_b32 v196, 16, v33
    v_lshlrev_b32 v197, 16, v35
    v_lshlrev_b32 v198, 16, v37
    v_lshlrev_b32 v199, 16, v39
    v_lshl_add_u32 v80, v80, 2, v74
    v_mfma_f32_16x16x32_bf16 v[188:191], v[164:167], v[4:7], v[188:191]
    v_mfma_f32_16x16x32_bf16 v[192:195], v[160:163], v[8:11], v[192:195]
    v_and_b32 v200, 0xffff0000, v33
    v_and_b32 v201, 0xffff0000, v35
    v_and_b32 v202, 0xffff0000, v37
    v_and_b32 v203, 0xffff0000, v39
    v_lshl_add_u32 v81, v81, 2, v74
    v_mfma_f32_16x16x32_bf16 v[192:195], v[164:167], v[12:15], v[192:195]
    v_mfma_f32_16x16x32_bf16 v[196:199], v[160:163], v[16:19], v[196:199]
    v_lshlrev_b32 v48, 16, v40
    v_lshlrev_b32 v49, 16, v42
    v_lshlrev_b32 v50, 16, v44
    v_lshlrev_b32 v51, 16, v46
    v_lshl_add_u32 v82, v82, 2, v74
    v_mfma_f32_16x16x32_bf16 v[196:199], v[164:167], v[20:23], v[196:199]
    v_mfma_f32_16x16x32_bf16 v[200:203], v[160:163], v[24:27], v[200:203]
    v_and_b32 v52, 0xffff0000, v40
    v_and_b32 v53, 0xffff0000, v42
    v_and_b32 v54, 0xffff0000, v44
    v_and_b32 v55, 0xffff0000, v46
    v_lshl_add_u32 v83, v83, 2, v74
    v_mfma_f32_16x16x32_bf16 v[200:203], v[164:167], v[28:31], v[200:203]
    v_mfma_f32_16x16x32_bf16 v[48:51], v[168:171], v[0:3], v[48:51]
    v_lshlrev_b32 v56, 16, v41
    v_lshlrev_b32 v57, 16, v43
    v_lshlrev_b32 v58, 16, v45
    v_lshlrev_b32 v59, 16, v47
    v_lshl_add_u32 v84, v84, 2, v75
    v_mfma_f32_16x16x32_bf16 v[48:51], v[172:175], v[4:7], v[48:51]
    v_mfma_f32_16x16x32_bf16 v[52:55], v[168:171], v[8:11], v[52:55]
    v_and_b32 v60, 0xffff0000, v41
    v_and_b32 v61, 0xffff0000, v43
    v_and_b32 v62, 0xffff0000, v45
    v_and_b32 v63, 0xffff0000, v47
    v_lshl_add_u32 v85, v85, 2, v75
    v_mfma_f32_16x16x32_bf16 v[52:55], v[172:175], v[12:15], v[52:55]
    v_mfma_f32_16x16x32_bf16 v[56:59], v[168:171], v[16:19], v[56:59]
    v_lshl_add_u32 v86, v86, 2, v75
    v_mfma_f32_16x16x32_bf16 v[56:59], v[172:175], v[20:23], v[56:59]
    v_mfma_f32_16x16x32_bf16 v[60:63], v[168:171], v[24:27], v[60:63]
    v_lshl_add_u32 v87, v87, 2, v75
    v_mfma_f32_16x16x32_bf16 v[60:63], v[172:175], v[28:31], v[60:63]
L_EPB:
    s_setprio 0
    s_mov_b64 exec, s[76:77]
    s_and_b32 s11, s25, 19
    s_nop 2
    s_cmp_eq_u32 s11, 0
    s_cbranch_scc1 L_NS0
    s_cmp_eq_u32 s11, 1
    s_cbranch_scc1 L_NS1
    s_cmp_eq_u32 s11, 2
    s_cbranch_scc1 L_NS2
    s_cmp_eq_u32 s11, 3
    s_cbranch_scc1 L_NS3
L_NSR:
    s_mov_b64 exec, -1
    v_rcp_f32 v96, v96
    v_rcp_f32 v97, v97
    v_rcp_f32 v98, v98
    v_rcp_f32 v99, v99
    v_rcp_f32 v100, v100
    v_rcp_f32 v101, v101
    v_rcp_f32 v102, v102
    v_rcp_f32 v103, v103
    v_rcp_f32 v104, v104
    v_rcp_f32 v105, v105
    v_rcp_f32 v106, v106
    v_rcp_f32 v107, v107
    v_rcp_f32 v108, v108
    v_rcp_f32 v109, v109
    v_rcp_f32 v110, v110
    v_rcp_f32 v111, v111
    v_pk_fma_f32 v[112:113], v[112:113], v[96:97], v[188:189]
    v_pk_fma_f32 v[114:115], v[114:115], v[98:99], v[190:191]
    v_pk_fma_f32 v[116:117], v[116:117], v[100:101], v[192:193]
    v_pk_fma_f32 v[118:119], v[118:119], v[102:103], v[194:195]
    v_pk_fma_f32 v[120:121], v[120:121], v[104:105], v[196:197]
    v_pk_fma_f32 v[122:123], v[122:123], v[106:107], v[198:199]
    v_pk_fma_f32 v[124:125], v[124:125], v[108:109], v[200:201]
    v_pk_fma_f32 v[126:127], v[126:127], v[110:111], v[202:203]
    v_cvt_pk_bf16_f32 v96, v112, v116
    v_cvt_pk_bf16_f32 v97, v120, v124
    v_pk_max_f16 v96, v96, v32
    v_pk_max_f16 v97, v97, v33
    buffer_store_dwordx2 v[96:97], v80, s[48:51], 0 offen sc1
    v_cvt_pk_bf16_f32 v98, v113, v117
    v_cvt_pk_bf16_f32 v99, v121, v125
    v_pk_max_f16 v98, v98, v34
    v_pk_max_f16 v99, v99, v35
    buffer_store_dwordx2 v[98:99], v81, s[48:51], 0 offen sc1
    v_cvt_pk_bf16_f32 v100, v114, v118
    v_cvt_pk_bf16_f32 v101, v122, v126
    v_pk_max_f16 v100, v100, v36
    v_pk_max_f16 v101, v101, v37
    buffer_store_dwordx2 v[100:101], v82, s[48:51], 0 offen sc1
    v_cvt_pk_bf16_f32 v102, v115, v119
    v_cvt_pk_bf16_f32 v103, v123, v127
    v_pk_max_f16 v102, v102, v38
    v_pk_max_f16 v103, v103, v39
    buffer_store_dwordx2 v[102:103], v83, s[48:51], 0 offen sc1
    v_rcp_f32 v128, v128
    v_rcp_f32 v129, v129
    v_rcp_f32 v130, v130
    v_rcp_f32 v131, v131
    v_rcp_f32 v132, v132
    v_rcp_f32 v133, v133
    v_rcp_f32 v134, v134
    v_rcp_f32 v135, v135
    v_rcp_f32 v136, v136
    v_rcp_f32 v137, v137
    v_rcp_f32 v138, v138
    v_rcp_f32 v139, v139
    v_rcp_f32 v140, v140
    v_rcp_f32 v141, v141
    v_rcp_f32 v142, v142
    v_rcp_f32 v143, v143
    v_pk_fma_f32 v[144:145], v[144:145], v[128:129], v[48:49]
    v_pk_fma_f32 v[146:147], v[146:147], v[130:131], v[50:51]
    v_pk_fma_f32 v[148:149], v[148:149], v[132:133], v[52:53]
    v_pk_fma_f32 v[150:151], v[150:151], v[134:135], v[54:55]
    v_pk_fma_f32 v[152:153], v[152:153], v[136:137], v[56:57]
    v_pk_fma_f32 v[154:155], v[154:155], v[138:139], v[58:59]
    v_pk_fma_f32 v[156:157], v[156:157], v[140:141], v[60:61]
    v_pk_fma_f32 v[158:159], v[158:159], v[142:143], v[62:63]
    v_cvt_pk_bf16_f32 v128, v144, v148
    v_cvt_pk_bf16_f32 v129, v152, v156
    v_pk_max_f16 v128, v128, v40
    v_pk_max_f16 v129, v129, v41
    buffer_store_dwordx2 v[128:129], v84, s[60:63], 0 offen sc1
    v_cvt_pk_bf16_f32 v130, v145, v149
    v_cvt_pk_bf16_f32 v131, v153, v157
    v_pk_max_f16 v130, v130, v42
    v_pk_max_f16 v131, v131, v43
    buffer_store_dwordx2 v[130:131], v85, s[60:63], 0 offen sc1
    v_cvt_pk_bf16_f32 v132, v146, v150
    v_cvt_pk_bf16_f32 v133, v154, v158
    v_pk_max_f16 v132, v132, v44
    v_pk_max_f16 v133, v133, v45
    buffer_store_dwordx2 v[132:133], v86, s[60:63], 0 offen sc1
    v_cvt_pk_bf16_f32 v134, v147, v151
    v_cvt_pk_bf16_f32 v135, v155, v159
    v_pk_max_f16 v134, v134, v46
    v_pk_max_f16 v135, v135, v47
    buffer_store_dwordx2 v[134:135], v87, s[60:63], 0 offen sc1
L_END:
    s_endpgm
L_NS0:
    v_add_f32 v96, v96, v128
    v_add_f32 v100, v100, v132
    v_add_f32 v104, v104, v136
    v_add_f32 v108, v108, v140
    v_add_f32 v112, v112, v144
    v_add_f32 v116, v116, v148
    v_add_f32 v120, v120, v152
    v_add_f32 v124, v124, v156
    s_branch L_NSR
L_NS1:
    v_add_f32 v97, v97, v129
    v_add_f32 v101, v101, v133
    v_add_f32 v105, v105, v137
    v_add_f32 v109, v109, v141
    v_add_f32 v113, v113, v145
    v_add_f32 v117, v117, v149
    v_add_f32 v121, v121, v153
    v_add_f32 v125, v125, v157
    s_branch L_NSR
L_NS2:
    v_add_f32 v98, v98, v130
    v_add_f32 v102, v102, v134
    v_add_f32 v106, v106, v138
    v_add_f32 v110, v110, v142
    v_add_f32 v114, v114, v146
    v_add_f32 v118, v118, v150
    v_add_f32 v122, v122, v154
    v_add_f32 v126, v126, v158
    s_branch L_NSR
L_NS3:
    v_add_f32 v99, v99, v131
    v_add_f32 v103, v103, v135
    v_add_f32 v107, v107, v139
    v_add_f32 v111, v111, v143
    v_add_f32 v115, v115, v147
    v_add_f32 v119, v119, v151
    v_add_f32 v123, v123, v155
    v_add_f32 v127, v127, v159
    s_branch L_NSR
L_RT0:
    s_waitcnt vmcnt(0)
    s_add_u32 s100, s100, 1
    s_cmp_gt_u32 s100, 200000
    s_cbranch_scc1 L_END
    s_sleep 1
    buffer_load_dwordx4 v[128:131], v232, s[56:59], 0 offen sc1
    buffer_load_dwordx4 v[132:135], v232, s[56:59], s26 offen sc1
    buffer_load_dwordx4 v[136:139], v232, s[56:59], s27 offen sc1
    buffer_load_dwordx4 v[140:143], v232, s[56:59], s28 offen sc1
    s_waitcnt vmcnt(0)
    s_branch L_PW0
L_RT1:
    s_waitcnt vmcnt(0)
    s_add_u32 s100, s100, 1
    s_cmp_gt_u32 s100, 200000
    s_cbranch_scc1 L_END
    s_sleep 1
    buffer_load_dwordx4 v[132:135], v232, s[56:59], s26 offen sc1
    buffer_load_dwordx4 v[136:139], v232, s[56:59], s27 offen sc1
    buffer_load_dwordx4 v[140:143], v232, s[56:59], s28 offen sc1
    s_waitcnt vmcnt(0)
    s_branch L_PW1
L_RT2:
    s_waitcnt vmcnt(0)
    s_add_u32 s100, s100, 1
    s_cmp_gt_u32 s100, 200000
    s_cbranch_scc1 L_END
    s_sleep 1
    buffer_load_dwordx4 v[136:139], v232, s[56:59], s27 offen sc1
    buffer_load_dwordx4 v[140:143], v232, s[56:59], s28 offen sc1
    s_waitcnt vmcnt(0)
    s_branch L_PW2
L_RT3:
    s_waitcnt vmcnt(0)
    s_add_u32 s100, s100, 1
    s_cmp_gt_u32 s100, 200000
    s_cbranch_scc1 L_END
    s_sleep 1
    buffer_load_dwordx4 v[140:143], v232, s[56:59], s28 offen sc1
    s_waitcnt vmcnt(0)
    s_branch L_PW3
L_XT2B:
    s_add_u32 s100, s100, 1
    s_cmp_gt_u32 s100, 200000
    s_cbranch_scc1 L_END
    s_sleep 1
    s_mov_b64 exec, s[70:71]
    s_cbranch_execz L_XLb0
    s_movk_i32 s10, 0
    buffer_load_dwordx4 v[64:67], v232, s[60:63], s10 offen sc1
L_XLb0:
    s_mov_b64 exec, s[78:79]
    s_cbranch_execz L_XLb1
    s_movk_i32 s10, 8192
    buffer_load_dwordx4 v[68:71], v232, s[60:63], s10 offen sc1
L_XLb1:
    s_mov_b64 exec, s[86:87]
    s_cbranch_execz L_XLb2
    s_movk_i32 s10, 16384
    buffer_load_dwordx4 v[72:75], v232, s[60:63], s10 offen sc1
L_XLb2:
    s_mov_b64 exec, s[94:95]
    s_cbranch_execz L_XLb3
    s_movk_i32 s10, 24576
    buffer_load_dwordx4 v[76:79], v232, s[60:63], s10 offen sc1
L_XLb3:
    s_mov_b64 exec, -1
    s_waitcnt vmcnt(0)
    s_branch L_XT2
L_OVF:
    s_mov_b32 s20, 0
    s_mov_b32 s17, 0
    s_mov_b32 s30, 0
    s_mov_b32 s19, 4
    s_waitcnt lgkmcnt(0)
    s_branch L_CA
L_POVF:
    s_movk_i32 s11, 1986
    v_mul_u32_u24 v64, s11, v192
    v_lshrrev_b32 v64, 16, v64
    v_mul_u32_u24 v65, s11, v193
    v_lshrrev_b32 v65, 16, v65
    v_mul_u32_u24 v66, s11, v194
    v_lshrrev_b32 v66, 16, v66
    v_mul_u32_u24 v67, s11, v195
    v_lshrrev_b32 v67, 16, v67
    v_add_u32 v69, v64, v65
    v_add_u32 v70, v69, v66
    v_add_u32 v71, v70, v67
    v_mov_b32 v72, v71
    s_nop 1
    v_add_u32_dpp v72, v72, v72 row_shr:1 row_mask:0xf bank_mask:0xf bound_ctrl:0
    s_nop 1
    v_add_u32_dpp v72, v72, v72 row_shr:2 row_mask:0xf bank_mask:0xf bound_ctrl:0
    s_nop 1
    v_add_u32_dpp v72, v72, v72 row_shr:4 row_mask:0xf bank_mask:0xf bound_ctrl:0
    s_nop 1
    v_add_u32_dpp v72, v72, v72 row_shr:8 row_mask:0xf bank_mask:0xf bound_ctrl:0
    s_nop 1
    v_add_u32_dpp v72, v72, v72 row_bcast:15 row_mask:0xa bank_mask:0xf
    s_nop 1
    v_add_u32_dpp v72, v72, v72 row_bcast:31 row_mask:0xc bank_mask:0xf
    s_nop 0
    v_sub_u32 v68, v72, v71
    v_add_u32 v71, v68, v70
    v_add_u32 v70, v68, v69
    v_add_u32 v69, v68, v64
    v_lshl_or_b32 v68, v64, 16, v68
    v_lshl_or_b32 v69, v65, 16, v69
    v_lshl_or_b32 v70, v66, 16, v70
    v_lshl_or_b32 v71, v67, 16, v71
    v_add_u32 v72, 154752, v185
    ds_write_b128 v72, v[68:71]
    s_lshl_b32 s10, s2, 10
    s_add_u32 s10, s10, 24772608
    buffer_store_dwordx4 v[68:71], v185, s[52:55], s10 offen sc1
    v_and_b32 v74, 0x3fc, v136
    v_add_u32 v74, 154752, v74
    ds_read_u16 v74, v74
    v_and_b32 v75, 0x3fc, v137
    v_add_u32 v75, 154752, v75
    ds_read_u16 v75, v75
    v_and_b32 v76, 0x3fc, v138
    v_add_u32 v76, 154752, v76
    ds_read_u16 v76, v76
    v_and_b32 v77, 0x3fc, v139
    v_add_u32 v77, 154752, v77
    ds_read_u16 v77, v77
    v_and_b32 v78, 0x3fc, v140
    v_add_u32 v78, 154752, v78
    ds_read_u16 v78, v78
    v_and_b32 v79, 0x3fc, v141
    v_add_u32 v79, 154752, v79
    ds_read_u16 v79, v79
    v_and_b32 v80, 0x3fc, v142
    v_add_u32 v80, 154752, v80
    ds_read_u16 v80, v80
    v_and_b32 v81, 0x3fc, v143
    v_add_u32 v81, 154752, v81
    ds_read_u16 v81, v81
    s_waitcnt lgkmcnt(0)
    v_cmpx_lt_u32 vcc, 1056, v228
    v_or_b32 v205, 0x10000, v205
    s_mov_b64 exec, -1
    v_cmpx_lt_u32 vcc, 1056, v229
    v_or_b32 v209, 0x10000, v209
    s_mov_b64 exec, -1
    v_cmpx_lt_u32 vcc, 1056, v230
    v_or_b32 v213, 0x10000, v213
    s_mov_b64 exec, -1
    v_cmpx_lt_u32 vcc, 1056, v231
    v_or_b32 v217, 0x10000, v217
    s_mov_b64 exec, -1
    s_mul_i32 s10, s2, 4152
    s_mov_b32 s34, 18874368
    s_mov_b32 s35, 23592960
    v_mul_u32_u24 v64, s11, v112
    v_lshrrev_b32 v64, 16, v64
    v_add3_u32 v64, v64, v74, s10
    v_lshlrev_b32 v65, 2, v64
    v_cmpx_le_u32 vcc, 1056, v112
    s_cbranch_execz L_PO0
    buffer_store_byte v120, v64, s[52:55], s35 offen sc1
    buffer_store_dword v96, v65, s[52:55], s34 offen sc1
L_PO0:
    s_mov_b64 exec, -1
    v_mul_u32_u24 v64, s11, v113
    v_lshrrev_b32 v64, 16, v64
    v_add3_u32 v64, v64, v75, s10
    v_lshlrev_b32 v65, 2, v64
    v_cmpx_le_u32 vcc, 1056, v113
    s_cbranch_execz L_PO1
    buffer_store_byte v121, v64, s[52:55], s35 offen sc1
    buffer_store_dword v97, v65, s[52:55], s34 offen sc1
L_PO1:
    s_mov_b64 exec, -1
    v_mul_u32_u24 v64, s11, v114
    v_lshrrev_b32 v64, 16, v64
    v_add3_u32 v64, v64, v76, s10
    v_lshlrev_b32 v65, 2, v64
    v_cmpx_le_u32 vcc, 1056, v114
    s_cbranch_execz L_PO2
    buffer_store_byte v122, v64, s[52:55], s35 offen sc1
    buffer_store_dword v98, v65, s[52:55], s34 offen sc1
L_PO2:
    s_mov_b64 exec, -1
    v_mul_u32_u24 v64, s11, v115
    v_lshrrev_b32 v64, 16, v64
    v_add3_u32 v64, v64, v77, s10
    v_lshlrev_b32 v65, 2, v64
    v_cmpx_le_u32 vcc, 1056, v115
    s_cbranch_execz L_PO3
    buffer_store_byte v123, v64, s[52:55], s35 offen sc1
    buffer_store_dword v99, v65, s[52:55], s34 offen sc1
L_PO3:
    s_mov_b64 exec, -1
    v_mul_u32_u24 v64, s11, v116
    v_lshrrev_b32 v64, 16, v64
    v_add3_u32 v64, v64, v78, s10
    v_lshlrev_b32 v65, 2, v64
    v_cmpx_le_u32 vcc, 1056, v116
    s_cbranch_execz L_PO4
    buffer_store_byte v120, v64, s[52:55], s35 offen sc1
    buffer_store_dword v100, v65, s[52:55], s34 offen sc1
L_PO4:
    s_mov_b64 exec, -1
    v_mul_u32_u24 v64, s11, v117
    v_lshrrev_b32 v64, 16, v64
    v_add3_u32 v64, v64, v79, s10
    v_lshlrev_b32 v65, 2, v64
    v_cmpx_le_u32 vcc, 1056, v117
    s_cbranch_execz L_PO5
    buffer_store_byte v121, v64, s[52:55], s35 offen sc1
    buffer_store_dword v101, v65, s[52:55], s34 offen sc1
L_PO5:
    s_mov_b64 exec, -1
    v_mul_u32_u24 v64, s11, v118
    v_lshrrev_b32 v64, 16, v64
    v_add3_u32 v64, v64, v80, s10
    v_lshlrev_b32 v65, 2, v64
    v_cmpx_le_u32 vcc, 1056, v118
    s_cbranch_execz L_PO6
    buffer_store_byte v122, v64, s[52:55], s35 offen sc1
    buffer_store_dword v102, v65, s[52:55], s34 offen sc1
L_PO6:
    s_mov_b64 exec, -1
    v_mul_u32_u24 v64, s11, v119
    v_lshrrev_b32 v64, 16, v64
    v_add3_u32 v64, v64, v81, s10
    v_lshlrev_b32 v65, 2, v64
    v_cmpx_le_u32 vcc, 1056, v119
    s_cbranch_execz L_PO7
    buffer_store_byte v123, v64, s[52:55], s35 offen sc1
    buffer_store_dword v103, v65, s[52:55], s34 offen sc1
L_PO7:
    s_mov_b64 exec, -1
    s_waitcnt vmcnt(0) lgkmcnt(0)
    s_barrier
    s_branch L_POUT
L_SLOW:
    s_setprio 0
    s_lshl_b32 s10, s3, 6
    v_add_u32 v255, s10, v253
    s_cmp_lg_u32 s19, 4
    s_cbranch_scc1 L_SL1
    s_mov_b32 s19, 1
    v_and_b32 v188, 0xff, v255
    v_lshlrev_b32 v189, 7, v188
    buffer_load_dword v190, v189, s[56:59], 0 offen offset:4 sc1
    v_lshlrev_b32 v189, 10, v188
    s_lshl_b32 s10, s5, 2
    s_add_u32 s10, s10, 24772608
    buffer_load_dword v191, v189, s[52:55], s10 offen sc1
    v_lshlrev_b32 v188, 2, v188
    v_add_u32 v188, 154752, v188
    s_waitcnt vmcnt(0)
    v_and_b32 v190, 0x10000, v190
    v_cmp_ne_u32 vcc, 0, v190
    v_mov_b32 v190, 2097152
    s_nop 0
    v_cndmask_b32 v190, v190, v191, vcc
    ds_write_b32 v188, v190
    s_waitcnt lgkmcnt(0)
    s_barrier
L_SL1:
    s_add_u32 s28, s28, 288
    s_cmp_lt_u32 s28, s29
    s_cbranch_scc1 L_BATCH
L_FIND:
    s_cmp_lg_u64 s[32:33], 0
    s_cbranch_scc1 L_GOT
    s_add_u32 s26, s26, 1
    s_cmp_ge_u32 s26, 4
    s_cbranch_scc1 L_EPI
    s_lshl_b32 s10, s26, 8
    s_add_u32 s10, s10, 154752
    v_lshl_add_u32 v188, v253, 2, s10
    ds_read_u16 v188, v188 offset:2
    s_waitcnt lgkmcnt(0)
    v_cmp_lt_u32 s[32:33], s20, v188
    s_nop 3
    s_branch L_FIND
L_GOT:
    s_ff1_i32_b64 s10, s[32:33]
    s_bitset0_b64 s[32:33], s10
    s_lshl_b32 s11, s26, 6
    s_add_u32 s27, s10, s11
    s_lshl_b32 s10, s27, 2
    s_add_u32 s10, s10, 154752
    v_mov_b32 v188, s10
    ds_read_b32 v188, v188
    s_waitcnt lgkmcnt(0)
    v_readfirstlane_b32 s10, v188
    s_nop 3
    s_lshr_b32 s29, s10, 16
    s_and_b32 s30, s10, 0xffff
    s_mov_b32 s28, s20
L_BATCH:
    s_waitcnt vmcnt(0)
    s_barrier
    v_mov_b64 v[192:193], 0
    v_mov_b64 v[194:195], 0
    v_mov_b32 v196, 0x20fffff
    v_mov_b32 v197, 0x20fffff
    v_mov_b32 v198, 0x20fffff
    v_mov_b32 v199, 0x20fffff
    v_lshl_add_u32 v200, v253, 4, s12
    ds_write_b128 v200, v[192:195] offset:0
    ds_write_b128 v200, v[196:199] offset:18432
    ds_write_b128 v200, v[192:195] offset:1024
    ds_write_b128 v200, v[196:199] offset:19456
    ds_write_b128 v200, v[192:195] offset:1280
    ds_write_b128 v200, v[196:199] offset:19712
    v_and_b32 v188, 15, v253
    v_mul_u32_u24 v189, 1152, v188
    v_add_u32 v189, 8192, v189
    v_lshlrev_b32 v188, 2, v188
    ds_write_b32 v188, v189 offset:576
    v_add_u32 v188, s28, v255
    s_mul_i32 s36, s27, 3128
    s_mul_i32 s11, s27, 4152
    s_add_u32 s11, s11, s30
    s_lshl_b32 s34, s11, 2
    s_add_u32 s34, s34, 18874368
    v_lshl_add_u32 v190, v188, 2, s34
    s_add_u32 s34, s11, 23592960
    v_add_u32 v191, s34, v188
    s_mul_i32 s10, s5, 32896
    s_lshl_b32 s34, s27, 7
    s_add_u32 s10, s10, s34
    s_add_u32 s10, s10, 65536
    v_and_b32 v206, 7, v188
    v_lshl_add_u32 v206, v206, 4, s10
    v_lshrrev_b32 v207, 3, v188
    v_cmpx_gt_u32 vcc, 32, v188
    v_add_u32 v190, 8421376, v206
    v_add_u32 v191, 8, v190
    v_cmpx_gt_u32 vcc, 24, v188
    v_lshl_add_u32 v190, v207, 2, v206
    v_add3_u32 v191, v206, v207, 12
    s_mov_b64 exec, -1
    s_add_u32 s10, s28, 288
    s_min_u32 s10, s10, s29
    v_cmp_gt_u32 vcc, s10, v188
    v_mov_b32 v206, 0x7ffffff0
    s_nop 0
    v_cndmask_b32 v190, v206, v190, vcc
    v_cndmask_b32 v191, v206, v191, vcc
    buffer_load_dwordx2 v[204:205], v190, s[52:55], 0 offen sc1
    buffer_load_ubyte v191, v191, s[52:55], 0 offen sc1
    s_waitcnt lgkmcnt(0)
    s_barrier
    s_waitcnt vmcnt(0)
    v_cmp_ne_u32 vcc, 3, v207
    v_cmp_eq_u32 s[10:11], s6, v205
    v_mov_b32 v206, s36
    s_or_b64 exec, vcc, s[10:11]
    v_cmpx_ne_u32 vcc, 0, v204
    v_bfe_u32 v190, v204, 18, 8
    v_lshlrev_b32 v190, 2, v190
    v_add_u32 v188, 153728, v190
    ds_read_b32 v188, v188
    v_add_u32_sdwa v191, v191, v206 dst_sel:DWORD dst_unused:UNUSED_PAD src0_sel:BYTE_0 src1_sel:DWORD
    v_lshrrev_b32 v189, 28, v204
    v_lshl_add_u32 v191, v189, 8, v191
    v_and_b32 v189, 60, v190
    v_lshl_add_u32 v191, v189, 19, v191
    v_mov_b32 v190, 4
    v_and_b32 v204, 0xffff, v204
    s_waitcnt lgkmcnt(0)
    ds_add_rtn_u32 v188, v188, v190 offset:576
    s_waitcnt lgkmcnt(0)
    ds_write2st64_b32 v188, v204, v191 offset0:148 offset1:220
    s_mov_b64 exec, -1
    s_waitcnt lgkmcnt(0)
    s_barrier
    v_lshrrev_b32 v190, 3, v253
    v_lshl_add_u32 v247, v190, 4, s12
    s_add_u32 s10, s12, 18432
    v_lshrrev_b32 v190, 1, v253
    v_lshl_add_u32 v248, v190, 2, s10
    s_add_u32 s10, s10, 2
    v_and_b32 v190, 48, v253
    v_lshl_add_u32 v250, v190, 1, s10
    v_and_b32 v190, 12, v253
    v_add_u32 v250, v250, v190
    v_lshrrev_b32 v190, 5, v253
    v_mul_u32_u24 v249, 18432, v190
    v_and_b32 v190, 15, v253
    v_lshl_add_u32 v249, v190, 2, v249
    s_add_u32 s10, s12, 2
    v_add_u32 v249, s10, v249
    ds_read_b128 v[236:239], v247
    ds_read_b32 v240, v248
    s_lshl_b32 s10, s4, 3
    v_mov_b32 v190, s10
    ds_read_b64 v[190:191], v190 offset:576
    s_waitcnt lgkmcnt(0)
    v_readfirstlane_b32 s34, v190
    v_readfirstlane_b32 s35, v191
    s_sub_u32 s10, s12, 37888
    s_sub_u32 s34, s34, s10
    s_sub_u32 s35, s35, s10
    s_sub_u32 s35, s35, 1152
    s_add_u32 s10, s34, 127
    s_lshr_b32 s10, s10, 7
    s_lshl1_add_u32 s10, s10, -1
    s_add_u32 s11, s35, 127
    s_lshr_b32 s11, s11, 6
    s_and_b32 s11, s11, -2
    s_max_i32 s17, s10, s11
    s_cselect_b32 s10, s34, s35
    s_sub_u32 s10, s10, 1
    s_andn2_b32 s99, 64, s10
    s_add_u32 m0, s13, 0
    v_mad_u32_u16 v236, v236, s15, v243
    buffer_load_dwordx4 v236, s[40:43], 0 offen lds
    s_add_u32 m0, s13, 1056
    v_mad_u32_u16 v237, v237, s15, v243
    buffer_load_dwordx4 v237, s[40:43], 0 offen lds
    s_add_u32 m0, s13, 2112
    v_mad_u32_u16 v238, v238, s15, v243
    buffer_load_dwordx4 v238, s[40:43], 0 offen lds
    s_add_u32 m0, s13, 3168
    v_mad_u32_u16 v239, v239, s15, v243
    buffer_load_dwordx4 v239, s[40:43], 0 offen lds
    s_mov_b32 m0, s14
    v_and_b32 v240, 0xfffff, v240
    buffer_load_dwordx4 v[240:241], s[44:47], 0 idxen offen lds
L_LAST:
    s_branch L_GO
.section .rodata,"a"
.p2align 6
.amdhsa_kernel standalone__edge_featured_mpnn_gatedgcn__graph_kernel
  .amdhsa_next_free_vgpr 256
  .amdhsa_next_free_sgpr 102
  .amdhsa_accum_offset 256
  .amdhsa_group_segment_fixed_size 0
  .amdhsa_kernarg_size 96
  .amdhsa_user_sgpr_count 2
  .amdhsa_user_sgpr_kernarg_segment_ptr 1
  .amdhsa_system_sgpr_workgroup_id_x 1
.end_amdhsa_kernel
```

```asm
; @launch grid=(256,1,1) block=(512,1,1) lds=158848
.amdgcn_target "amdgcn-amd-amdhsa--gfx950"
.text
.globl standalone__edge_featured_mpnn_gatedgcn__graph_kernel
.p2align 8
.type standalone__edge_featured_mpnn_gatedgcn__graph_kernel,@function
standalone__edge_featured_mpnn_gatedgcn__graph_kernel:
    s_load_dwordx16 s[16:31], s[0:1], 0
    s_load_dwordx8 s[32:39], s[0:1], 64
    s_getpc_b64 s[64:65]
L_PC:
    s_and_b32 s3, s2, -8
    v_add_lshl_u32 v1, v0, s3, 7
    v_min_u32 v1, L_LAST-L_PC, v1
    v_cmpx_gt_u32 vcc, 8, v0
    s_cbranch_execz L_NOCPF
    global_load_dword v251, v1, s[64:65]
L_NOCPF:
    s_mov_b64 exec, -1
    s_cmp_ge_u32 s2, 256
    s_cbranch_scc1 L_END
    s_mul_i32 s10, s2, 12512
    v_lshl_add_u32 v1, v0, 4, s10
    s_add_u32 s11, s10, 12512
    s_min_u32 s11, s11, 3200000
    v_add_u32 v2, 0x2000, v1
    s_waitcnt lgkmcnt(0)
    global_load_dwordx4 v[128:131], v1, s[22:23] nt
    global_load_dwordx4 v[96:99], v1, s[20:21] nt
    v_cmpx_gt_u32 s[70:71], s11, v2
    s_cbranch_execz L_NO8
    global_load_dwordx4 v[132:135], v2, s[22:23] nt
    global_load_dwordx4 v[100:103], v2, s[20:21] nt
L_NO8:
    s_mov_b64 exec, -1
L_NO7:
    s_mov_b64 exec, -1
    s_load_dword s6, s[38:39], 0
    v_mov_b32 v255, v0
    v_lshrrev_b32 v188, 6, v0
    v_and_b32 v253, 63, v0
    v_readfirstlane_b32 s3, v188
    v_lshlrev_b32 v232, 4, v0
    v_lshlrev_b32 v190, 3, v0
    v_lshlrev_b32 v191, 2, v0
    v_and_b32 v192, 0x3fc, v191
    s_and_b32 s5, s2, 7
    s_lshr_b32 s4, s2, 3
    s_lshl_b32 s5, s5, 5
    s_add_u32 s5, s5, s4
    s_mul_i32 s9, s5, 196
    s_cmp_eq_u32 s3, 7
    s_cselect_b32 s101, 0, s3
    s_lshl_b32 s12, s101, 5
    s_add_u32 s9, s9, s12
    v_lshrrev_b32 v193, 3, v253
    v_lshl_add_u32 v193, v193, 2, s9
    v_and_b32 v243, 7, v253
    v_lshlrev_b32 v243, 4, v243
    v_lshl_add_u32 v234, v193, 7, v243
    s_lshl_b32 s101, s101, 10
    s_add_u32 s101, s101, 116736
    v_mov_b64 v[196:197], 0
    v_mov_b64 v[198:199], 0
    v_mov_b32 v194, 132
    ds_write2st64_b32 v192, v194, v196 offset0:20 offset1:24
    v_add_u32 v193, 46080, v232
    ds_write_b128 v193, v[196:199] offset:0
    ds_write_b128 v193, v[196:199] offset:8192
    ds_write_b128 v193, v[196:199] offset:16384
    ds_write_b128 v193, v[196:199] offset:24576
    ds_write_b128 v193, v[196:199] offset:32768
    s_mov_b32 s44, s18
    s_or_b32 s45, s19, 0x200000
    s_mov_b32 s46, 800000
    s_mov_b32 s47, 0x20000
    s_mov_b32 s48, s34
    s_mov_b32 s49, s35
    s_mov_b32 s50, 6400000
    s_mov_b32 s51, 0x20000
    s_mov_b32 s40, s16
    s_mov_b32 s41, s17
    s_mov_b32 s42, 6400000
    s_mov_b32 s43, 0x20000
    s_mov_b32 s52, s38
    s_mov_b32 s53, s39
    s_mov_b32 s54, 25165824
    s_mov_b32 s55, 0x20000
    s_lshl_b32 s12, s2, 7
    s_add_u32 s12, s12, 65536
    s_add_u32 s56, s38, s12
    s_addc_u32 s57, s39, 0
    s_mov_b32 s58, 16809984
    s_mov_b32 s59, 0x20000
    s_mov_b32 s64, 85599
    s_mov_b32 s65, 4294967100
    s_movk_i32 s66, 5368
    s_mov_b32 s67, 0xc000000
    s_mov_b32 s68, 32896
    v_add_u32 v120, 0, v191
    v_add_u32 v121, 1, v191
    v_add_u32 v122, 2, v191
    v_add_u32 v123, 3, v191
    s_lshl_b32 s10, s3, 28
    s_or_b32 s10, s10, 0x20000
    v_mov_b32 v144, s10
    v_or_b32 v145, 0x80000000, v144
    v_mov_b32 v184, 33
    v_mov_b32 v146, 0x400
    s_and_b32 s10, s3, 3
    s_lshr_b32 s4, s3, 2
    s_lshl1_add_u32 s4, s10, s4
    s_xor_b32 s4, s4, 1
    s_mul_i32 s10, s4, 49
    s_sub_i32 s10, s10, 6
    s_ashr_i32 s10, s10, 1
    s_max_i32 s7, s10, 0
    s_mul_i32 s13, s4, 4224
    s_add_u32 s13, s13, 82944
    s_lshl_b32 s14, s4, 10
    s_add_u32 s14, s14, 5120
    s_mul_i32 s12, s4, 2304
    s_add_u32 s12, s12, 46080
    s_movk_i32 s15, 128
    v_bfe_u32 v194, v255, 4, 4
    v_and_b32 v195, 7, v255
    v_cmp_eq_u32 vcc, v194, v195
    v_and_b32 v194, 8, v255
    v_lshlrev_b32 v194, 1, v194
    v_mov_b32 v196, 0x3f80
    v_lshlrev_b32 v196, v194, v196
    v_cndmask_b32 v196, 0, v196, vcc
    ds_write_b32 v192, v196 offset:0
    v_mov_b64 v[196:197], 0
    ds_write_b64 v190, v[196:197] offset:1024
    v_add_u32 v194, 155776, v191
    ds_write_b32 v194, v196
    v_lshrrev_b32 v223, 3, v255
    v_mad_u32_u24 v220, v223, s68, v243
    v_mul_u32_u24 v224, 160, v223
    v_add_u32 v221, v224, v243
    v_add_u32 v221, 46080, v221
    v_bfe_u32 v194, v255, 5, 1
    v_bfe_u32 v196, v255, 6, 1
    v_sub_u32 v194, v194, v196
    v_mul_i32_i24 v194, 640, v194
    v_add_u32 v224, v224, v194
    v_lshl_add_u32 v224, v195, 2, v224
    v_add_u32 v224, 13312, v224
    v_lshlrev_b32 v185, 4, v253
    v_and_b32 v194, 3, v253
    v_lshlrev_b32 v246, 3, v194
    v_bfe_u32 v197, v253, 2, 3
    v_lshrrev_b32 v196, 5, v253
    v_lshl_add_u32 v197, v196, 4, v197
    v_mul_u32_u24 v225, 160, v197
    v_add_u32 v225, v225, v246
    s_movk_i32 s69, 11520
    v_mov_b64 v[116:117], 0
    v_mov_b64 v[118:119], 0
    s_waitcnt lgkmcnt(0)
    s_barrier
    s_cmp_eq_u64 s[70:71], 0
    s_cbranch_scc1 L_R4
    s_waitcnt vmcnt(3)
    v_mul_u32_u24 v104, s64, v128
    v_mul_u32_u24 v105, s64, v129
    v_mul_u32_u24 v106, s64, v130
    v_mul_u32_u24 v107, s64, v131
    v_lshrrev_b32 v136, 29, v104
    v_lshrrev_b32 v137, 29, v105
    v_lshrrev_b32 v138, 29, v106
    v_lshrrev_b32 v139, 29, v107
    v_cmp_eq_u32 s[72:73], v136, v137
    v_cmp_eq_u32 s[76:77], v138, v139
    v_cmp_eq_u32 vcc, v136, v138
    v_cmp_eq_u32 s[88:89], v137, v139
    v_cmp_eq_u32 s[90:91], v136, v139
    v_cmp_eq_u32 s[10:11], v137, v138
    v_lshrrev_b32 v104, 24, v104
    v_lshrrev_b32 v105, 24, v105
    v_lshrrev_b32 v106, 24, v106
    v_lshrrev_b32 v107, 24, v107
    s_or_b64 s[74:75], s[72:73], s[88:89]
    s_or_b64 s[78:79], s[76:77], s[88:89]
    s_or_b64 s[72:73], s[72:73], vcc
    s_or_b64 s[76:77], s[76:77], vcc
    s_or_b64 s[72:73], s[72:73], s[90:91]
    s_or_b64 s[74:75], s[74:75], s[10:11]
    s_or_b64 s[76:77], s[76:77], s[10:11]
    s_or_b64 s[78:79], s[78:79], s[90:91]
    v_cndmask_b32 v136, 0, v146, s[72:73]
    v_lshl_add_u32 v136, v104, 2, v136
    ds_add_rtn_u32 v112, v136, v184 offset:5120
    v_cndmask_b32 v137, 0, v146, s[74:75]
    v_lshl_add_u32 v137, v105, 2, v137
    ds_add_rtn_u32 v113, v137, v184 offset:5120
    v_cndmask_b32 v138, 0, v146, s[76:77]
    v_lshl_add_u32 v138, v106, 2, v138
    ds_add_rtn_u32 v114, v138, v184 offset:5120
    v_cndmask_b32 v139, 0, v146, s[78:79]
    v_lshl_add_u32 v139, v107, 2, v139
    ds_add_rtn_u32 v115, v139, v184 offset:5120
    s_waitcnt vmcnt(1)
    s_mov_b64 exec, s[70:71]
    v_mul_u32_u24 v108, s64, v132
    v_mul_u32_u24 v109, s64, v133
    v_mul_u32_u24 v110, s64, v134
    v_mul_u32_u24 v111, s64, v135
    v_lshrrev_b32 v108, 24, v108
    v_lshrrev_b32 v109, 24, v109
    v_lshrrev_b32 v110, 24, v110
    v_lshrrev_b32 v111, 24, v111
    v_lshlrev_b32 v140, 2, v108
    ds_add_rtn_u32 v116, v140, v184 offset:5120
    v_lshlrev_b32 v141, 2, v109
    ds_add_rtn_u32 v117, v141, v184 offset:5120
    v_lshlrev_b32 v142, 2, v110
    ds_add_rtn_u32 v118, v142, v184 offset:5120
    v_lshlrev_b32 v143, 2, v111
    ds_add_rtn_u32 v119, v143, v184 offset:5120
    s_waitcnt lgkmcnt(7)
    s_mov_b64 exec, s[72:73]
    v_cmpx_le_u32 vcc, 132, v112
    ds_add_rtn_u32 v112, v136, v184 offset:4096
    s_waitcnt lgkmcnt(7)
    s_mov_b64 exec, s[74:75]
    v_cmpx_le_u32 vcc, 132, v113
    ds_add_rtn_u32 v113, v137, v184 offset:4096
    s_waitcnt lgkmcnt(7)
    s_mov_b64 exec, s[76:77]
    v_cmpx_le_u32 vcc, 132, v114
    ds_add_rtn_u32 v114, v138, v184 offset:4096
    s_waitcnt lgkmcnt(7)
    s_mov_b64 exec, s[78:79]
    v_cmpx_le_u32 vcc, 132, v115
    ds_add_rtn_u32 v115, v139, v184 offset:4096
    s_mov_b64 exec, s[70:71]
    s_waitcnt vmcnt(0)
    v_mad_i32_i24 v132, v108, s65, v132
    v_mul_u32_u24 v194, s66, v100
    v_lshl_or_b32 v100, v132, 18, v100
    v_and_or_b32 v194, v194, s67, v145
    v_mad_u32_u24 v132, v108, 40, s69
    v_or_b32 v100, v100, v194
    v_mad_i32_i24 v133, v109, s65, v133
    v_mul_u32_u24 v194, s66, v101
    v_lshl_or_b32 v101, v133, 18, v101
    v_and_or_b32 v194, v194, s67, v145
    v_mad_u32_u24 v133, v109, 40, s69
    v_or_b32 v101, v101, v194
    v_mad_i32_i24 v134, v110, s65, v134
    v_mul_u32_u24 v194, s66, v102
    v_lshl_or_b32 v102, v134, 18, v102
    v_and_or_b32 v194, v194, s67, v145
    v_mad_u32_u24 v134, v110, 40, s69
    v_or_b32 v102, v102, v194
    v_mad_i32_i24 v135, v111, s65, v135
    v_mul_u32_u24 v194, s66, v103
    v_lshl_or_b32 v103, v135, 18, v103
    v_and_or_b32 v194, v194, s67, v145
    v_mad_u32_u24 v135, v111, 40, s69
    v_or_b32 v103, v103, v194
    s_waitcnt lgkmcnt(7)
    v_bfe_u32 v194, v116, 3, 5
    v_add_lshl_u32 v132, v194, v132, 2
    v_and_b32 v194, 3, v194
    v_mad_i32_i24 v194, v194, -3, v132
    v_cmpx_gt_u32 vcc, 792, v116
    ds_write_b32 v132, v100
    ds_write_b8 v194, v120 offset:12
    s_mov_b64 exec, s[70:71]
    s_waitcnt lgkmcnt(8)
    v_bfe_u32 v194, v117, 3, 5
    v_add_lshl_u32 v133, v194, v133, 2
    v_and_b32 v194, 3, v194
    v_mad_i32_i24 v194, v194, -3, v133
    v_cmpx_gt_u32 vcc, 792, v117
    ds_write_b32 v133, v101
    ds_write_b8 v194, v121 offset:12
    s_mov_b64 exec, s[70:71]
    s_waitcnt lgkmcnt(9)
    v_bfe_u32 v194, v118, 3, 5
    v_add_lshl_u32 v134, v194, v134, 2
    v_and_b32 v194, 3, v194
    v_mad_i32_i24 v194, v194, -3, v134
    v_cmpx_gt_u32 vcc, 792, v118
    ds_write_b32 v134, v102
    ds_write_b8 v194, v122 offset:12
    s_mov_b64 exec, s[70:71]
    s_waitcnt lgkmcnt(10)
    v_bfe_u32 v194, v119, 3, 5
    v_add_lshl_u32 v135, v194, v135, 2
    v_and_b32 v194, 3, v194
    v_mad_i32_i24 v194, v194, -3, v135
    v_cmpx_gt_u32 vcc, 792, v119
    ds_write_b32 v135, v103
    ds_write_b8 v194, v123 offset:12
    s_mov_b64 exec, -1
    v_mad_i32_i24 v128, v104, s65, v128
    v_mul_u32_u24 v194, s66, v96
    v_lshl_or_b32 v96, v128, 18, v96
    v_and_or_b32 v194, v194, s67, v144
    v_mad_u32_u24 v128, v104, 40, s69
    v_or_b32 v96, v96, v194
    v_mad_i32_i24 v129, v105, s65, v129
    v_mul_u32_u24 v194, s66, v97
    v_lshl_or_b32 v97, v129, 18, v97
    v_and_or_b32 v194, v194, s67, v144
    v_mad_u32_u24 v129, v105, 40, s69
    v_or_b32 v97, v97, v194
    v_mad_i32_i24 v130, v106, s65, v130
    v_mul_u32_u24 v194, s66, v98
    v_lshl_or_b32 v98, v130, 18, v98
    v_and_or_b32 v194, v194, s67, v144
    v_mad_u32_u24 v130, v106, 40, s69
    v_or_b32 v98, v98, v194
    v_mad_i32_i24 v131, v107, s65, v131
    v_mul_u32_u24 v194, s66, v99
    v_lshl_or_b32 v99, v131, 18, v99
    v_and_or_b32 v194, v194, s67, v144
    v_mad_u32_u24 v131, v107, 40, s69
    v_or_b32 v99, v99, v194
    s_waitcnt lgkmcnt(11)
    v_bfe_u32 v194, v112, 3, 5
    v_add_lshl_u32 v128, v194, v128, 2
    v_and_b32 v194, 3, v194
    v_mad_i32_i24 v194, v194, -3, v128
    v_cmpx_gt_u32 vcc, 792, v112
    ds_write_b32 v128, v96
    ds_write_b8 v194, v120 offset:12
    s_mov_b64 exec, -1
    s_waitcnt lgkmcnt(12)
    v_bfe_u32 v194, v113, 3, 5
    v_add_lshl_u32 v129, v194, v129, 2
    v_and_b32 v194, 3, v194
    v_mad_i32_i24 v194, v194, -3, v129
    v_cmpx_gt_u32 vcc, 792, v113
    ds_write_b32 v129, v97
    ds_write_b8 v194, v121 offset:12
    s_mov_b64 exec, -1
    s_waitcnt lgkmcnt(13)
    v_bfe_u32 v194, v114, 3, 5
    v_add_lshl_u32 v130, v194, v130, 2
    v_and_b32 v194, 3, v194
    v_mad_i32_i24 v194, v194, -3, v130
    v_cmpx_gt_u32 vcc, 792, v114
    ds_write_b32 v130, v98
    ds_write_b8 v194, v122 offset:12
    s_mov_b64 exec, -1
    s_waitcnt lgkmcnt(14)
    v_bfe_u32 v194, v115, 3, 5
    v_add_lshl_u32 v131, v194, v131, 2
    v_and_b32 v194, 3, v194
    v_mad_i32_i24 v194, v194, -3, v131
    v_cmpx_gt_u32 vcc, 792, v115
    ds_write_b32 v131, v99
    ds_write_b8 v194, v123 offset:12
    s_mov_b64 exec, -1
    s_branch L_B1
L_R4:
    s_waitcnt vmcnt(1)
    v_mul_u32_u24 v104, s64, v128
    v_mul_u32_u24 v105, s64, v129
    v_mul_u32_u24 v106, s64, v130
    v_mul_u32_u24 v107, s64, v131
    v_lshrrev_b32 v136, 29, v104
    v_lshrrev_b32 v137, 29, v105
    v_lshrrev_b32 v138, 29, v106
    v_lshrrev_b32 v139, 29, v107
    v_cmp_eq_u32 s[72:73], v136, v137
    v_cmp_eq_u32 s[76:77], v138, v139
    v_cmp_eq_u32 vcc, v136, v138
    v_cmp_eq_u32 s[88:89], v137, v139
    v_cmp_eq_u32 s[90:91], v136, v139
    v_cmp_eq_u32 s[10:11], v137, v138
    v_lshrrev_b32 v104, 24, v104
    v_lshrrev_b32 v105, 24, v105
    v_lshrrev_b32 v106, 24, v106
    v_lshrrev_b32 v107, 24, v107
    s_or_b64 s[74:75], s[72:73], s[88:89]
    s_or_b64 s[78:79], s[76:77], s[88:89]
    s_or_b64 s[72:73], s[72:73], vcc
    s_or_b64 s[76:77], s[76:77], vcc
    s_or_b64 s[72:73], s[72:73], s[90:91]
    s_or_b64 s[74:75], s[74:75], s[10:11]
    s_or_b64 s[76:77], s[76:77], s[10:11]
    s_or_b64 s[78:79], s[78:79], s[90:91]
    v_cndmask_b32 v136, 0, v146, s[72:73]
    v_lshl_add_u32 v136, v104, 2, v136
    ds_add_rtn_u32 v112, v136, v184 offset:5120
    v_cndmask_b32 v137, 0, v146, s[74:75]
    v_lshl_add_u32 v137, v105, 2, v137
    ds_add_rtn_u32 v113, v137, v184 offset:5120
    v_cndmask_b32 v138, 0, v146, s[76:77]
    v_lshl_add_u32 v138, v106, 2, v138
    ds_add_rtn_u32 v114, v138, v184 offset:5120
    v_cndmask_b32 v139, 0, v146, s[78:79]
    v_lshl_add_u32 v139, v107, 2, v139
    ds_add_rtn_u32 v115, v139, v184 offset:5120
    s_waitcnt vmcnt(0)
    v_mad_i32_i24 v128, v104, s65, v128
    v_mul_u32_u24 v194, s66, v96
    v_lshl_or_b32 v96, v128, 18, v96
    v_and_or_b32 v194, v194, s67, v144
    v_mad_u32_u24 v128, v104, 40, s69
    v_or_b32 v96, v96, v194
    v_mad_i32_i24 v129, v105, s65, v129
    v_mul_u32_u24 v194, s66, v97
    v_lshl_or_b32 v97, v129, 18, v97
    v_and_or_b32 v194, v194, s67, v144
    v_mad_u32_u24 v129, v105, 40, s69
    v_or_b32 v97, v97, v194
    s_waitcnt lgkmcnt(3)
    s_mov_b64 exec, s[72:73]
    v_cmpx_le_u32 vcc, 132, v112
    ds_add_rtn_u32 v112, v136, v184 offset:4096
    s_waitcnt lgkmcnt(3)
    s_mov_b64 exec, s[74:75]
    v_cmpx_le_u32 vcc, 132, v113
    ds_add_rtn_u32 v113, v137, v184 offset:4096
    s_waitcnt lgkmcnt(3)
    s_mov_b64 exec, s[76:77]
    v_cmpx_le_u32 vcc, 132, v114
    ds_add_rtn_u32 v114, v138, v184 offset:4096
    s_waitcnt lgkmcnt(3)
    s_mov_b64 exec, s[78:79]
    v_cmpx_le_u32 vcc, 132, v115
    ds_add_rtn_u32 v115, v139, v184 offset:4096
    s_mov_b64 exec, -1
    v_mad_i32_i24 v130, v106, s65, v130
    v_mul_u32_u24 v194, s66, v98
    v_lshl_or_b32 v98, v130, 18, v98
    v_and_or_b32 v194, v194, s67, v144
    v_mad_u32_u24 v130, v106, 40, s69
    v_or_b32 v98, v98, v194
    v_mad_i32_i24 v131, v107, s65, v131
    v_mul_u32_u24 v194, s66, v99
    v_lshl_or_b32 v99, v131, 18, v99
    v_and_or_b32 v194, v194, s67, v144
    v_mad_u32_u24 v131, v107, 40, s69
    v_or_b32 v99, v99, v194
    s_waitcnt lgkmcnt(3)
    v_bfe_u32 v194, v112, 3, 5
    v_add_lshl_u32 v128, v194, v128, 2
    v_and_b32 v194, 3, v194
    v_mad_i32_i24 v194, v194, -3, v128
    v_cmpx_gt_u32 vcc, 792, v112
    ds_write_b32 v128, v96
    ds_write_b8 v194, v120 offset:12
    s_mov_b64 exec, -1
    s_waitcnt lgkmcnt(4)
    v_bfe_u32 v194, v113, 3, 5
    v_add_lshl_u32 v129, v194, v129, 2
    v_and_b32 v194, 3, v194
    v_mad_i32_i24 v194, v194, -3, v129
    v_cmpx_gt_u32 vcc, 792, v113
    ds_write_b32 v129, v97
    ds_write_b8 v194, v121 offset:12
    s_mov_b64 exec, -1
    s_waitcnt lgkmcnt(5)
    v_bfe_u32 v194, v114, 3, 5
    v_add_lshl_u32 v130, v194, v130, 2
    v_and_b32 v194, 3, v194
    v_mad_i32_i24 v194, v194, -3, v130
    v_cmpx_gt_u32 vcc, 792, v114
    ds_write_b32 v130, v98
    ds_write_b8 v194, v122 offset:12
    s_mov_b64 exec, -1
    s_waitcnt lgkmcnt(6)
    v_bfe_u32 v194, v115, 3, 5
    v_add_lshl_u32 v131, v194, v131, 2
    v_and_b32 v194, 3, v194
    v_mad_i32_i24 v194, v194, -3, v131
    v_cmpx_gt_u32 vcc, 792, v115
    ds_write_b32 v131, v99
    ds_write_b8 v194, v123 offset:12
    s_mov_b64 exec, -1
L_B1:
    s_cmp_ge_u32 s3, 2
    s_cbranch_scc1 L_NOC
    global_load_dwordx4 v[176:179], v232, s[28:29]
L_NOC:
    global_load_dwordx4 v[160:163], v232, s[26:27]
    global_load_dwordx4 v[164:167], v232, s[32:33]
    global_load_dwordx4 v[168:171], v232, s[24:25]
    global_load_dwordx4 v[172:175], v232, s[30:31]
    s_add_u32 s6, s6, 0x2020202
    v_lshlrev_b32 v186, v246, s6
    v_and_b32 v189, 4, v253
    v_mul_u32_u24 v189, 1212416, v189
    v_lshl_add_u32 v186, v189, 8, v186
    v_and_b32 v186, 0xfe000000, v186
    v_and_b32 v187, 7, v253
    v_mul_u32_u24 v187, 33, v187
    v_add_u32 v187, 792, v187
    v_lshlrev_b32 v222, 2, v223
    s_mov_b32 s64, 0x1000000
    s_waitcnt lgkmcnt(0)
    s_barrier
    ds_read_b128 v[192:195], v185 offset:5120
    ds_read_b32 v228, v222 offset:5120
    ds_read_b128 v[204:207], v221 offset:0
    ds_read_b32 v229, v222 offset:5376
    ds_read_b128 v[208:211], v221 offset:10240
    ds_read_b32 v230, v222 offset:5632
    ds_read_b128 v[212:215], v221 offset:20480
    ds_read_b32 v231, v222 offset:5888
    ds_read_b128 v[216:219], v221 offset:30720
    s_mov_b32 s80, 2105344
    s_mov_b32 s81, 4210688
    s_mov_b32 s82, 6316032
    s_waitcnt lgkmcnt(8)
    v_max3_u32 v188, v192, v193, v194
    v_max_u32 v188, v188, v195
    v_cmp_lt_u32 vcc, 1056, v188
    s_cbranch_vccnz L_POVF
L_POUT:
    s_waitcnt lgkmcnt(7)
    v_sub_u32 v228, v187, v228
    v_and_or_b32 v228, v228, s64, v186
    s_waitcnt lgkmcnt(6)
    v_or_b32 v207, v207, v228
    buffer_store_dwordx4 v[204:207], v220, s[56:59], 0 offen sc1
    s_waitcnt lgkmcnt(5)
    v_sub_u32 v229, v187, v229
    v_and_or_b32 v229, v229, s64, v186
    s_waitcnt lgkmcnt(4)
    v_or_b32 v211, v211, v229
    buffer_store_dwordx4 v[208:211], v220, s[56:59], s80 offen sc1
    s_waitcnt lgkmcnt(3)
    v_sub_u32 v230, v187, v230
    v_and_or_b32 v230, v230, s64, v186
    s_waitcnt lgkmcnt(2)
    v_or_b32 v215, v215, v230
    buffer_store_dwordx4 v[212:215], v220, s[56:59], s81 offen sc1
    s_waitcnt lgkmcnt(1)
    v_sub_u32 v231, v187, v231
    v_and_or_b32 v231, v231, s64, v186
    s_waitcnt lgkmcnt(0)
    v_or_b32 v219, v219, v231
    buffer_store_dwordx4 v[216:219], v220, s[56:59], s82 offen sc1
    s_mov_b32 s10, 0xbfb8aa3b
    s_mov_b32 s11, s10
    s_mov_b32 s64, 0x05040100
    s_mov_b32 s66, 0x07060302
    s_waitcnt vmcnt(4)
    v_perm_b32 v144, v170, v168, s64
    v_perm_b32 v145, v170, v168, s66
    v_perm_b32 v146, v171, v169, s64
    v_perm_b32 v147, v171, v169, s66
    v_add_u32 v148, 77824, v224
    ds_write2_b32 v148, v144, v145 offset0:0 offset1:8
    ds_write2_b32 v148, v146, v147 offset0:16 offset1:24
    v_lshlrev_b32 v128, 16, v160
    v_and_b32 v129, 0xffff0000, v160
    v_lshlrev_b32 v130, 16, v161
    v_and_b32 v131, 0xffff0000, v161
    v_lshlrev_b32 v132, 16, v162
    v_and_b32 v133, 0xffff0000, v162
    v_lshlrev_b32 v134, 16, v163
    v_and_b32 v135, 0xffff0000, v163
    v_pk_mul_f32 v[128:129], v[128:129], s[10:11]
    v_pk_mul_f32 v[130:131], v[130:131], s[10:11]
    v_pk_mul_f32 v[132:133], v[132:133], s[10:11]
    v_pk_mul_f32 v[134:135], v[134:135], s[10:11]
    v_cvt_pk_bf16_f32 v136, v128, v132
    v_cvt_pk_bf16_f32 v137, v129, v133
    v_cvt_pk_bf16_f32 v138, v130, v134
    v_cvt_pk_bf16_f32 v139, v131, v135
    ds_write2_b32 v224, v136, v137 offset0:0 offset1:8
    ds_write2_b32 v224, v138, v139 offset0:16 offset1:24
    v_perm_b32 v152, v166, v164, s64
    v_perm_b32 v153, v166, v164, s66
    v_perm_b32 v154, v167, v165, s64
    v_perm_b32 v155, v167, v165, s66
    v_add_u32 v156, 10240, v224
    ds_write2_b32 v156, v152, v153 offset0:0 offset1:8
    ds_write2_b32 v156, v154, v155 offset0:16 offset1:24
    v_perm_b32 v144, v174, v172, s64
    v_perm_b32 v145, v174, v172, s66
    v_perm_b32 v146, v175, v173, s64
    v_perm_b32 v147, v175, v173, s66
    v_add_u32 v148, 130176, v224
    ds_write2_b32 v148, v144, v145 offset0:0 offset1:8
    ds_write2_b32 v148, v146, v147 offset0:16 offset1:24
    s_cmp_ge_u32 s3, 2
    s_cbranch_scc1 L_NOWC
    v_lshlrev_b32 v128, 16, v176
    v_and_b32 v129, 0xffff0000, v176
    v_lshlrev_b32 v130, 16, v177
    v_and_b32 v131, 0xffff0000, v177
    v_lshlrev_b32 v132, 16, v178
    v_and_b32 v133, 0xffff0000, v178
    v_lshlrev_b32 v134, 16, v179
    v_and_b32 v135, 0xffff0000, v179
    v_pk_mul_f32 v[128:129], v[128:129], s[10:11]
    v_pk_mul_f32 v[130:131], v[130:131], s[10:11]
    v_pk_mul_f32 v[132:133], v[132:133], s[10:11]
    v_pk_mul_f32 v[134:135], v[134:135], s[10:11]
    v_cvt_pk_bf16_f32 v136, v128, v132
    v_cvt_pk_bf16_f32 v137, v129, v133
    v_cvt_pk_bf16_f32 v138, v130, v134
    v_cvt_pk_bf16_f32 v139, v131, v135
    v_add_u32 v140, 20480, v224
    ds_write2_b32 v140, v136, v137 offset0:0 offset1:8
    ds_write2_b32 v140, v138, v139 offset0:16 offset1:24
L_NOWC:
    s_mul_i32 s34, s5, 32896
    s_add_u32 s34, s34, 65536
    s_add_u32 s56, s38, s34
    s_addc_u32 s57, s39, 0
    s_mov_b32 s58, 32768
    s_mov_b32 s59, 0x20000
    s_add_u32 s34, s34, 8421376
    s_add_u32 s60, s38, s34
    s_addc_u32 s61, s39, 0
    s_mov_b32 s62, 32768
    s_mov_b32 s63, 0x20000
    s_movk_i32 s26, 8192
    s_movk_i32 s27, 16384
    s_movk_i32 s28, 24576
    s_waitcnt lgkmcnt(0)
    s_barrier
    v_add_u32 v225, 13312, v225
    ds_read_b64_tr_b16 v[0:1], v225 offset:0
    ds_read_b64_tr_b16 v[2:3], v225 offset:1280
    ds_read_b64_tr_b16 v[4:5], v225 offset:5120
    ds_read_b64_tr_b16 v[6:7], v225 offset:6400
    ds_read_b64_tr_b16 v[8:9], v225 offset:32
    ds_read_b64_tr_b16 v[10:11], v225 offset:1312
    ds_read_b64_tr_b16 v[12:13], v225 offset:5152
    ds_read_b64_tr_b16 v[14:15], v225 offset:6432
    ds_read_b64_tr_b16 v[16:17], v225 offset:64
    ds_read_b64_tr_b16 v[18:19], v225 offset:1344
    ds_read_b64_tr_b16 v[20:21], v225 offset:5184
    ds_read_b64_tr_b16 v[22:23], v225 offset:6464
    ds_read_b64_tr_b16 v[24:25], v225 offset:96
    ds_read_b64_tr_b16 v[26:27], v225 offset:1376
    v_mov_b64 v[64:65], 0
    v_mov_b64 v[66:67], 0
    v_mov_b32 v68, 0x20fffff
    v_mov_b32 v69, 0x20fffff
    v_mov_b32 v70, 0x20fffff
    v_mov_b32 v71, 0x20fffff
    v_lshl_add_u32 v72, v253, 4, s12
    ds_write_b128 v72, v[64:67] offset:0
    ds_write_b128 v72, v[68:71] offset:18432
    ds_write_b128 v72, v[64:67] offset:1024
    ds_write_b128 v72, v[68:71] offset:19456
    ds_write_b128 v72, v[64:67] offset:1280
    ds_write_b128 v72, v[68:71] offset:19712
    ds_read_b64_tr_b16 v[28:29], v225 offset:5216
    ds_read_b64_tr_b16 v[30:31], v225 offset:6496
    ds_read_b64_tr_b16 v[32:33], v225 offset:10240
    ds_read_b64_tr_b16 v[34:35], v225 offset:11520
    ds_read_b64_tr_b16 v[36:37], v225 offset:15360
    ds_read_b64_tr_b16 v[38:39], v225 offset:16640
    ds_read_b64_tr_b16 v[40:41], v225 offset:10272
    ds_read_b64_tr_b16 v[42:43], v225 offset:11552
    ds_read_b64_tr_b16 v[44:45], v225 offset:15392
    ds_read_b64_tr_b16 v[46:47], v225 offset:16672
    v_mov_b32 v192, v225
    s_mov_b32 exec_lo, 0
    v_subrev_u32 v192, 2560, v225
    s_mov_b32 exec_lo, -1
    s_waitcnt lgkmcnt(4)
    ds_read_b64_tr_b16 v[48:49], v225 offset:10304
    ds_read_b64_tr_b16 v[50:51], v225 offset:11584
    ds_read_b64_tr_b16 v[52:53], v225 offset:15424
    ds_read_b64_tr_b16 v[54:55], v225 offset:16704
    ds_read_b64_tr_b16 v[56:57], v225 offset:10336
    ds_read_b64_tr_b16 v[58:59], v225 offset:11616
    ds_read_b64_tr_b16 v[60:61], v225 offset:15456
    ds_read_b64_tr_b16 v[62:63], v225 offset:16736
    ds_read_b64_tr_b16 v[80:81], v192 offset:20480
    ds_read_b64_tr_b16 v[82:83], v192 offset:21760
    ds_read_b64_tr_b16 v[84:85], v192 offset:20512
    ds_read_b64_tr_b16 v[86:87], v192 offset:21792
    ds_read_b64_tr_b16 v[88:89], v192 offset:20544
    ds_read_b64_tr_b16 v[90:91], v192 offset:21824
    ds_read_b64_tr_b16 v[92:93], v192 offset:20576
    ds_read_b64_tr_b16 v[94:95], v192 offset:21856
    v_add_u32 v225, 77824, v225
    v_and_b32 v241, 1, v253
    v_lshlrev_b32 v241, 4, v241
    v_mov_b32 v242, 0x3f80
    v_and_b32 v245, 16, v253
    v_and_b32 v194, 15, v253
    v_lshl_add_u32 v194, v194, 5, s14
    s_mov_b32 exec_hi, 0
    v_add_u32 v245, v245, v194
    s_mov_b32 exec_hi, -1
    v_and_b32 v194, 3, v253
    v_bfe_u32 v196, v253, 2, 2
    v_and_b32 v197, 48, v253
    v_lshl_add_u32 v198, v196, 7, v197
    v_mul_u32_u24 v244, 1056, v194
    v_add3_u32 v244, v244, v198, s13
    v_lshrrev_b32 v194, 3, v253
    v_lshl_add_u32 v247, v194, 4, s12
    s_add_u32 s10, s12, 18432
    v_lshrrev_b32 v194, 1, v253
    v_lshl_add_u32 v248, v194, 2, s10
    s_add_u32 s10, s10, 2
    v_and_b32 v194, 48, v253
    v_lshl_add_u32 v250, v194, 1, s10
    v_and_b32 v194, 12, v253
    v_add_u32 v250, v250, v194
    v_lshrrev_b32 v194, 5, v253
    v_mul_u32_u24 v249, 18432, v194
    v_and_b32 v194, 15, v253
    v_lshl_add_u32 v249, v194, 2, v249
    s_add_u32 s10, s12, 2
    v_add_u32 v249, s10, v249
    v_mul_u32_u24 v156, 3128, v223
    v_add_u32 v157, 200192, v156
    v_add_u32 v158, 400384, v156
    v_add_u32 v159, 600576, v156
    s_mov_b32 s98, 0xf0f0f0f
    s_mov_b32 s99, 0xf0f0f0f
    v_mov_b32 v180, 0xfffff
    v_cndmask_b32 v176, 0, v180, s[98:99]
    v_add_lshl_u32 v191, v232, v243, 16
    v_add_u32 v152, 0x34000000, v191
    v_cndmask_b32 v152, 0, v152, s[98:99]
    v_add_u32 v153, 0x54000000, v191
    v_cndmask_b32 v153, 0, v153, s[98:99]
    v_add_u32 v154, 0x74000000, v191
    v_cndmask_b32 v154, 0, v154, s[98:99]
    v_add_u32 v155, 0x94000000, v191
    v_cndmask_b32 v155, 0, v155, s[98:99]
    v_mov_b32 v184, 4
    v_and_b32 v177, 31, v253
    v_add_lshl_u32 v179, v177, s7, 2
    v_lshrrev_b32 v191, 5, v253
    v_lshl_add_u32 v178, v191, 11, v179
    v_add_u32 v179, 153728, v179
    v_lshlrev_b32 v191, 2, v253
    v_subrev_u32 v191, s7, v191
    s_mov_b32 s10, 0x10000
    v_add_u32 v228, 0, v191
    v_and_or_b32 v228, v228, s10, 1
    v_add_u32 v229, 1, v191
    v_and_or_b32 v229, v229, s10, 1
    v_add_u32 v230, 2, v191
    v_and_or_b32 v230, v230, s10, 1
    v_add_u32 v231, 3, v191
    v_and_or_b32 v231, v231, s10, 1
    s_movk_i32 s18, 0xffc
    s_movk_i32 s20, 32
    s_mov_b32 s21, 0
    s_mov_b32 s100, 0
    s_mov_b32 s16, 0x1ffffff
    s_mov_b32 s17, 0xffff
    s_mul_i32 s10, s4, 49
    s_sub_i32 s22, s10, 6
    s_ashr_i32 s22, s22, 1
    s_add_i32 s23, s10, 7
    s_ashr_i32 s23, s23, 1
    s_add_i32 s24, s10, 43
    s_ashr_i32 s24, s24, 1
    s_add_i32 s25, s22, 31
    s_cmp_eq_u32 s4, 7
    s_cselect_b32 s24, 196, s24
    s_cselect_b32 s25, 196, s25
    s_sub_i32 s23, s23, s7
    s_sub_i32 s24, s24, s7
    s_sub_i32 s25, s25, s7
    s_waitcnt vmcnt(0)
    buffer_load_dwordx4 v[128:131], v232, s[56:59], 0 offen sc1
    buffer_load_dwordx4 v[132:135], v232, s[56:59], s26 offen sc1
    buffer_load_dwordx4 v[136:139], v232, s[56:59], s27 offen sc1
    buffer_load_dwordx4 v[140:143], v232, s[56:59], s28 offen sc1
    v_max3_u32 v188, v112, v113, v114
    v_max3_u32 v189, v115, v116, v117
    v_max3_u32 v188, v188, v118, v119
    v_max_u32 v188, v188, v189
    v_cmp_le_u32 vcc, 792, v188
    s_cbranch_vccz L_PEXTR
    v_mov_b32 v65, s6
    s_lshl_b32 s34, s2, 7
    s_add_u32 s34, s34, 8486912
    v_subrev_u32 v68, 792, v112
    v_cmpx_gt_u32 vcc, 264, v68
    s_cbranch_execz L_PE0
    v_mov_b32 v64, v96
    v_mov_b32 v66, v120
    v_bfe_u32 v68, v112, 5, 3
    v_lshlrev_b32 v68, 4, v68
    v_mad_u32_u24 v68, v104, s68, v68
    buffer_store_dwordx4 v[64:67], v68, s[52:55], s34 offen sc1
L_PE0:
    s_mov_b64 exec, -1
    v_subrev_u32 v68, 792, v113
    v_cmpx_gt_u32 vcc, 264, v68
    s_cbranch_execz L_PE1
    v_mov_b32 v64, v97
    v_mov_b32 v66, v121
    v_bfe_u32 v68, v113, 5, 3
    v_lshlrev_b32 v68, 4, v68
    v_mad_u32_u24 v68, v105, s68, v68
    buffer_store_dwordx4 v[64:67], v68, s[52:55], s34 offen sc1
L_PE1:
    s_mov_b64 exec, -1
    v_subrev_u32 v68, 792, v114
    v_cmpx_gt_u32 vcc, 264, v68
    s_cbranch_execz L_PE2
    v_mov_b32 v64, v98
    v_mov_b32 v66, v122
    v_bfe_u32 v68, v114, 5, 3
    v_lshlrev_b32 v68, 4, v68
    v_mad_u32_u24 v68, v106, s68, v68
    buffer_store_dwordx4 v[64:67], v68, s[52:55], s34 offen sc1
L_PE2:
    s_mov_b64 exec, -1
    v_subrev_u32 v68, 792, v115
    v_cmpx_gt_u32 vcc, 264, v68
    s_cbranch_execz L_PE3
    v_mov_b32 v64, v99
    v_mov_b32 v66, v123
    v_bfe_u32 v68, v115, 5, 3
    v_lshlrev_b32 v68, 4, v68
    v_mad_u32_u24 v68, v107, s68, v68
    buffer_store_dwordx4 v[64:67], v68, s[52:55], s34 offen sc1
L_PE3:
    s_mov_b64 exec, -1
    v_subrev_u32 v68, 792, v116
    v_cmpx_gt_u32 vcc, 264, v68
    s_cbranch_execz L_PE4
    v_mov_b32 v64, v100
    v_mov_b32 v66, v120
    v_bfe_u32 v68, v116, 5, 3
    v_lshlrev_b32 v68, 4, v68
    v_mad_u32_u24 v68, v108, s68, v68
    buffer_store_dwordx4 v[64:67], v68, s[52:55], s34 offen sc1
L_PE4:
    s_mov_b64 exec, -1
    v_subrev_u32 v68, 792, v117
    v_cmpx_gt_u32 vcc, 264, v68
    s_cbranch_execz L_PE5
    v_mov_b32 v64, v101
    v_mov_b32 v66, v121
    v_bfe_u32 v68, v117, 5, 3
    v_lshlrev_b32 v68, 4, v68
    v_mad_u32_u24 v68, v109, s68, v68
    buffer_store_dwordx4 v[64:67], v68, s[52:55], s34 offen sc1
L_PE5:
    s_mov_b64 exec, -1
    v_subrev_u32 v68, 792, v118
    v_cmpx_gt_u32 vcc, 264, v68
    s_cbranch_execz L_PE6
    v_mov_b32 v64, v102
    v_mov_b32 v66, v122
    v_bfe_u32 v68, v118, 5, 3
    v_lshlrev_b32 v68, 4, v68
    v_mad_u32_u24 v68, v110, s68, v68
    buffer_store_dwordx4 v[64:67], v68, s[52:55], s34 offen sc1
L_PE6:
    s_mov_b64 exec, -1
    v_subrev_u32 v68, 792, v119
    v_cmpx_gt_u32 vcc, 264, v68
    s_cbranch_execz L_PE7
    v_mov_b32 v64, v103
    v_mov_b32 v66, v123
    v_bfe_u32 v68, v119, 5, 3
    v_lshlrev_b32 v68, 4, v68
    v_mad_u32_u24 v68, v111, s68, v68
    buffer_store_dwordx4 v[64:67], v68, s[52:55], s34 offen sc1
L_PE7:
    s_mov_b64 exec, -1
L_PEXTR:
L_PW0:
    s_waitcnt vmcnt(3)
    v_xor_b32 v188, v131, v186
    v_and_b32_sdwa v96, v128, s18 dst_sel:DWORD dst_unused:UNUSED_PAD src0_sel:WORD_1 src1_sel:DWORD
    v_and_b32_sdwa v97, v129, s18 dst_sel:DWORD dst_unused:UNUSED_PAD src0_sel:WORD_1 src1_sel:DWORD
    v_and_b32_sdwa v98, v130, s18 dst_sel:DWORD dst_unused:UNUSED_PAD src0_sel:WORD_1 src1_sel:DWORD
    v_cmp_lt_u32 vcc, s16, v188
    v_cmp_ne_u32 s[64:65], 0, v128
    v_cmp_ne_u32 s[66:67], 0, v129
    v_cmp_ne_u32 s[68:69], 0, v130
    s_cbranch_vccnz L_RT0
    s_mov_b64 exec, s[64:65]
    ds_add_rtn_u32 v112, v96, v184 offset:1024
    s_mov_b64 exec, s[66:67]
    ds_add_rtn_u32 v113, v97, v184 offset:1024
    s_mov_b64 exec, s[68:69]
    ds_add_rtn_u32 v114, v98, v184 offset:1024
    s_mov_b64 exec, -1
    v_add_u32_sdwa v207, v131, v156 dst_sel:DWORD dst_unused:UNUSED_PAD src0_sel:BYTE_0 src1_sel:DWORD
    v_lshrrev_b32 v189, 28, v128
    v_lshl_add_u32 v207, v189, 8, v207
    v_and_b32 v189, 60, v96
    v_lshl_add_u32 v204, v189, 19, v207
    v_add_u32_sdwa v205, v131, v156 dst_sel:DWORD dst_unused:UNUSED_PAD src0_sel:BYTE_1 src1_sel:DWORD
    v_lshrrev_b32 v189, 28, v129
    v_lshl_add_u32 v205, v189, 8, v205
    v_and_b32 v189, 60, v97
    v_lshl_add_u32 v205, v189, 19, v205
    v_add_u32_sdwa v206, v131, v156 dst_sel:DWORD dst_unused:UNUSED_PAD src0_sel:BYTE_2 src1_sel:DWORD
    v_lshrrev_b32 v189, 28, v130
    v_lshl_add_u32 v206, v189, 8, v206
    v_and_b32 v189, 60, v98
    v_lshl_add_u32 v206, v189, 19, v206
    v_cndmask_b32 v188, v180, v207, s[64:65]
    v_and_or_b32 v128, v128, s17, v152
    v_or_b32 v204, v204, v176
    v_mov_b32_dpp v189, v188 quad_perm:[2,2,3,3] row_mask:0xf bank_mask:0xf
    v_mov_b32_dpp v207, v188 quad_perm:[0,0,1,1] row_mask:0xf bank_mask:0xf
    v_and_b32 v130, s17, v130
    v_mov_b32_dpp v207, v189 row_shr:4 row_mask:0xf bank_mask:0xa
L_PW1:
    s_waitcnt vmcnt(2)
    v_xor_b32 v188, v135, v186
    v_and_b32_sdwa v100, v132, s18 dst_sel:DWORD dst_unused:UNUSED_PAD src0_sel:WORD_1 src1_sel:DWORD
    v_and_b32_sdwa v101, v133, s18 dst_sel:DWORD dst_unused:UNUSED_PAD src0_sel:WORD_1 src1_sel:DWORD
    v_and_b32_sdwa v102, v134, s18 dst_sel:DWORD dst_unused:UNUSED_PAD src0_sel:WORD_1 src1_sel:DWORD
    v_cmp_lt_u32 vcc, s16, v188
    v_cmp_ne_u32 s[72:73], 0, v132
    v_cmp_ne_u32 s[74:75], 0, v133
    v_cmp_ne_u32 s[76:77], 0, v134
    s_cbranch_vccnz L_RT1
    s_mov_b64 exec, s[72:73]
    ds_add_rtn_u32 v116, v100, v184 offset:1024
    s_mov_b64 exec, s[74:75]
    ds_add_rtn_u32 v117, v101, v184 offset:1024
    s_mov_b64 exec, s[76:77]
    ds_add_rtn_u32 v118, v102, v184 offset:1024
    s_mov_b64 exec, -1
    v_add_u32_sdwa v211, v135, v157 dst_sel:DWORD dst_unused:UNUSED_PAD src0_sel:BYTE_0 src1_sel:DWORD
    v_lshrrev_b32 v189, 28, v132
    v_lshl_add_u32 v211, v189, 8, v211
    v_and_b32 v189, 60, v100
    v_lshl_add_u32 v208, v189, 19, v211
    v_add_u32_sdwa v209, v135, v157 dst_sel:DWORD dst_unused:UNUSED_PAD src0_sel:BYTE_1 src1_sel:DWORD
    v_lshrrev_b32 v189, 28, v133
    v_lshl_add_u32 v209, v189, 8, v209
    v_and_b32 v189, 60, v101
    v_lshl_add_u32 v209, v189, 19, v209
    v_add_u32_sdwa v210, v135, v157 dst_sel:DWORD dst_unused:UNUSED_PAD src0_sel:BYTE_2 src1_sel:DWORD
    v_lshrrev_b32 v189, 28, v134
    v_lshl_add_u32 v210, v189, 8, v210
    v_and_b32 v189, 60, v102
    v_lshl_add_u32 v210, v189, 19, v210
    v_cndmask_b32 v188, v180, v211, s[72:73]
    v_and_or_b32 v132, v132, s17, v153
    v_or_b32 v208, v208, v176
    v_mov_b32_dpp v189, v188 quad_perm:[2,2,3,3] row_mask:0xf bank_mask:0xf
    v_mov_b32_dpp v211, v188 quad_perm:[0,0,1,1] row_mask:0xf bank_mask:0xf
    v_and_b32 v134, s17, v134
    v_mov_b32_dpp v211, v189 row_shr:4 row_mask:0xf bank_mask:0xa
L_PW2:
    s_waitcnt vmcnt(1)
    v_xor_b32 v188, v139, v186
    v_and_b32_sdwa v104, v136, s18 dst_sel:DWORD dst_unused:UNUSED_PAD src0_sel:WORD_1 src1_sel:DWORD
    v_and_b32_sdwa v105, v137, s18 dst_sel:DWORD dst_unused:UNUSED_PAD src0_sel:WORD_1 src1_sel:DWORD
    v_and_b32_sdwa v106, v138, s18 dst_sel:DWORD dst_unused:UNUSED_PAD src0_sel:WORD_1 src1_sel:DWORD
    v_cmp_lt_u32 vcc, s16, v188
    v_cmp_ne_u32 s[80:81], 0, v136
    v_cmp_ne_u32 s[82:83], 0, v137
    v_cmp_ne_u32 s[84:85], 0, v138
    s_cbranch_vccnz L_RT2
    s_mov_b64 exec, s[80:81]
    ds_add_rtn_u32 v120, v104, v184 offset:1024
    s_mov_b64 exec, s[82:83]
    ds_add_rtn_u32 v121, v105, v184 offset:1024
    s_mov_b64 exec, s[84:85]
    ds_add_rtn_u32 v122, v106, v184 offset:1024
    s_mov_b64 exec, -1
    v_add_u32_sdwa v215, v139, v158 dst_sel:DWORD dst_unused:UNUSED_PAD src0_sel:BYTE_0 src1_sel:DWORD
    v_lshrrev_b32 v189, 28, v136
    v_lshl_add_u32 v215, v189, 8, v215
    v_and_b32 v189, 60, v104
    v_lshl_add_u32 v212, v189, 19, v215
    v_add_u32_sdwa v213, v139, v158 dst_sel:DWORD dst_unused:UNUSED_PAD src0_sel:BYTE_1 src1_sel:DWORD
    v_lshrrev_b32 v189, 28, v137
    v_lshl_add_u32 v213, v189, 8, v213
    v_and_b32 v189, 60, v105
    v_lshl_add_u32 v213, v189, 19, v213
    v_add_u32_sdwa v214, v139, v158 dst_sel:DWORD dst_unused:UNUSED_PAD src0_sel:BYTE_2 src1_sel:DWORD
    v_lshrrev_b32 v189, 28, v138
    v_lshl_add_u32 v214, v189, 8, v214
    v_and_b32 v189, 60, v106
    v_lshl_add_u32 v214, v189, 19, v214
    v_cndmask_b32 v188, v180, v215, s[80:81]
    v_and_or_b32 v136, v136, s17, v154
    v_or_b32 v212, v212, v176
    v_mov_b32_dpp v189, v188 quad_perm:[2,2,3,3] row_mask:0xf bank_mask:0xf
    v_mov_b32_dpp v215, v188 quad_perm:[0,0,1,1] row_mask:0xf bank_mask:0xf
    v_and_b32 v138, s17, v138
    v_mov_b32_dpp v215, v189 row_shr:4 row_mask:0xf bank_mask:0xa
L_PW3:
    s_waitcnt vmcnt(0)
    v_xor_b32 v188, v143, v186
    v_and_b32_sdwa v108, v140, s18 dst_sel:DWORD dst_unused:UNUSED_PAD src0_sel:WORD_1 src1_sel:DWORD
    v_and_b32_sdwa v109, v141, s18 dst_sel:DWORD dst_unused:UNUSED_PAD src0_sel:WORD_1 src1_sel:DWORD
    v_and_b32_sdwa v110, v142, s18 dst_sel:DWORD dst_unused:UNUSED_PAD src0_sel:WORD_1 src1_sel:DWORD
    v_cmp_lt_u32 vcc, s16, v188
    v_cmp_ne_u32 s[88:89], 0, v140
    v_cmp_ne_u32 s[90:91], 0, v141
    v_cmp_ne_u32 s[92:93], 0, v142
    s_cbranch_vccnz L_RT3
    s_mov_b64 exec, s[88:89]
    ds_add_rtn_u32 v124, v108, v184 offset:1024
    s_mov_b64 exec, s[90:91]
    ds_add_rtn_u32 v125, v109, v184 offset:1024
    s_mov_b64 exec, s[92:93]
    ds_add_rtn_u32 v126, v110, v184 offset:1024
    s_mov_b64 exec, -1
    v_or3_b32 v190, v131, v135, v139
    v_or_b32 v190, v190, v143
    v_and_b32 v190, 0x1000000, v190
    v_cmp_ne_u32 vcc, 0, v190
    s_cbranch_vccz L_XT1R
    v_and_b32 v190, 0x1000000, v131
    v_cmp_ne_u32 s[70:71], 0, v190
    s_bcnt1_i32_b64 s10, s[70:71]
    s_lshl2_add_u32 s21, s10, s21
    v_and_b32 v190, 0x1000000, v135
    v_cmp_ne_u32 s[78:79], 0, v190
    s_bcnt1_i32_b64 s10, s[78:79]
    s_lshl2_add_u32 s21, s10, s21
    v_and_b32 v190, 0x1000000, v139
    v_cmp_ne_u32 s[86:87], 0, v190
    s_bcnt1_i32_b64 s10, s[86:87]
    s_lshl2_add_u32 s21, s10, s21
    v_and_b32 v190, 0x1000000, v143
    v_cmp_ne_u32 s[94:95], 0, v190
    s_bcnt1_i32_b64 s10, s[94:95]
    s_lshl2_add_u32 s21, s10, s21
    s_mov_b64 exec, s[70:71]
    s_cbranch_execz L_XLa0
    s_movk_i32 s10, 0
    buffer_load_dwordx4 v[64:67], v232, s[60:63], s10 offen sc1
L_XLa0:
    s_mov_b64 exec, s[78:79]
    s_cbranch_execz L_XLa1
    s_movk_i32 s10, 8192
    buffer_load_dwordx4 v[68:71], v232, s[60:63], s10 offen sc1
L_XLa1:
    s_mov_b64 exec, s[86:87]
    s_cbranch_execz L_XLa2
    s_movk_i32 s10, 16384
    buffer_load_dwordx4 v[72:75], v232, s[60:63], s10 offen sc1
L_XLa2:
    s_mov_b64 exec, s[94:95]
    s_cbranch_execz L_XLa3
    s_movk_i32 s10, 24576
    buffer_load_dwordx4 v[76:79], v232, s[60:63], s10 offen sc1
L_XLa3:
    s_mov_b64 exec, -1
    v_or3_b32 v190, v129, v133, v137
    v_or_b32 v190, v190, v141
    v_and_b32 v190, 0x10000, v190
    v_mov_b32 v191, 640
    v_cmpx_ne_u32 vcc, 0, v190
    ds_write_b32 v191, v184 offset:4
    s_mov_b64 exec, 1
    v_mov_b32 v190, s21
    ds_add_u32 v191, v190 offset:8
    s_mov_b64 exec, -1
L_XT1R:
    v_add_u32_sdwa v219, v143, v159 dst_sel:DWORD dst_unused:UNUSED_PAD src0_sel:BYTE_0 src1_sel:DWORD
    v_lshrrev_b32 v189, 28, v140
    v_lshl_add_u32 v219, v189, 8, v219
    v_and_b32 v189, 60, v108
    v_lshl_add_u32 v216, v189, 19, v219
    v_add_u32_sdwa v217, v143, v159 dst_sel:DWORD dst_unused:UNUSED_PAD src0_sel:BYTE_1 src1_sel:DWORD
    v_lshrrev_b32 v189, 28, v141
    v_lshl_add_u32 v217, v189, 8, v217
    v_and_b32 v189, 60, v109
    v_lshl_add_u32 v217, v189, 19, v217
    v_add_u32_sdwa v218, v143, v159 dst_sel:DWORD dst_unused:UNUSED_PAD src0_sel:BYTE_2 src1_sel:DWORD
    v_lshrrev_b32 v189, 28, v142
    v_lshl_add_u32 v218, v189, 8, v218
    v_and_b32 v189, 60, v110
    v_lshl_add_u32 v218, v189, 19, v218
    v_cndmask_b32 v188, v180, v219, s[88:89]
    v_and_or_b32 v140, v140, s17, v155
    v_or_b32 v216, v216, v176
    v_mov_b32_dpp v189, v188 quad_perm:[2,2,3,3] row_mask:0xf bank_mask:0xf
    v_mov_b32_dpp v219, v188 quad_perm:[0,0,1,1] row_mask:0xf bank_mask:0xf
    v_and_b32 v142, s17, v142
    v_mov_b32_dpp v219, v189 row_shr:4 row_mask:0xf bank_mask:0xa
    v_mov_b32 v197, 640
    s_cmp_eq_u32 s3, 6
    s_cselect_b32 exec_hi, 0, -1
    s_cmp_eq_u32 s3, 7
    s_cselect_b64 exec, 1, exec
    s_add_u32 m0, s101, 0
    s_nop 0
    buffer_load_dwordx4 v234, s[40:43], 0 offen offset:0 lds
    s_add_u32 m0, s101, 6560
    s_nop 0
    buffer_load_dwordx4 v234, s[40:43], 0 offen offset:128 lds
    s_add_u32 m0, s101, 13120
    s_nop 0
    buffer_load_dwordx4 v234, s[40:43], 0 offen offset:256 lds
    s_add_u32 m0, s101, 19680
    s_nop 0
    buffer_load_dwordx4 v234, s[40:43], 0 offen offset:384 lds
    s_mov_b64 exec, -1
    s_waitcnt lgkmcnt(0)
    s_barrier
    ds_read_u16 v198, v178 offset:1024
    ds_read_u16 v199, v178 offset:2048
    ds_read_b128 v[160:163], v185 offset:1024
    ds_read_b128 v[164:167], v185 offset:2048
    ds_read_b128 v[168:171], v185 offset:3072
    ds_read_b128 v[172:175], v185 offset:4096
    ds_read_b32 v236, v197 offset:8
    s_lshl_b32 m0, s3, 10
    v_mov_b32 v240, v207
    s_add_u32 m0, m0, 13312
    s_nop 0
    buffer_load_dwordx4 v[240:241], s[44:47], 0 idxen offen lds
    s_cmp_lg_u32 s2, 0
    s_cbranch_scc1 L_NOK
    v_mov_b32 v237, s6
    v_mov_b32 v238, 0
    buffer_store_dword v237, v238, s[52:55], 0 offen sc1
L_NOK:
    s_waitcnt lgkmcnt(5)
    v_lshl_or_b32 v198, v199, 16, v198
    v_mov_b32 v199, v198
    s_waitcnt lgkmcnt(0)
    v_add_u32_sdwa v188, v160, v164 dst_sel:DWORD dst_unused:UNUSED_PAD src0_sel:WORD_0 src1_sel:WORD_0
    v_add_u32_sdwa v192, v168, v172 dst_sel:DWORD dst_unused:UNUSED_PAD src0_sel:WORD_0 src1_sel:WORD_0
    v_add_u32_dpp v199, v199, v199 row_shr:1 row_mask:0xf bank_mask:0xf bound_ctrl:0
    v_add_u32_sdwa v189, v161, v165 dst_sel:DWORD dst_unused:UNUSED_PAD src0_sel:WORD_0 src1_sel:WORD_0
    v_add_u32_sdwa v193, v169, v173 dst_sel:DWORD dst_unused:UNUSED_PAD src0_sel:WORD_0 src1_sel:WORD_0
    v_add_u32_dpp v199, v199, v199 row_shr:2 row_mask:0xf bank_mask:0xf bound_ctrl:0
    v_add_u32_sdwa v190, v162, v166 dst_sel:DWORD dst_unused:UNUSED_PAD src0_sel:WORD_0 src1_sel:WORD_0
    v_add_u32_sdwa v194, v170, v174 dst_sel:DWORD dst_unused:UNUSED_PAD src0_sel:WORD_0 src1_sel:WORD_0
    v_add_u32_dpp v199, v199, v199 row_shr:4 row_mask:0xf bank_mask:0xf bound_ctrl:0
    v_add_u32_sdwa v191, v163, v167 dst_sel:DWORD dst_unused:UNUSED_PAD src0_sel:WORD_0 src1_sel:WORD_0
    v_add_u32_sdwa v195, v171, v175 dst_sel:DWORD dst_unused:UNUSED_PAD src0_sel:WORD_0 src1_sel:WORD_0
    v_add_u32_dpp v199, v199, v199 row_shr:8 row_mask:0xf bank_mask:0xf bound_ctrl:0
    v_add_u32 v188, v188, v192
    v_add_u32 v189, v189, v193
    v_add_u32_dpp v199, v199, v199 row_bcast:15 row_mask:0xa bank_mask:0xf
    v_add_u32 v190, v190, v194
    v_add_u32 v191, v191, v195
    v_mul_u32_u24 v196, v188, v228
    v_mad_u32_u24 v196, v189, v229, v196
    v_mad_u32_u24 v196, v190, v230, v196
    v_mad_u32_u24 v196, v191, v231, v196
    s_mov_b32 s96, -1
    s_mov_b32 s97, 0
    v_sub_u32 v200, v199, v198
    v_add_u32_sdwa v202, v199, v199 dst_sel:DWORD dst_unused:UNUSED_PAD src0_sel:WORD_0 src1_sel:WORD_1
    v_add_u32_dpp v196, v196, v196 row_shr:1 row_mask:0xf bank_mask:0xf bound_ctrl:0
    v_add_u32_sdwa v201, v200, v200 dst_sel:DWORD dst_unused:UNUSED_PAD src0_sel:WORD_0 src1_sel:WORD_1
    v_add_u32_sdwa v203, v198, v198 dst_sel:DWORD dst_unused:UNUSED_PAD src0_sel:WORD_0 src1_sel:WORD_1
    v_add_u32_dpp v196, v196, v196 row_shr:2 row_mask:0xf bank_mask:0xf bound_ctrl:0
    v_and_b32 v129, s17, v129
    v_readfirstlane_b32 s19, v236
    v_add_u32_dpp v196, v196, v196 row_shr:4 row_mask:0xf bank_mask:0xf bound_ctrl:0
    v_permlane32_swap_b32 v201, v202
    v_cndmask_b32 v203, 0, v203, s[96:97]
    v_add_u32_dpp v196, v196, v196 row_shr:8 row_mask:0xf bank_mask:0xf bound_ctrl:0
    v_add_u32 v201, v201, v202
    v_and_b32 v133, s17, v133
    v_add_u32_dpp v196, v196, v196 row_bcast:15 row_mask:0xa bank_mask:0xf
    v_add_u32 v202, v201, v203
    v_and_b32 v137, s17, v137
    v_add_u32_dpp v196, v196, v196 row_bcast:31 row_mask:0xc bank_mask:0xf
    v_sub_u32_sdwa v203, v202, v198 dst_sel:DWORD dst_unused:UNUSED_PAD src0_sel:DWORD src1_sel:WORD_1
    v_readlane_b32 s16, v196, 63
    s_lshl_b32 m0, s3, 10
    v_mov_b32 v240, v211
    s_add_u32 m0, m0, 21504
    s_nop 0
    buffer_load_dwordx4 v[240:241], s[44:47], 0 idxen offen lds
    s_bfe_u32 s10, s16, 0xe0002
    s_lshr_b32 s16, s16, 16
    s_lshr_b32 s11, s10, 1
    s_add_u32 s11, s11, 48
    s_and_b32 s11, s11, -128
    s_lshr_b32 s8, s4, 1
    s_mul_i32 s8, s8, s10
    s_sub_i32 s11, s11, 48
    s_sub_i32 s8, s8, s16
    s_add_i32 s11, s11, s8
    s_add_i32 s10, s10, s8
    s_bitcmp1_b32 s4, 0
    s_cselect_b32 s31, s11, s8
    s_cselect_b32 s10, s10, s11
    v_cmp_gt_i32 vcc, s31, v202
    v_cmp_gt_i32 s[34:35], s10, v202
    s_bcnt1_i32_b32 s22, vcc_lo
    s_bcnt1_i32_b32 s10, s34
    s_min_i32 s22, s22, s23
    s_max_i32 s10, s10, s24
    s_min_i32 s23, s10, s25
    v_readlane_b32 s16, v201, s22
    v_readlane_b32 s30, v201, s23
    s_add_u32 s8, s22, s7
    s_add_u32 s9, s23, s7
    s_add_u32 s10, s22, 32
    s_add_u32 s11, s23, 32
    v_readlane_b32 s26, v200, s22
    v_readlane_b32 s28, v200, s23
    v_readlane_b32 s27, v200, s10
    v_readlane_b32 s29, v200, s11
    s_sub_u32 s31, s30, s16
    s_add_u32 s10, s31, 255
    s_sub_i32 s11, s23, 16
    s_max_i32 s11, s11, s22
    v_readlane_b32 s11, v201, s11
    s_add_u32 vcc_lo, s31, 127
    s_and_b32 vcc_hi, vcc_lo, 127
    s_add_u32 vcc_hi, vcc_hi, s19
    s_cmp_lt_u32 vcc_hi, 55
    s_cselect_b32 vcc_lo, vcc_lo, s10
    s_sub_u32 s11, s11, s16
    s_add_u32 s11, s11, s19
    s_lshl_b32 s11, s11, 1
    s_and_b32 vcc_lo, vcc_lo, -256
    s_cmp_le_u32 s11, vcc_lo
    s_cselect_b32 s10, vcc_lo, s10
    s_lshr_b32 s10, s10, 8
    s_lshl_b32 s10, s10, 7
    s_sub_u32 s10, s10, s19
    s_max_i32 s10, s10, 0
    s_add_u32 s16, s16, s10
    s_add_u32 s10, s22, 16
    s_min_u32 s10, s10, s23
    s_sub_i32 s11, s23, 16
    v_cmp_ge_u32 s[34:35], s16, v203
    v_cmp_ge_u32 s[36:37], s16, v202
    v_cmp_gt_i32 vcc, s10, v177
    v_cmp_gt_i32 s[10:11], s11, v177
    v_cmp_le_u32 s[32:33], s22, v177
    v_cmp_gt_u32 s[96:97], s23, v177
    s_and_b64 s[34:35], s[34:35], vcc
    s_and_b64 s[36:37], s[36:37], vcc
    s_or_b64 s[34:35], s[34:35], s[10:11]
    s_or_b64 s[36:37], s[36:37], s[10:11]
    s_bcnt1_i32_b32 s24, s34
    s_bcnt1_i32_b32 s10, s36
    s_bcnt1_i32_b32 s11, s35
    s_bcnt1_i32_b32 s25, s37
    v_readlane_b32 s22, v200, s24
    v_readlane_b32 s10, v200, s10
    s_add_u32 s11, s11, 32
    s_add_u32 s16, s25, 32
    v_readlane_b32 s23, v200, s11
    v_readlane_b32 s11, v200, s16
    v_mov_b32 v188, s17
    v_cndmask_b32 v189, 0, v188, s[34:35]
    v_cndmask_b32 v188, 0, v188, s[36:37]
    s_and_b64 s[32:33], s[32:33], s[96:97]
    s_pack_lh_b32_b16 s22, s22, s10
    s_pack_lh_b32_b16 s23, s23, s11
    v_lshl_or_b32 v188, v188, 16, v189
    s_sub_u32 s16, s12, 37888
    s_pack_ll_b32_b16 s16, s16, s16
    s_sub_u32 s10, s22, s26
    s_sub_u32 s11, s23, s27
    s_mul_i32 s10, s10, 0x10001
    s_lshl_b32 vcc_lo, s10, 16
    s_pack_hh_b32_b16 s10, s10, s10
    s_lshl_b32 vcc_hi, s11, 16
    s_add_u32 vcc_hi, vcc_hi, s10
    s_add_u32 s96, vcc_hi, s11
    s_lshr_b32 s96, s96, 16
    s_sub_u32 s31, s31, s96
    s_cmp_gt_u32 s31, s96
    s_cselect_b32 s97, 0x4800480, 0
    s_add_u32 s16, s16, s97
    s_sub_u32 s10, s16, s26
    s_sub_u32 s11, s16, s27
    s_add_u32 s10, s10, vcc_lo
    s_add_u32 s11, s11, vcc_hi
    v_mov_b32 v192, s10
    v_mov_b32 v193, s11
    s_add_u32 s16, s16, 0x4800480
    s_sub_u32 s16, s16, s97
    s_sub_u32 s16, s16, s97
    s_sub_u32 s10, s28, s22
    s_sub_u32 s11, s29, s23
    s_mul_i32 s10, s10, 0x10001
    s_lshl_b32 vcc_lo, s10, 16
    s_pack_hh_b32_b16 s10, s10, s10
    s_lshl_b32 vcc_hi, s11, 16
    s_add_u32 vcc_hi, vcc_hi, s10
    s_sub_u32 s10, s16, s22
    s_sub_u32 s11, s16, s23
    s_add_u32 s10, s10, vcc_lo
    s_add_u32 s11, s11, vcc_hi
    v_mov_b32 v194, s10
    v_mov_b32 v195, s11
    v_bfi_b32 v192, v188, v192, v194
    v_bfi_b32 v193, v188, v193, v195
    s_mov_b32 exec_hi, 0
    v_mov_b32 v193, v192
    s_mov_b64 exec, s[32:33]
    v_add_u32 v200, v200, v193
    s_bfe_u32 s10, s97, 0x10007
    s_lshl1_add_u32 s10, s4, s10
    s_lshl_b32 s10, s10, 2
    v_cndmask_b32 v188, 4, 0, s[34:35]
    ds_write_b16 v178, v200 offset:1026
    ds_write_b16_d16_hi v178, v200 offset:2050
    s_mov_b32 exec_hi, 0
    v_xor_b32 v188, s10, v188
    ds_write_b32 v179, v188
    s_mov_b64 exec, -1
    s_min_u32 s10, s31, s96
    s_max_u32 s96, s31, s96
    s_mov_b32 s31, s10
    s_add_u32 s10, s96, s19
    s_mul_i32 s11, s30, 9216
    s_lshr_b32 s11, s11, 16
    s_max_u32 s10, s10, s11
    s_cmp_lt_u32 s10, 1152
    s_cbranch_scc1 L_LFIT
    ds_write_b32 v197, v184
L_LFIT:
    s_cmp_eq_u32 s19, 0
    s_cbranch_scc1 L_XCNR
    s_sub_u32 s10, s12, 37888
    s_add_u32 s11, s10, s96
    v_mov_b32 v188, s11
    s_add_u32 s11, s10, s31
    s_add_u32 s11, s11, 1152
    v_mov_b32 v189, s11
    s_lshl_b32 s10, s4, 3
    v_mov_b32 v190, s10
    ds_write_b64 v190, v[188:189] offset:576
L_XCNR:
    s_lshl_b32 m0, s3, 10
    v_mov_b32 v240, v215
    s_add_u32 m0, m0, 29696
    s_nop 0
    buffer_load_dwordx4 v[240:241], s[44:47], 0 idxen offen lds
    v_and_b32 v141, s17, v141
    s_waitcnt lgkmcnt(0)
    s_barrier
    ds_read_b64 v[202:203], v197
    ds_read_u16 v96, v96 offset:1026
    ds_read_u16 v97, v97 offset:1026
    ds_read_u16 v98, v98 offset:1026
    ds_read_u16 v100, v100 offset:1026
    ds_read_u16 v101, v101 offset:1026
    ds_read_u16 v102, v102 offset:1026
    ds_read_u16 v104, v104 offset:1026
    ds_read_u16 v105, v105 offset:1026
    ds_read_u16 v106, v106 offset:1026
    ds_read_u16 v108, v108 offset:1026
    ds_read_u16 v109, v109 offset:1026
    ds_read_u16 v110, v110 offset:1026
    s_lshl_b32 m0, s3, 10
    v_mov_b32 v240, v219
    s_add_u32 m0, m0, 37888
    s_nop 0
    buffer_load_dwordx4 v[240:241], s[44:47], 0 idxen offen lds
    s_add_u32 s24, s24, s7
    s_add_u32 s11, s25, s7
    s_and_b32 s10, s11, 15
    s_cmp_lt_u32 s11, s24
    s_cselect_b32 s25, s10, 16
    s_cmp_lg_u32 s97, 0
    s_cselect_b32 s23, s8, s11
    s_cselect_b32 s7, s8, s24
    s_cselect_b32 s8, s11, s8
    s_cselect_b32 s24, s9, s24
    s_cselect_b32 s9, s11, s9
    s_min_u32 s22, s8, 192
    s_min_u32 s23, s23, 192
    s_mov_b32 s30, s19
    s_waitcnt lgkmcnt(12)
    v_cmp_ne_u32 vcc, 0, v202
    v_readfirstlane_b32 s19, v203
    s_cbranch_vccnz L_OVF
    s_waitcnt lgkmcnt(9)
    s_mov_b64 exec, s[64:65]
    v_add_u32 v96, v96, v112
    ds_write2st64_b32 v96, v128, v204 offset0:148 offset1:220
    s_mov_b64 exec, s[66:67]
    v_add_u32 v97, v97, v113
    ds_write2st64_b32 v97, v129, v205 offset0:148 offset1:220
    s_mov_b64 exec, s[68:69]
    v_add_u32 v98, v98, v114
    ds_write2st64_b32 v98, v130, v206 offset0:148 offset1:220
    s_waitcnt lgkmcnt(9)
    s_mov_b64 exec, s[72:73]
    v_add_u32 v100, v100, v116
    ds_write2st64_b32 v100, v132, v208 offset0:148 offset1:220
    s_mov_b64 exec, s[74:75]
    v_add_u32 v101, v101, v117
    ds_write2st64_b32 v101, v133, v209 offset0:148 offset1:220
    s_mov_b64 exec, s[76:77]
    v_add_u32 v102, v102, v118
    ds_write2st64_b32 v102, v134, v210 offset0:148 offset1:220
    s_waitcnt lgkmcnt(9)
    s_mov_b64 exec, s[80:81]
    v_add_u32 v104, v104, v120
    ds_write2st64_b32 v104, v136, v212 offset0:148 offset1:220
    s_mov_b64 exec, s[82:83]
    v_add_u32 v105, v105, v121
    ds_write2st64_b32 v105, v137, v213 offset0:148 offset1:220
    s_mov_b64 exec, s[84:85]
    v_add_u32 v106, v106, v122
    ds_write2st64_b32 v106, v138, v214 offset0:148 offset1:220
    s_waitcnt lgkmcnt(9)
    s_mov_b64 exec, s[88:89]
    v_add_u32 v108, v108, v124
    ds_write2st64_b32 v108, v140, v216 offset0:148 offset1:220
    s_mov_b64 exec, s[90:91]
    v_add_u32 v109, v109, v125
    ds_write2st64_b32 v109, v141, v217 offset0:148 offset1:220
    s_mov_b64 exec, s[92:93]
    v_add_u32 v110, v110, v126
    ds_write2st64_b32 v110, v142, v218 offset0:148 offset1:220
    s_mov_b64 exec, -1
    s_add_u32 s10, s96, 127
    s_lshr_b32 s10, s10, 7
    s_lshl1_add_u32 s10, s10, -1
    s_add_u32 s11, s31, 127
    s_lshr_b32 s11, s11, 6
    s_and_b32 s11, s11, -2
    s_max_i32 s17, s10, s11
    s_cselect_b32 s10, s96, s31
    s_sub_u32 s10, s10, 1
    s_andn2_b32 s99, 64, s10
L_CA:
    ds_read_b64_tr_b16 v[96:97], v225 offset:0
    ds_read_b64_tr_b16 v[98:99], v225 offset:1280
    ds_read_b64_tr_b16 v[100:101], v225 offset:5120
    ds_read_b64_tr_b16 v[102:103], v225 offset:6400
    ds_read_b64_tr_b16 v[104:105], v225 offset:32
    ds_read_b64_tr_b16 v[106:107], v225 offset:1312
    ds_read_b64_tr_b16 v[108:109], v225 offset:5152
    ds_read_b64_tr_b16 v[110:111], v225 offset:6432
    ds_read_b64_tr_b16 v[112:113], v225 offset:64
    ds_read_b64_tr_b16 v[114:115], v225 offset:1344
    ds_read_b64_tr_b16 v[116:117], v225 offset:5184
    ds_read_b64_tr_b16 v[118:119], v225 offset:6464
    ds_read_b64_tr_b16 v[120:121], v225 offset:96
    ds_read_b64_tr_b16 v[122:123], v225 offset:1376
    ds_read_b64_tr_b16 v[124:125], v225 offset:5216
    ds_read_b64_tr_b16 v[126:127], v225 offset:6496
    s_cmp_eq_u32 s21, 0
    s_cbranch_scc1 L_XT2R
    s_waitcnt vmcnt(8)
L_XT2:
    s_mov_b64 s[34:35], 0
    v_cmp_ne_u32 vcc, s6, v65
    s_and_b64 vcc, vcc, s[70:71]
    s_or_b64 s[34:35], s[34:35], vcc
    v_cmp_ne_u32 vcc, s6, v69
    s_and_b64 vcc, vcc, s[78:79]
    s_or_b64 s[34:35], s[34:35], vcc
    v_cmp_ne_u32 vcc, s6, v73
    s_and_b64 vcc, vcc, s[86:87]
    s_or_b64 s[34:35], s[34:35], vcc
    v_cmp_ne_u32 vcc, s6, v77
    s_and_b64 vcc, vcc, s[94:95]
    s_or_b64 s[34:35], s[34:35], vcc
    s_cbranch_scc1 L_XT2B
    s_cmp_eq_u32 s20, 0
    s_cbranch_scc1 L_XT2R
    s_mov_b64 exec, s[70:71]
    s_cbranch_execz L_XS0
    v_bfe_u32 v65, v64, 18, 8
    v_lshlrev_b32 v65, 2, v65
    v_add_u32 v67, 153728, v65
    ds_read_b32 v67, v67
    v_add_u32_sdwa v66, v66, v156 dst_sel:DWORD dst_unused:UNUSED_PAD src0_sel:BYTE_0 src1_sel:DWORD
    v_lshrrev_b32 v189, 28, v64
    v_lshl_add_u32 v66, v189, 8, v66
    v_and_b32 v189, 60, v65
    v_lshl_add_u32 v66, v189, 19, v66
    v_and_b32 v64, 0xffff, v64
    s_waitcnt lgkmcnt(0)
    ds_add_rtn_u32 v67, v67, v184 offset:576
    s_waitcnt lgkmcnt(0)
    ds_write2st64_b32 v67, v64, v66 offset0:148 offset1:220
L_XS0:
    s_mov_b64 exec, s[78:79]
    s_cbranch_execz L_XS1
    v_bfe_u32 v69, v68, 18, 8
    v_lshlrev_b32 v69, 2, v69
    v_add_u32 v71, 153728, v69
    ds_read_b32 v71, v71
    v_add_u32_sdwa v70, v70, v157 dst_sel:DWORD dst_unused:UNUSED_PAD src0_sel:BYTE_0 src1_sel:DWORD
    v_lshrrev_b32 v189, 28, v68
    v_lshl_add_u32 v70, v189, 8, v70
    v_and_b32 v189, 60, v69
    v_lshl_add_u32 v70, v189, 19, v70
    v_and_b32 v68, 0xffff, v68
    s_waitcnt lgkmcnt(0)
    ds_add_rtn_u32 v71, v71, v184 offset:576
    s_waitcnt lgkmcnt(0)
    ds_write2st64_b32 v71, v68, v70 offset0:148 offset1:220
L_XS1:
    s_mov_b64 exec, s[86:87]
    s_cbranch_execz L_XS2
    v_bfe_u32 v73, v72, 18, 8
    v_lshlrev_b32 v73, 2, v73
    v_add_u32 v75, 153728, v73
    ds_read_b32 v75, v75
    v_add_u32_sdwa v74, v74, v158 dst_sel:DWORD dst_unused:UNUSED_PAD src0_sel:BYTE_0 src1_sel:DWORD
    v_lshrrev_b32 v189, 28, v72
    v_lshl_add_u32 v74, v189, 8, v74
    v_and_b32 v189, 60, v73
    v_lshl_add_u32 v74, v189, 19, v74
    v_and_b32 v72, 0xffff, v72
    s_waitcnt lgkmcnt(0)
    ds_add_rtn_u32 v75, v75, v184 offset:576
    s_waitcnt lgkmcnt(0)
    ds_write2st64_b32 v75, v72, v74 offset0:148 offset1:220
L_XS2:
    s_mov_b64 exec, s[94:95]
    s_cbranch_execz L_XS3
    v_bfe_u32 v77, v76, 18, 8
    v_lshlrev_b32 v77, 2, v77
    v_add_u32 v79, 153728, v77
    ds_read_b32 v79, v79
    v_add_u32_sdwa v78, v78, v159 dst_sel:DWORD dst_unused:UNUSED_PAD src0_sel:BYTE_0 src1_sel:DWORD
    v_lshrrev_b32 v189, 28, v76
    v_lshl_add_u32 v78, v189, 8, v78
    v_and_b32 v189, 60, v77
    v_lshl_add_u32 v78, v189, 19, v78
    v_and_b32 v76, 0xffff, v76
    s_waitcnt lgkmcnt(0)
    ds_add_rtn_u32 v79, v79, v184 offset:576
    s_waitcnt lgkmcnt(0)
    ds_write2st64_b32 v79, v76, v78 offset0:148 offset1:220
L_XS3:
    s_mov_b64 exec, -1
L_XT2R:
    s_cmp_ge_u32 s3, 4
    s_cbranch_scc1 L_EP0
    s_lshl_b32 s72, s4, 7
    s_add_u32 s72, s72, 157824
    v_mov_b32 v190, s22
    s_mov_b32 exec_lo, 0xffff0000
    v_mov_b32 v190, s23
    s_mov_b32 exec_lo, -1
    s_mov_b32 exec_hi, 0
    v_sub_u32 v191, v253, v190
    v_and_b32 v191, 15, v191
    v_add_lshl_u32 v191, v191, v190, 5
    v_lshl_add_u32 v190, v253, 2, s72
    ds_write_b32 v190, v191
    s_mov_b32 exec_hi, -1
    s_mul_i32 s10, s5, 196
    s_add_u32 s11, s10, s7
    s_add_u32 s62, s10, s9
    s_min_u32 s11, s11, 50000
    s_min_u32 s62, s62, 50000
    s_sub_u32 s62, s62, s11
    s_lshl_b32 s11, s11, 7
    s_lshl_b32 s62, s62, 7
    s_add_u32 s60, s48, s11
    s_addc_u32 s61, s49, 0
    s_mul_i32 s74, s7, -128
    s_add_u32 s11, s10, s8
    s_add_u32 s50, s10, s24
    s_min_u32 s11, s11, 50000
    s_min_u32 s50, s50, 50000
    s_sub_u32 s50, s50, s11
    s_lshl_b32 s11, s11, 7
    s_lshl_b32 s50, s50, 7
    s_add_u32 s48, s48, s11
    s_addc_u32 s49, s49, 0
    s_mul_i32 s73, s8, -128
    s_and_b32 s10, s25, 12
    s_lshl_b32 s10, s10, 2
    s_bfm_b64 s[76:77], 16, s10
L_EP0:
    s_waitcnt vmcnt(0) lgkmcnt(0)
    s_barrier
    s_mov_b32 s10, 0x358637bd
    ds_read_b128 v[236:239], v247
    ds_read_b32 v240, v248
    v_lshrrev_b32 v188, 2, v253
    v_and_b32 v188, 12, v188
    v_subrev_u32 v188, s25, v188
    s_waitcnt lgkmcnt(0)
    s_cmp_ge_u32 s3, 4
    s_cbranch_scc1 L_LATE0
    s_add_u32 m0, s13, 0
    v_mad_u32_u16 v236, v236, s15, v243
    buffer_load_dwordx4 v236, s[40:43], 0 offen lds
    s_add_u32 m0, s13, 1056
    v_mad_u32_u16 v237, v237, s15, v243
    buffer_load_dwordx4 v237, s[40:43], 0 offen lds
    s_add_u32 m0, s13, 2112
    v_mad_u32_u16 v238, v238, s15, v243
    buffer_load_dwordx4 v238, s[40:43], 0 offen lds
    s_add_u32 m0, s13, 3168
    v_mad_u32_u16 v239, v239, s15, v243
    buffer_load_dwordx4 v239, s[40:43], 0 offen lds
    s_mov_b32 m0, s14
    v_and_b32 v240, 0xfffff, v240
    buffer_load_dwordx4 v[240:241], s[44:47], 0 idxen offen lds
L_LATE0:
    s_lshl_b32 s34, s22, 5
    s_lshl_b32 s35, s23, 5
    s_mov_b32 vcc_lo, 0xff00ff00
    s_mov_b32 vcc_hi, 0xff00ff00
    v_mov_b32 v176, s35
    v_mov_b32 v177, s34
    v_cndmask_b32 v176, v176, v177, vcc
    v_and_b32 v177, 4, v253
    v_lshlrev_b32 v177, 6, v177
    v_lshl_add_u32 v177, v246, 2, v177
    v_sub_u32 v177, v177, v176
    v_and_b32 v178, 48, v253
    s_movk_i32 s34, 832
    v_mad_u32_u24 v178, v246, s34, v178
    s_mov_b32 s34, 116736
    v_add3_u32 v178, v178, v176, s34
    v_and_b32 v176, 0x1ff, v177
    v_add_u32 v176, v176, v178
    ds_read_b128 v[160:163], v176 offset:0
    ds_read_b128 v[164:167], v176 offset:64
    v_add_u32 v177, 0x80, v177
    v_and_b32 v176, 0x1ff, v177
    v_add_u32 v176, v176, v178
    ds_read_b128 v[168:171], v176 offset:0
    ds_read_b128 v[172:175], v176 offset:64
    s_mov_b32 s34, 0xbfb8aa3b
    s_mov_b32 s35, s34
    s_waitcnt lgkmcnt(3)
    v_mfma_f32_16x16x32_bf16 v[204:207], v[160:163], v[96:99], 0
    v_mfma_f32_16x16x32_bf16 v[212:215], v[160:163], v[104:107], 0
    v_mfma_f32_16x16x32_bf16 v[220:223], v[160:163], v[112:115], 0
    v_mfma_f32_16x16x32_bf16 v[228:231], v[160:163], v[120:123], 0
    s_waitcnt lgkmcnt(2)
    v_mfma_f32_16x16x32_bf16 v[204:207], v[164:167], v[100:103], v[204:207]
    v_mfma_f32_16x16x32_bf16 v[212:215], v[164:167], v[108:111], v[212:215]
    v_mfma_f32_16x16x32_bf16 v[220:223], v[164:167], v[116:119], v[220:223]
    v_mfma_f32_16x16x32_bf16 v[228:231], v[164:167], v[124:127], v[228:231]
    s_waitcnt lgkmcnt(1)
    v_mfma_f32_16x16x32_bf16 v[208:211], v[168:171], v[96:99], 0
    v_mfma_f32_16x16x32_bf16 v[216:219], v[168:171], v[104:107], 0
    v_mfma_f32_16x16x32_bf16 v[224:227], v[168:171], v[112:115], 0
    v_mfma_f32_16x16x32_bf16 v[232:235], v[168:171], v[120:123], 0
    s_waitcnt lgkmcnt(0)
    v_mfma_f32_16x16x32_bf16 v[208:211], v[172:175], v[100:103], v[208:211]
    v_mfma_f32_16x16x32_bf16 v[216:219], v[172:175], v[108:111], v[216:219]
    v_mfma_f32_16x16x32_bf16 v[224:227], v[172:175], v[116:119], v[224:227]
    v_mfma_f32_16x16x32_bf16 v[232:235], v[172:175], v[124:127], v[232:235]
    s_mov_b32 s11, s10
    v_mov_b32 v189, s10
    v_mov_b64 v[96:97], s[10:11]
    v_mov_b64 v[98:99], s[10:11]
    v_mov_b64 v[100:101], s[10:11]
    v_mov_b64 v[102:103], s[10:11]
    v_mov_b64 v[104:105], s[10:11]
    v_mov_b64 v[106:107], s[10:11]
    v_mov_b64 v[108:109], s[10:11]
    v_mov_b64 v[110:111], s[10:11]
    v_cmp_ne_u32 vcc, 0, v188
    v_mov_b64 v[112:113], 0
    v_mov_b64 v[114:115], 0
    v_cndmask_b32 v128, 0, v189, vcc
    v_cmp_ne_u32 vcc, -1, v188
    v_mov_b64 v[116:117], 0
    v_mov_b64 v[118:119], 0
    v_cndmask_b32 v129, 0, v189, vcc
    v_cmp_ne_u32 vcc, -2, v188
    v_mov_b64 v[120:121], 0
    v_mov_b64 v[122:123], 0
    v_cndmask_b32 v130, 0, v189, vcc
    v_cmp_ne_u32 vcc, -3, v188
    v_mov_b64 v[124:125], 0
    v_mov_b64 v[126:127], 0
    v_cndmask_b32 v131, 0, v189, vcc
    v_mov_b64 v[144:145], 0
    v_mov_b64 v[146:147], 0
    v_mov_b64 v[148:149], 0
    v_mov_b64 v[150:151], 0
    v_mov_b64 v[152:153], 0
    v_mov_b64 v[154:155], 0
    v_mov_b64 v[156:157], 0
    v_mov_b64 v[158:159], 0
    v_mov_b64 v[132:133], v[128:129]
    v_mov_b64 v[134:135], v[130:131]
    v_mov_b64 v[136:137], v[128:129]
    v_mov_b64 v[138:139], v[130:131]
    v_mov_b64 v[140:141], v[128:129]
    v_mov_b64 v[142:143], v[130:131]
    v_pk_mul_f32 v[204:205], v[204:205], s[34:35]
    v_pk_mul_f32 v[206:207], v[206:207], s[34:35]
    v_pk_mul_f32 v[208:209], v[208:209], s[34:35]
    v_pk_mul_f32 v[210:211], v[210:211], s[34:35]
    v_pk_mul_f32 v[212:213], v[212:213], s[34:35]
    v_pk_mul_f32 v[214:215], v[214:215], s[34:35]
    v_pk_mul_f32 v[216:217], v[216:217], s[34:35]
    v_pk_mul_f32 v[218:219], v[218:219], s[34:35]
    v_pk_mul_f32 v[220:221], v[220:221], s[34:35]
    v_pk_mul_f32 v[222:223], v[222:223], s[34:35]
    v_pk_mul_f32 v[224:225], v[224:225], s[34:35]
    v_pk_mul_f32 v[226:227], v[226:227], s[34:35]
    v_pk_mul_f32 v[228:229], v[228:229], s[34:35]
    v_pk_mul_f32 v[230:231], v[230:231], s[34:35]
    v_pk_mul_f32 v[232:233], v[232:233], s[34:35]
    v_pk_mul_f32 v[234:235], v[234:235], s[34:35]
    v_cvt_pk_bf16_f32 v64, v204, v205
    v_cvt_pk_bf16_f32 v65, v206, v207
    v_cvt_pk_bf16_f32 v66, v208, v209
    v_cvt_pk_bf16_f32 v67, v210, v211
    v_cvt_pk_bf16_f32 v68, v212, v213
    v_cvt_pk_bf16_f32 v69, v214, v215
    v_cvt_pk_bf16_f32 v70, v216, v217
    v_cvt_pk_bf16_f32 v71, v218, v219
    v_cvt_pk_bf16_f32 v72, v220, v221
    v_cvt_pk_bf16_f32 v73, v222, v223
    v_cvt_pk_bf16_f32 v74, v224, v225
    v_cvt_pk_bf16_f32 v75, v226, v227
    v_cvt_pk_bf16_f32 v76, v228, v229
    v_cvt_pk_bf16_f32 v77, v230, v231
    v_cvt_pk_bf16_f32 v78, v232, v233
    v_cvt_pk_bf16_f32 v79, v234, v235
    v_permlane32_swap_b32 v80, v64
    v_permlane32_swap_b32 v81, v65
    v_permlane32_swap_b32 v82, v66
    v_permlane32_swap_b32 v83, v67
    v_permlane32_swap_b32 v84, v68
    v_permlane32_swap_b32 v85, v69
    v_permlane32_swap_b32 v86, v70
    v_permlane32_swap_b32 v87, v71
    v_permlane32_swap_b32 v88, v72
    v_permlane32_swap_b32 v89, v73
    v_permlane32_swap_b32 v90, v74
    v_permlane32_swap_b32 v91, v75
    v_permlane32_swap_b32 v92, v76
    v_permlane32_swap_b32 v93, v77
    v_permlane32_swap_b32 v94, v78
    v_permlane32_swap_b32 v95, v79
    s_mov_b32 s26, -1
    s_mov_b64 s[32:33], 0
    s_mov_b32 s28, 0
    s_mov_b32 s29, 0
    s_cmp_lt_u32 s3, 4
    s_cbranch_scc1 L_HAD0
    s_add_u32 m0, s13, 0
    v_mad_u32_u16 v236, v236, s15, v243
    buffer_load_dwordx4 v236, s[40:43], 0 offen lds
    s_add_u32 m0, s13, 1056
    v_mad_u32_u16 v237, v237, s15, v243
    buffer_load_dwordx4 v237, s[40:43], 0 offen lds
    s_add_u32 m0, s13, 2112
    v_mad_u32_u16 v238, v238, s15, v243
    buffer_load_dwordx4 v238, s[40:43], 0 offen lds
    s_add_u32 m0, s13, 3168
    v_mad_u32_u16 v239, v239, s15, v243
    buffer_load_dwordx4 v239, s[40:43], 0 offen lds
    s_mov_b32 m0, s14
    v_and_b32 v240, 0xfffff, v240
    buffer_load_dwordx4 v[240:241], s[44:47], 0 idxen offen lds
    s_lshl_b32 s72, s4, 7
    s_add_u32 s72, s72, 157824
    v_mov_b32 v190, s22
    s_mov_b32 exec_lo, 0xffff0000
    v_mov_b32 v190, s23
    s_mov_b32 exec_lo, -1
    s_mov_b32 exec_hi, 0
    v_sub_u32 v191, v253, v190
    v_and_b32 v191, 15, v191
    v_add_lshl_u32 v191, v191, v190, 5
    v_lshl_add_u32 v190, v253, 2, s72
    ds_write_b32 v190, v191
    s_mov_b32 exec_hi, -1
    s_mul_i32 s10, s5, 196
    s_add_u32 s11, s10, s7
    s_add_u32 s62, s10, s9
    s_min_u32 s11, s11, 50000
    s_min_u32 s62, s62, 50000
    s_sub_u32 s62, s62, s11
    s_lshl_b32 s11, s11, 7
    s_lshl_b32 s62, s62, 7
    s_add_u32 s60, s48, s11
    s_addc_u32 s61, s49, 0
    s_mul_i32 s74, s7, -128
    s_add_u32 s11, s10, s8
    s_add_u32 s50, s10, s24
    s_min_u32 s11, s11, 50000
    s_min_u32 s50, s50, 50000
    s_sub_u32 s50, s50, s11
    s_lshl_b32 s11, s11, 7
    s_lshl_b32 s50, s50, 7
    s_add_u32 s48, s48, s11
    s_addc_u32 s49, s49, 0
    s_mul_i32 s73, s8, -128
    s_and_b32 s10, s25, 12
    s_lshl_b32 s10, s10, 2
    s_bfm_b64 s[76:77], 16, s10
L_HAD0:
    s_cmp_eq_u32 s30, 0
    s_cbranch_scc1 L_GO
    s_lshl_b32 s10, s4, 3
    v_mov_b32 v188, s10
    ds_read_b64 v[188:189], v188 offset:576
    s_waitcnt lgkmcnt(0)
    v_readfirstlane_b32 s34, v188
    v_readfirstlane_b32 s35, v189
    s_sub_u32 s10, s12, 37888
    s_sub_u32 s34, s34, s10
    s_sub_u32 s35, s35, s10
    s_sub_u32 s35, s35, 1152
    s_add_u32 s10, s34, 127
    s_lshr_b32 s10, s10, 7
    s_lshl1_add_u32 s10, s10, -1
    s_add_u32 s11, s35, 127
    s_lshr_b32 s11, s11, 6
    s_and_b32 s11, s11, -2
    s_max_i32 s17, s10, s11
    s_cselect_b32 s10, s34, s35
    s_sub_u32 s10, s10, 1
    s_andn2_b32 s99, 64, s10
L_GO:
    ds_read_u16 v251, v249 offset:0
    ds_read_u16 v252, v249 offset:64
    ds_read_b128 v[236:239], v247 offset:1152
    ds_read_b32 v240, v248 offset:1152
    s_lshr_b32 s10, s4, 1
    s_lshl_b32 s10, s10, 9
    s_add_u32 s10, s10, 155776
    v_lshl_add_u32 v246, v253, 3, s10
    s_bitcmp1_b32 s4, 0
    s_cselect_b32 s101, -1, 1
    s_mul_i32 s10, s101, 0xff000000
    s_or_b32 s10, s10, 0xdddd
    v_mov_b32 v255, s10
    s_max_i32 s10, s17, 1
    s_sub_u32 s10, s10, 1
    s_mul_i32 s10, s101, s10
    s_lshl_b32 s10, s10, 24
    v_mov_b32 v204, s10
    ds_add_u32 v246, v204
    v_mov_b32 v253, 0
    s_mov_b32 exec_hi, 0
    v_add_u32 v253, 0x200, v245
    s_mov_b32 exec_hi, -1
    v_mov_b64 v[204:205], 0
    v_mov_b64 v[206:207], 0
    v_mov_b64 v[208:209], 0
    v_mov_b64 v[210:211], 0
    v_mov_b64 v[212:213], 0
    v_mov_b64 v[214:215], 0
    v_mov_b64 v[216:217], 0
    v_mov_b64 v[218:219], 0
    v_mov_b64 v[220:221], 0
    v_mov_b64 v[222:223], 0
    v_mov_b64 v[224:225], 0
    v_mov_b64 v[226:227], 0
    v_mov_b64 v[228:229], 0
    v_mov_b64 v[230:231], 0
    v_mov_b64 v[232:233], 0
    v_mov_b64 v[234:235], 0
    v_mov_b64 v[184:185], 0
    v_mov_b64 v[186:187], 0
    s_waitcnt lgkmcnt(0)
    v_bfi_b32 v251, 31, v245, v251
    v_bfi_b32 v252, 31, v245, v252
    v_max_u32 v251, v251, v245
    v_max_u32 v252, v252, v253
    s_waitcnt vmcnt(0)
    ds_read_b128 v[176:179], v251
    ds_read_b128 v[180:183], v252
    ds_read_b128 v[160:163], v244 offset:0
    ds_read_b128 v[168:171], v244 offset:512
    ds_read_b128 v[164:167], v244 offset:64
    ds_read_b128 v[172:175], v244 offset:576
    s_cmp_lt_i32 s17, 1
    s_cbranch_scc1 L_DONE
    s_waitcnt lgkmcnt(4)
    v_mfma_f32_16x16x32_bf16 v[188:191], v[176:179], v[64:67], 0
    v_mfma_f32_16x16x32_bf16 v[196:199], v[176:179], v[68:71], 0
    v_mfma_f32_16x16x32_bf16 v[192:195], v[180:183], v[64:67], 0
    v_mfma_f32_16x16x32_bf16 v[200:203], v[180:183], v[68:71], 0
    s_waitcnt lgkmcnt(0)
    v_mfma_f32_16x16x32_bf16 v[188:191], v[160:163], v[0:3], v[188:191]
    v_mfma_f32_16x16x32_bf16 v[196:199], v[160:163], v[8:11], v[196:199]
    v_mfma_f32_16x16x32_bf16 v[192:195], v[168:171], v[0:3], v[192:195]
    v_mfma_f32_16x16x32_bf16 v[200:203], v[168:171], v[8:11], v[200:203]
    v_mfma_f32_16x16x32_bf16 v[188:191], v[164:167], v[4:7], v[188:191]
    v_mfma_f32_16x16x32_bf16 v[196:199], v[164:167], v[12:15], v[196:199]
    v_mfma_f32_16x16x32_bf16 v[192:195], v[172:175], v[4:7], v[192:195]
    v_mfma_f32_16x16x32_bf16 v[200:203], v[172:175], v[12:15], v[200:203]
    s_mov_b32 s16, 1
    s_cmp_eq_u32 s17, 1
    s_cbranch_scc1 L_LT0
    s_add_u32 m0, s13, 0
    v_mad_u32_u16 v236, v236, s15, v243
    buffer_load_dwordx4 v236, s[40:43], 0 offen lds
    s_add_u32 m0, s13, 1056
    v_mad_u32_u16 v237, v237, s15, v243
    buffer_load_dwordx4 v237, s[40:43], 0 offen lds
    s_add_u32 m0, s13, 2112
    v_mad_u32_u16 v238, v238, s15, v243
    buffer_load_dwordx4 v238, s[40:43], 0 offen lds
    s_add_u32 m0, s13, 3168
    v_mad_u32_u16 v239, v239, s15, v243
    buffer_load_dwordx4 v239, s[40:43], 0 offen lds
    s_mov_b32 m0, s14
    v_and_b32 v240, 0xfffff, v240
    buffer_load_dwordx4 v[240:241], s[44:47], 0 idxen offen lds
.p2align 6
L_LOOP1:
    s_setprio 1
    v_smfmac_f32_16x16x64_bf16 v[152:155], v[184:187], v[204:211], v255
    ds_read_u16 v236, v250 offset:0
    ds_read_u16 v237, v250 offset:16
    ds_add_rtn_u32 v238, v246, v255
    v_exp_f32 v188, v188
    v_smfmac_f32_16x16x64_bf16 v[156:159], v[184:187], v[212:219], v255
    v_exp_f32 v189, v189
    v_mfma_f32_16x16x32_bf16 v[204:207], v[160:163], v[32:35], 0
    v_exp_f32 v190, v190
    v_mfma_f32_16x16x32_bf16 v[212:215], v[160:163], v[40:43], 0
    v_exp_f32 v191, v191
    v_mfma_f32_16x16x32_bf16 v[208:211], v[168:171], v[32:35], 0
    v_exp_f32 v192, v192
    v_mfma_f32_16x16x32_bf16 v[216:219], v[168:171], v[40:43], 0
    v_exp_f32 v193, v193
    v_mfma_f32_16x16x32_bf16 v[204:207], v[164:167], v[36:39], v[204:207]
    v_exp_f32 v194, v194
    v_mfma_f32_16x16x32_bf16 v[212:215], v[164:167], v[44:47], v[212:215]
    v_exp_f32 v195, v195
    v_mfma_f32_16x16x32_bf16 v[208:211], v[172:175], v[36:39], v[208:211]
    s_waitcnt lgkmcnt(0)
    v_bfi_b32 v236, 31, v246, v236
    v_bfi_b32 v237, 31, v246, v237
    v_readfirstlane_b32 s96, v238
    v_exp_f32 v196, v196
    v_mfma_f32_16x16x32_bf16 v[216:219], v[172:175], v[44:47], v[216:219]
    v_exp_f32 v197, v197
    v_smfmac_f32_16x16x64_bf16 v[136:139], v[184:187], v[220:227], v255
    v_exp_f32 v198, v198
    v_smfmac_f32_16x16x64_bf16 v[140:143], v[184:187], v[228:235], v255
    v_exp_f32 v199, v199
    v_mfma_f32_4x4x4_16b_bf16 v[188:191], v[242:243], v[242:243], v[188:191]
    v_exp_f32 v200, v200
    v_mfma_f32_4x4x4_16b_bf16 v[192:195], v[242:243], v[242:243], v[192:195]
    v_exp_f32 v201, v201
    v_mfma_f32_4x4x4_16b_bf16 v[196:199], v[242:243], v[242:243], v[196:199]
    v_exp_f32 v202, v202
    v_mfma_f32_16x16x32_bf16 v[220:223], v[176:179], v[72:75], 0
    ds_read_b64_tr_b16 v[184:185], v236
    ds_read_b64_tr_b16 v[186:187], v237
    ds_read_u16 v251, v249 offset:1152
    ds_read_u16 v252, v249 offset:1216
    v_exp_f32 v203, v203
    v_mfma_f32_16x16x32_bf16 v[228:231], v[176:179], v[76:79], 0
    s_ashr_i32 s96, s96, 24
    s_mul_i32 s96, s96, s101
    v_rcp_f32 v188, v188
    v_mfma_f32_16x16x32_bf16 v[224:227], v[180:183], v[72:75], 0
    v_rcp_f32 v189, v189
    v_mfma_f32_4x4x4_16b_bf16 v[200:203], v[242:243], v[242:243], v[200:203]
    v_rcp_f32 v190, v190
    v_mfma_f32_16x16x32_bf16 v[232:235], v[180:183], v[76:79], 0
    v_rcp_f32 v191, v191
    v_mfma_f32_16x16x32_bf16 v[220:223], v[160:163], v[16:19], v[220:223]
    v_rcp_f32 v192, v192
    v_mfma_f32_16x16x32_bf16 v[228:231], v[160:163], v[24:27], v[228:231]
    v_rcp_f32 v193, v193
    v_mfma_f32_16x16x32_bf16 v[224:227], v[168:171], v[16:19], v[224:227]
    s_waitcnt lgkmcnt(0)
    v_bfi_b32 v251, 31, v245, v251
    v_bfi_b32 v252, 31, v245, v252
    v_max_u32 v251, v251, v245
    v_max_u32 v252, v252, v253
    ds_read_b128 v[236:239], v247 offset:128
    ds_read_b32 v240, v248 offset:128
    s_add_u32 s16, s16, 1
    v_rcp_f32 v194, v194
    v_mfma_f32_16x16x32_bf16 v[232:235], v[168:171], v[24:27], v[232:235]
    v_rcp_f32 v195, v195
    v_mfma_f32_16x16x32_bf16 v[220:223], v[164:167], v[20:23], v[220:223]
    v_rcp_f32 v196, v196
    v_mfma_f32_16x16x32_bf16 v[228:231], v[164:167], v[28:31], v[228:231]
    v_rcp_f32 v197, v197
    s_setprio 3
    v_mfma_f32_16x16x32_bf16 v[224:227], v[172:175], v[20:23], v[224:227]
    v_rcp_f32 v198, v198
    v_mfma_f32_16x16x32_bf16 v[232:235], v[172:175], v[28:31], v[232:235]
    v_rcp_f32 v199, v199
    v_rcp_f32 v200, v200
    v_rcp_f32 v201, v201
    v_rcp_f32 v202, v202
    v_rcp_f32 v203, v203
    v_pk_mul_f32 v[204:205], v[188:189], v[204:205]
    v_pk_mul_f32 v[206:207], v[190:191], v[206:207]
    v_pk_mul_f32 v[208:209], v[192:193], v[208:209]
    v_pk_mul_f32 v[210:211], v[194:195], v[210:211]
    v_pk_mul_f32 v[212:213], v[196:197], v[212:213]
    v_pk_mul_f32 v[214:215], v[198:199], v[214:215]
    v_pk_mul_f32 v[216:217], v[200:201], v[216:217]
    v_pk_mul_f32 v[218:219], v[202:203], v[218:219]
    s_cmp_ge_i32 s96, 1
    s_cbranch_scc0 L_PB00
L_PB01:
    s_setprio 1
    v_smfmac_f32_16x16x64_bf16 v[112:115], v[184:187], v[204:211], v255
    v_exp_f32 v220, v220
    v_smfmac_f32_16x16x64_bf16 v[116:119], v[184:187], v[212:219], v255
    v_exp_f32 v221, v221
    s_waitcnt vmcnt(0)
    ds_read_b128 v[176:179], v251
    ds_read_b128 v[180:183], v252
    v_mfma_f32_16x16x32_bf16 v[204:207], v[160:163], v[48:51], 0
    v_exp_f32 v222, v222
    v_mfma_f32_16x16x32_bf16 v[212:215], v[160:163], v[56:59], 0
    ds_read_b128 v[160:163], v244 offset:0
    v_exp_f32 v223, v223
    v_mfma_f32_16x16x32_bf16 v[208:211], v[168:171], v[48:51], 0
    v_exp_f32 v224, v224
    v_mfma_f32_16x16x32_bf16 v[216:219], v[168:171], v[56:59], 0
    ds_read_b128 v[168:171], v244 offset:512
    v_exp_f32 v225, v225
    v_mfma_f32_16x16x32_bf16 v[204:207], v[164:167], v[52:55], v[204:207]
    v_exp_f32 v226, v226
    v_mfma_f32_16x16x32_bf16 v[212:215], v[164:167], v[60:63], v[212:215]
    ds_read_b128 v[164:167], v244 offset:64
    v_exp_f32 v227, v227
    v_mfma_f32_16x16x32_bf16 v[208:211], v[172:175], v[52:55], v[208:211]
    v_exp_f32 v228, v228
    v_mfma_f32_16x16x32_bf16 v[216:219], v[172:175], v[60:63], v[216:219]
    ds_read_b128 v[172:175], v244 offset:576
    v_exp_f32 v229, v229
    v_smfmac_f32_16x16x64_bf16 v[96:99], v[184:187], v[188:195], v255
    v_exp_f32 v230, v230
    v_smfmac_f32_16x16x64_bf16 v[100:103], v[184:187], v[196:203], v255
    v_exp_f32 v231, v231
    v_mfma_f32_4x4x4_16b_bf16 v[220:223], v[242:243], v[242:243], v[220:223]
    v_exp_f32 v232, v232
    v_mfma_f32_4x4x4_16b_bf16 v[224:227], v[242:243], v[242:243], v[224:227]
    v_exp_f32 v233, v233
    v_mfma_f32_4x4x4_16b_bf16 v[228:231], v[242:243], v[242:243], v[228:231]
    v_exp_f32 v234, v234
    s_waitcnt lgkmcnt(4)
    v_mfma_f32_16x16x32_bf16 v[188:191], v[176:179], v[80:83], 0
    v_exp_f32 v235, v235
    v_mfma_f32_16x16x32_bf16 v[196:199], v[176:179], v[84:87], 0
    v_rcp_f32 v220, v220
    v_mfma_f32_16x16x32_bf16 v[192:195], v[180:183], v[80:83], 0
    v_rcp_f32 v221, v221
    v_mfma_f32_4x4x4_16b_bf16 v[232:235], v[242:243], v[242:243], v[232:235]
    v_rcp_f32 v222, v222
    v_mfma_f32_16x16x32_bf16 v[200:203], v[180:183], v[84:87], 0
    v_rcp_f32 v223, v223
    s_waitcnt lgkmcnt(3)
    v_mfma_f32_16x16x32_bf16 v[188:191], v[160:163], v[0:3], v[188:191]
    v_rcp_f32 v224, v224
    v_mfma_f32_16x16x32_bf16 v[196:199], v[160:163], v[8:11], v[196:199]
    v_rcp_f32 v225, v225
    s_waitcnt lgkmcnt(2)
    v_mfma_f32_16x16x32_bf16 v[192:195], v[168:171], v[0:3], v[192:195]
    v_rcp_f32 v226, v226
    v_mfma_f32_16x16x32_bf16 v[200:203], v[168:171], v[8:11], v[200:203]
    v_rcp_f32 v227, v227
    s_waitcnt lgkmcnt(1)
    v_mfma_f32_16x16x32_bf16 v[188:191], v[164:167], v[4:7], v[188:191]
    v_rcp_f32 v228, v228
    v_mfma_f32_16x16x32_bf16 v[196:199], v[164:167], v[12:15], v[196:199]
    v_rcp_f32 v229, v229
    s_setprio 3
    s_waitcnt lgkmcnt(0)
    v_mfma_f32_16x16x32_bf16 v[192:195], v[172:175], v[4:7], v[192:195]
    s_cmp_lt_u32 s16, s17
    s_cbranch_scc0 L_ND01
    s_add_u32 m0, s13, 0
    v_mad_u32_u16 v236, v236, s15, v243
    buffer_load_dwordx4 v236, s[40:43], 0 offen lds
    s_add_u32 m0, s13, 1056
    v_mad_u32_u16 v237, v237, s15, v243
    buffer_load_dwordx4 v237, s[40:43], 0 offen lds
    s_add_u32 m0, s13, 2112
    v_mad_u32_u16 v238, v238, s15, v243
    buffer_load_dwordx4 v238, s[40:43], 0 offen lds
    s_add_u32 m0, s13, 3168
    v_mad_u32_u16 v239, v239, s15, v243
    buffer_load_dwordx4 v239, s[40:43], 0 offen lds
    s_mov_b32 m0, s14
    v_and_b32 v240, 0xfffff, v240
    buffer_load_dwordx4 v[240:241], s[44:47], 0 idxen offen lds
L_ND01:
    v_rcp_f32 v230, v230
    v_mfma_f32_16x16x32_bf16 v[200:203], v[172:175], v[12:15], v[200:203]
    v_rcp_f32 v231, v231
    v_rcp_f32 v232, v232
    v_rcp_f32 v233, v233
    v_rcp_f32 v234, v234
    v_rcp_f32 v235, v235
    v_pk_mul_f32 v[204:205], v[220:221], v[204:205]
    v_pk_mul_f32 v[206:207], v[222:223], v[206:207]
    v_pk_mul_f32 v[208:209], v[224:225], v[208:209]
    v_pk_mul_f32 v[210:211], v[226:227], v[210:211]
    v_pk_mul_f32 v[212:213], v[228:229], v[212:213]
    v_pk_mul_f32 v[214:215], v[230:231], v[214:215]
    v_pk_mul_f32 v[216:217], v[232:233], v[216:217]
    v_pk_mul_f32 v[218:219], v[234:235], v[218:219]
    s_cmp_ge_u32 s16, s17
    s_cbranch_scc1 L_LT1
    s_setprio 1
    v_smfmac_f32_16x16x64_bf16 v[120:123], v[184:187], v[204:211], v255
    ds_read_u16 v236, v250 offset:1152
    ds_read_u16 v237, v250 offset:1168
    ds_add_rtn_u32 v238, v246, v255
    v_exp_f32 v188, v188
    v_smfmac_f32_16x16x64_bf16 v[124:127], v[184:187], v[212:219], v255
    v_exp_f32 v189, v189
    v_mfma_f32_16x16x32_bf16 v[204:207], v[160:163], v[32:35], 0
    v_exp_f32 v190, v190
    v_mfma_f32_16x16x32_bf16 v[212:215], v[160:163], v[40:43], 0
    v_exp_f32 v191, v191
    v_mfma_f32_16x16x32_bf16 v[208:211], v[168:171], v[32:35], 0
    v_exp_f32 v192, v192
    v_mfma_f32_16x16x32_bf16 v[216:219], v[168:171], v[40:43], 0
    v_exp_f32 v193, v193
    v_mfma_f32_16x16x32_bf16 v[204:207], v[164:167], v[36:39], v[204:207]
    v_exp_f32 v194, v194
    v_mfma_f32_16x16x32_bf16 v[212:215], v[164:167], v[44:47], v[212:215]
    v_exp_f32 v195, v195
    v_mfma_f32_16x16x32_bf16 v[208:211], v[172:175], v[36:39], v[208:211]
    s_waitcnt lgkmcnt(0)
    v_bfi_b32 v236, 31, v246, v236
    v_bfi_b32 v237, 31, v246, v237
    v_readfirstlane_b32 s96, v238
    v_exp_f32 v196, v196
    v_mfma_f32_16x16x32_bf16 v[216:219], v[172:175], v[44:47], v[216:219]
    v_exp_f32 v197, v197
    v_smfmac_f32_16x16x64_bf16 v[104:107], v[184:187], v[220:227], v255
    v_exp_f32 v198, v198
    v_smfmac_f32_16x16x64_bf16 v[108:111], v[184:187], v[228:235], v255
    v_exp_f32 v199, v199
    v_mfma_f32_4x4x4_16b_bf16 v[188:191], v[242:243], v[242:243], v[188:191]
    v_exp_f32 v200, v200
    v_mfma_f32_4x4x4_16b_bf16 v[192:195], v[242:243], v[242:243], v[192:195]
    v_exp_f32 v201, v201
    v_mfma_f32_4x4x4_16b_bf16 v[196:199], v[242:243], v[242:243], v[196:199]
    v_exp_f32 v202, v202
    v_mfma_f32_16x16x32_bf16 v[220:223], v[176:179], v[88:91], 0
    ds_read_b64_tr_b16 v[184:185], v236
    ds_read_b64_tr_b16 v[186:187], v237
    ds_read_u16 v251, v249 offset:128
    ds_read_u16 v252, v249 offset:192
    v_exp_f32 v203, v203
    v_mfma_f32_16x16x32_bf16 v[228:231], v[176:179], v[92:95], 0
    s_ashr_i32 s96, s96, 24
    s_mul_i32 s96, s96, s101
    v_rcp_f32 v188, v188
    v_mfma_f32_16x16x32_bf16 v[224:227], v[180:183], v[88:91], 0
    v_rcp_f32 v189, v189
    v_mfma_f32_4x4x4_16b_bf16 v[200:203], v[242:243], v[242:243], v[200:203]
    v_rcp_f32 v190, v190
    v_mfma_f32_16x16x32_bf16 v[232:235], v[180:183], v[92:95], 0
    v_rcp_f32 v191, v191
    v_mfma_f32_16x16x32_bf16 v[220:223], v[160:163], v[16:19], v[220:223]
    v_rcp_f32 v192, v192
    v_mfma_f32_16x16x32_bf16 v[228:231], v[160:163], v[24:27], v[228:231]
    v_rcp_f32 v193, v193
    v_mfma_f32_16x16x32_bf16 v[224:227], v[168:171], v[16:19], v[224:227]
    s_waitcnt lgkmcnt(0)
    v_bfi_b32 v251, 31, v245, v251
    v_bfi_b32 v252, 31, v245, v252
    v_max_u32 v251, v251, v245
    v_max_u32 v252, v252, v253
    ds_read_b128 v[236:239], v247 offset:1280
    ds_read_b32 v240, v248 offset:1280
    s_add_u32 s16, s16, 1
    v_rcp_f32 v194, v194
    v_mfma_f32_16x16x32_bf16 v[232:235], v[168:171], v[24:27], v[232:235]
    v_add_u32 v247, 0x80, v247
    v_add_u32 v248, 0x80, v248
    v_add_u32 v249, 0x80, v249
    v_add_u32 v250, 0x80, v250
    v_rcp_f32 v195, v195
    v_mfma_f32_16x16x32_bf16 v[220:223], v[164:167], v[20:23], v[220:223]
    v_rcp_f32 v196, v196
    v_mfma_f32_16x16x32_bf16 v[228:231], v[164:167], v[28:31], v[228:231]
    v_rcp_f32 v197, v197
    s_setprio 3
    v_mfma_f32_16x16x32_bf16 v[224:227], v[172:175], v[20:23], v[224:227]
    v_rcp_f32 v198, v198
    v_mfma_f32_16x16x32_bf16 v[232:235], v[172:175], v[28:31], v[232:235]
    v_rcp_f32 v199, v199
    v_rcp_f32 v200, v200
    v_rcp_f32 v201, v201
    v_rcp_f32 v202, v202
    v_rcp_f32 v203, v203
    v_pk_mul_f32 v[204:205], v[188:189], v[204:205]
    v_pk_mul_f32 v[206:207], v[190:191], v[206:207]
    v_pk_mul_f32 v[208:209], v[192:193], v[208:209]
    v_pk_mul_f32 v[210:211], v[194:195], v[210:211]
    v_pk_mul_f32 v[212:213], v[196:197], v[212:213]
    v_pk_mul_f32 v[214:215], v[198:199], v[214:215]
    v_pk_mul_f32 v[216:217], v[200:201], v[216:217]
    v_pk_mul_f32 v[218:219], v[202:203], v[218:219]
    s_cmp_ge_i32 s96, 1
    s_cbranch_scc0 L_PB10
L_PB11:
    s_setprio 1
    v_smfmac_f32_16x16x64_bf16 v[144:147], v[184:187], v[204:211], v255
    v_exp_f32 v220, v220
    v_smfmac_f32_16x16x64_bf16 v[148:151], v[184:187], v[212:219], v255
    v_exp_f32 v221, v221
    s_waitcnt vmcnt(0)
    ds_read_b128 v[176:179], v251
    ds_read_b128 v[180:183], v252
    v_mfma_f32_16x16x32_bf16 v[204:207], v[160:163], v[48:51], 0
    v_exp_f32 v222, v222
    v_mfma_f32_16x16x32_bf16 v[212:215], v[160:163], v[56:59], 0
    ds_read_b128 v[160:163], v244 offset:0
    v_exp_f32 v223, v223
    v_mfma_f32_16x16x32_bf16 v[208:211], v[168:171], v[48:51], 0
    v_exp_f32 v224, v224
    v_mfma_f32_16x16x32_bf16 v[216:219], v[168:171], v[56:59], 0
    ds_read_b128 v[168:171], v244 offset:512
    v_exp_f32 v225, v225
    v_mfma_f32_16x16x32_bf16 v[204:207], v[164:167], v[52:55], v[204:207]
    v_exp_f32 v226, v226
    v_mfma_f32_16x16x32_bf16 v[212:215], v[164:167], v[60:63], v[212:215]
    ds_read_b128 v[164:167], v244 offset:64
    v_exp_f32 v227, v227
    v_mfma_f32_16x16x32_bf16 v[208:211], v[172:175], v[52:55], v[208:211]
    v_exp_f32 v228, v228
    v_mfma_f32_16x16x32_bf16 v[216:219], v[172:175], v[60:63], v[216:219]
    ds_read_b128 v[172:175], v244 offset:576
    v_exp_f32 v229, v229
    v_smfmac_f32_16x16x64_bf16 v[128:131], v[184:187], v[188:195], v255
    v_exp_f32 v230, v230
    v_smfmac_f32_16x16x64_bf16 v[132:135], v[184:187], v[196:203], v255
    v_exp_f32 v231, v231
    v_mfma_f32_4x4x4_16b_bf16 v[220:223], v[242:243], v[242:243], v[220:223]
    v_exp_f32 v232, v232
    v_mfma_f32_4x4x4_16b_bf16 v[224:227], v[242:243], v[242:243], v[224:227]
    v_exp_f32 v233, v233
    v_mfma_f32_4x4x4_16b_bf16 v[228:231], v[242:243], v[242:243], v[228:231]
    v_exp_f32 v234, v234
    s_waitcnt lgkmcnt(4)
    v_mfma_f32_16x16x32_bf16 v[188:191], v[176:179], v[64:67], 0
    v_exp_f32 v235, v235
    v_mfma_f32_16x16x32_bf16 v[196:199], v[176:179], v[68:71], 0
    v_rcp_f32 v220, v220
    v_mfma_f32_16x16x32_bf16 v[192:195], v[180:183], v[64:67], 0
    v_rcp_f32 v221, v221
    v_mfma_f32_4x4x4_16b_bf16 v[232:235], v[242:243], v[242:243], v[232:235]
    v_rcp_f32 v222, v222
    v_mfma_f32_16x16x32_bf16 v[200:203], v[180:183], v[68:71], 0
    v_rcp_f32 v223, v223
    s_waitcnt lgkmcnt(3)
    v_mfma_f32_16x16x32_bf16 v[188:191], v[160:163], v[0:3], v[188:191]
    v_rcp_f32 v224, v224
    v_mfma_f32_16x16x32_bf16 v[196:199], v[160:163], v[8:11], v[196:199]
    v_rcp_f32 v225, v225
    s_waitcnt lgkmcnt(2)
    v_mfma_f32_16x16x32_bf16 v[192:195], v[168:171], v[0:3], v[192:195]
    v_rcp_f32 v226, v226
    v_mfma_f32_16x16x32_bf16 v[200:203], v[168:171], v[8:11], v[200:203]
    v_rcp_f32 v227, v227
    s_waitcnt lgkmcnt(1)
    v_mfma_f32_16x16x32_bf16 v[188:191], v[164:167], v[4:7], v[188:191]
    v_rcp_f32 v228, v228
    v_mfma_f32_16x16x32_bf16 v[196:199], v[164:167], v[12:15], v[196:199]
    v_rcp_f32 v229, v229
    s_setprio 3
    s_waitcnt lgkmcnt(0)
    v_mfma_f32_16x16x32_bf16 v[192:195], v[172:175], v[4:7], v[192:195]
    s_cmp_lt_u32 s16, s17
    s_cbranch_scc0 L_ND11
    s_add_u32 m0, s13, 0
    v_mad_u32_u16 v236, v236, s15, v243
    buffer_load_dwordx4 v236, s[40:43], 0 offen lds
    s_add_u32 m0, s13, 1056
    v_mad_u32_u16 v237, v237, s15, v243
    buffer_load_dwordx4 v237, s[40:43], 0 offen lds
    s_add_u32 m0, s13, 2112
    v_mad_u32_u16 v238, v238, s15, v243
    buffer_load_dwordx4 v238, s[40:43], 0 offen lds
    s_add_u32 m0, s13, 3168
    v_mad_u32_u16 v239, v239, s15, v243
    buffer_load_dwordx4 v239, s[40:43], 0 offen lds
    s_mov_b32 m0, s14
    v_and_b32 v240, 0xfffff, v240
    buffer_load_dwordx4 v[240:241], s[44:47], 0 idxen offen lds
L_ND11:
    v_rcp_f32 v230, v230
    v_mfma_f32_16x16x32_bf16 v[200:203], v[172:175], v[12:15], v[200:203]
    v_rcp_f32 v231, v231
    v_rcp_f32 v232, v232
    v_rcp_f32 v233, v233
    v_rcp_f32 v234, v234
    v_rcp_f32 v235, v235
    v_pk_mul_f32 v[204:205], v[220:221], v[204:205]
    v_pk_mul_f32 v[206:207], v[222:223], v[206:207]
    v_pk_mul_f32 v[208:209], v[224:225], v[208:209]
    v_pk_mul_f32 v[210:211], v[226:227], v[210:211]
    v_pk_mul_f32 v[212:213], v[228:229], v[212:213]
    v_pk_mul_f32 v[214:215], v[230:231], v[214:215]
    v_pk_mul_f32 v[216:217], v[232:233], v[216:217]
    v_pk_mul_f32 v[218:219], v[234:235], v[218:219]
    s_cmp_lt_u32 s16, s17
    s_cbranch_scc1 L_LOOP1
    s_branch L_LT0
.p2align 6
L_LOOP0:
    s_setprio 0
    v_smfmac_f32_16x16x64_bf16 v[152:155], v[184:187], v[204:211], v255
    ds_read_u16 v236, v250 offset:0
    ds_read_u16 v237, v250 offset:16
    ds_add_rtn_u32 v238, v246, v255
    v_exp_f32 v188, v188
    v_smfmac_f32_16x16x64_bf16 v[156:159], v[184:187], v[212:219], v255
    v_exp_f32 v189, v189
    v_mfma_f32_16x16x32_bf16 v[204:207], v[160:163], v[32:35], 0
    v_exp_f32 v190, v190
    v_mfma_f32_16x16x32_bf16 v[212:215], v[160:163], v[40:43], 0
    v_exp_f32 v191, v191
    v_mfma_f32_16x16x32_bf16 v[208:211], v[168:171], v[32:35], 0
    v_exp_f32 v192, v192
    v_mfma_f32_16x16x32_bf16 v[216:219], v[168:171], v[40:43], 0
    v_exp_f32 v193, v193
    v_mfma_f32_16x16x32_bf16 v[204:207], v[164:167], v[36:39], v[204:207]
    v_exp_f32 v194, v194
    v_mfma_f32_16x16x32_bf16 v[212:215], v[164:167], v[44:47], v[212:215]
    v_exp_f32 v195, v195
    v_mfma_f32_16x16x32_bf16 v[208:211], v[172:175], v[36:39], v[208:211]
    s_waitcnt lgkmcnt(0)
    v_bfi_b32 v236, 31, v246, v236
    v_bfi_b32 v237, 31, v246, v237
    v_readfirstlane_b32 s96, v238
    v_exp_f32 v196, v196
    v_mfma_f32_16x16x32_bf16 v[216:219], v[172:175], v[44:47], v[216:219]
    v_exp_f32 v197, v197
    v_smfmac_f32_16x16x64_bf16 v[136:139], v[184:187], v[220:227], v255
    v_exp_f32 v198, v198
    v_smfmac_f32_16x16x64_bf16 v[140:143], v[184:187], v[228:235], v255
    v_exp_f32 v199, v199
    v_mfma_f32_4x4x4_16b_bf16 v[188:191], v[242:243], v[242:243], v[188:191]
    v_exp_f32 v200, v200
    v_mfma_f32_4x4x4_16b_bf16 v[192:195], v[242:243], v[242:243], v[192:195]
    v_exp_f32 v201, v201
    v_mfma_f32_4x4x4_16b_bf16 v[196:199], v[242:243], v[242:243], v[196:199]
    v_exp_f32 v202, v202
    v_mfma_f32_16x16x32_bf16 v[220:223], v[176:179], v[72:75], 0
    ds_read_b64_tr_b16 v[184:185], v236
    ds_read_b64_tr_b16 v[186:187], v237
    ds_read_u16 v251, v249 offset:1152
    ds_read_u16 v252, v249 offset:1216
    v_exp_f32 v203, v203
    v_mfma_f32_16x16x32_bf16 v[228:231], v[176:179], v[76:79], 0
    s_ashr_i32 s96, s96, 24
    s_mul_i32 s96, s96, s101
    v_rcp_f32 v188, v188
    v_mfma_f32_16x16x32_bf16 v[224:227], v[180:183], v[72:75], 0
    v_rcp_f32 v189, v189
    v_mfma_f32_4x4x4_16b_bf16 v[200:203], v[242:243], v[242:243], v[200:203]
    v_rcp_f32 v190, v190
    v_mfma_f32_16x16x32_bf16 v[232:235], v[180:183], v[76:79], 0
    v_rcp_f32 v191, v191
    v_mfma_f32_16x16x32_bf16 v[220:223], v[160:163], v[16:19], v[220:223]
    v_rcp_f32 v192, v192
    v_mfma_f32_16x16x32_bf16 v[228:231], v[160:163], v[24:27], v[228:231]
    v_rcp_f32 v193, v193
    v_mfma_f32_16x16x32_bf16 v[224:227], v[168:171], v[16:19], v[224:227]
    s_waitcnt lgkmcnt(0)
    v_bfi_b32 v251, 31, v245, v251
    v_bfi_b32 v252, 31, v245, v252
    v_max_u32 v251, v251, v245
    v_max_u32 v252, v252, v253
    ds_read_b128 v[236:239], v247 offset:128
    ds_read_b32 v240, v248 offset:128
    s_add_u32 s16, s16, 1
    v_rcp_f32 v194, v194
    v_mfma_f32_16x16x32_bf16 v[232:235], v[168:171], v[24:27], v[232:235]
    v_rcp_f32 v195, v195
    v_mfma_f32_16x16x32_bf16 v[220:223], v[164:167], v[20:23], v[220:223]
    v_rcp_f32 v196, v196
    v_mfma_f32_16x16x32_bf16 v[228:231], v[164:167], v[28:31], v[228:231]
    v_rcp_f32 v197, v197
    s_setprio 3
    v_mfma_f32_16x16x32_bf16 v[224:227], v[172:175], v[20:23], v[224:227]
    v_rcp_f32 v198, v198
    v_mfma_f32_16x16x32_bf16 v[232:235], v[172:175], v[28:31], v[232:235]
    v_rcp_f32 v199, v199
    v_rcp_f32 v200, v200
    v_rcp_f32 v201, v201
    v_rcp_f32 v202, v202
    v_rcp_f32 v203, v203
    v_pk_mul_f32 v[204:205], v[188:189], v[204:205]
    v_pk_mul_f32 v[206:207], v[190:191], v[206:207]
    v_pk_mul_f32 v[208:209], v[192:193], v[208:209]
    v_pk_mul_f32 v[210:211], v[194:195], v[210:211]
    v_pk_mul_f32 v[212:213], v[196:197], v[212:213]
    v_pk_mul_f32 v[214:215], v[198:199], v[214:215]
    v_pk_mul_f32 v[216:217], v[200:201], v[216:217]
    v_pk_mul_f32 v[218:219], v[202:203], v[218:219]
    s_cmp_ge_i32 s96, 1
    s_cbranch_scc1 L_PB01
L_PB00:
    s_setprio 0
    v_smfmac_f32_16x16x64_bf16 v[112:115], v[184:187], v[204:211], v255
    v_exp_f32 v220, v220
    v_smfmac_f32_16x16x64_bf16 v[116:119], v[184:187], v[212:219], v255
    v_exp_f32 v221, v221
    s_waitcnt vmcnt(0)
    ds_read_b128 v[176:179], v251
    ds_read_b128 v[180:183], v252
    v_mfma_f32_16x16x32_bf16 v[204:207], v[160:163], v[48:51], 0
    v_exp_f32 v222, v222
    v_mfma_f32_16x16x32_bf16 v[212:215], v[160:163], v[56:59], 0
    ds_read_b128 v[160:163], v244 offset:0
    v_exp_f32 v223, v223
    v_mfma_f32_16x16x32_bf16 v[208:211], v[168:171], v[48:51], 0
    v_exp_f32 v224, v224
    v_mfma_f32_16x16x32_bf16 v[216:219], v[168:171], v[56:59], 0
    ds_read_b128 v[168:171], v244 offset:512
    v_exp_f32 v225, v225
    v_mfma_f32_16x16x32_bf16 v[204:207], v[164:167], v[52:55], v[204:207]
    v_exp_f32 v226, v226
    v_mfma_f32_16x16x32_bf16 v[212:215], v[164:167], v[60:63], v[212:215]
    ds_read_b128 v[164:167], v244 offset:64
    v_exp_f32 v227, v227
    v_mfma_f32_16x16x32_bf16 v[208:211], v[172:175], v[52:55], v[208:211]
    v_exp_f32 v228, v228
    v_mfma_f32_16x16x32_bf16 v[216:219], v[172:175], v[60:63], v[216:219]
    ds_read_b128 v[172:175], v244 offset:576
    v_exp_f32 v229, v229
    v_smfmac_f32_16x16x64_bf16 v[96:99], v[184:187], v[188:195], v255
    v_exp_f32 v230, v230
    v_smfmac_f32_16x16x64_bf16 v[100:103], v[184:187], v[196:203], v255
    v_exp_f32 v231, v231
    v_mfma_f32_4x4x4_16b_bf16 v[220:223], v[242:243], v[242:243], v[220:223]
    v_exp_f32 v232, v232
    v_mfma_f32_4x4x4_16b_bf16 v[224:227], v[242:243], v[242:243], v[224:227]
    v_exp_f32 v233, v233
    v_mfma_f32_4x4x4_16b_bf16 v[228:231], v[242:243], v[242:243], v[228:231]
    v_exp_f32 v234, v234
    s_waitcnt lgkmcnt(4)
    v_mfma_f32_16x16x32_bf16 v[188:191], v[176:179], v[80:83], 0
    v_exp_f32 v235, v235
    v_mfma_f32_16x16x32_bf16 v[196:199], v[176:179], v[84:87], 0
    v_rcp_f32 v220, v220
    v_mfma_f32_16x16x32_bf16 v[192:195], v[180:183], v[80:83], 0
    v_rcp_f32 v221, v221
    v_mfma_f32_4x4x4_16b_bf16 v[232:235], v[242:243], v[242:243], v[232:235]
    v_rcp_f32 v222, v222
    v_mfma_f32_16x16x32_bf16 v[200:203], v[180:183], v[84:87], 0
    v_rcp_f32 v223, v223
    s_waitcnt lgkmcnt(3)
    v_mfma_f32_16x16x32_bf16 v[188:191], v[160:163], v[0:3], v[188:191]
    v_rcp_f32 v224, v224
    v_mfma_f32_16x16x32_bf16 v[196:199], v[160:163], v[8:11], v[196:199]
    v_rcp_f32 v225, v225
    s_waitcnt lgkmcnt(2)
    v_mfma_f32_16x16x32_bf16 v[192:195], v[168:171], v[0:3], v[192:195]
    v_rcp_f32 v226, v226
    v_mfma_f32_16x16x32_bf16 v[200:203], v[168:171], v[8:11], v[200:203]
    v_rcp_f32 v227, v227
    s_waitcnt lgkmcnt(1)
    v_mfma_f32_16x16x32_bf16 v[188:191], v[164:167], v[4:7], v[188:191]
    v_rcp_f32 v228, v228
    v_mfma_f32_16x16x32_bf16 v[196:199], v[164:167], v[12:15], v[196:199]
    v_rcp_f32 v229, v229
    s_setprio 3
    s_waitcnt lgkmcnt(0)
    v_mfma_f32_16x16x32_bf16 v[192:195], v[172:175], v[4:7], v[192:195]
    s_cmp_lt_u32 s16, s17
    s_cbranch_scc0 L_ND00
    s_add_u32 m0, s13, 0
    v_mad_u32_u16 v236, v236, s15, v243
    buffer_load_dwordx4 v236, s[40:43], 0 offen lds
    s_add_u32 m0, s13, 1056
    v_mad_u32_u16 v237, v237, s15, v243
    buffer_load_dwordx4 v237, s[40:43], 0 offen lds
    s_add_u32 m0, s13, 2112
    v_mad_u32_u16 v238, v238, s15, v243
    buffer_load_dwordx4 v238, s[40:43], 0 offen lds
    s_add_u32 m0, s13, 3168
    v_mad_u32_u16 v239, v239, s15, v243
    buffer_load_dwordx4 v239, s[40:43], 0 offen lds
    s_mov_b32 m0, s14
    v_and_b32 v240, 0xfffff, v240
    buffer_load_dwordx4 v[240:241], s[44:47], 0 idxen offen lds
L_ND00:
    v_rcp_f32 v230, v230
    v_mfma_f32_16x16x32_bf16 v[200:203], v[172:175], v[12:15], v[200:203]
    v_rcp_f32 v231, v231
    v_rcp_f32 v232, v232
    v_rcp_f32 v233, v233
    v_rcp_f32 v234, v234
    v_rcp_f32 v235, v235
    v_pk_mul_f32 v[204:205], v[220:221], v[204:205]
    v_pk_mul_f32 v[206:207], v[222:223], v[206:207]
    v_pk_mul_f32 v[208:209], v[224:225], v[208:209]
    v_pk_mul_f32 v[210:211], v[226:227], v[210:211]
    v_pk_mul_f32 v[212:213], v[228:229], v[212:213]
    v_pk_mul_f32 v[214:215], v[230:231], v[214:215]
    v_pk_mul_f32 v[216:217], v[232:233], v[216:217]
    v_pk_mul_f32 v[218:219], v[234:235], v[218:219]
    s_cmp_ge_u32 s16, s17
    s_cbranch_scc1 L_LT1
    s_setprio 0
    v_smfmac_f32_16x16x64_bf16 v[120:123], v[184:187], v[204:211], v255
    ds_read_u16 v236, v250 offset:1152
    ds_read_u16 v237, v250 offset:1168
    ds_add_rtn_u32 v238, v246, v255
    v_exp_f32 v188, v188
    v_smfmac_f32_16x16x64_bf16 v[124:127], v[184:187], v[212:219], v255
    v_exp_f32 v189, v189
    v_mfma_f32_16x16x32_bf16 v[204:207], v[160:163], v[32:35], 0
    v_exp_f32 v190, v190
    v_mfma_f32_16x16x32_bf16 v[212:215], v[160:163], v[40:43], 0
    v_exp_f32 v191, v191
    v_mfma_f32_16x16x32_bf16 v[208:211], v[168:171], v[32:35], 0
    v_exp_f32 v192, v192
    v_mfma_f32_16x16x32_bf16 v[216:219], v[168:171], v[40:43], 0
    v_exp_f32 v193, v193
    v_mfma_f32_16x16x32_bf16 v[204:207], v[164:167], v[36:39], v[204:207]
    v_exp_f32 v194, v194
    v_mfma_f32_16x16x32_bf16 v[212:215], v[164:167], v[44:47], v[212:215]
    v_exp_f32 v195, v195
    v_mfma_f32_16x16x32_bf16 v[208:211], v[172:175], v[36:39], v[208:211]
    s_waitcnt lgkmcnt(0)
    v_bfi_b32 v236, 31, v246, v236
    v_bfi_b32 v237, 31, v246, v237
    v_readfirstlane_b32 s96, v238
    v_exp_f32 v196, v196
    v_mfma_f32_16x16x32_bf16 v[216:219], v[172:175], v[44:47], v[216:219]
    v_exp_f32 v197, v197
    v_smfmac_f32_16x16x64_bf16 v[104:107], v[184:187], v[220:227], v255
    v_exp_f32 v198, v198
    v_smfmac_f32_16x16x64_bf16 v[108:111], v[184:187], v[228:235], v255
    v_exp_f32 v199, v199
    v_mfma_f32_4x4x4_16b_bf16 v[188:191], v[242:243], v[242:243], v[188:191]
    v_exp_f32 v200, v200
    v_mfma_f32_4x4x4_16b_bf16 v[192:195], v[242:243], v[242:243], v[192:195]
    v_exp_f32 v201, v201
    v_mfma_f32_4x4x4_16b_bf16 v[196:199], v[242:243], v[242:243], v[196:199]
    v_exp_f32 v202, v202
    v_mfma_f32_16x16x32_bf16 v[220:223], v[176:179], v[88:91], 0
    ds_read_b64_tr_b16 v[184:185], v236
    ds_read_b64_tr_b16 v[186:187], v237
    ds_read_u16 v251, v249 offset:128
    ds_read_u16 v252, v249 offset:192
    v_exp_f32 v203, v203
    v_mfma_f32_16x16x32_bf16 v[228:231], v[176:179], v[92:95], 0
    s_ashr_i32 s96, s96, 24
    s_mul_i32 s96, s96, s101
    v_rcp_f32 v188, v188
    v_mfma_f32_16x16x32_bf16 v[224:227], v[180:183], v[88:91], 0
    v_rcp_f32 v189, v189
    v_mfma_f32_4x4x4_16b_bf16 v[200:203], v[242:243], v[242:243], v[200:203]
    v_rcp_f32 v190, v190
    v_mfma_f32_16x16x32_bf16 v[232:235], v[180:183], v[92:95], 0
    v_rcp_f32 v191, v191
    v_mfma_f32_16x16x32_bf16 v[220:223], v[160:163], v[16:19], v[220:223]
    v_rcp_f32 v192, v192
    v_mfma_f32_16x16x32_bf16 v[228:231], v[160:163], v[24:27], v[228:231]
    v_rcp_f32 v193, v193
    v_mfma_f32_16x16x32_bf16 v[224:227], v[168:171], v[16:19], v[224:227]
    s_waitcnt lgkmcnt(0)
    v_bfi_b32 v251, 31, v245, v251
    v_bfi_b32 v252, 31, v245, v252
    v_max_u32 v251, v251, v245
    v_max_u32 v252, v252, v253
    ds_read_b128 v[236:239], v247 offset:1280
    ds_read_b32 v240, v248 offset:1280
    s_add_u32 s16, s16, 1
    v_rcp_f32 v194, v194
    v_mfma_f32_16x16x32_bf16 v[232:235], v[168:171], v[24:27], v[232:235]
    v_add_u32 v247, 0x80, v247
    v_add_u32 v248, 0x80, v248
    v_add_u32 v249, 0x80, v249
    v_add_u32 v250, 0x80, v250
    v_rcp_f32 v195, v195
    v_mfma_f32_16x16x32_bf16 v[220:223], v[164:167], v[20:23], v[220:223]
    v_rcp_f32 v196, v196
    v_mfma_f32_16x16x32_bf16 v[228:231], v[164:167], v[28:31], v[228:231]
    v_rcp_f32 v197, v197
    s_setprio 3
    v_mfma_f32_16x16x32_bf16 v[224:227], v[172:175], v[20:23], v[224:227]
    v_rcp_f32 v198, v198
    v_mfma_f32_16x16x32_bf16 v[232:235], v[172:175], v[28:31], v[232:235]
    v_rcp_f32 v199, v199
    v_rcp_f32 v200, v200
    v_rcp_f32 v201, v201
    v_rcp_f32 v202, v202
    v_rcp_f32 v203, v203
    v_pk_mul_f32 v[204:205], v[188:189], v[204:205]
    v_pk_mul_f32 v[206:207], v[190:191], v[206:207]
    v_pk_mul_f32 v[208:209], v[192:193], v[208:209]
    v_pk_mul_f32 v[210:211], v[194:195], v[210:211]
    v_pk_mul_f32 v[212:213], v[196:197], v[212:213]
    v_pk_mul_f32 v[214:215], v[198:199], v[214:215]
    v_pk_mul_f32 v[216:217], v[200:201], v[216:217]
    v_pk_mul_f32 v[218:219], v[202:203], v[218:219]
    s_cmp_ge_i32 s96, 1
    s_cbranch_scc1 L_PB11
L_PB10:
    s_setprio 0
    v_smfmac_f32_16x16x64_bf16 v[144:147], v[184:187], v[204:211], v255
    v_exp_f32 v220, v220
    v_smfmac_f32_16x16x64_bf16 v[148:151], v[184:187], v[212:219], v255
    v_exp_f32 v221, v221
    s_waitcnt vmcnt(0)
    ds_read_b128 v[176:179], v251
    ds_read_b128 v[180:183], v252
    v_mfma_f32_16x16x32_bf16 v[204:207], v[160:163], v[48:51], 0
    v_exp_f32 v222, v222
    v_mfma_f32_16x16x32_bf16 v[212:215], v[160:163], v[56:59], 0
    ds_read_b128 v[160:163], v244 offset:0
    v_exp_f32 v223, v223
    v_mfma_f32_16x16x32_bf16 v[208:211], v[168:171], v[48:51], 0
    v_exp_f32 v224, v224
    v_mfma_f32_16x16x32_bf16 v[216:219], v[168:171], v[56:59], 0
    ds_read_b128 v[168:171], v244 offset:512
    v_exp_f32 v225, v225
    v_mfma_f32_16x16x32_bf16 v[204:207], v[164:167], v[52:55], v[204:207]
    v_exp_f32 v226, v226
    v_mfma_f32_16x16x32_bf16 v[212:215], v[164:167], v[60:63], v[212:215]
    ds_read_b128 v[164:167], v244 offset:64
    v_exp_f32 v227, v227
    v_mfma_f32_16x16x32_bf16 v[208:211], v[172:175], v[52:55], v[208:211]
    v_exp_f32 v228, v228
    v_mfma_f32_16x16x32_bf16 v[216:219], v[172:175], v[60:63], v[216:219]
    ds_read_b128 v[172:175], v244 offset:576
    v_exp_f32 v229, v229
    v_smfmac_f32_16x16x64_bf16 v[128:131], v[184:187], v[188:195], v255
    v_exp_f32 v230, v230
    v_smfmac_f32_16x16x64_bf16 v[132:135], v[184:187], v[196:203], v255
    v_exp_f32 v231, v231
    v_mfma_f32_4x4x4_16b_bf16 v[220:223], v[242:243], v[242:243], v[220:223]
    v_exp_f32 v232, v232
    v_mfma_f32_4x4x4_16b_bf16 v[224:227], v[242:243], v[242:243], v[224:227]
    v_exp_f32 v233, v233
    v_mfma_f32_4x4x4_16b_bf16 v[228:231], v[242:243], v[242:243], v[228:231]
    v_exp_f32 v234, v234
    s_waitcnt lgkmcnt(4)
    v_mfma_f32_16x16x32_bf16 v[188:191], v[176:179], v[64:67], 0
    v_exp_f32 v235, v235
    v_mfma_f32_16x16x32_bf16 v[196:199], v[176:179], v[68:71], 0
    v_rcp_f32 v220, v220
    v_mfma_f32_16x16x32_bf16 v[192:195], v[180:183], v[64:67], 0
    v_rcp_f32 v221, v221
    v_mfma_f32_4x4x4_16b_bf16 v[232:235], v[242:243], v[242:243], v[232:235]
    v_rcp_f32 v222, v222
    v_mfma_f32_16x16x32_bf16 v[200:203], v[180:183], v[68:71], 0
    v_rcp_f32 v223, v223
    s_waitcnt lgkmcnt(3)
    v_mfma_f32_16x16x32_bf16 v[188:191], v[160:163], v[0:3], v[188:191]
    v_rcp_f32 v224, v224
    v_mfma_f32_16x16x32_bf16 v[196:199], v[160:163], v[8:11], v[196:199]
    v_rcp_f32 v225, v225
    s_waitcnt lgkmcnt(2)
    v_mfma_f32_16x16x32_bf16 v[192:195], v[168:171], v[0:3], v[192:195]
    v_rcp_f32 v226, v226
    v_mfma_f32_16x16x32_bf16 v[200:203], v[168:171], v[8:11], v[200:203]
    v_rcp_f32 v227, v227
    s_waitcnt lgkmcnt(1)
    v_mfma_f32_16x16x32_bf16 v[188:191], v[164:167], v[4:7], v[188:191]
    v_rcp_f32 v228, v228
    v_mfma_f32_16x16x32_bf16 v[196:199], v[164:167], v[12:15], v[196:199]
    v_rcp_f32 v229, v229
    s_setprio 3
    s_waitcnt lgkmcnt(0)
    v_mfma_f32_16x16x32_bf16 v[192:195], v[172:175], v[4:7], v[192:195]
    s_cmp_lt_u32 s16, s17
    s_cbranch_scc0 L_ND10
    s_add_u32 m0, s13, 0
    v_mad_u32_u16 v236, v236, s15, v243
    buffer_load_dwordx4 v236, s[40:43], 0 offen lds
    s_add_u32 m0, s13, 1056
    v_mad_u32_u16 v237, v237, s15, v243
    buffer_load_dwordx4 v237, s[40:43], 0 offen lds
    s_add_u32 m0, s13, 2112
    v_mad_u32_u16 v238, v238, s15, v243
    buffer_load_dwordx4 v238, s[40:43], 0 offen lds
    s_add_u32 m0, s13, 3168
    v_mad_u32_u16 v239, v239, s15, v243
    buffer_load_dwordx4 v239, s[40:43], 0 offen lds
    s_mov_b32 m0, s14
    v_and_b32 v240, 0xfffff, v240
    buffer_load_dwordx4 v[240:241], s[44:47], 0 idxen offen lds
L_ND10:
    v_rcp_f32 v230, v230
    v_mfma_f32_16x16x32_bf16 v[200:203], v[172:175], v[12:15], v[200:203]
    v_rcp_f32 v231, v231
    v_rcp_f32 v232, v232
    v_rcp_f32 v233, v233
    v_rcp_f32 v234, v234
    v_rcp_f32 v235, v235
    v_pk_mul_f32 v[204:205], v[220:221], v[204:205]
    v_pk_mul_f32 v[206:207], v[222:223], v[206:207]
    v_pk_mul_f32 v[208:209], v[224:225], v[208:209]
    v_pk_mul_f32 v[210:211], v[226:227], v[210:211]
    v_pk_mul_f32 v[212:213], v[228:229], v[212:213]
    v_pk_mul_f32 v[214:215], v[230:231], v[214:215]
    v_pk_mul_f32 v[216:217], v[232:233], v[216:217]
    v_pk_mul_f32 v[218:219], v[234:235], v[218:219]
    s_cmp_lt_u32 s16, s17
    s_cbranch_scc1 L_LOOP0
    s_branch L_LT0
L_LT0:
    s_cmp_lg_u32 s99, 0
    s_cbranch_scc1 L_LH0
    s_setprio 0
    v_smfmac_f32_16x16x64_bf16 v[152:155], v[184:187], v[204:211], v255
    ds_read_u16 v236, v250 offset:0
    ds_read_u16 v237, v250 offset:16
    v_exp_f32 v188, v188
    v_smfmac_f32_16x16x64_bf16 v[156:159], v[184:187], v[212:219], v255
    v_exp_f32 v189, v189
    v_mfma_f32_16x16x32_bf16 v[204:207], v[160:163], v[32:35], 0
    v_exp_f32 v190, v190
    v_mfma_f32_16x16x32_bf16 v[212:215], v[160:163], v[40:43], 0
    v_exp_f32 v191, v191
    v_mfma_f32_16x16x32_bf16 v[208:211], v[168:171], v[32:35], 0
    v_exp_f32 v192, v192
    v_mfma_f32_16x16x32_bf16 v[216:219], v[168:171], v[40:43], 0
    v_exp_f32 v193, v193
    v_mfma_f32_16x16x32_bf16 v[204:207], v[164:167], v[36:39], v[204:207]
    v_exp_f32 v194, v194
    v_mfma_f32_16x16x32_bf16 v[212:215], v[164:167], v[44:47], v[212:215]
    v_exp_f32 v195, v195
    v_mfma_f32_16x16x32_bf16 v[208:211], v[172:175], v[36:39], v[208:211]
    v_exp_f32 v196, v196
    v_mfma_f32_16x16x32_bf16 v[216:219], v[172:175], v[44:47], v[216:219]
    v_exp_f32 v197, v197
    v_smfmac_f32_16x16x64_bf16 v[136:139], v[184:187], v[220:227], v255
    s_waitcnt lgkmcnt(0)
    v_bfi_b32 v236, 31, v246, v236
    v_bfi_b32 v237, 31, v246, v237
    v_exp_f32 v198, v198
    s_setprio 3
    v_smfmac_f32_16x16x64_bf16 v[140:143], v[184:187], v[228:235], v255
    v_exp_f32 v199, v199
    v_exp_f32 v200, v200
    v_exp_f32 v201, v201
    v_exp_f32 v202, v202
    v_exp_f32 v203, v203
    v_pk_add_f32 v[188:189], v[188:189], 1.0 op_sel_hi:[1,0]
    v_pk_add_f32 v[190:191], v[190:191], 1.0 op_sel_hi:[1,0]
    v_pk_add_f32 v[192:193], v[192:193], 1.0 op_sel_hi:[1,0]
    v_pk_add_f32 v[194:195], v[194:195], 1.0 op_sel_hi:[1,0]
    v_pk_add_f32 v[196:197], v[196:197], 1.0 op_sel_hi:[1,0]
    v_pk_add_f32 v[198:199], v[198:199], 1.0 op_sel_hi:[1,0]
    v_pk_add_f32 v[200:201], v[200:201], 1.0 op_sel_hi:[1,0]
    v_pk_add_f32 v[202:203], v[202:203], 1.0 op_sel_hi:[1,0]
    s_setprio 0
    v_mfma_f32_16x16x32_bf16 v[220:223], v[176:179], v[72:75], 0
    ds_read_b64_tr_b16 v[184:185], v236
    ds_read_b64_tr_b16 v[186:187], v237
    v_rcp_f32 v188, v188
    v_mfma_f32_16x16x32_bf16 v[228:231], v[176:179], v[76:79], 0
    v_rcp_f32 v189, v189
    v_mfma_f32_16x16x32_bf16 v[224:227], v[180:183], v[72:75], 0
    v_rcp_f32 v190, v190
    v_mfma_f32_16x16x32_bf16 v[232:235], v[180:183], v[76:79], 0
    v_rcp_f32 v191, v191
    v_mfma_f32_16x16x32_bf16 v[220:223], v[160:163], v[16:19], v[220:223]
    v_rcp_f32 v192, v192
    v_mfma_f32_16x16x32_bf16 v[228:231], v[160:163], v[24:27], v[228:231]
    v_rcp_f32 v193, v193
    v_mfma_f32_16x16x32_bf16 v[224:227], v[168:171], v[16:19], v[224:227]
    v_rcp_f32 v194, v194
    v_mfma_f32_16x16x32_bf16 v[232:235], v[168:171], v[24:27], v[232:235]
    v_rcp_f32 v195, v195
    v_mfma_f32_16x16x32_bf16 v[220:223], v[164:167], v[20:23], v[220:223]
    v_rcp_f32 v196, v196
    v_mfma_f32_16x16x32_bf16 v[228:231], v[164:167], v[28:31], v[228:231]
    v_rcp_f32 v197, v197
    v_mfma_f32_16x16x32_bf16 v[224:227], v[172:175], v[20:23], v[224:227]
    v_rcp_f32 v198, v198
    s_setprio 3
    v_mfma_f32_16x16x32_bf16 v[232:235], v[172:175], v[28:31], v[232:235]
    v_rcp_f32 v199, v199
    v_rcp_f32 v200, v200
    v_rcp_f32 v201, v201
    v_rcp_f32 v202, v202
    v_rcp_f32 v203, v203
    v_pk_mul_f32 v[204:205], v[188:189], v[204:205]
    v_pk_mul_f32 v[206:207], v[190:191], v[206:207]
    v_pk_mul_f32 v[208:209], v[192:193], v[208:209]
    v_pk_mul_f32 v[210:211], v[194:195], v[210:211]
    v_pk_mul_f32 v[212:213], v[196:197], v[212:213]
    v_pk_mul_f32 v[214:215], v[198:199], v[214:215]
    v_pk_mul_f32 v[216:217], v[200:201], v[216:217]
    v_pk_mul_f32 v[218:219], v[202:203], v[218:219]
    s_setprio 0
    s_waitcnt lgkmcnt(0)
    v_smfmac_f32_16x16x64_bf16 v[112:115], v[184:187], v[204:211], v255
    v_exp_f32 v220, v220
    v_smfmac_f32_16x16x64_bf16 v[116:119], v[184:187], v[212:219], v255
    v_exp_f32 v221, v221
    v_mfma_f32_16x16x32_bf16 v[204:207], v[160:163], v[48:51], 0
    v_exp_f32 v222, v222
    v_mfma_f32_16x16x32_bf16 v[212:215], v[160:163], v[56:59], 0
    v_exp_f32 v223, v223
    v_mfma_f32_16x16x32_bf16 v[208:211], v[168:171], v[48:51], 0
    v_exp_f32 v224, v224
    v_mfma_f32_16x16x32_bf16 v[216:219], v[168:171], v[56:59], 0
    v_exp_f32 v225, v225
    v_mfma_f32_16x16x32_bf16 v[204:207], v[164:167], v[52:55], v[204:207]
    v_exp_f32 v226, v226
    v_mfma_f32_16x16x32_bf16 v[212:215], v[164:167], v[60:63], v[212:215]
    v_exp_f32 v227, v227
    v_mfma_f32_16x16x32_bf16 v[208:211], v[172:175], v[52:55], v[208:211]
    v_exp_f32 v228, v228
    v_mfma_f32_16x16x32_bf16 v[216:219], v[172:175], v[60:63], v[216:219]
    v_exp_f32 v229, v229
    v_smfmac_f32_16x16x64_bf16 v[96:99], v[184:187], v[188:195], v255
    v_exp_f32 v230, v230
    s_setprio 3
    v_smfmac_f32_16x16x64_bf16 v[100:103], v[184:187], v[196:203], v255
    v_exp_f32 v231, v231
    v_exp_f32 v232, v232
    v_exp_f32 v233, v233
    v_exp_f32 v234, v234
    v_exp_f32 v235, v235
    v_pk_add_f32 v[220:221], v[220:221], 1.0 op_sel_hi:[1,0]
    v_pk_add_f32 v[222:223], v[222:223], 1.0 op_sel_hi:[1,0]
    v_pk_add_f32 v[224:225], v[224:225], 1.0 op_sel_hi:[1,0]
    v_pk_add_f32 v[226:227], v[226:227], 1.0 op_sel_hi:[1,0]
    v_pk_add_f32 v[228:229], v[228:229], 1.0 op_sel_hi:[1,0]
    v_pk_add_f32 v[230:231], v[230:231], 1.0 op_sel_hi:[1,0]
    v_pk_add_f32 v[232:233], v[232:233], 1.0 op_sel_hi:[1,0]
    v_pk_add_f32 v[234:235], v[234:235], 1.0 op_sel_hi:[1,0]
    s_setprio 0
    v_rcp_f32 v220, v220
    v_rcp_f32 v221, v221
    v_rcp_f32 v222, v222
    v_rcp_f32 v223, v223
    v_rcp_f32 v224, v224
    v_rcp_f32 v225, v225
    v_rcp_f32 v226, v226
    v_rcp_f32 v227, v227
    v_rcp_f32 v228, v228
    v_rcp_f32 v229, v229
    v_rcp_f32 v230, v230
    v_rcp_f32 v231, v231
    v_rcp_f32 v232, v232
    v_rcp_f32 v233, v233
    v_rcp_f32 v234, v234
    v_rcp_f32 v235, v235
    v_pk_mul_f32 v[204:205], v[220:221], v[204:205]
    v_pk_mul_f32 v[206:207], v[222:223], v[206:207]
    v_pk_mul_f32 v[208:209], v[224:225], v[208:209]
    v_pk_mul_f32 v[210:211], v[226:227], v[210:211]
    v_pk_mul_f32 v[212:213], v[228:229], v[212:213]
    v_pk_mul_f32 v[214:215], v[230:231], v[214:215]
    v_pk_mul_f32 v[216:217], v[232:233], v[216:217]
    v_pk_mul_f32 v[218:219], v[234:235], v[218:219]
    v_smfmac_f32_16x16x64_bf16 v[104:107], v[184:187], v[220:227], v255
    v_smfmac_f32_16x16x64_bf16 v[108:111], v[184:187], v[228:235], v255
    v_smfmac_f32_16x16x64_bf16 v[120:123], v[184:187], v[204:211], v255
    v_smfmac_f32_16x16x64_bf16 v[124:127], v[184:187], v[212:219], v255
    s_branch L_DONE
L_LH0:
    s_setprio 0
    v_smfmac_f32_16x16x64_bf16 v[152:155], v[184:187], v[204:211], v255
    ds_read_u16 v236, v250 offset:0
    ds_read_u16 v237, v250 offset:16
    v_smfmac_f32_16x16x64_bf16 v[156:159], v[184:187], v[212:219], v255
    v_exp_f32 v188, v188
    v_mfma_f32_16x16x32_bf16 v[204:207], v[160:163], v[32:35], 0
    v_mfma_f32_16x16x32_bf16 v[212:215], v[160:163], v[40:43], 0
    v_exp_f32 v189, v189
    v_mfma_f32_16x16x32_bf16 v[204:207], v[164:167], v[36:39], v[204:207]
    v_mfma_f32_16x16x32_bf16 v[212:215], v[164:167], v[44:47], v[212:215]
    v_exp_f32 v190, v190
    v_smfmac_f32_16x16x64_bf16 v[136:139], v[184:187], v[220:227], v255
    s_waitcnt lgkmcnt(0)
    v_bfi_b32 v236, 31, v246, v236
    v_bfi_b32 v237, 31, v246, v237
    v_exp_f32 v191, v191
    s_setprio 3
    v_smfmac_f32_16x16x64_bf16 v[140:143], v[184:187], v[228:235], v255
    v_exp_f32 v196, v196
    v_exp_f32 v197, v197
    v_exp_f32 v198, v198
    v_exp_f32 v199, v199
    v_pk_add_f32 v[188:189], v[188:189], 1.0 op_sel_hi:[1,0]
    v_pk_add_f32 v[190:191], v[190:191], 1.0 op_sel_hi:[1,0]
    v_pk_add_f32 v[196:197], v[196:197], 1.0 op_sel_hi:[1,0]
    v_pk_add_f32 v[198:199], v[198:199], 1.0 op_sel_hi:[1,0]
    s_setprio 0
    v_mfma_f32_16x16x32_bf16 v[220:223], v[176:179], v[72:75], 0
    ds_read_b64_tr_b16 v[184:185], v236
    ds_read_b64_tr_b16 v[186:187], v237
    v_mfma_f32_16x16x32_bf16 v[228:231], v[176:179], v[76:79], 0
    v_rcp_f32 v188, v188
    v_mfma_f32_16x16x32_bf16 v[220:223], v[160:163], v[16:19], v[220:223]
    v_rcp_f32 v189, v189
    v_mfma_f32_16x16x32_bf16 v[228:231], v[160:163], v[24:27], v[228:231]
    v_rcp_f32 v190, v190
    v_mfma_f32_16x16x32_bf16 v[220:223], v[164:167], v[20:23], v[220:223]
    v_rcp_f32 v191, v191
    s_setprio 3
    v_mfma_f32_16x16x32_bf16 v[228:231], v[164:167], v[28:31], v[228:231]
    v_rcp_f32 v196, v196
    v_rcp_f32 v197, v197
    v_rcp_f32 v198, v198
    v_rcp_f32 v199, v199
    v_pk_mul_f32 v[204:205], v[188:189], v[204:205]
    v_pk_mul_f32 v[206:207], v[190:191], v[206:207]
    v_pk_mul_f32 v[212:213], v[196:197], v[212:213]
    v_pk_mul_f32 v[214:215], v[198:199], v[214:215]
    s_setprio 0
    s_waitcnt lgkmcnt(0)
    v_smfmac_f32_16x16x64_bf16 v[112:115], v[184:187], v[204:211], v255
    v_smfmac_f32_16x16x64_bf16 v[116:119], v[184:187], v[212:219], v255
    v_exp_f32 v220, v220
    v_mfma_f32_16x16x32_bf16 v[204:207], v[160:163], v[48:51], 0
    v_mfma_f32_16x16x32_bf16 v[212:215], v[160:163], v[56:59], 0
    v_exp_f32 v221, v221
    v_mfma_f32_16x16x32_bf16 v[204:207], v[164:167], v[52:55], v[204:207]
    v_mfma_f32_16x16x32_bf16 v[212:215], v[164:167], v[60:63], v[212:215]
    v_exp_f32 v222, v222
    v_smfmac_f32_16x16x64_bf16 v[96:99], v[184:187], v[188:195], v255
    v_exp_f32 v223, v223
    s_setprio 3
    v_smfmac_f32_16x16x64_bf16 v[100:103], v[184:187], v[196:203], v255
    v_exp_f32 v228, v228
    v_exp_f32 v229, v229
    v_exp_f32 v230, v230
    v_exp_f32 v231, v231
    v_pk_add_f32 v[220:221], v[220:221], 1.0 op_sel_hi:[1,0]
    v_pk_add_f32 v[222:223], v[222:223], 1.0 op_sel_hi:[1,0]
    v_pk_add_f32 v[228:229], v[228:229], 1.0 op_sel_hi:[1,0]
    v_pk_add_f32 v[230:231], v[230:231], 1.0 op_sel_hi:[1,0]
    s_setprio 0
    v_rcp_f32 v220, v220
    v_rcp_f32 v221, v221
    v_rcp_f32 v222, v222
    v_rcp_f32 v223, v223
    v_rcp_f32 v228, v228
    v_rcp_f32 v229, v229
    v_rcp_f32 v230, v230
    v_rcp_f32 v231, v231
    v_pk_mul_f32 v[204:205], v[220:221], v[204:205]
    v_pk_mul_f32 v[206:207], v[222:223], v[206:207]
    v_pk_mul_f32 v[212:213], v[228:229], v[212:213]
    v_pk_mul_f32 v[214:215], v[230:231], v[214:215]
    v_smfmac_f32_16x16x64_bf16 v[104:107], v[184:187], v[220:227], v255
    v_smfmac_f32_16x16x64_bf16 v[108:111], v[184:187], v[228:235], v255
    v_smfmac_f32_16x16x64_bf16 v[120:123], v[184:187], v[204:211], v255
    v_smfmac_f32_16x16x64_bf16 v[124:127], v[184:187], v[212:219], v255
    s_branch L_DONE
L_LT1:
    s_cmp_lg_u32 s99, 0
    s_cbranch_scc1 L_LH1
    s_setprio 0
    v_smfmac_f32_16x16x64_bf16 v[120:123], v[184:187], v[204:211], v255
    ds_read_u16 v236, v250 offset:1152
    ds_read_u16 v237, v250 offset:1168
    v_exp_f32 v188, v188
    v_smfmac_f32_16x16x64_bf16 v[124:127], v[184:187], v[212:219], v255
    v_exp_f32 v189, v189
    v_mfma_f32_16x16x32_bf16 v[204:207], v[160:163], v[32:35], 0
    v_exp_f32 v190, v190
    v_mfma_f32_16x16x32_bf16 v[212:215], v[160:163], v[40:43], 0
    v_exp_f32 v191, v191
    v_mfma_f32_16x16x32_bf16 v[208:211], v[168:171], v[32:35], 0
    v_exp_f32 v192, v192
    v_mfma_f32_16x16x32_bf16 v[216:219], v[168:171], v[40:43], 0
    v_exp_f32 v193, v193
    v_mfma_f32_16x16x32_bf16 v[204:207], v[164:167], v[36:39], v[204:207]
    v_exp_f32 v194, v194
    v_mfma_f32_16x16x32_bf16 v[212:215], v[164:167], v[44:47], v[212:215]
    v_exp_f32 v195, v195
    v_mfma_f32_16x16x32_bf16 v[208:211], v[172:175], v[36:39], v[208:211]
    v_exp_f32 v196, v196
    v_mfma_f32_16x16x32_bf16 v[216:219], v[172:175], v[44:47], v[216:219]
    v_exp_f32 v197, v197
    v_smfmac_f32_16x16x64_bf16 v[104:107], v[184:187], v[220:227], v255
    s_waitcnt lgkmcnt(0)
    v_bfi_b32 v236, 31, v246, v236
    v_bfi_b32 v237, 31, v246, v237
    v_exp_f32 v198, v198
    s_setprio 3
    v_smfmac_f32_16x16x64_bf16 v[108:111], v[184:187], v[228:235], v255
    v_exp_f32 v199, v199
    v_exp_f32 v200, v200
    v_exp_f32 v201, v201
    v_exp_f32 v202, v202
    v_exp_f32 v203, v203
    v_pk_add_f32 v[188:189], v[188:189], 1.0 op_sel_hi:[1,0]
    v_pk_add_f32 v[190:191], v[190:191], 1.0 op_sel_hi:[1,0]
    v_pk_add_f32 v[192:193], v[192:193], 1.0 op_sel_hi:[1,0]
    v_pk_add_f32 v[194:195], v[194:195], 1.0 op_sel_hi:[1,0]
    v_pk_add_f32 v[196:197], v[196:197], 1.0 op_sel_hi:[1,0]
    v_pk_add_f32 v[198:199], v[198:199], 1.0 op_sel_hi:[1,0]
    v_pk_add_f32 v[200:201], v[200:201], 1.0 op_sel_hi:[1,0]
    v_pk_add_f32 v[202:203], v[202:203], 1.0 op_sel_hi:[1,0]
    s_setprio 0
    v_mfma_f32_16x16x32_bf16 v[220:223], v[176:179], v[88:91], 0
    ds_read_b64_tr_b16 v[184:185], v236
    ds_read_b64_tr_b16 v[186:187], v237
    v_rcp_f32 v188, v188
    v_mfma_f32_16x16x32_bf16 v[228:231], v[176:179], v[92:95], 0
    v_rcp_f32 v189, v189
    v_mfma_f32_16x16x32_bf16 v[224:227], v[180:183], v[88:91], 0
    v_rcp_f32 v190, v190
    v_mfma_f32_16x16x32_bf16 v[232:235], v[180:183], v[92:95], 0
    v_rcp_f32 v191, v191
    v_mfma_f32_16x16x32_bf16 v[220:223], v[160:163], v[16:19], v[220:223]
    v_rcp_f32 v192, v192
    v_mfma_f32_16x16x32_bf16 v[228:231], v[160:163], v[24:27], v[228:231]
    v_rcp_f32 v193, v193
    v_mfma_f32_16x16x32_bf16 v[224:227], v[168:171], v[16:19], v[224:227]
    v_rcp_f32 v194, v194
    v_mfma_f32_16x16x32_bf16 v[232:235], v[168:171], v[24:27], v[232:235]
    v_rcp_f32 v195, v195
    v_mfma_f32_16x16x32_bf16 v[220:223], v[164:167], v[20:23], v[220:223]
    v_rcp_f32 v196, v196
    v_mfma_f32_16x16x32_bf16 v[228:231], v[164:167], v[28:31], v[228:231]
    v_rcp_f32 v197, v197
    v_mfma_f32_16x16x32_bf16 v[224:227], v[172:175], v[20:23], v[224:227]
    v_rcp_f32 v198, v198
    s_setprio 3
    v_mfma_f32_16x16x32_bf16 v[232:235], v[172:175], v[28:31], v[232:235]
    v_rcp_f32 v199, v199
    v_rcp_f32 v200, v200
    v_rcp_f32 v201, v201
    v_rcp_f32 v202, v202
    v_rcp_f32 v203, v203
    v_pk_mul_f32 v[204:205], v[188:189], v[204:205]
    v_pk_mul_f32 v[206:207], v[190:191], v[206:207]
    v_pk_mul_f32 v[208:209], v[192:193], v[208:209]
    v_pk_mul_f32 v[210:211], v[194:195], v[210:211]
    v_pk_mul_f32 v[212:213], v[196:197], v[212:213]
    v_pk_mul_f32 v[214:215], v[198:199], v[214:215]
    v_pk_mul_f32 v[216:217], v[200:201], v[216:217]
    v_pk_mul_f32 v[218:219], v[202:203], v[218:219]
    s_setprio 0
    s_waitcnt lgkmcnt(0)
    v_smfmac_f32_16x16x64_bf16 v[144:147], v[184:187], v[204:211], v255
    v_exp_f32 v220, v220
    v_smfmac_f32_16x16x64_bf16 v[148:151], v[184:187], v[212:219], v255
    v_exp_f32 v221, v221
    v_mfma_f32_16x16x32_bf16 v[204:207], v[160:163], v[48:51], 0
    v_exp_f32 v222, v222
    v_mfma_f32_16x16x32_bf16 v[212:215], v[160:163], v[56:59], 0
    v_exp_f32 v223, v223
    v_mfma_f32_16x16x32_bf16 v[208:211], v[168:171], v[48:51], 0
    v_exp_f32 v224, v224
    v_mfma_f32_16x16x32_bf16 v[216:219], v[168:171], v[56:59], 0
    v_exp_f32 v225, v225
    v_mfma_f32_16x16x32_bf16 v[204:207], v[164:167], v[52:55], v[204:207]
    v_exp_f32 v226, v226
    v_mfma_f32_16x16x32_bf16 v[212:215], v[164:167], v[60:63], v[212:215]
    v_exp_f32 v227, v227
    v_mfma_f32_16x16x32_bf16 v[208:211], v[172:175], v[52:55], v[208:211]
    v_exp_f32 v228, v228
    v_mfma_f32_16x16x32_bf16 v[216:219], v[172:175], v[60:63], v[216:219]
    v_exp_f32 v229, v229
    v_smfmac_f32_16x16x64_bf16 v[128:131], v[184:187], v[188:195], v255
    v_exp_f32 v230, v230
    s_setprio 3
    v_smfmac_f32_16x16x64_bf16 v[132:135], v[184:187], v[196:203], v255
    v_exp_f32 v231, v231
    v_exp_f32 v232, v232
    v_exp_f32 v233, v233
    v_exp_f32 v234, v234
    v_exp_f32 v235, v235
    v_pk_add_f32 v[220:221], v[220:221], 1.0 op_sel_hi:[1,0]
    v_pk_add_f32 v[222:223], v[222:223], 1.0 op_sel_hi:[1,0]
    v_pk_add_f32 v[224:225], v[224:225], 1.0 op_sel_hi:[1,0]
    v_pk_add_f32 v[226:227], v[226:227], 1.0 op_sel_hi:[1,0]
    v_pk_add_f32 v[228:229], v[228:229], 1.0 op_sel_hi:[1,0]
    v_pk_add_f32 v[230:231], v[230:231], 1.0 op_sel_hi:[1,0]
    v_pk_add_f32 v[232:233], v[232:233], 1.0 op_sel_hi:[1,0]
    v_pk_add_f32 v[234:235], v[234:235], 1.0 op_sel_hi:[1,0]
    s_setprio 0
    v_rcp_f32 v220, v220
    v_rcp_f32 v221, v221
    v_rcp_f32 v222, v222
    v_rcp_f32 v223, v223
    v_rcp_f32 v224, v224
    v_rcp_f32 v225, v225
    v_rcp_f32 v226, v226
    v_rcp_f32 v227, v227
    v_rcp_f32 v228, v228
    v_rcp_f32 v229, v229
    v_rcp_f32 v230, v230
    v_rcp_f32 v231, v231
    v_rcp_f32 v232, v232
    v_rcp_f32 v233, v233
    v_rcp_f32 v234, v234
    v_rcp_f32 v235, v235
    v_pk_mul_f32 v[204:205], v[220:221], v[204:205]
    v_pk_mul_f32 v[206:207], v[222:223], v[206:207]
    v_pk_mul_f32 v[208:209], v[224:225], v[208:209]
    v_pk_mul_f32 v[210:211], v[226:227], v[210:211]
    v_pk_mul_f32 v[212:213], v[228:229], v[212:213]
    v_pk_mul_f32 v[214:215], v[230:231], v[214:215]
    v_pk_mul_f32 v[216:217], v[232:233], v[216:217]
    v_pk_mul_f32 v[218:219], v[234:235], v[218:219]
    v_smfmac_f32_16x16x64_bf16 v[136:139], v[184:187], v[220:227], v255
    v_smfmac_f32_16x16x64_bf16 v[140:143], v[184:187], v[228:235], v255
    v_smfmac_f32_16x16x64_bf16 v[152:155], v[184:187], v[204:211], v255
    v_smfmac_f32_16x16x64_bf16 v[156:159], v[184:187], v[212:219], v255
    s_branch L_DONE
L_LH1:
    s_setprio 0
    v_smfmac_f32_16x16x64_bf16 v[120:123], v[184:187], v[204:211], v255
    ds_read_u16 v236, v250 offset:1152
    ds_read_u16 v237, v250 offset:1168
    v_smfmac_f32_16x16x64_bf16 v[124:127], v[184:187], v[212:219], v255
    v_exp_f32 v188, v188
    v_mfma_f32_16x16x32_bf16 v[204:207], v[160:163], v[32:35], 0
    v_mfma_f32_16x16x32_bf16 v[212:215], v[160:163], v[40:43], 0
    v_exp_f32 v189, v189
    v_mfma_f32_16x16x32_bf16 v[204:207], v[164:167], v[36:39], v[204:207]
    v_mfma_f32_16x16x32_bf16 v[212:215], v[164:167], v[44:47], v[212:215]
    v_exp_f32 v190, v190
    v_smfmac_f32_16x16x64_bf16 v[104:107], v[184:187], v[220:227], v255
    s_waitcnt lgkmcnt(0)
    v_bfi_b32 v236, 31, v246, v236
    v_bfi_b32 v237, 31, v246, v237
    v_exp_f32 v191, v191
    s_setprio 3
    v_smfmac_f32_16x16x64_bf16 v[108:111], v[184:187], v[228:235], v255
    v_exp_f32 v196, v196
    v_exp_f32 v197, v197
    v_exp_f32 v198, v198
    v_exp_f32 v199, v199
    v_pk_add_f32 v[188:189], v[188:189], 1.0 op_sel_hi:[1,0]
    v_pk_add_f32 v[190:191], v[190:191], 1.0 op_sel_hi:[1,0]
    v_pk_add_f32 v[196:197], v[196:197], 1.0 op_sel_hi:[1,0]
    v_pk_add_f32 v[198:199], v[198:199], 1.0 op_sel_hi:[1,0]
    s_setprio 0
    v_mfma_f32_16x16x32_bf16 v[220:223], v[176:179], v[88:91], 0
    ds_read_b64_tr_b16 v[184:185], v236
    ds_read_b64_tr_b16 v[186:187], v237
    v_mfma_f32_16x16x32_bf16 v[228:231], v[176:179], v[92:95], 0
    v_rcp_f32 v188, v188
    v_mfma_f32_16x16x32_bf16 v[220:223], v[160:163], v[16:19], v[220:223]
    v_rcp_f32 v189, v189
    v_mfma_f32_16x16x32_bf16 v[228:231], v[160:163], v[24:27], v[228:231]
    v_rcp_f32 v190, v190
    v_mfma_f32_16x16x32_bf16 v[220:223], v[164:167], v[20:23], v[220:223]
    v_rcp_f32 v191, v191
    s_setprio 3
    v_mfma_f32_16x16x32_bf16 v[228:231], v[164:167], v[28:31], v[228:231]
    v_rcp_f32 v196, v196
    v_rcp_f32 v197, v197
    v_rcp_f32 v198, v198
    v_rcp_f32 v199, v199
    v_pk_mul_f32 v[204:205], v[188:189], v[204:205]
    v_pk_mul_f32 v[206:207], v[190:191], v[206:207]
    v_pk_mul_f32 v[212:213], v[196:197], v[212:213]
    v_pk_mul_f32 v[214:215], v[198:199], v[214:215]
    s_setprio 0
    s_waitcnt lgkmcnt(0)
    v_smfmac_f32_16x16x64_bf16 v[144:147], v[184:187], v[204:211], v255
    v_smfmac_f32_16x16x64_bf16 v[148:151], v[184:187], v[212:219], v255
    v_exp_f32 v220, v220
    v_mfma_f32_16x16x32_bf16 v[204:207], v[160:163], v[48:51], 0
    v_mfma_f32_16x16x32_bf16 v[212:215], v[160:163], v[56:59], 0
    v_exp_f32 v221, v221
    v_mfma_f32_16x16x32_bf16 v[204:207], v[164:167], v[52:55], v[204:207]
    v_mfma_f32_16x16x32_bf16 v[212:215], v[164:167], v[60:63], v[212:215]
    v_exp_f32 v222, v222
    v_smfmac_f32_16x16x64_bf16 v[128:131], v[184:187], v[188:195], v255
    v_exp_f32 v223, v223
    s_setprio 3
    v_smfmac_f32_16x16x64_bf16 v[132:135], v[184:187], v[196:203], v255
    v_exp_f32 v228, v228
    v_exp_f32 v229, v229
    v_exp_f32 v230, v230
    v_exp_f32 v231, v231
    v_pk_add_f32 v[220:221], v[220:221], 1.0 op_sel_hi:[1,0]
    v_pk_add_f32 v[222:223], v[222:223], 1.0 op_sel_hi:[1,0]
    v_pk_add_f32 v[228:229], v[228:229], 1.0 op_sel_hi:[1,0]
    v_pk_add_f32 v[230:231], v[230:231], 1.0 op_sel_hi:[1,0]
    s_setprio 0
    v_rcp_f32 v220, v220
    v_rcp_f32 v221, v221
    v_rcp_f32 v222, v222
    v_rcp_f32 v223, v223
    v_rcp_f32 v228, v228
    v_rcp_f32 v229, v229
    v_rcp_f32 v230, v230
    v_rcp_f32 v231, v231
    v_pk_mul_f32 v[204:205], v[220:221], v[204:205]
    v_pk_mul_f32 v[206:207], v[222:223], v[206:207]
    v_pk_mul_f32 v[212:213], v[228:229], v[212:213]
    v_pk_mul_f32 v[214:215], v[230:231], v[214:215]
    v_smfmac_f32_16x16x64_bf16 v[136:139], v[184:187], v[220:227], v255
    v_smfmac_f32_16x16x64_bf16 v[140:143], v[184:187], v[228:235], v255
    v_smfmac_f32_16x16x64_bf16 v[152:155], v[184:187], v[204:211], v255
    v_smfmac_f32_16x16x64_bf16 v[156:159], v[184:187], v[212:219], v255
    s_branch L_DONE
L_DONE:
    v_mbcnt_lo_u32_b32 v253, -1, 0
    v_mbcnt_hi_u32_b32 v253, -1, v253
    v_and_b32 v246, 24, v246
    s_cmp_lg_u32 s19, 0
    s_cbranch_scc1 L_SLOW
L_EPI:
    s_waitcnt lgkmcnt(0)
    v_and_b32 v64, 48, v253
    v_and_b32 v67, 15, v253
    v_add_u32 v69, s72, v64
    v_lshl_add_u32 v70, v67, 2, s72
    ds_read_b128 v[80:83], v69 offset:0
    ds_read_b128 v[84:87], v69 offset:64
    ds_read2_b32 v[72:73], v70 offset0:0 offset1:16
    v_bfe_u32 v65, v253, 2, 3
    v_lshrrev_b32 v66, 5, v253
    v_lshl_add_u32 v65, v66, 4, v65
    v_mul_u32_u24 v65, 160, v65
    s_mov_b32 s10, 143488
    v_add3_u32 v65, v65, v246, s10
    ds_read_b64_tr_b16 v[0:1], v65 offset:0
    ds_read_b64_tr_b16 v[2:3], v65 offset:1280
    ds_read_b64_tr_b16 v[8:9], v65 offset:32
    ds_read_b64_tr_b16 v[10:11], v65 offset:1312
    ds_read_b64_tr_b16 v[16:17], v65 offset:64
    ds_read_b64_tr_b16 v[18:19], v65 offset:1344
    ds_read_b64_tr_b16 v[24:25], v65 offset:96
    ds_read_b64_tr_b16 v[26:27], v65 offset:1376
    ds_read_b64_tr_b16 v[4:5], v65 offset:5120
    ds_read_b64_tr_b16 v[6:7], v65 offset:6400
    ds_read_b64_tr_b16 v[12:13], v65 offset:5152
    ds_read_b64_tr_b16 v[14:15], v65 offset:6432
    s_movk_i32 s10, 832
    v_mad_u32_u24 v64, v246, s10, v64
    s_mov_b32 s10, 116736
    v_lshl_add_u32 v69, v67, 3, s10
    v_lshl_add_u32 v74, v67, 3, s73
    v_lshl_add_u32 v75, v67, 3, s74
    s_waitcnt lgkmcnt(8)
    ds_read_b64_tr_b16 v[20:21], v65 offset:5184
    ds_read_b64_tr_b16 v[22:23], v65 offset:6464
    ds_read_b64_tr_b16 v[28:29], v65 offset:5216
    ds_read_b64_tr_b16 v[30:31], v65 offset:6496
    v_add_u32 v76, v80, v69
    ds_read_b64 v[32:33], v76 offset:0
    v_add_u32 v76, v81, v69
    ds_read_b64 v[34:35], v76 offset:6656
    v_add_u32 v76, v82, v69
    ds_read_b64 v[36:37], v76 offset:13312
    v_add_u32 v76, v83, v69
    ds_read_b64 v[38:39], v76 offset:19968
    v_add_u32 v76, v84, v69
    ds_read_b64 v[40:41], v76 offset:0
    v_add_u32 v76, v85, v69
    ds_read_b64 v[42:43], v76 offset:6656
    v_add_u32 v76, v86, v69
    ds_read_b64 v[44:45], v76 offset:13312
    v_add_u32 v76, v87, v69
    ds_read_b64 v[46:47], v76 offset:19968
    v_add3_u32 v72, v72, v64, s10
    ds_read_b128 v[160:163], v72 offset:0
    ds_read_b128 v[164:167], v72 offset:64
    v_add3_u32 v73, v73, v64, s10
    ds_read_b128 v[168:171], v73 offset:0
    ds_read_b128 v[172:175], v73 offset:64
    s_waitcnt lgkmcnt(0)
    v_lshlrev_b32 v188, 16, v32
    v_lshlrev_b32 v189, 16, v34
    v_lshlrev_b32 v190, 16, v36
    v_lshlrev_b32 v191, 16, v38
    v_and_b32 v192, 0xffff0000, v32
    v_and_b32 v193, 0xffff0000, v34
    v_and_b32 v194, 0xffff0000, v36
    v_and_b32 v195, 0xffff0000, v38
    v_mfma_f32_16x16x32_bf16 v[188:191], v[160:163], v[0:3], v[188:191]
    v_lshlrev_b32 v196, 16, v33
    v_lshlrev_b32 v197, 16, v35
    v_lshlrev_b32 v198, 16, v37
    v_lshlrev_b32 v199, 16, v39
    v_lshl_add_u32 v80, v80, 2, v74
    v_mfma_f32_16x16x32_bf16 v[188:191], v[164:167], v[4:7], v[188:191]
    v_mfma_f32_16x16x32_bf16 v[192:195], v[160:163], v[8:11], v[192:195]
    v_and_b32 v200, 0xffff0000, v33
    v_and_b32 v201, 0xffff0000, v35
    v_and_b32 v202, 0xffff0000, v37
    v_and_b32 v203, 0xffff0000, v39
    v_lshl_add_u32 v81, v81, 2, v74
    v_mfma_f32_16x16x32_bf16 v[192:195], v[164:167], v[12:15], v[192:195]
    v_mfma_f32_16x16x32_bf16 v[196:199], v[160:163], v[16:19], v[196:199]
    v_lshlrev_b32 v48, 16, v40
    v_lshlrev_b32 v49, 16, v42
    v_lshlrev_b32 v50, 16, v44
    v_lshlrev_b32 v51, 16, v46
    v_lshl_add_u32 v82, v82, 2, v74
    v_mfma_f32_16x16x32_bf16 v[196:199], v[164:167], v[20:23], v[196:199]
    v_mfma_f32_16x16x32_bf16 v[200:203], v[160:163], v[24:27], v[200:203]
    v_and_b32 v52, 0xffff0000, v40
    v_and_b32 v53, 0xffff0000, v42
    v_and_b32 v54, 0xffff0000, v44
    v_and_b32 v55, 0xffff0000, v46
    v_lshl_add_u32 v83, v83, 2, v74
    v_mfma_f32_16x16x32_bf16 v[200:203], v[164:167], v[28:31], v[200:203]
    v_mfma_f32_16x16x32_bf16 v[48:51], v[168:171], v[0:3], v[48:51]
    v_lshlrev_b32 v56, 16, v41
    v_lshlrev_b32 v57, 16, v43
    v_lshlrev_b32 v58, 16, v45
    v_lshlrev_b32 v59, 16, v47
    v_lshl_add_u32 v84, v84, 2, v75
    v_mfma_f32_16x16x32_bf16 v[48:51], v[172:175], v[4:7], v[48:51]
    v_mfma_f32_16x16x32_bf16 v[52:55], v[168:171], v[8:11], v[52:55]
    v_and_b32 v60, 0xffff0000, v41
    v_and_b32 v61, 0xffff0000, v43
    v_and_b32 v62, 0xffff0000, v45
    v_and_b32 v63, 0xffff0000, v47
    v_lshl_add_u32 v85, v85, 2, v75
    v_mfma_f32_16x16x32_bf16 v[52:55], v[172:175], v[12:15], v[52:55]
    v_mfma_f32_16x16x32_bf16 v[56:59], v[168:171], v[16:19], v[56:59]
    v_lshl_add_u32 v86, v86, 2, v75
    v_mfma_f32_16x16x32_bf16 v[56:59], v[172:175], v[20:23], v[56:59]
    v_mfma_f32_16x16x32_bf16 v[60:63], v[168:171], v[24:27], v[60:63]
    v_lshl_add_u32 v87, v87, 2, v75
    v_mfma_f32_16x16x32_bf16 v[60:63], v[172:175], v[28:31], v[60:63]
L_EPB:
    s_setprio 0
    s_mov_b64 exec, s[76:77]
    s_and_b32 s11, s25, 19
    s_nop 2
    s_cmp_eq_u32 s11, 0
    s_cbranch_scc1 L_NS0
    s_cmp_eq_u32 s11, 1
    s_cbranch_scc1 L_NS1
    s_cmp_eq_u32 s11, 2
    s_cbranch_scc1 L_NS2
    s_cmp_eq_u32 s11, 3
    s_cbranch_scc1 L_NS3
L_NSR:
    s_mov_b64 exec, -1
    v_rcp_f32 v96, v96
    v_rcp_f32 v97, v97
    v_rcp_f32 v98, v98
    v_rcp_f32 v99, v99
    v_rcp_f32 v100, v100
    v_rcp_f32 v101, v101
    v_rcp_f32 v102, v102
    v_rcp_f32 v103, v103
    v_rcp_f32 v104, v104
    v_rcp_f32 v105, v105
    v_rcp_f32 v106, v106
    v_rcp_f32 v107, v107
    v_rcp_f32 v108, v108
    v_rcp_f32 v109, v109
    v_rcp_f32 v110, v110
    v_rcp_f32 v111, v111
    v_pk_fma_f32 v[112:113], v[112:113], v[96:97], v[188:189]
    v_pk_fma_f32 v[114:115], v[114:115], v[98:99], v[190:191]
    v_pk_fma_f32 v[116:117], v[116:117], v[100:101], v[192:193]
    v_pk_fma_f32 v[118:119], v[118:119], v[102:103], v[194:195]
    v_pk_fma_f32 v[120:121], v[120:121], v[104:105], v[196:197]
    v_pk_fma_f32 v[122:123], v[122:123], v[106:107], v[198:199]
    v_pk_fma_f32 v[124:125], v[124:125], v[108:109], v[200:201]
    v_pk_fma_f32 v[126:127], v[126:127], v[110:111], v[202:203]
    v_cvt_pk_bf16_f32 v96, v112, v116
    v_cvt_pk_bf16_f32 v97, v120, v124
    v_pk_max_f16 v96, v96, v32
    v_pk_max_f16 v97, v97, v33
    buffer_store_dwordx2 v[96:97], v80, s[48:51], 0 offen sc1
    v_cvt_pk_bf16_f32 v98, v113, v117
    v_cvt_pk_bf16_f32 v99, v121, v125
    v_pk_max_f16 v98, v98, v34
    v_pk_max_f16 v99, v99, v35
    buffer_store_dwordx2 v[98:99], v81, s[48:51], 0 offen sc1
    v_cvt_pk_bf16_f32 v100, v114, v118
    v_cvt_pk_bf16_f32 v101, v122, v126
    v_pk_max_f16 v100, v100, v36
    v_pk_max_f16 v101, v101, v37
    buffer_store_dwordx2 v[100:101], v82, s[48:51], 0 offen sc1
    v_cvt_pk_bf16_f32 v102, v115, v119
    v_cvt_pk_bf16_f32 v103, v123, v127
    v_pk_max_f16 v102, v102, v38
    v_pk_max_f16 v103, v103, v39
    buffer_store_dwordx2 v[102:103], v83, s[48:51], 0 offen sc1
    v_rcp_f32 v128, v128
    v_rcp_f32 v129, v129
    v_rcp_f32 v130, v130
    v_rcp_f32 v131, v131
    v_rcp_f32 v132, v132
    v_rcp_f32 v133, v133
    v_rcp_f32 v134, v134
    v_rcp_f32 v135, v135
    v_rcp_f32 v136, v136
    v_rcp_f32 v137, v137
    v_rcp_f32 v138, v138
    v_rcp_f32 v139, v139
    v_rcp_f32 v140, v140
    v_rcp_f32 v141, v141
    v_rcp_f32 v142, v142
    v_rcp_f32 v143, v143
    v_pk_fma_f32 v[144:145], v[144:145], v[128:129], v[48:49]
    v_pk_fma_f32 v[146:147], v[146:147], v[130:131], v[50:51]
    v_pk_fma_f32 v[148:149], v[148:149], v[132:133], v[52:53]
    v_pk_fma_f32 v[150:151], v[150:151], v[134:135], v[54:55]
    v_pk_fma_f32 v[152:153], v[152:153], v[136:137], v[56:57]
    v_pk_fma_f32 v[154:155], v[154:155], v[138:139], v[58:59]
    v_pk_fma_f32 v[156:157], v[156:157], v[140:141], v[60:61]
    v_pk_fma_f32 v[158:159], v[158:159], v[142:143], v[62:63]
    v_cvt_pk_bf16_f32 v128, v144, v148
    v_cvt_pk_bf16_f32 v129, v152, v156
    v_pk_max_f16 v128, v128, v40
    v_pk_max_f16 v129, v129, v41
    buffer_store_dwordx2 v[128:129], v84, s[60:63], 0 offen sc1
    v_cvt_pk_bf16_f32 v130, v145, v149
    v_cvt_pk_bf16_f32 v131, v153, v157
    v_pk_max_f16 v130, v130, v42
    v_pk_max_f16 v131, v131, v43
    buffer_store_dwordx2 v[130:131], v85, s[60:63], 0 offen sc1
    v_cvt_pk_bf16_f32 v132, v146, v150
    v_cvt_pk_bf16_f32 v133, v154, v158
    v_pk_max_f16 v132, v132, v44
    v_pk_max_f16 v133, v133, v45
    buffer_store_dwordx2 v[132:133], v86, s[60:63], 0 offen sc1
    v_cvt_pk_bf16_f32 v134, v147, v151
    v_cvt_pk_bf16_f32 v135, v155, v159
    v_pk_max_f16 v134, v134, v46
    v_pk_max_f16 v135, v135, v47
    buffer_store_dwordx2 v[134:135], v87, s[60:63], 0 offen sc1
L_END:
    s_endpgm
L_NS0:
    v_add_f32 v96, v96, v128
    v_add_f32 v100, v100, v132
    v_add_f32 v104, v104, v136
    v_add_f32 v108, v108, v140
    v_add_f32 v112, v112, v144
    v_add_f32 v116, v116, v148
    v_add_f32 v120, v120, v152
    v_add_f32 v124, v124, v156
    s_branch L_NSR
L_NS1:
    v_add_f32 v97, v97, v129
    v_add_f32 v101, v101, v133
    v_add_f32 v105, v105, v137
    v_add_f32 v109, v109, v141
    v_add_f32 v113, v113, v145
    v_add_f32 v117, v117, v149
    v_add_f32 v121, v121, v153
    v_add_f32 v125, v125, v157
    s_branch L_NSR
L_NS2:
    v_add_f32 v98, v98, v130
    v_add_f32 v102, v102, v134
    v_add_f32 v106, v106, v138
    v_add_f32 v110, v110, v142
    v_add_f32 v114, v114, v146
    v_add_f32 v118, v118, v150
    v_add_f32 v122, v122, v154
    v_add_f32 v126, v126, v158
    s_branch L_NSR
L_NS3:
    v_add_f32 v99, v99, v131
    v_add_f32 v103, v103, v135
    v_add_f32 v107, v107, v139
    v_add_f32 v111, v111, v143
    v_add_f32 v115, v115, v147
    v_add_f32 v119, v119, v151
    v_add_f32 v123, v123, v155
    v_add_f32 v127, v127, v159
    s_branch L_NSR
L_RT0:
    s_waitcnt vmcnt(0)
    s_add_u32 s100, s100, 1
    s_cmp_gt_u32 s100, 200000
    s_cbranch_scc1 L_END
    s_sleep 1
    buffer_load_dwordx4 v[128:131], v232, s[56:59], 0 offen sc1
    buffer_load_dwordx4 v[132:135], v232, s[56:59], s26 offen sc1
    buffer_load_dwordx4 v[136:139], v232, s[56:59], s27 offen sc1
    buffer_load_dwordx4 v[140:143], v232, s[56:59], s28 offen sc1
    s_waitcnt vmcnt(0)
    s_branch L_PW0
L_RT1:
    s_waitcnt vmcnt(0)
    s_add_u32 s100, s100, 1
    s_cmp_gt_u32 s100, 200000
    s_cbranch_scc1 L_END
    s_sleep 1
    buffer_load_dwordx4 v[132:135], v232, s[56:59], s26 offen sc1
    buffer_load_dwordx4 v[136:139], v232, s[56:59], s27 offen sc1
    buffer_load_dwordx4 v[140:143], v232, s[56:59], s28 offen sc1
    s_waitcnt vmcnt(0)
    s_branch L_PW1
L_RT2:
    s_waitcnt vmcnt(0)
    s_add_u32 s100, s100, 1
    s_cmp_gt_u32 s100, 200000
    s_cbranch_scc1 L_END
    s_sleep 1
    buffer_load_dwordx4 v[136:139], v232, s[56:59], s27 offen sc1
    buffer_load_dwordx4 v[140:143], v232, s[56:59], s28 offen sc1
    s_waitcnt vmcnt(0)
    s_branch L_PW2
L_RT3:
    s_waitcnt vmcnt(0)
    s_add_u32 s100, s100, 1
    s_cmp_gt_u32 s100, 200000
    s_cbranch_scc1 L_END
    s_sleep 1
    buffer_load_dwordx4 v[140:143], v232, s[56:59], s28 offen sc1
    s_waitcnt vmcnt(0)
    s_branch L_PW3
L_XT2B:
    s_add_u32 s100, s100, 1
    s_cmp_gt_u32 s100, 200000
    s_cbranch_scc1 L_END
    s_sleep 1
    s_mov_b64 exec, s[70:71]
    s_cbranch_execz L_XLb0
    s_movk_i32 s10, 0
    buffer_load_dwordx4 v[64:67], v232, s[60:63], s10 offen sc1
L_XLb0:
    s_mov_b64 exec, s[78:79]
    s_cbranch_execz L_XLb1
    s_movk_i32 s10, 8192
    buffer_load_dwordx4 v[68:71], v232, s[60:63], s10 offen sc1
L_XLb1:
    s_mov_b64 exec, s[86:87]
    s_cbranch_execz L_XLb2
    s_movk_i32 s10, 16384
    buffer_load_dwordx4 v[72:75], v232, s[60:63], s10 offen sc1
L_XLb2:
    s_mov_b64 exec, s[94:95]
    s_cbranch_execz L_XLb3
    s_movk_i32 s10, 24576
    buffer_load_dwordx4 v[76:79], v232, s[60:63], s10 offen sc1
L_XLb3:
    s_mov_b64 exec, -1
    s_waitcnt vmcnt(0)
    s_branch L_XT2
L_OVF:
    s_mov_b32 s20, 0
    s_mov_b32 s17, 0
    s_mov_b32 s30, 0
    s_mov_b32 s19, 4
    s_waitcnt lgkmcnt(0)
    s_branch L_CA
L_POVF:
    s_movk_i32 s11, 1986
    v_mul_u32_u24 v64, s11, v192
    v_lshrrev_b32 v64, 16, v64
    v_mul_u32_u24 v65, s11, v193
    v_lshrrev_b32 v65, 16, v65
    v_mul_u32_u24 v66, s11, v194
    v_lshrrev_b32 v66, 16, v66
    v_mul_u32_u24 v67, s11, v195
    v_lshrrev_b32 v67, 16, v67
    v_add_u32 v69, v64, v65
    v_add_u32 v70, v69, v66
    v_add_u32 v71, v70, v67
    v_mov_b32 v72, v71
    s_nop 1
    v_add_u32_dpp v72, v72, v72 row_shr:1 row_mask:0xf bank_mask:0xf bound_ctrl:0
    s_nop 1
    v_add_u32_dpp v72, v72, v72 row_shr:2 row_mask:0xf bank_mask:0xf bound_ctrl:0
    s_nop 1
    v_add_u32_dpp v72, v72, v72 row_shr:4 row_mask:0xf bank_mask:0xf bound_ctrl:0
    s_nop 1
    v_add_u32_dpp v72, v72, v72 row_shr:8 row_mask:0xf bank_mask:0xf bound_ctrl:0
    s_nop 1
    v_add_u32_dpp v72, v72, v72 row_bcast:15 row_mask:0xa bank_mask:0xf
    s_nop 1
    v_add_u32_dpp v72, v72, v72 row_bcast:31 row_mask:0xc bank_mask:0xf
    s_nop 0
    v_sub_u32 v68, v72, v71
    v_add_u32 v71, v68, v70
    v_add_u32 v70, v68, v69
    v_add_u32 v69, v68, v64
    v_lshl_or_b32 v68, v64, 16, v68
    v_lshl_or_b32 v69, v65, 16, v69
    v_lshl_or_b32 v70, v66, 16, v70
    v_lshl_or_b32 v71, v67, 16, v71
    v_add_u32 v72, 154752, v185
    ds_write_b128 v72, v[68:71]
    s_lshl_b32 s10, s2, 10
    s_add_u32 s10, s10, 24772608
    buffer_store_dwordx4 v[68:71], v185, s[52:55], s10 offen sc1
    v_and_b32 v74, 0x3fc, v136
    v_add_u32 v74, 154752, v74
    ds_read_u16 v74, v74
    v_and_b32 v75, 0x3fc, v137
    v_add_u32 v75, 154752, v75
    ds_read_u16 v75, v75
    v_and_b32 v76, 0x3fc, v138
    v_add_u32 v76, 154752, v76
    ds_read_u16 v76, v76
    v_and_b32 v77, 0x3fc, v139
    v_add_u32 v77, 154752, v77
    ds_read_u16 v77, v77
    v_and_b32 v78, 0x3fc, v140
    v_add_u32 v78, 154752, v78
    ds_read_u16 v78, v78
    v_and_b32 v79, 0x3fc, v141
    v_add_u32 v79, 154752, v79
    ds_read_u16 v79, v79
    v_and_b32 v80, 0x3fc, v142
    v_add_u32 v80, 154752, v80
    ds_read_u16 v80, v80
    v_and_b32 v81, 0x3fc, v143
    v_add_u32 v81, 154752, v81
    ds_read_u16 v81, v81
    s_waitcnt lgkmcnt(0)
    v_cmpx_lt_u32 vcc, 1056, v228
    v_or_b32 v205, 0x10000, v205
    s_mov_b64 exec, -1
    v_cmpx_lt_u32 vcc, 1056, v229
    v_or_b32 v209, 0x10000, v209
    s_mov_b64 exec, -1
    v_cmpx_lt_u32 vcc, 1056, v230
    v_or_b32 v213, 0x10000, v213
    s_mov_b64 exec, -1
    v_cmpx_lt_u32 vcc, 1056, v231
    v_or_b32 v217, 0x10000, v217
    s_mov_b64 exec, -1
    s_mul_i32 s10, s2, 4152
    s_mov_b32 s34, 18874368
    s_mov_b32 s35, 23592960
    v_mul_u32_u24 v64, s11, v112
    v_lshrrev_b32 v64, 16, v64
    v_add3_u32 v64, v64, v74, s10
    v_lshlrev_b32 v65, 2, v64
    v_cmpx_le_u32 vcc, 1056, v112
    s_cbranch_execz L_PO0
    buffer_store_byte v120, v64, s[52:55], s35 offen sc1
    buffer_store_dword v96, v65, s[52:55], s34 offen sc1
L_PO0:
    s_mov_b64 exec, -1
    v_mul_u32_u24 v64, s11, v113
    v_lshrrev_b32 v64, 16, v64
    v_add3_u32 v64, v64, v75, s10
    v_lshlrev_b32 v65, 2, v64
    v_cmpx_le_u32 vcc, 1056, v113
    s_cbranch_execz L_PO1
    buffer_store_byte v121, v64, s[52:55], s35 offen sc1
    buffer_store_dword v97, v65, s[52:55], s34 offen sc1
L_PO1:
    s_mov_b64 exec, -1
    v_mul_u32_u24 v64, s11, v114
    v_lshrrev_b32 v64, 16, v64
    v_add3_u32 v64, v64, v76, s10
    v_lshlrev_b32 v65, 2, v64
    v_cmpx_le_u32 vcc, 1056, v114
    s_cbranch_execz L_PO2
    buffer_store_byte v122, v64, s[52:55], s35 offen sc1
    buffer_store_dword v98, v65, s[52:55], s34 offen sc1
L_PO2:
    s_mov_b64 exec, -1
    v_mul_u32_u24 v64, s11, v115
    v_lshrrev_b32 v64, 16, v64
    v_add3_u32 v64, v64, v77, s10
    v_lshlrev_b32 v65, 2, v64
    v_cmpx_le_u32 vcc, 1056, v115
    s_cbranch_execz L_PO3
    buffer_store_byte v123, v64, s[52:55], s35 offen sc1
    buffer_store_dword v99, v65, s[52:55], s34 offen sc1
L_PO3:
    s_mov_b64 exec, -1
    v_mul_u32_u24 v64, s11, v116
    v_lshrrev_b32 v64, 16, v64
    v_add3_u32 v64, v64, v78, s10
    v_lshlrev_b32 v65, 2, v64
    v_cmpx_le_u32 vcc, 1056, v116
    s_cbranch_execz L_PO4
    buffer_store_byte v120, v64, s[52:55], s35 offen sc1
    buffer_store_dword v100, v65, s[52:55], s34 offen sc1
L_PO4:
    s_mov_b64 exec, -1
    v_mul_u32_u24 v64, s11, v117
    v_lshrrev_b32 v64, 16, v64
    v_add3_u32 v64, v64, v79, s10
    v_lshlrev_b32 v65, 2, v64
    v_cmpx_le_u32 vcc, 1056, v117
    s_cbranch_execz L_PO5
    buffer_store_byte v121, v64, s[52:55], s35 offen sc1
    buffer_store_dword v101, v65, s[52:55], s34 offen sc1
L_PO5:
    s_mov_b64 exec, -1
    v_mul_u32_u24 v64, s11, v118
    v_lshrrev_b32 v64, 16, v64
    v_add3_u32 v64, v64, v80, s10
    v_lshlrev_b32 v65, 2, v64
    v_cmpx_le_u32 vcc, 1056, v118
    s_cbranch_execz L_PO6
    buffer_store_byte v122, v64, s[52:55], s35 offen sc1
    buffer_store_dword v102, v65, s[52:55], s34 offen sc1
L_PO6:
    s_mov_b64 exec, -1
    v_mul_u32_u24 v64, s11, v119
    v_lshrrev_b32 v64, 16, v64
    v_add3_u32 v64, v64, v81, s10
    v_lshlrev_b32 v65, 2, v64
    v_cmpx_le_u32 vcc, 1056, v119
    s_cbranch_execz L_PO7
    buffer_store_byte v123, v64, s[52:55], s35 offen sc1
    buffer_store_dword v103, v65, s[52:55], s34 offen sc1
L_PO7:
    s_mov_b64 exec, -1
    s_waitcnt vmcnt(0) lgkmcnt(0)
    s_barrier
    s_branch L_POUT
L_SLOW:
    s_setprio 0
    s_lshl_b32 s10, s3, 6
    v_add_u32 v255, s10, v253
    s_cmp_lg_u32 s19, 4
    s_cbranch_scc1 L_SL1
    s_mov_b32 s19, 1
    v_and_b32 v188, 0xff, v255
    v_lshlrev_b32 v189, 7, v188
    buffer_load_dword v190, v189, s[56:59], 0 offen offset:4 sc1
    v_lshlrev_b32 v189, 10, v188
    s_lshl_b32 s10, s5, 2
    s_add_u32 s10, s10, 24772608
    buffer_load_dword v191, v189, s[52:55], s10 offen sc1
    v_lshlrev_b32 v188, 2, v188
    v_add_u32 v188, 154752, v188
    s_waitcnt vmcnt(0)
    v_and_b32 v190, 0x10000, v190
    v_cmp_ne_u32 vcc, 0, v190
    v_mov_b32 v190, 2097152
    s_nop 0
    v_cndmask_b32 v190, v190, v191, vcc
    ds_write_b32 v188, v190
    s_waitcnt lgkmcnt(0)
    s_barrier
L_SL1:
    s_add_u32 s28, s28, 288
    s_cmp_lt_u32 s28, s29
    s_cbranch_scc1 L_BATCH
L_FIND:
    s_cmp_lg_u64 s[32:33], 0
    s_cbranch_scc1 L_GOT
    s_add_u32 s26, s26, 1
    s_cmp_ge_u32 s26, 4
    s_cbranch_scc1 L_EPI
    s_lshl_b32 s10, s26, 8
    s_add_u32 s10, s10, 154752
    v_lshl_add_u32 v188, v253, 2, s10
    ds_read_u16 v188, v188 offset:2
    s_waitcnt lgkmcnt(0)
    v_cmp_lt_u32 s[32:33], s20, v188
    s_nop 3
    s_branch L_FIND
L_GOT:
    s_ff1_i32_b64 s10, s[32:33]
    s_bitset0_b64 s[32:33], s10
    s_lshl_b32 s11, s26, 6
    s_add_u32 s27, s10, s11
    s_lshl_b32 s10, s27, 2
    s_add_u32 s10, s10, 154752
    v_mov_b32 v188, s10
    ds_read_b32 v188, v188
    s_waitcnt lgkmcnt(0)
    v_readfirstlane_b32 s10, v188
    s_nop 3
    s_lshr_b32 s29, s10, 16
    s_and_b32 s30, s10, 0xffff
    s_mov_b32 s28, s20
L_BATCH:
    s_waitcnt vmcnt(0)
    s_barrier
    v_mov_b64 v[192:193], 0
    v_mov_b64 v[194:195], 0
    v_mov_b32 v196, 0x20fffff
    v_mov_b32 v197, 0x20fffff
    v_mov_b32 v198, 0x20fffff
    v_mov_b32 v199, 0x20fffff
    v_lshl_add_u32 v200, v253, 4, s12
    ds_write_b128 v200, v[192:195] offset:0
    ds_write_b128 v200, v[196:199] offset:18432
    ds_write_b128 v200, v[192:195] offset:1024
    ds_write_b128 v200, v[196:199] offset:19456
    ds_write_b128 v200, v[192:195] offset:1280
    ds_write_b128 v200, v[196:199] offset:19712
    v_and_b32 v188, 15, v253
    v_mul_u32_u24 v189, 1152, v188
    v_add_u32 v189, 8192, v189
    v_lshlrev_b32 v188, 2, v188
    ds_write_b32 v188, v189 offset:576
    v_add_u32 v188, s28, v255
    s_mul_i32 s36, s27, 3128
    s_mul_i32 s11, s27, 4152
    s_add_u32 s11, s11, s30
    s_lshl_b32 s34, s11, 2
    s_add_u32 s34, s34, 18874368
    v_lshl_add_u32 v190, v188, 2, s34
    s_add_u32 s34, s11, 23592960
    v_add_u32 v191, s34, v188
    s_mul_i32 s10, s5, 32896
    s_lshl_b32 s34, s27, 7
    s_add_u32 s10, s10, s34
    s_add_u32 s10, s10, 65536
    v_and_b32 v206, 7, v188
    v_lshl_add_u32 v206, v206, 4, s10
    v_lshrrev_b32 v207, 3, v188
    v_cmpx_gt_u32 vcc, 32, v188
    v_add_u32 v190, 8421376, v206
    v_add_u32 v191, 8, v190
    v_cmpx_gt_u32 vcc, 24, v188
    v_lshl_add_u32 v190, v207, 2, v206
    v_add3_u32 v191, v206, v207, 12
    s_mov_b64 exec, -1
    s_add_u32 s10, s28, 288
    s_min_u32 s10, s10, s29
    v_cmp_gt_u32 vcc, s10, v188
    v_mov_b32 v206, 0x7ffffff0
    s_nop 0
    v_cndmask_b32 v190, v206, v190, vcc
    v_cndmask_b32 v191, v206, v191, vcc
    buffer_load_dwordx2 v[204:205], v190, s[52:55], 0 offen sc1
    buffer_load_ubyte v191, v191, s[52:55], 0 offen sc1
    s_waitcnt lgkmcnt(0)
    s_barrier
    s_waitcnt vmcnt(0)
    v_cmp_ne_u32 vcc, 3, v207
    v_cmp_eq_u32 s[10:11], s6, v205
    v_mov_b32 v206, s36
    s_or_b64 exec, vcc, s[10:11]
    v_cmpx_ne_u32 vcc, 0, v204
    v_bfe_u32 v190, v204, 18, 8
    v_lshlrev_b32 v190, 2, v190
    v_add_u32 v188, 153728, v190
    ds_read_b32 v188, v188
    v_add_u32_sdwa v191, v191, v206 dst_sel:DWORD dst_unused:UNUSED_PAD src0_sel:BYTE_0 src1_sel:DWORD
    v_lshrrev_b32 v189, 28, v204
    v_lshl_add_u32 v191, v189, 8, v191
    v_and_b32 v189, 60, v190
    v_lshl_add_u32 v191, v189, 19, v191
    v_mov_b32 v190, 4
    v_and_b32 v204, 0xffff, v204
    s_waitcnt lgkmcnt(0)
    ds_add_rtn_u32 v188, v188, v190 offset:576
    s_waitcnt lgkmcnt(0)
    ds_write2st64_b32 v188, v204, v191 offset0:148 offset1:220
    s_mov_b64 exec, -1
    s_waitcnt lgkmcnt(0)
    s_barrier
    v_lshrrev_b32 v190, 3, v253
    v_lshl_add_u32 v247, v190, 4, s12
    s_add_u32 s10, s12, 18432
    v_lshrrev_b32 v190, 1, v253
    v_lshl_add_u32 v248, v190, 2, s10
    s_add_u32 s10, s10, 2
    v_and_b32 v190, 48, v253
    v_lshl_add_u32 v250, v190, 1, s10
    v_and_b32 v190, 12, v253
    v_add_u32 v250, v250, v190
    v_lshrrev_b32 v190, 5, v253
    v_mul_u32_u24 v249, 18432, v190
    v_and_b32 v190, 15, v253
    v_lshl_add_u32 v249, v190, 2, v249
    s_add_u32 s10, s12, 2
    v_add_u32 v249, s10, v249
    ds_read_b128 v[236:239], v247
    ds_read_b32 v240, v248
    s_lshl_b32 s10, s4, 3
    v_mov_b32 v190, s10
    ds_read_b64 v[190:191], v190 offset:576
    s_waitcnt lgkmcnt(0)
    v_readfirstlane_b32 s34, v190
    v_readfirstlane_b32 s35, v191
    s_sub_u32 s10, s12, 37888
    s_sub_u32 s34, s34, s10
    s_sub_u32 s35, s35, s10
    s_sub_u32 s35, s35, 1152
    s_add_u32 s10, s34, 127
    s_lshr_b32 s10, s10, 7
    s_lshl1_add_u32 s10, s10, -1
    s_add_u32 s11, s35, 127
    s_lshr_b32 s11, s11, 6
    s_and_b32 s11, s11, -2
    s_max_i32 s17, s10, s11
    s_cselect_b32 s10, s34, s35
    s_sub_u32 s10, s10, 1
    s_andn2_b32 s99, 64, s10
    s_add_u32 m0, s13, 0
    v_mad_u32_u16 v236, v236, s15, v243
    buffer_load_dwordx4 v236, s[40:43], 0 offen lds
    s_add_u32 m0, s13, 1056
    v_mad_u32_u16 v237, v237, s15, v243
    buffer_load_dwordx4 v237, s[40:43], 0 offen lds
    s_add_u32 m0, s13, 2112
    v_mad_u32_u16 v238, v238, s15, v243
    buffer_load_dwordx4 v238, s[40:43], 0 offen lds
    s_add_u32 m0, s13, 3168
    v_mad_u32_u16 v239, v239, s15, v243
    buffer_load_dwordx4 v239, s[40:43], 0 offen lds
    s_mov_b32 m0, s14
    v_and_b32 v240, 0xfffff, v240
    buffer_load_dwordx4 v[240:241], s[44:47], 0 idxen offen lds
L_LAST:
    s_branch L_GO
.section .rodata,"a"
.p2align 6
.amdhsa_kernel standalone__edge_featured_mpnn_gatedgcn__graph_kernel
  .amdhsa_next_free_vgpr 256
  .amdhsa_next_free_sgpr 102
  .amdhsa_accum_offset 256
  .amdhsa_group_segment_fixed_size 0
  .amdhsa_kernarg_size 96
  .amdhsa_user_sgpr_count 2
  .amdhsa_user_sgpr_kernarg_segment_ptr 1
  .amdhsa_system_sgpr_workgroup_id_x 1
.end_amdhsa_kernel
```

```asm
; @launch grid=(256,1,1) block=(512,1,1) lds=158848
.amdgcn_target "amdgcn-amd-amdhsa--gfx950"
.text
.globl standalone__edge_featured_mpnn_gatedgcn__graph_kernel
.p2align 8
.type standalone__edge_featured_mpnn_gatedgcn__graph_kernel,@function
standalone__edge_featured_mpnn_gatedgcn__graph_kernel:
    s_load_dwordx16 s[16:31], s[0:1], 0
    s_load_dwordx8 s[32:39], s[0:1], 64
    s_getpc_b64 s[64:65]
L_PC:
    s_and_b32 s3, s2, -8
    v_add_lshl_u32 v1, v0, s3, 7
    v_min_u32 v1, L_LAST-L_PC, v1
    v_cmpx_gt_u32 vcc, 8, v0
    s_cbranch_execz L_NOCPF
    global_load_dword v251, v1, s[64:65]
L_NOCPF:
    s_mov_b64 exec, -1
    s_cmp_ge_u32 s2, 256
    s_cbranch_scc1 L_END
    s_mul_i32 s10, s2, 12512
    v_lshl_add_u32 v1, v0, 4, s10
    s_add_u32 s11, s10, 12512
    s_min_u32 s11, s11, 3200000
    v_add_u32 v2, 0x2000, v1
    s_waitcnt lgkmcnt(0)
    global_load_dwordx4 v[128:131], v1, s[22:23] nt
    global_load_dwordx4 v[96:99], v1, s[20:21] nt
    v_cmpx_gt_u32 s[70:71], s11, v2
    s_cbranch_execz L_NO8
    global_load_dwordx4 v[132:135], v2, s[22:23] nt
    global_load_dwordx4 v[100:103], v2, s[20:21] nt
L_NO8:
    s_mov_b64 exec, -1
L_NO7:
    s_mov_b64 exec, -1
    s_load_dword s6, s[38:39], 0
    v_mov_b32 v255, v0
    v_lshrrev_b32 v188, 6, v0
    v_and_b32 v253, 63, v0
    v_readfirstlane_b32 s3, v188
    v_lshlrev_b32 v232, 4, v0
    v_lshlrev_b32 v190, 3, v0
    v_lshlrev_b32 v191, 2, v0
    v_and_b32 v192, 0x3fc, v191
    s_and_b32 s5, s2, 7
    s_lshr_b32 s4, s2, 3
    s_lshl_b32 s5, s5, 5
    s_add_u32 s5, s5, s4
    s_mul_i32 s9, s5, 196
    s_cmp_eq_u32 s3, 7
    s_cselect_b32 s101, 0, s3
    s_lshl_b32 s12, s101, 5
    s_add_u32 s9, s9, s12
    v_lshrrev_b32 v193, 3, v253
    v_lshl_add_u32 v193, v193, 2, s9
    v_and_b32 v243, 7, v253
    v_lshlrev_b32 v243, 4, v243
    v_lshl_add_u32 v234, v193, 7, v243
    s_lshl_b32 s101, s101, 10
    s_add_u32 s101, s101, 116736
    v_mov_b64 v[196:197], 0
    v_mov_b64 v[198:199], 0
    v_mov_b32 v194, 132
    ds_write2st64_b32 v192, v194, v196 offset0:20 offset1:24
    v_add_u32 v193, 46080, v232
    ds_write_b128 v193, v[196:199] offset:0
    ds_write_b128 v193, v[196:199] offset:8192
    ds_write_b128 v193, v[196:199] offset:16384
    ds_write_b128 v193, v[196:199] offset:24576
    ds_write_b128 v193, v[196:199] offset:32768
    s_mov_b32 s44, s18
    s_or_b32 s45, s19, 0x200000
    s_mov_b32 s46, 800000
    s_mov_b32 s47, 0x20000
    s_mov_b32 s48, s34
    s_mov_b32 s49, s35
    s_mov_b32 s50, 6400000
    s_mov_b32 s51, 0x20000
    s_mov_b32 s40, s16
    s_mov_b32 s41, s17
    s_mov_b32 s42, 6400000
    s_mov_b32 s43, 0x20000
    s_mov_b32 s52, s38
    s_mov_b32 s53, s39
    s_mov_b32 s54, 25165824
    s_mov_b32 s55, 0x20000
    s_lshl_b32 s12, s2, 7
    s_add_u32 s12, s12, 65536
    s_add_u32 s56, s38, s12
    s_addc_u32 s57, s39, 0
    s_mov_b32 s58, 16809984
    s_mov_b32 s59, 0x20000
    s_mov_b32 s64, 85599
    s_mov_b32 s65, 4294967100
    s_movk_i32 s66, 5368
    s_mov_b32 s67, 0xc000000
    s_mov_b32 s68, 32896
    s_mov_b32 s100, 0xffeff220
    v_add_u32 v120, 0, v191
    v_add_u32 v121, 1, v191
    v_add_u32 v122, 2, v191
    v_add_u32 v123, 3, v191
    s_lshl_b32 s10, s3, 28
    s_or_b32 s10, s10, 0x20000
    v_mov_b32 v144, s10
    v_or_b32 v145, 0x80000000, v144
    v_mov_b32 v184, 33
    v_mov_b32 v146, 0x400
    s_and_b32 s10, s3, 3
    s_lshr_b32 s4, s3, 2
    s_lshl1_add_u32 s4, s10, s4
    s_xor_b32 s4, s4, 1
    s_mul_i32 s10, s4, 49
    s_sub_i32 s10, s10, 6
    s_ashr_i32 s10, s10, 1
    s_max_i32 s7, s10, 0
    s_mul_i32 s13, s4, 4224
    s_add_u32 s13, s13, 82944
    s_lshl_b32 s14, s4, 10
    s_add_u32 s14, s14, 5120
    s_mul_i32 s12, s4, 2304
    s_add_u32 s12, s12, 46080
    s_movk_i32 s15, 128
    v_bfe_u32 v194, v255, 4, 4
    v_and_b32 v195, 7, v255
    v_cmp_eq_u32 vcc, v194, v195
    v_and_b32 v194, 8, v255
    v_lshlrev_b32 v194, 1, v194
    v_mov_b32 v196, 0x3f80
    v_lshlrev_b32 v196, v194, v196
    v_cndmask_b32 v196, 0, v196, vcc
    ds_write_b32 v192, v196 offset:0
    v_mov_b64 v[196:197], 0
    ds_write_b64 v190, v[196:197] offset:1024
    v_add_u32 v194, 155776, v191
    ds_write_b32 v194, v196
    v_lshrrev_b32 v223, 3, v255
    v_mad_u32_u24 v220, v223, s68, v243
    v_mul_u32_u24 v224, 160, v223
    v_add_u32 v221, v224, v243
    v_add_u32 v221, 46080, v221
    v_bfe_u32 v194, v255, 5, 1
    v_bfe_u32 v196, v255, 6, 1
    v_sub_u32 v194, v194, v196
    v_mul_i32_i24 v194, 640, v194
    v_add_u32 v224, v224, v194
    v_lshl_add_u32 v224, v195, 2, v224
    v_add_u32 v224, 13312, v224
    v_lshlrev_b32 v185, 4, v253
    v_and_b32 v194, 3, v253
    v_lshlrev_b32 v246, 3, v194
    v_bfe_u32 v197, v253, 2, 3
    v_lshrrev_b32 v196, 5, v253
    v_lshl_add_u32 v197, v196, 4, v197
    v_mul_u32_u24 v225, 160, v197
    v_add_u32 v225, v225, v246
    s_movk_i32 s69, 11520
    v_mov_b64 v[116:117], 0
    v_mov_b64 v[118:119], 0
    s_waitcnt lgkmcnt(0)
    s_barrier
    s_cmp_eq_u64 s[70:71], 0
    s_cbranch_scc1 L_R4
    s_waitcnt vmcnt(3)
    v_mul_u32_u24 v104, s64, v128
    v_mul_u32_u24 v105, s64, v129
    v_mul_u32_u24 v106, s64, v130
    v_mul_u32_u24 v107, s64, v131
    v_lshrrev_b32 v136, 29, v104
    v_lshrrev_b32 v137, 29, v105
    v_lshrrev_b32 v138, 29, v106
    v_lshrrev_b32 v139, 29, v107
    v_cmp_eq_u32 s[72:73], v136, v137
    v_cmp_eq_u32 s[76:77], v138, v139
    v_cmp_eq_u32 vcc, v136, v138
    v_cmp_eq_u32 s[88:89], v137, v139
    v_cmp_eq_u32 s[90:91], v136, v139
    v_cmp_eq_u32 s[10:11], v137, v138
    v_lshrrev_b32 v104, 24, v104
    v_lshrrev_b32 v105, 24, v105
    v_lshrrev_b32 v106, 24, v106
    v_lshrrev_b32 v107, 24, v107
    s_or_b64 s[74:75], s[72:73], s[88:89]
    s_or_b64 s[78:79], s[76:77], s[88:89]
    s_or_b64 s[72:73], s[72:73], vcc
    s_or_b64 s[76:77], s[76:77], vcc
    s_or_b64 s[72:73], s[72:73], s[90:91]
    s_or_b64 s[74:75], s[74:75], s[10:11]
    s_or_b64 s[76:77], s[76:77], s[10:11]
    s_or_b64 s[78:79], s[78:79], s[90:91]
    v_cndmask_b32 v136, 0, v146, s[72:73]
    v_lshl_add_u32 v136, v104, 2, v136
    ds_add_rtn_u32 v112, v136, v184 offset:5120
    v_cndmask_b32 v137, 0, v146, s[74:75]
    v_lshl_add_u32 v137, v105, 2, v137
    ds_add_rtn_u32 v113, v137, v184 offset:5120
    v_cndmask_b32 v138, 0, v146, s[76:77]
    v_lshl_add_u32 v138, v106, 2, v138
    ds_add_rtn_u32 v114, v138, v184 offset:5120
    v_cndmask_b32 v139, 0, v146, s[78:79]
    v_lshl_add_u32 v139, v107, 2, v139
    ds_add_rtn_u32 v115, v139, v184 offset:5120
    s_waitcnt vmcnt(1)
    s_mov_b64 exec, s[70:71]
    v_mul_u32_u24 v108, s64, v132
    v_mul_u32_u24 v109, s64, v133
    v_mul_u32_u24 v110, s64, v134
    v_mul_u32_u24 v111, s64, v135
    v_lshrrev_b32 v108, 24, v108
    v_lshrrev_b32 v109, 24, v109
    v_lshrrev_b32 v110, 24, v110
    v_lshrrev_b32 v111, 24, v111
    v_lshlrev_b32 v140, 2, v108
    ds_add_rtn_u32 v116, v140, v184 offset:5120
    v_lshlrev_b32 v141, 2, v109
    ds_add_rtn_u32 v117, v141, v184 offset:5120
    v_lshlrev_b32 v142, 2, v110
    ds_add_rtn_u32 v118, v142, v184 offset:5120
    v_lshlrev_b32 v143, 2, v111
    ds_add_rtn_u32 v119, v143, v184 offset:5120
    s_waitcnt lgkmcnt(7)
    s_mov_b64 exec, s[72:73]
    v_cmpx_le_u32 vcc, 132, v112
    ds_add_rtn_u32 v112, v136, v184 offset:4096
    s_waitcnt lgkmcnt(7)
    s_mov_b64 exec, s[74:75]
    v_cmpx_le_u32 vcc, 132, v113
    ds_add_rtn_u32 v113, v137, v184 offset:4096
    s_waitcnt lgkmcnt(7)
    s_mov_b64 exec, s[76:77]
    v_cmpx_le_u32 vcc, 132, v114
    ds_add_rtn_u32 v114, v138, v184 offset:4096
    s_waitcnt lgkmcnt(7)
    s_mov_b64 exec, s[78:79]
    v_cmpx_le_u32 vcc, 132, v115
    ds_add_rtn_u32 v115, v139, v184 offset:4096
    s_mov_b64 exec, s[70:71]
    s_waitcnt vmcnt(0)
    v_mad_i32_i24 v132, v108, s65, v132
    v_mul_u32_u24 v194, s66, v100
    v_lshl_or_b32 v100, v132, 18, v100
    v_and_b32 v132, 0xe0, v108
    v_mad_i32_i24 v194, v132, s100, v194
    v_and_or_b32 v194, v194, s67, v145
    v_mad_u32_u24 v132, v108, 40, s69
    v_or_b32 v100, v100, v194
    v_mad_i32_i24 v133, v109, s65, v133
    v_mul_u32_u24 v194, s66, v101
    v_lshl_or_b32 v101, v133, 18, v101
    v_and_b32 v133, 0xe0, v109
    v_mad_i32_i24 v194, v133, s100, v194
    v_and_or_b32 v194, v194, s67, v145
    v_mad_u32_u24 v133, v109, 40, s69
    v_or_b32 v101, v101, v194
    v_mad_i32_i24 v134, v110, s65, v134
    v_mul_u32_u24 v194, s66, v102
    v_lshl_or_b32 v102, v134, 18, v102
    v_and_b32 v134, 0xe0, v110
    v_mad_i32_i24 v194, v134, s100, v194
    v_and_or_b32 v194, v194, s67, v145
    v_mad_u32_u24 v134, v110, 40, s69
    v_or_b32 v102, v102, v194
    v_mad_i32_i24 v135, v111, s65, v135
    v_mul_u32_u24 v194, s66, v103
    v_lshl_or_b32 v103, v135, 18, v103
    v_and_b32 v135, 0xe0, v111
    v_mad_i32_i24 v194, v135, s100, v194
    v_and_or_b32 v194, v194, s67, v145
    v_mad_u32_u24 v135, v111, 40, s69
    v_or_b32 v103, v103, v194
    s_waitcnt lgkmcnt(7)
    v_bfe_u32 v194, v116, 3, 5
    v_add_lshl_u32 v132, v194, v132, 2
    v_and_b32 v194, 3, v194
    v_mad_i32_i24 v194, v194, -3, v132
    v_cmpx_gt_u32 vcc, 792, v116
    ds_write_b32 v132, v100
    ds_write_b8 v194, v120 offset:12
    s_mov_b64 exec, s[70:71]
    s_waitcnt lgkmcnt(8)
    v_bfe_u32 v194, v117, 3, 5
    v_add_lshl_u32 v133, v194, v133, 2
    v_and_b32 v194, 3, v194
    v_mad_i32_i24 v194, v194, -3, v133
    v_cmpx_gt_u32 vcc, 792, v117
    ds_write_b32 v133, v101
    ds_write_b8 v194, v121 offset:12
    s_mov_b64 exec, s[70:71]
    s_waitcnt lgkmcnt(9)
    v_bfe_u32 v194, v118, 3, 5
    v_add_lshl_u32 v134, v194, v134, 2
    v_and_b32 v194, 3, v194
    v_mad_i32_i24 v194, v194, -3, v134
    v_cmpx_gt_u32 vcc, 792, v118
    ds_write_b32 v134, v102
    ds_write_b8 v194, v122 offset:12
    s_mov_b64 exec, s[70:71]
    s_waitcnt lgkmcnt(10)
    v_bfe_u32 v194, v119, 3, 5
    v_add_lshl_u32 v135, v194, v135, 2
    v_and_b32 v194, 3, v194
    v_mad_i32_i24 v194, v194, -3, v135
    v_cmpx_gt_u32 vcc, 792, v119
    ds_write_b32 v135, v103
    ds_write_b8 v194, v123 offset:12
    s_mov_b64 exec, -1
    v_mad_i32_i24 v128, v104, s65, v128
    v_mul_u32_u24 v194, s66, v96
    v_lshl_or_b32 v96, v128, 18, v96
    v_and_b32 v128, 0xe0, v104
    v_mad_i32_i24 v194, v128, s100, v194
    v_and_or_b32 v194, v194, s67, v144
    v_mad_u32_u24 v128, v104, 40, s69
    v_or_b32 v96, v96, v194
    v_mad_i32_i24 v129, v105, s65, v129
    v_mul_u32_u24 v194, s66, v97
    v_lshl_or_b32 v97, v129, 18, v97
    v_and_b32 v129, 0xe0, v105
    v_mad_i32_i24 v194, v129, s100, v194
    v_and_or_b32 v194, v194, s67, v144
    v_mad_u32_u24 v129, v105, 40, s69
    v_or_b32 v97, v97, v194
    v_mad_i32_i24 v130, v106, s65, v130
    v_mul_u32_u24 v194, s66, v98
    v_lshl_or_b32 v98, v130, 18, v98
    v_and_b32 v130, 0xe0, v106
    v_mad_i32_i24 v194, v130, s100, v194
    v_and_or_b32 v194, v194, s67, v144
    v_mad_u32_u24 v130, v106, 40, s69
    v_or_b32 v98, v98, v194
    v_mad_i32_i24 v131, v107, s65, v131
    v_mul_u32_u24 v194, s66, v99
    v_lshl_or_b32 v99, v131, 18, v99
    v_and_b32 v131, 0xe0, v107
    v_mad_i32_i24 v194, v131, s100, v194
    v_and_or_b32 v194, v194, s67, v144
    v_mad_u32_u24 v131, v107, 40, s69
    v_or_b32 v99, v99, v194
    s_waitcnt lgkmcnt(11)
    v_bfe_u32 v194, v112, 3, 5
    v_add_lshl_u32 v128, v194, v128, 2
    v_and_b32 v194, 3, v194
    v_mad_i32_i24 v194, v194, -3, v128
    v_cmpx_gt_u32 vcc, 792, v112
    ds_write_b32 v128, v96
    ds_write_b8 v194, v120 offset:12
    s_mov_b64 exec, -1
    s_waitcnt lgkmcnt(12)
    v_bfe_u32 v194, v113, 3, 5
    v_add_lshl_u32 v129, v194, v129, 2
    v_and_b32 v194, 3, v194
    v_mad_i32_i24 v194, v194, -3, v129
    v_cmpx_gt_u32 vcc, 792, v113
    ds_write_b32 v129, v97
    ds_write_b8 v194, v121 offset:12
    s_mov_b64 exec, -1
    s_waitcnt lgkmcnt(13)
    v_bfe_u32 v194, v114, 3, 5
    v_add_lshl_u32 v130, v194, v130, 2
    v_and_b32 v194, 3, v194
    v_mad_i32_i24 v194, v194, -3, v130
    v_cmpx_gt_u32 vcc, 792, v114
    ds_write_b32 v130, v98
    ds_write_b8 v194, v122 offset:12
    s_mov_b64 exec, -1
    s_waitcnt lgkmcnt(14)
    v_bfe_u32 v194, v115, 3, 5
    v_add_lshl_u32 v131, v194, v131, 2
    v_and_b32 v194, 3, v194
    v_mad_i32_i24 v194, v194, -3, v131
    v_cmpx_gt_u32 vcc, 792, v115
    ds_write_b32 v131, v99
    ds_write_b8 v194, v123 offset:12
    s_mov_b64 exec, -1
    s_branch L_B1
L_R4:
    s_waitcnt vmcnt(1)
    v_mul_u32_u24 v104, s64, v128
    v_mul_u32_u24 v105, s64, v129
    v_mul_u32_u24 v106, s64, v130
    v_mul_u32_u24 v107, s64, v131
    v_lshrrev_b32 v136, 29, v104
    v_lshrrev_b32 v137, 29, v105
    v_lshrrev_b32 v138, 29, v106
    v_lshrrev_b32 v139, 29, v107
    v_cmp_eq_u32 s[72:73], v136, v137
    v_cmp_eq_u32 s[76:77], v138, v139
    v_cmp_eq_u32 vcc, v136, v138
    v_cmp_eq_u32 s[88:89], v137, v139
    v_cmp_eq_u32 s[90:91], v136, v139
    v_cmp_eq_u32 s[10:11], v137, v138
    v_lshrrev_b32 v104, 24, v104
    v_lshrrev_b32 v105, 24, v105
    v_lshrrev_b32 v106, 24, v106
    v_lshrrev_b32 v107, 24, v107
    s_or_b64 s[74:75], s[72:73], s[88:89]
    s_or_b64 s[78:79], s[76:77], s[88:89]
    s_or_b64 s[72:73], s[72:73], vcc
    s_or_b64 s[76:77], s[76:77], vcc
    s_or_b64 s[72:73], s[72:73], s[90:91]
    s_or_b64 s[74:75], s[74:75], s[10:11]
    s_or_b64 s[76:77], s[76:77], s[10:11]
    s_or_b64 s[78:79], s[78:79], s[90:91]
    v_cndmask_b32 v136, 0, v146, s[72:73]
    v_lshl_add_u32 v136, v104, 2, v136
    ds_add_rtn_u32 v112, v136, v184 offset:5120
    v_cndmask_b32 v137, 0, v146, s[74:75]
    v_lshl_add_u32 v137, v105, 2, v137
    ds_add_rtn_u32 v113, v137, v184 offset:5120
    v_cndmask_b32 v138, 0, v146, s[76:77]
    v_lshl_add_u32 v138, v106, 2, v138
    ds_add_rtn_u32 v114, v138, v184 offset:5120
    v_cndmask_b32 v139, 0, v146, s[78:79]
    v_lshl_add_u32 v139, v107, 2, v139
    ds_add_rtn_u32 v115, v139, v184 offset:5120
    s_waitcnt vmcnt(0)
    v_mad_i32_i24 v128, v104, s65, v128
    v_mul_u32_u24 v194, s66, v96
    v_lshl_or_b32 v96, v128, 18, v96
    v_and_b32 v128, 0xe0, v104
    v_mad_i32_i24 v194, v128, s100, v194
    v_and_or_b32 v194, v194, s67, v144
    v_mad_u32_u24 v128, v104, 40, s69
    v_or_b32 v96, v96, v194
    v_mad_i32_i24 v129, v105, s65, v129
    v_mul_u32_u24 v194, s66, v97
    v_lshl_or_b32 v97, v129, 18, v97
    v_and_b32 v129, 0xe0, v105
    v_mad_i32_i24 v194, v129, s100, v194
    v_and_or_b32 v194, v194, s67, v144
    v_mad_u32_u24 v129, v105, 40, s69
    v_or_b32 v97, v97, v194
    s_waitcnt lgkmcnt(3)
    s_mov_b64 exec, s[72:73]
    v_cmpx_le_u32 vcc, 132, v112
    ds_add_rtn_u32 v112, v136, v184 offset:4096
    s_waitcnt lgkmcnt(3)
    s_mov_b64 exec, s[74:75]
    v_cmpx_le_u32 vcc, 132, v113
    ds_add_rtn_u32 v113, v137, v184 offset:4096
    s_waitcnt lgkmcnt(3)
    s_mov_b64 exec, s[76:77]
    v_cmpx_le_u32 vcc, 132, v114
    ds_add_rtn_u32 v114, v138, v184 offset:4096
    s_waitcnt lgkmcnt(3)
    s_mov_b64 exec, s[78:79]
    v_cmpx_le_u32 vcc, 132, v115
    ds_add_rtn_u32 v115, v139, v184 offset:4096
    s_mov_b64 exec, -1
    v_mad_i32_i24 v130, v106, s65, v130
    v_mul_u32_u24 v194, s66, v98
    v_lshl_or_b32 v98, v130, 18, v98
    v_and_b32 v130, 0xe0, v106
    v_mad_i32_i24 v194, v130, s100, v194
    v_and_or_b32 v194, v194, s67, v144
    v_mad_u32_u24 v130, v106, 40, s69
    v_or_b32 v98, v98, v194
    v_mad_i32_i24 v131, v107, s65, v131
    v_mul_u32_u24 v194, s66, v99
    v_lshl_or_b32 v99, v131, 18, v99
    v_and_b32 v131, 0xe0, v107
    v_mad_i32_i24 v194, v131, s100, v194
    v_and_or_b32 v194, v194, s67, v144
    v_mad_u32_u24 v131, v107, 40, s69
    v_or_b32 v99, v99, v194
    s_waitcnt lgkmcnt(3)
    v_bfe_u32 v194, v112, 3, 5
    v_add_lshl_u32 v128, v194, v128, 2
    v_and_b32 v194, 3, v194
    v_mad_i32_i24 v194, v194, -3, v128
    v_cmpx_gt_u32 vcc, 792, v112
    ds_write_b32 v128, v96
    ds_write_b8 v194, v120 offset:12
    s_mov_b64 exec, -1
    s_waitcnt lgkmcnt(4)
    v_bfe_u32 v194, v113, 3, 5
    v_add_lshl_u32 v129, v194, v129, 2
    v_and_b32 v194, 3, v194
    v_mad_i32_i24 v194, v194, -3, v129
    v_cmpx_gt_u32 vcc, 792, v113
    ds_write_b32 v129, v97
    ds_write_b8 v194, v121 offset:12
    s_mov_b64 exec, -1
    s_waitcnt lgkmcnt(5)
    v_bfe_u32 v194, v114, 3, 5
    v_add_lshl_u32 v130, v194, v130, 2
    v_and_b32 v194, 3, v194
    v_mad_i32_i24 v194, v194, -3, v130
    v_cmpx_gt_u32 vcc, 792, v114
    ds_write_b32 v130, v98
    ds_write_b8 v194, v122 offset:12
    s_mov_b64 exec, -1
    s_waitcnt lgkmcnt(6)
    v_bfe_u32 v194, v115, 3, 5
    v_add_lshl_u32 v131, v194, v131, 2
    v_and_b32 v194, 3, v194
    v_mad_i32_i24 v194, v194, -3, v131
    v_cmpx_gt_u32 vcc, 792, v115
    ds_write_b32 v131, v99
    ds_write_b8 v194, v123 offset:12
    s_mov_b64 exec, -1
L_B1:
    s_cmp_ge_u32 s3, 2
    s_cbranch_scc1 L_NOC
    global_load_dwordx4 v[176:179], v232, s[28:29]
L_NOC:
    global_load_dwordx4 v[160:163], v232, s[26:27]
    global_load_dwordx4 v[164:167], v232, s[32:33]
    global_load_dwordx4 v[168:171], v232, s[24:25]
    global_load_dwordx4 v[172:175], v232, s[30:31]
    s_add_u32 s6, s6, 0x2020202
    v_lshlrev_b32 v186, v246, s6
    v_and_b32 v189, 4, v253
    v_mul_u32_u24 v189, 1212416, v189
    v_lshl_add_u32 v186, v189, 8, v186
    v_and_b32 v186, 0xfe000000, v186
    v_and_b32 v187, 7, v253
    v_mul_u32_u24 v187, 33, v187
    v_add_u32 v187, 792, v187
    v_lshlrev_b32 v222, 2, v223
    s_mov_b32 s64, 0x1000000
    s_waitcnt lgkmcnt(0)
    s_barrier
    ds_read_b128 v[192:195], v185 offset:5120
    ds_read_b32 v228, v222 offset:5120
    ds_read_b128 v[204:207], v221 offset:0
    ds_read_b32 v229, v222 offset:5376
    ds_read_b128 v[208:211], v221 offset:10240
    ds_read_b32 v230, v222 offset:5632
    ds_read_b128 v[212:215], v221 offset:20480
    ds_read_b32 v231, v222 offset:5888
    ds_read_b128 v[216:219], v221 offset:30720
    s_mov_b32 s80, 2105344
    s_mov_b32 s81, 4210688
    s_mov_b32 s82, 6316032
    s_waitcnt lgkmcnt(8)
    v_max3_u32 v188, v192, v193, v194
    v_max_u32 v188, v188, v195
    v_cmp_lt_u32 vcc, 1056, v188
    s_cbranch_vccnz L_POVF
L_POUT:
    s_waitcnt lgkmcnt(7)
    v_sub_u32 v228, v187, v228
    v_and_or_b32 v228, v228, s64, v186
    s_waitcnt lgkmcnt(6)
    v_or_b32 v207, v207, v228
    buffer_store_dwordx4 v[204:207], v220, s[56:59], 0 offen sc1
    s_waitcnt lgkmcnt(5)
    v_sub_u32 v229, v187, v229
    v_and_or_b32 v229, v229, s64, v186
    s_waitcnt lgkmcnt(4)
    v_or_b32 v211, v211, v229
    buffer_store_dwordx4 v[208:211], v220, s[56:59], s80 offen sc1
    s_waitcnt lgkmcnt(3)
    v_sub_u32 v230, v187, v230
    v_and_or_b32 v230, v230, s64, v186
    s_waitcnt lgkmcnt(2)
    v_or_b32 v215, v215, v230
    buffer_store_dwordx4 v[212:215], v220, s[56:59], s81 offen sc1
    s_waitcnt lgkmcnt(1)
    v_sub_u32 v231, v187, v231
    v_and_or_b32 v231, v231, s64, v186
    s_waitcnt lgkmcnt(0)
    v_or_b32 v219, v219, v231
    buffer_store_dwordx4 v[216:219], v220, s[56:59], s82 offen sc1
    s_mov_b32 s10, 0xbfb8aa3b
    s_mov_b32 s11, s10
    s_mov_b32 s64, 0x05040100
    s_mov_b32 s66, 0x07060302
    s_waitcnt vmcnt(4)
    v_perm_b32 v144, v170, v168, s64
    v_perm_b32 v145, v170, v168, s66
    v_perm_b32 v146, v171, v169, s64
    v_perm_b32 v147, v171, v169, s66
    v_add_u32 v148, 77824, v224
    ds_write2_b32 v148, v144, v145 offset0:0 offset1:8
    ds_write2_b32 v148, v146, v147 offset0:16 offset1:24
    v_lshlrev_b32 v128, 16, v160
    v_and_b32 v129, 0xffff0000, v160
    v_lshlrev_b32 v130, 16, v161
    v_and_b32 v131, 0xffff0000, v161
    v_lshlrev_b32 v132, 16, v162
    v_and_b32 v133, 0xffff0000, v162
    v_lshlrev_b32 v134, 16, v163
    v_and_b32 v135, 0xffff0000, v163
    v_pk_mul_f32 v[128:129], v[128:129], s[10:11]
    v_pk_mul_f32 v[130:131], v[130:131], s[10:11]
    v_pk_mul_f32 v[132:133], v[132:133], s[10:11]
    v_pk_mul_f32 v[134:135], v[134:135], s[10:11]
    v_cvt_pk_bf16_f32 v136, v128, v132
    v_cvt_pk_bf16_f32 v137, v129, v133
    v_cvt_pk_bf16_f32 v138, v130, v134
    v_cvt_pk_bf16_f32 v139, v131, v135
    ds_write2_b32 v224, v136, v137 offset0:0 offset1:8
    ds_write2_b32 v224, v138, v139 offset0:16 offset1:24
    v_perm_b32 v152, v166, v164, s64
    v_perm_b32 v153, v166, v164, s66
    v_perm_b32 v154, v167, v165, s64
    v_perm_b32 v155, v167, v165, s66
    v_add_u32 v156, 10240, v224
    ds_write2_b32 v156, v152, v153 offset0:0 offset1:8
    ds_write2_b32 v156, v154, v155 offset0:16 offset1:24
    v_perm_b32 v144, v174, v172, s64
    v_perm_b32 v145, v174, v172, s66
    v_perm_b32 v146, v175, v173, s64
    v_perm_b32 v147, v175, v173, s66
    v_add_u32 v148, 130176, v224
    ds_write2_b32 v148, v144, v145 offset0:0 offset1:8
    ds_write2_b32 v148, v146, v147 offset0:16 offset1:24
    s_cmp_ge_u32 s3, 2
    s_cbranch_scc1 L_NOWC
    v_lshlrev_b32 v128, 16, v176
    v_and_b32 v129, 0xffff0000, v176
    v_lshlrev_b32 v130, 16, v177
    v_and_b32 v131, 0xffff0000, v177
    v_lshlrev_b32 v132, 16, v178
    v_and_b32 v133, 0xffff0000, v178
    v_lshlrev_b32 v134, 16, v179
    v_and_b32 v135, 0xffff0000, v179
    v_pk_mul_f32 v[128:129], v[128:129], s[10:11]
    v_pk_mul_f32 v[130:131], v[130:131], s[10:11]
    v_pk_mul_f32 v[132:133], v[132:133], s[10:11]
    v_pk_mul_f32 v[134:135], v[134:135], s[10:11]
    v_cvt_pk_bf16_f32 v136, v128, v132
    v_cvt_pk_bf16_f32 v137, v129, v133
    v_cvt_pk_bf16_f32 v138, v130, v134
    v_cvt_pk_bf16_f32 v139, v131, v135
    v_add_u32 v140, 20480, v224
    ds_write2_b32 v140, v136, v137 offset0:0 offset1:8
    ds_write2_b32 v140, v138, v139 offset0:16 offset1:24
L_NOWC:
    s_mul_i32 s34, s5, 32896
    s_add_u32 s34, s34, 65536
    s_add_u32 s56, s38, s34
    s_addc_u32 s57, s39, 0
    s_mov_b32 s58, 32768
    s_mov_b32 s59, 0x20000
    s_add_u32 s34, s34, 8421376
    s_add_u32 s60, s38, s34
    s_addc_u32 s61, s39, 0
    s_mov_b32 s62, 32768
    s_mov_b32 s63, 0x20000
    s_movk_i32 s26, 8192
    s_movk_i32 s27, 16384
    s_movk_i32 s28, 24576
    s_waitcnt lgkmcnt(0)
    s_barrier
    v_add_u32 v225, 13312, v225
    ds_read_b64_tr_b16 v[0:1], v225 offset:0
    ds_read_b64_tr_b16 v[2:3], v225 offset:1280
    ds_read_b64_tr_b16 v[4:5], v225 offset:5120
    ds_read_b64_tr_b16 v[6:7], v225 offset:6400
    ds_read_b64_tr_b16 v[8:9], v225 offset:32
    ds_read_b64_tr_b16 v[10:11], v225 offset:1312
    ds_read_b64_tr_b16 v[12:13], v225 offset:5152
    ds_read_b64_tr_b16 v[14:15], v225 offset:6432
    ds_read_b64_tr_b16 v[16:17], v225 offset:64
    ds_read_b64_tr_b16 v[18:19], v225 offset:1344
    ds_read_b64_tr_b16 v[20:21], v225 offset:5184
    ds_read_b64_tr_b16 v[22:23], v225 offset:6464
    ds_read_b64_tr_b16 v[24:25], v225 offset:96
    ds_read_b64_tr_b16 v[26:27], v225 offset:1376
    v_mov_b64 v[64:65], 0
    v_mov_b64 v[66:67], 0
    v_mov_b32 v68, 0x20fffff
    v_mov_b32 v69, 0x20fffff
    v_mov_b32 v70, 0x20fffff
    v_mov_b32 v71, 0x20fffff
    v_lshl_add_u32 v72, v253, 4, s12
    ds_write_b128 v72, v[64:67] offset:0
    ds_write_b128 v72, v[68:71] offset:18432
    ds_write_b128 v72, v[64:67] offset:1024
    ds_write_b128 v72, v[68:71] offset:19456
    ds_write_b128 v72, v[64:67] offset:1280
    ds_write_b128 v72, v[68:71] offset:19712
    ds_read_b64_tr_b16 v[28:29], v225 offset:5216
    ds_read_b64_tr_b16 v[30:31], v225 offset:6496
    ds_read_b64_tr_b16 v[32:33], v225 offset:10240
    ds_read_b64_tr_b16 v[34:35], v225 offset:11520
    ds_read_b64_tr_b16 v[36:37], v225 offset:15360
    ds_read_b64_tr_b16 v[38:39], v225 offset:16640
    ds_read_b64_tr_b16 v[40:41], v225 offset:10272
    ds_read_b64_tr_b16 v[42:43], v225 offset:11552
    ds_read_b64_tr_b16 v[44:45], v225 offset:15392
    ds_read_b64_tr_b16 v[46:47], v225 offset:16672
    v_mov_b32 v192, v225
    s_mov_b32 exec_lo, 0
    v_subrev_u32 v192, 2560, v225
    s_mov_b32 exec_lo, -1
    s_waitcnt lgkmcnt(4)
    ds_read_b64_tr_b16 v[48:49], v225 offset:10304
    ds_read_b64_tr_b16 v[50:51], v225 offset:11584
    ds_read_b64_tr_b16 v[52:53], v225 offset:15424
    ds_read_b64_tr_b16 v[54:55], v225 offset:16704
    ds_read_b64_tr_b16 v[56:57], v225 offset:10336
    ds_read_b64_tr_b16 v[58:59], v225 offset:11616
    ds_read_b64_tr_b16 v[60:61], v225 offset:15456
    ds_read_b64_tr_b16 v[62:63], v225 offset:16736
    ds_read_b64_tr_b16 v[80:81], v192 offset:20480
    ds_read_b64_tr_b16 v[82:83], v192 offset:21760
    ds_read_b64_tr_b16 v[84:85], v192 offset:20512
    ds_read_b64_tr_b16 v[86:87], v192 offset:21792
    ds_read_b64_tr_b16 v[88:89], v192 offset:20544
    ds_read_b64_tr_b16 v[90:91], v192 offset:21824
    ds_read_b64_tr_b16 v[92:93], v192 offset:20576
    ds_read_b64_tr_b16 v[94:95], v192 offset:21856
    v_add_u32 v225, 77824, v225
    v_and_b32 v241, 1, v253
    v_lshlrev_b32 v241, 4, v241
    v_mov_b32 v242, 0x3f80
    v_and_b32 v245, 16, v253
    v_and_b32 v194, 15, v253
    v_lshl_add_u32 v194, v194, 5, s14
    s_mov_b32 exec_hi, 0
    v_add_u32 v245, v245, v194
    s_mov_b32 exec_hi, -1
    v_and_b32 v194, 3, v253
    v_bfe_u32 v196, v253, 2, 2
    v_and_b32 v197, 48, v253
    v_lshl_add_u32 v198, v196, 7, v197
    v_mul_u32_u24 v244, 1056, v194
    v_add3_u32 v244, v244, v198, s13
    v_lshrrev_b32 v194, 3, v253
    v_lshl_add_u32 v247, v194, 4, s12
    s_add_u32 s10, s12, 18432
    v_lshrrev_b32 v194, 1, v253
    v_lshl_add_u32 v248, v194, 2, s10
    s_add_u32 s10, s10, 2
    v_and_b32 v194, 48, v253
    v_lshl_add_u32 v250, v194, 1, s10
    v_and_b32 v194, 12, v253
    v_add_u32 v250, v250, v194
    v_lshrrev_b32 v194, 5, v253
    v_mul_u32_u24 v249, 18432, v194
    v_and_b32 v194, 15, v253
    v_lshl_add_u32 v249, v194, 2, v249
    s_add_u32 s10, s12, 2
    v_add_u32 v249, s10, v249
    v_mul_u32_u24 v156, 3128, v223
    v_add_u32 v157, 200192, v156
    v_add_u32 v158, 400384, v156
    v_add_u32 v159, 600576, v156
    s_mov_b32 s98, 0xf0f0f0f
    s_mov_b32 s99, 0xf0f0f0f
    v_mov_b32 v180, 0xfffff
    v_cndmask_b32 v176, 0, v180, s[98:99]
    v_add_lshl_u32 v191, v232, v243, 16
    v_add_u32 v152, 0x34000000, v191
    v_cndmask_b32 v152, 0, v152, s[98:99]
    v_add_u32 v153, 0x54000000, v191
    v_cndmask_b32 v153, 0, v153, s[98:99]
    v_add_u32 v154, 0x74000000, v191
    v_cndmask_b32 v154, 0, v154, s[98:99]
    v_add_u32 v155, 0x94000000, v191
    v_cndmask_b32 v155, 0, v155, s[98:99]
    v_mov_b32 v184, 4
    v_and_b32 v177, 31, v253
    v_add_lshl_u32 v179, v177, s7, 2
    v_lshrrev_b32 v191, 5, v253
    v_lshl_add_u32 v178, v191, 11, v179
    v_add_u32 v179, 153728, v179
    v_lshlrev_b32 v191, 2, v253
    v_subrev_u32 v191, s7, v191
    s_mov_b32 s10, 0x10000
    v_add_u32 v228, 0, v191
    v_and_or_b32 v228, v228, s10, 1
    v_add_u32 v229, 1, v191
    v_and_or_b32 v229, v229, s10, 1
    v_add_u32 v230, 2, v191
    v_and_or_b32 v230, v230, s10, 1
    v_add_u32 v231, 3, v191
    v_and_or_b32 v231, v231, s10, 1
    s_movk_i32 s18, 0xffc
    s_movk_i32 s20, 32
    s_mov_b32 s21, 0
    s_mov_b32 s100, 0
    s_mov_b32 s16, 0x1ffffff
    s_mov_b32 s17, 0xffff
    s_mul_i32 s10, s4, 49
    s_sub_i32 s22, s10, 6
    s_ashr_i32 s22, s22, 1
    s_add_i32 s23, s10, 7
    s_ashr_i32 s23, s23, 1
    s_add_i32 s24, s10, 43
    s_ashr_i32 s24, s24, 1
    s_add_i32 s25, s22, 31
    s_cmp_eq_u32 s4, 7
    s_cselect_b32 s24, 196, s24
    s_cselect_b32 s25, 196, s25
    s_sub_i32 s23, s23, s7
    s_sub_i32 s24, s24, s7
    s_sub_i32 s25, s25, s7
    s_waitcnt vmcnt(0)
    buffer_load_dwordx4 v[128:131], v232, s[56:59], 0 offen sc1
    buffer_load_dwordx4 v[132:135], v232, s[56:59], s26 offen sc1
    buffer_load_dwordx4 v[136:139], v232, s[56:59], s27 offen sc1
    buffer_load_dwordx4 v[140:143], v232, s[56:59], s28 offen sc1
    v_max3_u32 v188, v112, v113, v114
    v_max3_u32 v189, v115, v116, v117
    v_max3_u32 v188, v188, v118, v119
    v_max_u32 v188, v188, v189
    v_cmp_le_u32 vcc, 792, v188
    s_cbranch_vccz L_PEXTR
    v_mov_b32 v65, s6
    s_lshl_b32 s34, s2, 7
    s_add_u32 s34, s34, 8486912
    v_subrev_u32 v68, 792, v112
    v_cmpx_gt_u32 vcc, 264, v68
    s_cbranch_execz L_PE0
    v_mov_b32 v64, v96
    v_mov_b32 v66, v120
    v_bfe_u32 v68, v112, 5, 3
    v_lshlrev_b32 v68, 4, v68
    v_mad_u32_u24 v68, v104, s68, v68
    buffer_store_dwordx4 v[64:67], v68, s[52:55], s34 offen sc1
L_PE0:
    s_mov_b64 exec, -1
    v_subrev_u32 v68, 792, v113
    v_cmpx_gt_u32 vcc, 264, v68
    s_cbranch_execz L_PE1
    v_mov_b32 v64, v97
    v_mov_b32 v66, v121
    v_bfe_u32 v68, v113, 5, 3
    v_lshlrev_b32 v68, 4, v68
    v_mad_u32_u24 v68, v105, s68, v68
    buffer_store_dwordx4 v[64:67], v68, s[52:55], s34 offen sc1
L_PE1:
    s_mov_b64 exec, -1
    v_subrev_u32 v68, 792, v114
    v_cmpx_gt_u32 vcc, 264, v68
    s_cbranch_execz L_PE2
    v_mov_b32 v64, v98
    v_mov_b32 v66, v122
    v_bfe_u32 v68, v114, 5, 3
    v_lshlrev_b32 v68, 4, v68
    v_mad_u32_u24 v68, v106, s68, v68
    buffer_store_dwordx4 v[64:67], v68, s[52:55], s34 offen sc1
L_PE2:
    s_mov_b64 exec, -1
    v_subrev_u32 v68, 792, v115
    v_cmpx_gt_u32 vcc, 264, v68
    s_cbranch_execz L_PE3
    v_mov_b32 v64, v99
    v_mov_b32 v66, v123
    v_bfe_u32 v68, v115, 5, 3
    v_lshlrev_b32 v68, 4, v68
    v_mad_u32_u24 v68, v107, s68, v68
    buffer_store_dwordx4 v[64:67], v68, s[52:55], s34 offen sc1
L_PE3:
    s_mov_b64 exec, -1
    v_subrev_u32 v68, 792, v116
    v_cmpx_gt_u32 vcc, 264, v68
    s_cbranch_execz L_PE4
    v_mov_b32 v64, v100
    v_mov_b32 v66, v120
    v_bfe_u32 v68, v116, 5, 3
    v_lshlrev_b32 v68, 4, v68
    v_mad_u32_u24 v68, v108, s68, v68
    buffer_store_dwordx4 v[64:67], v68, s[52:55], s34 offen sc1
L_PE4:
    s_mov_b64 exec, -1
    v_subrev_u32 v68, 792, v117
    v_cmpx_gt_u32 vcc, 264, v68
    s_cbranch_execz L_PE5
    v_mov_b32 v64, v101
    v_mov_b32 v66, v121
    v_bfe_u32 v68, v117, 5, 3
    v_lshlrev_b32 v68, 4, v68
    v_mad_u32_u24 v68, v109, s68, v68
    buffer_store_dwordx4 v[64:67], v68, s[52:55], s34 offen sc1
L_PE5:
    s_mov_b64 exec, -1
    v_subrev_u32 v68, 792, v118
    v_cmpx_gt_u32 vcc, 264, v68
    s_cbranch_execz L_PE6
    v_mov_b32 v64, v102
    v_mov_b32 v66, v122
    v_bfe_u32 v68, v118, 5, 3
    v_lshlrev_b32 v68, 4, v68
    v_mad_u32_u24 v68, v110, s68, v68
    buffer_store_dwordx4 v[64:67], v68, s[52:55], s34 offen sc1
L_PE6:
    s_mov_b64 exec, -1
    v_subrev_u32 v68, 792, v119
    v_cmpx_gt_u32 vcc, 264, v68
    s_cbranch_execz L_PE7
    v_mov_b32 v64, v103
    v_mov_b32 v66, v123
    v_bfe_u32 v68, v119, 5, 3
    v_lshlrev_b32 v68, 4, v68
    v_mad_u32_u24 v68, v111, s68, v68
    buffer_store_dwordx4 v[64:67], v68, s[52:55], s34 offen sc1
L_PE7:
    s_mov_b64 exec, -1
L_PEXTR:
L_PW0:
    s_waitcnt vmcnt(3)
    v_xor_b32 v188, v131, v186
    v_and_b32_sdwa v96, v128, s18 dst_sel:DWORD dst_unused:UNUSED_PAD src0_sel:WORD_1 src1_sel:DWORD
    v_and_b32_sdwa v97, v129, s18 dst_sel:DWORD dst_unused:UNUSED_PAD src0_sel:WORD_1 src1_sel:DWORD
    v_and_b32_sdwa v98, v130, s18 dst_sel:DWORD dst_unused:UNUSED_PAD src0_sel:WORD_1 src1_sel:DWORD
    v_cmp_lt_u32 vcc, s16, v188
    v_cmp_ne_u32 s[64:65], 0, v128
    v_cmp_ne_u32 s[66:67], 0, v129
    v_cmp_ne_u32 s[68:69], 0, v130
    s_cbranch_vccnz L_RT0
    s_mov_b64 exec, s[64:65]
    ds_add_rtn_u32 v112, v96, v184 offset:1024
    s_mov_b64 exec, s[66:67]
    ds_add_rtn_u32 v113, v97, v184 offset:1024
    s_mov_b64 exec, s[68:69]
    ds_add_rtn_u32 v114, v98, v184 offset:1024
    s_mov_b64 exec, -1
    v_add_u32_sdwa v207, v131, v156 dst_sel:DWORD dst_unused:UNUSED_PAD src0_sel:BYTE_0 src1_sel:DWORD
    v_lshrrev_b32 v189, 28, v128
    v_lshl_add_u32 v207, v189, 8, v207
    v_and_b32 v189, 60, v96
    v_lshl_add_u32 v204, v189, 19, v207
    v_add_u32_sdwa v205, v131, v156 dst_sel:DWORD dst_unused:UNUSED_PAD src0_sel:BYTE_1 src1_sel:DWORD
    v_lshrrev_b32 v189, 28, v129
    v_lshl_add_u32 v205, v189, 8, v205
    v_and_b32 v189, 60, v97
    v_lshl_add_u32 v205, v189, 19, v205
    v_add_u32_sdwa v206, v131, v156 dst_sel:DWORD dst_unused:UNUSED_PAD src0_sel:BYTE_2 src1_sel:DWORD
    v_lshrrev_b32 v189, 28, v130
    v_lshl_add_u32 v206, v189, 8, v206
    v_and_b32 v189, 60, v98
    v_lshl_add_u32 v206, v189, 19, v206
    v_cndmask_b32 v188, v180, v207, s[64:65]
    v_and_or_b32 v128, v128, s17, v152
    v_or_b32 v204, v204, v176
    v_mov_b32_dpp v189, v188 quad_perm:[2,2,3,3] row_mask:0xf bank_mask:0xf
    v_mov_b32_dpp v207, v188 quad_perm:[0,0,1,1] row_mask:0xf bank_mask:0xf
    v_and_b32 v130, s17, v130
    v_mov_b32_dpp v207, v189 row_shr:4 row_mask:0xf bank_mask:0xa
L_PW1:
    s_waitcnt vmcnt(2)
    v_xor_b32 v188, v135, v186
    v_and_b32_sdwa v100, v132, s18 dst_sel:DWORD dst_unused:UNUSED_PAD src0_sel:WORD_1 src1_sel:DWORD
    v_and_b32_sdwa v101, v133, s18 dst_sel:DWORD dst_unused:UNUSED_PAD src0_sel:WORD_1 src1_sel:DWORD
    v_and_b32_sdwa v102, v134, s18 dst_sel:DWORD dst_unused:UNUSED_PAD src0_sel:WORD_1 src1_sel:DWORD
    v_cmp_lt_u32 vcc, s16, v188
    v_cmp_ne_u32 s[72:73], 0, v132
    v_cmp_ne_u32 s[74:75], 0, v133
    v_cmp_ne_u32 s[76:77], 0, v134
    s_cbranch_vccnz L_RT1
    s_mov_b64 exec, s[72:73]
    ds_add_rtn_u32 v116, v100, v184 offset:1024
    s_mov_b64 exec, s[74:75]
    ds_add_rtn_u32 v117, v101, v184 offset:1024
    s_mov_b64 exec, s[76:77]
    ds_add_rtn_u32 v118, v102, v184 offset:1024
    s_mov_b64 exec, -1
    v_add_u32_sdwa v211, v135, v157 dst_sel:DWORD dst_unused:UNUSED_PAD src0_sel:BYTE_0 src1_sel:DWORD
    v_lshrrev_b32 v189, 28, v132
    v_lshl_add_u32 v211, v189, 8, v211
    v_and_b32 v189, 60, v100
    v_lshl_add_u32 v208, v189, 19, v211
    v_add_u32_sdwa v209, v135, v157 dst_sel:DWORD dst_unused:UNUSED_PAD src0_sel:BYTE_1 src1_sel:DWORD
    v_lshrrev_b32 v189, 28, v133
    v_lshl_add_u32 v209, v189, 8, v209
    v_and_b32 v189, 60, v101
    v_lshl_add_u32 v209, v189, 19, v209
    v_add_u32_sdwa v210, v135, v157 dst_sel:DWORD dst_unused:UNUSED_PAD src0_sel:BYTE_2 src1_sel:DWORD
    v_lshrrev_b32 v189, 28, v134
    v_lshl_add_u32 v210, v189, 8, v210
    v_and_b32 v189, 60, v102
    v_lshl_add_u32 v210, v189, 19, v210
    v_cndmask_b32 v188, v180, v211, s[72:73]
    v_and_or_b32 v132, v132, s17, v153
    v_or_b32 v208, v208, v176
    v_mov_b32_dpp v189, v188 quad_perm:[2,2,3,3] row_mask:0xf bank_mask:0xf
    v_mov_b32_dpp v211, v188 quad_perm:[0,0,1,1] row_mask:0xf bank_mask:0xf
    v_and_b32 v134, s17, v134
    v_mov_b32_dpp v211, v189 row_shr:4 row_mask:0xf bank_mask:0xa
L_PW2:
    s_waitcnt vmcnt(1)
    v_xor_b32 v188, v139, v186
    v_and_b32_sdwa v104, v136, s18 dst_sel:DWORD dst_unused:UNUSED_PAD src0_sel:WORD_1 src1_sel:DWORD
    v_and_b32_sdwa v105, v137, s18 dst_sel:DWORD dst_unused:UNUSED_PAD src0_sel:WORD_1 src1_sel:DWORD
    v_and_b32_sdwa v106, v138, s18 dst_sel:DWORD dst_unused:UNUSED_PAD src0_sel:WORD_1 src1_sel:DWORD
    v_cmp_lt_u32 vcc, s16, v188
    v_cmp_ne_u32 s[80:81], 0, v136
    v_cmp_ne_u32 s[82:83], 0, v137
    v_cmp_ne_u32 s[84:85], 0, v138
    s_cbranch_vccnz L_RT2
    s_mov_b64 exec, s[80:81]
    ds_add_rtn_u32 v120, v104, v184 offset:1024
    s_mov_b64 exec, s[82:83]
    ds_add_rtn_u32 v121, v105, v184 offset:1024
    s_mov_b64 exec, s[84:85]
    ds_add_rtn_u32 v122, v106, v184 offset:1024
    s_mov_b64 exec, -1
    v_add_u32_sdwa v215, v139, v158 dst_sel:DWORD dst_unused:UNUSED_PAD src0_sel:BYTE_0 src1_sel:DWORD
    v_lshrrev_b32 v189, 28, v136
    v_lshl_add_u32 v215, v189, 8, v215
    v_and_b32 v189, 60, v104
    v_lshl_add_u32 v212, v189, 19, v215
    v_add_u32_sdwa v213, v139, v158 dst_sel:DWORD dst_unused:UNUSED_PAD src0_sel:BYTE_1 src1_sel:DWORD
    v_lshrrev_b32 v189, 28, v137
    v_lshl_add_u32 v213, v189, 8, v213
    v_and_b32 v189, 60, v105
    v_lshl_add_u32 v213, v189, 19, v213
    v_add_u32_sdwa v214, v139, v158 dst_sel:DWORD dst_unused:UNUSED_PAD src0_sel:BYTE_2 src1_sel:DWORD
    v_lshrrev_b32 v189, 28, v138
    v_lshl_add_u32 v214, v189, 8, v214
    v_and_b32 v189, 60, v106
    v_lshl_add_u32 v214, v189, 19, v214
    v_cndmask_b32 v188, v180, v215, s[80:81]
    v_and_or_b32 v136, v136, s17, v154
    v_or_b32 v212, v212, v176
    v_mov_b32_dpp v189, v188 quad_perm:[2,2,3,3] row_mask:0xf bank_mask:0xf
    v_mov_b32_dpp v215, v188 quad_perm:[0,0,1,1] row_mask:0xf bank_mask:0xf
    v_and_b32 v138, s17, v138
    v_mov_b32_dpp v215, v189 row_shr:4 row_mask:0xf bank_mask:0xa
L_PW3:
    s_waitcnt vmcnt(0)
    v_xor_b32 v188, v143, v186
    v_and_b32_sdwa v108, v140, s18 dst_sel:DWORD dst_unused:UNUSED_PAD src0_sel:WORD_1 src1_sel:DWORD
    v_and_b32_sdwa v109, v141, s18 dst_sel:DWORD dst_unused:UNUSED_PAD src0_sel:WORD_1 src1_sel:DWORD
    v_and_b32_sdwa v110, v142, s18 dst_sel:DWORD dst_unused:UNUSED_PAD src0_sel:WORD_1 src1_sel:DWORD
    v_cmp_lt_u32 vcc, s16, v188
    v_cmp_ne_u32 s[88:89], 0, v140
    v_cmp_ne_u32 s[90:91], 0, v141
    v_cmp_ne_u32 s[92:93], 0, v142
    s_cbranch_vccnz L_RT3
    s_mov_b64 exec, s[88:89]
    ds_add_rtn_u32 v124, v108, v184 offset:1024
    s_mov_b64 exec, s[90:91]
    ds_add_rtn_u32 v125, v109, v184 offset:1024
    s_mov_b64 exec, s[92:93]
    ds_add_rtn_u32 v126, v110, v184 offset:1024
    s_mov_b64 exec, -1
    v_or3_b32 v190, v131, v135, v139
    v_or_b32 v190, v190, v143
    v_and_b32 v190, 0x1000000, v190
    v_cmp_ne_u32 vcc, 0, v190
    s_cbranch_vccz L_XT1R
    v_and_b32 v190, 0x1000000, v131
    v_cmp_ne_u32 s[70:71], 0, v190
    s_bcnt1_i32_b64 s10, s[70:71]
    s_lshl2_add_u32 s21, s10, s21
    v_and_b32 v190, 0x1000000, v135
    v_cmp_ne_u32 s[78:79], 0, v190
    s_bcnt1_i32_b64 s10, s[78:79]
    s_lshl2_add_u32 s21, s10, s21
    v_and_b32 v190, 0x1000000, v139
    v_cmp_ne_u32 s[86:87], 0, v190
    s_bcnt1_i32_b64 s10, s[86:87]
    s_lshl2_add_u32 s21, s10, s21
    v_and_b32 v190, 0x1000000, v143
    v_cmp_ne_u32 s[94:95], 0, v190
    s_bcnt1_i32_b64 s10, s[94:95]
    s_lshl2_add_u32 s21, s10, s21
    s_mov_b64 exec, s[70:71]
    s_cbranch_execz L_XLa0
    s_movk_i32 s10, 0
    buffer_load_dwordx4 v[64:67], v232, s[60:63], s10 offen sc1
L_XLa0:
    s_mov_b64 exec, s[78:79]
    s_cbranch_execz L_XLa1
    s_movk_i32 s10, 8192
    buffer_load_dwordx4 v[68:71], v232, s[60:63], s10 offen sc1
L_XLa1:
    s_mov_b64 exec, s[86:87]
    s_cbranch_execz L_XLa2
    s_movk_i32 s10, 16384
    buffer_load_dwordx4 v[72:75], v232, s[60:63], s10 offen sc1
L_XLa2:
    s_mov_b64 exec, s[94:95]
    s_cbranch_execz L_XLa3
    s_movk_i32 s10, 24576
    buffer_load_dwordx4 v[76:79], v232, s[60:63], s10 offen sc1
L_XLa3:
    s_mov_b64 exec, -1
    v_or3_b32 v190, v129, v133, v137
    v_or_b32 v190, v190, v141
    v_and_b32 v190, 0x10000, v190
    v_mov_b32 v191, 640
    v_cmpx_ne_u32 vcc, 0, v190
    ds_write_b32 v191, v184 offset:4
    s_mov_b64 exec, 1
    v_mov_b32 v190, s21
    ds_add_u32 v191, v190 offset:8
    s_mov_b64 exec, -1
L_XT1R:
    v_add_u32_sdwa v219, v143, v159 dst_sel:DWORD dst_unused:UNUSED_PAD src0_sel:BYTE_0 src1_sel:DWORD
    v_lshrrev_b32 v189, 28, v140
    v_lshl_add_u32 v219, v189, 8, v219
    v_and_b32 v189, 60, v108
    v_lshl_add_u32 v216, v189, 19, v219
    v_add_u32_sdwa v217, v143, v159 dst_sel:DWORD dst_unused:UNUSED_PAD src0_sel:BYTE_1 src1_sel:DWORD
    v_lshrrev_b32 v189, 28, v141
    v_lshl_add_u32 v217, v189, 8, v217
    v_and_b32 v189, 60, v109
    v_lshl_add_u32 v217, v189, 19, v217
    v_add_u32_sdwa v218, v143, v159 dst_sel:DWORD dst_unused:UNUSED_PAD src0_sel:BYTE_2 src1_sel:DWORD
    v_lshrrev_b32 v189, 28, v142
    v_lshl_add_u32 v218, v189, 8, v218
    v_and_b32 v189, 60, v110
    v_lshl_add_u32 v218, v189, 19, v218
    v_cndmask_b32 v188, v180, v219, s[88:89]
    v_and_or_b32 v140, v140, s17, v155
    v_or_b32 v216, v216, v176
    v_mov_b32_dpp v189, v188 quad_perm:[2,2,3,3] row_mask:0xf bank_mask:0xf
    v_mov_b32_dpp v219, v188 quad_perm:[0,0,1,1] row_mask:0xf bank_mask:0xf
    v_and_b32 v142, s17, v142
    v_mov_b32_dpp v219, v189 row_shr:4 row_mask:0xf bank_mask:0xa
    v_mov_b32 v197, 640
    s_cmp_eq_u32 s3, 6
    s_cselect_b32 exec_hi, 0, -1
    s_cmp_eq_u32 s3, 7
    s_cselect_b64 exec, 1, exec
    s_add_u32 m0, s101, 0
    s_nop 0
    buffer_load_dwordx4 v234, s[40:43], 0 offen offset:0 lds
    s_add_u32 m0, s101, 6560
    s_nop 0
    buffer_load_dwordx4 v234, s[40:43], 0 offen offset:128 lds
    s_add_u32 m0, s101, 13120
    s_nop 0
    buffer_load_dwordx4 v234, s[40:43], 0 offen offset:256 lds
    s_add_u32 m0, s101, 19680
    s_nop 0
    buffer_load_dwordx4 v234, s[40:43], 0 offen offset:384 lds
    s_mov_b64 exec, -1
    s_waitcnt lgkmcnt(0)
    s_barrier
    ds_read_u16 v198, v178 offset:1024
    ds_read_u16 v199, v178 offset:2048
    ds_read_b128 v[160:163], v185 offset:1024
    ds_read_b128 v[164:167], v185 offset:2048
    ds_read_b128 v[168:171], v185 offset:3072
    ds_read_b128 v[172:175], v185 offset:4096
    ds_read_b32 v236, v197 offset:8
    s_lshl_b32 m0, s3, 10
    v_mov_b32 v240, v207
    s_add_u32 m0, m0, 13312
    s_nop 0
    buffer_load_dwordx4 v[240:241], s[44:47], 0 idxen offen lds
    s_cmp_lg_u32 s2, 0
    s_cbranch_scc1 L_NOK
    v_mov_b32 v237, s6
    v_mov_b32 v238, 0
    buffer_store_dword v237, v238, s[52:55], 0 offen sc1
L_NOK:
    s_waitcnt lgkmcnt(5)
    v_lshl_or_b32 v198, v199, 16, v198
    v_mov_b32 v199, v198
    s_waitcnt lgkmcnt(0)
    v_add_u32_sdwa v188, v160, v164 dst_sel:DWORD dst_unused:UNUSED_PAD src0_sel:WORD_0 src1_sel:WORD_0
    v_add_u32_sdwa v192, v168, v172 dst_sel:DWORD dst_unused:UNUSED_PAD src0_sel:WORD_0 src1_sel:WORD_0
    v_add_u32_dpp v199, v199, v199 row_shr:1 row_mask:0xf bank_mask:0xf bound_ctrl:0
    v_add_u32_sdwa v189, v161, v165 dst_sel:DWORD dst_unused:UNUSED_PAD src0_sel:WORD_0 src1_sel:WORD_0
    v_add_u32_sdwa v193, v169, v173 dst_sel:DWORD dst_unused:UNUSED_PAD src0_sel:WORD_0 src1_sel:WORD_0
    v_add_u32_dpp v199, v199, v199 row_shr:2 row_mask:0xf bank_mask:0xf bound_ctrl:0
    v_add_u32_sdwa v190, v162, v166 dst_sel:DWORD dst_unused:UNUSED_PAD src0_sel:WORD_0 src1_sel:WORD_0
    v_add_u32_sdwa v194, v170, v174 dst_sel:DWORD dst_unused:UNUSED_PAD src0_sel:WORD_0 src1_sel:WORD_0
    v_add_u32_dpp v199, v199, v199 row_shr:4 row_mask:0xf bank_mask:0xf bound_ctrl:0
    v_add_u32_sdwa v191, v163, v167 dst_sel:DWORD dst_unused:UNUSED_PAD src0_sel:WORD_0 src1_sel:WORD_0
    v_add_u32_sdwa v195, v171, v175 dst_sel:DWORD dst_unused:UNUSED_PAD src0_sel:WORD_0 src1_sel:WORD_0
    v_add_u32_dpp v199, v199, v199 row_shr:8 row_mask:0xf bank_mask:0xf bound_ctrl:0
    v_add_u32 v188, v188, v192
    v_add_u32 v189, v189, v193
    v_add_u32_dpp v199, v199, v199 row_bcast:15 row_mask:0xa bank_mask:0xf
    v_add_u32 v190, v190, v194
    v_add_u32 v191, v191, v195
    v_mul_u32_u24 v196, v188, v228
    v_mad_u32_u24 v196, v189, v229, v196
    v_mad_u32_u24 v196, v190, v230, v196
    v_mad_u32_u24 v196, v191, v231, v196
    s_mov_b32 s96, -1
    s_mov_b32 s97, 0
    v_sub_u32 v200, v199, v198
    v_add_u32_sdwa v202, v199, v199 dst_sel:DWORD dst_unused:UNUSED_PAD src0_sel:WORD_0 src1_sel:WORD_1
    v_add_u32_dpp v196, v196, v196 row_shr:1 row_mask:0xf bank_mask:0xf bound_ctrl:0
    v_add_u32_sdwa v201, v200, v200 dst_sel:DWORD dst_unused:UNUSED_PAD src0_sel:WORD_0 src1_sel:WORD_1
    v_add_u32_sdwa v203, v198, v198 dst_sel:DWORD dst_unused:UNUSED_PAD src0_sel:WORD_0 src1_sel:WORD_1
    v_add_u32_dpp v196, v196, v196 row_shr:2 row_mask:0xf bank_mask:0xf bound_ctrl:0
    v_and_b32 v129, s17, v129
    v_readfirstlane_b32 s19, v236
    v_add_u32_dpp v196, v196, v196 row_shr:4 row_mask:0xf bank_mask:0xf bound_ctrl:0
    v_permlane32_swap_b32 v201, v202
    v_cndmask_b32 v203, 0, v203, s[96:97]
    v_add_u32_dpp v196, v196, v196 row_shr:8 row_mask:0xf bank_mask:0xf bound_ctrl:0
    v_add_u32 v201, v201, v202
    v_and_b32 v133, s17, v133
    v_add_u32_dpp v196, v196, v196 row_bcast:15 row_mask:0xa bank_mask:0xf
    v_add_u32 v202, v201, v203
    v_and_b32 v137, s17, v137
    v_add_u32_dpp v196, v196, v196 row_bcast:31 row_mask:0xc bank_mask:0xf
    v_sub_u32_sdwa v203, v202, v198 dst_sel:DWORD dst_unused:UNUSED_PAD src0_sel:DWORD src1_sel:WORD_1
    v_readlane_b32 s16, v196, 63
    s_lshl_b32 m0, s3, 10
    v_mov_b32 v240, v211
    s_add_u32 m0, m0, 21504
    s_nop 0
    buffer_load_dwordx4 v[240:241], s[44:47], 0 idxen offen lds
    s_bfe_u32 s10, s16, 0xe0002
    s_lshr_b32 s16, s16, 16
    s_lshr_b32 s11, s10, 1
    s_add_u32 s11, s11, 48
    s_and_b32 s11, s11, -128
    s_lshr_b32 s8, s4, 1
    s_mul_i32 s8, s8, s10
    s_sub_i32 s11, s11, 48
    s_sub_i32 s8, s8, s16
    s_add_i32 s11, s11, s8
    s_add_i32 s10, s10, s8
    s_bitcmp1_b32 s4, 0
    s_cselect_b32 s31, s11, s8
    s_cselect_b32 s10, s10, s11
    v_cmp_gt_i32 vcc, s31, v202
    v_cmp_gt_i32 s[34:35], s10, v202
    s_bcnt1_i32_b32 s22, vcc_lo
    s_bcnt1_i32_b32 s10, s34
    s_min_i32 s22, s22, s23
    s_max_i32 s10, s10, s24
    s_min_i32 s23, s10, s25
    v_readlane_b32 s16, v201, s22
    v_readlane_b32 s30, v201, s23
    s_add_u32 s8, s22, s7
    s_add_u32 s9, s23, s7
    s_add_u32 s10, s22, 32
    s_add_u32 s11, s23, 32
    v_readlane_b32 s26, v200, s22
    v_readlane_b32 s28, v200, s23
    v_readlane_b32 s27, v200, s10
    v_readlane_b32 s29, v200, s11
    s_sub_u32 s31, s30, s16
    s_add_u32 s10, s31, 255
    s_sub_i32 s11, s23, 16
    s_max_i32 s11, s11, s22
    v_readlane_b32 s11, v201, s11
    s_add_u32 vcc_lo, s31, 127
    s_and_b32 vcc_hi, vcc_lo, 127
    s_add_u32 vcc_hi, vcc_hi, s19
    s_cmp_lt_u32 vcc_hi, 55
    s_cselect_b32 vcc_lo, vcc_lo, s10
    s_sub_u32 s11, s11, s16
    s_add_u32 s11, s11, s19
    s_lshl_b32 s11, s11, 1
    s_and_b32 vcc_lo, vcc_lo, -256
    s_cmp_le_u32 s11, vcc_lo
    s_cselect_b32 s10, vcc_lo, s10
    s_lshr_b32 s10, s10, 8
    s_lshl_b32 s10, s10, 7
    s_sub_u32 s10, s10, s19
    s_max_i32 s10, s10, 0
    s_add_u32 s16, s16, s10
    s_add_u32 s10, s22, 16
    s_min_u32 s10, s10, s23
    s_sub_i32 s11, s23, 16
    v_cmp_ge_u32 s[34:35], s16, v203
    v_cmp_ge_u32 s[36:37], s16, v202
    v_cmp_gt_i32 vcc, s10, v177
    v_cmp_gt_i32 s[10:11], s11, v177
    v_cmp_le_u32 s[32:33], s22, v177
    v_cmp_gt_u32 s[96:97], s23, v177
    s_and_b64 s[34:35], s[34:35], vcc
    s_and_b64 s[36:37], s[36:37], vcc
    s_or_b64 s[34:35], s[34:35], s[10:11]
    s_or_b64 s[36:37], s[36:37], s[10:11]
    s_bcnt1_i32_b32 s24, s34
    s_bcnt1_i32_b32 s10, s36
    s_bcnt1_i32_b32 s11, s35
    s_bcnt1_i32_b32 s25, s37
    v_readlane_b32 s22, v200, s24
    v_readlane_b32 s10, v200, s10
    s_add_u32 s11, s11, 32
    s_add_u32 s16, s25, 32
    v_readlane_b32 s23, v200, s11
    v_readlane_b32 s11, v200, s16
    v_mov_b32 v188, s17
    v_cndmask_b32 v189, 0, v188, s[34:35]
    v_cndmask_b32 v188, 0, v188, s[36:37]
    s_and_b64 s[32:33], s[32:33], s[96:97]
    s_pack_lh_b32_b16 s22, s22, s10
    s_pack_lh_b32_b16 s23, s23, s11
    v_lshl_or_b32 v188, v188, 16, v189
    s_sub_u32 s16, s12, 37888
    s_pack_ll_b32_b16 s16, s16, s16
    s_sub_u32 s10, s22, s26
    s_sub_u32 s11, s23, s27
    s_mul_i32 s10, s10, 0x10001
    s_lshl_b32 vcc_lo, s10, 16
    s_pack_hh_b32_b16 s10, s10, s10
    s_lshl_b32 vcc_hi, s11, 16
    s_add_u32 vcc_hi, vcc_hi, s10
    s_add_u32 s96, vcc_hi, s11
    s_lshr_b32 s96, s96, 16
    s_sub_u32 s31, s31, s96
    s_cmp_gt_u32 s31, s96
    s_cselect_b32 s97, 0x4800480, 0
    s_add_u32 s16, s16, s97
    s_sub_u32 s10, s16, s26
    s_sub_u32 s11, s16, s27
    s_add_u32 s10, s10, vcc_lo
    s_add_u32 s11, s11, vcc_hi
    v_mov_b32 v192, s10
    v_mov_b32 v193, s11
    s_add_u32 s16, s16, 0x4800480
    s_sub_u32 s16, s16, s97
    s_sub_u32 s16, s16, s97
    s_sub_u32 s10, s28, s22
    s_sub_u32 s11, s29, s23
    s_mul_i32 s10, s10, 0x10001
    s_lshl_b32 vcc_lo, s10, 16
    s_pack_hh_b32_b16 s10, s10, s10
    s_lshl_b32 vcc_hi, s11, 16
    s_add_u32 vcc_hi, vcc_hi, s10
    s_sub_u32 s10, s16, s22
    s_sub_u32 s11, s16, s23
    s_add_u32 s10, s10, vcc_lo
    s_add_u32 s11, s11, vcc_hi
    v_mov_b32 v194, s10
    v_mov_b32 v195, s11
    v_bfi_b32 v192, v188, v192, v194
    v_bfi_b32 v193, v188, v193, v195
    s_mov_b32 exec_hi, 0
    v_mov_b32 v193, v192
    s_mov_b64 exec, s[32:33]
    v_add_u32 v200, v200, v193
    s_bfe_u32 s10, s97, 0x10007
    s_lshl1_add_u32 s10, s4, s10
    s_lshl_b32 s10, s10, 2
    v_cndmask_b32 v188, 4, 0, s[34:35]
    ds_write_b16 v178, v200 offset:1026
    ds_write_b16_d16_hi v178, v200 offset:2050
    s_mov_b32 exec_hi, 0
    v_xor_b32 v188, s10, v188
    ds_write_b32 v179, v188
    s_mov_b64 exec, -1
    s_min_u32 s10, s31, s96
    s_max_u32 s96, s31, s96
    s_mov_b32 s31, s10
    s_add_u32 s10, s96, s19
    s_mul_i32 s11, s30, 9216
    s_lshr_b32 s11, s11, 16
    s_max_u32 s10, s10, s11
    s_cmp_lt_u32 s10, 1152
    s_cbranch_scc1 L_LFIT
    ds_write_b32 v197, v184
L_LFIT:
    s_cmp_eq_u32 s19, 0
    s_cbranch_scc1 L_XCNR
    s_sub_u32 s10, s12, 37888
    s_add_u32 s11, s10, s96
    v_mov_b32 v188, s11
    s_add_u32 s11, s10, s31
    s_add_u32 s11, s11, 1152
    v_mov_b32 v189, s11
    s_lshl_b32 s10, s4, 3
    v_mov_b32 v190, s10
    ds_write_b64 v190, v[188:189] offset:576
L_XCNR:
    s_lshl_b32 m0, s3, 10
    v_mov_b32 v240, v215
    s_add_u32 m0, m0, 29696
    s_nop 0
    buffer_load_dwordx4 v[240:241], s[44:47], 0 idxen offen lds
    v_and_b32 v141, s17, v141
    s_waitcnt lgkmcnt(0)
    s_barrier
    ds_read_b64 v[202:203], v197
    ds_read_u16 v96, v96 offset:1026
    ds_read_u16 v97, v97 offset:1026
    ds_read_u16 v98, v98 offset:1026
    ds_read_u16 v100, v100 offset:1026
    ds_read_u16 v101, v101 offset:1026
    ds_read_u16 v102, v102 offset:1026
    ds_read_u16 v104, v104 offset:1026
    ds_read_u16 v105, v105 offset:1026
    ds_read_u16 v106, v106 offset:1026
    ds_read_u16 v108, v108 offset:1026
    ds_read_u16 v109, v109 offset:1026
    ds_read_u16 v110, v110 offset:1026
    s_lshl_b32 m0, s3, 10
    v_mov_b32 v240, v219
    s_add_u32 m0, m0, 37888
    s_nop 0
    buffer_load_dwordx4 v[240:241], s[44:47], 0 idxen offen lds
    s_add_u32 s24, s24, s7
    s_add_u32 s11, s25, s7
    s_and_b32 s10, s11, 15
    s_cmp_lt_u32 s11, s24
    s_cselect_b32 s25, s10, 16
    s_cmp_lg_u32 s97, 0
    s_cselect_b32 s23, s8, s11
    s_cselect_b32 s7, s8, s24
    s_cselect_b32 s8, s11, s8
    s_cselect_b32 s24, s9, s24
    s_cselect_b32 s9, s11, s9
    s_min_u32 s22, s8, 192
    s_min_u32 s23, s23, 192
    s_mov_b32 s30, s19
    s_waitcnt lgkmcnt(12)
    v_cmp_ne_u32 vcc, 0, v202
    v_readfirstlane_b32 s19, v203
    s_cbranch_vccnz L_OVF
    s_waitcnt lgkmcnt(9)
    s_mov_b64 exec, s[64:65]
    v_add_u32 v96, v96, v112
    ds_write2st64_b32 v96, v128, v204 offset0:148 offset1:220
    s_mov_b64 exec, s[66:67]
    v_add_u32 v97, v97, v113
    ds_write2st64_b32 v97, v129, v205 offset0:148 offset1:220
    s_mov_b64 exec, s[68:69]
    v_add_u32 v98, v98, v114
    ds_write2st64_b32 v98, v130, v206 offset0:148 offset1:220
    s_waitcnt lgkmcnt(9)
    s_mov_b64 exec, s[72:73]
    v_add_u32 v100, v100, v116
    ds_write2st64_b32 v100, v132, v208 offset0:148 offset1:220
    s_mov_b64 exec, s[74:75]
    v_add_u32 v101, v101, v117
    ds_write2st64_b32 v101, v133, v209 offset0:148 offset1:220
    s_mov_b64 exec, s[76:77]
    v_add_u32 v102, v102, v118
    ds_write2st64_b32 v102, v134, v210 offset0:148 offset1:220
    s_waitcnt lgkmcnt(9)
    s_mov_b64 exec, s[80:81]
    v_add_u32 v104, v104, v120
    ds_write2st64_b32 v104, v136, v212 offset0:148 offset1:220
    s_mov_b64 exec, s[82:83]
    v_add_u32 v105, v105, v121
    ds_write2st64_b32 v105, v137, v213 offset0:148 offset1:220
    s_mov_b64 exec, s[84:85]
    v_add_u32 v106, v106, v122
    ds_write2st64_b32 v106, v138, v214 offset0:148 offset1:220
    s_waitcnt lgkmcnt(9)
    s_mov_b64 exec, s[88:89]
    v_add_u32 v108, v108, v124
    ds_write2st64_b32 v108, v140, v216 offset0:148 offset1:220
    s_mov_b64 exec, s[90:91]
    v_add_u32 v109, v109, v125
    ds_write2st64_b32 v109, v141, v217 offset0:148 offset1:220
    s_mov_b64 exec, s[92:93]
    v_add_u32 v110, v110, v126
    ds_write2st64_b32 v110, v142, v218 offset0:148 offset1:220
    s_mov_b64 exec, -1
    s_add_u32 s10, s96, 127
    s_lshr_b32 s10, s10, 7
    s_lshl1_add_u32 s10, s10, -1
    s_add_u32 s11, s31, 127
    s_lshr_b32 s11, s11, 6
    s_and_b32 s11, s11, -2
    s_max_i32 s17, s10, s11
    s_cselect_b32 s10, s96, s31
    s_sub_u32 s10, s10, 1
    s_andn2_b32 s99, 64, s10
L_CA:
    ds_read_b64_tr_b16 v[96:97], v225 offset:0
    ds_read_b64_tr_b16 v[98:99], v225 offset:1280
    ds_read_b64_tr_b16 v[100:101], v225 offset:5120
    ds_read_b64_tr_b16 v[102:103], v225 offset:6400
    ds_read_b64_tr_b16 v[104:105], v225 offset:32
    ds_read_b64_tr_b16 v[106:107], v225 offset:1312
    ds_read_b64_tr_b16 v[108:109], v225 offset:5152
    ds_read_b64_tr_b16 v[110:111], v225 offset:6432
    ds_read_b64_tr_b16 v[112:113], v225 offset:64
    ds_read_b64_tr_b16 v[114:115], v225 offset:1344
    ds_read_b64_tr_b16 v[116:117], v225 offset:5184
    ds_read_b64_tr_b16 v[118:119], v225 offset:6464
    ds_read_b64_tr_b16 v[120:121], v225 offset:96
    ds_read_b64_tr_b16 v[122:123], v225 offset:1376
    ds_read_b64_tr_b16 v[124:125], v225 offset:5216
    ds_read_b64_tr_b16 v[126:127], v225 offset:6496
    s_cmp_eq_u32 s21, 0
    s_cbranch_scc1 L_XT2R
    s_waitcnt vmcnt(8)
L_XT2:
    s_mov_b64 s[34:35], 0
    v_cmp_ne_u32 vcc, s6, v65
    s_and_b64 vcc, vcc, s[70:71]
    s_or_b64 s[34:35], s[34:35], vcc
    v_cmp_ne_u32 vcc, s6, v69
    s_and_b64 vcc, vcc, s[78:79]
    s_or_b64 s[34:35], s[34:35], vcc
    v_cmp_ne_u32 vcc, s6, v73
    s_and_b64 vcc, vcc, s[86:87]
    s_or_b64 s[34:35], s[34:35], vcc
    v_cmp_ne_u32 vcc, s6, v77
    s_and_b64 vcc, vcc, s[94:95]
    s_or_b64 s[34:35], s[34:35], vcc
    s_cbranch_scc1 L_XT2B
    s_cmp_eq_u32 s20, 0
    s_cbranch_scc1 L_XT2R
    s_mov_b64 exec, s[70:71]
    s_cbranch_execz L_XS0
    v_bfe_u32 v65, v64, 18, 8
    v_lshlrev_b32 v65, 2, v65
    v_add_u32 v67, 153728, v65
    ds_read_b32 v67, v67
    v_add_u32_sdwa v66, v66, v156 dst_sel:DWORD dst_unused:UNUSED_PAD src0_sel:BYTE_0 src1_sel:DWORD
    v_lshrrev_b32 v189, 28, v64
    v_lshl_add_u32 v66, v189, 8, v66
    v_and_b32 v189, 60, v65
    v_lshl_add_u32 v66, v189, 19, v66
    v_and_b32 v64, 0xffff, v64
    s_waitcnt lgkmcnt(0)
    ds_add_rtn_u32 v67, v67, v184 offset:576
    s_waitcnt lgkmcnt(0)
    ds_write2st64_b32 v67, v64, v66 offset0:148 offset1:220
L_XS0:
    s_mov_b64 exec, s[78:79]
    s_cbranch_execz L_XS1
    v_bfe_u32 v69, v68, 18, 8
    v_lshlrev_b32 v69, 2, v69
    v_add_u32 v71, 153728, v69
    ds_read_b32 v71, v71
    v_add_u32_sdwa v70, v70, v157 dst_sel:DWORD dst_unused:UNUSED_PAD src0_sel:BYTE_0 src1_sel:DWORD
    v_lshrrev_b32 v189, 28, v68
    v_lshl_add_u32 v70, v189, 8, v70
    v_and_b32 v189, 60, v69
    v_lshl_add_u32 v70, v189, 19, v70
    v_and_b32 v68, 0xffff, v68
    s_waitcnt lgkmcnt(0)
    ds_add_rtn_u32 v71, v71, v184 offset:576
    s_waitcnt lgkmcnt(0)
    ds_write2st64_b32 v71, v68, v70 offset0:148 offset1:220
L_XS1:
    s_mov_b64 exec, s[86:87]
    s_cbranch_execz L_XS2
    v_bfe_u32 v73, v72, 18, 8
    v_lshlrev_b32 v73, 2, v73
    v_add_u32 v75, 153728, v73
    ds_read_b32 v75, v75
    v_add_u32_sdwa v74, v74, v158 dst_sel:DWORD dst_unused:UNUSED_PAD src0_sel:BYTE_0 src1_sel:DWORD
    v_lshrrev_b32 v189, 28, v72
    v_lshl_add_u32 v74, v189, 8, v74
    v_and_b32 v189, 60, v73
    v_lshl_add_u32 v74, v189, 19, v74
    v_and_b32 v72, 0xffff, v72
    s_waitcnt lgkmcnt(0)
    ds_add_rtn_u32 v75, v75, v184 offset:576
    s_waitcnt lgkmcnt(0)
    ds_write2st64_b32 v75, v72, v74 offset0:148 offset1:220
L_XS2:
    s_mov_b64 exec, s[94:95]
    s_cbranch_execz L_XS3
    v_bfe_u32 v77, v76, 18, 8
    v_lshlrev_b32 v77, 2, v77
    v_add_u32 v79, 153728, v77
    ds_read_b32 v79, v79
    v_add_u32_sdwa v78, v78, v159 dst_sel:DWORD dst_unused:UNUSED_PAD src0_sel:BYTE_0 src1_sel:DWORD
    v_lshrrev_b32 v189, 28, v76
    v_lshl_add_u32 v78, v189, 8, v78
    v_and_b32 v189, 60, v77
    v_lshl_add_u32 v78, v189, 19, v78
    v_and_b32 v76, 0xffff, v76
    s_waitcnt lgkmcnt(0)
    ds_add_rtn_u32 v79, v79, v184 offset:576
    s_waitcnt lgkmcnt(0)
    ds_write2st64_b32 v79, v76, v78 offset0:148 offset1:220
L_XS3:
    s_mov_b64 exec, -1
L_XT2R:
    s_lshl_b32 s34, s22, 5
    s_lshl_b32 s35, s23, 5
    s_mov_b32 vcc_lo, 0xff00ff00
    s_mov_b32 vcc_hi, 0xff00ff00
    v_mov_b32 v176, s35
    v_mov_b32 v177, s34
    v_cndmask_b32 v176, v176, v177, vcc
    v_and_b32 v177, 4, v253
    v_lshlrev_b32 v177, 6, v177
    v_lshl_add_u32 v177, v246, 2, v177
    v_sub_u32 v177, v177, v176
    v_and_b32 v178, 48, v253
    s_movk_i32 s34, 832
    v_mad_u32_u24 v178, v246, s34, v178
    s_mov_b32 s34, 116736
    v_add3_u32 v178, v178, v176, s34
    v_and_b32 v176, 0x1ff, v177
    v_add_u32 v176, v176, v178
    v_add_u32 v177, 0x80, v177
    v_and_b32 v177, 0x1ff, v177
    v_add_u32 v177, v177, v178
    v_mov_b64 v[184:185], 0
    v_mov_b64 v[186:187], 0
    v_lshrrev_b32 v188, 2, v253
    v_and_b32 v188, 12, v188
    v_subrev_u32 v188, s25, v188
    v_mov_b32 v189, 0x358637bd
    v_mfma_f32_32x32x16_bf16 v[144:159], v[184:187], v[184:187], 0
    v_cmp_ne_u32 s[80:81], 0, v188
    v_cmp_ne_u32 s[82:83], -1, v188
    v_cmp_ne_u32 s[84:85], -2, v188
    v_cmp_ne_u32 s[86:87], -3, v188
    v_cndmask_b32 v128, 0, v189, s[80:81]
    v_cndmask_b32 v129, 0, v189, s[82:83]
    v_cndmask_b32 v130, 0, v189, s[84:85]
    v_cndmask_b32 v131, 0, v189, s[86:87]
    v_mov_b64 v[132:133], v[128:129]
    v_mov_b64 v[134:135], v[130:131]
    v_mov_b64 v[136:137], v[128:129]
    v_mov_b64 v[138:139], v[130:131]
    v_mov_b64 v[140:141], v[128:129]
    v_mov_b64 v[142:143], v[130:131]
    s_cmp_ge_u32 s3, 4
    s_cbranch_scc1 L_EP0
    s_lshl_b32 s72, s4, 7
    s_add_u32 s72, s72, 157824
    v_mov_b32 v190, s22
    s_mov_b32 exec_lo, 0xffff0000
    v_mov_b32 v190, s23
    s_mov_b32 exec_lo, -1
    s_mov_b32 exec_hi, 0
    v_sub_u32 v191, v253, v190
    v_and_b32 v191, 15, v191
    v_add_lshl_u32 v191, v191, v190, 5
    v_lshl_add_u32 v190, v253, 2, s72
    ds_write_b32 v190, v191
    s_mov_b32 exec_hi, -1
    s_mul_i32 s10, s5, 196
    s_add_u32 s11, s10, s7
    s_add_u32 s62, s10, s9
    s_min_u32 s11, s11, 50000
    s_min_u32 s62, s62, 50000
    s_sub_u32 s62, s62, s11
    s_lshl_b32 s11, s11, 7
    s_lshl_b32 s62, s62, 7
    s_add_u32 s60, s48, s11
    s_addc_u32 s61, s49, 0
    s_mul_i32 s74, s7, -128
    s_add_u32 s11, s10, s8
    s_add_u32 s50, s10, s24
    s_min_u32 s11, s11, 50000
    s_min_u32 s50, s50, 50000
    s_sub_u32 s50, s50, s11
    s_lshl_b32 s11, s11, 7
    s_lshl_b32 s50, s50, 7
    s_add_u32 s48, s48, s11
    s_addc_u32 s49, s49, 0
    s_mul_i32 s73, s8, -128
    s_and_b32 s10, s25, 12
    s_lshl_b32 s10, s10, 2
    s_bfm_b64 s[76:77], 16, s10
L_EP0:
    s_waitcnt vmcnt(0) lgkmcnt(0)
    s_barrier
    s_mov_b32 s10, 0x358637bd
    ds_read_b128 v[236:239], v247
    ds_read_b32 v240, v248
    ds_read_b128 v[160:163], v176 offset:0
    ds_read_b128 v[164:167], v176 offset:64
    ds_read_b128 v[168:171], v177 offset:0
    ds_read_b128 v[172:175], v177 offset:64
    s_waitcnt lgkmcnt(4)
    s_cmp_ge_u32 s3, 4
    s_cbranch_scc1 L_LATE0
    s_add_u32 m0, s13, 0
    v_mad_u32_u16 v236, v236, s15, v243
    buffer_load_dwordx4 v236, s[40:43], 0 offen lds
    s_add_u32 m0, s13, 1056
    v_mad_u32_u16 v237, v237, s15, v243
    buffer_load_dwordx4 v237, s[40:43], 0 offen lds
    s_add_u32 m0, s13, 2112
    v_mad_u32_u16 v238, v238, s15, v243
    buffer_load_dwordx4 v238, s[40:43], 0 offen lds
    s_add_u32 m0, s13, 3168
    v_mad_u32_u16 v239, v239, s15, v243
    buffer_load_dwordx4 v239, s[40:43], 0 offen lds
    s_mov_b32 m0, s14
    v_and_b32 v240, 0xfffff, v240
    buffer_load_dwordx4 v[240:241], s[44:47], 0 idxen offen lds
L_LATE0:
    s_mov_b32 s34, 0xbfb8aa3b
    s_mov_b32 s35, s34
    s_waitcnt lgkmcnt(3)
    v_mfma_f32_16x16x32_bf16 v[204:207], v[160:163], v[96:99], 0
    v_mfma_f32_16x16x32_bf16 v[212:215], v[160:163], v[104:107], 0
    v_mfma_f32_16x16x32_bf16 v[220:223], v[160:163], v[112:115], 0
    v_mfma_f32_16x16x32_bf16 v[228:231], v[160:163], v[120:123], 0
    s_waitcnt lgkmcnt(2)
    v_mfma_f32_16x16x32_bf16 v[204:207], v[164:167], v[100:103], v[204:207]
    v_mfma_f32_16x16x32_bf16 v[212:215], v[164:167], v[108:111], v[212:215]
    v_mfma_f32_16x16x32_bf16 v[220:223], v[164:167], v[116:119], v[220:223]
    v_mfma_f32_16x16x32_bf16 v[228:231], v[164:167], v[124:127], v[228:231]
    s_waitcnt lgkmcnt(1)
    v_mfma_f32_16x16x32_bf16 v[208:211], v[168:171], v[96:99], 0
    v_mfma_f32_16x16x32_bf16 v[216:219], v[168:171], v[104:107], 0
    v_mfma_f32_16x16x32_bf16 v[224:227], v[168:171], v[112:115], 0
    v_mfma_f32_16x16x32_bf16 v[232:235], v[168:171], v[120:123], 0
    s_waitcnt lgkmcnt(0)
    v_mfma_f32_16x16x32_bf16 v[208:211], v[172:175], v[100:103], v[208:211]
    v_mfma_f32_16x16x32_bf16 v[216:219], v[172:175], v[108:111], v[216:219]
    v_mfma_f32_16x16x32_bf16 v[224:227], v[172:175], v[116:119], v[224:227]
    v_mfma_f32_16x16x32_bf16 v[232:235], v[172:175], v[124:127], v[232:235]
    s_mov_b32 s11, s10
    v_mov_b64 v[96:97], s[10:11]
    v_mov_b64 v[98:99], s[10:11]
    v_mov_b64 v[100:101], s[10:11]
    v_mov_b64 v[102:103], s[10:11]
    v_mov_b64 v[104:105], s[10:11]
    v_mov_b64 v[106:107], s[10:11]
    v_mov_b64 v[108:109], s[10:11]
    v_mov_b64 v[110:111], s[10:11]
    v_pk_mul_f32 v[204:205], v[204:205], s[34:35]
    v_pk_mul_f32 v[206:207], v[206:207], s[34:35]
    v_pk_mul_f32 v[208:209], v[208:209], s[34:35]
    v_pk_mul_f32 v[210:211], v[210:211], s[34:35]
    v_pk_mul_f32 v[212:213], v[212:213], s[34:35]
    v_pk_mul_f32 v[214:215], v[214:215], s[34:35]
    v_pk_mul_f32 v[216:217], v[216:217], s[34:35]
    v_pk_mul_f32 v[218:219], v[218:219], s[34:35]
    v_pk_mul_f32 v[220:221], v[220:221], s[34:35]
    v_pk_mul_f32 v[222:223], v[222:223], s[34:35]
    v_pk_mul_f32 v[224:225], v[224:225], s[34:35]
    v_pk_mul_f32 v[226:227], v[226:227], s[34:35]
    v_pk_mul_f32 v[228:229], v[228:229], s[34:35]
    v_pk_mul_f32 v[230:231], v[230:231], s[34:35]
    v_pk_mul_f32 v[232:233], v[232:233], s[34:35]
    v_pk_mul_f32 v[234:235], v[234:235], s[34:35]
    v_mfma_f32_32x32x16_bf16 v[112:127], v[184:187], v[184:187], 0
    v_cvt_pk_bf16_f32 v64, v204, v205
    v_cvt_pk_bf16_f32 v65, v206, v207
    v_cvt_pk_bf16_f32 v66, v208, v209
    v_cvt_pk_bf16_f32 v67, v210, v211
    v_cvt_pk_bf16_f32 v68, v212, v213
    v_cvt_pk_bf16_f32 v69, v214, v215
    v_cvt_pk_bf16_f32 v70, v216, v217
    v_cvt_pk_bf16_f32 v71, v218, v219
    v_cvt_pk_bf16_f32 v72, v220, v221
    v_cvt_pk_bf16_f32 v73, v222, v223
    v_cvt_pk_bf16_f32 v74, v224, v225
    v_cvt_pk_bf16_f32 v75, v226, v227
    v_cvt_pk_bf16_f32 v76, v228, v229
    v_cvt_pk_bf16_f32 v77, v230, v231
    v_cvt_pk_bf16_f32 v78, v232, v233
    v_cvt_pk_bf16_f32 v79, v234, v235
    v_permlane32_swap_b32 v80, v64
    v_permlane32_swap_b32 v81, v65
    v_permlane32_swap_b32 v82, v66
    v_permlane32_swap_b32 v83, v67
    v_permlane32_swap_b32 v84, v68
    v_permlane32_swap_b32 v85, v69
    v_permlane32_swap_b32 v86, v70
    v_permlane32_swap_b32 v87, v71
    v_permlane32_swap_b32 v88, v72
    v_permlane32_swap_b32 v89, v73
    v_permlane32_swap_b32 v90, v74
    v_permlane32_swap_b32 v91, v75
    v_permlane32_swap_b32 v92, v76
    v_permlane32_swap_b32 v93, v77
    v_permlane32_swap_b32 v94, v78
    v_permlane32_swap_b32 v95, v79
    s_mov_b32 s26, -1
    s_mov_b64 s[32:33], 0
    s_mov_b32 s28, 0
    s_mov_b32 s29, 0
    s_cmp_lt_u32 s3, 4
    s_cbranch_scc1 L_HAD0
    s_add_u32 m0, s13, 0
    v_mad_u32_u16 v236, v236, s15, v243
    buffer_load_dwordx4 v236, s[40:43], 0 offen lds
    s_add_u32 m0, s13, 1056
    v_mad_u32_u16 v237, v237, s15, v243
    buffer_load_dwordx4 v237, s[40:43], 0 offen lds
    s_add_u32 m0, s13, 2112
    v_mad_u32_u16 v238, v238, s15, v243
    buffer_load_dwordx4 v238, s[40:43], 0 offen lds
    s_add_u32 m0, s13, 3168
    v_mad_u32_u16 v239, v239, s15, v243
    buffer_load_dwordx4 v239, s[40:43], 0 offen lds
    s_mov_b32 m0, s14
    v_and_b32 v240, 0xfffff, v240
    buffer_load_dwordx4 v[240:241], s[44:47], 0 idxen offen lds
    s_lshl_b32 s72, s4, 7
    s_add_u32 s72, s72, 157824
    v_mov_b32 v190, s22
    s_mov_b32 exec_lo, 0xffff0000
    v_mov_b32 v190, s23
    s_mov_b32 exec_lo, -1
    s_mov_b32 exec_hi, 0
    v_sub_u32 v191, v253, v190
    v_and_b32 v191, 15, v191
    v_add_lshl_u32 v191, v191, v190, 5
    v_lshl_add_u32 v190, v253, 2, s72
    ds_write_b32 v190, v191
    s_mov_b32 exec_hi, -1
    s_mul_i32 s10, s5, 196
    s_add_u32 s11, s10, s7
    s_add_u32 s62, s10, s9
    s_min_u32 s11, s11, 50000
    s_min_u32 s62, s62, 50000
    s_sub_u32 s62, s62, s11
    s_lshl_b32 s11, s11, 7
    s_lshl_b32 s62, s62, 7
    s_add_u32 s60, s48, s11
    s_addc_u32 s61, s49, 0
    s_mul_i32 s74, s7, -128
    s_add_u32 s11, s10, s8
    s_add_u32 s50, s10, s24
    s_min_u32 s11, s11, 50000
    s_min_u32 s50, s50, 50000
    s_sub_u32 s50, s50, s11
    s_lshl_b32 s11, s11, 7
    s_lshl_b32 s50, s50, 7
    s_add_u32 s48, s48, s11
    s_addc_u32 s49, s49, 0
    s_mul_i32 s73, s8, -128
    s_and_b32 s10, s25, 12
    s_lshl_b32 s10, s10, 2
    s_bfm_b64 s[76:77], 16, s10
L_HAD0:
    s_cmp_eq_u32 s30, 0
    s_cbranch_scc1 L_GO
    s_lshl_b32 s10, s4, 3
    v_mov_b32 v188, s10
    ds_read_b64 v[188:189], v188 offset:576
    s_waitcnt lgkmcnt(0)
    v_readfirstlane_b32 s34, v188
    v_readfirstlane_b32 s35, v189
    s_sub_u32 s10, s12, 37888
    s_sub_u32 s34, s34, s10
    s_sub_u32 s35, s35, s10
    s_sub_u32 s35, s35, 1152
    s_add_u32 s10, s34, 127
    s_lshr_b32 s10, s10, 7
    s_lshl1_add_u32 s10, s10, -1
    s_add_u32 s11, s35, 127
    s_lshr_b32 s11, s11, 6
    s_and_b32 s11, s11, -2
    s_max_i32 s17, s10, s11
    s_cselect_b32 s10, s34, s35
    s_sub_u32 s10, s10, 1
    s_andn2_b32 s99, 64, s10
L_GO:
    ds_read_u16 v251, v249 offset:0
    ds_read_u16 v252, v249 offset:64
    ds_read_b128 v[236:239], v247 offset:1152
    ds_read_b32 v240, v248 offset:1152
    s_lshr_b32 s10, s4, 1
    s_lshl_b32 s10, s10, 9
    s_add_u32 s10, s10, 155776
    v_lshl_add_u32 v246, v253, 3, s10
    s_bitcmp1_b32 s4, 0
    s_cselect_b32 s101, -1, 1
    s_mul_i32 s10, s101, 0xff000000
    s_or_b32 s10, s10, 0xdddd
    v_mov_b32 v255, s10
    s_max_i32 s10, s17, 1
    s_sub_u32 s10, s10, 1
    s_mul_i32 s10, s101, s10
    s_lshl_b32 s10, s10, 24
    v_mov_b32 v188, s10
    ds_add_u32 v246, v188
    v_mov_b32 v253, 0
    s_mov_b32 exec_hi, 0
    v_add_u32 v253, 0x200, v245
    s_mov_b32 exec_hi, -1
    s_waitcnt lgkmcnt(0)
    v_bfi_b32 v251, 31, v245, v251
    v_bfi_b32 v252, 31, v245, v252
    v_max_u32 v251, v251, v245
    v_max_u32 v252, v252, v253
    s_waitcnt vmcnt(0)
    ds_read_b128 v[176:179], v251
    ds_read_b128 v[180:183], v252
    ds_read_b128 v[160:163], v244 offset:0
    ds_read_b128 v[168:171], v244 offset:512
    ds_read_b128 v[164:167], v244 offset:64
    ds_read_b128 v[172:175], v244 offset:576
    s_cmp_lt_i32 s17, 1
    s_cbranch_scc1 L_DONE
    s_waitcnt lgkmcnt(4)
    v_mfma_f32_16x16x32_bf16 v[188:191], v[176:179], v[64:67], 0
    v_mfma_f32_16x16x32_bf16 v[196:199], v[176:179], v[68:71], 0
    v_mfma_f32_16x16x32_bf16 v[192:195], v[180:183], v[64:67], 0
    v_mfma_f32_16x16x32_bf16 v[200:203], v[180:183], v[68:71], 0
    s_waitcnt lgkmcnt(0)
    v_mfma_f32_16x16x32_bf16 v[188:191], v[160:163], v[0:3], v[188:191]
    v_mfma_f32_16x16x32_bf16 v[196:199], v[160:163], v[8:11], v[196:199]
    v_mfma_f32_16x16x32_bf16 v[192:195], v[168:171], v[0:3], v[192:195]
    v_mfma_f32_16x16x32_bf16 v[200:203], v[168:171], v[8:11], v[200:203]
    v_mfma_f32_16x16x32_bf16 v[188:191], v[164:167], v[4:7], v[188:191]
    v_mfma_f32_16x16x32_bf16 v[196:199], v[164:167], v[12:15], v[196:199]
    v_mfma_f32_16x16x32_bf16 v[192:195], v[172:175], v[4:7], v[192:195]
    v_mfma_f32_16x16x32_bf16 v[200:203], v[172:175], v[12:15], v[200:203]
    s_mov_b32 s16, 1
    s_cmp_eq_u32 s17, 1
    s_cbranch_scc1 L_LT0
    s_add_u32 m0, s13, 0
    v_mad_u32_u16 v236, v236, s15, v243
    buffer_load_dwordx4 v236, s[40:43], 0 offen lds
    s_add_u32 m0, s13, 1056
    v_mad_u32_u16 v237, v237, s15, v243
    buffer_load_dwordx4 v237, s[40:43], 0 offen lds
    s_add_u32 m0, s13, 2112
    v_mad_u32_u16 v238, v238, s15, v243
    buffer_load_dwordx4 v238, s[40:43], 0 offen lds
    s_add_u32 m0, s13, 3168
    v_mad_u32_u16 v239, v239, s15, v243
    buffer_load_dwordx4 v239, s[40:43], 0 offen lds
    s_mov_b32 m0, s14
    v_and_b32 v240, 0xfffff, v240
    buffer_load_dwordx4 v[240:241], s[44:47], 0 idxen offen lds
.p2align 6
L_LOOP1:
    s_setprio 1
    v_smfmac_f32_16x16x64_bf16 v[152:155], v[184:187], v[204:211], v255
    ds_read_u16 v236, v250 offset:0
    ds_read_u16 v237, v250 offset:16
    ds_add_rtn_u32 v238, v246, v255
    v_exp_f32 v188, v188
    v_smfmac_f32_16x16x64_bf16 v[156:159], v[184:187], v[212:219], v255
    v_exp_f32 v189, v189
    v_mfma_f32_16x16x32_bf16 v[204:207], v[160:163], v[32:35], 0
    v_exp_f32 v190, v190
    v_mfma_f32_16x16x32_bf16 v[212:215], v[160:163], v[40:43], 0
    v_exp_f32 v191, v191
    v_mfma_f32_16x16x32_bf16 v[208:211], v[168:171], v[32:35], 0
    v_exp_f32 v192, v192
    v_mfma_f32_16x16x32_bf16 v[216:219], v[168:171], v[40:43], 0
    v_exp_f32 v193, v193
    v_mfma_f32_16x16x32_bf16 v[204:207], v[164:167], v[36:39], v[204:207]
    v_exp_f32 v194, v194
    v_mfma_f32_16x16x32_bf16 v[212:215], v[164:167], v[44:47], v[212:215]
    v_exp_f32 v195, v195
    v_mfma_f32_16x16x32_bf16 v[208:211], v[172:175], v[36:39], v[208:211]
    s_waitcnt lgkmcnt(0)
    v_bfi_b32 v236, 31, v246, v236
    v_bfi_b32 v237, 31, v246, v237
    v_readfirstlane_b32 s96, v238
    v_exp_f32 v196, v196
    v_mfma_f32_16x16x32_bf16 v[216:219], v[172:175], v[44:47], v[216:219]
    v_exp_f32 v197, v197
    v_smfmac_f32_16x16x64_bf16 v[136:139], v[184:187], v[220:227], v255
    v_exp_f32 v198, v198
    v_smfmac_f32_16x16x64_bf16 v[140:143], v[184:187], v[228:235], v255
    v_exp_f32 v199, v199
    v_mfma_f32_4x4x4_16b_bf16 v[188:191], v[242:243], v[242:243], v[188:191]
    v_exp_f32 v200, v200
    v_mfma_f32_4x4x4_16b_bf16 v[192:195], v[242:243], v[242:243], v[192:195]
    v_exp_f32 v201, v201
    v_mfma_f32_4x4x4_16b_bf16 v[196:199], v[242:243], v[242:243], v[196:199]
    v_exp_f32 v202, v202
    v_mfma_f32_16x16x32_bf16 v[220:223], v[176:179], v[72:75], 0
    ds_read_b64_tr_b16 v[184:185], v236
    ds_read_b64_tr_b16 v[186:187], v237
    ds_read_u16 v251, v249 offset:1152
    ds_read_u16 v252, v249 offset:1216
    v_exp_f32 v203, v203
    v_mfma_f32_16x16x32_bf16 v[228:231], v[176:179], v[76:79], 0
    s_ashr_i32 s96, s96, 24
    s_mul_i32 s96, s96, s101
    v_rcp_f32 v188, v188
    v_mfma_f32_16x16x32_bf16 v[224:227], v[180:183], v[72:75], 0
    v_rcp_f32 v189, v189
    v_mfma_f32_4x4x4_16b_bf16 v[200:203], v[242:243], v[242:243], v[200:203]
    v_rcp_f32 v190, v190
    v_mfma_f32_16x16x32_bf16 v[232:235], v[180:183], v[76:79], 0
    v_rcp_f32 v191, v191
    v_mfma_f32_16x16x32_bf16 v[220:223], v[160:163], v[16:19], v[220:223]
    v_rcp_f32 v192, v192
    v_mfma_f32_16x16x32_bf16 v[228:231], v[160:163], v[24:27], v[228:231]
    v_rcp_f32 v193, v193
    v_mfma_f32_16x16x32_bf16 v[224:227], v[168:171], v[16:19], v[224:227]
    s_waitcnt lgkmcnt(0)
    v_bfi_b32 v251, 31, v245, v251
    v_bfi_b32 v252, 31, v245, v252
    v_max_u32 v251, v251, v245
    v_max_u32 v252, v252, v253
    ds_read_b128 v[236:239], v247 offset:128
    ds_read_b32 v240, v248 offset:128
    s_add_u32 s16, s16, 1
    v_rcp_f32 v194, v194
    v_mfma_f32_16x16x32_bf16 v[232:235], v[168:171], v[24:27], v[232:235]
    v_rcp_f32 v195, v195
    v_mfma_f32_16x16x32_bf16 v[220:223], v[164:167], v[20:23], v[220:223]
    v_rcp_f32 v196, v196
    v_mfma_f32_16x16x32_bf16 v[228:231], v[164:167], v[28:31], v[228:231]
    v_rcp_f32 v197, v197
    s_setprio 3
    v_mfma_f32_16x16x32_bf16 v[224:227], v[172:175], v[20:23], v[224:227]
    v_rcp_f32 v198, v198
    v_mfma_f32_16x16x32_bf16 v[232:235], v[172:175], v[28:31], v[232:235]
    v_rcp_f32 v199, v199
    v_rcp_f32 v200, v200
    v_rcp_f32 v201, v201
    v_rcp_f32 v202, v202
    v_rcp_f32 v203, v203
    v_pk_mul_f32 v[204:205], v[188:189], v[204:205]
    v_pk_mul_f32 v[206:207], v[190:191], v[206:207]
    v_pk_mul_f32 v[208:209], v[192:193], v[208:209]
    v_pk_mul_f32 v[210:211], v[194:195], v[210:211]
    v_pk_mul_f32 v[212:213], v[196:197], v[212:213]
    v_pk_mul_f32 v[214:215], v[198:199], v[214:215]
    v_pk_mul_f32 v[216:217], v[200:201], v[216:217]
    v_pk_mul_f32 v[218:219], v[202:203], v[218:219]
    s_cmp_ge_i32 s96, 1
    s_cbranch_scc0 L_PB00
L_PB01:
    s_setprio 1
    v_smfmac_f32_16x16x64_bf16 v[112:115], v[184:187], v[204:211], v255
    v_exp_f32 v220, v220
    v_smfmac_f32_16x16x64_bf16 v[116:119], v[184:187], v[212:219], v255
    v_exp_f32 v221, v221
    s_waitcnt vmcnt(0)
    ds_read_b128 v[176:179], v251
    ds_read_b128 v[180:183], v252
    v_mfma_f32_16x16x32_bf16 v[204:207], v[160:163], v[48:51], 0
    v_exp_f32 v222, v222
    v_mfma_f32_16x16x32_bf16 v[212:215], v[160:163], v[56:59], 0
    ds_read_b128 v[160:163], v244 offset:0
    v_exp_f32 v223, v223
    v_mfma_f32_16x16x32_bf16 v[208:211], v[168:171], v[48:51], 0
    v_exp_f32 v224, v224
    v_mfma_f32_16x16x32_bf16 v[216:219], v[168:171], v[56:59], 0
    ds_read_b128 v[168:171], v244 offset:512
    v_exp_f32 v225, v225
    v_mfma_f32_16x16x32_bf16 v[204:207], v[164:167], v[52:55], v[204:207]
    v_exp_f32 v226, v226
    v_mfma_f32_16x16x32_bf16 v[212:215], v[164:167], v[60:63], v[212:215]
    ds_read_b128 v[164:167], v244 offset:64
    v_exp_f32 v227, v227
    v_mfma_f32_16x16x32_bf16 v[208:211], v[172:175], v[52:55], v[208:211]
    v_exp_f32 v228, v228
    v_mfma_f32_16x16x32_bf16 v[216:219], v[172:175], v[60:63], v[216:219]
    ds_read_b128 v[172:175], v244 offset:576
    v_exp_f32 v229, v229
    v_smfmac_f32_16x16x64_bf16 v[96:99], v[184:187], v[188:195], v255
    v_exp_f32 v230, v230
    v_smfmac_f32_16x16x64_bf16 v[100:103], v[184:187], v[196:203], v255
    v_exp_f32 v231, v231
    v_mfma_f32_4x4x4_16b_bf16 v[220:223], v[242:243], v[242:243], v[220:223]
    v_exp_f32 v232, v232
    v_mfma_f32_4x4x4_16b_bf16 v[224:227], v[242:243], v[242:243], v[224:227]
    v_exp_f32 v233, v233
    v_mfma_f32_4x4x4_16b_bf16 v[228:231], v[242:243], v[242:243], v[228:231]
    v_exp_f32 v234, v234
    s_waitcnt lgkmcnt(4)
    v_mfma_f32_16x16x32_bf16 v[188:191], v[176:179], v[80:83], 0
    v_exp_f32 v235, v235
    v_mfma_f32_16x16x32_bf16 v[196:199], v[176:179], v[84:87], 0
    v_rcp_f32 v220, v220
    v_mfma_f32_16x16x32_bf16 v[192:195], v[180:183], v[80:83], 0
    v_rcp_f32 v221, v221
    v_mfma_f32_4x4x4_16b_bf16 v[232:235], v[242:243], v[242:243], v[232:235]
    v_rcp_f32 v222, v222
    v_mfma_f32_16x16x32_bf16 v[200:203], v[180:183], v[84:87], 0
    v_rcp_f32 v223, v223
    s_waitcnt lgkmcnt(3)
    v_mfma_f32_16x16x32_bf16 v[188:191], v[160:163], v[0:3], v[188:191]
    v_rcp_f32 v224, v224
    v_mfma_f32_16x16x32_bf16 v[196:199], v[160:163], v[8:11], v[196:199]
    v_rcp_f32 v225, v225
    s_waitcnt lgkmcnt(2)
    v_mfma_f32_16x16x32_bf16 v[192:195], v[168:171], v[0:3], v[192:195]
    v_rcp_f32 v226, v226
    v_mfma_f32_16x16x32_bf16 v[200:203], v[168:171], v[8:11], v[200:203]
    v_rcp_f32 v227, v227
    s_waitcnt lgkmcnt(1)
    v_mfma_f32_16x16x32_bf16 v[188:191], v[164:167], v[4:7], v[188:191]
    v_rcp_f32 v228, v228
    v_mfma_f32_16x16x32_bf16 v[196:199], v[164:167], v[12:15], v[196:199]
    v_rcp_f32 v229, v229
    s_setprio 3
    s_waitcnt lgkmcnt(0)
    v_mfma_f32_16x16x32_bf16 v[192:195], v[172:175], v[4:7], v[192:195]
    s_cmp_lt_u32 s16, s17
    s_cbranch_scc0 L_ND01
    s_add_u32 m0, s13, 0
    v_mad_u32_u16 v236, v236, s15, v243
    buffer_load_dwordx4 v236, s[40:43], 0 offen lds
    s_add_u32 m0, s13, 1056
    v_mad_u32_u16 v237, v237, s15, v243
    buffer_load_dwordx4 v237, s[40:43], 0 offen lds
    s_add_u32 m0, s13, 2112
    v_mad_u32_u16 v238, v238, s15, v243
    buffer_load_dwordx4 v238, s[40:43], 0 offen lds
    s_add_u32 m0, s13, 3168
    v_mad_u32_u16 v239, v239, s15, v243
    buffer_load_dwordx4 v239, s[40:43], 0 offen lds
    s_mov_b32 m0, s14
    v_and_b32 v240, 0xfffff, v240
    buffer_load_dwordx4 v[240:241], s[44:47], 0 idxen offen lds
L_ND01:
    v_rcp_f32 v230, v230
    v_mfma_f32_16x16x32_bf16 v[200:203], v[172:175], v[12:15], v[200:203]
    v_rcp_f32 v231, v231
    v_rcp_f32 v232, v232
    v_rcp_f32 v233, v233
    v_rcp_f32 v234, v234
    v_rcp_f32 v235, v235
    v_pk_mul_f32 v[204:205], v[220:221], v[204:205]
    v_pk_mul_f32 v[206:207], v[222:223], v[206:207]
    v_pk_mul_f32 v[208:209], v[224:225], v[208:209]
    v_pk_mul_f32 v[210:211], v[226:227], v[210:211]
    v_pk_mul_f32 v[212:213], v[228:229], v[212:213]
    v_pk_mul_f32 v[214:215], v[230:231], v[214:215]
    v_pk_mul_f32 v[216:217], v[232:233], v[216:217]
    v_pk_mul_f32 v[218:219], v[234:235], v[218:219]
    s_cmp_ge_u32 s16, s17
    s_cbranch_scc1 L_LT1
    s_setprio 1
    v_smfmac_f32_16x16x64_bf16 v[120:123], v[184:187], v[204:211], v255
    ds_read_u16 v236, v250 offset:1152
    ds_read_u16 v237, v250 offset:1168
    ds_add_rtn_u32 v238, v246, v255
    v_exp_f32 v188, v188
    v_smfmac_f32_16x16x64_bf16 v[124:127], v[184:187], v[212:219], v255
    v_exp_f32 v189, v189
    v_mfma_f32_16x16x32_bf16 v[204:207], v[160:163], v[32:35], 0
    v_exp_f32 v190, v190
    v_mfma_f32_16x16x32_bf16 v[212:215], v[160:163], v[40:43], 0
    v_exp_f32 v191, v191
    v_mfma_f32_16x16x32_bf16 v[208:211], v[168:171], v[32:35], 0
    v_exp_f32 v192, v192
    v_mfma_f32_16x16x32_bf16 v[216:219], v[168:171], v[40:43], 0
    v_exp_f32 v193, v193
    v_mfma_f32_16x16x32_bf16 v[204:207], v[164:167], v[36:39], v[204:207]
    v_exp_f32 v194, v194
    v_mfma_f32_16x16x32_bf16 v[212:215], v[164:167], v[44:47], v[212:215]
    v_exp_f32 v195, v195
    v_mfma_f32_16x16x32_bf16 v[208:211], v[172:175], v[36:39], v[208:211]
    s_waitcnt lgkmcnt(0)
    v_bfi_b32 v236, 31, v246, v236
    v_bfi_b32 v237, 31, v246, v237
    v_readfirstlane_b32 s96, v238
    v_exp_f32 v196, v196
    v_mfma_f32_16x16x32_bf16 v[216:219], v[172:175], v[44:47], v[216:219]
    v_exp_f32 v197, v197
    v_smfmac_f32_16x16x64_bf16 v[104:107], v[184:187], v[220:227], v255
    v_exp_f32 v198, v198
    v_smfmac_f32_16x16x64_bf16 v[108:111], v[184:187], v[228:235], v255
    v_exp_f32 v199, v199
    v_mfma_f32_4x4x4_16b_bf16 v[188:191], v[242:243], v[242:243], v[188:191]
    v_exp_f32 v200, v200
    v_mfma_f32_4x4x4_16b_bf16 v[192:195], v[242:243], v[242:243], v[192:195]
    v_exp_f32 v201, v201
    v_mfma_f32_4x4x4_16b_bf16 v[196:199], v[242:243], v[242:243], v[196:199]
    v_exp_f32 v202, v202
    v_mfma_f32_16x16x32_bf16 v[220:223], v[176:179], v[88:91], 0
    ds_read_b64_tr_b16 v[184:185], v236
    ds_read_b64_tr_b16 v[186:187], v237
    ds_read_u16 v251, v249 offset:128
    ds_read_u16 v252, v249 offset:192
    v_exp_f32 v203, v203
    v_mfma_f32_16x16x32_bf16 v[228:231], v[176:179], v[92:95], 0
    s_ashr_i32 s96, s96, 24
    s_mul_i32 s96, s96, s101
    v_rcp_f32 v188, v188
    v_mfma_f32_16x16x32_bf16 v[224:227], v[180:183], v[88:91], 0
    v_rcp_f32 v189, v189
    v_mfma_f32_4x4x4_16b_bf16 v[200:203], v[242:243], v[242:243], v[200:203]
    v_rcp_f32 v190, v190
    v_mfma_f32_16x16x32_bf16 v[232:235], v[180:183], v[92:95], 0
    v_rcp_f32 v191, v191
    v_mfma_f32_16x16x32_bf16 v[220:223], v[160:163], v[16:19], v[220:223]
    v_rcp_f32 v192, v192
    v_mfma_f32_16x16x32_bf16 v[228:231], v[160:163], v[24:27], v[228:231]
    v_rcp_f32 v193, v193
    v_mfma_f32_16x16x32_bf16 v[224:227], v[168:171], v[16:19], v[224:227]
    s_waitcnt lgkmcnt(0)
    v_bfi_b32 v251, 31, v245, v251
    v_bfi_b32 v252, 31, v245, v252
    v_max_u32 v251, v251, v245
    v_max_u32 v252, v252, v253
    ds_read_b128 v[236:239], v247 offset:1280
    ds_read_b32 v240, v248 offset:1280
    s_add_u32 s16, s16, 1
    v_rcp_f32 v194, v194
    v_mfma_f32_16x16x32_bf16 v[232:235], v[168:171], v[24:27], v[232:235]
    v_add_u32 v247, 0x80, v247
    v_add_u32 v248, 0x80, v248
    v_add_u32 v249, 0x80, v249
    v_add_u32 v250, 0x80, v250
    v_rcp_f32 v195, v195
    v_mfma_f32_16x16x32_bf16 v[220:223], v[164:167], v[20:23], v[220:223]
    v_rcp_f32 v196, v196
    v_mfma_f32_16x16x32_bf16 v[228:231], v[164:167], v[28:31], v[228:231]
    v_rcp_f32 v197, v197
    s_setprio 3
    v_mfma_f32_16x16x32_bf16 v[224:227], v[172:175], v[20:23], v[224:227]
    v_rcp_f32 v198, v198
    v_mfma_f32_16x16x32_bf16 v[232:235], v[172:175], v[28:31], v[232:235]
    v_rcp_f32 v199, v199
    v_rcp_f32 v200, v200
    v_rcp_f32 v201, v201
    v_rcp_f32 v202, v202
    v_rcp_f32 v203, v203
    v_pk_mul_f32 v[204:205], v[188:189], v[204:205]
    v_pk_mul_f32 v[206:207], v[190:191], v[206:207]
    v_pk_mul_f32 v[208:209], v[192:193], v[208:209]
    v_pk_mul_f32 v[210:211], v[194:195], v[210:211]
    v_pk_mul_f32 v[212:213], v[196:197], v[212:213]
    v_pk_mul_f32 v[214:215], v[198:199], v[214:215]
    v_pk_mul_f32 v[216:217], v[200:201], v[216:217]
    v_pk_mul_f32 v[218:219], v[202:203], v[218:219]
    s_cmp_ge_i32 s96, 1
    s_cbranch_scc0 L_PB10
L_PB11:
    s_setprio 1
    v_smfmac_f32_16x16x64_bf16 v[144:147], v[184:187], v[204:211], v255
    v_exp_f32 v220, v220
    v_smfmac_f32_16x16x64_bf16 v[148:151], v[184:187], v[212:219], v255
    v_exp_f32 v221, v221
    s_waitcnt vmcnt(0)
    ds_read_b128 v[176:179], v251
    ds_read_b128 v[180:183], v252
    v_mfma_f32_16x16x32_bf16 v[204:207], v[160:163], v[48:51], 0
    v_exp_f32 v222, v222
    v_mfma_f32_16x16x32_bf16 v[212:215], v[160:163], v[56:59], 0
    ds_read_b128 v[160:163], v244 offset:0
    v_exp_f32 v223, v223
    v_mfma_f32_16x16x32_bf16 v[208:211], v[168:171], v[48:51], 0
    v_exp_f32 v224, v224
    v_mfma_f32_16x16x32_bf16 v[216:219], v[168:171], v[56:59], 0
    ds_read_b128 v[168:171], v244 offset:512
    v_exp_f32 v225, v225
    v_mfma_f32_16x16x32_bf16 v[204:207], v[164:167], v[52:55], v[204:207]
    v_exp_f32 v226, v226
    v_mfma_f32_16x16x32_bf16 v[212:215], v[164:167], v[60:63], v[212:215]
    ds_read_b128 v[164:167], v244 offset:64
    v_exp_f32 v227, v227
    v_mfma_f32_16x16x32_bf16 v[208:211], v[172:175], v[52:55], v[208:211]
    v_exp_f32 v228, v228
    v_mfma_f32_16x16x32_bf16 v[216:219], v[172:175], v[60:63], v[216:219]
    ds_read_b128 v[172:175], v244 offset:576
    v_exp_f32 v229, v229
    v_smfmac_f32_16x16x64_bf16 v[128:131], v[184:187], v[188:195], v255
    v_exp_f32 v230, v230
    v_smfmac_f32_16x16x64_bf16 v[132:135], v[184:187], v[196:203], v255
    v_exp_f32 v231, v231
    v_mfma_f32_4x4x4_16b_bf16 v[220:223], v[242:243], v[242:243], v[220:223]
    v_exp_f32 v232, v232
    v_mfma_f32_4x4x4_16b_bf16 v[224:227], v[242:243], v[242:243], v[224:227]
    v_exp_f32 v233, v233
    v_mfma_f32_4x4x4_16b_bf16 v[228:231], v[242:243], v[242:243], v[228:231]
    v_exp_f32 v234, v234
    s_waitcnt lgkmcnt(4)
    v_mfma_f32_16x16x32_bf16 v[188:191], v[176:179], v[64:67], 0
    v_exp_f32 v235, v235
    v_mfma_f32_16x16x32_bf16 v[196:199], v[176:179], v[68:71], 0
    v_rcp_f32 v220, v220
    v_mfma_f32_16x16x32_bf16 v[192:195], v[180:183], v[64:67], 0
    v_rcp_f32 v221, v221
    v_mfma_f32_4x4x4_16b_bf16 v[232:235], v[242:243], v[242:243], v[232:235]
    v_rcp_f32 v222, v222
    v_mfma_f32_16x16x32_bf16 v[200:203], v[180:183], v[68:71], 0
    v_rcp_f32 v223, v223
    s_waitcnt lgkmcnt(3)
    v_mfma_f32_16x16x32_bf16 v[188:191], v[160:163], v[0:3], v[188:191]
    v_rcp_f32 v224, v224
    v_mfma_f32_16x16x32_bf16 v[196:199], v[160:163], v[8:11], v[196:199]
    v_rcp_f32 v225, v225
    s_waitcnt lgkmcnt(2)
    v_mfma_f32_16x16x32_bf16 v[192:195], v[168:171], v[0:3], v[192:195]
    v_rcp_f32 v226, v226
    v_mfma_f32_16x16x32_bf16 v[200:203], v[168:171], v[8:11], v[200:203]
    v_rcp_f32 v227, v227
    s_waitcnt lgkmcnt(1)
    v_mfma_f32_16x16x32_bf16 v[188:191], v[164:167], v[4:7], v[188:191]
    v_rcp_f32 v228, v228
    v_mfma_f32_16x16x32_bf16 v[196:199], v[164:167], v[12:15], v[196:199]
    v_rcp_f32 v229, v229
    s_setprio 3
    s_waitcnt lgkmcnt(0)
    v_mfma_f32_16x16x32_bf16 v[192:195], v[172:175], v[4:7], v[192:195]
    s_cmp_lt_u32 s16, s17
    s_cbranch_scc0 L_ND11
    s_add_u32 m0, s13, 0
    v_mad_u32_u16 v236, v236, s15, v243
    buffer_load_dwordx4 v236, s[40:43], 0 offen lds
    s_add_u32 m0, s13, 1056
    v_mad_u32_u16 v237, v237, s15, v243
    buffer_load_dwordx4 v237, s[40:43], 0 offen lds
    s_add_u32 m0, s13, 2112
    v_mad_u32_u16 v238, v238, s15, v243
    buffer_load_dwordx4 v238, s[40:43], 0 offen lds
    s_add_u32 m0, s13, 3168
    v_mad_u32_u16 v239, v239, s15, v243
    buffer_load_dwordx4 v239, s[40:43], 0 offen lds
    s_mov_b32 m0, s14
    v_and_b32 v240, 0xfffff, v240
    buffer_load_dwordx4 v[240:241], s[44:47], 0 idxen offen lds
L_ND11:
    v_rcp_f32 v230, v230
    v_mfma_f32_16x16x32_bf16 v[200:203], v[172:175], v[12:15], v[200:203]
    v_rcp_f32 v231, v231
    v_rcp_f32 v232, v232
    v_rcp_f32 v233, v233
    v_rcp_f32 v234, v234
    v_rcp_f32 v235, v235
    v_pk_mul_f32 v[204:205], v[220:221], v[204:205]
    v_pk_mul_f32 v[206:207], v[222:223], v[206:207]
    v_pk_mul_f32 v[208:209], v[224:225], v[208:209]
    v_pk_mul_f32 v[210:211], v[226:227], v[210:211]
    v_pk_mul_f32 v[212:213], v[228:229], v[212:213]
    v_pk_mul_f32 v[214:215], v[230:231], v[214:215]
    v_pk_mul_f32 v[216:217], v[232:233], v[216:217]
    v_pk_mul_f32 v[218:219], v[234:235], v[218:219]
    s_cmp_lt_u32 s16, s17
    s_cbranch_scc1 L_LOOP1
    s_branch L_LT0
.p2align 6
L_LOOP0:
    s_setprio 0
    v_smfmac_f32_16x16x64_bf16 v[152:155], v[184:187], v[204:211], v255
    ds_read_u16 v236, v250 offset:0
    ds_read_u16 v237, v250 offset:16
    ds_add_rtn_u32 v238, v246, v255
    v_exp_f32 v188, v188
    v_smfmac_f32_16x16x64_bf16 v[156:159], v[184:187], v[212:219], v255
    v_exp_f32 v189, v189
    v_mfma_f32_16x16x32_bf16 v[204:207], v[160:163], v[32:35], 0
    v_exp_f32 v190, v190
    v_mfma_f32_16x16x32_bf16 v[212:215], v[160:163], v[40:43], 0
    v_exp_f32 v191, v191
    v_mfma_f32_16x16x32_bf16 v[208:211], v[168:171], v[32:35], 0
    v_exp_f32 v192, v192
    v_mfma_f32_16x16x32_bf16 v[216:219], v[168:171], v[40:43], 0
    v_exp_f32 v193, v193
    v_mfma_f32_16x16x32_bf16 v[204:207], v[164:167], v[36:39], v[204:207]
    v_exp_f32 v194, v194
    v_mfma_f32_16x16x32_bf16 v[212:215], v[164:167], v[44:47], v[212:215]
    v_exp_f32 v195, v195
    v_mfma_f32_16x16x32_bf16 v[208:211], v[172:175], v[36:39], v[208:211]
    s_waitcnt lgkmcnt(0)
    v_bfi_b32 v236, 31, v246, v236
    v_bfi_b32 v237, 31, v246, v237
    v_readfirstlane_b32 s96, v238
    v_exp_f32 v196, v196
    v_mfma_f32_16x16x32_bf16 v[216:219], v[172:175], v[44:47], v[216:219]
    v_exp_f32 v197, v197
    v_smfmac_f32_16x16x64_bf16 v[136:139], v[184:187], v[220:227], v255
    v_exp_f32 v198, v198
    v_smfmac_f32_16x16x64_bf16 v[140:143], v[184:187], v[228:235], v255
    v_exp_f32 v199, v199
    v_mfma_f32_4x4x4_16b_bf16 v[188:191], v[242:243], v[242:243], v[188:191]
    v_exp_f32 v200, v200
    v_mfma_f32_4x4x4_16b_bf16 v[192:195], v[242:243], v[242:243], v[192:195]
    v_exp_f32 v201, v201
    v_mfma_f32_4x4x4_16b_bf16 v[196:199], v[242:243], v[242:243], v[196:199]
    v_exp_f32 v202, v202
    v_mfma_f32_16x16x32_bf16 v[220:223], v[176:179], v[72:75], 0
    ds_read_b64_tr_b16 v[184:185], v236
    ds_read_b64_tr_b16 v[186:187], v237
    ds_read_u16 v251, v249 offset:1152
    ds_read_u16 v252, v249 offset:1216
    v_exp_f32 v203, v203
    v_mfma_f32_16x16x32_bf16 v[228:231], v[176:179], v[76:79], 0
    s_ashr_i32 s96, s96, 24
    s_mul_i32 s96, s96, s101
    v_rcp_f32 v188, v188
    v_mfma_f32_16x16x32_bf16 v[224:227], v[180:183], v[72:75], 0
    v_rcp_f32 v189, v189
    v_mfma_f32_4x4x4_16b_bf16 v[200:203], v[242:243], v[242:243], v[200:203]
    v_rcp_f32 v190, v190
    v_mfma_f32_16x16x32_bf16 v[232:235], v[180:183], v[76:79], 0
    v_rcp_f32 v191, v191
    v_mfma_f32_16x16x32_bf16 v[220:223], v[160:163], v[16:19], v[220:223]
    v_rcp_f32 v192, v192
    v_mfma_f32_16x16x32_bf16 v[228:231], v[160:163], v[24:27], v[228:231]
    v_rcp_f32 v193, v193
    v_mfma_f32_16x16x32_bf16 v[224:227], v[168:171], v[16:19], v[224:227]
    s_waitcnt lgkmcnt(0)
    v_bfi_b32 v251, 31, v245, v251
    v_bfi_b32 v252, 31, v245, v252
    v_max_u32 v251, v251, v245
    v_max_u32 v252, v252, v253
    ds_read_b128 v[236:239], v247 offset:128
    ds_read_b32 v240, v248 offset:128
    s_add_u32 s16, s16, 1
    v_rcp_f32 v194, v194
    v_mfma_f32_16x16x32_bf16 v[232:235], v[168:171], v[24:27], v[232:235]
    v_rcp_f32 v195, v195
    v_mfma_f32_16x16x32_bf16 v[220:223], v[164:167], v[20:23], v[220:223]
    v_rcp_f32 v196, v196
    v_mfma_f32_16x16x32_bf16 v[228:231], v[164:167], v[28:31], v[228:231]
    v_rcp_f32 v197, v197
    s_setprio 3
    v_mfma_f32_16x16x32_bf16 v[224:227], v[172:175], v[20:23], v[224:227]
    v_rcp_f32 v198, v198
    v_mfma_f32_16x16x32_bf16 v[232:235], v[172:175], v[28:31], v[232:235]
    v_rcp_f32 v199, v199
    v_rcp_f32 v200, v200
    v_rcp_f32 v201, v201
    v_rcp_f32 v202, v202
    v_rcp_f32 v203, v203
    v_pk_mul_f32 v[204:205], v[188:189], v[204:205]
    v_pk_mul_f32 v[206:207], v[190:191], v[206:207]
    v_pk_mul_f32 v[208:209], v[192:193], v[208:209]
    v_pk_mul_f32 v[210:211], v[194:195], v[210:211]
    v_pk_mul_f32 v[212:213], v[196:197], v[212:213]
    v_pk_mul_f32 v[214:215], v[198:199], v[214:215]
    v_pk_mul_f32 v[216:217], v[200:201], v[216:217]
    v_pk_mul_f32 v[218:219], v[202:203], v[218:219]
    s_cmp_ge_i32 s96, 1
    s_cbranch_scc1 L_PB01
L_PB00:
    s_setprio 0
    v_smfmac_f32_16x16x64_bf16 v[112:115], v[184:187], v[204:211], v255
    v_exp_f32 v220, v220
    v_smfmac_f32_16x16x64_bf16 v[116:119], v[184:187], v[212:219], v255
    v_exp_f32 v221, v221
    s_waitcnt vmcnt(0)
    ds_read_b128 v[176:179], v251
    ds_read_b128 v[180:183], v252
    v_mfma_f32_16x16x32_bf16 v[204:207], v[160:163], v[48:51], 0
    v_exp_f32 v222, v222
    v_mfma_f32_16x16x32_bf16 v[212:215], v[160:163], v[56:59], 0
    ds_read_b128 v[160:163], v244 offset:0
    v_exp_f32 v223, v223
    v_mfma_f32_16x16x32_bf16 v[208:211], v[168:171], v[48:51], 0
    v_exp_f32 v224, v224
    v_mfma_f32_16x16x32_bf16 v[216:219], v[168:171], v[56:59], 0
    ds_read_b128 v[168:171], v244 offset:512
    v_exp_f32 v225, v225
    v_mfma_f32_16x16x32_bf16 v[204:207], v[164:167], v[52:55], v[204:207]
    v_exp_f32 v226, v226
    v_mfma_f32_16x16x32_bf16 v[212:215], v[164:167], v[60:63], v[212:215]
    ds_read_b128 v[164:167], v244 offset:64
    v_exp_f32 v227, v227
    v_mfma_f32_16x16x32_bf16 v[208:211], v[172:175], v[52:55], v[208:211]
    v_exp_f32 v228, v228
    v_mfma_f32_16x16x32_bf16 v[216:219], v[172:175], v[60:63], v[216:219]
    ds_read_b128 v[172:175], v244 offset:576
    v_exp_f32 v229, v229
    v_smfmac_f32_16x16x64_bf16 v[96:99], v[184:187], v[188:195], v255
    v_exp_f32 v230, v230
    v_smfmac_f32_16x16x64_bf16 v[100:103], v[184:187], v[196:203], v255
    v_exp_f32 v231, v231
    v_mfma_f32_4x4x4_16b_bf16 v[220:223], v[242:243], v[242:243], v[220:223]
    v_exp_f32 v232, v232
    v_mfma_f32_4x4x4_16b_bf16 v[224:227], v[242:243], v[242:243], v[224:227]
    v_exp_f32 v233, v233
    v_mfma_f32_4x4x4_16b_bf16 v[228:231], v[242:243], v[242:243], v[228:231]
    v_exp_f32 v234, v234
    s_waitcnt lgkmcnt(4)
    v_mfma_f32_16x16x32_bf16 v[188:191], v[176:179], v[80:83], 0
    v_exp_f32 v235, v235
    v_mfma_f32_16x16x32_bf16 v[196:199], v[176:179], v[84:87], 0
    v_rcp_f32 v220, v220
    v_mfma_f32_16x16x32_bf16 v[192:195], v[180:183], v[80:83], 0
    v_rcp_f32 v221, v221
    v_mfma_f32_4x4x4_16b_bf16 v[232:235], v[242:243], v[242:243], v[232:235]
    v_rcp_f32 v222, v222
    v_mfma_f32_16x16x32_bf16 v[200:203], v[180:183], v[84:87], 0
    v_rcp_f32 v223, v223
    s_waitcnt lgkmcnt(3)
    v_mfma_f32_16x16x32_bf16 v[188:191], v[160:163], v[0:3], v[188:191]
    v_rcp_f32 v224, v224
    v_mfma_f32_16x16x32_bf16 v[196:199], v[160:163], v[8:11], v[196:199]
    v_rcp_f32 v225, v225
    s_waitcnt lgkmcnt(2)
    v_mfma_f32_16x16x32_bf16 v[192:195], v[168:171], v[0:3], v[192:195]
    v_rcp_f32 v226, v226
    v_mfma_f32_16x16x32_bf16 v[200:203], v[168:171], v[8:11], v[200:203]
    v_rcp_f32 v227, v227
    s_waitcnt lgkmcnt(1)
    v_mfma_f32_16x16x32_bf16 v[188:191], v[164:167], v[4:7], v[188:191]
    v_rcp_f32 v228, v228
    v_mfma_f32_16x16x32_bf16 v[196:199], v[164:167], v[12:15], v[196:199]
    v_rcp_f32 v229, v229
    s_setprio 3
    s_waitcnt lgkmcnt(0)
    v_mfma_f32_16x16x32_bf16 v[192:195], v[172:175], v[4:7], v[192:195]
    s_cmp_lt_u32 s16, s17
    s_cbranch_scc0 L_ND00
    s_add_u32 m0, s13, 0
    v_mad_u32_u16 v236, v236, s15, v243
    buffer_load_dwordx4 v236, s[40:43], 0 offen lds
    s_add_u32 m0, s13, 1056
    v_mad_u32_u16 v237, v237, s15, v243
    buffer_load_dwordx4 v237, s[40:43], 0 offen lds
    s_add_u32 m0, s13, 2112
    v_mad_u32_u16 v238, v238, s15, v243
    buffer_load_dwordx4 v238, s[40:43], 0 offen lds
    s_add_u32 m0, s13, 3168
    v_mad_u32_u16 v239, v239, s15, v243
    buffer_load_dwordx4 v239, s[40:43], 0 offen lds
    s_mov_b32 m0, s14
    v_and_b32 v240, 0xfffff, v240
    buffer_load_dwordx4 v[240:241], s[44:47], 0 idxen offen lds
L_ND00:
    v_rcp_f32 v230, v230
    v_mfma_f32_16x16x32_bf16 v[200:203], v[172:175], v[12:15], v[200:203]
    v_rcp_f32 v231, v231
    v_rcp_f32 v232, v232
    v_rcp_f32 v233, v233
    v_rcp_f32 v234, v234
    v_rcp_f32 v235, v235
    v_pk_mul_f32 v[204:205], v[220:221], v[204:205]
    v_pk_mul_f32 v[206:207], v[222:223], v[206:207]
    v_pk_mul_f32 v[208:209], v[224:225], v[208:209]
    v_pk_mul_f32 v[210:211], v[226:227], v[210:211]
    v_pk_mul_f32 v[212:213], v[228:229], v[212:213]
    v_pk_mul_f32 v[214:215], v[230:231], v[214:215]
    v_pk_mul_f32 v[216:217], v[232:233], v[216:217]
    v_pk_mul_f32 v[218:219], v[234:235], v[218:219]
    s_cmp_ge_u32 s16, s17
    s_cbranch_scc1 L_LT1
    s_setprio 0
    v_smfmac_f32_16x16x64_bf16 v[120:123], v[184:187], v[204:211], v255
    ds_read_u16 v236, v250 offset:1152
    ds_read_u16 v237, v250 offset:1168
    ds_add_rtn_u32 v238, v246, v255
    v_exp_f32 v188, v188
    v_smfmac_f32_16x16x64_bf16 v[124:127], v[184:187], v[212:219], v255
    v_exp_f32 v189, v189
    v_mfma_f32_16x16x32_bf16 v[204:207], v[160:163], v[32:35], 0
    v_exp_f32 v190, v190
    v_mfma_f32_16x16x32_bf16 v[212:215], v[160:163], v[40:43], 0
    v_exp_f32 v191, v191
    v_mfma_f32_16x16x32_bf16 v[208:211], v[168:171], v[32:35], 0
    v_exp_f32 v192, v192
    v_mfma_f32_16x16x32_bf16 v[216:219], v[168:171], v[40:43], 0
    v_exp_f32 v193, v193
    v_mfma_f32_16x16x32_bf16 v[204:207], v[164:167], v[36:39], v[204:207]
    v_exp_f32 v194, v194
    v_mfma_f32_16x16x32_bf16 v[212:215], v[164:167], v[44:47], v[212:215]
    v_exp_f32 v195, v195
    v_mfma_f32_16x16x32_bf16 v[208:211], v[172:175], v[36:39], v[208:211]
    s_waitcnt lgkmcnt(0)
    v_bfi_b32 v236, 31, v246, v236
    v_bfi_b32 v237, 31, v246, v237
    v_readfirstlane_b32 s96, v238
    v_exp_f32 v196, v196
    v_mfma_f32_16x16x32_bf16 v[216:219], v[172:175], v[44:47], v[216:219]
    v_exp_f32 v197, v197
    v_smfmac_f32_16x16x64_bf16 v[104:107], v[184:187], v[220:227], v255
    v_exp_f32 v198, v198
    v_smfmac_f32_16x16x64_bf16 v[108:111], v[184:187], v[228:235], v255
    v_exp_f32 v199, v199
    v_mfma_f32_4x4x4_16b_bf16 v[188:191], v[242:243], v[242:243], v[188:191]
    v_exp_f32 v200, v200
    v_mfma_f32_4x4x4_16b_bf16 v[192:195], v[242:243], v[242:243], v[192:195]
    v_exp_f32 v201, v201
    v_mfma_f32_4x4x4_16b_bf16 v[196:199], v[242:243], v[242:243], v[196:199]
    v_exp_f32 v202, v202
    v_mfma_f32_16x16x32_bf16 v[220:223], v[176:179], v[88:91], 0
    ds_read_b64_tr_b16 v[184:185], v236
    ds_read_b64_tr_b16 v[186:187], v237
    ds_read_u16 v251, v249 offset:128
    ds_read_u16 v252, v249 offset:192
    v_exp_f32 v203, v203
    v_mfma_f32_16x16x32_bf16 v[228:231], v[176:179], v[92:95], 0
    s_ashr_i32 s96, s96, 24
    s_mul_i32 s96, s96, s101
    v_rcp_f32 v188, v188
    v_mfma_f32_16x16x32_bf16 v[224:227], v[180:183], v[88:91], 0
    v_rcp_f32 v189, v189
    v_mfma_f32_4x4x4_16b_bf16 v[200:203], v[242:243], v[242:243], v[200:203]
    v_rcp_f32 v190, v190
    v_mfma_f32_16x16x32_bf16 v[232:235], v[180:183], v[92:95], 0
    v_rcp_f32 v191, v191
    v_mfma_f32_16x16x32_bf16 v[220:223], v[160:163], v[16:19], v[220:223]
    v_rcp_f32 v192, v192
    v_mfma_f32_16x16x32_bf16 v[228:231], v[160:163], v[24:27], v[228:231]
    v_rcp_f32 v193, v193
    v_mfma_f32_16x16x32_bf16 v[224:227], v[168:171], v[16:19], v[224:227]
    s_waitcnt lgkmcnt(0)
    v_bfi_b32 v251, 31, v245, v251
    v_bfi_b32 v252, 31, v245, v252
    v_max_u32 v251, v251, v245
    v_max_u32 v252, v252, v253
    ds_read_b128 v[236:239], v247 offset:1280
    ds_read_b32 v240, v248 offset:1280
    s_add_u32 s16, s16, 1
    v_rcp_f32 v194, v194
    v_mfma_f32_16x16x32_bf16 v[232:235], v[168:171], v[24:27], v[232:235]
    v_add_u32 v247, 0x80, v247
    v_add_u32 v248, 0x80, v248
    v_add_u32 v249, 0x80, v249
    v_add_u32 v250, 0x80, v250
    v_rcp_f32 v195, v195
    v_mfma_f32_16x16x32_bf16 v[220:223], v[164:167], v[20:23], v[220:223]
    v_rcp_f32 v196, v196
    v_mfma_f32_16x16x32_bf16 v[228:231], v[164:167], v[28:31], v[228:231]
    v_rcp_f32 v197, v197
    s_setprio 3
    v_mfma_f32_16x16x32_bf16 v[224:227], v[172:175], v[20:23], v[224:227]
    v_rcp_f32 v198, v198
    v_mfma_f32_16x16x32_bf16 v[232:235], v[172:175], v[28:31], v[232:235]
    v_rcp_f32 v199, v199
    v_rcp_f32 v200, v200
    v_rcp_f32 v201, v201
    v_rcp_f32 v202, v202
    v_rcp_f32 v203, v203
    v_pk_mul_f32 v[204:205], v[188:189], v[204:205]
    v_pk_mul_f32 v[206:207], v[190:191], v[206:207]
    v_pk_mul_f32 v[208:209], v[192:193], v[208:209]
    v_pk_mul_f32 v[210:211], v[194:195], v[210:211]
    v_pk_mul_f32 v[212:213], v[196:197], v[212:213]
    v_pk_mul_f32 v[214:215], v[198:199], v[214:215]
    v_pk_mul_f32 v[216:217], v[200:201], v[216:217]
    v_pk_mul_f32 v[218:219], v[202:203], v[218:219]
    s_cmp_ge_i32 s96, 1
    s_cbranch_scc1 L_PB11
L_PB10:
    s_setprio 0
    v_smfmac_f32_16x16x64_bf16 v[144:147], v[184:187], v[204:211], v255
    v_exp_f32 v220, v220
    v_smfmac_f32_16x16x64_bf16 v[148:151], v[184:187], v[212:219], v255
    v_exp_f32 v221, v221
    s_waitcnt vmcnt(0)
    ds_read_b128 v[176:179], v251
    ds_read_b128 v[180:183], v252
    v_mfma_f32_16x16x32_bf16 v[204:207], v[160:163], v[48:51], 0
    v_exp_f32 v222, v222
    v_mfma_f32_16x16x32_bf16 v[212:215], v[160:163], v[56:59], 0
    ds_read_b128 v[160:163], v244 offset:0
    v_exp_f32 v223, v223
    v_mfma_f32_16x16x32_bf16 v[208:211], v[168:171], v[48:51], 0
    v_exp_f32 v224, v224
    v_mfma_f32_16x16x32_bf16 v[216:219], v[168:171], v[56:59], 0
    ds_read_b128 v[168:171], v244 offset:512
    v_exp_f32 v225, v225
    v_mfma_f32_16x16x32_bf16 v[204:207], v[164:167], v[52:55], v[204:207]
    v_exp_f32 v226, v226
    v_mfma_f32_16x16x32_bf16 v[212:215], v[164:167], v[60:63], v[212:215]
    ds_read_b128 v[164:167], v244 offset:64
    v_exp_f32 v227, v227
    v_mfma_f32_16x16x32_bf16 v[208:211], v[172:175], v[52:55], v[208:211]
    v_exp_f32 v228, v228
    v_mfma_f32_16x16x32_bf16 v[216:219], v[172:175], v[60:63], v[216:219]
    ds_read_b128 v[172:175], v244 offset:576
    v_exp_f32 v229, v229
    v_smfmac_f32_16x16x64_bf16 v[128:131], v[184:187], v[188:195], v255
    v_exp_f32 v230, v230
    v_smfmac_f32_16x16x64_bf16 v[132:135], v[184:187], v[196:203], v255
    v_exp_f32 v231, v231
    v_mfma_f32_4x4x4_16b_bf16 v[220:223], v[242:243], v[242:243], v[220:223]
    v_exp_f32 v232, v232
    v_mfma_f32_4x4x4_16b_bf16 v[224:227], v[242:243], v[242:243], v[224:227]
    v_exp_f32 v233, v233
    v_mfma_f32_4x4x4_16b_bf16 v[228:231], v[242:243], v[242:243], v[228:231]
    v_exp_f32 v234, v234
    s_waitcnt lgkmcnt(4)
    v_mfma_f32_16x16x32_bf16 v[188:191], v[176:179], v[64:67], 0
    v_exp_f32 v235, v235
    v_mfma_f32_16x16x32_bf16 v[196:199], v[176:179], v[68:71], 0
    v_rcp_f32 v220, v220
    v_mfma_f32_16x16x32_bf16 v[192:195], v[180:183], v[64:67], 0
    v_rcp_f32 v221, v221
    v_mfma_f32_4x4x4_16b_bf16 v[232:235], v[242:243], v[242:243], v[232:235]
    v_rcp_f32 v222, v222
    v_mfma_f32_16x16x32_bf16 v[200:203], v[180:183], v[68:71], 0
    v_rcp_f32 v223, v223
    s_waitcnt lgkmcnt(3)
    v_mfma_f32_16x16x32_bf16 v[188:191], v[160:163], v[0:3], v[188:191]
    v_rcp_f32 v224, v224
    v_mfma_f32_16x16x32_bf16 v[196:199], v[160:163], v[8:11], v[196:199]
    v_rcp_f32 v225, v225
    s_waitcnt lgkmcnt(2)
    v_mfma_f32_16x16x32_bf16 v[192:195], v[168:171], v[0:3], v[192:195]
    v_rcp_f32 v226, v226
    v_mfma_f32_16x16x32_bf16 v[200:203], v[168:171], v[8:11], v[200:203]
    v_rcp_f32 v227, v227
    s_waitcnt lgkmcnt(1)
    v_mfma_f32_16x16x32_bf16 v[188:191], v[164:167], v[4:7], v[188:191]
    v_rcp_f32 v228, v228
    v_mfma_f32_16x16x32_bf16 v[196:199], v[164:167], v[12:15], v[196:199]
    v_rcp_f32 v229, v229
    s_setprio 3
    s_waitcnt lgkmcnt(0)
    v_mfma_f32_16x16x32_bf16 v[192:195], v[172:175], v[4:7], v[192:195]
    s_cmp_lt_u32 s16, s17
    s_cbranch_scc0 L_ND10
    s_add_u32 m0, s13, 0
    v_mad_u32_u16 v236, v236, s15, v243
    buffer_load_dwordx4 v236, s[40:43], 0 offen lds
    s_add_u32 m0, s13, 1056
    v_mad_u32_u16 v237, v237, s15, v243
    buffer_load_dwordx4 v237, s[40:43], 0 offen lds
    s_add_u32 m0, s13, 2112
    v_mad_u32_u16 v238, v238, s15, v243
    buffer_load_dwordx4 v238, s[40:43], 0 offen lds
    s_add_u32 m0, s13, 3168
    v_mad_u32_u16 v239, v239, s15, v243
    buffer_load_dwordx4 v239, s[40:43], 0 offen lds
    s_mov_b32 m0, s14
    v_and_b32 v240, 0xfffff, v240
    buffer_load_dwordx4 v[240:241], s[44:47], 0 idxen offen lds
L_ND10:
    v_rcp_f32 v230, v230
    v_mfma_f32_16x16x32_bf16 v[200:203], v[172:175], v[12:15], v[200:203]
    v_rcp_f32 v231, v231
    v_rcp_f32 v232, v232
    v_rcp_f32 v233, v233
    v_rcp_f32 v234, v234
    v_rcp_f32 v235, v235
    v_pk_mul_f32 v[204:205], v[220:221], v[204:205]
    v_pk_mul_f32 v[206:207], v[222:223], v[206:207]
    v_pk_mul_f32 v[208:209], v[224:225], v[208:209]
    v_pk_mul_f32 v[210:211], v[226:227], v[210:211]
    v_pk_mul_f32 v[212:213], v[228:229], v[212:213]
    v_pk_mul_f32 v[214:215], v[230:231], v[214:215]
    v_pk_mul_f32 v[216:217], v[232:233], v[216:217]
    v_pk_mul_f32 v[218:219], v[234:235], v[218:219]
    s_cmp_lt_u32 s16, s17
    s_cbranch_scc1 L_LOOP0
    s_branch L_LT0
L_LT0:
    s_cmp_lg_u32 s99, 0
    s_cbranch_scc1 L_LH0
    s_setprio 0
    v_smfmac_f32_16x16x64_bf16 v[152:155], v[184:187], v[204:211], v255
    ds_read_u16 v236, v250 offset:0
    ds_read_u16 v237, v250 offset:16
    v_exp_f32 v188, v188
    v_smfmac_f32_16x16x64_bf16 v[156:159], v[184:187], v[212:219], v255
    v_exp_f32 v189, v189
    v_mfma_f32_16x16x32_bf16 v[204:207], v[160:163], v[32:35], 0
    v_exp_f32 v190, v190
    v_mfma_f32_16x16x32_bf16 v[212:215], v[160:163], v[40:43], 0
    v_exp_f32 v191, v191
    v_mfma_f32_16x16x32_bf16 v[208:211], v[168:171], v[32:35], 0
    v_exp_f32 v192, v192
    v_mfma_f32_16x16x32_bf16 v[216:219], v[168:171], v[40:43], 0
    v_exp_f32 v193, v193
    v_mfma_f32_16x16x32_bf16 v[204:207], v[164:167], v[36:39], v[204:207]
    v_exp_f32 v194, v194
    v_mfma_f32_16x16x32_bf16 v[212:215], v[164:167], v[44:47], v[212:215]
    v_exp_f32 v195, v195
    v_mfma_f32_16x16x32_bf16 v[208:211], v[172:175], v[36:39], v[208:211]
    v_exp_f32 v196, v196
    v_mfma_f32_16x16x32_bf16 v[216:219], v[172:175], v[44:47], v[216:219]
    v_exp_f32 v197, v197
    v_smfmac_f32_16x16x64_bf16 v[136:139], v[184:187], v[220:227], v255
    s_waitcnt lgkmcnt(0)
    v_bfi_b32 v236, 31, v246, v236
    v_bfi_b32 v237, 31, v246, v237
    v_exp_f32 v198, v198
    s_setprio 3
    v_smfmac_f32_16x16x64_bf16 v[140:143], v[184:187], v[228:235], v255
    v_exp_f32 v199, v199
    v_exp_f32 v200, v200
    v_exp_f32 v201, v201
    v_exp_f32 v202, v202
    v_exp_f32 v203, v203
    v_pk_add_f32 v[188:189], v[188:189], 1.0 op_sel_hi:[1,0]
    v_pk_add_f32 v[190:191], v[190:191], 1.0 op_sel_hi:[1,0]
    v_pk_add_f32 v[192:193], v[192:193], 1.0 op_sel_hi:[1,0]
    v_pk_add_f32 v[194:195], v[194:195], 1.0 op_sel_hi:[1,0]
    v_pk_add_f32 v[196:197], v[196:197], 1.0 op_sel_hi:[1,0]
    v_pk_add_f32 v[198:199], v[198:199], 1.0 op_sel_hi:[1,0]
    v_pk_add_f32 v[200:201], v[200:201], 1.0 op_sel_hi:[1,0]
    v_pk_add_f32 v[202:203], v[202:203], 1.0 op_sel_hi:[1,0]
    s_setprio 0
    v_mfma_f32_16x16x32_bf16 v[220:223], v[176:179], v[72:75], 0
    ds_read_b64_tr_b16 v[184:185], v236
    ds_read_b64_tr_b16 v[186:187], v237
    v_rcp_f32 v188, v188
    v_mfma_f32_16x16x32_bf16 v[228:231], v[176:179], v[76:79], 0
    v_rcp_f32 v189, v189
    v_mfma_f32_16x16x32_bf16 v[224:227], v[180:183], v[72:75], 0
    v_rcp_f32 v190, v190
    v_mfma_f32_16x16x32_bf16 v[232:235], v[180:183], v[76:79], 0
    v_rcp_f32 v191, v191
    v_mfma_f32_16x16x32_bf16 v[220:223], v[160:163], v[16:19], v[220:223]
    v_rcp_f32 v192, v192
    v_mfma_f32_16x16x32_bf16 v[228:231], v[160:163], v[24:27], v[228:231]
    v_rcp_f32 v193, v193
    v_mfma_f32_16x16x32_bf16 v[224:227], v[168:171], v[16:19], v[224:227]
    v_rcp_f32 v194, v194
    v_mfma_f32_16x16x32_bf16 v[232:235], v[168:171], v[24:27], v[232:235]
    v_rcp_f32 v195, v195
    v_mfma_f32_16x16x32_bf16 v[220:223], v[164:167], v[20:23], v[220:223]
    v_rcp_f32 v196, v196
    v_mfma_f32_16x16x32_bf16 v[228:231], v[164:167], v[28:31], v[228:231]
    v_rcp_f32 v197, v197
    v_mfma_f32_16x16x32_bf16 v[224:227], v[172:175], v[20:23], v[224:227]
    v_rcp_f32 v198, v198
    s_setprio 3
    v_mfma_f32_16x16x32_bf16 v[232:235], v[172:175], v[28:31], v[232:235]
    v_rcp_f32 v199, v199
    v_rcp_f32 v200, v200
    v_rcp_f32 v201, v201
    v_rcp_f32 v202, v202
    v_rcp_f32 v203, v203
    v_pk_mul_f32 v[204:205], v[188:189], v[204:205]
    v_pk_mul_f32 v[206:207], v[190:191], v[206:207]
    v_pk_mul_f32 v[208:209], v[192:193], v[208:209]
    v_pk_mul_f32 v[210:211], v[194:195], v[210:211]
    v_pk_mul_f32 v[212:213], v[196:197], v[212:213]
    v_pk_mul_f32 v[214:215], v[198:199], v[214:215]
    v_pk_mul_f32 v[216:217], v[200:201], v[216:217]
    v_pk_mul_f32 v[218:219], v[202:203], v[218:219]
    s_setprio 0
    s_waitcnt lgkmcnt(0)
    v_smfmac_f32_16x16x64_bf16 v[112:115], v[184:187], v[204:211], v255
    v_exp_f32 v220, v220
    v_smfmac_f32_16x16x64_bf16 v[116:119], v[184:187], v[212:219], v255
    v_exp_f32 v221, v221
    v_mfma_f32_16x16x32_bf16 v[204:207], v[160:163], v[48:51], 0
    v_exp_f32 v222, v222
    v_mfma_f32_16x16x32_bf16 v[212:215], v[160:163], v[56:59], 0
    v_exp_f32 v223, v223
    v_mfma_f32_16x16x32_bf16 v[208:211], v[168:171], v[48:51], 0
    v_exp_f32 v224, v224
    v_mfma_f32_16x16x32_bf16 v[216:219], v[168:171], v[56:59], 0
    v_exp_f32 v225, v225
    v_mfma_f32_16x16x32_bf16 v[204:207], v[164:167], v[52:55], v[204:207]
    v_exp_f32 v226, v226
    v_mfma_f32_16x16x32_bf16 v[212:215], v[164:167], v[60:63], v[212:215]
    v_exp_f32 v227, v227
    v_mfma_f32_16x16x32_bf16 v[208:211], v[172:175], v[52:55], v[208:211]
    v_exp_f32 v228, v228
    v_mfma_f32_16x16x32_bf16 v[216:219], v[172:175], v[60:63], v[216:219]
    v_exp_f32 v229, v229
    v_smfmac_f32_16x16x64_bf16 v[96:99], v[184:187], v[188:195], v255
    v_exp_f32 v230, v230
    s_setprio 3
    v_smfmac_f32_16x16x64_bf16 v[100:103], v[184:187], v[196:203], v255
    v_exp_f32 v231, v231
    v_exp_f32 v232, v232
    v_exp_f32 v233, v233
    v_exp_f32 v234, v234
    v_exp_f32 v235, v235
    v_pk_add_f32 v[220:221], v[220:221], 1.0 op_sel_hi:[1,0]
    v_pk_add_f32 v[222:223], v[222:223], 1.0 op_sel_hi:[1,0]
    v_pk_add_f32 v[224:225], v[224:225], 1.0 op_sel_hi:[1,0]
    v_pk_add_f32 v[226:227], v[226:227], 1.0 op_sel_hi:[1,0]
    v_pk_add_f32 v[228:229], v[228:229], 1.0 op_sel_hi:[1,0]
    v_pk_add_f32 v[230:231], v[230:231], 1.0 op_sel_hi:[1,0]
    v_pk_add_f32 v[232:233], v[232:233], 1.0 op_sel_hi:[1,0]
    v_pk_add_f32 v[234:235], v[234:235], 1.0 op_sel_hi:[1,0]
    s_setprio 0
    v_rcp_f32 v220, v220
    v_rcp_f32 v221, v221
    v_rcp_f32 v222, v222
    v_rcp_f32 v223, v223
    v_rcp_f32 v224, v224
    v_rcp_f32 v225, v225
    v_rcp_f32 v226, v226
    v_rcp_f32 v227, v227
    v_rcp_f32 v228, v228
    v_rcp_f32 v229, v229
    v_rcp_f32 v230, v230
    v_rcp_f32 v231, v231
    v_rcp_f32 v232, v232
    v_rcp_f32 v233, v233
    v_rcp_f32 v234, v234
    v_rcp_f32 v235, v235
    v_pk_mul_f32 v[204:205], v[220:221], v[204:205]
    v_pk_mul_f32 v[206:207], v[222:223], v[206:207]
    v_pk_mul_f32 v[208:209], v[224:225], v[208:209]
    v_pk_mul_f32 v[210:211], v[226:227], v[210:211]
    v_pk_mul_f32 v[212:213], v[228:229], v[212:213]
    v_pk_mul_f32 v[214:215], v[230:231], v[214:215]
    v_pk_mul_f32 v[216:217], v[232:233], v[216:217]
    v_pk_mul_f32 v[218:219], v[234:235], v[218:219]
    v_smfmac_f32_16x16x64_bf16 v[104:107], v[184:187], v[220:227], v255
    v_smfmac_f32_16x16x64_bf16 v[108:111], v[184:187], v[228:235], v255
    v_smfmac_f32_16x16x64_bf16 v[120:123], v[184:187], v[204:211], v255
    v_smfmac_f32_16x16x64_bf16 v[124:127], v[184:187], v[212:219], v255
    s_branch L_DONE
L_LH0:
    s_setprio 0
    v_smfmac_f32_16x16x64_bf16 v[152:155], v[184:187], v[204:211], v255
    ds_read_u16 v236, v250 offset:0
    ds_read_u16 v237, v250 offset:16
    v_smfmac_f32_16x16x64_bf16 v[156:159], v[184:187], v[212:219], v255
    v_exp_f32 v188, v188
    v_mfma_f32_16x16x32_bf16 v[204:207], v[160:163], v[32:35], 0
    v_mfma_f32_16x16x32_bf16 v[212:215], v[160:163], v[40:43], 0
    v_exp_f32 v189, v189
    v_mfma_f32_16x16x32_bf16 v[204:207], v[164:167], v[36:39], v[204:207]
    v_mfma_f32_16x16x32_bf16 v[212:215], v[164:167], v[44:47], v[212:215]
    v_exp_f32 v190, v190
    v_smfmac_f32_16x16x64_bf16 v[136:139], v[184:187], v[220:227], v255
    s_waitcnt lgkmcnt(0)
    v_bfi_b32 v236, 31, v246, v236
    v_bfi_b32 v237, 31, v246, v237
    v_exp_f32 v191, v191
    s_setprio 3
    v_smfmac_f32_16x16x64_bf16 v[140:143], v[184:187], v[228:235], v255
    v_exp_f32 v196, v196
    v_exp_f32 v197, v197
    v_exp_f32 v198, v198
    v_exp_f32 v199, v199
    v_pk_add_f32 v[188:189], v[188:189], 1.0 op_sel_hi:[1,0]
    v_pk_add_f32 v[190:191], v[190:191], 1.0 op_sel_hi:[1,0]
    v_pk_add_f32 v[196:197], v[196:197], 1.0 op_sel_hi:[1,0]
    v_pk_add_f32 v[198:199], v[198:199], 1.0 op_sel_hi:[1,0]
    s_setprio 0
    v_mfma_f32_16x16x32_bf16 v[220:223], v[176:179], v[72:75], 0
    ds_read_b64_tr_b16 v[184:185], v236
    ds_read_b64_tr_b16 v[186:187], v237
    v_mfma_f32_16x16x32_bf16 v[228:231], v[176:179], v[76:79], 0
    v_rcp_f32 v188, v188
    v_mfma_f32_16x16x32_bf16 v[220:223], v[160:163], v[16:19], v[220:223]
    v_rcp_f32 v189, v189
    v_mfma_f32_16x16x32_bf16 v[228:231], v[160:163], v[24:27], v[228:231]
    v_rcp_f32 v190, v190
    v_mfma_f32_16x16x32_bf16 v[220:223], v[164:167], v[20:23], v[220:223]
    v_rcp_f32 v191, v191
    s_setprio 3
    v_mfma_f32_16x16x32_bf16 v[228:231], v[164:167], v[28:31], v[228:231]
    v_rcp_f32 v196, v196
    v_rcp_f32 v197, v197
    v_rcp_f32 v198, v198
    v_rcp_f32 v199, v199
    v_pk_mul_f32 v[204:205], v[188:189], v[204:205]
    v_pk_mul_f32 v[206:207], v[190:191], v[206:207]
    v_pk_mul_f32 v[212:213], v[196:197], v[212:213]
    v_pk_mul_f32 v[214:215], v[198:199], v[214:215]
    s_setprio 0
    s_waitcnt lgkmcnt(0)
    v_smfmac_f32_16x16x64_bf16 v[112:115], v[184:187], v[204:211], v255
    v_smfmac_f32_16x16x64_bf16 v[116:119], v[184:187], v[212:219], v255
    v_exp_f32 v220, v220
    v_mfma_f32_16x16x32_bf16 v[204:207], v[160:163], v[48:51], 0
    v_mfma_f32_16x16x32_bf16 v[212:215], v[160:163], v[56:59], 0
    v_exp_f32 v221, v221
    v_mfma_f32_16x16x32_bf16 v[204:207], v[164:167], v[52:55], v[204:207]
    v_mfma_f32_16x16x32_bf16 v[212:215], v[164:167], v[60:63], v[212:215]
    v_exp_f32 v222, v222
    v_smfmac_f32_16x16x64_bf16 v[96:99], v[184:187], v[188:195], v255
    v_exp_f32 v223, v223
    s_setprio 3
    v_smfmac_f32_16x16x64_bf16 v[100:103], v[184:187], v[196:203], v255
    v_exp_f32 v228, v228
    v_exp_f32 v229, v229
    v_exp_f32 v230, v230
    v_exp_f32 v231, v231
    v_pk_add_f32 v[220:221], v[220:221], 1.0 op_sel_hi:[1,0]
    v_pk_add_f32 v[222:223], v[222:223], 1.0 op_sel_hi:[1,0]
    v_pk_add_f32 v[228:229], v[228:229], 1.0 op_sel_hi:[1,0]
    v_pk_add_f32 v[230:231], v[230:231], 1.0 op_sel_hi:[1,0]
    s_setprio 0
    v_rcp_f32 v220, v220
    v_rcp_f32 v221, v221
    v_rcp_f32 v222, v222
    v_rcp_f32 v223, v223
    v_rcp_f32 v228, v228
    v_rcp_f32 v229, v229
    v_rcp_f32 v230, v230
    v_rcp_f32 v231, v231
    v_pk_mul_f32 v[204:205], v[220:221], v[204:205]
    v_pk_mul_f32 v[206:207], v[222:223], v[206:207]
    v_pk_mul_f32 v[212:213], v[228:229], v[212:213]
    v_pk_mul_f32 v[214:215], v[230:231], v[214:215]
    v_smfmac_f32_16x16x64_bf16 v[104:107], v[184:187], v[220:227], v255
    v_smfmac_f32_16x16x64_bf16 v[108:111], v[184:187], v[228:235], v255
    v_smfmac_f32_16x16x64_bf16 v[120:123], v[184:187], v[204:211], v255
    v_smfmac_f32_16x16x64_bf16 v[124:127], v[184:187], v[212:219], v255
    s_branch L_DONE
L_LT1:
    s_cmp_lg_u32 s99, 0
    s_cbranch_scc1 L_LH1
    s_setprio 0
    v_smfmac_f32_16x16x64_bf16 v[120:123], v[184:187], v[204:211], v255
    ds_read_u16 v236, v250 offset:1152
    ds_read_u16 v237, v250 offset:1168
    v_exp_f32 v188, v188
    v_smfmac_f32_16x16x64_bf16 v[124:127], v[184:187], v[212:219], v255
    v_exp_f32 v189, v189
    v_mfma_f32_16x16x32_bf16 v[204:207], v[160:163], v[32:35], 0
    v_exp_f32 v190, v190
    v_mfma_f32_16x16x32_bf16 v[212:215], v[160:163], v[40:43], 0
    v_exp_f32 v191, v191
    v_mfma_f32_16x16x32_bf16 v[208:211], v[168:171], v[32:35], 0
    v_exp_f32 v192, v192
    v_mfma_f32_16x16x32_bf16 v[216:219], v[168:171], v[40:43], 0
    v_exp_f32 v193, v193
    v_mfma_f32_16x16x32_bf16 v[204:207], v[164:167], v[36:39], v[204:207]
    v_exp_f32 v194, v194
    v_mfma_f32_16x16x32_bf16 v[212:215], v[164:167], v[44:47], v[212:215]
    v_exp_f32 v195, v195
    v_mfma_f32_16x16x32_bf16 v[208:211], v[172:175], v[36:39], v[208:211]
    v_exp_f32 v196, v196
    v_mfma_f32_16x16x32_bf16 v[216:219], v[172:175], v[44:47], v[216:219]
    v_exp_f32 v197, v197
    v_smfmac_f32_16x16x64_bf16 v[104:107], v[184:187], v[220:227], v255
    s_waitcnt lgkmcnt(0)
    v_bfi_b32 v236, 31, v246, v236
    v_bfi_b32 v237, 31, v246, v237
    v_exp_f32 v198, v198
    s_setprio 3
    v_smfmac_f32_16x16x64_bf16 v[108:111], v[184:187], v[228:235], v255
    v_exp_f32 v199, v199
    v_exp_f32 v200, v200
    v_exp_f32 v201, v201
    v_exp_f32 v202, v202
    v_exp_f32 v203, v203
    v_pk_add_f32 v[188:189], v[188:189], 1.0 op_sel_hi:[1,0]
    v_pk_add_f32 v[190:191], v[190:191], 1.0 op_sel_hi:[1,0]
    v_pk_add_f32 v[192:193], v[192:193], 1.0 op_sel_hi:[1,0]
    v_pk_add_f32 v[194:195], v[194:195], 1.0 op_sel_hi:[1,0]
    v_pk_add_f32 v[196:197], v[196:197], 1.0 op_sel_hi:[1,0]
    v_pk_add_f32 v[198:199], v[198:199], 1.0 op_sel_hi:[1,0]
    v_pk_add_f32 v[200:201], v[200:201], 1.0 op_sel_hi:[1,0]
    v_pk_add_f32 v[202:203], v[202:203], 1.0 op_sel_hi:[1,0]
    s_setprio 0
    v_mfma_f32_16x16x32_bf16 v[220:223], v[176:179], v[88:91], 0
    ds_read_b64_tr_b16 v[184:185], v236
    ds_read_b64_tr_b16 v[186:187], v237
    v_rcp_f32 v188, v188
    v_mfma_f32_16x16x32_bf16 v[228:231], v[176:179], v[92:95], 0
    v_rcp_f32 v189, v189
    v_mfma_f32_16x16x32_bf16 v[224:227], v[180:183], v[88:91], 0
    v_rcp_f32 v190, v190
    v_mfma_f32_16x16x32_bf16 v[232:235], v[180:183], v[92:95], 0
    v_rcp_f32 v191, v191
    v_mfma_f32_16x16x32_bf16 v[220:223], v[160:163], v[16:19], v[220:223]
    v_rcp_f32 v192, v192
    v_mfma_f32_16x16x32_bf16 v[228:231], v[160:163], v[24:27], v[228:231]
    v_rcp_f32 v193, v193
    v_mfma_f32_16x16x32_bf16 v[224:227], v[168:171], v[16:19], v[224:227]
    v_rcp_f32 v194, v194
    v_mfma_f32_16x16x32_bf16 v[232:235], v[168:171], v[24:27], v[232:235]
    v_rcp_f32 v195, v195
    v_mfma_f32_16x16x32_bf16 v[220:223], v[164:167], v[20:23], v[220:223]
    v_rcp_f32 v196, v196
    v_mfma_f32_16x16x32_bf16 v[228:231], v[164:167], v[28:31], v[228:231]
    v_rcp_f32 v197, v197
    v_mfma_f32_16x16x32_bf16 v[224:227], v[172:175], v[20:23], v[224:227]
    v_rcp_f32 v198, v198
    s_setprio 3
    v_mfma_f32_16x16x32_bf16 v[232:235], v[172:175], v[28:31], v[232:235]
    v_rcp_f32 v199, v199
    v_rcp_f32 v200, v200
    v_rcp_f32 v201, v201
    v_rcp_f32 v202, v202
    v_rcp_f32 v203, v203
    v_pk_mul_f32 v[204:205], v[188:189], v[204:205]
    v_pk_mul_f32 v[206:207], v[190:191], v[206:207]
    v_pk_mul_f32 v[208:209], v[192:193], v[208:209]
    v_pk_mul_f32 v[210:211], v[194:195], v[210:211]
    v_pk_mul_f32 v[212:213], v[196:197], v[212:213]
    v_pk_mul_f32 v[214:215], v[198:199], v[214:215]
    v_pk_mul_f32 v[216:217], v[200:201], v[216:217]
    v_pk_mul_f32 v[218:219], v[202:203], v[218:219]
    s_setprio 0
    s_waitcnt lgkmcnt(0)
    v_smfmac_f32_16x16x64_bf16 v[144:147], v[184:187], v[204:211], v255
    v_exp_f32 v220, v220
    v_smfmac_f32_16x16x64_bf16 v[148:151], v[184:187], v[212:219], v255
    v_exp_f32 v221, v221
    v_mfma_f32_16x16x32_bf16 v[204:207], v[160:163], v[48:51], 0
    v_exp_f32 v222, v222
    v_mfma_f32_16x16x32_bf16 v[212:215], v[160:163], v[56:59], 0
    v_exp_f32 v223, v223
    v_mfma_f32_16x16x32_bf16 v[208:211], v[168:171], v[48:51], 0
    v_exp_f32 v224, v224
    v_mfma_f32_16x16x32_bf16 v[216:219], v[168:171], v[56:59], 0
    v_exp_f32 v225, v225
    v_mfma_f32_16x16x32_bf16 v[204:207], v[164:167], v[52:55], v[204:207]
    v_exp_f32 v226, v226
    v_mfma_f32_16x16x32_bf16 v[212:215], v[164:167], v[60:63], v[212:215]
    v_exp_f32 v227, v227
    v_mfma_f32_16x16x32_bf16 v[208:211], v[172:175], v[52:55], v[208:211]
    v_exp_f32 v228, v228
    v_mfma_f32_16x16x32_bf16 v[216:219], v[172:175], v[60:63], v[216:219]
    v_exp_f32 v229, v229
    v_smfmac_f32_16x16x64_bf16 v[128:131], v[184:187], v[188:195], v255
    v_exp_f32 v230, v230
    s_setprio 3
    v_smfmac_f32_16x16x64_bf16 v[132:135], v[184:187], v[196:203], v255
    v_exp_f32 v231, v231
    v_exp_f32 v232, v232
    v_exp_f32 v233, v233
    v_exp_f32 v234, v234
    v_exp_f32 v235, v235
    v_pk_add_f32 v[220:221], v[220:221], 1.0 op_sel_hi:[1,0]
    v_pk_add_f32 v[222:223], v[222:223], 1.0 op_sel_hi:[1,0]
    v_pk_add_f32 v[224:225], v[224:225], 1.0 op_sel_hi:[1,0]
    v_pk_add_f32 v[226:227], v[226:227], 1.0 op_sel_hi:[1,0]
    v_pk_add_f32 v[228:229], v[228:229], 1.0 op_sel_hi:[1,0]
    v_pk_add_f32 v[230:231], v[230:231], 1.0 op_sel_hi:[1,0]
    v_pk_add_f32 v[232:233], v[232:233], 1.0 op_sel_hi:[1,0]
    v_pk_add_f32 v[234:235], v[234:235], 1.0 op_sel_hi:[1,0]
    s_setprio 0
    v_rcp_f32 v220, v220
    v_rcp_f32 v221, v221
    v_rcp_f32 v222, v222
    v_rcp_f32 v223, v223
    v_rcp_f32 v224, v224
    v_rcp_f32 v225, v225
    v_rcp_f32 v226, v226
    v_rcp_f32 v227, v227
    v_rcp_f32 v228, v228
    v_rcp_f32 v229, v229
    v_rcp_f32 v230, v230
    v_rcp_f32 v231, v231
    v_rcp_f32 v232, v232
    v_rcp_f32 v233, v233
    v_rcp_f32 v234, v234
    v_rcp_f32 v235, v235
    v_pk_mul_f32 v[204:205], v[220:221], v[204:205]
    v_pk_mul_f32 v[206:207], v[222:223], v[206:207]
    v_pk_mul_f32 v[208:209], v[224:225], v[208:209]
    v_pk_mul_f32 v[210:211], v[226:227], v[210:211]
    v_pk_mul_f32 v[212:213], v[228:229], v[212:213]
    v_pk_mul_f32 v[214:215], v[230:231], v[214:215]
    v_pk_mul_f32 v[216:217], v[232:233], v[216:217]
    v_pk_mul_f32 v[218:219], v[234:235], v[218:219]
    v_smfmac_f32_16x16x64_bf16 v[136:139], v[184:187], v[220:227], v255
    v_smfmac_f32_16x16x64_bf16 v[140:143], v[184:187], v[228:235], v255
    v_smfmac_f32_16x16x64_bf16 v[152:155], v[184:187], v[204:211], v255
    v_smfmac_f32_16x16x64_bf16 v[156:159], v[184:187], v[212:219], v255
    s_branch L_DONE
L_LH1:
    s_setprio 0
    v_smfmac_f32_16x16x64_bf16 v[120:123], v[184:187], v[204:211], v255
    ds_read_u16 v236, v250 offset:1152
    ds_read_u16 v237, v250 offset:1168
    v_smfmac_f32_16x16x64_bf16 v[124:127], v[184:187], v[212:219], v255
    v_exp_f32 v188, v188
    v_mfma_f32_16x16x32_bf16 v[204:207], v[160:163], v[32:35], 0
    v_mfma_f32_16x16x32_bf16 v[212:215], v[160:163], v[40:43], 0
    v_exp_f32 v189, v189
    v_mfma_f32_16x16x32_bf16 v[204:207], v[164:167], v[36:39], v[204:207]
    v_mfma_f32_16x16x32_bf16 v[212:215], v[164:167], v[44:47], v[212:215]
    v_exp_f32 v190, v190
    v_smfmac_f32_16x16x64_bf16 v[104:107], v[184:187], v[220:227], v255
    s_waitcnt lgkmcnt(0)
    v_bfi_b32 v236, 31, v246, v236
    v_bfi_b32 v237, 31, v246, v237
    v_exp_f32 v191, v191
    s_setprio 3
    v_smfmac_f32_16x16x64_bf16 v[108:111], v[184:187], v[228:235], v255
    v_exp_f32 v196, v196
    v_exp_f32 v197, v197
    v_exp_f32 v198, v198
    v_exp_f32 v199, v199
    v_pk_add_f32 v[188:189], v[188:189], 1.0 op_sel_hi:[1,0]
    v_pk_add_f32 v[190:191], v[190:191], 1.0 op_sel_hi:[1,0]
    v_pk_add_f32 v[196:197], v[196:197], 1.0 op_sel_hi:[1,0]
    v_pk_add_f32 v[198:199], v[198:199], 1.0 op_sel_hi:[1,0]
    s_setprio 0
    v_mfma_f32_16x16x32_bf16 v[220:223], v[176:179], v[88:91], 0
    ds_read_b64_tr_b16 v[184:185], v236
    ds_read_b64_tr_b16 v[186:187], v237
    v_mfma_f32_16x16x32_bf16 v[228:231], v[176:179], v[92:95], 0
    v_rcp_f32 v188, v188
    v_mfma_f32_16x16x32_bf16 v[220:223], v[160:163], v[16:19], v[220:223]
    v_rcp_f32 v189, v189
    v_mfma_f32_16x16x32_bf16 v[228:231], v[160:163], v[24:27], v[228:231]
    v_rcp_f32 v190, v190
    v_mfma_f32_16x16x32_bf16 v[220:223], v[164:167], v[20:23], v[220:223]
    v_rcp_f32 v191, v191
    s_setprio 3
    v_mfma_f32_16x16x32_bf16 v[228:231], v[164:167], v[28:31], v[228:231]
    v_rcp_f32 v196, v196
    v_rcp_f32 v197, v197
    v_rcp_f32 v198, v198
    v_rcp_f32 v199, v199
    v_pk_mul_f32 v[204:205], v[188:189], v[204:205]
    v_pk_mul_f32 v[206:207], v[190:191], v[206:207]
    v_pk_mul_f32 v[212:213], v[196:197], v[212:213]
    v_pk_mul_f32 v[214:215], v[198:199], v[214:215]
    s_setprio 0
    s_waitcnt lgkmcnt(0)
    v_smfmac_f32_16x16x64_bf16 v[144:147], v[184:187], v[204:211], v255
    v_smfmac_f32_16x16x64_bf16 v[148:151], v[184:187], v[212:219], v255
    v_exp_f32 v220, v220
    v_mfma_f32_16x16x32_bf16 v[204:207], v[160:163], v[48:51], 0
    v_mfma_f32_16x16x32_bf16 v[212:215], v[160:163], v[56:59], 0
    v_exp_f32 v221, v221
    v_mfma_f32_16x16x32_bf16 v[204:207], v[164:167], v[52:55], v[204:207]
    v_mfma_f32_16x16x32_bf16 v[212:215], v[164:167], v[60:63], v[212:215]
    v_exp_f32 v222, v222
    v_smfmac_f32_16x16x64_bf16 v[128:131], v[184:187], v[188:195], v255
    v_exp_f32 v223, v223
    s_setprio 3
    v_smfmac_f32_16x16x64_bf16 v[132:135], v[184:187], v[196:203], v255
    v_exp_f32 v228, v228
    v_exp_f32 v229, v229
    v_exp_f32 v230, v230
    v_exp_f32 v231, v231
    v_pk_add_f32 v[220:221], v[220:221], 1.0 op_sel_hi:[1,0]
    v_pk_add_f32 v[222:223], v[222:223], 1.0 op_sel_hi:[1,0]
    v_pk_add_f32 v[228:229], v[228:229], 1.0 op_sel_hi:[1,0]
    v_pk_add_f32 v[230:231], v[230:231], 1.0 op_sel_hi:[1,0]
    s_setprio 0
    v_rcp_f32 v220, v220
    v_rcp_f32 v221, v221
    v_rcp_f32 v222, v222
    v_rcp_f32 v223, v223
    v_rcp_f32 v228, v228
    v_rcp_f32 v229, v229
    v_rcp_f32 v230, v230
    v_rcp_f32 v231, v231
    v_pk_mul_f32 v[204:205], v[220:221], v[204:205]
    v_pk_mul_f32 v[206:207], v[222:223], v[206:207]
    v_pk_mul_f32 v[212:213], v[228:229], v[212:213]
    v_pk_mul_f32 v[214:215], v[230:231], v[214:215]
    v_smfmac_f32_16x16x64_bf16 v[136:139], v[184:187], v[220:227], v255
    v_smfmac_f32_16x16x64_bf16 v[140:143], v[184:187], v[228:235], v255
    v_smfmac_f32_16x16x64_bf16 v[152:155], v[184:187], v[204:211], v255
    v_smfmac_f32_16x16x64_bf16 v[156:159], v[184:187], v[212:219], v255
    s_branch L_DONE
L_DONE:
    v_mbcnt_lo_u32_b32 v253, -1, 0
    v_mbcnt_hi_u32_b32 v253, -1, v253
    v_and_b32 v246, 24, v246
    s_cmp_lg_u32 s19, 0
    s_cbranch_scc1 L_SLOW
L_EPI:
    s_waitcnt lgkmcnt(0)
    v_and_b32 v64, 48, v253
    v_and_b32 v67, 15, v253
    v_add_u32 v69, s72, v64
    v_lshl_add_u32 v70, v67, 2, s72
    ds_read_b128 v[80:83], v69 offset:0
    ds_read_b128 v[84:87], v69 offset:64
    ds_read2_b32 v[72:73], v70 offset0:0 offset1:16
    v_bfe_u32 v65, v253, 2, 3
    v_lshrrev_b32 v66, 5, v253
    v_lshl_add_u32 v65, v66, 4, v65
    v_mul_u32_u24 v65, 160, v65
    s_mov_b32 s10, 143488
    v_add3_u32 v65, v65, v246, s10
    ds_read_b64_tr_b16 v[0:1], v65 offset:0
    ds_read_b64_tr_b16 v[2:3], v65 offset:1280
    ds_read_b64_tr_b16 v[8:9], v65 offset:32
    ds_read_b64_tr_b16 v[10:11], v65 offset:1312
    ds_read_b64_tr_b16 v[16:17], v65 offset:64
    ds_read_b64_tr_b16 v[18:19], v65 offset:1344
    ds_read_b64_tr_b16 v[24:25], v65 offset:96
    ds_read_b64_tr_b16 v[26:27], v65 offset:1376
    ds_read_b64_tr_b16 v[4:5], v65 offset:5120
    ds_read_b64_tr_b16 v[6:7], v65 offset:6400
    ds_read_b64_tr_b16 v[12:13], v65 offset:5152
    ds_read_b64_tr_b16 v[14:15], v65 offset:6432
    s_movk_i32 s10, 832
    v_mad_u32_u24 v64, v246, s10, v64
    s_mov_b32 s10, 116736
    v_lshl_add_u32 v69, v67, 3, s10
    v_lshl_add_u32 v74, v67, 3, s73
    v_lshl_add_u32 v75, v67, 3, s74
    s_waitcnt lgkmcnt(8)
    ds_read_b64_tr_b16 v[20:21], v65 offset:5184
    ds_read_b64_tr_b16 v[22:23], v65 offset:6464
    ds_read_b64_tr_b16 v[28:29], v65 offset:5216
    ds_read_b64_tr_b16 v[30:31], v65 offset:6496
    v_add_u32 v76, v80, v69
    ds_read_b64 v[32:33], v76 offset:0
    v_add_u32 v76, v81, v69
    ds_read_b64 v[34:35], v76 offset:6656
    v_add_u32 v76, v82, v69
    ds_read_b64 v[36:37], v76 offset:13312
    v_add_u32 v76, v83, v69
    ds_read_b64 v[38:39], v76 offset:19968
    v_add_u32 v76, v84, v69
    ds_read_b64 v[40:41], v76 offset:0
    v_add_u32 v76, v85, v69
    ds_read_b64 v[42:43], v76 offset:6656
    v_add_u32 v76, v86, v69
    ds_read_b64 v[44:45], v76 offset:13312
    v_add_u32 v76, v87, v69
    ds_read_b64 v[46:47], v76 offset:19968
    v_add3_u32 v72, v72, v64, s10
    ds_read_b128 v[160:163], v72 offset:0
    ds_read_b128 v[164:167], v72 offset:64
    v_add3_u32 v73, v73, v64, s10
    ds_read_b128 v[168:171], v73 offset:0
    ds_read_b128 v[172:175], v73 offset:64
    s_waitcnt lgkmcnt(0)
    v_lshlrev_b32 v188, 16, v32
    v_lshlrev_b32 v189, 16, v34
    v_lshlrev_b32 v190, 16, v36
    v_lshlrev_b32 v191, 16, v38
    v_and_b32 v192, 0xffff0000, v32
    v_and_b32 v193, 0xffff0000, v34
    v_and_b32 v194, 0xffff0000, v36
    v_and_b32 v195, 0xffff0000, v38
    v_mfma_f32_16x16x32_bf16 v[188:191], v[160:163], v[0:3], v[188:191]
    v_lshlrev_b32 v196, 16, v33
    v_lshlrev_b32 v197, 16, v35
    v_lshlrev_b32 v198, 16, v37
    v_lshlrev_b32 v199, 16, v39
    v_lshl_add_u32 v80, v80, 2, v74
    v_mfma_f32_16x16x32_bf16 v[188:191], v[164:167], v[4:7], v[188:191]
    v_mfma_f32_16x16x32_bf16 v[192:195], v[160:163], v[8:11], v[192:195]
    v_and_b32 v200, 0xffff0000, v33
    v_and_b32 v201, 0xffff0000, v35
    v_and_b32 v202, 0xffff0000, v37
    v_and_b32 v203, 0xffff0000, v39
    v_lshl_add_u32 v81, v81, 2, v74
    v_mfma_f32_16x16x32_bf16 v[192:195], v[164:167], v[12:15], v[192:195]
    v_mfma_f32_16x16x32_bf16 v[196:199], v[160:163], v[16:19], v[196:199]
    v_lshlrev_b32 v48, 16, v40
    v_lshlrev_b32 v49, 16, v42
    v_lshlrev_b32 v50, 16, v44
    v_lshlrev_b32 v51, 16, v46
    v_lshl_add_u32 v82, v82, 2, v74
    v_mfma_f32_16x16x32_bf16 v[196:199], v[164:167], v[20:23], v[196:199]
    v_mfma_f32_16x16x32_bf16 v[200:203], v[160:163], v[24:27], v[200:203]
    v_and_b32 v52, 0xffff0000, v40
    v_and_b32 v53, 0xffff0000, v42
    v_and_b32 v54, 0xffff0000, v44
    v_and_b32 v55, 0xffff0000, v46
    v_lshl_add_u32 v83, v83, 2, v74
    v_mfma_f32_16x16x32_bf16 v[200:203], v[164:167], v[28:31], v[200:203]
    v_mfma_f32_16x16x32_bf16 v[48:51], v[168:171], v[0:3], v[48:51]
    v_lshlrev_b32 v56, 16, v41
    v_lshlrev_b32 v57, 16, v43
    v_lshlrev_b32 v58, 16, v45
    v_lshlrev_b32 v59, 16, v47
    v_lshl_add_u32 v84, v84, 2, v75
    v_mfma_f32_16x16x32_bf16 v[48:51], v[172:175], v[4:7], v[48:51]
    v_mfma_f32_16x16x32_bf16 v[52:55], v[168:171], v[8:11], v[52:55]
    v_and_b32 v60, 0xffff0000, v41
    v_and_b32 v61, 0xffff0000, v43
    v_and_b32 v62, 0xffff0000, v45
    v_and_b32 v63, 0xffff0000, v47
    v_lshl_add_u32 v85, v85, 2, v75
    v_mfma_f32_16x16x32_bf16 v[52:55], v[172:175], v[12:15], v[52:55]
    v_mfma_f32_16x16x32_bf16 v[56:59], v[168:171], v[16:19], v[56:59]
    v_lshl_add_u32 v86, v86, 2, v75
    v_mfma_f32_16x16x32_bf16 v[56:59], v[172:175], v[20:23], v[56:59]
    v_mfma_f32_16x16x32_bf16 v[60:63], v[168:171], v[24:27], v[60:63]
    v_lshl_add_u32 v87, v87, 2, v75
    v_mfma_f32_16x16x32_bf16 v[60:63], v[172:175], v[28:31], v[60:63]
L_EPB:
    s_setprio 0
    s_mov_b64 exec, s[76:77]
    s_and_b32 s11, s25, 19
    s_nop 2
    s_cmp_eq_u32 s11, 0
    s_cbranch_scc1 L_NS0
    s_cmp_eq_u32 s11, 1
    s_cbranch_scc1 L_NS1
    s_cmp_eq_u32 s11, 2
    s_cbranch_scc1 L_NS2
    s_cmp_eq_u32 s11, 3
    s_cbranch_scc1 L_NS3
L_NSR:
    s_mov_b64 exec, -1
    v_rcp_f32 v96, v96
    v_rcp_f32 v97, v97
    v_rcp_f32 v98, v98
    v_rcp_f32 v99, v99
    v_rcp_f32 v100, v100
    v_rcp_f32 v101, v101
    v_rcp_f32 v102, v102
    v_rcp_f32 v103, v103
    v_rcp_f32 v104, v104
    v_rcp_f32 v105, v105
    v_rcp_f32 v106, v106
    v_rcp_f32 v107, v107
    v_rcp_f32 v108, v108
    v_rcp_f32 v109, v109
    v_rcp_f32 v110, v110
    v_rcp_f32 v111, v111
    v_pk_fma_f32 v[112:113], v[112:113], v[96:97], v[188:189]
    v_pk_fma_f32 v[114:115], v[114:115], v[98:99], v[190:191]
    v_pk_fma_f32 v[116:117], v[116:117], v[100:101], v[192:193]
    v_pk_fma_f32 v[118:119], v[118:119], v[102:103], v[194:195]
    v_pk_fma_f32 v[120:121], v[120:121], v[104:105], v[196:197]
    v_pk_fma_f32 v[122:123], v[122:123], v[106:107], v[198:199]
    v_pk_fma_f32 v[124:125], v[124:125], v[108:109], v[200:201]
    v_pk_fma_f32 v[126:127], v[126:127], v[110:111], v[202:203]
    v_cvt_pk_bf16_f32 v96, v112, v116
    v_cvt_pk_bf16_f32 v97, v120, v124
    v_pk_max_f16 v96, v96, v32
    v_pk_max_f16 v97, v97, v33
    buffer_store_dwordx2 v[96:97], v80, s[48:51], 0 offen sc1
    v_cvt_pk_bf16_f32 v98, v113, v117
    v_cvt_pk_bf16_f32 v99, v121, v125
    v_pk_max_f16 v98, v98, v34
    v_pk_max_f16 v99, v99, v35
    buffer_store_dwordx2 v[98:99], v81, s[48:51], 0 offen sc1
    v_cvt_pk_bf16_f32 v100, v114, v118
    v_cvt_pk_bf16_f32 v101, v122, v126
    v_pk_max_f16 v100, v100, v36
    v_pk_max_f16 v101, v101, v37
    buffer_store_dwordx2 v[100:101], v82, s[48:51], 0 offen sc1
    v_cvt_pk_bf16_f32 v102, v115, v119
    v_cvt_pk_bf16_f32 v103, v123, v127
    v_pk_max_f16 v102, v102, v38
    v_pk_max_f16 v103, v103, v39
    buffer_store_dwordx2 v[102:103], v83, s[48:51], 0 offen sc1
    v_rcp_f32 v128, v128
    v_rcp_f32 v129, v129
    v_rcp_f32 v130, v130
    v_rcp_f32 v131, v131
    v_rcp_f32 v132, v132
    v_rcp_f32 v133, v133
    v_rcp_f32 v134, v134
    v_rcp_f32 v135, v135
    v_rcp_f32 v136, v136
    v_rcp_f32 v137, v137
    v_rcp_f32 v138, v138
    v_rcp_f32 v139, v139
    v_rcp_f32 v140, v140
    v_rcp_f32 v141, v141
    v_rcp_f32 v142, v142
    v_rcp_f32 v143, v143
    v_pk_fma_f32 v[144:145], v[144:145], v[128:129], v[48:49]
    v_pk_fma_f32 v[146:147], v[146:147], v[130:131], v[50:51]
    v_pk_fma_f32 v[148:149], v[148:149], v[132:133], v[52:53]
    v_pk_fma_f32 v[150:151], v[150:151], v[134:135], v[54:55]
    v_pk_fma_f32 v[152:153], v[152:153], v[136:137], v[56:57]
    v_pk_fma_f32 v[154:155], v[154:155], v[138:139], v[58:59]
    v_pk_fma_f32 v[156:157], v[156:157], v[140:141], v[60:61]
    v_pk_fma_f32 v[158:159], v[158:159], v[142:143], v[62:63]
    v_cvt_pk_bf16_f32 v128, v144, v148
    v_cvt_pk_bf16_f32 v129, v152, v156
    v_pk_max_f16 v128, v128, v40
    v_pk_max_f16 v129, v129, v41
    buffer_store_dwordx2 v[128:129], v84, s[60:63], 0 offen sc1
    v_cvt_pk_bf16_f32 v130, v145, v149
    v_cvt_pk_bf16_f32 v131, v153, v157
    v_pk_max_f16 v130, v130, v42
    v_pk_max_f16 v131, v131, v43
    buffer_store_dwordx2 v[130:131], v85, s[60:63], 0 offen sc1
    v_cvt_pk_bf16_f32 v132, v146, v150
    v_cvt_pk_bf16_f32 v133, v154, v158
    v_pk_max_f16 v132, v132, v44
    v_pk_max_f16 v133, v133, v45
    buffer_store_dwordx2 v[132:133], v86, s[60:63], 0 offen sc1
    v_cvt_pk_bf16_f32 v134, v147, v151
    v_cvt_pk_bf16_f32 v135, v155, v159
    v_pk_max_f16 v134, v134, v46
    v_pk_max_f16 v135, v135, v47
    buffer_store_dwordx2 v[134:135], v87, s[60:63], 0 offen sc1
L_END:
    s_endpgm
L_NS0:
    v_add_f32 v96, v96, v128
    v_add_f32 v100, v100, v132
    v_add_f32 v104, v104, v136
    v_add_f32 v108, v108, v140
    v_add_f32 v112, v112, v144
    v_add_f32 v116, v116, v148
    v_add_f32 v120, v120, v152
    v_add_f32 v124, v124, v156
    s_branch L_NSR
L_NS1:
    v_add_f32 v97, v97, v129
    v_add_f32 v101, v101, v133
    v_add_f32 v105, v105, v137
    v_add_f32 v109, v109, v141
    v_add_f32 v113, v113, v145
    v_add_f32 v117, v117, v149
    v_add_f32 v121, v121, v153
    v_add_f32 v125, v125, v157
    s_branch L_NSR
L_NS2:
    v_add_f32 v98, v98, v130
    v_add_f32 v102, v102, v134
    v_add_f32 v106, v106, v138
    v_add_f32 v110, v110, v142
    v_add_f32 v114, v114, v146
    v_add_f32 v118, v118, v150
    v_add_f32 v122, v122, v154
    v_add_f32 v126, v126, v158
    s_branch L_NSR
L_NS3:
    v_add_f32 v99, v99, v131
    v_add_f32 v103, v103, v135
    v_add_f32 v107, v107, v139
    v_add_f32 v111, v111, v143
    v_add_f32 v115, v115, v147
    v_add_f32 v119, v119, v151
    v_add_f32 v123, v123, v155
    v_add_f32 v127, v127, v159
    s_branch L_NSR
L_RT0:
    s_waitcnt vmcnt(0)
    s_add_u32 s100, s100, 1
    s_cmp_gt_u32 s100, 200000
    s_cbranch_scc1 L_END
    s_sleep 1
    buffer_load_dwordx4 v[128:131], v232, s[56:59], 0 offen sc1
    buffer_load_dwordx4 v[132:135], v232, s[56:59], s26 offen sc1
    buffer_load_dwordx4 v[136:139], v232, s[56:59], s27 offen sc1
    buffer_load_dwordx4 v[140:143], v232, s[56:59], s28 offen sc1
    s_waitcnt vmcnt(0)
    s_branch L_PW0
L_RT1:
    s_waitcnt vmcnt(0)
    s_add_u32 s100, s100, 1
    s_cmp_gt_u32 s100, 200000
    s_cbranch_scc1 L_END
    s_sleep 1
    buffer_load_dwordx4 v[132:135], v232, s[56:59], s26 offen sc1
    buffer_load_dwordx4 v[136:139], v232, s[56:59], s27 offen sc1
    buffer_load_dwordx4 v[140:143], v232, s[56:59], s28 offen sc1
    s_waitcnt vmcnt(0)
    s_branch L_PW1
L_RT2:
    s_waitcnt vmcnt(0)
    s_add_u32 s100, s100, 1
    s_cmp_gt_u32 s100, 200000
    s_cbranch_scc1 L_END
    s_sleep 1
    buffer_load_dwordx4 v[136:139], v232, s[56:59], s27 offen sc1
    buffer_load_dwordx4 v[140:143], v232, s[56:59], s28 offen sc1
    s_waitcnt vmcnt(0)
    s_branch L_PW2
L_RT3:
    s_waitcnt vmcnt(0)
    s_add_u32 s100, s100, 1
    s_cmp_gt_u32 s100, 200000
    s_cbranch_scc1 L_END
    s_sleep 1
    buffer_load_dwordx4 v[140:143], v232, s[56:59], s28 offen sc1
    s_waitcnt vmcnt(0)
    s_branch L_PW3
L_XT2B:
    s_add_u32 s100, s100, 1
    s_cmp_gt_u32 s100, 200000
    s_cbranch_scc1 L_END
    s_sleep 1
    s_mov_b64 exec, s[70:71]
    s_cbranch_execz L_XLb0
    s_movk_i32 s10, 0
    buffer_load_dwordx4 v[64:67], v232, s[60:63], s10 offen sc1
L_XLb0:
    s_mov_b64 exec, s[78:79]
    s_cbranch_execz L_XLb1
    s_movk_i32 s10, 8192
    buffer_load_dwordx4 v[68:71], v232, s[60:63], s10 offen sc1
L_XLb1:
    s_mov_b64 exec, s[86:87]
    s_cbranch_execz L_XLb2
    s_movk_i32 s10, 16384
    buffer_load_dwordx4 v[72:75], v232, s[60:63], s10 offen sc1
L_XLb2:
    s_mov_b64 exec, s[94:95]
    s_cbranch_execz L_XLb3
    s_movk_i32 s10, 24576
    buffer_load_dwordx4 v[76:79], v232, s[60:63], s10 offen sc1
L_XLb3:
    s_mov_b64 exec, -1
    s_waitcnt vmcnt(0)
    s_branch L_XT2
L_OVF:
    s_mov_b32 s20, 0
    s_mov_b32 s17, 0
    s_mov_b32 s30, 0
    s_mov_b32 s19, 4
    s_waitcnt lgkmcnt(0)
    s_branch L_CA
L_POVF:
    s_movk_i32 s11, 1986
    v_mul_u32_u24 v64, s11, v192
    v_lshrrev_b32 v64, 16, v64
    v_mul_u32_u24 v65, s11, v193
    v_lshrrev_b32 v65, 16, v65
    v_mul_u32_u24 v66, s11, v194
    v_lshrrev_b32 v66, 16, v66
    v_mul_u32_u24 v67, s11, v195
    v_lshrrev_b32 v67, 16, v67
    v_add_u32 v69, v64, v65
    v_add_u32 v70, v69, v66
    v_add_u32 v71, v70, v67
    v_mov_b32 v72, v71
    s_nop 1
    v_add_u32_dpp v72, v72, v72 row_shr:1 row_mask:0xf bank_mask:0xf bound_ctrl:0
    s_nop 1
    v_add_u32_dpp v72, v72, v72 row_shr:2 row_mask:0xf bank_mask:0xf bound_ctrl:0
    s_nop 1
    v_add_u32_dpp v72, v72, v72 row_shr:4 row_mask:0xf bank_mask:0xf bound_ctrl:0
    s_nop 1
    v_add_u32_dpp v72, v72, v72 row_shr:8 row_mask:0xf bank_mask:0xf bound_ctrl:0
    s_nop 1
    v_add_u32_dpp v72, v72, v72 row_bcast:15 row_mask:0xa bank_mask:0xf
    s_nop 1
    v_add_u32_dpp v72, v72, v72 row_bcast:31 row_mask:0xc bank_mask:0xf
    s_nop 0
    v_sub_u32 v68, v72, v71
    v_add_u32 v71, v68, v70
    v_add_u32 v70, v68, v69
    v_add_u32 v69, v68, v64
    v_lshl_or_b32 v68, v64, 16, v68
    v_lshl_or_b32 v69, v65, 16, v69
    v_lshl_or_b32 v70, v66, 16, v70
    v_lshl_or_b32 v71, v67, 16, v71
    v_add_u32 v72, 154752, v185
    ds_write_b128 v72, v[68:71]
    s_lshl_b32 s10, s2, 10
    s_add_u32 s10, s10, 24772608
    buffer_store_dwordx4 v[68:71], v185, s[52:55], s10 offen sc1
    v_and_b32 v74, 0x3fc, v136
    v_add_u32 v74, 154752, v74
    ds_read_u16 v74, v74
    v_and_b32 v75, 0x3fc, v137
    v_add_u32 v75, 154752, v75
    ds_read_u16 v75, v75
    v_and_b32 v76, 0x3fc, v138
    v_add_u32 v76, 154752, v76
    ds_read_u16 v76, v76
    v_and_b32 v77, 0x3fc, v139
    v_add_u32 v77, 154752, v77
    ds_read_u16 v77, v77
    v_and_b32 v78, 0x3fc, v140
    v_add_u32 v78, 154752, v78
    ds_read_u16 v78, v78
    v_and_b32 v79, 0x3fc, v141
    v_add_u32 v79, 154752, v79
    ds_read_u16 v79, v79
    v_and_b32 v80, 0x3fc, v142
    v_add_u32 v80, 154752, v80
    ds_read_u16 v80, v80
    v_and_b32 v81, 0x3fc, v143
    v_add_u32 v81, 154752, v81
    ds_read_u16 v81, v81
    s_waitcnt lgkmcnt(0)
    v_cmpx_lt_u32 vcc, 1056, v228
    v_or_b32 v205, 0x10000, v205
    s_mov_b64 exec, -1
    v_cmpx_lt_u32 vcc, 1056, v229
    v_or_b32 v209, 0x10000, v209
    s_mov_b64 exec, -1
    v_cmpx_lt_u32 vcc, 1056, v230
    v_or_b32 v213, 0x10000, v213
    s_mov_b64 exec, -1
    v_cmpx_lt_u32 vcc, 1056, v231
    v_or_b32 v217, 0x10000, v217
    s_mov_b64 exec, -1
    s_mul_i32 s10, s2, 4152
    s_mov_b32 s34, 18874368
    s_mov_b32 s35, 23592960
    v_mul_u32_u24 v64, s11, v112
    v_lshrrev_b32 v64, 16, v64
    v_add3_u32 v64, v64, v74, s10
    v_lshlrev_b32 v65, 2, v64
    v_cmpx_le_u32 vcc, 1056, v112
    s_cbranch_execz L_PO0
    buffer_store_byte v120, v64, s[52:55], s35 offen sc1
    buffer_store_dword v96, v65, s[52:55], s34 offen sc1
L_PO0:
    s_mov_b64 exec, -1
    v_mul_u32_u24 v64, s11, v113
    v_lshrrev_b32 v64, 16, v64
    v_add3_u32 v64, v64, v75, s10
    v_lshlrev_b32 v65, 2, v64
    v_cmpx_le_u32 vcc, 1056, v113
    s_cbranch_execz L_PO1
    buffer_store_byte v121, v64, s[52:55], s35 offen sc1
    buffer_store_dword v97, v65, s[52:55], s34 offen sc1
L_PO1:
    s_mov_b64 exec, -1
    v_mul_u32_u24 v64, s11, v114
    v_lshrrev_b32 v64, 16, v64
    v_add3_u32 v64, v64, v76, s10
    v_lshlrev_b32 v65, 2, v64
    v_cmpx_le_u32 vcc, 1056, v114
    s_cbranch_execz L_PO2
    buffer_store_byte v122, v64, s[52:55], s35 offen sc1
    buffer_store_dword v98, v65, s[52:55], s34 offen sc1
L_PO2:
    s_mov_b64 exec, -1
    v_mul_u32_u24 v64, s11, v115
    v_lshrrev_b32 v64, 16, v64
    v_add3_u32 v64, v64, v77, s10
    v_lshlrev_b32 v65, 2, v64
    v_cmpx_le_u32 vcc, 1056, v115
    s_cbranch_execz L_PO3
    buffer_store_byte v123, v64, s[52:55], s35 offen sc1
    buffer_store_dword v99, v65, s[52:55], s34 offen sc1
L_PO3:
    s_mov_b64 exec, -1
    v_mul_u32_u24 v64, s11, v116
    v_lshrrev_b32 v64, 16, v64
    v_add3_u32 v64, v64, v78, s10
    v_lshlrev_b32 v65, 2, v64
    v_cmpx_le_u32 vcc, 1056, v116
    s_cbranch_execz L_PO4
    buffer_store_byte v120, v64, s[52:55], s35 offen sc1
    buffer_store_dword v100, v65, s[52:55], s34 offen sc1
L_PO4:
    s_mov_b64 exec, -1
    v_mul_u32_u24 v64, s11, v117
    v_lshrrev_b32 v64, 16, v64
    v_add3_u32 v64, v64, v79, s10
    v_lshlrev_b32 v65, 2, v64
    v_cmpx_le_u32 vcc, 1056, v117
    s_cbranch_execz L_PO5
    buffer_store_byte v121, v64, s[52:55], s35 offen sc1
    buffer_store_dword v101, v65, s[52:55], s34 offen sc1
L_PO5:
    s_mov_b64 exec, -1
    v_mul_u32_u24 v64, s11, v118
    v_lshrrev_b32 v64, 16, v64
    v_add3_u32 v64, v64, v80, s10
    v_lshlrev_b32 v65, 2, v64
    v_cmpx_le_u32 vcc, 1056, v118
    s_cbranch_execz L_PO6
    buffer_store_byte v122, v64, s[52:55], s35 offen sc1
    buffer_store_dword v102, v65, s[52:55], s34 offen sc1
L_PO6:
    s_mov_b64 exec, -1
    v_mul_u32_u24 v64, s11, v119
    v_lshrrev_b32 v64, 16, v64
    v_add3_u32 v64, v64, v81, s10
    v_lshlrev_b32 v65, 2, v64
    v_cmpx_le_u32 vcc, 1056, v119
    s_cbranch_execz L_PO7
    buffer_store_byte v123, v64, s[52:55], s35 offen sc1
    buffer_store_dword v103, v65, s[52:55], s34 offen sc1
L_PO7:
    s_mov_b64 exec, -1
    s_waitcnt vmcnt(0) lgkmcnt(0)
    s_barrier
    s_branch L_POUT
L_SLOW:
    s_setprio 0
    s_lshl_b32 s10, s3, 6
    v_add_u32 v255, s10, v253
    s_cmp_lg_u32 s19, 4
    s_cbranch_scc1 L_SL1
    s_mov_b32 s19, 1
    v_and_b32 v188, 0xff, v255
    v_lshlrev_b32 v189, 7, v188
    buffer_load_dword v190, v189, s[56:59], 0 offen offset:4 sc1
    v_lshlrev_b32 v189, 10, v188
    s_lshl_b32 s10, s5, 2
    s_add_u32 s10, s10, 24772608
    buffer_load_dword v191, v189, s[52:55], s10 offen sc1
    v_lshlrev_b32 v188, 2, v188
    v_add_u32 v188, 154752, v188
    s_waitcnt vmcnt(0)
    v_and_b32 v190, 0x10000, v190
    v_cmp_ne_u32 vcc, 0, v190
    v_mov_b32 v190, 2097152
    s_nop 0
    v_cndmask_b32 v190, v190, v191, vcc
    ds_write_b32 v188, v190
    s_waitcnt lgkmcnt(0)
    s_barrier
L_SL1:
    s_add_u32 s28, s28, 288
    s_cmp_lt_u32 s28, s29
    s_cbranch_scc1 L_BATCH
L_FIND:
    s_cmp_lg_u64 s[32:33], 0
    s_cbranch_scc1 L_GOT
    s_add_u32 s26, s26, 1
    s_cmp_ge_u32 s26, 4
    s_cbranch_scc1 L_EPI
    s_lshl_b32 s10, s26, 8
    s_add_u32 s10, s10, 154752
    v_lshl_add_u32 v188, v253, 2, s10
    ds_read_u16 v188, v188 offset:2
    s_waitcnt lgkmcnt(0)
    v_cmp_lt_u32 s[32:33], s20, v188
    s_nop 3
    s_branch L_FIND
L_GOT:
    s_ff1_i32_b64 s10, s[32:33]
    s_bitset0_b64 s[32:33], s10
    s_lshl_b32 s11, s26, 6
    s_add_u32 s27, s10, s11
    s_lshl_b32 s10, s27, 2
    s_add_u32 s10, s10, 154752
    v_mov_b32 v188, s10
    ds_read_b32 v188, v188
    s_waitcnt lgkmcnt(0)
    v_readfirstlane_b32 s10, v188
    s_nop 3
    s_lshr_b32 s29, s10, 16
    s_and_b32 s30, s10, 0xffff
    s_mov_b32 s28, s20
L_BATCH:
    s_waitcnt vmcnt(0)
    s_barrier
    v_mov_b64 v[192:193], 0
    v_mov_b64 v[194:195], 0
    v_mov_b32 v196, 0x20fffff
    v_mov_b32 v197, 0x20fffff
    v_mov_b32 v198, 0x20fffff
    v_mov_b32 v199, 0x20fffff
    v_lshl_add_u32 v200, v253, 4, s12
    ds_write_b128 v200, v[192:195] offset:0
    ds_write_b128 v200, v[196:199] offset:18432
    ds_write_b128 v200, v[192:195] offset:1024
    ds_write_b128 v200, v[196:199] offset:19456
    ds_write_b128 v200, v[192:195] offset:1280
    ds_write_b128 v200, v[196:199] offset:19712
    v_and_b32 v188, 15, v253
    v_mul_u32_u24 v189, 1152, v188
    v_add_u32 v189, 8192, v189
    v_lshlrev_b32 v188, 2, v188
    ds_write_b32 v188, v189 offset:576
    v_add_u32 v188, s28, v255
    s_mul_i32 s36, s27, 3128
    s_mul_i32 s11, s27, 4152
    s_add_u32 s11, s11, s30
    s_lshl_b32 s34, s11, 2
    s_add_u32 s34, s34, 18874368
    v_lshl_add_u32 v190, v188, 2, s34
    s_add_u32 s34, s11, 23592960
    v_add_u32 v191, s34, v188
    s_mul_i32 s10, s5, 32896
    s_lshl_b32 s34, s27, 7
    s_add_u32 s10, s10, s34
    s_add_u32 s10, s10, 65536
    v_and_b32 v206, 7, v188
    v_lshl_add_u32 v206, v206, 4, s10
    v_lshrrev_b32 v207, 3, v188
    v_cmpx_gt_u32 vcc, 32, v188
    v_add_u32 v190, 8421376, v206
    v_add_u32 v191, 8, v190
    v_cmpx_gt_u32 vcc, 24, v188
    v_lshl_add_u32 v190, v207, 2, v206
    v_add3_u32 v191, v206, v207, 12
    s_mov_b64 exec, -1
    s_add_u32 s10, s28, 288
    s_min_u32 s10, s10, s29
    v_cmp_gt_u32 vcc, s10, v188
    v_mov_b32 v206, 0x7ffffff0
    s_nop 0
    v_cndmask_b32 v190, v206, v190, vcc
    v_cndmask_b32 v191, v206, v191, vcc
    buffer_load_dwordx2 v[204:205], v190, s[52:55], 0 offen sc1
    buffer_load_ubyte v191, v191, s[52:55], 0 offen sc1
    s_waitcnt lgkmcnt(0)
    s_barrier
    s_waitcnt vmcnt(0)
    v_cmp_ne_u32 vcc, 3, v207
    v_cmp_eq_u32 s[10:11], s6, v205
    v_mov_b32 v206, s36
    s_or_b64 exec, vcc, s[10:11]
    v_cmpx_ne_u32 vcc, 0, v204
    v_bfe_u32 v190, v204, 18, 8
    v_lshlrev_b32 v190, 2, v190
    v_add_u32 v188, 153728, v190
    ds_read_b32 v188, v188
    v_add_u32_sdwa v191, v191, v206 dst_sel:DWORD dst_unused:UNUSED_PAD src0_sel:BYTE_0 src1_sel:DWORD
    v_lshrrev_b32 v189, 28, v204
    v_lshl_add_u32 v191, v189, 8, v191
    v_and_b32 v189, 60, v190
    v_lshl_add_u32 v191, v189, 19, v191
    v_mov_b32 v190, 4
    v_and_b32 v204, 0xffff, v204
    s_waitcnt lgkmcnt(0)
    ds_add_rtn_u32 v188, v188, v190 offset:576
    s_waitcnt lgkmcnt(0)
    ds_write2st64_b32 v188, v204, v191 offset0:148 offset1:220
    s_mov_b64 exec, -1
    s_waitcnt lgkmcnt(0)
    s_barrier
    v_lshrrev_b32 v190, 3, v253
    v_lshl_add_u32 v247, v190, 4, s12
    s_add_u32 s10, s12, 18432
    v_lshrrev_b32 v190, 1, v253
    v_lshl_add_u32 v248, v190, 2, s10
    s_add_u32 s10, s10, 2
    v_and_b32 v190, 48, v253
    v_lshl_add_u32 v250, v190, 1, s10
    v_and_b32 v190, 12, v253
    v_add_u32 v250, v250, v190
    v_lshrrev_b32 v190, 5, v253
    v_mul_u32_u24 v249, 18432, v190
    v_and_b32 v190, 15, v253
    v_lshl_add_u32 v249, v190, 2, v249
    s_add_u32 s10, s12, 2
    v_add_u32 v249, s10, v249
    ds_read_b128 v[236:239], v247
    ds_read_b32 v240, v248
    s_lshl_b32 s10, s4, 3
    v_mov_b32 v190, s10
    ds_read_b64 v[190:191], v190 offset:576
    s_waitcnt lgkmcnt(0)
    v_readfirstlane_b32 s34, v190
    v_readfirstlane_b32 s35, v191
    s_sub_u32 s10, s12, 37888
    s_sub_u32 s34, s34, s10
    s_sub_u32 s35, s35, s10
    s_sub_u32 s35, s35, 1152
    s_add_u32 s10, s34, 127
    s_lshr_b32 s10, s10, 7
    s_lshl1_add_u32 s10, s10, -1
    s_add_u32 s11, s35, 127
    s_lshr_b32 s11, s11, 6
    s_and_b32 s11, s11, -2
    s_max_i32 s17, s10, s11
    s_cselect_b32 s10, s34, s35
    s_sub_u32 s10, s10, 1
    s_andn2_b32 s99, 64, s10
    v_mov_b64 v[204:205], 0
    v_mov_b64 v[206:207], 0
    v_mov_b64 v[184:185], 0
    v_mov_b64 v[186:187], 0
    s_add_u32 m0, s13, 0
    v_mad_u32_u16 v236, v236, s15, v243
    buffer_load_dwordx4 v236, s[40:43], 0 offen lds
    s_add_u32 m0, s13, 1056
    v_mad_u32_u16 v237, v237, s15, v243
    buffer_load_dwordx4 v237, s[40:43], 0 offen lds
    s_add_u32 m0, s13, 2112
    v_mad_u32_u16 v238, v238, s15, v243
    buffer_load_dwordx4 v238, s[40:43], 0 offen lds
    s_add_u32 m0, s13, 3168
    v_mad_u32_u16 v239, v239, s15, v243
    buffer_load_dwordx4 v239, s[40:43], 0 offen lds
    s_mov_b32 m0, s14
    v_and_b32 v240, 0xfffff, v240
    buffer_load_dwordx4 v[240:241], s[44:47], 0 idxen offen lds
L_LAST:
    s_branch L_GO
.section .rodata,"a"
.p2align 6
.amdhsa_kernel standalone__edge_featured_mpnn_gatedgcn__graph_kernel
  .amdhsa_next_free_vgpr 256
  .amdhsa_next_free_sgpr 102
  .amdhsa_accum_offset 256
  .amdhsa_group_segment_fixed_size 0
  .amdhsa_kernarg_size 96
  .amdhsa_user_sgpr_count 2
  .amdhsa_user_sgpr_kernarg_segment_ptr 1
  .amdhsa_system_sgpr_workgroup_id_x 1
.end_amdhsa_kernel
```

```asm
; @launch grid=(256,1,1) block=(512,1,1) lds=158848
.amdgcn_target "amdgcn-amd-amdhsa--gfx950"
.text
.globl standalone__edge_featured_mpnn_gatedgcn__graph_kernel
.p2align 8
.type standalone__edge_featured_mpnn_gatedgcn__graph_kernel,@function
standalone__edge_featured_mpnn_gatedgcn__graph_kernel:
    s_load_dwordx16 s[16:31], s[0:1], 0
    s_load_dwordx8 s[32:39], s[0:1], 64
    s_getpc_b64 s[64:65]
L_PC:
    s_and_b32 s3, s2, -8
    v_add_lshl_u32 v1, v0, s3, 7
    v_min_u32 v1, L_LAST-L_PC, v1
    v_cmpx_gt_u32 vcc, 8, v0
    s_cbranch_execz L_NOCPF
    global_load_dword v252, v1, s[64:65]
L_NOCPF:
    s_mov_b64 exec, -1
    s_cmp_ge_u32 s2, 256
    s_cbranch_scc1 L_END
    s_mul_i32 s10, s2, 12512
    v_lshl_add_u32 v1, v0, 4, s10
    s_add_u32 s11, s10, 12512
    s_min_u32 s11, s11, 3200000
    v_add_u32 v2, 0x2000, v1
    s_waitcnt lgkmcnt(0)
    global_load_dwordx4 v[128:131], v1, s[22:23] nt
    global_load_dwordx4 v[96:99], v1, s[20:21] nt
    v_cmpx_gt_u32 s[70:71], s11, v2
    s_cbranch_execz L_NO8
    global_load_dwordx4 v[132:135], v2, s[22:23] nt
    global_load_dwordx4 v[100:103], v2, s[20:21] nt
L_NO8:
    s_mov_b64 exec, -1
L_NO7:
    s_mov_b64 exec, -1
    s_load_dword s6, s[38:39], 0
    v_mov_b32 v255, v0
    v_lshrrev_b32 v188, 6, v0
    v_and_b32 v247, 63, v0
    v_readfirstlane_b32 s3, v188
    v_lshlrev_b32 v232, 4, v0
    v_lshlrev_b32 v190, 3, v0
    v_lshlrev_b32 v191, 2, v0
    v_and_b32 v192, 0x3fc, v191
    s_and_b32 s5, s2, 7
    s_lshr_b32 s4, s2, 3
    s_lshl_b32 s5, s5, 5
    s_add_u32 s5, s5, s4
    s_mul_i32 s9, s5, 196
    s_cmp_eq_u32 s3, 7
    s_cselect_b32 s101, 0, s3
    s_lshl_b32 s12, s101, 5
    s_add_u32 s9, s9, s12
    v_lshrrev_b32 v193, 3, v247
    v_lshl_add_u32 v193, v193, 2, s9
    v_and_b32 v243, 7, v247
    v_lshlrev_b32 v243, 4, v243
    v_lshl_add_u32 v234, v193, 7, v243
    s_lshl_b32 s101, s101, 10
    s_add_u32 s101, s101, 116736
    v_mov_b64 v[196:197], 0
    v_mov_b64 v[198:199], 0
    v_mov_b32 v194, 132
    ds_write2st64_b32 v192, v194, v196 offset0:20 offset1:24
    v_add_u32 v193, 46080, v232
    ds_write_b128 v193, v[196:199] offset:0
    ds_write_b128 v193, v[196:199] offset:8192
    ds_write_b128 v193, v[196:199] offset:16384
    ds_write_b128 v193, v[196:199] offset:24576
    ds_write_b128 v193, v[196:199] offset:32768
    s_mov_b32 s44, s18
    s_or_b32 s45, s19, 0x200000
    s_mov_b32 s46, 800000
    s_mov_b32 s47, 0x20000
    s_mov_b32 s48, s34
    s_mov_b32 s49, s35
    s_mov_b32 s50, 6400000
    s_mov_b32 s51, 0x20000
    s_mov_b32 s40, s16
    s_mov_b32 s41, s17
    s_mov_b32 s42, 6400000
    s_mov_b32 s43, 0x20000
    s_mov_b32 s52, s38
    s_mov_b32 s53, s39
    s_mov_b32 s54, 25165824
    s_mov_b32 s55, 0x20000
    s_lshl_b32 s12, s2, 7
    s_add_u32 s12, s12, 65536
    s_add_u32 s56, s38, s12
    s_addc_u32 s57, s39, 0
    s_mov_b32 s58, 16809984
    s_mov_b32 s59, 0x20000
    s_mov_b32 s64, 85599
    s_mov_b32 s65, 4294967100
    s_movk_i32 s66, 5368
    s_mov_b32 s67, 0xc000000
    s_mov_b32 s68, 32896
    s_mov_b32 s100, 0xffeff220
    v_add_u32 v120, 0, v191
    v_add_u32 v121, 1, v191
    v_add_u32 v122, 2, v191
    v_add_u32 v123, 3, v191
    s_lshl_b32 s10, s3, 28
    s_or_b32 s10, s10, 0x20000
    v_mov_b32 v144, s10
    v_or_b32 v145, 0x80000000, v144
    v_mov_b32 v184, 33
    v_mov_b32 v146, 0x400
    s_and_b32 s10, s3, 3
    s_lshr_b32 s4, s3, 2
    s_lshl1_add_u32 s4, s10, s4
    s_xor_b32 s4, s4, 1
    s_mul_i32 s10, s4, 49
    s_sub_i32 s10, s10, 6
    s_ashr_i32 s10, s10, 1
    s_max_i32 s7, s10, 0
    s_mul_i32 s13, s4, 4224
    s_add_u32 s13, s13, 82944
    s_lshl_b32 s14, s4, 10
    s_add_u32 s14, s14, 5120
    s_mul_i32 s12, s4, 2304
    s_add_u32 s12, s12, 46080
    s_movk_i32 s15, 128
    v_bfe_u32 v194, v255, 4, 4
    v_and_b32 v195, 7, v255
    v_cmp_eq_u32 vcc, v194, v195
    v_and_b32 v194, 8, v255
    v_lshlrev_b32 v194, 1, v194
    v_mov_b32 v196, 0x3f80
    v_lshlrev_b32 v196, v194, v196
    v_cndmask_b32 v196, 0, v196, vcc
    ds_write_b32 v192, v196 offset:0
    v_mov_b64 v[196:197], 0
    ds_write_b64 v190, v[196:197] offset:1024
    v_add_u32 v194, 155776, v191
    ds_write_b32 v194, v196
    v_lshrrev_b32 v223, 3, v255
    v_mad_u32_u24 v220, v223, s68, v243
    v_mul_u32_u24 v224, 160, v223
    v_add_u32 v221, v224, v243
    v_add_u32 v221, 46080, v221
    v_bfe_u32 v194, v255, 5, 1
    v_bfe_u32 v196, v255, 6, 1
    v_sub_u32 v194, v194, v196
    v_mul_i32_i24 v194, 640, v194
    v_add_u32 v224, v224, v194
    v_lshl_add_u32 v224, v195, 2, v224
    v_add_u32 v224, 13312, v224
    v_lshlrev_b32 v185, 4, v247
    v_and_b32 v194, 3, v247
    v_lshlrev_b32 v246, 3, v194
    v_bfe_u32 v197, v247, 2, 3
    v_lshrrev_b32 v196, 5, v247
    v_lshl_add_u32 v197, v196, 4, v197
    v_mul_u32_u24 v225, 160, v197
    v_add_u32 v225, v225, v246
    s_movk_i32 s69, 11520
    v_mov_b64 v[116:117], 0
    v_mov_b64 v[118:119], 0
    s_waitcnt lgkmcnt(0)
    s_barrier
    s_cmp_eq_u64 s[70:71], 0
    s_cbranch_scc1 L_R4
    s_waitcnt vmcnt(3)
    v_mul_u32_u24 v104, s64, v128
    v_mul_u32_u24 v105, s64, v129
    v_mul_u32_u24 v106, s64, v130
    v_mul_u32_u24 v107, s64, v131
    v_lshrrev_b32 v136, 29, v104
    v_lshrrev_b32 v137, 29, v105
    v_lshrrev_b32 v138, 29, v106
    v_lshrrev_b32 v139, 29, v107
    v_cmp_eq_u32 s[72:73], v136, v137
    v_cmp_eq_u32 s[76:77], v138, v139
    v_cmp_eq_u32 vcc, v136, v138
    v_cmp_eq_u32 s[88:89], v137, v139
    v_cmp_eq_u32 s[90:91], v136, v139
    v_cmp_eq_u32 s[10:11], v137, v138
    v_lshrrev_b32 v104, 24, v104
    v_lshrrev_b32 v105, 24, v105
    v_lshrrev_b32 v106, 24, v106
    v_lshrrev_b32 v107, 24, v107
    s_or_b64 s[74:75], s[72:73], s[88:89]
    s_or_b64 s[78:79], s[76:77], s[88:89]
    s_or_b64 s[72:73], s[72:73], vcc
    s_or_b64 s[76:77], s[76:77], vcc
    s_or_b64 s[72:73], s[72:73], s[90:91]
    s_or_b64 s[74:75], s[74:75], s[10:11]
    s_or_b64 s[76:77], s[76:77], s[10:11]
    s_or_b64 s[78:79], s[78:79], s[90:91]
    v_cndmask_b32 v136, 0, v146, s[72:73]
    v_lshl_add_u32 v136, v104, 2, v136
    ds_add_rtn_u32 v112, v136, v184 offset:5120
    v_cndmask_b32 v137, 0, v146, s[74:75]
    v_lshl_add_u32 v137, v105, 2, v137
    ds_add_rtn_u32 v113, v137, v184 offset:5120
    v_cndmask_b32 v138, 0, v146, s[76:77]
    v_lshl_add_u32 v138, v106, 2, v138
    ds_add_rtn_u32 v114, v138, v184 offset:5120
    v_cndmask_b32 v139, 0, v146, s[78:79]
    v_lshl_add_u32 v139, v107, 2, v139
    ds_add_rtn_u32 v115, v139, v184 offset:5120
    s_waitcnt vmcnt(1)
    s_mov_b64 exec, s[70:71]
    v_mul_u32_u24 v108, s64, v132
    v_mul_u32_u24 v109, s64, v133
    v_mul_u32_u24 v110, s64, v134
    v_mul_u32_u24 v111, s64, v135
    v_lshrrev_b32 v108, 24, v108
    v_lshrrev_b32 v109, 24, v109
    v_lshrrev_b32 v110, 24, v110
    v_lshrrev_b32 v111, 24, v111
    v_lshlrev_b32 v140, 2, v108
    ds_add_rtn_u32 v116, v140, v184 offset:5120
    v_lshlrev_b32 v141, 2, v109
    ds_add_rtn_u32 v117, v141, v184 offset:5120
    v_lshlrev_b32 v142, 2, v110
    ds_add_rtn_u32 v118, v142, v184 offset:5120
    v_lshlrev_b32 v143, 2, v111
    ds_add_rtn_u32 v119, v143, v184 offset:5120
    s_waitcnt lgkmcnt(7)
    s_mov_b64 exec, s[72:73]
    v_cmpx_le_u32 vcc, 132, v112
    ds_add_rtn_u32 v112, v136, v184 offset:4096
    s_waitcnt lgkmcnt(7)
    s_mov_b64 exec, s[74:75]
    v_cmpx_le_u32 vcc, 132, v113
    ds_add_rtn_u32 v113, v137, v184 offset:4096
    s_waitcnt lgkmcnt(7)
    s_mov_b64 exec, s[76:77]
    v_cmpx_le_u32 vcc, 132, v114
    ds_add_rtn_u32 v114, v138, v184 offset:4096
    s_waitcnt lgkmcnt(7)
    s_mov_b64 exec, s[78:79]
    v_cmpx_le_u32 vcc, 132, v115
    ds_add_rtn_u32 v115, v139, v184 offset:4096
    s_mov_b64 exec, s[70:71]
    s_waitcnt vmcnt(0)
    v_mad_i32_i24 v132, v108, s65, v132
    v_mul_u32_u24 v194, s66, v100
    v_lshl_or_b32 v100, v132, 18, v100
    v_and_b32 v132, 0xe0, v108
    v_mad_i32_i24 v194, v132, s100, v194
    v_and_or_b32 v194, v194, s67, v145
    v_mad_u32_u24 v132, v108, 40, s69
    v_or_b32 v100, v100, v194
    v_mad_i32_i24 v133, v109, s65, v133
    v_mul_u32_u24 v194, s66, v101
    v_lshl_or_b32 v101, v133, 18, v101
    v_and_b32 v133, 0xe0, v109
    v_mad_i32_i24 v194, v133, s100, v194
    v_and_or_b32 v194, v194, s67, v145
    v_mad_u32_u24 v133, v109, 40, s69
    v_or_b32 v101, v101, v194
    v_mad_i32_i24 v134, v110, s65, v134
    v_mul_u32_u24 v194, s66, v102
    v_lshl_or_b32 v102, v134, 18, v102
    v_and_b32 v134, 0xe0, v110
    v_mad_i32_i24 v194, v134, s100, v194
    v_and_or_b32 v194, v194, s67, v145
    v_mad_u32_u24 v134, v110, 40, s69
    v_or_b32 v102, v102, v194
    v_mad_i32_i24 v135, v111, s65, v135
    v_mul_u32_u24 v194, s66, v103
    v_lshl_or_b32 v103, v135, 18, v103
    v_and_b32 v135, 0xe0, v111
    v_mad_i32_i24 v194, v135, s100, v194
    v_and_or_b32 v194, v194, s67, v145
    v_mad_u32_u24 v135, v111, 40, s69
    v_or_b32 v103, v103, v194
    s_waitcnt lgkmcnt(7)
    v_bfe_u32 v194, v116, 3, 5
    v_add_lshl_u32 v132, v194, v132, 2
    v_and_b32 v194, 3, v194
    v_mad_i32_i24 v194, v194, -3, v132
    v_cmpx_gt_u32 vcc, 792, v116
    ds_write_b32 v132, v100
    ds_write_b8 v194, v120 offset:12
    s_mov_b64 exec, s[70:71]
    s_waitcnt lgkmcnt(8)
    v_bfe_u32 v194, v117, 3, 5
    v_add_lshl_u32 v133, v194, v133, 2
    v_and_b32 v194, 3, v194
    v_mad_i32_i24 v194, v194, -3, v133
    v_cmpx_gt_u32 vcc, 792, v117
    ds_write_b32 v133, v101
    ds_write_b8 v194, v121 offset:12
    s_mov_b64 exec, s[70:71]
    s_waitcnt lgkmcnt(9)
    v_bfe_u32 v194, v118, 3, 5
    v_add_lshl_u32 v134, v194, v134, 2
    v_and_b32 v194, 3, v194
    v_mad_i32_i24 v194, v194, -3, v134
    v_cmpx_gt_u32 vcc, 792, v118
    ds_write_b32 v134, v102
    ds_write_b8 v194, v122 offset:12
    s_mov_b64 exec, s[70:71]
    s_waitcnt lgkmcnt(10)
    v_bfe_u32 v194, v119, 3, 5
    v_add_lshl_u32 v135, v194, v135, 2
    v_and_b32 v194, 3, v194
    v_mad_i32_i24 v194, v194, -3, v135
    v_cmpx_gt_u32 vcc, 792, v119
    ds_write_b32 v135, v103
    ds_write_b8 v194, v123 offset:12
    s_mov_b64 exec, -1
    v_mad_i32_i24 v128, v104, s65, v128
    v_mul_u32_u24 v194, s66, v96
    v_lshl_or_b32 v96, v128, 18, v96
    v_and_b32 v128, 0xe0, v104
    v_mad_i32_i24 v194, v128, s100, v194
    v_and_or_b32 v194, v194, s67, v144
    v_mad_u32_u24 v128, v104, 40, s69
    v_or_b32 v96, v96, v194
    v_mad_i32_i24 v129, v105, s65, v129
    v_mul_u32_u24 v194, s66, v97
    v_lshl_or_b32 v97, v129, 18, v97
    v_and_b32 v129, 0xe0, v105
    v_mad_i32_i24 v194, v129, s100, v194
    v_and_or_b32 v194, v194, s67, v144
    v_mad_u32_u24 v129, v105, 40, s69
    v_or_b32 v97, v97, v194
    v_mad_i32_i24 v130, v106, s65, v130
    v_mul_u32_u24 v194, s66, v98
    v_lshl_or_b32 v98, v130, 18, v98
    v_and_b32 v130, 0xe0, v106
    v_mad_i32_i24 v194, v130, s100, v194
    v_and_or_b32 v194, v194, s67, v144
    v_mad_u32_u24 v130, v106, 40, s69
    v_or_b32 v98, v98, v194
    v_mad_i32_i24 v131, v107, s65, v131
    v_mul_u32_u24 v194, s66, v99
    v_lshl_or_b32 v99, v131, 18, v99
    v_and_b32 v131, 0xe0, v107
    v_mad_i32_i24 v194, v131, s100, v194
    v_and_or_b32 v194, v194, s67, v144
    v_mad_u32_u24 v131, v107, 40, s69
    v_or_b32 v99, v99, v194
    s_waitcnt lgkmcnt(11)
    v_bfe_u32 v194, v112, 3, 5
    v_add_lshl_u32 v128, v194, v128, 2
    v_and_b32 v194, 3, v194
    v_mad_i32_i24 v194, v194, -3, v128
    v_cmpx_gt_u32 vcc, 792, v112
    ds_write_b32 v128, v96
    ds_write_b8 v194, v120 offset:12
    s_mov_b64 exec, -1
    s_waitcnt lgkmcnt(12)
    v_bfe_u32 v194, v113, 3, 5
    v_add_lshl_u32 v129, v194, v129, 2
    v_and_b32 v194, 3, v194
    v_mad_i32_i24 v194, v194, -3, v129
    v_cmpx_gt_u32 vcc, 792, v113
    ds_write_b32 v129, v97
    ds_write_b8 v194, v121 offset:12
    s_mov_b64 exec, -1
    s_waitcnt lgkmcnt(13)
    v_bfe_u32 v194, v114, 3, 5
    v_add_lshl_u32 v130, v194, v130, 2
    v_and_b32 v194, 3, v194
    v_mad_i32_i24 v194, v194, -3, v130
    v_cmpx_gt_u32 vcc, 792, v114
    ds_write_b32 v130, v98
    ds_write_b8 v194, v122 offset:12
    s_mov_b64 exec, -1
    s_waitcnt lgkmcnt(14)
    v_bfe_u32 v194, v115, 3, 5
    v_add_lshl_u32 v131, v194, v131, 2
    v_and_b32 v194, 3, v194
    v_mad_i32_i24 v194, v194, -3, v131
    v_cmpx_gt_u32 vcc, 792, v115
    ds_write_b32 v131, v99
    ds_write_b8 v194, v123 offset:12
    s_mov_b64 exec, -1
    s_branch L_B1
L_R4:
    s_waitcnt vmcnt(1)
    v_mul_u32_u24 v104, s64, v128
    v_mul_u32_u24 v105, s64, v129
    v_mul_u32_u24 v106, s64, v130
    v_mul_u32_u24 v107, s64, v131
    v_lshrrev_b32 v136, 29, v104
    v_lshrrev_b32 v137, 29, v105
    v_lshrrev_b32 v138, 29, v106
    v_lshrrev_b32 v139, 29, v107
    v_cmp_eq_u32 s[72:73], v136, v137
    v_cmp_eq_u32 s[76:77], v138, v139
    v_cmp_eq_u32 vcc, v136, v138
    v_cmp_eq_u32 s[88:89], v137, v139
    v_cmp_eq_u32 s[90:91], v136, v139
    v_cmp_eq_u32 s[10:11], v137, v138
    v_lshrrev_b32 v104, 24, v104
    v_lshrrev_b32 v105, 24, v105
    v_lshrrev_b32 v106, 24, v106
    v_lshrrev_b32 v107, 24, v107
    s_or_b64 s[74:75], s[72:73], s[88:89]
    s_or_b64 s[78:79], s[76:77], s[88:89]
    s_or_b64 s[72:73], s[72:73], vcc
    s_or_b64 s[76:77], s[76:77], vcc
    s_or_b64 s[72:73], s[72:73], s[90:91]
    s_or_b64 s[74:75], s[74:75], s[10:11]
    s_or_b64 s[76:77], s[76:77], s[10:11]
    s_or_b64 s[78:79], s[78:79], s[90:91]
    v_cndmask_b32 v136, 0, v146, s[72:73]
    v_lshl_add_u32 v136, v104, 2, v136
    ds_add_rtn_u32 v112, v136, v184 offset:5120
    v_cndmask_b32 v137, 0, v146, s[74:75]
    v_lshl_add_u32 v137, v105, 2, v137
    ds_add_rtn_u32 v113, v137, v184 offset:5120
    v_cndmask_b32 v138, 0, v146, s[76:77]
    v_lshl_add_u32 v138, v106, 2, v138
    ds_add_rtn_u32 v114, v138, v184 offset:5120
    v_cndmask_b32 v139, 0, v146, s[78:79]
    v_lshl_add_u32 v139, v107, 2, v139
    ds_add_rtn_u32 v115, v139, v184 offset:5120
    s_waitcnt vmcnt(0)
    v_mad_i32_i24 v128, v104, s65, v128
    v_mul_u32_u24 v194, s66, v96
    v_lshl_or_b32 v96, v128, 18, v96
    v_and_b32 v128, 0xe0, v104
    v_mad_i32_i24 v194, v128, s100, v194
    v_and_or_b32 v194, v194, s67, v144
    v_mad_u32_u24 v128, v104, 40, s69
    v_or_b32 v96, v96, v194
    v_mad_i32_i24 v129, v105, s65, v129
    v_mul_u32_u24 v194, s66, v97
    v_lshl_or_b32 v97, v129, 18, v97
    v_and_b32 v129, 0xe0, v105
    v_mad_i32_i24 v194, v129, s100, v194
    v_and_or_b32 v194, v194, s67, v144
    v_mad_u32_u24 v129, v105, 40, s69
    v_or_b32 v97, v97, v194
    s_waitcnt lgkmcnt(3)
    s_mov_b64 exec, s[72:73]
    v_cmpx_le_u32 vcc, 132, v112
    ds_add_rtn_u32 v112, v136, v184 offset:4096
    s_waitcnt lgkmcnt(3)
    s_mov_b64 exec, s[74:75]
    v_cmpx_le_u32 vcc, 132, v113
    ds_add_rtn_u32 v113, v137, v184 offset:4096
    s_waitcnt lgkmcnt(3)
    s_mov_b64 exec, s[76:77]
    v_cmpx_le_u32 vcc, 132, v114
    ds_add_rtn_u32 v114, v138, v184 offset:4096
    s_waitcnt lgkmcnt(3)
    s_mov_b64 exec, s[78:79]
    v_cmpx_le_u32 vcc, 132, v115
    ds_add_rtn_u32 v115, v139, v184 offset:4096
    s_mov_b64 exec, -1
    v_mad_i32_i24 v130, v106, s65, v130
    v_mul_u32_u24 v194, s66, v98
    v_lshl_or_b32 v98, v130, 18, v98
    v_and_b32 v130, 0xe0, v106
    v_mad_i32_i24 v194, v130, s100, v194
    v_and_or_b32 v194, v194, s67, v144
    v_mad_u32_u24 v130, v106, 40, s69
    v_or_b32 v98, v98, v194
    v_mad_i32_i24 v131, v107, s65, v131
    v_mul_u32_u24 v194, s66, v99
    v_lshl_or_b32 v99, v131, 18, v99
    v_and_b32 v131, 0xe0, v107
    v_mad_i32_i24 v194, v131, s100, v194
    v_and_or_b32 v194, v194, s67, v144
    v_mad_u32_u24 v131, v107, 40, s69
    v_or_b32 v99, v99, v194
    s_waitcnt lgkmcnt(3)
    v_bfe_u32 v194, v112, 3, 5
    v_add_lshl_u32 v128, v194, v128, 2
    v_and_b32 v194, 3, v194
    v_mad_i32_i24 v194, v194, -3, v128
    v_cmpx_gt_u32 vcc, 792, v112
    ds_write_b32 v128, v96
    ds_write_b8 v194, v120 offset:12
    s_mov_b64 exec, -1
    s_waitcnt lgkmcnt(4)
    v_bfe_u32 v194, v113, 3, 5
    v_add_lshl_u32 v129, v194, v129, 2
    v_and_b32 v194, 3, v194
    v_mad_i32_i24 v194, v194, -3, v129
    v_cmpx_gt_u32 vcc, 792, v113
    ds_write_b32 v129, v97
    ds_write_b8 v194, v121 offset:12
    s_mov_b64 exec, -1
    s_waitcnt lgkmcnt(5)
    v_bfe_u32 v194, v114, 3, 5
    v_add_lshl_u32 v130, v194, v130, 2
    v_and_b32 v194, 3, v194
    v_mad_i32_i24 v194, v194, -3, v130
    v_cmpx_gt_u32 vcc, 792, v114
    ds_write_b32 v130, v98
    ds_write_b8 v194, v122 offset:12
    s_mov_b64 exec, -1
    s_waitcnt lgkmcnt(6)
    v_bfe_u32 v194, v115, 3, 5
    v_add_lshl_u32 v131, v194, v131, 2
    v_and_b32 v194, 3, v194
    v_mad_i32_i24 v194, v194, -3, v131
    v_cmpx_gt_u32 vcc, 792, v115
    ds_write_b32 v131, v99
    ds_write_b8 v194, v123 offset:12
    s_mov_b64 exec, -1
L_B1:
    s_cmp_ge_u32 s3, 2
    s_cbranch_scc1 L_NOC
    global_load_dwordx4 v[176:179], v232, s[28:29]
L_NOC:
    global_load_dwordx4 v[160:163], v232, s[26:27]
    global_load_dwordx4 v[164:167], v232, s[32:33]
    global_load_dwordx4 v[168:171], v232, s[24:25]
    global_load_dwordx4 v[172:175], v232, s[30:31]
    s_add_u32 s6, s6, 0x2020202
    v_lshlrev_b32 v186, v246, s6
    v_and_b32 v189, 4, v247
    v_mul_u32_u24 v189, 1212416, v189
    v_lshl_add_u32 v186, v189, 8, v186
    v_and_b32 v186, 0xfe000000, v186
    v_and_b32 v187, 7, v247
    v_mul_u32_u24 v187, 33, v187
    v_add_u32 v187, 792, v187
    v_lshlrev_b32 v222, 2, v223
    s_mov_b32 s64, 0x1000000
    s_waitcnt lgkmcnt(0)
    s_barrier
    ds_read_b128 v[192:195], v185 offset:5120
    ds_read_b32 v228, v222 offset:5120
    ds_read_b128 v[204:207], v221 offset:0
    ds_read_b32 v229, v222 offset:5376
    ds_read_b128 v[208:211], v221 offset:10240
    ds_read_b32 v230, v222 offset:5632
    ds_read_b128 v[212:215], v221 offset:20480
    ds_read_b32 v231, v222 offset:5888
    ds_read_b128 v[216:219], v221 offset:30720
    s_mov_b32 s80, 2105344
    s_mov_b32 s81, 4210688
    s_mov_b32 s82, 6316032
    s_waitcnt lgkmcnt(8)
    v_max3_u32 v188, v192, v193, v194
    v_max_u32 v188, v188, v195
    v_cmp_lt_u32 vcc, 1056, v188
    s_cbranch_vccnz L_POVF
L_POUT:
    s_waitcnt lgkmcnt(7)
    v_sub_u32 v228, v187, v228
    v_and_or_b32 v228, v228, s64, v186
    s_waitcnt lgkmcnt(6)
    v_or_b32 v207, v207, v228
    buffer_store_dwordx4 v[204:207], v220, s[56:59], 0 offen sc1
    s_waitcnt lgkmcnt(5)
    v_sub_u32 v229, v187, v229
    v_and_or_b32 v229, v229, s64, v186
    s_waitcnt lgkmcnt(4)
    v_or_b32 v211, v211, v229
    buffer_store_dwordx4 v[208:211], v220, s[56:59], s80 offen sc1
    s_waitcnt lgkmcnt(3)
    v_sub_u32 v230, v187, v230
    v_and_or_b32 v230, v230, s64, v186
    s_waitcnt lgkmcnt(2)
    v_or_b32 v215, v215, v230
    buffer_store_dwordx4 v[212:215], v220, s[56:59], s81 offen sc1
    s_waitcnt lgkmcnt(1)
    v_sub_u32 v231, v187, v231
    v_and_or_b32 v231, v231, s64, v186
    s_waitcnt lgkmcnt(0)
    v_or_b32 v219, v219, v231
    buffer_store_dwordx4 v[216:219], v220, s[56:59], s82 offen sc1
    s_mov_b32 s10, 0xbfb8aa3b
    s_mov_b32 s11, s10
    s_mov_b32 s64, 0x05040100
    s_mov_b32 s66, 0x07060302
    s_waitcnt vmcnt(4)
    v_perm_b32 v144, v170, v168, s64
    v_perm_b32 v145, v170, v168, s66
    v_perm_b32 v146, v171, v169, s64
    v_perm_b32 v147, v171, v169, s66
    v_add_u32 v148, 77824, v224
    ds_write2_b32 v148, v144, v145 offset0:0 offset1:8
    ds_write2_b32 v148, v146, v147 offset0:16 offset1:24
    v_lshlrev_b32 v128, 16, v160
    v_and_b32 v129, 0xffff0000, v160
    v_lshlrev_b32 v130, 16, v161
    v_and_b32 v131, 0xffff0000, v161
    v_lshlrev_b32 v132, 16, v162
    v_and_b32 v133, 0xffff0000, v162
    v_lshlrev_b32 v134, 16, v163
    v_and_b32 v135, 0xffff0000, v163
    v_pk_mul_f32 v[128:129], v[128:129], s[10:11]
    v_pk_mul_f32 v[130:131], v[130:131], s[10:11]
    v_pk_mul_f32 v[132:133], v[132:133], s[10:11]
    v_pk_mul_f32 v[134:135], v[134:135], s[10:11]
    v_cvt_pk_bf16_f32 v136, v128, v132
    v_cvt_pk_bf16_f32 v137, v129, v133
    v_cvt_pk_bf16_f32 v138, v130, v134
    v_cvt_pk_bf16_f32 v139, v131, v135
    ds_write2_b32 v224, v136, v137 offset0:0 offset1:8
    ds_write2_b32 v224, v138, v139 offset0:16 offset1:24
    v_perm_b32 v152, v166, v164, s64
    v_perm_b32 v153, v166, v164, s66
    v_perm_b32 v154, v167, v165, s64
    v_perm_b32 v155, v167, v165, s66
    v_add_u32 v156, 10240, v224
    ds_write2_b32 v156, v152, v153 offset0:0 offset1:8
    ds_write2_b32 v156, v154, v155 offset0:16 offset1:24
    v_perm_b32 v144, v174, v172, s64
    v_perm_b32 v145, v174, v172, s66
    v_perm_b32 v146, v175, v173, s64
    v_perm_b32 v147, v175, v173, s66
    v_add_u32 v148, 130176, v224
    ds_write2_b32 v148, v144, v145 offset0:0 offset1:8
    ds_write2_b32 v148, v146, v147 offset0:16 offset1:24
    s_cmp_ge_u32 s3, 2
    s_cbranch_scc1 L_NOWC
    v_lshlrev_b32 v128, 16, v176
    v_and_b32 v129, 0xffff0000, v176
    v_lshlrev_b32 v130, 16, v177
    v_and_b32 v131, 0xffff0000, v177
    v_lshlrev_b32 v132, 16, v178
    v_and_b32 v133, 0xffff0000, v178
    v_lshlrev_b32 v134, 16, v179
    v_and_b32 v135, 0xffff0000, v179
    v_pk_mul_f32 v[128:129], v[128:129], s[10:11]
    v_pk_mul_f32 v[130:131], v[130:131], s[10:11]
    v_pk_mul_f32 v[132:133], v[132:133], s[10:11]
    v_pk_mul_f32 v[134:135], v[134:135], s[10:11]
    v_cvt_pk_bf16_f32 v136, v128, v132
    v_cvt_pk_bf16_f32 v137, v129, v133
    v_cvt_pk_bf16_f32 v138, v130, v134
    v_cvt_pk_bf16_f32 v139, v131, v135
    v_add_u32 v140, 20480, v224
    ds_write2_b32 v140, v136, v137 offset0:0 offset1:8
    ds_write2_b32 v140, v138, v139 offset0:16 offset1:24
L_NOWC:
    s_mul_i32 s34, s5, 32896
    s_add_u32 s34, s34, 65536
    s_add_u32 s56, s38, s34
    s_addc_u32 s57, s39, 0
    s_mov_b32 s58, 32768
    s_mov_b32 s59, 0x20000
    s_add_u32 s34, s34, 8421376
    s_add_u32 s60, s38, s34
    s_addc_u32 s61, s39, 0
    s_mov_b32 s62, 32768
    s_mov_b32 s63, 0x20000
    s_movk_i32 s26, 8192
    s_movk_i32 s27, 16384
    s_movk_i32 s28, 24576
    s_waitcnt lgkmcnt(0)
    s_barrier
    v_add_u32 v225, 13312, v225
    ds_read_b64_tr_b16 v[0:1], v225 offset:0
    ds_read_b64_tr_b16 v[2:3], v225 offset:1280
    ds_read_b64_tr_b16 v[4:5], v225 offset:5120
    ds_read_b64_tr_b16 v[6:7], v225 offset:6400
    ds_read_b64_tr_b16 v[8:9], v225 offset:32
    ds_read_b64_tr_b16 v[10:11], v225 offset:1312
    ds_read_b64_tr_b16 v[12:13], v225 offset:5152
    ds_read_b64_tr_b16 v[14:15], v225 offset:6432
    ds_read_b64_tr_b16 v[16:17], v225 offset:64
    ds_read_b64_tr_b16 v[18:19], v225 offset:1344
    ds_read_b64_tr_b16 v[20:21], v225 offset:5184
    ds_read_b64_tr_b16 v[22:23], v225 offset:6464
    ds_read_b64_tr_b16 v[24:25], v225 offset:96
    ds_read_b64_tr_b16 v[26:27], v225 offset:1376
    v_mov_b32 v64, 0x2000000
    v_mov_b32 v65, 0x2000000
    v_mov_b32 v66, 0x2000000
    v_mov_b32 v67, 0x2000000
    v_mov_b32 v68, 0xfffff
    v_mov_b32 v69, 0xfffff
    v_mov_b32 v70, 0xfffff
    v_mov_b32 v71, 0xfffff
    v_lshl_add_u32 v72, v247, 4, s12
    ds_write_b128 v72, v[64:67] offset:0
    ds_write_b128 v72, v[68:71] offset:18432
    ds_write_b128 v72, v[64:67] offset:1024
    ds_write_b128 v72, v[68:71] offset:19456
    ds_write_b128 v72, v[64:67] offset:1280
    ds_write_b128 v72, v[68:71] offset:19712
    ds_read_b64_tr_b16 v[28:29], v225 offset:5216
    ds_read_b64_tr_b16 v[30:31], v225 offset:6496
    ds_read_b64_tr_b16 v[32:33], v225 offset:10240
    ds_read_b64_tr_b16 v[34:35], v225 offset:11520
    ds_read_b64_tr_b16 v[36:37], v225 offset:15360
    ds_read_b64_tr_b16 v[38:39], v225 offset:16640
    ds_read_b64_tr_b16 v[40:41], v225 offset:10272
    ds_read_b64_tr_b16 v[42:43], v225 offset:11552
    ds_read_b64_tr_b16 v[44:45], v225 offset:15392
    ds_read_b64_tr_b16 v[46:47], v225 offset:16672
    v_mov_b32 v192, v225
    s_mov_b32 exec_lo, 0
    v_subrev_u32 v192, 2560, v225
    s_mov_b32 exec_lo, -1
    s_waitcnt lgkmcnt(4)
    ds_read_b64_tr_b16 v[48:49], v225 offset:10304
    ds_read_b64_tr_b16 v[50:51], v225 offset:11584
    ds_read_b64_tr_b16 v[52:53], v225 offset:15424
    ds_read_b64_tr_b16 v[54:55], v225 offset:16704
    ds_read_b64_tr_b16 v[56:57], v225 offset:10336
    ds_read_b64_tr_b16 v[58:59], v225 offset:11616
    ds_read_b64_tr_b16 v[60:61], v225 offset:15456
    ds_read_b64_tr_b16 v[62:63], v225 offset:16736
    ds_read_b64_tr_b16 v[80:81], v192 offset:20480
    ds_read_b64_tr_b16 v[82:83], v192 offset:21760
    ds_read_b64_tr_b16 v[84:85], v192 offset:20512
    ds_read_b64_tr_b16 v[86:87], v192 offset:21792
    ds_read_b64_tr_b16 v[88:89], v192 offset:20544
    ds_read_b64_tr_b16 v[90:91], v192 offset:21824
    ds_read_b64_tr_b16 v[92:93], v192 offset:20576
    ds_read_b64_tr_b16 v[94:95], v192 offset:21856
    v_add_u32 v225, 77824, v225
    v_and_b32 v241, 1, v247
    v_lshlrev_b32 v241, 4, v241
    v_mov_b32 v242, 0x3f80
    v_and_b32 v245, 16, v247
    v_and_b32 v194, 15, v247
    v_lshl_add_u32 v194, v194, 5, s14
    s_mov_b32 exec_hi, 0
    v_add_u32 v245, v245, v194
    s_mov_b32 exec_hi, -1
    v_and_b32 v194, 3, v247
    v_bfe_u32 v196, v247, 2, 2
    v_and_b32 v197, 48, v247
    v_lshl_add_u32 v198, v196, 7, v197
    v_mul_u32_u24 v244, 1056, v194
    v_add3_u32 v244, v244, v198, s13
    v_lshrrev_b32 v194, 3, v247
    v_lshl_add_u32 v248, v194, 4, s12
    s_add_u32 s10, s12, 18432
    v_lshrrev_b32 v194, 1, v247
    v_lshl_add_u32 v249, v194, 2, s10
    s_add_u32 s10, s10, 2
    v_lshrrev_b32 v194, 5, v247
    v_mul_i32_i24 v250, 0xffffb800, v194
    v_and_b32 v194, 15, v247
    v_lshl_add_u32 v250, v194, 2, v250
    v_add_u32 v250, s10, v250
    s_add_u32 s10, s12, 2
    v_and_b32 v194, 48, v247
    v_lshl_add_u32 v251, v194, 1, s10
    v_and_b32 v194, 12, v247
    v_add_u32 v251, v251, v194
    v_mul_u32_u24 v156, 3128, v223
    v_add_u32 v157, 200192, v156
    v_add_u32 v158, 400384, v156
    v_add_u32 v159, 600576, v156
    s_mov_b32 s98, 0xf0f0f0f
    s_mov_b32 s99, 0xf0f0f0f
    v_mov_b32 v180, 0xfffff
    v_mov_b32 v176, 0
    v_add_lshl_u32 v191, v232, v243, 16
    v_add_u32 v152, 0x34000000, v191
    v_cndmask_b32 v152, 0, v152, s[98:99]
    v_add_u32 v153, 0x54000000, v191
    v_cndmask_b32 v153, 0, v153, s[98:99]
    v_add_u32 v154, 0x74000000, v191
    v_cndmask_b32 v154, 0, v154, s[98:99]
    v_add_u32 v155, 0x94000000, v191
    v_cndmask_b32 v155, 0, v155, s[98:99]
    v_mov_b32 v184, 4
    v_and_b32 v177, 31, v247
    v_add_lshl_u32 v179, v177, s7, 2
    v_lshrrev_b32 v191, 5, v247
    v_lshl_add_u32 v178, v191, 11, v179
    v_add_u32 v179, 153728, v179
    v_lshlrev_b32 v191, 2, v247
    v_subrev_u32 v191, s7, v191
    s_mov_b32 s10, 0x10000
    v_add_u32 v228, 0, v191
    v_and_or_b32 v228, v228, s10, 1
    v_add_u32 v229, 1, v191
    v_and_or_b32 v229, v229, s10, 1
    v_add_u32 v230, 2, v191
    v_and_or_b32 v230, v230, s10, 1
    v_add_u32 v231, 3, v191
    v_and_or_b32 v231, v231, s10, 1
    s_movk_i32 s18, 0xffc
    s_movk_i32 s20, 32
    s_mov_b32 s21, 0
    s_mov_b32 s100, 0
    s_mov_b32 s16, 0x1ffffff
    s_mov_b32 s17, 0xffff
    s_mul_i32 s10, s4, 49
    s_sub_i32 s22, s10, 6
    s_ashr_i32 s22, s22, 1
    s_add_i32 s23, s10, 7
    s_ashr_i32 s23, s23, 1
    s_add_i32 s24, s10, 43
    s_ashr_i32 s24, s24, 1
    s_add_i32 s25, s22, 31
    s_cmp_eq_u32 s4, 7
    s_cselect_b32 s24, 196, s24
    s_cselect_b32 s25, 196, s25
    s_sub_i32 s23, s23, s7
    s_sub_i32 s24, s24, s7
    s_sub_i32 s25, s25, s7
    s_waitcnt vmcnt(0)
    buffer_load_dwordx4 v[128:131], v232, s[56:59], 0 offen sc1
    buffer_load_dwordx4 v[132:135], v232, s[56:59], s26 offen sc1
    buffer_load_dwordx4 v[136:139], v232, s[56:59], s27 offen sc1
    buffer_load_dwordx4 v[140:143], v232, s[56:59], s28 offen sc1
    v_max3_u32 v188, v112, v113, v114
    v_max3_u32 v189, v115, v116, v117
    v_max3_u32 v188, v188, v118, v119
    v_max_u32 v188, v188, v189
    v_cmp_le_u32 vcc, 792, v188
    s_cbranch_vccz L_PEXTR
    v_mov_b32 v65, s6
    s_lshl_b32 s34, s2, 7
    s_add_u32 s34, s34, 8486912
    v_subrev_u32 v68, 792, v112
    v_cmpx_gt_u32 vcc, 264, v68
    s_cbranch_execz L_PE0
    v_mov_b32 v64, v96
    v_mov_b32 v66, v120
    v_bfe_u32 v68, v112, 5, 3
    v_lshlrev_b32 v68, 4, v68
    v_mad_u32_u24 v68, v104, s68, v68
    buffer_store_dwordx4 v[64:67], v68, s[52:55], s34 offen sc1
L_PE0:
    s_mov_b64 exec, -1
    v_subrev_u32 v68, 792, v113
    v_cmpx_gt_u32 vcc, 264, v68
    s_cbranch_execz L_PE1
    v_mov_b32 v64, v97
    v_mov_b32 v66, v121
    v_bfe_u32 v68, v113, 5, 3
    v_lshlrev_b32 v68, 4, v68
    v_mad_u32_u24 v68, v105, s68, v68
    buffer_store_dwordx4 v[64:67], v68, s[52:55], s34 offen sc1
L_PE1:
    s_mov_b64 exec, -1
    v_subrev_u32 v68, 792, v114
    v_cmpx_gt_u32 vcc, 264, v68
    s_cbranch_execz L_PE2
    v_mov_b32 v64, v98
    v_mov_b32 v66, v122
    v_bfe_u32 v68, v114, 5, 3
    v_lshlrev_b32 v68, 4, v68
    v_mad_u32_u24 v68, v106, s68, v68
    buffer_store_dwordx4 v[64:67], v68, s[52:55], s34 offen sc1
L_PE2:
    s_mov_b64 exec, -1
    v_subrev_u32 v68, 792, v115
    v_cmpx_gt_u32 vcc, 264, v68
    s_cbranch_execz L_PE3
    v_mov_b32 v64, v99
    v_mov_b32 v66, v123
    v_bfe_u32 v68, v115, 5, 3
    v_lshlrev_b32 v68, 4, v68
    v_mad_u32_u24 v68, v107, s68, v68
    buffer_store_dwordx4 v[64:67], v68, s[52:55], s34 offen sc1
L_PE3:
    s_mov_b64 exec, -1
    v_subrev_u32 v68, 792, v116
    v_cmpx_gt_u32 vcc, 264, v68
    s_cbranch_execz L_PE4
    v_mov_b32 v64, v100
    v_mov_b32 v66, v120
    v_bfe_u32 v68, v116, 5, 3
    v_lshlrev_b32 v68, 4, v68
    v_mad_u32_u24 v68, v108, s68, v68
    buffer_store_dwordx4 v[64:67], v68, s[52:55], s34 offen sc1
L_PE4:
    s_mov_b64 exec, -1
    v_subrev_u32 v68, 792, v117
    v_cmpx_gt_u32 vcc, 264, v68
    s_cbranch_execz L_PE5
    v_mov_b32 v64, v101
    v_mov_b32 v66, v121
    v_bfe_u32 v68, v117, 5, 3
    v_lshlrev_b32 v68, 4, v68
    v_mad_u32_u24 v68, v109, s68, v68
    buffer_store_dwordx4 v[64:67], v68, s[52:55], s34 offen sc1
L_PE5:
    s_mov_b64 exec, -1
    v_subrev_u32 v68, 792, v118
    v_cmpx_gt_u32 vcc, 264, v68
    s_cbranch_execz L_PE6
    v_mov_b32 v64, v102
    v_mov_b32 v66, v122
    v_bfe_u32 v68, v118, 5, 3
    v_lshlrev_b32 v68, 4, v68
    v_mad_u32_u24 v68, v110, s68, v68
    buffer_store_dwordx4 v[64:67], v68, s[52:55], s34 offen sc1
L_PE6:
    s_mov_b64 exec, -1
    v_subrev_u32 v68, 792, v119
    v_cmpx_gt_u32 vcc, 264, v68
    s_cbranch_execz L_PE7
    v_mov_b32 v64, v103
    v_mov_b32 v66, v123
    v_bfe_u32 v68, v119, 5, 3
    v_lshlrev_b32 v68, 4, v68
    v_mad_u32_u24 v68, v111, s68, v68
    buffer_store_dwordx4 v[64:67], v68, s[52:55], s34 offen sc1
L_PE7:
    s_mov_b64 exec, -1
L_PEXTR:
L_PW0:
    s_waitcnt vmcnt(3)
    v_xor_b32 v188, v131, v186
    v_and_b32_sdwa v96, v128, s18 dst_sel:DWORD dst_unused:UNUSED_PAD src0_sel:WORD_1 src1_sel:DWORD
    v_and_b32_sdwa v97, v129, s18 dst_sel:DWORD dst_unused:UNUSED_PAD src0_sel:WORD_1 src1_sel:DWORD
    v_and_b32_sdwa v98, v130, s18 dst_sel:DWORD dst_unused:UNUSED_PAD src0_sel:WORD_1 src1_sel:DWORD
    v_cmp_lt_u32 vcc, s16, v188
    v_cmp_ne_u32 s[64:65], 0, v128
    v_cmp_ne_u32 s[66:67], 0, v129
    v_cmp_ne_u32 s[68:69], 0, v130
    s_cbranch_vccnz L_RT0
    s_mov_b64 exec, s[64:65]
    ds_add_rtn_u32 v112, v96, v184 offset:1024
    s_mov_b64 exec, s[66:67]
    ds_add_rtn_u32 v113, v97, v184 offset:1024
    s_mov_b64 exec, s[68:69]
    ds_add_rtn_u32 v114, v98, v184 offset:1024
    s_mov_b64 exec, -1
    v_or_b32 v176, v176, v129
    v_add_u32_sdwa v204, v131, v156 dst_sel:DWORD dst_unused:UNUSED_PAD src0_sel:BYTE_0 src1_sel:DWORD
    v_lshrrev_b32 v189, 28, v128
    v_lshl_add_u32 v204, v189, 8, v204
    v_and_b32 v189, 60, v96
    v_and_b32 v128, 0xffff, v128
    v_lshl_or_b32 v128, v189, 19, v128
    v_cndmask_b32 v188, v180, v204, s[64:65]
    v_max_u32 v204, v204, v152
    v_add_u32_sdwa v205, v131, v156 dst_sel:DWORD dst_unused:UNUSED_PAD src0_sel:BYTE_1 src1_sel:DWORD
    v_lshrrev_b32 v189, 28, v129
    v_lshl_add_u32 v205, v189, 8, v205
    v_and_b32 v189, 60, v97
    v_and_b32 v129, 0xffff, v129
    v_lshl_or_b32 v129, v189, 19, v129
    v_mov_b32_dpp v190, v188 quad_perm:[2,2,3,3] row_mask:0xf bank_mask:0xf
    v_mov_b32_dpp v207, v188 quad_perm:[0,0,1,1] row_mask:0xf bank_mask:0xf
    v_add_u32_sdwa v206, v131, v156 dst_sel:DWORD dst_unused:UNUSED_PAD src0_sel:BYTE_2 src1_sel:DWORD
    v_lshrrev_b32 v189, 28, v130
    v_lshl_add_u32 v206, v189, 8, v206
    v_and_b32 v189, 60, v98
    v_and_b32 v130, 0xffff, v130
    v_lshl_or_b32 v130, v189, 19, v130
    v_mov_b32_dpp v207, v190 row_shr:4 row_mask:0xf bank_mask:0xa
L_PW1:
    s_waitcnt vmcnt(2)
    v_xor_b32 v188, v135, v186
    v_and_b32_sdwa v100, v132, s18 dst_sel:DWORD dst_unused:UNUSED_PAD src0_sel:WORD_1 src1_sel:DWORD
    v_and_b32_sdwa v101, v133, s18 dst_sel:DWORD dst_unused:UNUSED_PAD src0_sel:WORD_1 src1_sel:DWORD
    v_and_b32_sdwa v102, v134, s18 dst_sel:DWORD dst_unused:UNUSED_PAD src0_sel:WORD_1 src1_sel:DWORD
    v_cmp_lt_u32 vcc, s16, v188
    v_cmp_ne_u32 s[72:73], 0, v132
    v_cmp_ne_u32 s[74:75], 0, v133
    v_cmp_ne_u32 s[76:77], 0, v134
    s_cbranch_vccnz L_RT1
    s_mov_b64 exec, s[72:73]
    ds_add_rtn_u32 v116, v100, v184 offset:1024
    s_mov_b64 exec, s[74:75]
    ds_add_rtn_u32 v117, v101, v184 offset:1024
    s_mov_b64 exec, s[76:77]
    ds_add_rtn_u32 v118, v102, v184 offset:1024
    s_mov_b64 exec, -1
    v_or_b32 v176, v176, v133
    v_add_u32_sdwa v208, v135, v157 dst_sel:DWORD dst_unused:UNUSED_PAD src0_sel:BYTE_0 src1_sel:DWORD
    v_lshrrev_b32 v189, 28, v132
    v_lshl_add_u32 v208, v189, 8, v208
    v_and_b32 v189, 60, v100
    v_and_b32 v132, 0xffff, v132
    v_lshl_or_b32 v132, v189, 19, v132
    v_cndmask_b32 v188, v180, v208, s[72:73]
    v_max_u32 v208, v208, v153
    v_add_u32_sdwa v209, v135, v157 dst_sel:DWORD dst_unused:UNUSED_PAD src0_sel:BYTE_1 src1_sel:DWORD
    v_lshrrev_b32 v189, 28, v133
    v_lshl_add_u32 v209, v189, 8, v209
    v_and_b32 v189, 60, v101
    v_and_b32 v133, 0xffff, v133
    v_lshl_or_b32 v133, v189, 19, v133
    v_mov_b32_dpp v190, v188 quad_perm:[2,2,3,3] row_mask:0xf bank_mask:0xf
    v_mov_b32_dpp v211, v188 quad_perm:[0,0,1,1] row_mask:0xf bank_mask:0xf
    v_add_u32_sdwa v210, v135, v157 dst_sel:DWORD dst_unused:UNUSED_PAD src0_sel:BYTE_2 src1_sel:DWORD
    v_lshrrev_b32 v189, 28, v134
    v_lshl_add_u32 v210, v189, 8, v210
    v_and_b32 v189, 60, v102
    v_and_b32 v134, 0xffff, v134
    v_lshl_or_b32 v134, v189, 19, v134
    v_mov_b32_dpp v211, v190 row_shr:4 row_mask:0xf bank_mask:0xa
L_PW2:
    s_waitcnt vmcnt(1)
    v_xor_b32 v188, v139, v186
    v_and_b32_sdwa v104, v136, s18 dst_sel:DWORD dst_unused:UNUSED_PAD src0_sel:WORD_1 src1_sel:DWORD
    v_and_b32_sdwa v105, v137, s18 dst_sel:DWORD dst_unused:UNUSED_PAD src0_sel:WORD_1 src1_sel:DWORD
    v_and_b32_sdwa v106, v138, s18 dst_sel:DWORD dst_unused:UNUSED_PAD src0_sel:WORD_1 src1_sel:DWORD
    v_cmp_lt_u32 vcc, s16, v188
    v_cmp_ne_u32 s[80:81], 0, v136
    v_cmp_ne_u32 s[82:83], 0, v137
    v_cmp_ne_u32 s[84:85], 0, v138
    s_cbranch_vccnz L_RT2
    s_mov_b64 exec, s[80:81]
    ds_add_rtn_u32 v120, v104, v184 offset:1024
    s_mov_b64 exec, s[82:83]
    ds_add_rtn_u32 v121, v105, v184 offset:1024
    s_mov_b64 exec, s[84:85]
    ds_add_rtn_u32 v122, v106, v184 offset:1024
    s_mov_b64 exec, -1
    v_or_b32 v176, v176, v137
    v_add_u32_sdwa v212, v139, v158 dst_sel:DWORD dst_unused:UNUSED_PAD src0_sel:BYTE_0 src1_sel:DWORD
    v_lshrrev_b32 v189, 28, v136
    v_lshl_add_u32 v212, v189, 8, v212
    v_and_b32 v189, 60, v104
    v_and_b32 v136, 0xffff, v136
    v_lshl_or_b32 v136, v189, 19, v136
    v_cndmask_b32 v188, v180, v212, s[80:81]
    v_max_u32 v212, v212, v154
    v_add_u32_sdwa v213, v139, v158 dst_sel:DWORD dst_unused:UNUSED_PAD src0_sel:BYTE_1 src1_sel:DWORD
    v_lshrrev_b32 v189, 28, v137
    v_lshl_add_u32 v213, v189, 8, v213
    v_and_b32 v189, 60, v105
    v_and_b32 v137, 0xffff, v137
    v_lshl_or_b32 v137, v189, 19, v137
    v_mov_b32_dpp v190, v188 quad_perm:[2,2,3,3] row_mask:0xf bank_mask:0xf
    v_mov_b32_dpp v215, v188 quad_perm:[0,0,1,1] row_mask:0xf bank_mask:0xf
    v_add_u32_sdwa v214, v139, v158 dst_sel:DWORD dst_unused:UNUSED_PAD src0_sel:BYTE_2 src1_sel:DWORD
    v_lshrrev_b32 v189, 28, v138
    v_lshl_add_u32 v214, v189, 8, v214
    v_and_b32 v189, 60, v106
    v_and_b32 v138, 0xffff, v138
    v_lshl_or_b32 v138, v189, 19, v138
    v_mov_b32_dpp v215, v190 row_shr:4 row_mask:0xf bank_mask:0xa
L_PW3:
    s_waitcnt vmcnt(0)
    v_xor_b32 v188, v143, v186
    v_and_b32_sdwa v108, v140, s18 dst_sel:DWORD dst_unused:UNUSED_PAD src0_sel:WORD_1 src1_sel:DWORD
    v_and_b32_sdwa v109, v141, s18 dst_sel:DWORD dst_unused:UNUSED_PAD src0_sel:WORD_1 src1_sel:DWORD
    v_and_b32_sdwa v110, v142, s18 dst_sel:DWORD dst_unused:UNUSED_PAD src0_sel:WORD_1 src1_sel:DWORD
    v_cmp_lt_u32 vcc, s16, v188
    v_cmp_ne_u32 s[88:89], 0, v140
    v_cmp_ne_u32 s[90:91], 0, v141
    v_cmp_ne_u32 s[92:93], 0, v142
    s_cbranch_vccnz L_RT3
    s_mov_b64 exec, s[88:89]
    ds_add_rtn_u32 v124, v108, v184 offset:1024
    s_mov_b64 exec, s[90:91]
    ds_add_rtn_u32 v125, v109, v184 offset:1024
    s_mov_b64 exec, s[92:93]
    ds_add_rtn_u32 v126, v110, v184 offset:1024
    s_mov_b64 exec, -1
    v_or_b32 v176, v176, v141
    v_or3_b32 v190, v131, v135, v139
    v_or_b32 v190, v190, v143
    v_and_b32 v190, 0x1000000, v190
    v_cmp_ne_u32 vcc, 0, v190
    s_cbranch_vccz L_XT1R
    v_and_b32 v190, 0x1000000, v131
    v_cmp_ne_u32 s[70:71], 0, v190
    s_bcnt1_i32_b64 s10, s[70:71]
    s_lshl2_add_u32 s21, s10, s21
    v_and_b32 v190, 0x1000000, v135
    v_cmp_ne_u32 s[78:79], 0, v190
    s_bcnt1_i32_b64 s10, s[78:79]
    s_lshl2_add_u32 s21, s10, s21
    v_and_b32 v190, 0x1000000, v139
    v_cmp_ne_u32 s[86:87], 0, v190
    s_bcnt1_i32_b64 s10, s[86:87]
    s_lshl2_add_u32 s21, s10, s21
    v_and_b32 v190, 0x1000000, v143
    v_cmp_ne_u32 s[94:95], 0, v190
    s_bcnt1_i32_b64 s10, s[94:95]
    s_lshl2_add_u32 s21, s10, s21
    s_mov_b64 exec, s[70:71]
    s_cbranch_execz L_XLa0
    s_movk_i32 s10, 0
    buffer_load_dwordx4 v[64:67], v232, s[60:63], s10 offen sc1
L_XLa0:
    s_mov_b64 exec, s[78:79]
    s_cbranch_execz L_XLa1
    s_movk_i32 s10, 8192
    buffer_load_dwordx4 v[68:71], v232, s[60:63], s10 offen sc1
L_XLa1:
    s_mov_b64 exec, s[86:87]
    s_cbranch_execz L_XLa2
    s_movk_i32 s10, 16384
    buffer_load_dwordx4 v[72:75], v232, s[60:63], s10 offen sc1
L_XLa2:
    s_mov_b64 exec, s[94:95]
    s_cbranch_execz L_XLa3
    s_movk_i32 s10, 24576
    buffer_load_dwordx4 v[76:79], v232, s[60:63], s10 offen sc1
L_XLa3:
    s_mov_b64 exec, -1
    v_and_b32 v190, 0x10000, v176
    v_mov_b32 v191, 640
    v_cmpx_ne_u32 vcc, 0, v190
    ds_write_b32 v191, v184 offset:4
    s_mov_b64 exec, 1
    v_mov_b32 v190, s21
    ds_add_u32 v191, v190 offset:8
    s_mov_b64 exec, -1
L_XT1R:
    v_add_u32_sdwa v216, v143, v159 dst_sel:DWORD dst_unused:UNUSED_PAD src0_sel:BYTE_0 src1_sel:DWORD
    v_lshrrev_b32 v189, 28, v140
    v_lshl_add_u32 v216, v189, 8, v216
    v_and_b32 v189, 60, v108
    v_and_b32 v140, 0xffff, v140
    v_lshl_or_b32 v140, v189, 19, v140
    v_cndmask_b32 v188, v180, v216, s[88:89]
    v_max_u32 v216, v216, v155
    v_add_u32_sdwa v217, v143, v159 dst_sel:DWORD dst_unused:UNUSED_PAD src0_sel:BYTE_1 src1_sel:DWORD
    v_lshrrev_b32 v189, 28, v141
    v_lshl_add_u32 v217, v189, 8, v217
    v_and_b32 v189, 60, v109
    v_and_b32 v141, 0xffff, v141
    v_lshl_or_b32 v141, v189, 19, v141
    v_mov_b32_dpp v190, v188 quad_perm:[2,2,3,3] row_mask:0xf bank_mask:0xf
    v_mov_b32_dpp v219, v188 quad_perm:[0,0,1,1] row_mask:0xf bank_mask:0xf
    v_add_u32_sdwa v218, v143, v159 dst_sel:DWORD dst_unused:UNUSED_PAD src0_sel:BYTE_2 src1_sel:DWORD
    v_lshrrev_b32 v189, 28, v142
    v_lshl_add_u32 v218, v189, 8, v218
    v_mov_b32_dpp v219, v190 row_shr:4 row_mask:0xf bank_mask:0xa
    v_mov_b32 v197, 640
    s_cmp_eq_u32 s3, 6
    s_cselect_b32 exec_hi, 0, -1
    s_cmp_eq_u32 s3, 7
    s_cselect_b64 exec, 1, exec
    s_add_u32 m0, s101, 0
    s_nop 0
    buffer_load_dwordx4 v234, s[40:43], 0 offen offset:0 lds
    s_add_u32 m0, s101, 6560
    s_nop 0
    buffer_load_dwordx4 v234, s[40:43], 0 offen offset:128 lds
    s_add_u32 m0, s101, 13120
    s_nop 0
    buffer_load_dwordx4 v234, s[40:43], 0 offen offset:256 lds
    s_add_u32 m0, s101, 19680
    s_nop 0
    buffer_load_dwordx4 v234, s[40:43], 0 offen offset:384 lds
    s_mov_b64 exec, -1
    s_waitcnt lgkmcnt(0)
    s_barrier
    ds_read_u16 v198, v178 offset:1024
    ds_read_u16 v199, v178 offset:2048
    ds_read_b128 v[160:163], v185 offset:1024
    ds_read_b128 v[164:167], v185 offset:2048
    ds_read_b128 v[168:171], v185 offset:3072
    ds_read_b128 v[172:175], v185 offset:4096
    ds_read_b32 v236, v197 offset:8
    s_lshl_b32 m0, s3, 10
    v_mov_b32 v240, v207
    s_add_u32 m0, m0, 13312
    s_nop 0
    buffer_load_dwordx4 v[240:241], s[44:47], 0 idxen offen lds
    s_cmp_lg_u32 s2, 0
    s_cbranch_scc1 L_NOK
    v_mov_b32 v237, s6
    v_mov_b32 v238, 0
    buffer_store_dword v237, v238, s[52:55], 0 offen sc1
L_NOK:
    s_waitcnt lgkmcnt(5)
    v_lshl_or_b32 v198, v199, 16, v198
    v_mov_b32 v199, v198
    s_waitcnt lgkmcnt(0)
    v_add_u32_sdwa v188, v160, v164 dst_sel:DWORD dst_unused:UNUSED_PAD src0_sel:WORD_0 src1_sel:WORD_0
    v_add_u32_sdwa v192, v168, v172 dst_sel:DWORD dst_unused:UNUSED_PAD src0_sel:WORD_0 src1_sel:WORD_0
    v_add_u32_dpp v199, v199, v199 row_shr:1 row_mask:0xf bank_mask:0xf bound_ctrl:0
    v_add_u32_sdwa v189, v161, v165 dst_sel:DWORD dst_unused:UNUSED_PAD src0_sel:WORD_0 src1_sel:WORD_0
    v_add_u32_sdwa v193, v169, v173 dst_sel:DWORD dst_unused:UNUSED_PAD src0_sel:WORD_0 src1_sel:WORD_0
    v_add_u32_dpp v199, v199, v199 row_shr:2 row_mask:0xf bank_mask:0xf bound_ctrl:0
    v_add_u32_sdwa v190, v162, v166 dst_sel:DWORD dst_unused:UNUSED_PAD src0_sel:WORD_0 src1_sel:WORD_0
    v_add_u32_sdwa v194, v170, v174 dst_sel:DWORD dst_unused:UNUSED_PAD src0_sel:WORD_0 src1_sel:WORD_0
    v_add_u32_dpp v199, v199, v199 row_shr:4 row_mask:0xf bank_mask:0xf bound_ctrl:0
    v_add_u32_sdwa v191, v163, v167 dst_sel:DWORD dst_unused:UNUSED_PAD src0_sel:WORD_0 src1_sel:WORD_0
    v_add_u32_sdwa v195, v171, v175 dst_sel:DWORD dst_unused:UNUSED_PAD src0_sel:WORD_0 src1_sel:WORD_0
    v_add_u32_dpp v199, v199, v199 row_shr:8 row_mask:0xf bank_mask:0xf bound_ctrl:0
    v_add_u32 v188, v188, v192
    v_add_u32 v189, v189, v193
    v_add_u32_dpp v199, v199, v199 row_bcast:15 row_mask:0xa bank_mask:0xf
    v_add_u32 v190, v190, v194
    v_add_u32 v191, v191, v195
    v_mul_u32_u24 v196, v188, v228
    v_mad_u32_u24 v196, v189, v229, v196
    v_mad_u32_u24 v196, v190, v230, v196
    v_mad_u32_u24 v196, v191, v231, v196
    s_mov_b32 s96, -1
    s_mov_b32 s97, 0
    v_sub_u32 v200, v199, v198
    v_add_u32_sdwa v202, v199, v199 dst_sel:DWORD dst_unused:UNUSED_PAD src0_sel:WORD_0 src1_sel:WORD_1
    v_add_u32_dpp v196, v196, v196 row_shr:1 row_mask:0xf bank_mask:0xf bound_ctrl:0
    v_add_u32_sdwa v201, v200, v200 dst_sel:DWORD dst_unused:UNUSED_PAD src0_sel:WORD_0 src1_sel:WORD_1
    v_add_u32_sdwa v203, v198, v198 dst_sel:DWORD dst_unused:UNUSED_PAD src0_sel:WORD_0 src1_sel:WORD_1
    v_add_u32_dpp v196, v196, v196 row_shr:2 row_mask:0xf bank_mask:0xf bound_ctrl:0
    v_and_b32 v239, 60, v110
    v_readfirstlane_b32 s19, v236
    v_add_u32_dpp v196, v196, v196 row_shr:4 row_mask:0xf bank_mask:0xf bound_ctrl:0
    v_permlane32_swap_b32 v201, v202
    v_cndmask_b32 v203, 0, v203, s[96:97]
    v_add_u32_dpp v196, v196, v196 row_shr:8 row_mask:0xf bank_mask:0xf bound_ctrl:0
    v_add_u32 v201, v201, v202
    v_and_b32 v142, 0xffff, v142
    v_add_u32_dpp v196, v196, v196 row_bcast:15 row_mask:0xa bank_mask:0xf
    v_add_u32 v202, v201, v203
    v_lshl_or_b32 v142, v239, 19, v142
    v_add_u32_dpp v196, v196, v196 row_bcast:31 row_mask:0xc bank_mask:0xf
    v_sub_u32_sdwa v203, v202, v198 dst_sel:DWORD dst_unused:UNUSED_PAD src0_sel:DWORD src1_sel:WORD_1
    v_readlane_b32 s16, v196, 63
    s_lshl_b32 m0, s3, 10
    v_mov_b32 v240, v211
    s_add_u32 m0, m0, 21504
    s_nop 0
    buffer_load_dwordx4 v[240:241], s[44:47], 0 idxen offen lds
    s_bfe_u32 s10, s16, 0xe0002
    s_lshr_b32 s16, s16, 16
    s_lshr_b32 s11, s10, 1
    s_add_u32 s11, s11, 48
    s_and_b32 s11, s11, -128
    s_lshr_b32 s8, s4, 1
    s_mul_i32 s8, s8, s10
    s_sub_i32 s11, s11, 48
    s_sub_i32 s8, s8, s16
    s_add_i32 s11, s11, s8
    s_add_i32 s10, s10, s8
    s_bitcmp1_b32 s4, 0
    s_cselect_b32 s31, s11, s8
    s_cselect_b32 s10, s10, s11
    v_cmp_gt_i32 vcc, s31, v202
    v_cmp_gt_i32 s[34:35], s10, v202
    s_bcnt1_i32_b32 s22, vcc_lo
    s_bcnt1_i32_b32 s10, s34
    s_min_i32 s22, s22, s23
    s_max_i32 s10, s10, s24
    s_min_i32 s23, s10, s25
    v_readlane_b32 s16, v201, s22
    v_readlane_b32 s30, v201, s23
    s_add_u32 s8, s22, s7
    s_add_u32 s9, s23, s7
    s_add_u32 s10, s22, 32
    s_add_u32 s11, s23, 32
    v_readlane_b32 s26, v200, s22
    v_readlane_b32 s28, v200, s23
    v_readlane_b32 s27, v200, s10
    v_readlane_b32 s29, v200, s11
    s_sub_u32 s31, s30, s16
    s_add_u32 s10, s31, 255
    s_sub_i32 s11, s23, 16
    s_max_i32 s11, s11, s22
    v_readlane_b32 s11, v201, s11
    s_add_u32 vcc_lo, s31, 127
    s_and_b32 vcc_hi, vcc_lo, 127
    s_add_u32 vcc_hi, vcc_hi, s19
    s_cmp_lt_u32 vcc_hi, 55
    s_cselect_b32 vcc_lo, vcc_lo, s10
    s_sub_u32 s11, s11, s16
    s_add_u32 s11, s11, s19
    s_lshl_b32 s11, s11, 1
    s_and_b32 vcc_lo, vcc_lo, -256
    s_cmp_le_u32 s11, vcc_lo
    s_cselect_b32 s10, vcc_lo, s10
    s_lshr_b32 s10, s10, 8
    s_lshl_b32 s10, s10, 7
    s_sub_u32 s10, s10, s19
    s_max_i32 s10, s10, 0
    s_add_u32 s16, s16, s10
    s_add_u32 s10, s22, 16
    s_min_u32 s10, s10, s23
    s_sub_i32 s11, s23, 16
    v_cmp_ge_u32 s[34:35], s16, v203
    v_cmp_ge_u32 s[36:37], s16, v202
    v_cmp_gt_i32 vcc, s10, v177
    v_cmp_gt_i32 s[10:11], s11, v177
    v_cmp_le_u32 s[32:33], s22, v177
    v_cmp_gt_u32 s[96:97], s23, v177
    s_and_b64 s[34:35], s[34:35], vcc
    s_and_b64 s[36:37], s[36:37], vcc
    s_or_b64 s[34:35], s[34:35], s[10:11]
    s_or_b64 s[36:37], s[36:37], s[10:11]
    s_bcnt1_i32_b32 s24, s34
    s_bcnt1_i32_b32 s10, s36
    s_bcnt1_i32_b32 s11, s35
    s_bcnt1_i32_b32 s25, s37
    v_readlane_b32 s22, v200, s24
    v_readlane_b32 s10, v200, s10
    s_add_u32 s11, s11, 32
    s_add_u32 s16, s25, 32
    v_readlane_b32 s23, v200, s11
    v_readlane_b32 s11, v200, s16
    v_mov_b32 v188, s17
    v_cndmask_b32 v189, 0, v188, s[34:35]
    v_cndmask_b32 v188, 0, v188, s[36:37]
    s_and_b64 s[32:33], s[32:33], s[96:97]
    s_pack_lh_b32_b16 s22, s22, s10
    s_pack_lh_b32_b16 s23, s23, s11
    v_lshl_or_b32 v188, v188, 16, v189
    s_sub_u32 s16, s12, 37888
    s_pack_ll_b32_b16 s16, s16, s16
    s_sub_u32 s10, s22, s26
    s_sub_u32 s11, s23, s27
    s_mul_i32 s10, s10, 0x10001
    s_lshl_b32 vcc_lo, s10, 16
    s_pack_hh_b32_b16 s10, s10, s10
    s_lshl_b32 vcc_hi, s11, 16
    s_add_u32 vcc_hi, vcc_hi, s10
    s_add_u32 s96, vcc_hi, s11
    s_lshr_b32 s96, s96, 16
    s_sub_u32 s31, s31, s96
    s_cmp_gt_u32 s31, s96
    s_cselect_b32 s97, 0x4800480, 0
    s_add_u32 s16, s16, s97
    s_sub_u32 s10, s16, s26
    s_sub_u32 s11, s16, s27
    s_add_u32 s10, s10, vcc_lo
    s_add_u32 s11, s11, vcc_hi
    v_mov_b32 v192, s10
    v_mov_b32 v193, s11
    s_add_u32 s16, s16, 0x4800480
    s_sub_u32 s16, s16, s97
    s_sub_u32 s16, s16, s97
    s_sub_u32 s10, s28, s22
    s_sub_u32 s11, s29, s23
    s_mul_i32 s10, s10, 0x10001
    s_lshl_b32 vcc_lo, s10, 16
    s_pack_hh_b32_b16 s10, s10, s10
    s_lshl_b32 vcc_hi, s11, 16
    s_add_u32 vcc_hi, vcc_hi, s10
    s_sub_u32 s10, s16, s22
    s_sub_u32 s11, s16, s23
    s_add_u32 s10, s10, vcc_lo
    s_add_u32 s11, s11, vcc_hi
    v_mov_b32 v194, s10
    v_mov_b32 v195, s11
    v_bfi_b32 v192, v188, v192, v194
    v_bfi_b32 v193, v188, v193, v195
    s_mov_b32 exec_hi, 0
    v_mov_b32 v193, v192
    s_mov_b64 exec, s[32:33]
    v_add_u32 v200, v200, v193
    s_bfe_u32 s10, s97, 0x10007
    s_lshl1_add_u32 s10, s4, s10
    s_lshl_b32 s10, s10, 2
    v_cndmask_b32 v188, 4, 0, s[34:35]
    ds_write_b16 v178, v200 offset:1026
    ds_write_b16_d16_hi v178, v200 offset:2050
    s_mov_b32 exec_hi, 0
    v_xor_b32 v188, s10, v188
    ds_write_b32 v179, v188
    s_mov_b64 exec, -1
    s_min_u32 s10, s31, s96
    s_max_u32 s96, s31, s96
    s_mov_b32 s31, s10
    s_add_u32 s10, s96, s19
    s_mul_i32 s11, s30, 9216
    s_lshr_b32 s11, s11, 16
    s_max_u32 s10, s10, s11
    s_cmp_lt_u32 s10, 1152
    s_cbranch_scc1 L_LFIT
    ds_write_b32 v197, v184
L_LFIT:
    s_cmp_eq_u32 s19, 0
    s_cbranch_scc1 L_XCNR
    s_sub_u32 s10, s12, 37888
    s_add_u32 s11, s10, s96
    v_mov_b32 v188, s11
    s_add_u32 s11, s10, s31
    s_add_u32 s11, s11, 1152
    v_mov_b32 v189, s11
    s_lshl_b32 s10, s4, 3
    v_mov_b32 v190, s10
    ds_write_b64 v190, v[188:189] offset:576
L_XCNR:
    s_lshl_b32 m0, s3, 10
    v_mov_b32 v240, v215
    s_add_u32 m0, m0, 29696
    s_nop 0
    buffer_load_dwordx4 v[240:241], s[44:47], 0 idxen offen lds
    s_waitcnt lgkmcnt(0)
    s_barrier
    ds_read_b64 v[202:203], v197
    ds_read_u16 v96, v96 offset:1026
    ds_read_u16 v97, v97 offset:1026
    ds_read_u16 v98, v98 offset:1026
    ds_read_u16 v100, v100 offset:1026
    ds_read_u16 v101, v101 offset:1026
    ds_read_u16 v102, v102 offset:1026
    ds_read_u16 v104, v104 offset:1026
    ds_read_u16 v105, v105 offset:1026
    ds_read_u16 v106, v106 offset:1026
    ds_read_u16 v108, v108 offset:1026
    ds_read_u16 v109, v109 offset:1026
    ds_read_u16 v110, v110 offset:1026
    s_lshl_b32 m0, s3, 10
    v_mov_b32 v240, v219
    s_add_u32 m0, m0, 37888
    s_nop 0
    buffer_load_dwordx4 v[240:241], s[44:47], 0 idxen offen lds
    s_add_u32 s24, s24, s7
    s_add_u32 s11, s25, s7
    s_and_b32 s10, s11, 15
    s_cmp_lt_u32 s11, s24
    s_cselect_b32 s25, s10, 16
    s_cmp_lg_u32 s97, 0
    s_cselect_b32 s23, s8, s11
    s_cselect_b32 s7, s8, s24
    s_cselect_b32 s8, s11, s8
    s_cselect_b32 s24, s9, s24
    s_cselect_b32 s9, s11, s9
    s_min_u32 s22, s8, 192
    s_min_u32 s23, s23, 192
    s_mov_b32 s30, s19
    s_waitcnt lgkmcnt(12)
    v_cmp_ne_u32 vcc, 0, v202
    v_readfirstlane_b32 s19, v203
    s_cbranch_vccnz L_OVF
    s_waitcnt lgkmcnt(9)
    s_mov_b64 exec, s[64:65]
    v_add_u32 v96, v96, v112
    ds_write2st64_b32 v96, v128, v204 offset0:148 offset1:220
    s_mov_b64 exec, s[66:67]
    v_add_u32 v97, v97, v113
    ds_write2st64_b32 v97, v129, v205 offset0:148 offset1:220
    s_mov_b64 exec, s[68:69]
    v_add_u32 v98, v98, v114
    ds_write2st64_b32 v98, v130, v206 offset0:148 offset1:220
    s_waitcnt lgkmcnt(9)
    s_mov_b64 exec, s[72:73]
    v_add_u32 v100, v100, v116
    ds_write2st64_b32 v100, v132, v208 offset0:148 offset1:220
    s_mov_b64 exec, s[74:75]
    v_add_u32 v101, v101, v117
    ds_write2st64_b32 v101, v133, v209 offset0:148 offset1:220
    s_mov_b64 exec, s[76:77]
    v_add_u32 v102, v102, v118
    ds_write2st64_b32 v102, v134, v210 offset0:148 offset1:220
    s_waitcnt lgkmcnt(9)
    s_mov_b64 exec, s[80:81]
    v_add_u32 v104, v104, v120
    ds_write2st64_b32 v104, v136, v212 offset0:148 offset1:220
    s_mov_b64 exec, s[82:83]
    v_add_u32 v105, v105, v121
    ds_write2st64_b32 v105, v137, v213 offset0:148 offset1:220
    s_mov_b64 exec, s[84:85]
    v_add_u32 v106, v106, v122
    ds_write2st64_b32 v106, v138, v214 offset0:148 offset1:220
    s_waitcnt lgkmcnt(9)
    s_mov_b64 exec, s[88:89]
    v_add_u32 v108, v108, v124
    ds_write2st64_b32 v108, v140, v216 offset0:148 offset1:220
    s_mov_b64 exec, s[90:91]
    v_add_u32 v109, v109, v125
    ds_write2st64_b32 v109, v141, v217 offset0:148 offset1:220
    s_mov_b64 exec, s[92:93]
    v_add_u32 v110, v110, v126
    ds_write2st64_b32 v110, v142, v218 offset0:148 offset1:220
    s_mov_b64 exec, -1
    s_add_u32 s10, s96, 127
    s_lshr_b32 s10, s10, 7
    s_lshl1_add_u32 s10, s10, -1
    s_add_u32 s11, s31, 127
    s_lshr_b32 s11, s11, 6
    s_and_b32 s11, s11, -2
    s_max_i32 s17, s10, s11
    s_cselect_b32 s10, s96, s31
    s_sub_u32 s10, s10, 1
    s_andn2_b32 s99, 64, s10
L_CA:
    ds_read_b64_tr_b16 v[96:97], v225 offset:0
    ds_read_b64_tr_b16 v[98:99], v225 offset:1280
    ds_read_b64_tr_b16 v[100:101], v225 offset:5120
    ds_read_b64_tr_b16 v[102:103], v225 offset:6400
    ds_read_b64_tr_b16 v[104:105], v225 offset:32
    ds_read_b64_tr_b16 v[106:107], v225 offset:1312
    ds_read_b64_tr_b16 v[108:109], v225 offset:5152
    ds_read_b64_tr_b16 v[110:111], v225 offset:6432
    ds_read_b64_tr_b16 v[112:113], v225 offset:64
    ds_read_b64_tr_b16 v[114:115], v225 offset:1344
    ds_read_b64_tr_b16 v[116:117], v225 offset:5184
    ds_read_b64_tr_b16 v[118:119], v225 offset:6464
    ds_read_b64_tr_b16 v[120:121], v225 offset:96
    ds_read_b64_tr_b16 v[122:123], v225 offset:1376
    ds_read_b64_tr_b16 v[124:125], v225 offset:5216
    ds_read_b64_tr_b16 v[126:127], v225 offset:6496
    s_cmp_eq_u32 s21, 0
    s_cbranch_scc1 L_XT2R
    s_waitcnt vmcnt(8)
L_XT2:
    s_mov_b64 s[34:35], 0
    v_cmp_ne_u32 vcc, s6, v65
    s_and_b64 vcc, vcc, s[70:71]
    s_or_b64 s[34:35], s[34:35], vcc
    v_cmp_ne_u32 vcc, s6, v69
    s_and_b64 vcc, vcc, s[78:79]
    s_or_b64 s[34:35], s[34:35], vcc
    v_cmp_ne_u32 vcc, s6, v73
    s_and_b64 vcc, vcc, s[86:87]
    s_or_b64 s[34:35], s[34:35], vcc
    v_cmp_ne_u32 vcc, s6, v77
    s_and_b64 vcc, vcc, s[94:95]
    s_or_b64 s[34:35], s[34:35], vcc
    s_cbranch_scc1 L_XT2B
    s_cmp_eq_u32 s20, 0
    s_cbranch_scc1 L_XT2R
    s_mov_b64 exec, s[70:71]
    s_cbranch_execz L_XS0
    v_bfe_u32 v65, v64, 18, 8
    v_lshlrev_b32 v65, 2, v65
    v_add_u32 v67, 153728, v65
    ds_read_b32 v67, v67
    v_add_u32_sdwa v66, v66, v156 dst_sel:DWORD dst_unused:UNUSED_PAD src0_sel:BYTE_0 src1_sel:DWORD
    v_lshrrev_b32 v189, 28, v64
    v_lshl_add_u32 v66, v189, 8, v66
    v_and_b32 v189, 60, v65
    v_and_b32 v64, 0xffff, v64
    v_lshl_or_b32 v64, v189, 19, v64
    s_waitcnt lgkmcnt(0)
    ds_add_rtn_u32 v67, v67, v184 offset:576
    s_waitcnt lgkmcnt(0)
    ds_write2st64_b32 v67, v64, v66 offset0:148 offset1:220
L_XS0:
    s_mov_b64 exec, s[78:79]
    s_cbranch_execz L_XS1
    v_bfe_u32 v69, v68, 18, 8
    v_lshlrev_b32 v69, 2, v69
    v_add_u32 v71, 153728, v69
    ds_read_b32 v71, v71
    v_add_u32_sdwa v70, v70, v157 dst_sel:DWORD dst_unused:UNUSED_PAD src0_sel:BYTE_0 src1_sel:DWORD
    v_lshrrev_b32 v189, 28, v68
    v_lshl_add_u32 v70, v189, 8, v70
    v_and_b32 v189, 60, v69
    v_and_b32 v68, 0xffff, v68
    v_lshl_or_b32 v68, v189, 19, v68
    s_waitcnt lgkmcnt(0)
    ds_add_rtn_u32 v71, v71, v184 offset:576
    s_waitcnt lgkmcnt(0)
    ds_write2st64_b32 v71, v68, v70 offset0:148 offset1:220
L_XS1:
    s_mov_b64 exec, s[86:87]
    s_cbranch_execz L_XS2
    v_bfe_u32 v73, v72, 18, 8
    v_lshlrev_b32 v73, 2, v73
    v_add_u32 v75, 153728, v73
    ds_read_b32 v75, v75
    v_add_u32_sdwa v74, v74, v158 dst_sel:DWORD dst_unused:UNUSED_PAD src0_sel:BYTE_0 src1_sel:DWORD
    v_lshrrev_b32 v189, 28, v72
    v_lshl_add_u32 v74, v189, 8, v74
    v_and_b32 v189, 60, v73
    v_and_b32 v72, 0xffff, v72
    v_lshl_or_b32 v72, v189, 19, v72
    s_waitcnt lgkmcnt(0)
    ds_add_rtn_u32 v75, v75, v184 offset:576
    s_waitcnt lgkmcnt(0)
    ds_write2st64_b32 v75, v72, v74 offset0:148 offset1:220
L_XS2:
    s_mov_b64 exec, s[94:95]
    s_cbranch_execz L_XS3
    v_bfe_u32 v77, v76, 18, 8
    v_lshlrev_b32 v77, 2, v77
    v_add_u32 v79, 153728, v77
    ds_read_b32 v79, v79
    v_add_u32_sdwa v78, v78, v159 dst_sel:DWORD dst_unused:UNUSED_PAD src0_sel:BYTE_0 src1_sel:DWORD
    v_lshrrev_b32 v189, 28, v76
    v_lshl_add_u32 v78, v189, 8, v78
    v_and_b32 v189, 60, v77
    v_and_b32 v76, 0xffff, v76
    v_lshl_or_b32 v76, v189, 19, v76
    s_waitcnt lgkmcnt(0)
    ds_add_rtn_u32 v79, v79, v184 offset:576
    s_waitcnt lgkmcnt(0)
    ds_write2st64_b32 v79, v76, v78 offset0:148 offset1:220
L_XS3:
    s_mov_b64 exec, -1
L_XT2R:
    s_lshl_b32 s34, s22, 5
    s_lshl_b32 s35, s23, 5
    s_mov_b32 vcc_lo, 0xff00ff00
    s_mov_b32 vcc_hi, 0xff00ff00
    v_mov_b32 v176, s35
    v_mov_b32 v177, s34
    v_cndmask_b32 v176, v176, v177, vcc
    v_and_b32 v177, 4, v247
    v_lshlrev_b32 v177, 6, v177
    v_lshl_add_u32 v177, v246, 2, v177
    v_sub_u32 v177, v177, v176
    v_and_b32 v178, 48, v247
    s_movk_i32 s34, 832
    v_mad_u32_u24 v178, v246, s34, v178
    s_mov_b32 s34, 116736
    v_add3_u32 v178, v178, v176, s34
    v_and_b32 v176, 0x1ff, v177
    v_add_u32 v176, v176, v178
    v_add_u32 v177, 0x80, v177
    v_and_b32 v177, 0x1ff, v177
    v_add_u32 v177, v177, v178
    v_mov_b64 v[184:185], 0
    v_mov_b64 v[186:187], 0
    v_lshrrev_b32 v188, 2, v247
    v_and_b32 v188, 12, v188
    v_subrev_u32 v188, s25, v188
    v_mov_b32 v189, 0x358637bd
    v_mfma_f32_32x32x16_bf16 v[144:159], v[184:187], v[184:187], 0
    v_cmp_ne_u32 s[80:81], 0, v188
    v_cmp_ne_u32 s[82:83], -1, v188
    v_cmp_ne_u32 s[84:85], -2, v188
    v_cmp_ne_u32 s[86:87], -3, v188
    v_cndmask_b32 v128, 0, v189, s[80:81]
    v_cndmask_b32 v129, 0, v189, s[82:83]
    v_cndmask_b32 v130, 0, v189, s[84:85]
    v_cndmask_b32 v131, 0, v189, s[86:87]
    v_mov_b64 v[132:133], v[128:129]
    v_mov_b64 v[134:135], v[130:131]
    v_mov_b64 v[136:137], v[128:129]
    v_mov_b64 v[138:139], v[130:131]
    v_mov_b64 v[140:141], v[128:129]
    v_mov_b64 v[142:143], v[130:131]
    s_cmp_ge_u32 s3, 4
    s_cbranch_scc1 L_EP0
    s_lshl_b32 s72, s4, 7
    s_add_u32 s72, s72, 157824
    v_mov_b32 v190, s22
    s_mov_b32 exec_lo, 0xffff0000
    v_mov_b32 v190, s23
    s_mov_b32 exec_lo, -1
    s_mov_b32 exec_hi, 0
    v_sub_u32 v191, v247, v190
    v_and_b32 v191, 15, v191
    v_add_lshl_u32 v191, v191, v190, 5
    v_lshl_add_u32 v190, v247, 2, s72
    ds_write_b32 v190, v191
    s_mov_b32 exec_hi, -1
    s_mul_i32 s10, s5, 196
    s_add_u32 s11, s10, s7
    s_add_u32 s62, s10, s9
    s_min_u32 s11, s11, 50000
    s_min_u32 s62, s62, 50000
    s_sub_u32 s62, s62, s11
    s_lshl_b32 s11, s11, 7
    s_lshl_b32 s62, s62, 7
    s_add_u32 s60, s48, s11
    s_addc_u32 s61, s49, 0
    s_mul_i32 s74, s7, -128
    s_add_u32 s11, s10, s8
    s_add_u32 s50, s10, s24
    s_min_u32 s11, s11, 50000
    s_min_u32 s50, s50, 50000
    s_sub_u32 s50, s50, s11
    s_lshl_b32 s11, s11, 7
    s_lshl_b32 s50, s50, 7
    s_add_u32 s48, s48, s11
    s_addc_u32 s49, s49, 0
    s_mul_i32 s73, s8, -128
    s_and_b32 s10, s25, 12
    s_lshl_b32 s10, s10, 2
    s_bfm_b64 s[76:77], 16, s10
L_EP0:
    s_waitcnt vmcnt(0) lgkmcnt(0)
    s_barrier
    s_mov_b32 s10, 0x358637bd
    ds_read_b128 v[236:239], v248
    ds_read_b32 v240, v249
    ds_read_b128 v[160:163], v176 offset:0
    ds_read_b128 v[164:167], v176 offset:64
    ds_read_b128 v[168:171], v177 offset:0
    ds_read_b128 v[172:175], v177 offset:64
    s_waitcnt lgkmcnt(4)
    s_cmp_ge_u32 s3, 4
    s_cbranch_scc1 L_LATE0
    s_add_u32 m0, s13, 0
    v_mad_u32_u16 v236, v236, s15, v243
    buffer_load_dwordx4 v236, s[40:43], 0 offen lds
    s_add_u32 m0, s13, 1056
    v_mad_u32_u16 v237, v237, s15, v243
    buffer_load_dwordx4 v237, s[40:43], 0 offen lds
    s_add_u32 m0, s13, 2112
    v_mad_u32_u16 v238, v238, s15, v243
    buffer_load_dwordx4 v238, s[40:43], 0 offen lds
    s_add_u32 m0, s13, 3168
    v_mad_u32_u16 v239, v239, s15, v243
    buffer_load_dwordx4 v239, s[40:43], 0 offen lds
    s_mov_b32 m0, s14
    s_nop 0
    buffer_load_dwordx4 v[240:241], s[44:47], 0 idxen offen lds
L_LATE0:
    s_mov_b32 s34, 0xbfb8aa3b
    s_mov_b32 s35, s34
    s_waitcnt lgkmcnt(3)
    v_mfma_f32_16x16x32_bf16 v[204:207], v[160:163], v[96:99], 0
    v_mfma_f32_16x16x32_bf16 v[212:215], v[160:163], v[104:107], 0
    v_mfma_f32_16x16x32_bf16 v[220:223], v[160:163], v[112:115], 0
    v_mfma_f32_16x16x32_bf16 v[228:231], v[160:163], v[120:123], 0
    s_waitcnt lgkmcnt(2)
    v_mfma_f32_16x16x32_bf16 v[204:207], v[164:167], v[100:103], v[204:207]
    v_mfma_f32_16x16x32_bf16 v[212:215], v[164:167], v[108:111], v[212:215]
    v_mfma_f32_16x16x32_bf16 v[220:223], v[164:167], v[116:119], v[220:223]
    v_mfma_f32_16x16x32_bf16 v[228:231], v[164:167], v[124:127], v[228:231]
    s_waitcnt lgkmcnt(1)
    v_mfma_f32_16x16x32_bf16 v[208:211], v[168:171], v[96:99], 0
    v_mfma_f32_16x16x32_bf16 v[216:219], v[168:171], v[104:107], 0
    v_mfma_f32_16x16x32_bf16 v[224:227], v[168:171], v[112:115], 0
    v_mfma_f32_16x16x32_bf16 v[232:235], v[168:171], v[120:123], 0
    s_waitcnt lgkmcnt(0)
    v_mfma_f32_16x16x32_bf16 v[208:211], v[172:175], v[100:103], v[208:211]
    v_mfma_f32_16x16x32_bf16 v[216:219], v[172:175], v[108:111], v[216:219]
    v_mfma_f32_16x16x32_bf16 v[224:227], v[172:175], v[116:119], v[224:227]
    v_mfma_f32_16x16x32_bf16 v[232:235], v[172:175], v[124:127], v[232:235]
    s_mov_b32 s11, s10
    v_mov_b64 v[96:97], s[10:11]
    v_mov_b64 v[98:99], s[10:11]
    v_mov_b64 v[100:101], s[10:11]
    v_mov_b64 v[102:103], s[10:11]
    v_mov_b64 v[104:105], s[10:11]
    v_mov_b64 v[106:107], s[10:11]
    v_mov_b64 v[108:109], s[10:11]
    v_mov_b64 v[110:111], s[10:11]
    v_pk_mul_f32 v[204:205], v[204:205], s[34:35]
    v_pk_mul_f32 v[206:207], v[206:207], s[34:35]
    v_pk_mul_f32 v[208:209], v[208:209], s[34:35]
    v_pk_mul_f32 v[210:211], v[210:211], s[34:35]
    v_pk_mul_f32 v[212:213], v[212:213], s[34:35]
    v_pk_mul_f32 v[214:215], v[214:215], s[34:35]
    v_pk_mul_f32 v[216:217], v[216:217], s[34:35]
    v_pk_mul_f32 v[218:219], v[218:219], s[34:35]
    v_pk_mul_f32 v[220:221], v[220:221], s[34:35]
    v_pk_mul_f32 v[222:223], v[222:223], s[34:35]
    v_pk_mul_f32 v[224:225], v[224:225], s[34:35]
    v_pk_mul_f32 v[226:227], v[226:227], s[34:35]
    v_pk_mul_f32 v[228:229], v[228:229], s[34:35]
    v_pk_mul_f32 v[230:231], v[230:231], s[34:35]
    v_pk_mul_f32 v[232:233], v[232:233], s[34:35]
    v_pk_mul_f32 v[234:235], v[234:235], s[34:35]
    v_mfma_f32_32x32x16_bf16 v[112:127], v[184:187], v[184:187], 0
    v_cvt_pk_bf16_f32 v64, v204, v205
    v_cvt_pk_bf16_f32 v65, v206, v207
    v_cvt_pk_bf16_f32 v66, v208, v209
    v_cvt_pk_bf16_f32 v67, v210, v211
    v_cvt_pk_bf16_f32 v68, v212, v213
    v_cvt_pk_bf16_f32 v69, v214, v215
    v_cvt_pk_bf16_f32 v70, v216, v217
    v_cvt_pk_bf16_f32 v71, v218, v219
    v_cvt_pk_bf16_f32 v72, v220, v221
    v_cvt_pk_bf16_f32 v73, v222, v223
    v_cvt_pk_bf16_f32 v74, v224, v225
    v_cvt_pk_bf16_f32 v75, v226, v227
    v_cvt_pk_bf16_f32 v76, v228, v229
    v_cvt_pk_bf16_f32 v77, v230, v231
    v_cvt_pk_bf16_f32 v78, v232, v233
    v_cvt_pk_bf16_f32 v79, v234, v235
    v_permlane32_swap_b32 v80, v64
    v_permlane32_swap_b32 v81, v65
    v_permlane32_swap_b32 v82, v66
    v_permlane32_swap_b32 v83, v67
    v_permlane32_swap_b32 v84, v68
    v_permlane32_swap_b32 v85, v69
    v_permlane32_swap_b32 v86, v70
    v_permlane32_swap_b32 v87, v71
    v_permlane32_swap_b32 v88, v72
    v_permlane32_swap_b32 v89, v73
    v_permlane32_swap_b32 v90, v74
    v_permlane32_swap_b32 v91, v75
    v_permlane32_swap_b32 v92, v76
    v_permlane32_swap_b32 v93, v77
    v_permlane32_swap_b32 v94, v78
    v_permlane32_swap_b32 v95, v79
    s_mov_b32 s26, -1
    s_mov_b64 s[32:33], 0
    s_mov_b32 s28, 0
    s_mov_b32 s29, 0
    s_cmp_lt_u32 s3, 4
    s_cbranch_scc1 L_HAD0
    s_add_u32 m0, s13, 0
    v_mad_u32_u16 v236, v236, s15, v243
    buffer_load_dwordx4 v236, s[40:43], 0 offen lds
    s_add_u32 m0, s13, 1056
    v_mad_u32_u16 v237, v237, s15, v243
    buffer_load_dwordx4 v237, s[40:43], 0 offen lds
    s_add_u32 m0, s13, 2112
    v_mad_u32_u16 v238, v238, s15, v243
    buffer_load_dwordx4 v238, s[40:43], 0 offen lds
    s_add_u32 m0, s13, 3168
    v_mad_u32_u16 v239, v239, s15, v243
    buffer_load_dwordx4 v239, s[40:43], 0 offen lds
    s_mov_b32 m0, s14
    s_nop 0
    buffer_load_dwordx4 v[240:241], s[44:47], 0 idxen offen lds
    s_lshl_b32 s72, s4, 7
    s_add_u32 s72, s72, 157824
    v_mov_b32 v190, s22
    s_mov_b32 exec_lo, 0xffff0000
    v_mov_b32 v190, s23
    s_mov_b32 exec_lo, -1
    s_mov_b32 exec_hi, 0
    v_sub_u32 v191, v247, v190
    v_and_b32 v191, 15, v191
    v_add_lshl_u32 v191, v191, v190, 5
    v_lshl_add_u32 v190, v247, 2, s72
    ds_write_b32 v190, v191
    s_mov_b32 exec_hi, -1
    s_mul_i32 s10, s5, 196
    s_add_u32 s11, s10, s7
    s_add_u32 s62, s10, s9
    s_min_u32 s11, s11, 50000
    s_min_u32 s62, s62, 50000
    s_sub_u32 s62, s62, s11
    s_lshl_b32 s11, s11, 7
    s_lshl_b32 s62, s62, 7
    s_add_u32 s60, s48, s11
    s_addc_u32 s61, s49, 0
    s_mul_i32 s74, s7, -128
    s_add_u32 s11, s10, s8
    s_add_u32 s50, s10, s24
    s_min_u32 s11, s11, 50000
    s_min_u32 s50, s50, 50000
    s_sub_u32 s50, s50, s11
    s_lshl_b32 s11, s11, 7
    s_lshl_b32 s50, s50, 7
    s_add_u32 s48, s48, s11
    s_addc_u32 s49, s49, 0
    s_mul_i32 s73, s8, -128
    s_and_b32 s10, s25, 12
    s_lshl_b32 s10, s10, 2
    s_bfm_b64 s[76:77], 16, s10
L_HAD0:
    s_cmp_eq_u32 s30, 0
    s_cbranch_scc1 L_GO
    s_lshl_b32 s10, s4, 3
    v_mov_b32 v188, s10
    ds_read_b64 v[188:189], v188 offset:576
    s_waitcnt lgkmcnt(0)
    v_readfirstlane_b32 s34, v188
    v_readfirstlane_b32 s35, v189
    s_sub_u32 s10, s12, 37888
    s_sub_u32 s34, s34, s10
    s_sub_u32 s35, s35, s10
    s_sub_u32 s35, s35, 1152
    s_add_u32 s10, s34, 127
    s_lshr_b32 s10, s10, 7
    s_lshl1_add_u32 s10, s10, -1
    s_add_u32 s11, s35, 127
    s_lshr_b32 s11, s11, 6
    s_and_b32 s11, s11, -2
    s_max_i32 s17, s10, s11
    s_cselect_b32 s10, s34, s35
    s_sub_u32 s10, s10, 1
    s_andn2_b32 s99, 64, s10
L_GO:
    ds_read_u16 v252, v250 offset:0
    ds_read_u16 v253, v250 offset:64
    ds_read_b128 v[236:239], v248 offset:1152
    ds_read_b32 v240, v249 offset:1152
    s_lshr_b32 s10, s4, 1
    s_lshl_b32 s10, s10, 9
    s_add_u32 s10, s10, 155776
    v_lshl_add_u32 v246, v247, 3, s10
    s_bitcmp1_b32 s4, 0
    s_cselect_b32 s101, -1, 1
    s_mul_i32 s10, s101, 0xff000000
    s_or_b32 s10, s10, 0xdddd
    v_mov_b32 v255, s10
    s_max_i32 s10, s17, 1
    s_sub_u32 s10, s10, 1
    s_mul_i32 s10, s101, s10
    s_lshl_b32 s10, s10, 24
    v_mov_b32 v188, s10
    ds_add_u32 v246, v188
    s_movk_i32 s94, 128
    s_movk_i32 s95, 128
    v_mov_b32 v247, 0
    s_mov_b32 exec_hi, 0
    v_add_u32 v247, 0x200, v245
    s_mov_b32 exec_hi, -1
    s_waitcnt lgkmcnt(0)
    v_bfi_b32 v252, 31, v245, v252
    v_bfi_b32 v253, 31, v245, v253
    v_max_u32 v252, v252, v245
    v_max_u32 v253, v253, v247
    s_waitcnt vmcnt(0)
    ds_read_b128 v[176:179], v252
    ds_read_b128 v[180:183], v253
    ds_read_b128 v[160:163], v244 offset:0
    ds_read_b128 v[168:171], v244 offset:512
    ds_read_b128 v[164:167], v244 offset:64
    ds_read_b128 v[172:175], v244 offset:576
    s_cmp_lt_i32 s17, 1
    s_cbranch_scc1 L_DONE
    s_waitcnt lgkmcnt(4)
    v_mfma_f32_16x16x32_bf16 v[188:191], v[176:179], v[64:67], 0
    v_mfma_f32_16x16x32_bf16 v[196:199], v[176:179], v[68:71], 0
    v_mfma_f32_16x16x32_bf16 v[192:195], v[180:183], v[64:67], 0
    v_mfma_f32_16x16x32_bf16 v[200:203], v[180:183], v[68:71], 0
    s_waitcnt lgkmcnt(0)
    v_mfma_f32_16x16x32_bf16 v[188:191], v[160:163], v[0:3], v[188:191]
    v_mfma_f32_16x16x32_bf16 v[196:199], v[160:163], v[8:11], v[196:199]
    v_mfma_f32_16x16x32_bf16 v[192:195], v[168:171], v[0:3], v[192:195]
    v_mfma_f32_16x16x32_bf16 v[200:203], v[168:171], v[8:11], v[200:203]
    v_mfma_f32_16x16x32_bf16 v[188:191], v[164:167], v[4:7], v[188:191]
    v_mfma_f32_16x16x32_bf16 v[196:199], v[164:167], v[12:15], v[196:199]
    v_mfma_f32_16x16x32_bf16 v[192:195], v[172:175], v[4:7], v[192:195]
    v_mfma_f32_16x16x32_bf16 v[200:203], v[172:175], v[12:15], v[200:203]
    s_mov_b32 s16, 1
    s_cmp_eq_u32 s17, 1
    s_cbranch_scc1 L_LT0
    s_add_u32 m0, s13, 0
    v_mad_u32_u16 v236, v236, s15, v243
    buffer_load_dwordx4 v236, s[40:43], 0 offen lds
    s_add_u32 m0, s13, 1056
    v_mad_u32_u16 v237, v237, s15, v243
    buffer_load_dwordx4 v237, s[40:43], 0 offen lds
    s_add_u32 m0, s13, 2112
    v_mad_u32_u16 v238, v238, s15, v243
    buffer_load_dwordx4 v238, s[40:43], 0 offen lds
    s_add_u32 m0, s13, 3168
    v_mad_u32_u16 v239, v239, s15, v243
    buffer_load_dwordx4 v239, s[40:43], 0 offen lds
    s_mov_b32 m0, s14
    s_nop 0
    buffer_load_dwordx4 v[240:241], s[44:47], 0 idxen offen lds
.p2align 6
L_LOOP1:
    s_setprio 1
    v_smfmac_f32_16x16x64_bf16 v[152:155], v[184:187], v[204:211], v255
    ds_read_u16 v236, v251 offset:0
    ds_read_u16 v237, v251 offset:16
    ds_add_rtn_u32 v238, v246, v255
    v_exp_f32 v188, v188
    v_smfmac_f32_16x16x64_bf16 v[156:159], v[184:187], v[212:219], v255
    v_exp_f32 v189, v189
    v_mfma_f32_16x16x32_bf16 v[204:207], v[160:163], v[32:35], 0
    v_exp_f32 v190, v190
    v_mfma_f32_16x16x32_bf16 v[212:215], v[160:163], v[40:43], 0
    v_exp_f32 v191, v191
    v_mfma_f32_16x16x32_bf16 v[208:211], v[168:171], v[32:35], 0
    v_exp_f32 v192, v192
    v_mfma_f32_16x16x32_bf16 v[216:219], v[168:171], v[40:43], 0
    v_exp_f32 v193, v193
    v_mfma_f32_16x16x32_bf16 v[204:207], v[164:167], v[36:39], v[204:207]
    v_exp_f32 v194, v194
    v_mfma_f32_16x16x32_bf16 v[212:215], v[164:167], v[44:47], v[212:215]
    v_exp_f32 v195, v195
    v_mfma_f32_16x16x32_bf16 v[208:211], v[172:175], v[36:39], v[208:211]
    s_waitcnt lgkmcnt(0)
    v_bfi_b32 v236, 31, v246, v236
    v_bfi_b32 v237, 31, v246, v237
    v_readfirstlane_b32 s96, v238
    v_exp_f32 v196, v196
    v_mfma_f32_16x16x32_bf16 v[216:219], v[172:175], v[44:47], v[216:219]
    v_exp_f32 v197, v197
    v_smfmac_f32_16x16x64_bf16 v[136:139], v[184:187], v[220:227], v255
    v_exp_f32 v198, v198
    v_smfmac_f32_16x16x64_bf16 v[140:143], v[184:187], v[228:235], v255
    v_exp_f32 v199, v199
    v_mfma_f32_4x4x4_16b_bf16 v[188:191], v[242:243], v[242:243], v[188:191]
    v_exp_f32 v200, v200
    v_mfma_f32_4x4x4_16b_bf16 v[192:195], v[242:243], v[242:243], v[192:195]
    v_exp_f32 v201, v201
    v_mfma_f32_4x4x4_16b_bf16 v[196:199], v[242:243], v[242:243], v[196:199]
    v_exp_f32 v202, v202
    v_mfma_f32_16x16x32_bf16 v[220:223], v[176:179], v[72:75], 0
    ds_read_b64_tr_b16 v[184:185], v236
    ds_read_b64_tr_b16 v[186:187], v237
    ds_read_u16 v252, v250 offset:1152
    ds_read_u16 v253, v250 offset:1216
    v_exp_f32 v203, v203
    v_mfma_f32_16x16x32_bf16 v[228:231], v[176:179], v[76:79], 0
    s_ashr_i32 s96, s96, 24
    s_mul_i32 s96, s96, s101
    v_rcp_f32 v188, v188
    v_mfma_f32_16x16x32_bf16 v[224:227], v[180:183], v[72:75], 0
    v_rcp_f32 v189, v189
    v_mfma_f32_4x4x4_16b_bf16 v[200:203], v[242:243], v[242:243], v[200:203]
    v_rcp_f32 v190, v190
    v_mfma_f32_16x16x32_bf16 v[232:235], v[180:183], v[76:79], 0
    v_rcp_f32 v191, v191
    v_mfma_f32_16x16x32_bf16 v[220:223], v[160:163], v[16:19], v[220:223]
    v_rcp_f32 v192, v192
    v_mfma_f32_16x16x32_bf16 v[228:231], v[160:163], v[24:27], v[228:231]
    v_rcp_f32 v193, v193
    v_mfma_f32_16x16x32_bf16 v[224:227], v[168:171], v[16:19], v[224:227]
    s_waitcnt lgkmcnt(0)
    v_bfi_b32 v252, 31, v245, v252
    v_bfi_b32 v253, 31, v245, v253
    v_max_u32 v252, v252, v245
    v_max_u32 v253, v253, v247
    ds_read_b128 v[236:239], v248 offset:128
    ds_read_b32 v240, v249 offset:128
    s_add_u32 s16, s16, 1
    v_rcp_f32 v194, v194
    v_mfma_f32_16x16x32_bf16 v[232:235], v[168:171], v[24:27], v[232:235]
    v_rcp_f32 v195, v195
    v_mfma_f32_16x16x32_bf16 v[220:223], v[164:167], v[20:23], v[220:223]
    v_rcp_f32 v196, v196
    v_mfma_f32_16x16x32_bf16 v[228:231], v[164:167], v[28:31], v[228:231]
    v_rcp_f32 v197, v197
    s_setprio 3
    v_mfma_f32_16x16x32_bf16 v[224:227], v[172:175], v[20:23], v[224:227]
    v_rcp_f32 v198, v198
    v_mfma_f32_16x16x32_bf16 v[232:235], v[172:175], v[28:31], v[232:235]
    v_rcp_f32 v199, v199
    v_rcp_f32 v200, v200
    v_rcp_f32 v201, v201
    v_rcp_f32 v202, v202
    v_rcp_f32 v203, v203
    v_pk_mul_f32 v[204:205], v[188:189], v[204:205]
    v_pk_mul_f32 v[206:207], v[190:191], v[206:207]
    v_pk_mul_f32 v[208:209], v[192:193], v[208:209]
    v_pk_mul_f32 v[210:211], v[194:195], v[210:211]
    v_pk_mul_f32 v[212:213], v[196:197], v[212:213]
    v_pk_mul_f32 v[214:215], v[198:199], v[214:215]
    v_pk_mul_f32 v[216:217], v[200:201], v[216:217]
    v_pk_mul_f32 v[218:219], v[202:203], v[218:219]
    s_cmp_ge_i32 s96, 1
    s_cbranch_scc0 L_PB00
L_PB01:
    s_setprio 1
    v_smfmac_f32_16x16x64_bf16 v[112:115], v[184:187], v[204:211], v255
    v_exp_f32 v220, v220
    v_smfmac_f32_16x16x64_bf16 v[116:119], v[184:187], v[212:219], v255
    v_exp_f32 v221, v221
    s_waitcnt vmcnt(0)
    ds_read_b128 v[176:179], v252
    ds_read_b128 v[180:183], v253
    v_mfma_f32_16x16x32_bf16 v[204:207], v[160:163], v[48:51], 0
    v_exp_f32 v222, v222
    v_mfma_f32_16x16x32_bf16 v[212:215], v[160:163], v[56:59], 0
    ds_read_b128 v[160:163], v244 offset:0
    v_exp_f32 v223, v223
    v_mfma_f32_16x16x32_bf16 v[208:211], v[168:171], v[48:51], 0
    v_exp_f32 v224, v224
    v_mfma_f32_16x16x32_bf16 v[216:219], v[168:171], v[56:59], 0
    ds_read_b128 v[168:171], v244 offset:512
    v_exp_f32 v225, v225
    v_mfma_f32_16x16x32_bf16 v[204:207], v[164:167], v[52:55], v[204:207]
    v_exp_f32 v226, v226
    v_mfma_f32_16x16x32_bf16 v[212:215], v[164:167], v[60:63], v[212:215]
    ds_read_b128 v[164:167], v244 offset:64
    v_exp_f32 v227, v227
    v_mfma_f32_16x16x32_bf16 v[208:211], v[172:175], v[52:55], v[208:211]
    v_exp_f32 v228, v228
    v_mfma_f32_16x16x32_bf16 v[216:219], v[172:175], v[60:63], v[216:219]
    ds_read_b128 v[172:175], v244 offset:576
    v_exp_f32 v229, v229
    v_smfmac_f32_16x16x64_bf16 v[96:99], v[184:187], v[188:195], v255
    v_exp_f32 v230, v230
    v_smfmac_f32_16x16x64_bf16 v[100:103], v[184:187], v[196:203], v255
    v_exp_f32 v231, v231
    v_mfma_f32_4x4x4_16b_bf16 v[220:223], v[242:243], v[242:243], v[220:223]
    v_exp_f32 v232, v232
    v_mfma_f32_4x4x4_16b_bf16 v[224:227], v[242:243], v[242:243], v[224:227]
    v_exp_f32 v233, v233
    v_mfma_f32_4x4x4_16b_bf16 v[228:231], v[242:243], v[242:243], v[228:231]
    v_exp_f32 v234, v234
    s_waitcnt lgkmcnt(4)
    v_mfma_f32_16x16x32_bf16 v[188:191], v[176:179], v[80:83], 0
    v_exp_f32 v235, v235
    v_mfma_f32_16x16x32_bf16 v[196:199], v[176:179], v[84:87], 0
    v_rcp_f32 v220, v220
    v_mfma_f32_16x16x32_bf16 v[192:195], v[180:183], v[80:83], 0
    v_rcp_f32 v221, v221
    v_mfma_f32_4x4x4_16b_bf16 v[232:235], v[242:243], v[242:243], v[232:235]
    v_rcp_f32 v222, v222
    v_mfma_f32_16x16x32_bf16 v[200:203], v[180:183], v[84:87], 0
    v_rcp_f32 v223, v223
    s_waitcnt lgkmcnt(3)
    v_mfma_f32_16x16x32_bf16 v[188:191], v[160:163], v[0:3], v[188:191]
    v_rcp_f32 v224, v224
    v_mfma_f32_16x16x32_bf16 v[196:199], v[160:163], v[8:11], v[196:199]
    v_rcp_f32 v225, v225
    s_waitcnt lgkmcnt(2)
    v_mfma_f32_16x16x32_bf16 v[192:195], v[168:171], v[0:3], v[192:195]
    v_rcp_f32 v226, v226
    v_mfma_f32_16x16x32_bf16 v[200:203], v[168:171], v[8:11], v[200:203]
    v_rcp_f32 v227, v227
    s_waitcnt lgkmcnt(1)
    v_mfma_f32_16x16x32_bf16 v[188:191], v[164:167], v[4:7], v[188:191]
    v_rcp_f32 v228, v228
    v_mfma_f32_16x16x32_bf16 v[196:199], v[164:167], v[12:15], v[196:199]
    v_rcp_f32 v229, v229
    s_setprio 3
    s_waitcnt lgkmcnt(0)
    v_mfma_f32_16x16x32_bf16 v[192:195], v[172:175], v[4:7], v[192:195]
    s_cmp_lt_u32 s16, s17
    s_cbranch_scc0 L_ND01
    s_add_u32 m0, s13, 0
    v_mad_u32_u16 v236, v236, s15, v243
    buffer_load_dwordx4 v236, s[40:43], 0 offen lds
    s_add_u32 m0, s13, 1056
    v_mad_u32_u16 v237, v237, s15, v243
    buffer_load_dwordx4 v237, s[40:43], 0 offen lds
    s_add_u32 m0, s13, 2112
    v_mad_u32_u16 v238, v238, s15, v243
    buffer_load_dwordx4 v238, s[40:43], 0 offen lds
    s_add_u32 m0, s13, 3168
    v_mad_u32_u16 v239, v239, s15, v243
    buffer_load_dwordx4 v239, s[40:43], 0 offen lds
    s_mov_b32 m0, s14
    s_nop 0
    buffer_load_dwordx4 v[240:241], s[44:47], 0 idxen offen lds
L_ND01:
    v_rcp_f32 v230, v230
    v_mfma_f32_16x16x32_bf16 v[200:203], v[172:175], v[12:15], v[200:203]
    v_rcp_f32 v231, v231
    v_rcp_f32 v232, v232
    v_rcp_f32 v233, v233
    v_rcp_f32 v234, v234
    v_rcp_f32 v235, v235
    v_pk_mul_f32 v[204:205], v[220:221], v[204:205]
    v_pk_mul_f32 v[206:207], v[222:223], v[206:207]
    v_pk_mul_f32 v[208:209], v[224:225], v[208:209]
    v_pk_mul_f32 v[210:211], v[226:227], v[210:211]
    v_pk_mul_f32 v[212:213], v[228:229], v[212:213]
    v_pk_mul_f32 v[214:215], v[230:231], v[214:215]
    v_pk_mul_f32 v[216:217], v[232:233], v[216:217]
    v_pk_mul_f32 v[218:219], v[234:235], v[218:219]
    s_cmp_ge_u32 s16, s17
    s_cbranch_scc1 L_LT1
    s_setprio 1
    v_smfmac_f32_16x16x64_bf16 v[120:123], v[184:187], v[204:211], v255
    ds_read_u16 v236, v251 offset:1152
    ds_read_u16 v237, v251 offset:1168
    ds_add_rtn_u32 v238, v246, v255
    v_exp_f32 v188, v188
    v_smfmac_f32_16x16x64_bf16 v[124:127], v[184:187], v[212:219], v255
    v_exp_f32 v189, v189
    v_mfma_f32_16x16x32_bf16 v[204:207], v[160:163], v[32:35], 0
    v_exp_f32 v190, v190
    v_mfma_f32_16x16x32_bf16 v[212:215], v[160:163], v[40:43], 0
    v_exp_f32 v191, v191
    v_mfma_f32_16x16x32_bf16 v[208:211], v[168:171], v[32:35], 0
    v_exp_f32 v192, v192
    v_mfma_f32_16x16x32_bf16 v[216:219], v[168:171], v[40:43], 0
    v_exp_f32 v193, v193
    v_mfma_f32_16x16x32_bf16 v[204:207], v[164:167], v[36:39], v[204:207]
    v_exp_f32 v194, v194
    v_mfma_f32_16x16x32_bf16 v[212:215], v[164:167], v[44:47], v[212:215]
    v_exp_f32 v195, v195
    v_mfma_f32_16x16x32_bf16 v[208:211], v[172:175], v[36:39], v[208:211]
    s_waitcnt lgkmcnt(0)
    v_bfi_b32 v236, 31, v246, v236
    v_bfi_b32 v237, 31, v246, v237
    v_readfirstlane_b32 s96, v238
    v_exp_f32 v196, v196
    v_mfma_f32_16x16x32_bf16 v[216:219], v[172:175], v[44:47], v[216:219]
    v_exp_f32 v197, v197
    v_smfmac_f32_16x16x64_bf16 v[104:107], v[184:187], v[220:227], v255
    v_exp_f32 v198, v198
    v_smfmac_f32_16x16x64_bf16 v[108:111], v[184:187], v[228:235], v255
    v_exp_f32 v199, v199
    v_mfma_f32_4x4x4_16b_bf16 v[188:191], v[242:243], v[242:243], v[188:191]
    v_exp_f32 v200, v200
    v_mfma_f32_4x4x4_16b_bf16 v[192:195], v[242:243], v[242:243], v[192:195]
    v_exp_f32 v201, v201
    v_mfma_f32_4x4x4_16b_bf16 v[196:199], v[242:243], v[242:243], v[196:199]
    v_exp_f32 v202, v202
    v_mfma_f32_16x16x32_bf16 v[220:223], v[176:179], v[88:91], 0
    ds_read_b64_tr_b16 v[184:185], v236
    ds_read_b64_tr_b16 v[186:187], v237
    ds_read_u16 v252, v250 offset:128
    ds_read_u16 v253, v250 offset:192
    v_exp_f32 v203, v203
    v_mfma_f32_16x16x32_bf16 v[228:231], v[176:179], v[92:95], 0
    s_ashr_i32 s96, s96, 24
    s_mul_i32 s96, s96, s101
    v_rcp_f32 v188, v188
    v_mfma_f32_16x16x32_bf16 v[224:227], v[180:183], v[88:91], 0
    v_rcp_f32 v189, v189
    v_mfma_f32_4x4x4_16b_bf16 v[200:203], v[242:243], v[242:243], v[200:203]
    v_rcp_f32 v190, v190
    v_mfma_f32_16x16x32_bf16 v[232:235], v[180:183], v[92:95], 0
    v_rcp_f32 v191, v191
    v_mfma_f32_16x16x32_bf16 v[220:223], v[160:163], v[16:19], v[220:223]
    v_rcp_f32 v192, v192
    v_mfma_f32_16x16x32_bf16 v[228:231], v[160:163], v[24:27], v[228:231]
    v_rcp_f32 v193, v193
    v_mfma_f32_16x16x32_bf16 v[224:227], v[168:171], v[16:19], v[224:227]
    s_waitcnt lgkmcnt(0)
    v_bfi_b32 v252, 31, v245, v252
    v_bfi_b32 v253, 31, v245, v253
    v_max_u32 v252, v252, v245
    v_max_u32 v253, v253, v247
    ds_read_b128 v[236:239], v248 offset:1280
    ds_read_b32 v240, v249 offset:1280
    s_add_u32 s16, s16, 1
    v_rcp_f32 v194, v194
    v_mfma_f32_16x16x32_bf16 v[232:235], v[168:171], v[24:27], v[232:235]
    v_lshl_add_u64 v[248:249], v[248:249], 0, s[94:95]
    v_lshl_add_u64 v[250:251], v[250:251], 0, s[94:95]
    v_rcp_f32 v195, v195
    v_mfma_f32_16x16x32_bf16 v[220:223], v[164:167], v[20:23], v[220:223]
    v_rcp_f32 v196, v196
    v_mfma_f32_16x16x32_bf16 v[228:231], v[164:167], v[28:31], v[228:231]
    v_rcp_f32 v197, v197
    s_setprio 3
    v_mfma_f32_16x16x32_bf16 v[224:227], v[172:175], v[20:23], v[224:227]
    v_rcp_f32 v198, v198
    v_mfma_f32_16x16x32_bf16 v[232:235], v[172:175], v[28:31], v[232:235]
    v_rcp_f32 v199, v199
    v_rcp_f32 v200, v200
    v_rcp_f32 v201, v201
    v_rcp_f32 v202, v202
    v_rcp_f32 v203, v203
    v_pk_mul_f32 v[204:205], v[188:189], v[204:205]
    v_pk_mul_f32 v[206:207], v[190:191], v[206:207]
    v_pk_mul_f32 v[208:209], v[192:193], v[208:209]
    v_pk_mul_f32 v[210:211], v[194:195], v[210:211]
    v_pk_mul_f32 v[212:213], v[196:197], v[212:213]
    v_pk_mul_f32 v[214:215], v[198:199], v[214:215]
    v_pk_mul_f32 v[216:217], v[200:201], v[216:217]
    v_pk_mul_f32 v[218:219], v[202:203], v[218:219]
    s_cmp_ge_i32 s96, 1
    s_cbranch_scc0 L_PB10
L_PB11:
    s_setprio 1
    v_smfmac_f32_16x16x64_bf16 v[144:147], v[184:187], v[204:211], v255
    v_exp_f32 v220, v220
    v_smfmac_f32_16x16x64_bf16 v[148:151], v[184:187], v[212:219], v255
    v_exp_f32 v221, v221
    s_waitcnt vmcnt(0)
    ds_read_b128 v[176:179], v252
    ds_read_b128 v[180:183], v253
    v_mfma_f32_16x16x32_bf16 v[204:207], v[160:163], v[48:51], 0
    v_exp_f32 v222, v222
    v_mfma_f32_16x16x32_bf16 v[212:215], v[160:163], v[56:59], 0
    ds_read_b128 v[160:163], v244 offset:0
    v_exp_f32 v223, v223
    v_mfma_f32_16x16x32_bf16 v[208:211], v[168:171], v[48:51], 0
    v_exp_f32 v224, v224
    v_mfma_f32_16x16x32_bf16 v[216:219], v[168:171], v[56:59], 0
    ds_read_b128 v[168:171], v244 offset:512
    v_exp_f32 v225, v225
    v_mfma_f32_16x16x32_bf16 v[204:207], v[164:167], v[52:55], v[204:207]
    v_exp_f32 v226, v226
    v_mfma_f32_16x16x32_bf16 v[212:215], v[164:167], v[60:63], v[212:215]
    ds_read_b128 v[164:167], v244 offset:64
    v_exp_f32 v227, v227
    v_mfma_f32_16x16x32_bf16 v[208:211], v[172:175], v[52:55], v[208:211]
    v_exp_f32 v228, v228
    v_mfma_f32_16x16x32_bf16 v[216:219], v[172:175], v[60:63], v[216:219]
    ds_read_b128 v[172:175], v244 offset:576
    v_exp_f32 v229, v229
    v_smfmac_f32_16x16x64_bf16 v[128:131], v[184:187], v[188:195], v255
    v_exp_f32 v230, v230
    v_smfmac_f32_16x16x64_bf16 v[132:135], v[184:187], v[196:203], v255
    v_exp_f32 v231, v231
    v_mfma_f32_4x4x4_16b_bf16 v[220:223], v[242:243], v[242:243], v[220:223]
    v_exp_f32 v232, v232
    v_mfma_f32_4x4x4_16b_bf16 v[224:227], v[242:243], v[242:243], v[224:227]
    v_exp_f32 v233, v233
    v_mfma_f32_4x4x4_16b_bf16 v[228:231], v[242:243], v[242:243], v[228:231]
    v_exp_f32 v234, v234
    s_waitcnt lgkmcnt(4)
    v_mfma_f32_16x16x32_bf16 v[188:191], v[176:179], v[64:67], 0
    v_exp_f32 v235, v235
    v_mfma_f32_16x16x32_bf16 v[196:199], v[176:179], v[68:71], 0
    v_rcp_f32 v220, v220
    v_mfma_f32_16x16x32_bf16 v[192:195], v[180:183], v[64:67], 0
    v_rcp_f32 v221, v221
    v_mfma_f32_4x4x4_16b_bf16 v[232:235], v[242:243], v[242:243], v[232:235]
    v_rcp_f32 v222, v222
    v_mfma_f32_16x16x32_bf16 v[200:203], v[180:183], v[68:71], 0
    v_rcp_f32 v223, v223
    s_waitcnt lgkmcnt(3)
    v_mfma_f32_16x16x32_bf16 v[188:191], v[160:163], v[0:3], v[188:191]
    v_rcp_f32 v224, v224
    v_mfma_f32_16x16x32_bf16 v[196:199], v[160:163], v[8:11], v[196:199]
    v_rcp_f32 v225, v225
    s_waitcnt lgkmcnt(2)
    v_mfma_f32_16x16x32_bf16 v[192:195], v[168:171], v[0:3], v[192:195]
    v_rcp_f32 v226, v226
    v_mfma_f32_16x16x32_bf16 v[200:203], v[168:171], v[8:11], v[200:203]
    v_rcp_f32 v227, v227
    s_waitcnt lgkmcnt(1)
    v_mfma_f32_16x16x32_bf16 v[188:191], v[164:167], v[4:7], v[188:191]
    v_rcp_f32 v228, v228
    v_mfma_f32_16x16x32_bf16 v[196:199], v[164:167], v[12:15], v[196:199]
    v_rcp_f32 v229, v229
    s_setprio 3
    s_waitcnt lgkmcnt(0)
    v_mfma_f32_16x16x32_bf16 v[192:195], v[172:175], v[4:7], v[192:195]
    s_cmp_lt_u32 s16, s17
    s_cbranch_scc0 L_ND11
    s_add_u32 m0, s13, 0
    v_mad_u32_u16 v236, v236, s15, v243
    buffer_load_dwordx4 v236, s[40:43], 0 offen lds
    s_add_u32 m0, s13, 1056
    v_mad_u32_u16 v237, v237, s15, v243
    buffer_load_dwordx4 v237, s[40:43], 0 offen lds
    s_add_u32 m0, s13, 2112
    v_mad_u32_u16 v238, v238, s15, v243
    buffer_load_dwordx4 v238, s[40:43], 0 offen lds
    s_add_u32 m0, s13, 3168
    v_mad_u32_u16 v239, v239, s15, v243
    buffer_load_dwordx4 v239, s[40:43], 0 offen lds
    s_mov_b32 m0, s14
    s_nop 0
    buffer_load_dwordx4 v[240:241], s[44:47], 0 idxen offen lds
L_ND11:
    v_rcp_f32 v230, v230
    v_mfma_f32_16x16x32_bf16 v[200:203], v[172:175], v[12:15], v[200:203]
    v_rcp_f32 v231, v231
    v_rcp_f32 v232, v232
    v_rcp_f32 v233, v233
    v_rcp_f32 v234, v234
    v_rcp_f32 v235, v235
    v_pk_mul_f32 v[204:205], v[220:221], v[204:205]
    v_pk_mul_f32 v[206:207], v[222:223], v[206:207]
    v_pk_mul_f32 v[208:209], v[224:225], v[208:209]
    v_pk_mul_f32 v[210:211], v[226:227], v[210:211]
    v_pk_mul_f32 v[212:213], v[228:229], v[212:213]
    v_pk_mul_f32 v[214:215], v[230:231], v[214:215]
    v_pk_mul_f32 v[216:217], v[232:233], v[216:217]
    v_pk_mul_f32 v[218:219], v[234:235], v[218:219]
    s_cmp_lt_u32 s16, s17
    s_cbranch_scc1 L_LOOP1
    s_branch L_LT0
.p2align 6
L_LOOP0:
    s_setprio 0
    v_smfmac_f32_16x16x64_bf16 v[152:155], v[184:187], v[204:211], v255
    ds_read_u16 v236, v251 offset:0
    ds_read_u16 v237, v251 offset:16
    ds_add_rtn_u32 v238, v246, v255
    v_exp_f32 v188, v188
    v_smfmac_f32_16x16x64_bf16 v[156:159], v[184:187], v[212:219], v255
    v_exp_f32 v189, v189
    v_mfma_f32_16x16x32_bf16 v[204:207], v[160:163], v[32:35], 0
    v_exp_f32 v190, v190
    v_mfma_f32_16x16x32_bf16 v[212:215], v[160:163], v[40:43], 0
    v_exp_f32 v191, v191
    v_mfma_f32_16x16x32_bf16 v[208:211], v[168:171], v[32:35], 0
    v_exp_f32 v192, v192
    v_mfma_f32_16x16x32_bf16 v[216:219], v[168:171], v[40:43], 0
    v_exp_f32 v193, v193
    v_mfma_f32_16x16x32_bf16 v[204:207], v[164:167], v[36:39], v[204:207]
    v_exp_f32 v194, v194
    v_mfma_f32_16x16x32_bf16 v[212:215], v[164:167], v[44:47], v[212:215]
    v_exp_f32 v195, v195
    v_mfma_f32_16x16x32_bf16 v[208:211], v[172:175], v[36:39], v[208:211]
    s_waitcnt lgkmcnt(0)
    v_bfi_b32 v236, 31, v246, v236
    v_bfi_b32 v237, 31, v246, v237
    v_readfirstlane_b32 s96, v238
    v_exp_f32 v196, v196
    v_mfma_f32_16x16x32_bf16 v[216:219], v[172:175], v[44:47], v[216:219]
    v_exp_f32 v197, v197
    v_smfmac_f32_16x16x64_bf16 v[136:139], v[184:187], v[220:227], v255
    v_exp_f32 v198, v198
    v_smfmac_f32_16x16x64_bf16 v[140:143], v[184:187], v[228:235], v255
    v_exp_f32 v199, v199
    v_mfma_f32_4x4x4_16b_bf16 v[188:191], v[242:243], v[242:243], v[188:191]
    v_exp_f32 v200, v200
    v_mfma_f32_4x4x4_16b_bf16 v[192:195], v[242:243], v[242:243], v[192:195]
    v_exp_f32 v201, v201
    v_mfma_f32_4x4x4_16b_bf16 v[196:199], v[242:243], v[242:243], v[196:199]
    v_exp_f32 v202, v202
    v_mfma_f32_16x16x32_bf16 v[220:223], v[176:179], v[72:75], 0
    ds_read_b64_tr_b16 v[184:185], v236
    ds_read_b64_tr_b16 v[186:187], v237
    ds_read_u16 v252, v250 offset:1152
    ds_read_u16 v253, v250 offset:1216
    v_exp_f32 v203, v203
    v_mfma_f32_16x16x32_bf16 v[228:231], v[176:179], v[76:79], 0
    s_ashr_i32 s96, s96, 24
    s_mul_i32 s96, s96, s101
    v_rcp_f32 v188, v188
    v_mfma_f32_16x16x32_bf16 v[224:227], v[180:183], v[72:75], 0
    v_rcp_f32 v189, v189
    v_mfma_f32_4x4x4_16b_bf16 v[200:203], v[242:243], v[242:243], v[200:203]
    v_rcp_f32 v190, v190
    v_mfma_f32_16x16x32_bf16 v[232:235], v[180:183], v[76:79], 0
    v_rcp_f32 v191, v191
    v_mfma_f32_16x16x32_bf16 v[220:223], v[160:163], v[16:19], v[220:223]
    v_rcp_f32 v192, v192
    v_mfma_f32_16x16x32_bf16 v[228:231], v[160:163], v[24:27], v[228:231]
    v_rcp_f32 v193, v193
    v_mfma_f32_16x16x32_bf16 v[224:227], v[168:171], v[16:19], v[224:227]
    s_waitcnt lgkmcnt(0)
    v_bfi_b32 v252, 31, v245, v252
    v_bfi_b32 v253, 31, v245, v253
    v_max_u32 v252, v252, v245
    v_max_u32 v253, v253, v247
    ds_read_b128 v[236:239], v248 offset:128
    ds_read_b32 v240, v249 offset:128
    s_add_u32 s16, s16, 1
    v_rcp_f32 v194, v194
    v_mfma_f32_16x16x32_bf16 v[232:235], v[168:171], v[24:27], v[232:235]
    v_rcp_f32 v195, v195
    v_mfma_f32_16x16x32_bf16 v[220:223], v[164:167], v[20:23], v[220:223]
    v_rcp_f32 v196, v196
    v_mfma_f32_16x16x32_bf16 v[228:231], v[164:167], v[28:31], v[228:231]
    v_rcp_f32 v197, v197
    s_setprio 3
    v_mfma_f32_16x16x32_bf16 v[224:227], v[172:175], v[20:23], v[224:227]
    v_rcp_f32 v198, v198
    v_mfma_f32_16x16x32_bf16 v[232:235], v[172:175], v[28:31], v[232:235]
    v_rcp_f32 v199, v199
    v_rcp_f32 v200, v200
    v_rcp_f32 v201, v201
    v_rcp_f32 v202, v202
    v_rcp_f32 v203, v203
    v_pk_mul_f32 v[204:205], v[188:189], v[204:205]
    v_pk_mul_f32 v[206:207], v[190:191], v[206:207]
    v_pk_mul_f32 v[208:209], v[192:193], v[208:209]
    v_pk_mul_f32 v[210:211], v[194:195], v[210:211]
    v_pk_mul_f32 v[212:213], v[196:197], v[212:213]
    v_pk_mul_f32 v[214:215], v[198:199], v[214:215]
    v_pk_mul_f32 v[216:217], v[200:201], v[216:217]
    v_pk_mul_f32 v[218:219], v[202:203], v[218:219]
    s_cmp_ge_i32 s96, 1
    s_cbranch_scc1 L_PB01
L_PB00:
    s_setprio 0
    v_smfmac_f32_16x16x64_bf16 v[112:115], v[184:187], v[204:211], v255
    v_exp_f32 v220, v220
    v_smfmac_f32_16x16x64_bf16 v[116:119], v[184:187], v[212:219], v255
    v_exp_f32 v221, v221
    s_waitcnt vmcnt(0)
    ds_read_b128 v[176:179], v252
    ds_read_b128 v[180:183], v253
    v_mfma_f32_16x16x32_bf16 v[204:207], v[160:163], v[48:51], 0
    v_exp_f32 v222, v222
    v_mfma_f32_16x16x32_bf16 v[212:215], v[160:163], v[56:59], 0
    ds_read_b128 v[160:163], v244 offset:0
    v_exp_f32 v223, v223
    v_mfma_f32_16x16x32_bf16 v[208:211], v[168:171], v[48:51], 0
    v_exp_f32 v224, v224
    v_mfma_f32_16x16x32_bf16 v[216:219], v[168:171], v[56:59], 0
    ds_read_b128 v[168:171], v244 offset:512
    v_exp_f32 v225, v225
    v_mfma_f32_16x16x32_bf16 v[204:207], v[164:167], v[52:55], v[204:207]
    v_exp_f32 v226, v226
    v_mfma_f32_16x16x32_bf16 v[212:215], v[164:167], v[60:63], v[212:215]
    ds_read_b128 v[164:167], v244 offset:64
    v_exp_f32 v227, v227
    v_mfma_f32_16x16x32_bf16 v[208:211], v[172:175], v[52:55], v[208:211]
    v_exp_f32 v228, v228
    v_mfma_f32_16x16x32_bf16 v[216:219], v[172:175], v[60:63], v[216:219]
    ds_read_b128 v[172:175], v244 offset:576
    v_exp_f32 v229, v229
    v_smfmac_f32_16x16x64_bf16 v[96:99], v[184:187], v[188:195], v255
    v_exp_f32 v230, v230
    v_smfmac_f32_16x16x64_bf16 v[100:103], v[184:187], v[196:203], v255
    v_exp_f32 v231, v231
    v_mfma_f32_4x4x4_16b_bf16 v[220:223], v[242:243], v[242:243], v[220:223]
    v_exp_f32 v232, v232
    v_mfma_f32_4x4x4_16b_bf16 v[224:227], v[242:243], v[242:243], v[224:227]
    v_exp_f32 v233, v233
    v_mfma_f32_4x4x4_16b_bf16 v[228:231], v[242:243], v[242:243], v[228:231]
    v_exp_f32 v234, v234
    s_waitcnt lgkmcnt(4)
    v_mfma_f32_16x16x32_bf16 v[188:191], v[176:179], v[80:83], 0
    v_exp_f32 v235, v235
    v_mfma_f32_16x16x32_bf16 v[196:199], v[176:179], v[84:87], 0
    v_rcp_f32 v220, v220
    v_mfma_f32_16x16x32_bf16 v[192:195], v[180:183], v[80:83], 0
    v_rcp_f32 v221, v221
    v_mfma_f32_4x4x4_16b_bf16 v[232:235], v[242:243], v[242:243], v[232:235]
    v_rcp_f32 v222, v222
    v_mfma_f32_16x16x32_bf16 v[200:203], v[180:183], v[84:87], 0
    v_rcp_f32 v223, v223
    s_waitcnt lgkmcnt(3)
    v_mfma_f32_16x16x32_bf16 v[188:191], v[160:163], v[0:3], v[188:191]
    v_rcp_f32 v224, v224
    v_mfma_f32_16x16x32_bf16 v[196:199], v[160:163], v[8:11], v[196:199]
    v_rcp_f32 v225, v225
    s_waitcnt lgkmcnt(2)
    v_mfma_f32_16x16x32_bf16 v[192:195], v[168:171], v[0:3], v[192:195]
    v_rcp_f32 v226, v226
    v_mfma_f32_16x16x32_bf16 v[200:203], v[168:171], v[8:11], v[200:203]
    v_rcp_f32 v227, v227
    s_waitcnt lgkmcnt(1)
    v_mfma_f32_16x16x32_bf16 v[188:191], v[164:167], v[4:7], v[188:191]
    v_rcp_f32 v228, v228
    v_mfma_f32_16x16x32_bf16 v[196:199], v[164:167], v[12:15], v[196:199]
    v_rcp_f32 v229, v229
    s_setprio 3
    s_waitcnt lgkmcnt(0)
    v_mfma_f32_16x16x32_bf16 v[192:195], v[172:175], v[4:7], v[192:195]
    s_cmp_lt_u32 s16, s17
    s_cbranch_scc0 L_ND00
    s_add_u32 m0, s13, 0
    v_mad_u32_u16 v236, v236, s15, v243
    buffer_load_dwordx4 v236, s[40:43], 0 offen lds
    s_add_u32 m0, s13, 1056
    v_mad_u32_u16 v237, v237, s15, v243
    buffer_load_dwordx4 v237, s[40:43], 0 offen lds
    s_add_u32 m0, s13, 2112
    v_mad_u32_u16 v238, v238, s15, v243
    buffer_load_dwordx4 v238, s[40:43], 0 offen lds
    s_add_u32 m0, s13, 3168
    v_mad_u32_u16 v239, v239, s15, v243
    buffer_load_dwordx4 v239, s[40:43], 0 offen lds
    s_mov_b32 m0, s14
    s_nop 0
    buffer_load_dwordx4 v[240:241], s[44:47], 0 idxen offen lds
L_ND00:
    v_rcp_f32 v230, v230
    v_mfma_f32_16x16x32_bf16 v[200:203], v[172:175], v[12:15], v[200:203]
    v_rcp_f32 v231, v231
    v_rcp_f32 v232, v232
    v_rcp_f32 v233, v233
    v_rcp_f32 v234, v234
    v_rcp_f32 v235, v235
    v_pk_mul_f32 v[204:205], v[220:221], v[204:205]
    v_pk_mul_f32 v[206:207], v[222:223], v[206:207]
    v_pk_mul_f32 v[208:209], v[224:225], v[208:209]
    v_pk_mul_f32 v[210:211], v[226:227], v[210:211]
    v_pk_mul_f32 v[212:213], v[228:229], v[212:213]
    v_pk_mul_f32 v[214:215], v[230:231], v[214:215]
    v_pk_mul_f32 v[216:217], v[232:233], v[216:217]
    v_pk_mul_f32 v[218:219], v[234:235], v[218:219]
    s_cmp_ge_u32 s16, s17
    s_cbranch_scc1 L_LT1
    s_setprio 0
    v_smfmac_f32_16x16x64_bf16 v[120:123], v[184:187], v[204:211], v255
    ds_read_u16 v236, v251 offset:1152
    ds_read_u16 v237, v251 offset:1168
    ds_add_rtn_u32 v238, v246, v255
    v_exp_f32 v188, v188
    v_smfmac_f32_16x16x64_bf16 v[124:127], v[184:187], v[212:219], v255
    v_exp_f32 v189, v189
    v_mfma_f32_16x16x32_bf16 v[204:207], v[160:163], v[32:35], 0
    v_exp_f32 v190, v190
    v_mfma_f32_16x16x32_bf16 v[212:215], v[160:163], v[40:43], 0
    v_exp_f32 v191, v191
    v_mfma_f32_16x16x32_bf16 v[208:211], v[168:171], v[32:35], 0
    v_exp_f32 v192, v192
    v_mfma_f32_16x16x32_bf16 v[216:219], v[168:171], v[40:43], 0
    v_exp_f32 v193, v193
    v_mfma_f32_16x16x32_bf16 v[204:207], v[164:167], v[36:39], v[204:207]
    v_exp_f32 v194, v194
    v_mfma_f32_16x16x32_bf16 v[212:215], v[164:167], v[44:47], v[212:215]
    v_exp_f32 v195, v195
    v_mfma_f32_16x16x32_bf16 v[208:211], v[172:175], v[36:39], v[208:211]
    s_waitcnt lgkmcnt(0)
    v_bfi_b32 v236, 31, v246, v236
    v_bfi_b32 v237, 31, v246, v237
    v_readfirstlane_b32 s96, v238
    v_exp_f32 v196, v196
    v_mfma_f32_16x16x32_bf16 v[216:219], v[172:175], v[44:47], v[216:219]
    v_exp_f32 v197, v197
    v_smfmac_f32_16x16x64_bf16 v[104:107], v[184:187], v[220:227], v255
    v_exp_f32 v198, v198
    v_smfmac_f32_16x16x64_bf16 v[108:111], v[184:187], v[228:235], v255
    v_exp_f32 v199, v199
    v_mfma_f32_4x4x4_16b_bf16 v[188:191], v[242:243], v[242:243], v[188:191]
    v_exp_f32 v200, v200
    v_mfma_f32_4x4x4_16b_bf16 v[192:195], v[242:243], v[242:243], v[192:195]
    v_exp_f32 v201, v201
    v_mfma_f32_4x4x4_16b_bf16 v[196:199], v[242:243], v[242:243], v[196:199]
    v_exp_f32 v202, v202
    v_mfma_f32_16x16x32_bf16 v[220:223], v[176:179], v[88:91], 0
    ds_read_b64_tr_b16 v[184:185], v236
    ds_read_b64_tr_b16 v[186:187], v237
    ds_read_u16 v252, v250 offset:128
    ds_read_u16 v253, v250 offset:192
    v_exp_f32 v203, v203
    v_mfma_f32_16x16x32_bf16 v[228:231], v[176:179], v[92:95], 0
    s_ashr_i32 s96, s96, 24
    s_mul_i32 s96, s96, s101
    v_rcp_f32 v188, v188
    v_mfma_f32_16x16x32_bf16 v[224:227], v[180:183], v[88:91], 0
    v_rcp_f32 v189, v189
    v_mfma_f32_4x4x4_16b_bf16 v[200:203], v[242:243], v[242:243], v[200:203]
    v_rcp_f32 v190, v190
    v_mfma_f32_16x16x32_bf16 v[232:235], v[180:183], v[92:95], 0
    v_rcp_f32 v191, v191
    v_mfma_f32_16x16x32_bf16 v[220:223], v[160:163], v[16:19], v[220:223]
    v_rcp_f32 v192, v192
    v_mfma_f32_16x16x32_bf16 v[228:231], v[160:163], v[24:27], v[228:231]
    v_rcp_f32 v193, v193
    v_mfma_f32_16x16x32_bf16 v[224:227], v[168:171], v[16:19], v[224:227]
    s_waitcnt lgkmcnt(0)
    v_bfi_b32 v252, 31, v245, v252
    v_bfi_b32 v253, 31, v245, v253
    v_max_u32 v252, v252, v245
    v_max_u32 v253, v253, v247
    ds_read_b128 v[236:239], v248 offset:1280
    ds_read_b32 v240, v249 offset:1280
    s_add_u32 s16, s16, 1
    v_rcp_f32 v194, v194
    v_mfma_f32_16x16x32_bf16 v[232:235], v[168:171], v[24:27], v[232:235]
    v_lshl_add_u64 v[248:249], v[248:249], 0, s[94:95]
    v_lshl_add_u64 v[250:251], v[250:251], 0, s[94:95]
    v_rcp_f32 v195, v195
    v_mfma_f32_16x16x32_bf16 v[220:223], v[164:167], v[20:23], v[220:223]
    v_rcp_f32 v196, v196
    v_mfma_f32_16x16x32_bf16 v[228:231], v[164:167], v[28:31], v[228:231]
    v_rcp_f32 v197, v197
    s_setprio 3
    v_mfma_f32_16x16x32_bf16 v[224:227], v[172:175], v[20:23], v[224:227]
    v_rcp_f32 v198, v198
    v_mfma_f32_16x16x32_bf16 v[232:235], v[172:175], v[28:31], v[232:235]
    v_rcp_f32 v199, v199
    v_rcp_f32 v200, v200
    v_rcp_f32 v201, v201
    v_rcp_f32 v202, v202
    v_rcp_f32 v203, v203
    v_pk_mul_f32 v[204:205], v[188:189], v[204:205]
    v_pk_mul_f32 v[206:207], v[190:191], v[206:207]
    v_pk_mul_f32 v[208:209], v[192:193], v[208:209]
    v_pk_mul_f32 v[210:211], v[194:195], v[210:211]
    v_pk_mul_f32 v[212:213], v[196:197], v[212:213]
    v_pk_mul_f32 v[214:215], v[198:199], v[214:215]
    v_pk_mul_f32 v[216:217], v[200:201], v[216:217]
    v_pk_mul_f32 v[218:219], v[202:203], v[218:219]
    s_cmp_ge_i32 s96, 1
    s_cbranch_scc1 L_PB11
L_PB10:
    s_setprio 0
    v_smfmac_f32_16x16x64_bf16 v[144:147], v[184:187], v[204:211], v255
    v_exp_f32 v220, v220
    v_smfmac_f32_16x16x64_bf16 v[148:151], v[184:187], v[212:219], v255
    v_exp_f32 v221, v221
    s_waitcnt vmcnt(0)
    ds_read_b128 v[176:179], v252
    ds_read_b128 v[180:183], v253
    v_mfma_f32_16x16x32_bf16 v[204:207], v[160:163], v[48:51], 0
    v_exp_f32 v222, v222
    v_mfma_f32_16x16x32_bf16 v[212:215], v[160:163], v[56:59], 0
    ds_read_b128 v[160:163], v244 offset:0
    v_exp_f32 v223, v223
    v_mfma_f32_16x16x32_bf16 v[208:211], v[168:171], v[48:51], 0
    v_exp_f32 v224, v224
    v_mfma_f32_16x16x32_bf16 v[216:219], v[168:171], v[56:59], 0
    ds_read_b128 v[168:171], v244 offset:512
    v_exp_f32 v225, v225
    v_mfma_f32_16x16x32_bf16 v[204:207], v[164:167], v[52:55], v[204:207]
    v_exp_f32 v226, v226
    v_mfma_f32_16x16x32_bf16 v[212:215], v[164:167], v[60:63], v[212:215]
    ds_read_b128 v[164:167], v244 offset:64
    v_exp_f32 v227, v227
    v_mfma_f32_16x16x32_bf16 v[208:211], v[172:175], v[52:55], v[208:211]
    v_exp_f32 v228, v228
    v_mfma_f32_16x16x32_bf16 v[216:219], v[172:175], v[60:63], v[216:219]
    ds_read_b128 v[172:175], v244 offset:576
    v_exp_f32 v229, v229
    v_smfmac_f32_16x16x64_bf16 v[128:131], v[184:187], v[188:195], v255
    v_exp_f32 v230, v230
    v_smfmac_f32_16x16x64_bf16 v[132:135], v[184:187], v[196:203], v255
    v_exp_f32 v231, v231
    v_mfma_f32_4x4x4_16b_bf16 v[220:223], v[242:243], v[242:243], v[220:223]
    v_exp_f32 v232, v232
    v_mfma_f32_4x4x4_16b_bf16 v[224:227], v[242:243], v[242:243], v[224:227]
    v_exp_f32 v233, v233
    v_mfma_f32_4x4x4_16b_bf16 v[228:231], v[242:243], v[242:243], v[228:231]
    v_exp_f32 v234, v234
    s_waitcnt lgkmcnt(4)
    v_mfma_f32_16x16x32_bf16 v[188:191], v[176:179], v[64:67], 0
    v_exp_f32 v235, v235
    v_mfma_f32_16x16x32_bf16 v[196:199], v[176:179], v[68:71], 0
    v_rcp_f32 v220, v220
    v_mfma_f32_16x16x32_bf16 v[192:195], v[180:183], v[64:67], 0
    v_rcp_f32 v221, v221
    v_mfma_f32_4x4x4_16b_bf16 v[232:235], v[242:243], v[242:243], v[232:235]
    v_rcp_f32 v222, v222
    v_mfma_f32_16x16x32_bf16 v[200:203], v[180:183], v[68:71], 0
    v_rcp_f32 v223, v223
    s_waitcnt lgkmcnt(3)
    v_mfma_f32_16x16x32_bf16 v[188:191], v[160:163], v[0:3], v[188:191]
    v_rcp_f32 v224, v224
    v_mfma_f32_16x16x32_bf16 v[196:199], v[160:163], v[8:11], v[196:199]
    v_rcp_f32 v225, v225
    s_waitcnt lgkmcnt(2)
    v_mfma_f32_16x16x32_bf16 v[192:195], v[168:171], v[0:3], v[192:195]
    v_rcp_f32 v226, v226
    v_mfma_f32_16x16x32_bf16 v[200:203], v[168:171], v[8:11], v[200:203]
    v_rcp_f32 v227, v227
    s_waitcnt lgkmcnt(1)
    v_mfma_f32_16x16x32_bf16 v[188:191], v[164:167], v[4:7], v[188:191]
    v_rcp_f32 v228, v228
    v_mfma_f32_16x16x32_bf16 v[196:199], v[164:167], v[12:15], v[196:199]
    v_rcp_f32 v229, v229
    s_setprio 3
    s_waitcnt lgkmcnt(0)
    v_mfma_f32_16x16x32_bf16 v[192:195], v[172:175], v[4:7], v[192:195]
    s_cmp_lt_u32 s16, s17
    s_cbranch_scc0 L_ND10
    s_add_u32 m0, s13, 0
    v_mad_u32_u16 v236, v236, s15, v243
    buffer_load_dwordx4 v236, s[40:43], 0 offen lds
    s_add_u32 m0, s13, 1056
    v_mad_u32_u16 v237, v237, s15, v243
    buffer_load_dwordx4 v237, s[40:43], 0 offen lds
    s_add_u32 m0, s13, 2112
    v_mad_u32_u16 v238, v238, s15, v243
    buffer_load_dwordx4 v238, s[40:43], 0 offen lds
    s_add_u32 m0, s13, 3168
    v_mad_u32_u16 v239, v239, s15, v243
    buffer_load_dwordx4 v239, s[40:43], 0 offen lds
    s_mov_b32 m0, s14
    s_nop 0
    buffer_load_dwordx4 v[240:241], s[44:47], 0 idxen offen lds
L_ND10:
    v_rcp_f32 v230, v230
    v_mfma_f32_16x16x32_bf16 v[200:203], v[172:175], v[12:15], v[200:203]
    v_rcp_f32 v231, v231
    v_rcp_f32 v232, v232
    v_rcp_f32 v233, v233
    v_rcp_f32 v234, v234
    v_rcp_f32 v235, v235
    v_pk_mul_f32 v[204:205], v[220:221], v[204:205]
    v_pk_mul_f32 v[206:207], v[222:223], v[206:207]
    v_pk_mul_f32 v[208:209], v[224:225], v[208:209]
    v_pk_mul_f32 v[210:211], v[226:227], v[210:211]
    v_pk_mul_f32 v[212:213], v[228:229], v[212:213]
    v_pk_mul_f32 v[214:215], v[230:231], v[214:215]
    v_pk_mul_f32 v[216:217], v[232:233], v[216:217]
    v_pk_mul_f32 v[218:219], v[234:235], v[218:219]
    s_cmp_lt_u32 s16, s17
    s_cbranch_scc1 L_LOOP0
    s_branch L_LT0
L_LT0:
    s_cmp_lg_u32 s99, 0
    s_cbranch_scc1 L_LH0
    s_setprio 0
    v_smfmac_f32_16x16x64_bf16 v[152:155], v[184:187], v[204:211], v255
    ds_read_u16 v236, v251 offset:0
    ds_read_u16 v237, v251 offset:16
    v_exp_f32 v188, v188
    v_smfmac_f32_16x16x64_bf16 v[156:159], v[184:187], v[212:219], v255
    v_exp_f32 v189, v189
    v_mfma_f32_16x16x32_bf16 v[204:207], v[160:163], v[32:35], 0
    v_exp_f32 v190, v190
    v_mfma_f32_16x16x32_bf16 v[212:215], v[160:163], v[40:43], 0
    v_exp_f32 v191, v191
    v_mfma_f32_16x16x32_bf16 v[208:211], v[168:171], v[32:35], 0
    v_exp_f32 v192, v192
    v_mfma_f32_16x16x32_bf16 v[216:219], v[168:171], v[40:43], 0
    v_exp_f32 v193, v193
    v_mfma_f32_16x16x32_bf16 v[204:207], v[164:167], v[36:39], v[204:207]
    v_exp_f32 v194, v194
    v_mfma_f32_16x16x32_bf16 v[212:215], v[164:167], v[44:47], v[212:215]
    v_exp_f32 v195, v195
    v_mfma_f32_16x16x32_bf16 v[208:211], v[172:175], v[36:39], v[208:211]
    v_exp_f32 v196, v196
    v_mfma_f32_16x16x32_bf16 v[216:219], v[172:175], v[44:47], v[216:219]
    v_exp_f32 v197, v197
    v_smfmac_f32_16x16x64_bf16 v[136:139], v[184:187], v[220:227], v255
    s_waitcnt lgkmcnt(0)
    v_bfi_b32 v236, 31, v246, v236
    v_bfi_b32 v237, 31, v246, v237
    v_exp_f32 v198, v198
    s_setprio 3
    v_smfmac_f32_16x16x64_bf16 v[140:143], v[184:187], v[228:235], v255
    v_exp_f32 v199, v199
    v_exp_f32 v200, v200
    v_exp_f32 v201, v201
    v_exp_f32 v202, v202
    v_exp_f32 v203, v203
    v_pk_add_f32 v[188:189], v[188:189], 1.0 op_sel_hi:[1,0]
    v_pk_add_f32 v[190:191], v[190:191], 1.0 op_sel_hi:[1,0]
    v_pk_add_f32 v[192:193], v[192:193], 1.0 op_sel_hi:[1,0]
    v_pk_add_f32 v[194:195], v[194:195], 1.0 op_sel_hi:[1,0]
    v_pk_add_f32 v[196:197], v[196:197], 1.0 op_sel_hi:[1,0]
    v_pk_add_f32 v[198:199], v[198:199], 1.0 op_sel_hi:[1,0]
    v_pk_add_f32 v[200:201], v[200:201], 1.0 op_sel_hi:[1,0]
    v_pk_add_f32 v[202:203], v[202:203], 1.0 op_sel_hi:[1,0]
    s_setprio 0
    v_mfma_f32_16x16x32_bf16 v[220:223], v[176:179], v[72:75], 0
    ds_read_b64_tr_b16 v[184:185], v236
    ds_read_b64_tr_b16 v[186:187], v237
    v_rcp_f32 v188, v188
    v_mfma_f32_16x16x32_bf16 v[228:231], v[176:179], v[76:79], 0
    v_rcp_f32 v189, v189
    v_mfma_f32_16x16x32_bf16 v[224:227], v[180:183], v[72:75], 0
    v_rcp_f32 v190, v190
    v_mfma_f32_16x16x32_bf16 v[232:235], v[180:183], v[76:79], 0
    v_rcp_f32 v191, v191
    v_mfma_f32_16x16x32_bf16 v[220:223], v[160:163], v[16:19], v[220:223]
    v_rcp_f32 v192, v192
    v_mfma_f32_16x16x32_bf16 v[228:231], v[160:163], v[24:27], v[228:231]
    v_rcp_f32 v193, v193
    v_mfma_f32_16x16x32_bf16 v[224:227], v[168:171], v[16:19], v[224:227]
    v_rcp_f32 v194, v194
    v_mfma_f32_16x16x32_bf16 v[232:235], v[168:171], v[24:27], v[232:235]
    v_rcp_f32 v195, v195
    v_mfma_f32_16x16x32_bf16 v[220:223], v[164:167], v[20:23], v[220:223]
    v_rcp_f32 v196, v196
    v_mfma_f32_16x16x32_bf16 v[228:231], v[164:167], v[28:31], v[228:231]
    v_rcp_f32 v197, v197
    v_mfma_f32_16x16x32_bf16 v[224:227], v[172:175], v[20:23], v[224:227]
    v_rcp_f32 v198, v198
    s_setprio 3
    v_mfma_f32_16x16x32_bf16 v[232:235], v[172:175], v[28:31], v[232:235]
    v_rcp_f32 v199, v199
    v_rcp_f32 v200, v200
    v_rcp_f32 v201, v201
    v_rcp_f32 v202, v202
    v_rcp_f32 v203, v203
    v_pk_mul_f32 v[204:205], v[188:189], v[204:205]
    v_pk_mul_f32 v[206:207], v[190:191], v[206:207]
    v_pk_mul_f32 v[208:209], v[192:193], v[208:209]
    v_pk_mul_f32 v[210:211], v[194:195], v[210:211]
    v_pk_mul_f32 v[212:213], v[196:197], v[212:213]
    v_pk_mul_f32 v[214:215], v[198:199], v[214:215]
    v_pk_mul_f32 v[216:217], v[200:201], v[216:217]
    v_pk_mul_f32 v[218:219], v[202:203], v[218:219]
    s_setprio 0
    s_waitcnt lgkmcnt(0)
    v_smfmac_f32_16x16x64_bf16 v[112:115], v[184:187], v[204:211], v255
    v_exp_f32 v220, v220
    v_smfmac_f32_16x16x64_bf16 v[116:119], v[184:187], v[212:219], v255
    v_exp_f32 v221, v221
    v_mfma_f32_16x16x32_bf16 v[204:207], v[160:163], v[48:51], 0
    v_exp_f32 v222, v222
    v_mfma_f32_16x16x32_bf16 v[212:215], v[160:163], v[56:59], 0
    v_exp_f32 v223, v223
    v_mfma_f32_16x16x32_bf16 v[208:211], v[168:171], v[48:51], 0
    v_exp_f32 v224, v224
    v_mfma_f32_16x16x32_bf16 v[216:219], v[168:171], v[56:59], 0
    v_exp_f32 v225, v225
    v_mfma_f32_16x16x32_bf16 v[204:207], v[164:167], v[52:55], v[204:207]
    v_exp_f32 v226, v226
    v_mfma_f32_16x16x32_bf16 v[212:215], v[164:167], v[60:63], v[212:215]
    v_exp_f32 v227, v227
    v_mfma_f32_16x16x32_bf16 v[208:211], v[172:175], v[52:55], v[208:211]
    v_exp_f32 v228, v228
    v_mfma_f32_16x16x32_bf16 v[216:219], v[172:175], v[60:63], v[216:219]
    v_exp_f32 v229, v229
    v_smfmac_f32_16x16x64_bf16 v[96:99], v[184:187], v[188:195], v255
    v_exp_f32 v230, v230
    s_setprio 3
    v_smfmac_f32_16x16x64_bf16 v[100:103], v[184:187], v[196:203], v255
    v_exp_f32 v231, v231
    v_exp_f32 v232, v232
    v_exp_f32 v233, v233
    v_exp_f32 v234, v234
    v_exp_f32 v235, v235
    v_pk_add_f32 v[220:221], v[220:221], 1.0 op_sel_hi:[1,0]
    v_pk_add_f32 v[222:223], v[222:223], 1.0 op_sel_hi:[1,0]
    v_pk_add_f32 v[224:225], v[224:225], 1.0 op_sel_hi:[1,0]
    v_pk_add_f32 v[226:227], v[226:227], 1.0 op_sel_hi:[1,0]
    v_pk_add_f32 v[228:229], v[228:229], 1.0 op_sel_hi:[1,0]
    v_pk_add_f32 v[230:231], v[230:231], 1.0 op_sel_hi:[1,0]
    v_pk_add_f32 v[232:233], v[232:233], 1.0 op_sel_hi:[1,0]
    v_pk_add_f32 v[234:235], v[234:235], 1.0 op_sel_hi:[1,0]
    s_setprio 0
    v_rcp_f32 v220, v220
    v_rcp_f32 v221, v221
    v_rcp_f32 v222, v222
    v_rcp_f32 v223, v223
    v_rcp_f32 v224, v224
    v_rcp_f32 v225, v225
    v_rcp_f32 v226, v226
    v_rcp_f32 v227, v227
    v_rcp_f32 v228, v228
    v_rcp_f32 v229, v229
    v_rcp_f32 v230, v230
    v_rcp_f32 v231, v231
    v_rcp_f32 v232, v232
    v_rcp_f32 v233, v233
    v_rcp_f32 v234, v234
    v_rcp_f32 v235, v235
    v_pk_mul_f32 v[204:205], v[220:221], v[204:205]
    v_pk_mul_f32 v[206:207], v[222:223], v[206:207]
    v_pk_mul_f32 v[208:209], v[224:225], v[208:209]
    v_pk_mul_f32 v[210:211], v[226:227], v[210:211]
    v_pk_mul_f32 v[212:213], v[228:229], v[212:213]
    v_pk_mul_f32 v[214:215], v[230:231], v[214:215]
    v_pk_mul_f32 v[216:217], v[232:233], v[216:217]
    v_pk_mul_f32 v[218:219], v[234:235], v[218:219]
    v_smfmac_f32_16x16x64_bf16 v[104:107], v[184:187], v[220:227], v255
    v_smfmac_f32_16x16x64_bf16 v[108:111], v[184:187], v[228:235], v255
    v_smfmac_f32_16x16x64_bf16 v[120:123], v[184:187], v[204:211], v255
    v_smfmac_f32_16x16x64_bf16 v[124:127], v[184:187], v[212:219], v255
    s_branch L_DONE
L_LH0:
    s_setprio 0
    v_smfmac_f32_16x16x64_bf16 v[152:155], v[184:187], v[204:211], v255
    ds_read_u16 v236, v251 offset:0
    ds_read_u16 v237, v251 offset:16
    v_smfmac_f32_16x16x64_bf16 v[156:159], v[184:187], v[212:219], v255
    v_exp_f32 v188, v188
    v_mfma_f32_16x16x32_bf16 v[204:207], v[160:163], v[32:35], 0
    v_mfma_f32_16x16x32_bf16 v[212:215], v[160:163], v[40:43], 0
    v_exp_f32 v189, v189
    v_mfma_f32_16x16x32_bf16 v[204:207], v[164:167], v[36:39], v[204:207]
    v_mfma_f32_16x16x32_bf16 v[212:215], v[164:167], v[44:47], v[212:215]
    v_exp_f32 v190, v190
    v_smfmac_f32_16x16x64_bf16 v[136:139], v[184:187], v[220:227], v255
    s_waitcnt lgkmcnt(0)
    v_bfi_b32 v236, 31, v246, v236
    v_bfi_b32 v237, 31, v246, v237
    v_exp_f32 v191, v191
    s_setprio 3
    v_smfmac_f32_16x16x64_bf16 v[140:143], v[184:187], v[228:235], v255
    v_exp_f32 v196, v196
    v_exp_f32 v197, v197
    v_exp_f32 v198, v198
    v_exp_f32 v199, v199
    v_pk_add_f32 v[188:189], v[188:189], 1.0 op_sel_hi:[1,0]
    v_pk_add_f32 v[190:191], v[190:191], 1.0 op_sel_hi:[1,0]
    v_pk_add_f32 v[196:197], v[196:197], 1.0 op_sel_hi:[1,0]
    v_pk_add_f32 v[198:199], v[198:199], 1.0 op_sel_hi:[1,0]
    s_setprio 0
    v_mfma_f32_16x16x32_bf16 v[220:223], v[176:179], v[72:75], 0
    ds_read_b64_tr_b16 v[184:185], v236
    ds_read_b64_tr_b16 v[186:187], v237
    v_mfma_f32_16x16x32_bf16 v[228:231], v[176:179], v[76:79], 0
    v_rcp_f32 v188, v188
    v_mfma_f32_16x16x32_bf16 v[220:223], v[160:163], v[16:19], v[220:223]
    v_rcp_f32 v189, v189
    v_mfma_f32_16x16x32_bf16 v[228:231], v[160:163], v[24:27], v[228:231]
    v_rcp_f32 v190, v190
    v_mfma_f32_16x16x32_bf16 v[220:223], v[164:167], v[20:23], v[220:223]
    v_rcp_f32 v191, v191
    s_setprio 3
    v_mfma_f32_16x16x32_bf16 v[228:231], v[164:167], v[28:31], v[228:231]
    v_rcp_f32 v196, v196
    v_rcp_f32 v197, v197
    v_rcp_f32 v198, v198
    v_rcp_f32 v199, v199
    v_pk_mul_f32 v[204:205], v[188:189], v[204:205]
    v_pk_mul_f32 v[206:207], v[190:191], v[206:207]
    v_pk_mul_f32 v[212:213], v[196:197], v[212:213]
    v_pk_mul_f32 v[214:215], v[198:199], v[214:215]
    s_setprio 0
    s_waitcnt lgkmcnt(0)
    v_smfmac_f32_16x16x64_bf16 v[112:115], v[184:187], v[204:211], v255
    v_smfmac_f32_16x16x64_bf16 v[116:119], v[184:187], v[212:219], v255
    v_exp_f32 v220, v220
    v_mfma_f32_16x16x32_bf16 v[204:207], v[160:163], v[48:51], 0
    v_mfma_f32_16x16x32_bf16 v[212:215], v[160:163], v[56:59], 0
    v_exp_f32 v221, v221
    v_mfma_f32_16x16x32_bf16 v[204:207], v[164:167], v[52:55], v[204:207]
    v_mfma_f32_16x16x32_bf16 v[212:215], v[164:167], v[60:63], v[212:215]
    v_exp_f32 v222, v222
    v_smfmac_f32_16x16x64_bf16 v[96:99], v[184:187], v[188:195], v255
    v_exp_f32 v223, v223
    s_setprio 3
    v_smfmac_f32_16x16x64_bf16 v[100:103], v[184:187], v[196:203], v255
    v_exp_f32 v228, v228
    v_exp_f32 v229, v229
    v_exp_f32 v230, v230
    v_exp_f32 v231, v231
    v_pk_add_f32 v[220:221], v[220:221], 1.0 op_sel_hi:[1,0]
    v_pk_add_f32 v[222:223], v[222:223], 1.0 op_sel_hi:[1,0]
    v_pk_add_f32 v[228:229], v[228:229], 1.0 op_sel_hi:[1,0]
    v_pk_add_f32 v[230:231], v[230:231], 1.0 op_sel_hi:[1,0]
    s_setprio 0
    v_rcp_f32 v220, v220
    v_rcp_f32 v221, v221
    v_rcp_f32 v222, v222
    v_rcp_f32 v223, v223
    v_rcp_f32 v228, v228
    v_rcp_f32 v229, v229
    v_rcp_f32 v230, v230
    v_rcp_f32 v231, v231
    v_pk_mul_f32 v[204:205], v[220:221], v[204:205]
    v_pk_mul_f32 v[206:207], v[222:223], v[206:207]
    v_pk_mul_f32 v[212:213], v[228:229], v[212:213]
    v_pk_mul_f32 v[214:215], v[230:231], v[214:215]
    v_smfmac_f32_16x16x64_bf16 v[104:107], v[184:187], v[220:227], v255
    v_smfmac_f32_16x16x64_bf16 v[108:111], v[184:187], v[228:235], v255
    v_smfmac_f32_16x16x64_bf16 v[120:123], v[184:187], v[204:211], v255
    v_smfmac_f32_16x16x64_bf16 v[124:127], v[184:187], v[212:219], v255
    s_branch L_DONE
L_LT1:
    s_cmp_lg_u32 s99, 0
    s_cbranch_scc1 L_LH1
    s_setprio 0
    v_smfmac_f32_16x16x64_bf16 v[120:123], v[184:187], v[204:211], v255
    ds_read_u16 v236, v251 offset:1152
    ds_read_u16 v237, v251 offset:1168
    v_exp_f32 v188, v188
    v_smfmac_f32_16x16x64_bf16 v[124:127], v[184:187], v[212:219], v255
    v_exp_f32 v189, v189
    v_mfma_f32_16x16x32_bf16 v[204:207], v[160:163], v[32:35], 0
    v_exp_f32 v190, v190
    v_mfma_f32_16x16x32_bf16 v[212:215], v[160:163], v[40:43], 0
    v_exp_f32 v191, v191
    v_mfma_f32_16x16x32_bf16 v[208:211], v[168:171], v[32:35], 0
    v_exp_f32 v192, v192
    v_mfma_f32_16x16x32_bf16 v[216:219], v[168:171], v[40:43], 0
    v_exp_f32 v193, v193
    v_mfma_f32_16x16x32_bf16 v[204:207], v[164:167], v[36:39], v[204:207]
    v_exp_f32 v194, v194
    v_mfma_f32_16x16x32_bf16 v[212:215], v[164:167], v[44:47], v[212:215]
    v_exp_f32 v195, v195
    v_mfma_f32_16x16x32_bf16 v[208:211], v[172:175], v[36:39], v[208:211]
    v_exp_f32 v196, v196
    v_mfma_f32_16x16x32_bf16 v[216:219], v[172:175], v[44:47], v[216:219]
    v_exp_f32 v197, v197
    v_smfmac_f32_16x16x64_bf16 v[104:107], v[184:187], v[220:227], v255
    s_waitcnt lgkmcnt(0)
    v_bfi_b32 v236, 31, v246, v236
    v_bfi_b32 v237, 31, v246, v237
    v_exp_f32 v198, v198
    s_setprio 3
    v_smfmac_f32_16x16x64_bf16 v[108:111], v[184:187], v[228:235], v255
    v_exp_f32 v199, v199
    v_exp_f32 v200, v200
    v_exp_f32 v201, v201
    v_exp_f32 v202, v202
    v_exp_f32 v203, v203
    v_pk_add_f32 v[188:189], v[188:189], 1.0 op_sel_hi:[1,0]
    v_pk_add_f32 v[190:191], v[190:191], 1.0 op_sel_hi:[1,0]
    v_pk_add_f32 v[192:193], v[192:193], 1.0 op_sel_hi:[1,0]
    v_pk_add_f32 v[194:195], v[194:195], 1.0 op_sel_hi:[1,0]
    v_pk_add_f32 v[196:197], v[196:197], 1.0 op_sel_hi:[1,0]
    v_pk_add_f32 v[198:199], v[198:199], 1.0 op_sel_hi:[1,0]
    v_pk_add_f32 v[200:201], v[200:201], 1.0 op_sel_hi:[1,0]
    v_pk_add_f32 v[202:203], v[202:203], 1.0 op_sel_hi:[1,0]
    s_setprio 0
    v_mfma_f32_16x16x32_bf16 v[220:223], v[176:179], v[88:91], 0
    ds_read_b64_tr_b16 v[184:185], v236
    ds_read_b64_tr_b16 v[186:187], v237
    v_rcp_f32 v188, v188
    v_mfma_f32_16x16x32_bf16 v[228:231], v[176:179], v[92:95], 0
    v_rcp_f32 v189, v189
    v_mfma_f32_16x16x32_bf16 v[224:227], v[180:183], v[88:91], 0
    v_rcp_f32 v190, v190
    v_mfma_f32_16x16x32_bf16 v[232:235], v[180:183], v[92:95], 0
    v_rcp_f32 v191, v191
    v_mfma_f32_16x16x32_bf16 v[220:223], v[160:163], v[16:19], v[220:223]
    v_rcp_f32 v192, v192
    v_mfma_f32_16x16x32_bf16 v[228:231], v[160:163], v[24:27], v[228:231]
    v_rcp_f32 v193, v193
    v_mfma_f32_16x16x32_bf16 v[224:227], v[168:171], v[16:19], v[224:227]
    v_rcp_f32 v194, v194
    v_mfma_f32_16x16x32_bf16 v[232:235], v[168:171], v[24:27], v[232:235]
    v_rcp_f32 v195, v195
    v_mfma_f32_16x16x32_bf16 v[220:223], v[164:167], v[20:23], v[220:223]
    v_rcp_f32 v196, v196
    v_mfma_f32_16x16x32_bf16 v[228:231], v[164:167], v[28:31], v[228:231]
    v_rcp_f32 v197, v197
    v_mfma_f32_16x16x32_bf16 v[224:227], v[172:175], v[20:23], v[224:227]
    v_rcp_f32 v198, v198
    s_setprio 3
    v_mfma_f32_16x16x32_bf16 v[232:235], v[172:175], v[28:31], v[232:235]
    v_rcp_f32 v199, v199
    v_rcp_f32 v200, v200
    v_rcp_f32 v201, v201
    v_rcp_f32 v202, v202
    v_rcp_f32 v203, v203
    v_pk_mul_f32 v[204:205], v[188:189], v[204:205]
    v_pk_mul_f32 v[206:207], v[190:191], v[206:207]
    v_pk_mul_f32 v[208:209], v[192:193], v[208:209]
    v_pk_mul_f32 v[210:211], v[194:195], v[210:211]
    v_pk_mul_f32 v[212:213], v[196:197], v[212:213]
    v_pk_mul_f32 v[214:215], v[198:199], v[214:215]
    v_pk_mul_f32 v[216:217], v[200:201], v[216:217]
    v_pk_mul_f32 v[218:219], v[202:203], v[218:219]
    s_setprio 0
    s_waitcnt lgkmcnt(0)
    v_smfmac_f32_16x16x64_bf16 v[144:147], v[184:187], v[204:211], v255
    v_exp_f32 v220, v220
    v_smfmac_f32_16x16x64_bf16 v[148:151], v[184:187], v[212:219], v255
    v_exp_f32 v221, v221
    v_mfma_f32_16x16x32_bf16 v[204:207], v[160:163], v[48:51], 0
    v_exp_f32 v222, v222
    v_mfma_f32_16x16x32_bf16 v[212:215], v[160:163], v[56:59], 0
    v_exp_f32 v223, v223
    v_mfma_f32_16x16x32_bf16 v[208:211], v[168:171], v[48:51], 0
    v_exp_f32 v224, v224
    v_mfma_f32_16x16x32_bf16 v[216:219], v[168:171], v[56:59], 0
    v_exp_f32 v225, v225
    v_mfma_f32_16x16x32_bf16 v[204:207], v[164:167], v[52:55], v[204:207]
    v_exp_f32 v226, v226
    v_mfma_f32_16x16x32_bf16 v[212:215], v[164:167], v[60:63], v[212:215]
    v_exp_f32 v227, v227
    v_mfma_f32_16x16x32_bf16 v[208:211], v[172:175], v[52:55], v[208:211]
    v_exp_f32 v228, v228
    v_mfma_f32_16x16x32_bf16 v[216:219], v[172:175], v[60:63], v[216:219]
    v_exp_f32 v229, v229
    v_smfmac_f32_16x16x64_bf16 v[128:131], v[184:187], v[188:195], v255
    v_exp_f32 v230, v230
    s_setprio 3
    v_smfmac_f32_16x16x64_bf16 v[132:135], v[184:187], v[196:203], v255
    v_exp_f32 v231, v231
    v_exp_f32 v232, v232
    v_exp_f32 v233, v233
    v_exp_f32 v234, v234
    v_exp_f32 v235, v235
    v_pk_add_f32 v[220:221], v[220:221], 1.0 op_sel_hi:[1,0]
    v_pk_add_f32 v[222:223], v[222:223], 1.0 op_sel_hi:[1,0]
    v_pk_add_f32 v[224:225], v[224:225], 1.0 op_sel_hi:[1,0]
    v_pk_add_f32 v[226:227], v[226:227], 1.0 op_sel_hi:[1,0]
    v_pk_add_f32 v[228:229], v[228:229], 1.0 op_sel_hi:[1,0]
    v_pk_add_f32 v[230:231], v[230:231], 1.0 op_sel_hi:[1,0]
    v_pk_add_f32 v[232:233], v[232:233], 1.0 op_sel_hi:[1,0]
    v_pk_add_f32 v[234:235], v[234:235], 1.0 op_sel_hi:[1,0]
    s_setprio 0
    v_rcp_f32 v220, v220
    v_rcp_f32 v221, v221
    v_rcp_f32 v222, v222
    v_rcp_f32 v223, v223
    v_rcp_f32 v224, v224
    v_rcp_f32 v225, v225
    v_rcp_f32 v226, v226
    v_rcp_f32 v227, v227
    v_rcp_f32 v228, v228
    v_rcp_f32 v229, v229
    v_rcp_f32 v230, v230
    v_rcp_f32 v231, v231
    v_rcp_f32 v232, v232
    v_rcp_f32 v233, v233
    v_rcp_f32 v234, v234
    v_rcp_f32 v235, v235
    v_pk_mul_f32 v[204:205], v[220:221], v[204:205]
    v_pk_mul_f32 v[206:207], v[222:223], v[206:207]
    v_pk_mul_f32 v[208:209], v[224:225], v[208:209]
    v_pk_mul_f32 v[210:211], v[226:227], v[210:211]
    v_pk_mul_f32 v[212:213], v[228:229], v[212:213]
    v_pk_mul_f32 v[214:215], v[230:231], v[214:215]
    v_pk_mul_f32 v[216:217], v[232:233], v[216:217]
    v_pk_mul_f32 v[218:219], v[234:235], v[218:219]
    v_smfmac_f32_16x16x64_bf16 v[136:139], v[184:187], v[220:227], v255
    v_smfmac_f32_16x16x64_bf16 v[140:143], v[184:187], v[228:235], v255
    v_smfmac_f32_16x16x64_bf16 v[152:155], v[184:187], v[204:211], v255
    v_smfmac_f32_16x16x64_bf16 v[156:159], v[184:187], v[212:219], v255
    s_branch L_DONE
L_LH1:
    s_setprio 0
    v_smfmac_f32_16x16x64_bf16 v[120:123], v[184:187], v[204:211], v255
    ds_read_u16 v236, v251 offset:1152
    ds_read_u16 v237, v251 offset:1168
    v_smfmac_f32_16x16x64_bf16 v[124:127], v[184:187], v[212:219], v255
    v_exp_f32 v188, v188
    v_mfma_f32_16x16x32_bf16 v[204:207], v[160:163], v[32:35], 0
    v_mfma_f32_16x16x32_bf16 v[212:215], v[160:163], v[40:43], 0
    v_exp_f32 v189, v189
    v_mfma_f32_16x16x32_bf16 v[204:207], v[164:167], v[36:39], v[204:207]
    v_mfma_f32_16x16x32_bf16 v[212:215], v[164:167], v[44:47], v[212:215]
    v_exp_f32 v190, v190
    v_smfmac_f32_16x16x64_bf16 v[104:107], v[184:187], v[220:227], v255
    s_waitcnt lgkmcnt(0)
    v_bfi_b32 v236, 31, v246, v236
    v_bfi_b32 v237, 31, v246, v237
    v_exp_f32 v191, v191
    s_setprio 3
    v_smfmac_f32_16x16x64_bf16 v[108:111], v[184:187], v[228:235], v255
    v_exp_f32 v196, v196
    v_exp_f32 v197, v197
    v_exp_f32 v198, v198
    v_exp_f32 v199, v199
    v_pk_add_f32 v[188:189], v[188:189], 1.0 op_sel_hi:[1,0]
    v_pk_add_f32 v[190:191], v[190:191], 1.0 op_sel_hi:[1,0]
    v_pk_add_f32 v[196:197], v[196:197], 1.0 op_sel_hi:[1,0]
    v_pk_add_f32 v[198:199], v[198:199], 1.0 op_sel_hi:[1,0]
    s_setprio 0
    v_mfma_f32_16x16x32_bf16 v[220:223], v[176:179], v[88:91], 0
    ds_read_b64_tr_b16 v[184:185], v236
    ds_read_b64_tr_b16 v[186:187], v237
    v_mfma_f32_16x16x32_bf16 v[228:231], v[176:179], v[92:95], 0
    v_rcp_f32 v188, v188
    v_mfma_f32_16x16x32_bf16 v[220:223], v[160:163], v[16:19], v[220:223]
    v_rcp_f32 v189, v189
    v_mfma_f32_16x16x32_bf16 v[228:231], v[160:163], v[24:27], v[228:231]
    v_rcp_f32 v190, v190
    v_mfma_f32_16x16x32_bf16 v[220:223], v[164:167], v[20:23], v[220:223]
    v_rcp_f32 v191, v191
    s_setprio 3
    v_mfma_f32_16x16x32_bf16 v[228:231], v[164:167], v[28:31], v[228:231]
    v_rcp_f32 v196, v196
    v_rcp_f32 v197, v197
    v_rcp_f32 v198, v198
    v_rcp_f32 v199, v199
    v_pk_mul_f32 v[204:205], v[188:189], v[204:205]
    v_pk_mul_f32 v[206:207], v[190:191], v[206:207]
    v_pk_mul_f32 v[212:213], v[196:197], v[212:213]
    v_pk_mul_f32 v[214:215], v[198:199], v[214:215]
    s_setprio 0
    s_waitcnt lgkmcnt(0)
    v_smfmac_f32_16x16x64_bf16 v[144:147], v[184:187], v[204:211], v255
    v_smfmac_f32_16x16x64_bf16 v[148:151], v[184:187], v[212:219], v255
    v_exp_f32 v220, v220
    v_mfma_f32_16x16x32_bf16 v[204:207], v[160:163], v[48:51], 0
    v_mfma_f32_16x16x32_bf16 v[212:215], v[160:163], v[56:59], 0
    v_exp_f32 v221, v221
    v_mfma_f32_16x16x32_bf16 v[204:207], v[164:167], v[52:55], v[204:207]
    v_mfma_f32_16x16x32_bf16 v[212:215], v[164:167], v[60:63], v[212:215]
    v_exp_f32 v222, v222
    v_smfmac_f32_16x16x64_bf16 v[128:131], v[184:187], v[188:195], v255
    v_exp_f32 v223, v223
    s_setprio 3
    v_smfmac_f32_16x16x64_bf16 v[132:135], v[184:187], v[196:203], v255
    v_exp_f32 v228, v228
    v_exp_f32 v229, v229
    v_exp_f32 v230, v230
    v_exp_f32 v231, v231
    v_pk_add_f32 v[220:221], v[220:221], 1.0 op_sel_hi:[1,0]
    v_pk_add_f32 v[222:223], v[222:223], 1.0 op_sel_hi:[1,0]
    v_pk_add_f32 v[228:229], v[228:229], 1.0 op_sel_hi:[1,0]
    v_pk_add_f32 v[230:231], v[230:231], 1.0 op_sel_hi:[1,0]
    s_setprio 0
    v_rcp_f32 v220, v220
    v_rcp_f32 v221, v221
    v_rcp_f32 v222, v222
    v_rcp_f32 v223, v223
    v_rcp_f32 v228, v228
    v_rcp_f32 v229, v229
    v_rcp_f32 v230, v230
    v_rcp_f32 v231, v231
    v_pk_mul_f32 v[204:205], v[220:221], v[204:205]
    v_pk_mul_f32 v[206:207], v[222:223], v[206:207]
    v_pk_mul_f32 v[212:213], v[228:229], v[212:213]
    v_pk_mul_f32 v[214:215], v[230:231], v[214:215]
    v_smfmac_f32_16x16x64_bf16 v[136:139], v[184:187], v[220:227], v255
    v_smfmac_f32_16x16x64_bf16 v[140:143], v[184:187], v[228:235], v255
    v_smfmac_f32_16x16x64_bf16 v[152:155], v[184:187], v[204:211], v255
    v_smfmac_f32_16x16x64_bf16 v[156:159], v[184:187], v[212:219], v255
    s_branch L_DONE
L_DONE:
    v_mbcnt_lo_u32_b32 v247, -1, 0
    v_mbcnt_hi_u32_b32 v247, -1, v247
    v_and_b32 v246, 24, v246
    s_cmp_lg_u32 s19, 0
    s_cbranch_scc1 L_SLOW
L_EPI:
    s_waitcnt lgkmcnt(0)
    v_and_b32 v64, 48, v247
    v_and_b32 v67, 15, v247
    v_add_u32 v69, s72, v64
    v_lshl_add_u32 v70, v67, 2, s72
    ds_read_b128 v[80:83], v69 offset:0
    ds_read_b128 v[84:87], v69 offset:64
    ds_read2_b32 v[72:73], v70 offset0:0 offset1:16
    v_bfe_u32 v65, v247, 2, 3
    v_lshrrev_b32 v66, 5, v247
    v_lshl_add_u32 v65, v66, 4, v65
    v_mul_u32_u24 v65, 160, v65
    s_mov_b32 s10, 143488
    v_add3_u32 v65, v65, v246, s10
    ds_read_b64_tr_b16 v[0:1], v65 offset:0
    ds_read_b64_tr_b16 v[2:3], v65 offset:1280
    ds_read_b64_tr_b16 v[8:9], v65 offset:32
    ds_read_b64_tr_b16 v[10:11], v65 offset:1312
    ds_read_b64_tr_b16 v[16:17], v65 offset:64
    ds_read_b64_tr_b16 v[18:19], v65 offset:1344
    ds_read_b64_tr_b16 v[24:25], v65 offset:96
    ds_read_b64_tr_b16 v[26:27], v65 offset:1376
    ds_read_b64_tr_b16 v[4:5], v65 offset:5120
    ds_read_b64_tr_b16 v[6:7], v65 offset:6400
    ds_read_b64_tr_b16 v[12:13], v65 offset:5152
    ds_read_b64_tr_b16 v[14:15], v65 offset:6432
    s_movk_i32 s10, 832
    v_mad_u32_u24 v64, v246, s10, v64
    s_mov_b32 s10, 116736
    v_lshl_add_u32 v69, v67, 3, s10
    v_lshl_add_u32 v74, v67, 3, s73
    v_lshl_add_u32 v75, v67, 3, s74
    s_waitcnt lgkmcnt(8)
    ds_read_b64_tr_b16 v[20:21], v65 offset:5184
    ds_read_b64_tr_b16 v[22:23], v65 offset:6464
    ds_read_b64_tr_b16 v[28:29], v65 offset:5216
    ds_read_b64_tr_b16 v[30:31], v65 offset:6496
    v_add_u32 v76, v80, v69
    ds_read_b64 v[32:33], v76 offset:0
    v_add_u32 v76, v81, v69
    ds_read_b64 v[34:35], v76 offset:6656
    v_add_u32 v76, v82, v69
    ds_read_b64 v[36:37], v76 offset:13312
    v_add_u32 v76, v83, v69
    ds_read_b64 v[38:39], v76 offset:19968
    v_add_u32 v76, v84, v69
    ds_read_b64 v[40:41], v76 offset:0
    v_add_u32 v76, v85, v69
    ds_read_b64 v[42:43], v76 offset:6656
    v_add_u32 v76, v86, v69
    ds_read_b64 v[44:45], v76 offset:13312
    v_add_u32 v76, v87, v69
    ds_read_b64 v[46:47], v76 offset:19968
    v_add3_u32 v72, v72, v64, s10
    ds_read_b128 v[160:163], v72 offset:0
    ds_read_b128 v[164:167], v72 offset:64
    v_add3_u32 v73, v73, v64, s10
    ds_read_b128 v[168:171], v73 offset:0
    ds_read_b128 v[172:175], v73 offset:64
    s_waitcnt lgkmcnt(0)
    v_lshlrev_b32 v188, 16, v32
    v_lshlrev_b32 v189, 16, v34
    v_lshlrev_b32 v190, 16, v36
    v_lshlrev_b32 v191, 16, v38
    v_and_b32 v192, 0xffff0000, v32
    v_and_b32 v193, 0xffff0000, v34
    v_and_b32 v194, 0xffff0000, v36
    v_and_b32 v195, 0xffff0000, v38
    v_mfma_f32_16x16x32_bf16 v[188:191], v[160:163], v[0:3], v[188:191]
    v_lshlrev_b32 v196, 16, v33
    v_lshlrev_b32 v197, 16, v35
    v_lshlrev_b32 v198, 16, v37
    v_lshlrev_b32 v199, 16, v39
    v_lshl_add_u32 v80, v80, 2, v74
    v_mfma_f32_16x16x32_bf16 v[188:191], v[164:167], v[4:7], v[188:191]
    v_mfma_f32_16x16x32_bf16 v[192:195], v[160:163], v[8:11], v[192:195]
    v_and_b32 v200, 0xffff0000, v33
    v_and_b32 v201, 0xffff0000, v35
    v_and_b32 v202, 0xffff0000, v37
    v_and_b32 v203, 0xffff0000, v39
    v_lshl_add_u32 v81, v81, 2, v74
    v_mfma_f32_16x16x32_bf16 v[192:195], v[164:167], v[12:15], v[192:195]
    v_mfma_f32_16x16x32_bf16 v[196:199], v[160:163], v[16:19], v[196:199]
    v_lshlrev_b32 v48, 16, v40
    v_lshlrev_b32 v49, 16, v42
    v_lshlrev_b32 v50, 16, v44
    v_lshlrev_b32 v51, 16, v46
    v_lshl_add_u32 v82, v82, 2, v74
    v_mfma_f32_16x16x32_bf16 v[196:199], v[164:167], v[20:23], v[196:199]
    v_mfma_f32_16x16x32_bf16 v[200:203], v[160:163], v[24:27], v[200:203]
    v_and_b32 v52, 0xffff0000, v40
    v_and_b32 v53, 0xffff0000, v42
    v_and_b32 v54, 0xffff0000, v44
    v_and_b32 v55, 0xffff0000, v46
    v_lshl_add_u32 v83, v83, 2, v74
    v_mfma_f32_16x16x32_bf16 v[200:203], v[164:167], v[28:31], v[200:203]
    v_mfma_f32_16x16x32_bf16 v[48:51], v[168:171], v[0:3], v[48:51]
    v_lshlrev_b32 v56, 16, v41
    v_lshlrev_b32 v57, 16, v43
    v_lshlrev_b32 v58, 16, v45
    v_lshlrev_b32 v59, 16, v47
    v_lshl_add_u32 v84, v84, 2, v75
    v_mfma_f32_16x16x32_bf16 v[48:51], v[172:175], v[4:7], v[48:51]
    v_mfma_f32_16x16x32_bf16 v[52:55], v[168:171], v[8:11], v[52:55]
    v_and_b32 v60, 0xffff0000, v41
    v_and_b32 v61, 0xffff0000, v43
    v_and_b32 v62, 0xffff0000, v45
    v_and_b32 v63, 0xffff0000, v47
    v_lshl_add_u32 v85, v85, 2, v75
    v_mfma_f32_16x16x32_bf16 v[52:55], v[172:175], v[12:15], v[52:55]
    v_mfma_f32_16x16x32_bf16 v[56:59], v[168:171], v[16:19], v[56:59]
    v_lshl_add_u32 v86, v86, 2, v75
    v_mfma_f32_16x16x32_bf16 v[56:59], v[172:175], v[20:23], v[56:59]
    v_mfma_f32_16x16x32_bf16 v[60:63], v[168:171], v[24:27], v[60:63]
    v_lshl_add_u32 v87, v87, 2, v75
    v_mfma_f32_16x16x32_bf16 v[60:63], v[172:175], v[28:31], v[60:63]
L_EPB:
    s_setprio 0
    s_mov_b64 exec, s[76:77]
    s_and_b32 s11, s25, 19
    s_nop 2
    s_cmp_eq_u32 s11, 0
    s_cbranch_scc1 L_NS0
    s_cmp_eq_u32 s11, 1
    s_cbranch_scc1 L_NS1
    s_cmp_eq_u32 s11, 2
    s_cbranch_scc1 L_NS2
    s_cmp_eq_u32 s11, 3
    s_cbranch_scc1 L_NS3
L_NSR:
    s_mov_b64 exec, -1
    v_rcp_f32 v96, v96
    v_rcp_f32 v97, v97
    v_rcp_f32 v98, v98
    v_rcp_f32 v99, v99
    v_rcp_f32 v100, v100
    v_rcp_f32 v101, v101
    v_rcp_f32 v102, v102
    v_rcp_f32 v103, v103
    v_rcp_f32 v104, v104
    v_rcp_f32 v105, v105
    v_rcp_f32 v106, v106
    v_rcp_f32 v107, v107
    v_rcp_f32 v108, v108
    v_rcp_f32 v109, v109
    v_rcp_f32 v110, v110
    v_rcp_f32 v111, v111
    v_pk_fma_f32 v[112:113], v[112:113], v[96:97], v[188:189]
    v_pk_fma_f32 v[114:115], v[114:115], v[98:99], v[190:191]
    v_pk_fma_f32 v[116:117], v[116:117], v[100:101], v[192:193]
    v_pk_fma_f32 v[118:119], v[118:119], v[102:103], v[194:195]
    v_pk_fma_f32 v[120:121], v[120:121], v[104:105], v[196:197]
    v_pk_fma_f32 v[122:123], v[122:123], v[106:107], v[198:199]
    v_pk_fma_f32 v[124:125], v[124:125], v[108:109], v[200:201]
    v_pk_fma_f32 v[126:127], v[126:127], v[110:111], v[202:203]
    v_cvt_pk_bf16_f32 v96, v112, v116
    v_cvt_pk_bf16_f32 v97, v120, v124
    v_pk_max_f16 v96, v96, v32
    v_pk_max_f16 v97, v97, v33
    buffer_store_dwordx2 v[96:97], v80, s[48:51], 0 offen sc1
    v_cvt_pk_bf16_f32 v98, v113, v117
    v_cvt_pk_bf16_f32 v99, v121, v125
    v_pk_max_f16 v98, v98, v34
    v_pk_max_f16 v99, v99, v35
    buffer_store_dwordx2 v[98:99], v81, s[48:51], 0 offen sc1
    v_cvt_pk_bf16_f32 v100, v114, v118
    v_cvt_pk_bf16_f32 v101, v122, v126
    v_pk_max_f16 v100, v100, v36
    v_pk_max_f16 v101, v101, v37
    buffer_store_dwordx2 v[100:101], v82, s[48:51], 0 offen sc1
    v_cvt_pk_bf16_f32 v102, v115, v119
    v_cvt_pk_bf16_f32 v103, v123, v127
    v_pk_max_f16 v102, v102, v38
    v_pk_max_f16 v103, v103, v39
    buffer_store_dwordx2 v[102:103], v83, s[48:51], 0 offen sc1
    v_rcp_f32 v128, v128
    v_rcp_f32 v129, v129
    v_rcp_f32 v130, v130
    v_rcp_f32 v131, v131
    v_rcp_f32 v132, v132
    v_rcp_f32 v133, v133
    v_rcp_f32 v134, v134
    v_rcp_f32 v135, v135
    v_rcp_f32 v136, v136
    v_rcp_f32 v137, v137
    v_rcp_f32 v138, v138
    v_rcp_f32 v139, v139
    v_rcp_f32 v140, v140
    v_rcp_f32 v141, v141
    v_rcp_f32 v142, v142
    v_rcp_f32 v143, v143
    v_pk_fma_f32 v[144:145], v[144:145], v[128:129], v[48:49]
    v_pk_fma_f32 v[146:147], v[146:147], v[130:131], v[50:51]
    v_pk_fma_f32 v[148:149], v[148:149], v[132:133], v[52:53]
    v_pk_fma_f32 v[150:151], v[150:151], v[134:135], v[54:55]
    v_pk_fma_f32 v[152:153], v[152:153], v[136:137], v[56:57]
    v_pk_fma_f32 v[154:155], v[154:155], v[138:139], v[58:59]
    v_pk_fma_f32 v[156:157], v[156:157], v[140:141], v[60:61]
    v_pk_fma_f32 v[158:159], v[158:159], v[142:143], v[62:63]
    v_cvt_pk_bf16_f32 v128, v144, v148
    v_cvt_pk_bf16_f32 v129, v152, v156
    v_pk_max_f16 v128, v128, v40
    v_pk_max_f16 v129, v129, v41
    buffer_store_dwordx2 v[128:129], v84, s[60:63], 0 offen sc1
    v_cvt_pk_bf16_f32 v130, v145, v149
    v_cvt_pk_bf16_f32 v131, v153, v157
    v_pk_max_f16 v130, v130, v42
    v_pk_max_f16 v131, v131, v43
    buffer_store_dwordx2 v[130:131], v85, s[60:63], 0 offen sc1
    v_cvt_pk_bf16_f32 v132, v146, v150
    v_cvt_pk_bf16_f32 v133, v154, v158
    v_pk_max_f16 v132, v132, v44
    v_pk_max_f16 v133, v133, v45
    buffer_store_dwordx2 v[132:133], v86, s[60:63], 0 offen sc1
    v_cvt_pk_bf16_f32 v134, v147, v151
    v_cvt_pk_bf16_f32 v135, v155, v159
    v_pk_max_f16 v134, v134, v46
    v_pk_max_f16 v135, v135, v47
    buffer_store_dwordx2 v[134:135], v87, s[60:63], 0 offen sc1
L_END:
    s_endpgm
L_NS0:
    v_add_f32 v96, v96, v128
    v_add_f32 v100, v100, v132
    v_add_f32 v104, v104, v136
    v_add_f32 v108, v108, v140
    v_add_f32 v112, v112, v144
    v_add_f32 v116, v116, v148
    v_add_f32 v120, v120, v152
    v_add_f32 v124, v124, v156
    s_branch L_NSR
L_NS1:
    v_add_f32 v97, v97, v129
    v_add_f32 v101, v101, v133
    v_add_f32 v105, v105, v137
    v_add_f32 v109, v109, v141
    v_add_f32 v113, v113, v145
    v_add_f32 v117, v117, v149
    v_add_f32 v121, v121, v153
    v_add_f32 v125, v125, v157
    s_branch L_NSR
L_NS2:
    v_add_f32 v98, v98, v130
    v_add_f32 v102, v102, v134
    v_add_f32 v106, v106, v138
    v_add_f32 v110, v110, v142
    v_add_f32 v114, v114, v146
    v_add_f32 v118, v118, v150
    v_add_f32 v122, v122, v154
    v_add_f32 v126, v126, v158
    s_branch L_NSR
L_NS3:
    v_add_f32 v99, v99, v131
    v_add_f32 v103, v103, v135
    v_add_f32 v107, v107, v139
    v_add_f32 v111, v111, v143
    v_add_f32 v115, v115, v147
    v_add_f32 v119, v119, v151
    v_add_f32 v123, v123, v155
    v_add_f32 v127, v127, v159
    s_branch L_NSR
L_RT0:
    s_waitcnt vmcnt(0)
    s_add_u32 s100, s100, 1
    s_cmp_gt_u32 s100, 200000
    s_cbranch_scc1 L_END
    s_sleep 1
    buffer_load_dwordx4 v[128:131], v232, s[56:59], 0 offen sc1
    buffer_load_dwordx4 v[132:135], v232, s[56:59], s26 offen sc1
    buffer_load_dwordx4 v[136:139], v232, s[56:59], s27 offen sc1
    buffer_load_dwordx4 v[140:143], v232, s[56:59], s28 offen sc1
    s_waitcnt vmcnt(0)
    s_branch L_PW0
L_RT1:
    s_waitcnt vmcnt(0)
    s_add_u32 s100, s100, 1
    s_cmp_gt_u32 s100, 200000
    s_cbranch_scc1 L_END
    s_sleep 1
    buffer_load_dwordx4 v[132:135], v232, s[56:59], s26 offen sc1
    buffer_load_dwordx4 v[136:139], v232, s[56:59], s27 offen sc1
    buffer_load_dwordx4 v[140:143], v232, s[56:59], s28 offen sc1
    s_waitcnt vmcnt(0)
    s_branch L_PW1
L_RT2:
    s_waitcnt vmcnt(0)
    s_add_u32 s100, s100, 1
    s_cmp_gt_u32 s100, 200000
    s_cbranch_scc1 L_END
    s_sleep 1
    buffer_load_dwordx4 v[136:139], v232, s[56:59], s27 offen sc1
    buffer_load_dwordx4 v[140:143], v232, s[56:59], s28 offen sc1
    s_waitcnt vmcnt(0)
    s_branch L_PW2
L_RT3:
    s_waitcnt vmcnt(0)
    s_add_u32 s100, s100, 1
    s_cmp_gt_u32 s100, 200000
    s_cbranch_scc1 L_END
    s_sleep 1
    buffer_load_dwordx4 v[140:143], v232, s[56:59], s28 offen sc1
    s_waitcnt vmcnt(0)
    s_branch L_PW3
L_XT2B:
    s_add_u32 s100, s100, 1
    s_cmp_gt_u32 s100, 200000
    s_cbranch_scc1 L_END
    s_sleep 1
    s_mov_b64 exec, s[70:71]
    s_cbranch_execz L_XLb0
    s_movk_i32 s10, 0
    buffer_load_dwordx4 v[64:67], v232, s[60:63], s10 offen sc1
L_XLb0:
    s_mov_b64 exec, s[78:79]
    s_cbranch_execz L_XLb1
    s_movk_i32 s10, 8192
    buffer_load_dwordx4 v[68:71], v232, s[60:63], s10 offen sc1
L_XLb1:
    s_mov_b64 exec, s[86:87]
    s_cbranch_execz L_XLb2
    s_movk_i32 s10, 16384
    buffer_load_dwordx4 v[72:75], v232, s[60:63], s10 offen sc1
L_XLb2:
    s_mov_b64 exec, s[94:95]
    s_cbranch_execz L_XLb3
    s_movk_i32 s10, 24576
    buffer_load_dwordx4 v[76:79], v232, s[60:63], s10 offen sc1
L_XLb3:
    s_mov_b64 exec, -1
    s_waitcnt vmcnt(0)
    s_branch L_XT2
L_OVF:
    s_mov_b32 s20, 0
    s_mov_b32 s17, 0
    s_mov_b32 s30, 0
    s_mov_b32 s19, 4
    s_waitcnt lgkmcnt(0)
    s_branch L_CA
L_POVF:
    s_movk_i32 s11, 1986
    v_mul_u32_u24 v64, s11, v192
    v_lshrrev_b32 v64, 16, v64
    v_mul_u32_u24 v65, s11, v193
    v_lshrrev_b32 v65, 16, v65
    v_mul_u32_u24 v66, s11, v194
    v_lshrrev_b32 v66, 16, v66
    v_mul_u32_u24 v67, s11, v195
    v_lshrrev_b32 v67, 16, v67
    v_add_u32 v69, v64, v65
    v_add_u32 v70, v69, v66
    v_add_u32 v71, v70, v67
    v_mov_b32 v72, v71
    s_nop 1
    v_add_u32_dpp v72, v72, v72 row_shr:1 row_mask:0xf bank_mask:0xf bound_ctrl:0
    s_nop 1
    v_add_u32_dpp v72, v72, v72 row_shr:2 row_mask:0xf bank_mask:0xf bound_ctrl:0
    s_nop 1
    v_add_u32_dpp v72, v72, v72 row_shr:4 row_mask:0xf bank_mask:0xf bound_ctrl:0
    s_nop 1
    v_add_u32_dpp v72, v72, v72 row_shr:8 row_mask:0xf bank_mask:0xf bound_ctrl:0
    s_nop 1
    v_add_u32_dpp v72, v72, v72 row_bcast:15 row_mask:0xa bank_mask:0xf
    s_nop 1
    v_add_u32_dpp v72, v72, v72 row_bcast:31 row_mask:0xc bank_mask:0xf
    s_nop 0
    v_sub_u32 v68, v72, v71
    v_add_u32 v71, v68, v70
    v_add_u32 v70, v68, v69
    v_add_u32 v69, v68, v64
    v_lshl_or_b32 v68, v64, 16, v68
    v_lshl_or_b32 v69, v65, 16, v69
    v_lshl_or_b32 v70, v66, 16, v70
    v_lshl_or_b32 v71, v67, 16, v71
    v_add_u32 v72, 154752, v185
    ds_write_b128 v72, v[68:71]
    s_lshl_b32 s10, s2, 10
    s_add_u32 s10, s10, 24772608
    buffer_store_dwordx4 v[68:71], v185, s[52:55], s10 offen sc1
    v_and_b32 v74, 0x3fc, v136
    v_add_u32 v74, 154752, v74
    ds_read_u16 v74, v74
    v_and_b32 v75, 0x3fc, v137
    v_add_u32 v75, 154752, v75
    ds_read_u16 v75, v75
    v_and_b32 v76, 0x3fc, v138
    v_add_u32 v76, 154752, v76
    ds_read_u16 v76, v76
    v_and_b32 v77, 0x3fc, v139
    v_add_u32 v77, 154752, v77
    ds_read_u16 v77, v77
    v_and_b32 v78, 0x3fc, v140
    v_add_u32 v78, 154752, v78
    ds_read_u16 v78, v78
    v_and_b32 v79, 0x3fc, v141
    v_add_u32 v79, 154752, v79
    ds_read_u16 v79, v79
    v_and_b32 v80, 0x3fc, v142
    v_add_u32 v80, 154752, v80
    ds_read_u16 v80, v80
    v_and_b32 v81, 0x3fc, v143
    v_add_u32 v81, 154752, v81
    ds_read_u16 v81, v81
    s_waitcnt lgkmcnt(0)
    v_cmpx_lt_u32 vcc, 1056, v228
    v_or_b32 v205, 0x10000, v205
    s_mov_b64 exec, -1
    v_cmpx_lt_u32 vcc, 1056, v229
    v_or_b32 v209, 0x10000, v209
    s_mov_b64 exec, -1
    v_cmpx_lt_u32 vcc, 1056, v230
    v_or_b32 v213, 0x10000, v213
    s_mov_b64 exec, -1
    v_cmpx_lt_u32 vcc, 1056, v231
    v_or_b32 v217, 0x10000, v217
    s_mov_b64 exec, -1
    s_mul_i32 s10, s2, 4152
    s_mov_b32 s34, 18874368
    s_mov_b32 s35, 23592960
    v_mul_u32_u24 v64, s11, v112
    v_lshrrev_b32 v64, 16, v64
    v_add3_u32 v64, v64, v74, s10
    v_lshlrev_b32 v65, 2, v64
    v_cmpx_le_u32 vcc, 1056, v112
    s_cbranch_execz L_PO0
    buffer_store_byte v120, v64, s[52:55], s35 offen sc1
    buffer_store_dword v96, v65, s[52:55], s34 offen sc1
L_PO0:
    s_mov_b64 exec, -1
    v_mul_u32_u24 v64, s11, v113
    v_lshrrev_b32 v64, 16, v64
    v_add3_u32 v64, v64, v75, s10
    v_lshlrev_b32 v65, 2, v64
    v_cmpx_le_u32 vcc, 1056, v113
    s_cbranch_execz L_PO1
    buffer_store_byte v121, v64, s[52:55], s35 offen sc1
    buffer_store_dword v97, v65, s[52:55], s34 offen sc1
L_PO1:
    s_mov_b64 exec, -1
    v_mul_u32_u24 v64, s11, v114
    v_lshrrev_b32 v64, 16, v64
    v_add3_u32 v64, v64, v76, s10
    v_lshlrev_b32 v65, 2, v64
    v_cmpx_le_u32 vcc, 1056, v114
    s_cbranch_execz L_PO2
    buffer_store_byte v122, v64, s[52:55], s35 offen sc1
    buffer_store_dword v98, v65, s[52:55], s34 offen sc1
L_PO2:
    s_mov_b64 exec, -1
    v_mul_u32_u24 v64, s11, v115
    v_lshrrev_b32 v64, 16, v64
    v_add3_u32 v64, v64, v77, s10
    v_lshlrev_b32 v65, 2, v64
    v_cmpx_le_u32 vcc, 1056, v115
    s_cbranch_execz L_PO3
    buffer_store_byte v123, v64, s[52:55], s35 offen sc1
    buffer_store_dword v99, v65, s[52:55], s34 offen sc1
L_PO3:
    s_mov_b64 exec, -1
    v_mul_u32_u24 v64, s11, v116
    v_lshrrev_b32 v64, 16, v64
    v_add3_u32 v64, v64, v78, s10
    v_lshlrev_b32 v65, 2, v64
    v_cmpx_le_u32 vcc, 1056, v116
    s_cbranch_execz L_PO4
    buffer_store_byte v120, v64, s[52:55], s35 offen sc1
    buffer_store_dword v100, v65, s[52:55], s34 offen sc1
L_PO4:
    s_mov_b64 exec, -1
    v_mul_u32_u24 v64, s11, v117
    v_lshrrev_b32 v64, 16, v64
    v_add3_u32 v64, v64, v79, s10
    v_lshlrev_b32 v65, 2, v64
    v_cmpx_le_u32 vcc, 1056, v117
    s_cbranch_execz L_PO5
    buffer_store_byte v121, v64, s[52:55], s35 offen sc1
    buffer_store_dword v101, v65, s[52:55], s34 offen sc1
L_PO5:
    s_mov_b64 exec, -1
    v_mul_u32_u24 v64, s11, v118
    v_lshrrev_b32 v64, 16, v64
    v_add3_u32 v64, v64, v80, s10
    v_lshlrev_b32 v65, 2, v64
    v_cmpx_le_u32 vcc, 1056, v118
    s_cbranch_execz L_PO6
    buffer_store_byte v122, v64, s[52:55], s35 offen sc1
    buffer_store_dword v102, v65, s[52:55], s34 offen sc1
L_PO6:
    s_mov_b64 exec, -1
    v_mul_u32_u24 v64, s11, v119
    v_lshrrev_b32 v64, 16, v64
    v_add3_u32 v64, v64, v81, s10
    v_lshlrev_b32 v65, 2, v64
    v_cmpx_le_u32 vcc, 1056, v119
    s_cbranch_execz L_PO7
    buffer_store_byte v123, v64, s[52:55], s35 offen sc1
    buffer_store_dword v103, v65, s[52:55], s34 offen sc1
L_PO7:
    s_mov_b64 exec, -1
    s_waitcnt vmcnt(0) lgkmcnt(0)
    s_barrier
    s_branch L_POUT
L_SLOW:
    s_setprio 0
    s_lshl_b32 s10, s3, 6
    v_add_u32 v255, s10, v247
    s_cmp_lg_u32 s19, 4
    s_cbranch_scc1 L_SL1
    s_mov_b32 s19, 1
    v_and_b32 v188, 0xff, v255
    v_lshlrev_b32 v189, 7, v188
    buffer_load_dword v190, v189, s[56:59], 0 offen offset:4 sc1
    v_lshlrev_b32 v189, 10, v188
    s_lshl_b32 s10, s5, 2
    s_add_u32 s10, s10, 24772608
    buffer_load_dword v191, v189, s[52:55], s10 offen sc1
    v_lshlrev_b32 v188, 2, v188
    v_add_u32 v188, 154752, v188
    s_waitcnt vmcnt(0)
    v_and_b32 v190, 0x10000, v190
    v_cmp_ne_u32 vcc, 0, v190
    v_mov_b32 v190, 2097152
    s_nop 0
    v_cndmask_b32 v190, v190, v191, vcc
    ds_write_b32 v188, v190
    s_waitcnt lgkmcnt(0)
    s_barrier
L_SL1:
    s_add_u32 s28, s28, 288
    s_cmp_lt_u32 s28, s29
    s_cbranch_scc1 L_BATCH
L_FIND:
    s_cmp_lg_u64 s[32:33], 0
    s_cbranch_scc1 L_GOT
    s_add_u32 s26, s26, 1
    s_cmp_ge_u32 s26, 4
    s_cbranch_scc1 L_EPI
    s_lshl_b32 s10, s26, 8
    s_add_u32 s10, s10, 154752
    v_lshl_add_u32 v188, v247, 2, s10
    ds_read_u16 v188, v188 offset:2
    s_waitcnt lgkmcnt(0)
    v_cmp_lt_u32 s[32:33], s20, v188
    s_nop 3
    s_branch L_FIND
L_GOT:
    s_ff1_i32_b64 s10, s[32:33]
    s_bitset0_b64 s[32:33], s10
    s_lshl_b32 s11, s26, 6
    s_add_u32 s27, s10, s11
    s_lshl_b32 s10, s27, 2
    s_add_u32 s10, s10, 154752
    v_mov_b32 v188, s10
    ds_read_b32 v188, v188
    s_waitcnt lgkmcnt(0)
    v_readfirstlane_b32 s10, v188
    s_nop 3
    s_lshr_b32 s29, s10, 16
    s_and_b32 s30, s10, 0xffff
    s_mov_b32 s28, s20
L_BATCH:
    s_waitcnt vmcnt(0)
    s_barrier
    v_mov_b32 v192, 0x2000000
    v_mov_b32 v193, 0x2000000
    v_mov_b32 v194, 0x2000000
    v_mov_b32 v195, 0x2000000
    v_mov_b32 v196, 0xfffff
    v_mov_b32 v197, 0xfffff
    v_mov_b32 v198, 0xfffff
    v_mov_b32 v199, 0xfffff
    v_lshl_add_u32 v200, v247, 4, s12
    ds_write_b128 v200, v[192:195] offset:0
    ds_write_b128 v200, v[196:199] offset:18432
    ds_write_b128 v200, v[192:195] offset:1024
    ds_write_b128 v200, v[196:199] offset:19456
    ds_write_b128 v200, v[192:195] offset:1280
    ds_write_b128 v200, v[196:199] offset:19712
    v_and_b32 v188, 15, v247
    v_mul_u32_u24 v189, 1152, v188
    v_add_u32 v189, 8192, v189
    v_lshlrev_b32 v188, 2, v188
    ds_write_b32 v188, v189 offset:576
    v_add_u32 v188, s28, v255
    s_mul_i32 s36, s27, 3128
    s_mul_i32 s11, s27, 4152
    s_add_u32 s11, s11, s30
    s_lshl_b32 s34, s11, 2
    s_add_u32 s34, s34, 18874368
    v_lshl_add_u32 v190, v188, 2, s34
    s_add_u32 s34, s11, 23592960
    v_add_u32 v191, s34, v188
    s_mul_i32 s10, s5, 32896
    s_lshl_b32 s34, s27, 7
    s_add_u32 s10, s10, s34
    s_add_u32 s10, s10, 65536
    v_and_b32 v206, 7, v188
    v_lshl_add_u32 v206, v206, 4, s10
    v_lshrrev_b32 v207, 3, v188
    v_cmpx_gt_u32 vcc, 32, v188
    v_add_u32 v190, 8421376, v206
    v_add_u32 v191, 8, v190
    v_cmpx_gt_u32 vcc, 24, v188
    v_lshl_add_u32 v190, v207, 2, v206
    v_add3_u32 v191, v206, v207, 12
    s_mov_b64 exec, -1
    s_add_u32 s10, s28, 288
    s_min_u32 s10, s10, s29
    v_cmp_gt_u32 vcc, s10, v188
    v_mov_b32 v206, 0x7ffffff0
    s_nop 0
    v_cndmask_b32 v190, v206, v190, vcc
    v_cndmask_b32 v191, v206, v191, vcc
    buffer_load_dwordx2 v[204:205], v190, s[52:55], 0 offen sc1
    buffer_load_ubyte v191, v191, s[52:55], 0 offen sc1
    s_waitcnt lgkmcnt(0)
    s_barrier
    s_waitcnt vmcnt(0)
    v_cmp_ne_u32 vcc, 3, v207
    v_cmp_eq_u32 s[10:11], s6, v205
    v_mov_b32 v206, s36
    s_or_b64 exec, vcc, s[10:11]
    v_cmpx_ne_u32 vcc, 0, v204
    v_bfe_u32 v190, v204, 18, 8
    v_lshlrev_b32 v190, 2, v190
    v_add_u32 v188, 153728, v190
    ds_read_b32 v188, v188
    v_add_u32_sdwa v191, v191, v206 dst_sel:DWORD dst_unused:UNUSED_PAD src0_sel:BYTE_0 src1_sel:DWORD
    v_lshrrev_b32 v189, 28, v204
    v_lshl_add_u32 v191, v189, 8, v191
    v_and_b32 v189, 60, v190
    v_and_b32 v204, 0xffff, v204
    v_lshl_or_b32 v204, v189, 19, v204
    v_mov_b32 v190, 4
    s_waitcnt lgkmcnt(0)
    ds_add_rtn_u32 v188, v188, v190 offset:576
    s_waitcnt lgkmcnt(0)
    ds_write2st64_b32 v188, v204, v191 offset0:148 offset1:220
    s_mov_b64 exec, -1
    s_waitcnt lgkmcnt(0)
    s_barrier
    v_lshrrev_b32 v190, 3, v247
    v_lshl_add_u32 v248, v190, 4, s12
    s_add_u32 s10, s12, 18432
    v_lshrrev_b32 v190, 1, v247
    v_lshl_add_u32 v249, v190, 2, s10
    s_add_u32 s10, s10, 2
    v_lshrrev_b32 v190, 5, v247
    v_mul_i32_i24 v250, 0xffffb800, v190
    v_and_b32 v190, 15, v247
    v_lshl_add_u32 v250, v190, 2, v250
    v_add_u32 v250, s10, v250
    s_add_u32 s10, s12, 2
    v_and_b32 v190, 48, v247
    v_lshl_add_u32 v251, v190, 1, s10
    v_and_b32 v190, 12, v247
    v_add_u32 v251, v251, v190
    ds_read_b128 v[236:239], v248
    ds_read_b32 v240, v249
    s_lshl_b32 s10, s4, 3
    v_mov_b32 v190, s10
    ds_read_b64 v[190:191], v190 offset:576
    s_waitcnt lgkmcnt(0)
    v_readfirstlane_b32 s34, v190
    v_readfirstlane_b32 s35, v191
    s_sub_u32 s10, s12, 37888
    s_sub_u32 s34, s34, s10
    s_sub_u32 s35, s35, s10
    s_sub_u32 s35, s35, 1152
    s_add_u32 s10, s34, 127
    s_lshr_b32 s10, s10, 7
    s_lshl1_add_u32 s10, s10, -1
    s_add_u32 s11, s35, 127
    s_lshr_b32 s11, s11, 6
    s_and_b32 s11, s11, -2
    s_max_i32 s17, s10, s11
    s_cselect_b32 s10, s34, s35
    s_sub_u32 s10, s10, 1
    s_andn2_b32 s99, 64, s10
    v_mov_b64 v[204:205], 0
    v_mov_b64 v[206:207], 0
    v_mov_b64 v[184:185], 0
    v_mov_b64 v[186:187], 0
    s_add_u32 m0, s13, 0
    v_mad_u32_u16 v236, v236, s15, v243
    buffer_load_dwordx4 v236, s[40:43], 0 offen lds
    s_add_u32 m0, s13, 1056
    v_mad_u32_u16 v237, v237, s15, v243
    buffer_load_dwordx4 v237, s[40:43], 0 offen lds
    s_add_u32 m0, s13, 2112
    v_mad_u32_u16 v238, v238, s15, v243
    buffer_load_dwordx4 v238, s[40:43], 0 offen lds
    s_add_u32 m0, s13, 3168
    v_mad_u32_u16 v239, v239, s15, v243
    buffer_load_dwordx4 v239, s[40:43], 0 offen lds
    s_mov_b32 m0, s14
    s_nop 0
    buffer_load_dwordx4 v[240:241], s[44:47], 0 idxen offen lds
L_LAST:
    s_branch L_GO
.section .rodata,"a"
.p2align 6
.amdhsa_kernel standalone__edge_featured_mpnn_gatedgcn__graph_kernel
  .amdhsa_next_free_vgpr 256
  .amdhsa_next_free_sgpr 102
  .amdhsa_accum_offset 256
  .amdhsa_group_segment_fixed_size 0
  .amdhsa_kernarg_size 96
  .amdhsa_user_sgpr_count 2
  .amdhsa_user_sgpr_kernarg_segment_ptr 1
  .amdhsa_system_sgpr_workgroup_id_x 1
.end_amdhsa_kernel
```

```asm
; @launch grid=(256,1,1) block=(512,1,1) lds=158848
.amdgcn_target "amdgcn-amd-amdhsa--gfx950"
.text
.globl standalone__edge_featured_mpnn_gatedgcn__graph_kernel
.p2align 8
.type standalone__edge_featured_mpnn_gatedgcn__graph_kernel,@function
standalone__edge_featured_mpnn_gatedgcn__graph_kernel:
    s_load_dwordx16 s[16:31], s[0:1], 0
    s_load_dwordx8 s[32:39], s[0:1], 64
    s_getpc_b64 s[64:65]
L_PC:
    s_and_b32 s3, s2, -8
    v_add_lshl_u32 v1, v0, s3, 7
    v_min_u32 v1, L_LAST-L_PC, v1
    v_cmpx_gt_u32 vcc, 8, v0
    s_cbranch_execz L_NOCPF
    global_load_dword v252, v1, s[64:65]
L_NOCPF:
    s_mov_b64 exec, -1
    s_cmp_ge_u32 s2, 256
    s_cbranch_scc1 L_END
    s_mul_i32 s10, s2, 12512
    v_lshl_add_u32 v1, v0, 4, s10
    s_add_u32 s11, s10, 12512
    s_min_u32 s11, s11, 3200000
    v_add_u32 v2, 0x2000, v1
    s_waitcnt lgkmcnt(0)
    global_load_dwordx4 v[128:131], v1, s[22:23] nt
    global_load_dwordx4 v[96:99], v1, s[20:21] nt
    v_cmpx_gt_u32 s[70:71], s11, v2
    s_cbranch_execz L_NO8
    global_load_dwordx4 v[132:135], v2, s[22:23] nt
    global_load_dwordx4 v[100:103], v2, s[20:21] nt
L_NO8:
    s_mov_b64 exec, -1
L_NO7:
    s_mov_b64 exec, -1
    s_load_dword s6, s[38:39], 0
    v_mov_b32 v255, v0
    v_lshrrev_b32 v188, 6, v0
    v_and_b32 v247, 63, v0
    v_readfirstlane_b32 s3, v188
    v_lshlrev_b32 v232, 4, v0
    v_lshlrev_b32 v190, 3, v0
    v_lshlrev_b32 v191, 2, v0
    v_and_b32 v192, 0x3fc, v191
    s_and_b32 s5, s2, 7
    s_lshr_b32 s4, s2, 3
    s_lshl_b32 s5, s5, 5
    s_add_u32 s5, s5, s4
    s_mul_i32 s9, s5, 196
    s_cmp_eq_u32 s3, 7
    s_cselect_b32 s101, 0, s3
    s_lshl_b32 s12, s101, 5
    s_add_u32 s9, s9, s12
    v_lshrrev_b32 v193, 3, v247
    v_lshl_add_u32 v193, v193, 2, s9
    v_and_b32 v243, 7, v247
    v_lshlrev_b32 v243, 4, v243
    v_lshl_add_u32 v234, v193, 7, v243
    s_lshl_b32 s101, s101, 10
    s_add_u32 s101, s101, 116736
    v_mov_b64 v[196:197], 0
    v_mov_b64 v[198:199], 0
    v_mov_b32 v194, 132
    ds_write2st64_b32 v192, v194, v196 offset0:20 offset1:24
    v_add_u32 v193, 46080, v232
    ds_write_b128 v193, v[196:199] offset:0
    ds_write_b128 v193, v[196:199] offset:8192
    ds_write_b128 v193, v[196:199] offset:16384
    ds_write_b128 v193, v[196:199] offset:24576
    ds_write_b128 v193, v[196:199] offset:32768
    s_mov_b32 s44, s18
    s_or_b32 s45, s19, 0x200000
    s_mov_b32 s46, 800000
    s_mov_b32 s47, 0x20000
    s_mov_b32 s48, s34
    s_mov_b32 s49, s35
    s_mov_b32 s50, 6400000
    s_mov_b32 s51, 0x20000
    s_mov_b32 s40, s16
    s_mov_b32 s41, s17
    s_mov_b32 s42, 6400000
    s_mov_b32 s43, 0x20000
    s_mov_b32 s52, s38
    s_mov_b32 s53, s39
    s_mov_b32 s54, 25165824
    s_mov_b32 s55, 0x20000
    s_lshl_b32 s12, s2, 7
    s_add_u32 s12, s12, 65536
    s_add_u32 s56, s38, s12
    s_addc_u32 s57, s39, 0
    s_mov_b32 s58, 16809984
    s_mov_b32 s59, 0x20000
    s_mov_b32 s64, 85599
    s_mov_b32 s65, 4294967100
    s_movk_i32 s66, 5368
    s_mov_b32 s67, 0xc000000
    s_mov_b32 s68, 32896
    s_mov_b32 s100, 0xffeff220
    v_add_u32 v120, 0, v191
    v_add_u32 v121, 1, v191
    v_add_u32 v122, 2, v191
    v_add_u32 v123, 3, v191
    s_lshl_b32 s10, s3, 28
    s_or_b32 s10, s10, 0x20000
    v_mov_b32 v144, s10
    v_or_b32 v145, 0x80000000, v144
    v_mov_b32 v184, 33
    v_mov_b32 v146, 0x400
    s_and_b32 s10, s3, 3
    s_lshr_b32 s4, s3, 2
    s_lshl1_add_u32 s4, s10, s4
    s_xor_b32 s4, s4, 1
    s_mul_i32 s10, s4, 49
    s_sub_i32 s10, s10, 6
    s_ashr_i32 s10, s10, 1
    s_max_i32 s7, s10, 0
    s_mul_i32 s13, s4, 4224
    s_add_u32 s13, s13, 82944
    s_lshl_b32 s14, s4, 10
    s_add_u32 s14, s14, 5120
    s_mul_i32 s12, s4, 2304
    s_add_u32 s12, s12, 46080
    s_movk_i32 s15, 128
    v_bfe_u32 v194, v255, 4, 4
    v_and_b32 v195, 7, v255
    v_cmp_eq_u32 vcc, v194, v195
    v_and_b32 v194, 8, v255
    v_lshlrev_b32 v194, 1, v194
    v_mov_b32 v196, 0x3f80
    v_lshlrev_b32 v196, v194, v196
    v_cndmask_b32 v196, 0, v196, vcc
    ds_write_b32 v192, v196 offset:0
    v_mov_b64 v[196:197], 0
    ds_write_b64 v190, v[196:197] offset:1024
    v_add_u32 v194, 155776, v191
    ds_write_b32 v194, v196
    v_lshrrev_b32 v223, 3, v255
    v_mul_u32_u24 v224, 160, v223
    v_mad_u32_u24 v220, v223, s68, v243
    v_add_u32 v221, v224, v243
    v_add_u32 v221, 46080, v221
    v_bfe_u32 v194, v255, 5, 1
    v_bfe_u32 v196, v255, 6, 1
    v_sub_u32 v194, v194, v196
    v_mul_i32_i24 v194, 640, v194
    v_add_u32 v224, v224, v194
    v_lshl_add_u32 v224, v195, 2, v224
    v_add_u32 v224, 13312, v224
    v_lshlrev_b32 v185, 4, v247
    v_and_b32 v194, 3, v247
    v_lshlrev_b32 v246, 3, v194
    v_bfe_u32 v197, v247, 2, 3
    v_lshrrev_b32 v196, 5, v247
    v_lshl_add_u32 v197, v196, 4, v197
    v_mul_u32_u24 v225, 160, v197
    v_add_u32 v225, v225, v246
    s_movk_i32 s69, 11520
    v_mov_b64 v[116:117], 0
    v_mov_b64 v[118:119], 0
    s_waitcnt lgkmcnt(0)
    s_barrier
    s_cmp_eq_u64 s[70:71], 0
    s_cbranch_scc1 L_R4
    s_waitcnt vmcnt(3)
    v_mul_u32_u24 v104, s64, v128
    v_mul_u32_u24 v105, s64, v129
    v_mul_u32_u24 v106, s64, v130
    v_mul_u32_u24 v107, s64, v131
    v_lshrrev_b32 v136, 29, v104
    v_lshrrev_b32 v137, 29, v105
    v_lshrrev_b32 v138, 29, v106
    v_lshrrev_b32 v139, 29, v107
    v_cmp_eq_u32 s[72:73], v136, v137
    v_cmp_eq_u32 s[76:77], v138, v139
    v_cmp_eq_u32 vcc, v136, v138
    v_cmp_eq_u32 s[88:89], v137, v139
    v_cmp_eq_u32 s[90:91], v136, v139
    v_cmp_eq_u32 s[10:11], v137, v138
    v_lshrrev_b32 v104, 24, v104
    v_lshrrev_b32 v105, 24, v105
    v_lshrrev_b32 v106, 24, v106
    v_lshrrev_b32 v107, 24, v107
    s_or_b64 s[74:75], s[72:73], s[88:89]
    s_or_b64 s[78:79], s[76:77], s[88:89]
    s_or_b64 s[72:73], s[72:73], vcc
    s_or_b64 s[76:77], s[76:77], vcc
    s_or_b64 s[72:73], s[72:73], s[90:91]
    s_or_b64 s[74:75], s[74:75], s[10:11]
    s_or_b64 s[76:77], s[76:77], s[10:11]
    s_or_b64 s[78:79], s[78:79], s[90:91]
    v_cndmask_b32 v136, 0, v146, s[72:73]
    v_lshl_add_u32 v136, v104, 2, v136
    ds_add_rtn_u32 v112, v136, v184 offset:5120
    v_cndmask_b32 v137, 0, v146, s[74:75]
    v_lshl_add_u32 v137, v105, 2, v137
    ds_add_rtn_u32 v113, v137, v184 offset:5120
    v_cndmask_b32 v138, 0, v146, s[76:77]
    v_lshl_add_u32 v138, v106, 2, v138
    ds_add_rtn_u32 v114, v138, v184 offset:5120
    v_cndmask_b32 v139, 0, v146, s[78:79]
    v_lshl_add_u32 v139, v107, 2, v139
    ds_add_rtn_u32 v115, v139, v184 offset:5120
    s_waitcnt vmcnt(1)
    s_mov_b64 exec, s[70:71]
    v_mul_u32_u24 v108, s64, v132
    v_mul_u32_u24 v109, s64, v133
    v_mul_u32_u24 v110, s64, v134
    v_mul_u32_u24 v111, s64, v135
    v_lshrrev_b32 v108, 24, v108
    v_lshrrev_b32 v109, 24, v109
    v_lshrrev_b32 v110, 24, v110
    v_lshrrev_b32 v111, 24, v111
    v_lshlrev_b32 v140, 2, v108
    ds_add_rtn_u32 v116, v140, v184 offset:5120
    v_lshlrev_b32 v141, 2, v109
    ds_add_rtn_u32 v117, v141, v184 offset:5120
    v_lshlrev_b32 v142, 2, v110
    ds_add_rtn_u32 v118, v142, v184 offset:5120
    v_lshlrev_b32 v143, 2, v111
    ds_add_rtn_u32 v119, v143, v184 offset:5120
    s_waitcnt lgkmcnt(7)
    s_mov_b64 exec, s[72:73]
    v_cmpx_le_u32 vcc, 132, v112
    ds_add_rtn_u32 v112, v136, v184 offset:4096
    s_waitcnt lgkmcnt(7)
    s_mov_b64 exec, s[74:75]
    v_cmpx_le_u32 vcc, 132, v113
    ds_add_rtn_u32 v113, v137, v184 offset:4096
    s_waitcnt lgkmcnt(7)
    s_mov_b64 exec, s[76:77]
    v_cmpx_le_u32 vcc, 132, v114
    ds_add_rtn_u32 v114, v138, v184 offset:4096
    s_waitcnt lgkmcnt(7)
    s_mov_b64 exec, s[78:79]
    v_cmpx_le_u32 vcc, 132, v115
    ds_add_rtn_u32 v115, v139, v184 offset:4096
    s_mov_b64 exec, s[70:71]
    s_waitcnt vmcnt(0)
    v_mad_i32_i24 v132, v108, s65, v132
    v_mul_u32_u24 v194, s66, v100
    v_lshl_or_b32 v100, v132, 18, v100
    v_and_b32 v132, 0xe0, v108
    v_mad_i32_i24 v194, v132, s100, v194
    v_and_or_b32 v194, v194, s67, v145
    v_mad_u32_u24 v132, v108, 40, s69
    v_or_b32 v100, v100, v194
    v_mad_i32_i24 v133, v109, s65, v133
    v_mul_u32_u24 v194, s66, v101
    v_lshl_or_b32 v101, v133, 18, v101
    v_and_b32 v133, 0xe0, v109
    v_mad_i32_i24 v194, v133, s100, v194
    v_and_or_b32 v194, v194, s67, v145
    v_mad_u32_u24 v133, v109, 40, s69
    v_or_b32 v101, v101, v194
    v_mad_i32_i24 v134, v110, s65, v134
    v_mul_u32_u24 v194, s66, v102
    v_lshl_or_b32 v102, v134, 18, v102
    v_and_b32 v134, 0xe0, v110
    v_mad_i32_i24 v194, v134, s100, v194
    v_and_or_b32 v194, v194, s67, v145
    v_mad_u32_u24 v134, v110, 40, s69
    v_or_b32 v102, v102, v194
    v_mad_i32_i24 v135, v111, s65, v135
    v_mul_u32_u24 v194, s66, v103
    v_lshl_or_b32 v103, v135, 18, v103
    v_and_b32 v135, 0xe0, v111
    v_mad_i32_i24 v194, v135, s100, v194
    v_and_or_b32 v194, v194, s67, v145
    v_mad_u32_u24 v135, v111, 40, s69
    v_or_b32 v103, v103, v194
    s_waitcnt lgkmcnt(7)
    v_bfe_u32 v194, v116, 3, 5
    v_add_lshl_u32 v132, v194, v132, 2
    v_and_b32 v194, 3, v194
    v_mad_i32_i24 v194, v194, -3, v132
    v_cmpx_gt_u32 vcc, 792, v116
    ds_write_b32 v132, v100
    ds_write_b8 v194, v120 offset:12
    s_mov_b64 exec, s[70:71]
    s_waitcnt lgkmcnt(8)
    v_bfe_u32 v194, v117, 3, 5
    v_add_lshl_u32 v133, v194, v133, 2
    v_and_b32 v194, 3, v194
    v_mad_i32_i24 v194, v194, -3, v133
    v_cmpx_gt_u32 vcc, 792, v117
    ds_write_b32 v133, v101
    ds_write_b8 v194, v121 offset:12
    s_mov_b64 exec, s[70:71]
    s_waitcnt lgkmcnt(9)
    v_bfe_u32 v194, v118, 3, 5
    v_add_lshl_u32 v134, v194, v134, 2
    v_and_b32 v194, 3, v194
    v_mad_i32_i24 v194, v194, -3, v134
    v_cmpx_gt_u32 vcc, 792, v118
    ds_write_b32 v134, v102
    ds_write_b8 v194, v122 offset:12
    s_mov_b64 exec, s[70:71]
    s_waitcnt lgkmcnt(10)
    v_bfe_u32 v194, v119, 3, 5
    v_add_lshl_u32 v135, v194, v135, 2
    v_and_b32 v194, 3, v194
    v_mad_i32_i24 v194, v194, -3, v135
    v_cmpx_gt_u32 vcc, 792, v119
    ds_write_b32 v135, v103
    ds_write_b8 v194, v123 offset:12
    s_mov_b64 exec, -1
    v_mad_i32_i24 v128, v104, s65, v128
    v_mul_u32_u24 v194, s66, v96
    v_lshl_or_b32 v96, v128, 18, v96
    v_and_b32 v128, 0xe0, v104
    v_mad_i32_i24 v194, v128, s100, v194
    v_and_or_b32 v194, v194, s67, v144
    v_mad_u32_u24 v128, v104, 40, s69
    v_or_b32 v96, v96, v194
    v_mad_i32_i24 v129, v105, s65, v129
    v_mul_u32_u24 v194, s66, v97
    v_lshl_or_b32 v97, v129, 18, v97
    v_and_b32 v129, 0xe0, v105
    v_mad_i32_i24 v194, v129, s100, v194
    v_and_or_b32 v194, v194, s67, v144
    v_mad_u32_u24 v129, v105, 40, s69
    v_or_b32 v97, v97, v194
    v_mad_i32_i24 v130, v106, s65, v130
    v_mul_u32_u24 v194, s66, v98
    v_lshl_or_b32 v98, v130, 18, v98
    v_and_b32 v130, 0xe0, v106
    v_mad_i32_i24 v194, v130, s100, v194
    v_and_or_b32 v194, v194, s67, v144
    v_mad_u32_u24 v130, v106, 40, s69
    v_or_b32 v98, v98, v194
    v_mad_i32_i24 v131, v107, s65, v131
    v_mul_u32_u24 v194, s66, v99
    v_lshl_or_b32 v99, v131, 18, v99
    v_and_b32 v131, 0xe0, v107
    v_mad_i32_i24 v194, v131, s100, v194
    v_and_or_b32 v194, v194, s67, v144
    v_mad_u32_u24 v131, v107, 40, s69
    v_or_b32 v99, v99, v194
    s_waitcnt lgkmcnt(11)
    v_bfe_u32 v194, v112, 3, 5
    v_add_lshl_u32 v128, v194, v128, 2
    v_and_b32 v194, 3, v194
    v_mad_i32_i24 v194, v194, -3, v128
    v_cmpx_gt_u32 vcc, 792, v112
    ds_write_b32 v128, v96
    ds_write_b8 v194, v120 offset:12
    s_mov_b64 exec, -1
    s_waitcnt lgkmcnt(12)
    v_bfe_u32 v194, v113, 3, 5
    v_add_lshl_u32 v129, v194, v129, 2
    v_and_b32 v194, 3, v194
    v_mad_i32_i24 v194, v194, -3, v129
    v_cmpx_gt_u32 vcc, 792, v113
    ds_write_b32 v129, v97
    ds_write_b8 v194, v121 offset:12
    s_mov_b64 exec, -1
    s_waitcnt lgkmcnt(13)
    v_bfe_u32 v194, v114, 3, 5
    v_add_lshl_u32 v130, v194, v130, 2
    v_and_b32 v194, 3, v194
    v_mad_i32_i24 v194, v194, -3, v130
    v_cmpx_gt_u32 vcc, 792, v114
    ds_write_b32 v130, v98
    ds_write_b8 v194, v122 offset:12
    s_mov_b64 exec, -1
    s_waitcnt lgkmcnt(14)
    v_bfe_u32 v194, v115, 3, 5
    v_add_lshl_u32 v131, v194, v131, 2
    v_and_b32 v194, 3, v194
    v_mad_i32_i24 v194, v194, -3, v131
    v_cmpx_gt_u32 vcc, 792, v115
    ds_write_b32 v131, v99
    ds_write_b8 v194, v123 offset:12
    s_mov_b64 exec, -1
    s_branch L_B1
L_R4:
    s_waitcnt vmcnt(1)
    v_mul_u32_u24 v104, s64, v128
    v_mul_u32_u24 v105, s64, v129
    v_mul_u32_u24 v106, s64, v130
    v_mul_u32_u24 v107, s64, v131
    v_lshrrev_b32 v136, 29, v104
    v_lshrrev_b32 v137, 29, v105
    v_lshrrev_b32 v138, 29, v106
    v_lshrrev_b32 v139, 29, v107
    v_cmp_eq_u32 s[72:73], v136, v137
    v_cmp_eq_u32 s[76:77], v138, v139
    v_cmp_eq_u32 vcc, v136, v138
    v_cmp_eq_u32 s[88:89], v137, v139
    v_cmp_eq_u32 s[90:91], v136, v139
    v_cmp_eq_u32 s[10:11], v137, v138
    v_lshrrev_b32 v104, 24, v104
    v_lshrrev_b32 v105, 24, v105
    v_lshrrev_b32 v106, 24, v106
    v_lshrrev_b32 v107, 24, v107
    s_or_b64 s[74:75], s[72:73], s[88:89]
    s_or_b64 s[78:79], s[76:77], s[88:89]
    s_or_b64 s[72:73], s[72:73], vcc
    s_or_b64 s[76:77], s[76:77], vcc
    s_or_b64 s[72:73], s[72:73], s[90:91]
    s_or_b64 s[74:75], s[74:75], s[10:11]
    s_or_b64 s[76:77], s[76:77], s[10:11]
    s_or_b64 s[78:79], s[78:79], s[90:91]
    v_cndmask_b32 v136, 0, v146, s[72:73]
    v_lshl_add_u32 v136, v104, 2, v136
    ds_add_rtn_u32 v112, v136, v184 offset:5120
    v_cndmask_b32 v137, 0, v146, s[74:75]
    v_lshl_add_u32 v137, v105, 2, v137
    ds_add_rtn_u32 v113, v137, v184 offset:5120
    v_cndmask_b32 v138, 0, v146, s[76:77]
    v_lshl_add_u32 v138, v106, 2, v138
    ds_add_rtn_u32 v114, v138, v184 offset:5120
    v_cndmask_b32 v139, 0, v146, s[78:79]
    v_lshl_add_u32 v139, v107, 2, v139
    ds_add_rtn_u32 v115, v139, v184 offset:5120
    s_waitcnt vmcnt(0)
    v_mad_i32_i24 v128, v104, s65, v128
    v_mul_u32_u24 v194, s66, v96
    v_lshl_or_b32 v96, v128, 18, v96
    v_and_b32 v128, 0xe0, v104
    v_mad_i32_i24 v194, v128, s100, v194
    v_and_or_b32 v194, v194, s67, v144
    v_mad_u32_u24 v128, v104, 40, s69
    v_or_b32 v96, v96, v194
    v_mad_i32_i24 v129, v105, s65, v129
    v_mul_u32_u24 v194, s66, v97
    v_lshl_or_b32 v97, v129, 18, v97
    v_and_b32 v129, 0xe0, v105
    v_mad_i32_i24 v194, v129, s100, v194
    v_and_or_b32 v194, v194, s67, v144
    v_mad_u32_u24 v129, v105, 40, s69
    v_or_b32 v97, v97, v194
    s_waitcnt lgkmcnt(3)
    s_mov_b64 exec, s[72:73]
    v_cmpx_le_u32 vcc, 132, v112
    ds_add_rtn_u32 v112, v136, v184 offset:4096
    s_waitcnt lgkmcnt(3)
    s_mov_b64 exec, s[74:75]
    v_cmpx_le_u32 vcc, 132, v113
    ds_add_rtn_u32 v113, v137, v184 offset:4096
    s_waitcnt lgkmcnt(3)
    s_mov_b64 exec, s[76:77]
    v_cmpx_le_u32 vcc, 132, v114
    ds_add_rtn_u32 v114, v138, v184 offset:4096
    s_waitcnt lgkmcnt(3)
    s_mov_b64 exec, s[78:79]
    v_cmpx_le_u32 vcc, 132, v115
    ds_add_rtn_u32 v115, v139, v184 offset:4096
    s_mov_b64 exec, -1
    v_mad_i32_i24 v130, v106, s65, v130
    v_mul_u32_u24 v194, s66, v98
    v_lshl_or_b32 v98, v130, 18, v98
    v_and_b32 v130, 0xe0, v106
    v_mad_i32_i24 v194, v130, s100, v194
    v_and_or_b32 v194, v194, s67, v144
    v_mad_u32_u24 v130, v106, 40, s69
    v_or_b32 v98, v98, v194
    v_mad_i32_i24 v131, v107, s65, v131
    v_mul_u32_u24 v194, s66, v99
    v_lshl_or_b32 v99, v131, 18, v99
    v_and_b32 v131, 0xe0, v107
    v_mad_i32_i24 v194, v131, s100, v194
    v_and_or_b32 v194, v194, s67, v144
    v_mad_u32_u24 v131, v107, 40, s69
    v_or_b32 v99, v99, v194
    s_waitcnt lgkmcnt(3)
    v_bfe_u32 v194, v112, 3, 5
    v_add_lshl_u32 v128, v194, v128, 2
    v_and_b32 v194, 3, v194
    v_mad_i32_i24 v194, v194, -3, v128
    v_cmpx_gt_u32 vcc, 792, v112
    ds_write_b32 v128, v96
    ds_write_b8 v194, v120 offset:12
    s_mov_b64 exec, -1
    s_waitcnt lgkmcnt(4)
    v_bfe_u32 v194, v113, 3, 5
    v_add_lshl_u32 v129, v194, v129, 2
    v_and_b32 v194, 3, v194
    v_mad_i32_i24 v194, v194, -3, v129
    v_cmpx_gt_u32 vcc, 792, v113
    ds_write_b32 v129, v97
    ds_write_b8 v194, v121 offset:12
    s_mov_b64 exec, -1
    s_waitcnt lgkmcnt(5)
    v_bfe_u32 v194, v114, 3, 5
    v_add_lshl_u32 v130, v194, v130, 2
    v_and_b32 v194, 3, v194
    v_mad_i32_i24 v194, v194, -3, v130
    v_cmpx_gt_u32 vcc, 792, v114
    ds_write_b32 v130, v98
    ds_write_b8 v194, v122 offset:12
    s_mov_b64 exec, -1
    s_waitcnt lgkmcnt(6)
    v_bfe_u32 v194, v115, 3, 5
    v_add_lshl_u32 v131, v194, v131, 2
    v_and_b32 v194, 3, v194
    v_mad_i32_i24 v194, v194, -3, v131
    v_cmpx_gt_u32 vcc, 792, v115
    ds_write_b32 v131, v99
    ds_write_b8 v194, v123 offset:12
    s_mov_b64 exec, -1
L_B1:
    s_cmp_ge_u32 s3, 2
    s_cbranch_scc1 L_NOC
    global_load_dwordx4 v[176:179], v232, s[28:29]
L_NOC:
    global_load_dwordx4 v[160:163], v232, s[26:27]
    global_load_dwordx4 v[164:167], v232, s[32:33]
    global_load_dwordx4 v[168:171], v232, s[24:25]
    global_load_dwordx4 v[172:175], v232, s[30:31]
    s_add_u32 s6, s6, 0x2020202
    v_lshlrev_b32 v186, v246, s6
    v_and_b32 v189, 4, v247
    v_mul_u32_u24 v189, 1212416, v189
    v_lshl_add_u32 v186, v189, 8, v186
    v_and_b32 v186, 0xfe000000, v186
    v_and_b32 v187, 7, v247
    v_mul_u32_u24 v187, 33, v187
    v_add_u32 v187, 792, v187
    v_lshlrev_b32 v222, 2, v223
    s_mov_b32 s64, 0x1000000
    s_waitcnt lgkmcnt(0)
    s_barrier
    ds_read_b128 v[192:195], v185 offset:5120
    ds_read_b32 v228, v222 offset:5120
    ds_read_b128 v[204:207], v221 offset:0
    ds_read_b32 v229, v222 offset:5376
    ds_read_b128 v[208:211], v221 offset:10240
    ds_read_b32 v230, v222 offset:5632
    ds_read_b128 v[212:215], v221 offset:20480
    ds_read_b32 v231, v222 offset:5888
    ds_read_b128 v[216:219], v221 offset:30720
    s_mov_b32 s80, 2105344
    s_mov_b32 s81, 4210688
    s_mov_b32 s82, 6316032
    s_waitcnt lgkmcnt(8)
    v_max3_u32 v188, v192, v193, v194
    v_max_u32 v188, v188, v195
    v_cmp_lt_u32 vcc, 1056, v188
    s_cbranch_vccnz L_POVF
L_POUT:
    s_waitcnt lgkmcnt(7)
    v_sub_u32 v228, v187, v228
    v_and_or_b32 v228, v228, s64, v186
    s_waitcnt lgkmcnt(6)
    v_or_b32 v207, v207, v228
    buffer_store_dwordx4 v[204:207], v220, s[56:59], 0 offen sc1
    s_waitcnt lgkmcnt(5)
    v_sub_u32 v229, v187, v229
    v_and_or_b32 v229, v229, s64, v186
    s_waitcnt lgkmcnt(4)
    v_or_b32 v211, v211, v229
    buffer_store_dwordx4 v[208:211], v220, s[56:59], s80 offen sc1
    s_waitcnt lgkmcnt(3)
    v_sub_u32 v230, v187, v230
    v_and_or_b32 v230, v230, s64, v186
    s_waitcnt lgkmcnt(2)
    v_or_b32 v215, v215, v230
    buffer_store_dwordx4 v[212:215], v220, s[56:59], s81 offen sc1
    s_waitcnt lgkmcnt(1)
    v_sub_u32 v231, v187, v231
    v_and_or_b32 v231, v231, s64, v186
    s_waitcnt lgkmcnt(0)
    v_or_b32 v219, v219, v231
    buffer_store_dwordx4 v[216:219], v220, s[56:59], s82 offen sc1
    s_mov_b32 s10, 0xbfb8aa3b
    s_mov_b32 s11, s10
    s_mov_b32 s64, 0x05040100
    s_mov_b32 s66, 0x07060302
    s_waitcnt vmcnt(4)
    v_perm_b32 v144, v170, v168, s64
    v_perm_b32 v145, v170, v168, s66
    v_perm_b32 v146, v171, v169, s64
    v_perm_b32 v147, v171, v169, s66
    v_add_u32 v148, 77824, v224
    ds_write2_b32 v148, v144, v145 offset0:0 offset1:8
    ds_write2_b32 v148, v146, v147 offset0:16 offset1:24
    v_lshlrev_b32 v128, 16, v160
    v_and_b32 v129, 0xffff0000, v160
    v_lshlrev_b32 v130, 16, v161
    v_and_b32 v131, 0xffff0000, v161
    v_lshlrev_b32 v132, 16, v162
    v_and_b32 v133, 0xffff0000, v162
    v_lshlrev_b32 v134, 16, v163
    v_and_b32 v135, 0xffff0000, v163
    v_pk_mul_f32 v[128:129], v[128:129], s[10:11]
    v_pk_mul_f32 v[130:131], v[130:131], s[10:11]
    v_pk_mul_f32 v[132:133], v[132:133], s[10:11]
    v_pk_mul_f32 v[134:135], v[134:135], s[10:11]
    v_cvt_pk_bf16_f32 v136, v128, v132
    v_cvt_pk_bf16_f32 v137, v129, v133
    v_cvt_pk_bf16_f32 v138, v130, v134
    v_cvt_pk_bf16_f32 v139, v131, v135
    ds_write2_b32 v224, v136, v137 offset0:0 offset1:8
    ds_write2_b32 v224, v138, v139 offset0:16 offset1:24
    v_perm_b32 v152, v166, v164, s64
    v_perm_b32 v153, v166, v164, s66
    v_perm_b32 v154, v167, v165, s64
    v_perm_b32 v155, v167, v165, s66
    v_add_u32 v156, 10240, v224
    ds_write2_b32 v156, v152, v153 offset0:0 offset1:8
    ds_write2_b32 v156, v154, v155 offset0:16 offset1:24
    v_perm_b32 v144, v174, v172, s64
    v_perm_b32 v145, v174, v172, s66
    v_perm_b32 v146, v175, v173, s64
    v_perm_b32 v147, v175, v173, s66
    v_add_u32 v148, 130176, v224
    ds_write2_b32 v148, v144, v145 offset0:0 offset1:8
    ds_write2_b32 v148, v146, v147 offset0:16 offset1:24
    s_cmp_ge_u32 s3, 2
    s_cbranch_scc1 L_NOWC
    v_lshlrev_b32 v128, 16, v176
    v_and_b32 v129, 0xffff0000, v176
    v_lshlrev_b32 v130, 16, v177
    v_and_b32 v131, 0xffff0000, v177
    v_lshlrev_b32 v132, 16, v178
    v_and_b32 v133, 0xffff0000, v178
    v_lshlrev_b32 v134, 16, v179
    v_and_b32 v135, 0xffff0000, v179
    v_pk_mul_f32 v[128:129], v[128:129], s[10:11]
    v_pk_mul_f32 v[130:131], v[130:131], s[10:11]
    v_pk_mul_f32 v[132:133], v[132:133], s[10:11]
    v_pk_mul_f32 v[134:135], v[134:135], s[10:11]
    v_cvt_pk_bf16_f32 v136, v128, v132
    v_cvt_pk_bf16_f32 v137, v129, v133
    v_cvt_pk_bf16_f32 v138, v130, v134
    v_cvt_pk_bf16_f32 v139, v131, v135
    v_add_u32 v140, 20480, v224
    ds_write2_b32 v140, v136, v137 offset0:0 offset1:8
    ds_write2_b32 v140, v138, v139 offset0:16 offset1:24
L_NOWC:
    s_mul_i32 s34, s5, 32896
    s_add_u32 s34, s34, 65536
    s_add_u32 s56, s38, s34
    s_addc_u32 s57, s39, 0
    s_mov_b32 s58, 32768
    s_mov_b32 s59, 0x20000
    s_add_u32 s34, s34, 8421376
    s_add_u32 s60, s38, s34
    s_addc_u32 s61, s39, 0
    s_mov_b32 s62, 32768
    s_mov_b32 s63, 0x20000
    s_movk_i32 s26, 0
    s_movk_i32 s27, 8192
    s_movk_i32 s28, 16384
    s_movk_i32 s29, 24576
    s_waitcnt lgkmcnt(0)
    s_barrier
    v_add_u32 v225, 13312, v225
    ds_read_b64_tr_b16 v[0:1], v225 offset:0
    ds_read_b64_tr_b16 v[2:3], v225 offset:1280
    ds_read_b64_tr_b16 v[4:5], v225 offset:5120
    ds_read_b64_tr_b16 v[6:7], v225 offset:6400
    ds_read_b64_tr_b16 v[8:9], v225 offset:32
    ds_read_b64_tr_b16 v[10:11], v225 offset:1312
    ds_read_b64_tr_b16 v[12:13], v225 offset:5152
    ds_read_b64_tr_b16 v[14:15], v225 offset:6432
    ds_read_b64_tr_b16 v[16:17], v225 offset:64
    ds_read_b64_tr_b16 v[18:19], v225 offset:1344
    ds_read_b64_tr_b16 v[20:21], v225 offset:5184
    ds_read_b64_tr_b16 v[22:23], v225 offset:6464
    ds_read_b64_tr_b16 v[24:25], v225 offset:96
    ds_read_b64_tr_b16 v[26:27], v225 offset:1376
    v_mov_b32 v64, 0x2000000
    v_mov_b32 v65, 0x2000000
    v_mov_b32 v66, 0x2000000
    v_mov_b32 v67, 0x2000000
    v_mov_b32 v68, 0xfffff
    v_mov_b32 v69, 0xfffff
    v_mov_b32 v70, 0xfffff
    v_mov_b32 v71, 0xfffff
    v_lshl_add_u32 v72, v247, 4, s12
    ds_write_b128 v72, v[64:67] offset:0
    ds_write_b128 v72, v[68:71] offset:18432
    ds_write_b128 v72, v[64:67] offset:1024
    ds_write_b128 v72, v[68:71] offset:19456
    ds_write_b128 v72, v[64:67] offset:1280
    ds_write_b128 v72, v[68:71] offset:19712
    ds_read_b64_tr_b16 v[28:29], v225 offset:5216
    ds_read_b64_tr_b16 v[30:31], v225 offset:6496
    ds_read_b64_tr_b16 v[32:33], v225 offset:10240
    ds_read_b64_tr_b16 v[34:35], v225 offset:11520
    ds_read_b64_tr_b16 v[36:37], v225 offset:15360
    ds_read_b64_tr_b16 v[38:39], v225 offset:16640
    ds_read_b64_tr_b16 v[40:41], v225 offset:10272
    ds_read_b64_tr_b16 v[42:43], v225 offset:11552
    ds_read_b64_tr_b16 v[44:45], v225 offset:15392
    ds_read_b64_tr_b16 v[46:47], v225 offset:16672
    v_mov_b32 v192, v225
    s_mov_b32 exec_lo, 0
    v_subrev_u32 v192, 2560, v225
    s_mov_b32 exec_lo, -1
    s_waitcnt lgkmcnt(4)
    ds_read_b64_tr_b16 v[48:49], v225 offset:10304
    ds_read_b64_tr_b16 v[50:51], v225 offset:11584
    ds_read_b64_tr_b16 v[52:53], v225 offset:15424
    ds_read_b64_tr_b16 v[54:55], v225 offset:16704
    ds_read_b64_tr_b16 v[56:57], v225 offset:10336
    ds_read_b64_tr_b16 v[58:59], v225 offset:11616
    ds_read_b64_tr_b16 v[60:61], v225 offset:15456
    ds_read_b64_tr_b16 v[62:63], v225 offset:16736
    ds_read_b64_tr_b16 v[80:81], v192 offset:20480
    ds_read_b64_tr_b16 v[82:83], v192 offset:21760
    ds_read_b64_tr_b16 v[84:85], v192 offset:20512
    ds_read_b64_tr_b16 v[86:87], v192 offset:21792
    ds_read_b64_tr_b16 v[88:89], v192 offset:20544
    ds_read_b64_tr_b16 v[90:91], v192 offset:21824
    ds_read_b64_tr_b16 v[92:93], v192 offset:20576
    ds_read_b64_tr_b16 v[94:95], v192 offset:21856
    v_add_u32 v225, 77824, v225
    v_and_b32 v241, 1, v247
    v_lshlrev_b32 v241, 4, v241
    v_mov_b32 v242, 0x3f80
    v_and_b32 v245, 16, v247
    v_and_b32 v194, 15, v247
    v_lshl_add_u32 v194, v194, 5, s14
    s_mov_b32 exec_hi, 0
    v_add_u32 v245, v245, v194
    s_mov_b32 exec_hi, -1
    v_and_b32 v194, 3, v247
    v_bfe_u32 v196, v247, 2, 2
    v_and_b32 v197, 48, v247
    v_lshl_add_u32 v198, v196, 7, v197
    v_mul_u32_u24 v244, 1056, v194
    v_add3_u32 v244, v244, v198, s13
    v_lshrrev_b32 v194, 3, v247
    v_lshl_add_u32 v248, v194, 4, s12
    s_add_u32 s10, s12, 18432
    v_lshrrev_b32 v194, 1, v247
    v_lshl_add_u32 v249, v194, 2, s10
    s_add_u32 s10, s10, 2
    v_lshrrev_b32 v194, 5, v247
    v_mul_i32_i24 v250, 0xffffb800, v194
    v_and_b32 v194, 15, v247
    v_lshl_add_u32 v250, v194, 2, v250
    v_add_u32 v250, s10, v250
    s_add_u32 s10, s12, 2
    v_and_b32 v194, 48, v247
    v_lshl_add_u32 v251, v194, 1, s10
    v_and_b32 v194, 12, v247
    v_add_u32 v251, v251, v194
    v_mul_u32_u24 v159, 3128, v223
    v_add_u32 v156, 0, v159
    v_add_u32 v157, 200192, v159
    v_add_u32 v158, 400384, v159
    v_add_u32 v159, 600576, v159
    s_mov_b32 s98, 0xf0f0f0f
    s_mov_b32 s99, 0xf0f0f0f
    v_mov_b32 v180, 0xfffff
    v_mov_b32 v176, 0
    v_add_lshl_u32 v191, v232, v243, 16
    v_add_u32 v152, 0x34000000, v191
    v_cndmask_b32 v152, 0, v152, s[98:99]
    v_add_u32 v153, 0x54000000, v191
    v_cndmask_b32 v153, 0, v153, s[98:99]
    v_add_u32 v154, 0x74000000, v191
    v_cndmask_b32 v154, 0, v154, s[98:99]
    v_add_u32 v155, 0x94000000, v191
    v_cndmask_b32 v155, 0, v155, s[98:99]
    v_mov_b32 v184, 4
    v_and_b32 v177, 31, v247
    v_add_lshl_u32 v179, v177, s7, 2
    v_lshrrev_b32 v191, 5, v247
    v_lshl_add_u32 v178, v191, 11, v179
    v_add_u32 v179, 153728, v179
    v_lshlrev_b32 v191, 2, v247
    v_subrev_u32 v191, s7, v191
    s_mov_b32 s10, 0x10000
    v_add_u32 v228, 0, v191
    v_and_or_b32 v228, v228, s10, 1
    v_add_u32 v229, 1, v191
    v_and_or_b32 v229, v229, s10, 1
    v_add_u32 v230, 2, v191
    v_and_or_b32 v230, v230, s10, 1
    v_add_u32 v231, 3, v191
    v_and_or_b32 v231, v231, s10, 1
    s_movk_i32 s18, 0xffc
    s_movk_i32 s20, 32
    s_mov_b32 s21, 0
    s_mov_b32 s100, 0
    s_mov_b32 s16, 0x1ffffff
    s_mov_b32 s17, 0xffff
    s_mul_i32 s10, s4, 49
    s_sub_i32 s22, s10, 6
    s_ashr_i32 s22, s22, 1
    s_add_i32 s23, s10, 7
    s_ashr_i32 s23, s23, 1
    s_add_i32 s24, s10, 43
    s_ashr_i32 s24, s24, 1
    s_add_i32 s25, s22, 31
    s_cmp_eq_u32 s4, 7
    s_cselect_b32 s24, 196, s24
    s_cselect_b32 s25, 196, s25
    s_sub_i32 s23, s23, s7
    s_sub_i32 s24, s24, s7
    s_sub_i32 s25, s25, s7
    s_waitcnt vmcnt(0)
    buffer_load_dwordx4 v[128:131], v232, s[56:59], s26 offen sc1
    buffer_load_dwordx4 v[132:135], v232, s[56:59], s27 offen sc1
    buffer_load_dwordx4 v[136:139], v232, s[56:59], s28 offen sc1
    buffer_load_dwordx4 v[140:143], v232, s[56:59], s29 offen sc1
    v_max3_u32 v188, v112, v113, v114
    v_max3_u32 v189, v115, v116, v117
    v_max3_u32 v188, v188, v118, v119
    v_max_u32 v188, v188, v189
    v_cmp_le_u32 vcc, 792, v188
    s_cbranch_vccz L_PEXTR
    v_mov_b32 v65, s6
    s_lshl_b32 s34, s2, 7
    s_add_u32 s34, s34, 8486912
    v_subrev_u32 v68, 792, v112
    v_cmpx_gt_u32 vcc, 264, v68
    s_cbranch_execz L_PE0
    v_mov_b32 v64, v96
    v_mov_b32 v66, v120
    v_bfe_u32 v68, v112, 5, 3
    v_lshlrev_b32 v68, 4, v68
    v_mad_u32_u24 v68, v104, s68, v68
    buffer_store_dwordx4 v[64:67], v68, s[52:55], s34 offen sc1
L_PE0:
    s_mov_b64 exec, -1
    v_subrev_u32 v68, 792, v113
    v_cmpx_gt_u32 vcc, 264, v68
    s_cbranch_execz L_PE1
    v_mov_b32 v64, v97
    v_mov_b32 v66, v121
    v_bfe_u32 v68, v113, 5, 3
    v_lshlrev_b32 v68, 4, v68
    v_mad_u32_u24 v68, v105, s68, v68
    buffer_store_dwordx4 v[64:67], v68, s[52:55], s34 offen sc1
L_PE1:
    s_mov_b64 exec, -1
    v_subrev_u32 v68, 792, v114
    v_cmpx_gt_u32 vcc, 264, v68
    s_cbranch_execz L_PE2
    v_mov_b32 v64, v98
    v_mov_b32 v66, v122
    v_bfe_u32 v68, v114, 5, 3
    v_lshlrev_b32 v68, 4, v68
    v_mad_u32_u24 v68, v106, s68, v68
    buffer_store_dwordx4 v[64:67], v68, s[52:55], s34 offen sc1
L_PE2:
    s_mov_b64 exec, -1
    v_subrev_u32 v68, 792, v115
    v_cmpx_gt_u32 vcc, 264, v68
    s_cbranch_execz L_PE3
    v_mov_b32 v64, v99
    v_mov_b32 v66, v123
    v_bfe_u32 v68, v115, 5, 3
    v_lshlrev_b32 v68, 4, v68
    v_mad_u32_u24 v68, v107, s68, v68
    buffer_store_dwordx4 v[64:67], v68, s[52:55], s34 offen sc1
L_PE3:
    s_mov_b64 exec, -1
    v_subrev_u32 v68, 792, v116
    v_cmpx_gt_u32 vcc, 264, v68
    s_cbranch_execz L_PE4
    v_mov_b32 v64, v100
    v_mov_b32 v66, v120
    v_bfe_u32 v68, v116, 5, 3
    v_lshlrev_b32 v68, 4, v68
    v_mad_u32_u24 v68, v108, s68, v68
    buffer_store_dwordx4 v[64:67], v68, s[52:55], s34 offen sc1
L_PE4:
    s_mov_b64 exec, -1
    v_subrev_u32 v68, 792, v117
    v_cmpx_gt_u32 vcc, 264, v68
    s_cbranch_execz L_PE5
    v_mov_b32 v64, v101
    v_mov_b32 v66, v121
    v_bfe_u32 v68, v117, 5, 3
    v_lshlrev_b32 v68, 4, v68
    v_mad_u32_u24 v68, v109, s68, v68
    buffer_store_dwordx4 v[64:67], v68, s[52:55], s34 offen sc1
L_PE5:
    s_mov_b64 exec, -1
    v_subrev_u32 v68, 792, v118
    v_cmpx_gt_u32 vcc, 264, v68
    s_cbranch_execz L_PE6
    v_mov_b32 v64, v102
    v_mov_b32 v66, v122
    v_bfe_u32 v68, v118, 5, 3
    v_lshlrev_b32 v68, 4, v68
    v_mad_u32_u24 v68, v110, s68, v68
    buffer_store_dwordx4 v[64:67], v68, s[52:55], s34 offen sc1
L_PE6:
    s_mov_b64 exec, -1
    v_subrev_u32 v68, 792, v119
    v_cmpx_gt_u32 vcc, 264, v68
    s_cbranch_execz L_PE7
    v_mov_b32 v64, v103
    v_mov_b32 v66, v123
    v_bfe_u32 v68, v119, 5, 3
    v_lshlrev_b32 v68, 4, v68
    v_mad_u32_u24 v68, v111, s68, v68
    buffer_store_dwordx4 v[64:67], v68, s[52:55], s34 offen sc1
L_PE7:
    s_mov_b64 exec, -1
L_PEXTR:
L_PW0:
    s_waitcnt vmcnt(3)
    v_xor_b32 v188, v131, v186
    v_and_b32_sdwa v96, v128, s18 dst_sel:DWORD dst_unused:UNUSED_PAD src0_sel:WORD_1 src1_sel:DWORD
    v_and_b32_sdwa v97, v129, s18 dst_sel:DWORD dst_unused:UNUSED_PAD src0_sel:WORD_1 src1_sel:DWORD
    v_and_b32_sdwa v98, v130, s18 dst_sel:DWORD dst_unused:UNUSED_PAD src0_sel:WORD_1 src1_sel:DWORD
    v_cmp_lt_u32 vcc, s16, v188
    v_cmp_ne_u32 s[64:65], 0, v128
    v_cmp_ne_u32 s[66:67], 0, v129
    v_cmp_ne_u32 s[68:69], 0, v130
    s_cbranch_vccnz L_RT0
    s_mov_b64 exec, s[64:65]
    ds_add_rtn_u32 v112, v96, v184 offset:1024
    s_mov_b64 exec, s[66:67]
    ds_add_rtn_u32 v113, v97, v184 offset:1024
    s_mov_b64 exec, s[68:69]
    ds_add_rtn_u32 v114, v98, v184 offset:1024
    s_mov_b64 exec, -1
    v_or_b32 v176, v176, v129
    v_add_u32_sdwa v204, v131, v156 dst_sel:DWORD dst_unused:UNUSED_PAD src0_sel:BYTE_0 src1_sel:DWORD
    v_lshrrev_b32 v189, 28, v128
    v_lshl_add_u32 v204, v189, 8, v204
    v_and_b32 v189, 60, v96
    v_and_b32 v128, 0xffff, v128
    v_lshl_or_b32 v128, v189, 19, v128
    v_cndmask_b32 v188, v180, v204, s[64:65]
    v_max_u32 v204, v204, v152
    v_add_u32_sdwa v205, v131, v156 dst_sel:DWORD dst_unused:UNUSED_PAD src0_sel:BYTE_1 src1_sel:DWORD
    v_lshrrev_b32 v189, 28, v129
    v_lshl_add_u32 v205, v189, 8, v205
    v_and_b32 v189, 60, v97
    v_and_b32 v129, 0xffff, v129
    v_lshl_or_b32 v129, v189, 19, v129
    v_mov_b32_dpp v190, v188 quad_perm:[2,2,3,3] row_mask:0xf bank_mask:0xf
    v_mov_b32_dpp v207, v188 quad_perm:[0,0,1,1] row_mask:0xf bank_mask:0xf
    v_add_u32_sdwa v206, v131, v156 dst_sel:DWORD dst_unused:UNUSED_PAD src0_sel:BYTE_2 src1_sel:DWORD
    v_lshrrev_b32 v189, 28, v130
    v_lshl_add_u32 v206, v189, 8, v206
    v_and_b32 v189, 60, v98
    v_and_b32 v130, 0xffff, v130
    v_lshl_or_b32 v130, v189, 19, v130
    v_mov_b32_dpp v207, v190 row_shr:4 row_mask:0xf bank_mask:0xa
L_PW1:
    s_waitcnt vmcnt(2)
    v_xor_b32 v188, v135, v186
    v_and_b32_sdwa v100, v132, s18 dst_sel:DWORD dst_unused:UNUSED_PAD src0_sel:WORD_1 src1_sel:DWORD
    v_and_b32_sdwa v101, v133, s18 dst_sel:DWORD dst_unused:UNUSED_PAD src0_sel:WORD_1 src1_sel:DWORD
    v_and_b32_sdwa v102, v134, s18 dst_sel:DWORD dst_unused:UNUSED_PAD src0_sel:WORD_1 src1_sel:DWORD
    v_cmp_lt_u32 vcc, s16, v188
    v_cmp_ne_u32 s[72:73], 0, v132
    v_cmp_ne_u32 s[74:75], 0, v133
    v_cmp_ne_u32 s[76:77], 0, v134
    s_cbranch_vccnz L_RT1
    s_mov_b64 exec, s[72:73]
    ds_add_rtn_u32 v116, v100, v184 offset:1024
    s_mov_b64 exec, s[74:75]
    ds_add_rtn_u32 v117, v101, v184 offset:1024
    s_mov_b64 exec, s[76:77]
    ds_add_rtn_u32 v118, v102, v184 offset:1024
    s_mov_b64 exec, -1
    v_or_b32 v176, v176, v133
    v_add_u32_sdwa v208, v135, v157 dst_sel:DWORD dst_unused:UNUSED_PAD src0_sel:BYTE_0 src1_sel:DWORD
    v_lshrrev_b32 v189, 28, v132
    v_lshl_add_u32 v208, v189, 8, v208
    v_and_b32 v189, 60, v100
    v_and_b32 v132, 0xffff, v132
    v_lshl_or_b32 v132, v189, 19, v132
    v_cndmask_b32 v188, v180, v208, s[72:73]
    v_max_u32 v208, v208, v153
    v_add_u32_sdwa v209, v135, v157 dst_sel:DWORD dst_unused:UNUSED_PAD src0_sel:BYTE_1 src1_sel:DWORD
    v_lshrrev_b32 v189, 28, v133
    v_lshl_add_u32 v209, v189, 8, v209
    v_and_b32 v189, 60, v101
    v_and_b32 v133, 0xffff, v133
    v_lshl_or_b32 v133, v189, 19, v133
    v_mov_b32_dpp v190, v188 quad_perm:[2,2,3,3] row_mask:0xf bank_mask:0xf
    v_mov_b32_dpp v211, v188 quad_perm:[0,0,1,1] row_mask:0xf bank_mask:0xf
    v_add_u32_sdwa v210, v135, v157 dst_sel:DWORD dst_unused:UNUSED_PAD src0_sel:BYTE_2 src1_sel:DWORD
    v_lshrrev_b32 v189, 28, v134
    v_lshl_add_u32 v210, v189, 8, v210
    v_and_b32 v189, 60, v102
    v_and_b32 v134, 0xffff, v134
    v_lshl_or_b32 v134, v189, 19, v134
    v_mov_b32_dpp v211, v190 row_shr:4 row_mask:0xf bank_mask:0xa
L_PW2:
    s_waitcnt vmcnt(1)
    v_xor_b32 v188, v139, v186
    v_and_b32_sdwa v104, v136, s18 dst_sel:DWORD dst_unused:UNUSED_PAD src0_sel:WORD_1 src1_sel:DWORD
    v_and_b32_sdwa v105, v137, s18 dst_sel:DWORD dst_unused:UNUSED_PAD src0_sel:WORD_1 src1_sel:DWORD
    v_and_b32_sdwa v106, v138, s18 dst_sel:DWORD dst_unused:UNUSED_PAD src0_sel:WORD_1 src1_sel:DWORD
    v_cmp_lt_u32 vcc, s16, v188
    v_cmp_ne_u32 s[80:81], 0, v136
    v_cmp_ne_u32 s[82:83], 0, v137
    v_cmp_ne_u32 s[84:85], 0, v138
    s_cbranch_vccnz L_RT2
    s_mov_b64 exec, s[80:81]
    ds_add_rtn_u32 v120, v104, v184 offset:1024
    s_mov_b64 exec, s[82:83]
    ds_add_rtn_u32 v121, v105, v184 offset:1024
    s_mov_b64 exec, s[84:85]
    ds_add_rtn_u32 v122, v106, v184 offset:1024
    s_mov_b64 exec, -1
    v_or_b32 v176, v176, v137
    v_add_u32_sdwa v212, v139, v158 dst_sel:DWORD dst_unused:UNUSED_PAD src0_sel:BYTE_0 src1_sel:DWORD
    v_lshrrev_b32 v189, 28, v136
    v_lshl_add_u32 v212, v189, 8, v212
    v_and_b32 v189, 60, v104
    v_and_b32 v136, 0xffff, v136
    v_lshl_or_b32 v136, v189, 19, v136
    v_cndmask_b32 v188, v180, v212, s[80:81]
    v_max_u32 v212, v212, v154
    v_add_u32_sdwa v213, v139, v158 dst_sel:DWORD dst_unused:UNUSED_PAD src0_sel:BYTE_1 src1_sel:DWORD
    v_lshrrev_b32 v189, 28, v137
    v_lshl_add_u32 v213, v189, 8, v213
    v_and_b32 v189, 60, v105
    v_and_b32 v137, 0xffff, v137
    v_lshl_or_b32 v137, v189, 19, v137
    v_mov_b32_dpp v190, v188 quad_perm:[2,2,3,3] row_mask:0xf bank_mask:0xf
    v_mov_b32_dpp v215, v188 quad_perm:[0,0,1,1] row_mask:0xf bank_mask:0xf
    v_add_u32_sdwa v214, v139, v158 dst_sel:DWORD dst_unused:UNUSED_PAD src0_sel:BYTE_2 src1_sel:DWORD
    v_lshrrev_b32 v189, 28, v138
    v_lshl_add_u32 v214, v189, 8, v214
    v_and_b32 v189, 60, v106
    v_and_b32 v138, 0xffff, v138
    v_lshl_or_b32 v138, v189, 19, v138
    v_mov_b32_dpp v215, v190 row_shr:4 row_mask:0xf bank_mask:0xa
L_PW3:
    s_waitcnt vmcnt(0)
    v_xor_b32 v188, v143, v186
    v_and_b32_sdwa v108, v140, s18 dst_sel:DWORD dst_unused:UNUSED_PAD src0_sel:WORD_1 src1_sel:DWORD
    v_and_b32_sdwa v109, v141, s18 dst_sel:DWORD dst_unused:UNUSED_PAD src0_sel:WORD_1 src1_sel:DWORD
    v_and_b32_sdwa v110, v142, s18 dst_sel:DWORD dst_unused:UNUSED_PAD src0_sel:WORD_1 src1_sel:DWORD
    v_cmp_lt_u32 vcc, s16, v188
    v_cmp_ne_u32 s[88:89], 0, v140
    v_cmp_ne_u32 s[90:91], 0, v141
    v_cmp_ne_u32 s[92:93], 0, v142
    s_cbranch_vccnz L_RT3
    s_mov_b64 exec, s[88:89]
    ds_add_rtn_u32 v124, v108, v184 offset:1024
    s_mov_b64 exec, s[90:91]
    ds_add_rtn_u32 v125, v109, v184 offset:1024
    s_mov_b64 exec, s[92:93]
    ds_add_rtn_u32 v126, v110, v184 offset:1024
    s_mov_b64 exec, -1
    v_or_b32 v176, v176, v141
    v_or3_b32 v190, v131, v135, v139
    v_or_b32 v190, v190, v143
    v_and_b32 v190, 0x1000000, v190
    v_cmp_ne_u32 vcc, 0, v190
    s_cbranch_vccz L_XT1R
    v_and_b32 v190, 0x1000000, v131
    v_cmp_ne_u32 s[70:71], 0, v190
    s_bcnt1_i32_b64 s10, s[70:71]
    s_lshl2_add_u32 s21, s10, s21
    v_and_b32 v190, 0x1000000, v135
    v_cmp_ne_u32 s[78:79], 0, v190
    s_bcnt1_i32_b64 s10, s[78:79]
    s_lshl2_add_u32 s21, s10, s21
    v_and_b32 v190, 0x1000000, v139
    v_cmp_ne_u32 s[86:87], 0, v190
    s_bcnt1_i32_b64 s10, s[86:87]
    s_lshl2_add_u32 s21, s10, s21
    v_and_b32 v190, 0x1000000, v143
    v_cmp_ne_u32 s[94:95], 0, v190
    s_bcnt1_i32_b64 s10, s[94:95]
    s_lshl2_add_u32 s21, s10, s21
    s_mov_b64 exec, s[70:71]
    s_cbranch_execz L_XLa0
    s_movk_i32 s10, 0
    buffer_load_dwordx4 v[64:67], v232, s[60:63], s10 offen sc1
L_XLa0:
    s_mov_b64 exec, s[78:79]
    s_cbranch_execz L_XLa1
    s_movk_i32 s10, 8192
    buffer_load_dwordx4 v[68:71], v232, s[60:63], s10 offen sc1
L_XLa1:
    s_mov_b64 exec, s[86:87]
    s_cbranch_execz L_XLa2
    s_movk_i32 s10, 16384
    buffer_load_dwordx4 v[72:75], v232, s[60:63], s10 offen sc1
L_XLa2:
    s_mov_b64 exec, s[94:95]
    s_cbranch_execz L_XLa3
    s_movk_i32 s10, 24576
    buffer_load_dwordx4 v[76:79], v232, s[60:63], s10 offen sc1
L_XLa3:
    s_mov_b64 exec, -1
    v_and_b32 v190, 0x10000, v176
    v_mov_b32 v191, 640
    v_cmpx_ne_u32 vcc, 0, v190
    ds_write_b32 v191, v184 offset:4
    s_mov_b64 exec, 1
    v_mov_b32 v190, s21
    ds_add_u32 v191, v190 offset:8
    s_mov_b64 exec, -1
L_XT1R:
    v_add_u32_sdwa v216, v143, v159 dst_sel:DWORD dst_unused:UNUSED_PAD src0_sel:BYTE_0 src1_sel:DWORD
    v_lshrrev_b32 v189, 28, v140
    v_lshl_add_u32 v216, v189, 8, v216
    v_and_b32 v189, 60, v108
    v_and_b32 v140, 0xffff, v140
    v_lshl_or_b32 v140, v189, 19, v140
    v_cndmask_b32 v188, v180, v216, s[88:89]
    v_max_u32 v216, v216, v155
    v_add_u32_sdwa v217, v143, v159 dst_sel:DWORD dst_unused:UNUSED_PAD src0_sel:BYTE_1 src1_sel:DWORD
    v_lshrrev_b32 v189, 28, v141
    v_lshl_add_u32 v217, v189, 8, v217
    v_and_b32 v189, 60, v109
    v_and_b32 v141, 0xffff, v141
    v_lshl_or_b32 v141, v189, 19, v141
    v_mov_b32_dpp v190, v188 quad_perm:[2,2,3,3] row_mask:0xf bank_mask:0xf
    v_mov_b32_dpp v219, v188 quad_perm:[0,0,1,1] row_mask:0xf bank_mask:0xf
    v_add_u32_sdwa v218, v143, v159 dst_sel:DWORD dst_unused:UNUSED_PAD src0_sel:BYTE_2 src1_sel:DWORD
    v_lshrrev_b32 v189, 28, v142
    v_lshl_add_u32 v218, v189, 8, v218
    v_mov_b32_dpp v219, v190 row_shr:4 row_mask:0xf bank_mask:0xa
    v_mov_b32 v197, 640
    s_cmp_eq_u32 s3, 6
    s_cselect_b32 exec_hi, 0, -1
    s_cmp_eq_u32 s3, 7
    s_cselect_b64 exec, 1, exec
    s_add_u32 m0, s101, 0
    s_nop 0
    buffer_load_dwordx4 v234, s[40:43], 0 offen offset:0 lds
    s_add_u32 m0, s101, 6560
    s_nop 0
    buffer_load_dwordx4 v234, s[40:43], 0 offen offset:128 lds
    s_add_u32 m0, s101, 13120
    s_nop 0
    buffer_load_dwordx4 v234, s[40:43], 0 offen offset:256 lds
    s_add_u32 m0, s101, 19680
    s_nop 0
    buffer_load_dwordx4 v234, s[40:43], 0 offen offset:384 lds
    s_mov_b64 exec, -1
    s_waitcnt lgkmcnt(0)
    s_barrier
    ds_read_u16 v198, v178 offset:1024
    ds_read_u16 v199, v178 offset:2048
    ds_read_b128 v[160:163], v185 offset:1024
    ds_read_b128 v[164:167], v185 offset:2048
    ds_read_b128 v[168:171], v185 offset:3072
    ds_read_b128 v[172:175], v185 offset:4096
    ds_read_b32 v236, v197 offset:8
    s_lshl_b32 m0, s3, 10
    v_mov_b32 v240, v207
    s_add_u32 m0, m0, 13312
    s_nop 0
    buffer_load_dwordx4 v[240:241], s[44:47], 0 idxen offen lds
    s_cmp_lg_u32 s2, 0
    s_cbranch_scc1 L_NOK
    v_mov_b32 v237, s6
    v_mov_b32 v238, 0
    buffer_store_dword v237, v238, s[52:55], 0 offen sc1
L_NOK:
    s_waitcnt lgkmcnt(5)
    v_lshl_or_b32 v198, v199, 16, v198
    v_mov_b32 v199, v198
    s_waitcnt lgkmcnt(0)
    v_add_u32_sdwa v188, v160, v164 dst_sel:DWORD dst_unused:UNUSED_PAD src0_sel:WORD_0 src1_sel:WORD_0
    v_add_u32_sdwa v192, v168, v172 dst_sel:DWORD dst_unused:UNUSED_PAD src0_sel:WORD_0 src1_sel:WORD_0
    v_add_u32_dpp v199, v199, v199 row_shr:1 row_mask:0xf bank_mask:0xf bound_ctrl:0
    v_add_u32_sdwa v189, v161, v165 dst_sel:DWORD dst_unused:UNUSED_PAD src0_sel:WORD_0 src1_sel:WORD_0
    v_add_u32_sdwa v193, v169, v173 dst_sel:DWORD dst_unused:UNUSED_PAD src0_sel:WORD_0 src1_sel:WORD_0
    v_add_u32_dpp v199, v199, v199 row_shr:2 row_mask:0xf bank_mask:0xf bound_ctrl:0
    v_add_u32_sdwa v190, v162, v166 dst_sel:DWORD dst_unused:UNUSED_PAD src0_sel:WORD_0 src1_sel:WORD_0
    v_add_u32_sdwa v194, v170, v174 dst_sel:DWORD dst_unused:UNUSED_PAD src0_sel:WORD_0 src1_sel:WORD_0
    v_add_u32_dpp v199, v199, v199 row_shr:4 row_mask:0xf bank_mask:0xf bound_ctrl:0
    v_add_u32_sdwa v191, v163, v167 dst_sel:DWORD dst_unused:UNUSED_PAD src0_sel:WORD_0 src1_sel:WORD_0
    v_add_u32_sdwa v195, v171, v175 dst_sel:DWORD dst_unused:UNUSED_PAD src0_sel:WORD_0 src1_sel:WORD_0
    v_add_u32_dpp v199, v199, v199 row_shr:8 row_mask:0xf bank_mask:0xf bound_ctrl:0
    v_add_u32 v188, v188, v192
    v_add_u32 v189, v189, v193
    v_add_u32_dpp v199, v199, v199 row_bcast:15 row_mask:0xa bank_mask:0xf
    v_add_u32 v190, v190, v194
    v_add_u32 v191, v191, v195
    v_mul_u32_u24 v196, v188, v228
    v_mad_u32_u24 v196, v189, v229, v196
    v_mad_u32_u24 v196, v190, v230, v196
    v_mad_u32_u24 v196, v191, v231, v196
    s_mov_b32 s96, -1
    s_mov_b32 s97, 0
    v_sub_u32 v200, v199, v198
    v_add_u32_sdwa v202, v199, v199 dst_sel:DWORD dst_unused:UNUSED_PAD src0_sel:WORD_0 src1_sel:WORD_1
    v_add_u32_dpp v196, v196, v196 row_shr:1 row_mask:0xf bank_mask:0xf bound_ctrl:0
    v_add_u32_sdwa v201, v200, v200 dst_sel:DWORD dst_unused:UNUSED_PAD src0_sel:WORD_0 src1_sel:WORD_1
    v_add_u32_sdwa v203, v198, v198 dst_sel:DWORD dst_unused:UNUSED_PAD src0_sel:WORD_0 src1_sel:WORD_1
    v_add_u32_dpp v196, v196, v196 row_shr:2 row_mask:0xf bank_mask:0xf bound_ctrl:0
    v_and_b32 v239, 60, v110
    v_readfirstlane_b32 s19, v236
    v_add_u32_dpp v196, v196, v196 row_shr:4 row_mask:0xf bank_mask:0xf bound_ctrl:0
    v_permlane32_swap_b32 v201, v202
    v_cndmask_b32 v203, 0, v203, s[96:97]
    v_add_u32_dpp v196, v196, v196 row_shr:8 row_mask:0xf bank_mask:0xf bound_ctrl:0
    v_add_u32 v201, v201, v202
    v_and_b32 v142, 0xffff, v142
    v_add_u32_dpp v196, v196, v196 row_bcast:15 row_mask:0xa bank_mask:0xf
    v_add_u32 v202, v201, v203
    v_lshl_or_b32 v142, v239, 19, v142
    v_add_u32_dpp v196, v196, v196 row_bcast:31 row_mask:0xc bank_mask:0xf
    v_sub_u32_sdwa v203, v202, v198 dst_sel:DWORD dst_unused:UNUSED_PAD src0_sel:DWORD src1_sel:WORD_1
    v_readlane_b32 s16, v196, 63
    s_lshl_b32 m0, s3, 10
    v_mov_b32 v240, v211
    s_add_u32 m0, m0, 21504
    s_nop 0
    buffer_load_dwordx4 v[240:241], s[44:47], 0 idxen offen lds
    s_bfe_u32 s10, s16, 0xe0002
    s_lshr_b32 s16, s16, 16
    s_lshr_b32 s11, s10, 1
    s_add_u32 s11, s11, 48
    s_and_b32 s11, s11, -128
    s_lshr_b32 s8, s4, 1
    s_mul_i32 s8, s8, s10
    s_sub_i32 s11, s11, 48
    s_sub_i32 s8, s8, s16
    s_add_i32 s11, s11, s8
    s_add_i32 s10, s10, s8
    s_bitcmp1_b32 s4, 0
    s_cselect_b32 s31, s11, s8
    s_cselect_b32 s10, s10, s11
    v_cmp_gt_i32 vcc, s31, v202
    v_cmp_gt_i32 s[34:35], s10, v202
    s_bcnt1_i32_b32 s22, vcc_lo
    s_bcnt1_i32_b32 s10, s34
    s_min_i32 s22, s22, s23
    s_max_i32 s10, s10, s24
    s_min_i32 s23, s10, s25
    v_readlane_b32 s16, v201, s22
    v_readlane_b32 s30, v201, s23
    s_add_u32 s8, s22, s7
    s_add_u32 s9, s23, s7
    s_add_u32 s10, s22, 32
    s_add_u32 s11, s23, 32
    v_readlane_b32 s26, v200, s22
    v_readlane_b32 s28, v200, s23
    v_readlane_b32 s27, v200, s10
    v_readlane_b32 s29, v200, s11
    s_sub_u32 s31, s30, s16
    s_add_u32 s10, s31, 255
    s_sub_i32 s11, s23, 16
    s_max_i32 s11, s11, s22
    v_readlane_b32 s11, v201, s11
    s_add_u32 vcc_lo, s31, 127
    s_and_b32 vcc_hi, vcc_lo, 127
    s_add_u32 vcc_hi, vcc_hi, s19
    s_cmp_lt_u32 vcc_hi, 55
    s_cselect_b32 vcc_lo, vcc_lo, s10
    s_sub_u32 s11, s11, s16
    s_add_u32 s11, s11, s19
    s_lshl_b32 s11, s11, 1
    s_and_b32 vcc_lo, vcc_lo, -256
    s_cmp_le_u32 s11, vcc_lo
    s_cselect_b32 s10, vcc_lo, s10
    s_lshr_b32 s10, s10, 8
    s_lshl_b32 s10, s10, 7
    s_sub_u32 s10, s10, s19
    s_max_i32 s10, s10, 0
    s_add_u32 s16, s16, s10
    s_add_u32 s10, s22, 16
    s_min_u32 s10, s10, s23
    s_sub_i32 s11, s23, 16
    v_cmp_ge_u32 s[34:35], s16, v203
    v_cmp_ge_u32 s[36:37], s16, v202
    v_cmp_gt_i32 vcc, s10, v177
    v_cmp_gt_i32 s[10:11], s11, v177
    v_cmp_le_u32 s[32:33], s22, v177
    v_cmp_gt_u32 s[96:97], s23, v177
    s_and_b64 s[34:35], s[34:35], vcc
    s_and_b64 s[36:37], s[36:37], vcc
    s_or_b64 s[34:35], s[34:35], s[10:11]
    s_or_b64 s[36:37], s[36:37], s[10:11]
    s_bcnt1_i32_b32 s24, s34
    s_bcnt1_i32_b32 s10, s36
    s_bcnt1_i32_b32 s11, s35
    s_bcnt1_i32_b32 s25, s37
    v_readlane_b32 s22, v200, s24
    v_readlane_b32 s10, v200, s10
    s_add_u32 s11, s11, 32
    s_add_u32 s16, s25, 32
    v_readlane_b32 s23, v200, s11
    v_readlane_b32 s11, v200, s16
    v_mov_b32 v188, s17
    v_cndmask_b32 v189, 0, v188, s[34:35]
    v_cndmask_b32 v188, 0, v188, s[36:37]
    s_and_b64 s[32:33], s[32:33], s[96:97]
    s_pack_lh_b32_b16 s22, s22, s10
    s_pack_lh_b32_b16 s23, s23, s11
    v_lshl_or_b32 v188, v188, 16, v189
    s_sub_u32 s16, s12, 37888
    s_pack_ll_b32_b16 s16, s16, s16
    s_sub_u32 s10, s22, s26
    s_sub_u32 s11, s23, s27
    s_mul_i32 s10, s10, 0x10001
    s_lshl_b32 vcc_lo, s10, 16
    s_pack_hh_b32_b16 s10, s10, s10
    s_lshl_b32 vcc_hi, s11, 16
    s_add_u32 vcc_hi, vcc_hi, s10
    s_add_u32 s96, vcc_hi, s11
    s_lshr_b32 s96, s96, 16
    s_sub_u32 s31, s31, s96
    s_cmp_gt_u32 s31, s96
    s_cselect_b32 s97, 0x4800480, 0
    s_add_u32 s16, s16, s97
    s_sub_u32 s10, s16, s26
    s_sub_u32 s11, s16, s27
    s_add_u32 s10, s10, vcc_lo
    s_add_u32 s11, s11, vcc_hi
    v_mov_b32 v192, s10
    v_mov_b32 v193, s11
    s_add_u32 s16, s16, 0x4800480
    s_sub_u32 s16, s16, s97
    s_sub_u32 s16, s16, s97
    s_sub_u32 s10, s28, s22
    s_sub_u32 s11, s29, s23
    s_mul_i32 s10, s10, 0x10001
    s_lshl_b32 vcc_lo, s10, 16
    s_pack_hh_b32_b16 s10, s10, s10
    s_lshl_b32 vcc_hi, s11, 16
    s_add_u32 vcc_hi, vcc_hi, s10
    s_sub_u32 s10, s16, s22
    s_sub_u32 s11, s16, s23
    s_add_u32 s10, s10, vcc_lo
    s_add_u32 s11, s11, vcc_hi
    v_mov_b32 v194, s10
    v_mov_b32 v195, s11
    v_bfi_b32 v192, v188, v192, v194
    v_bfi_b32 v193, v188, v193, v195
    s_mov_b32 exec_hi, 0
    v_mov_b32 v193, v192
    s_mov_b64 exec, s[32:33]
    v_add_u32 v200, v200, v193
    s_bfe_u32 s10, s97, 0x10007
    s_lshl1_add_u32 s10, s4, s10
    s_lshl_b32 s10, s10, 2
    v_cndmask_b32 v188, 4, 0, s[34:35]
    ds_write_b16 v178, v200 offset:1026
    ds_write_b16_d16_hi v178, v200 offset:2050
    s_mov_b32 exec_hi, 0
    v_xor_b32 v188, s10, v188
    ds_write_b32 v179, v188
    s_mov_b64 exec, -1
    s_min_u32 s10, s31, s96
    s_max_u32 s96, s31, s96
    s_mov_b32 s31, s10
    s_add_u32 s10, s96, s19
    s_mul_i32 s11, s30, 9216
    s_lshr_b32 s11, s11, 16
    s_max_u32 s10, s10, s11
    s_cmp_lt_u32 s10, 1152
    s_cbranch_scc1 L_LFIT
    ds_write_b32 v197, v184
L_LFIT:
    s_cmp_eq_u32 s19, 0
    s_cbranch_scc1 L_XCNR
    s_sub_u32 s10, s12, 37888
    s_add_u32 s11, s10, s96
    v_mov_b32 v188, s11
    s_add_u32 s11, s10, s31
    s_add_u32 s11, s11, 1152
    v_mov_b32 v189, s11
    s_lshl_b32 s10, s4, 3
    v_mov_b32 v190, s10
    ds_write_b64 v190, v[188:189] offset:576
L_XCNR:
    s_lshl_b32 m0, s3, 10
    v_mov_b32 v240, v215
    s_add_u32 m0, m0, 29696
    s_nop 0
    buffer_load_dwordx4 v[240:241], s[44:47], 0 idxen offen lds
    s_waitcnt lgkmcnt(0)
    s_barrier
    ds_read_b64 v[202:203], v197
    ds_read_u16 v96, v96 offset:1026
    ds_read_u16 v97, v97 offset:1026
    ds_read_u16 v98, v98 offset:1026
    ds_read_u16 v100, v100 offset:1026
    ds_read_u16 v101, v101 offset:1026
    ds_read_u16 v102, v102 offset:1026
    ds_read_u16 v104, v104 offset:1026
    ds_read_u16 v105, v105 offset:1026
    ds_read_u16 v106, v106 offset:1026
    ds_read_u16 v108, v108 offset:1026
    ds_read_u16 v109, v109 offset:1026
    ds_read_u16 v110, v110 offset:1026
    s_lshl_b32 m0, s3, 10
    v_mov_b32 v240, v219
    s_add_u32 m0, m0, 37888
    s_nop 0
    buffer_load_dwordx4 v[240:241], s[44:47], 0 idxen offen lds
    s_add_u32 s24, s24, s7
    s_add_u32 s11, s25, s7
    s_and_b32 s10, s11, 15
    s_cmp_lt_u32 s11, s24
    s_cselect_b32 s25, s10, 16
    s_cmp_lg_u32 s97, 0
    s_cselect_b32 s23, s8, s11
    s_cselect_b32 s7, s8, s24
    s_cselect_b32 s8, s11, s8
    s_cselect_b32 s24, s9, s24
    s_cselect_b32 s9, s11, s9
    s_min_u32 s22, s8, 192
    s_min_u32 s23, s23, 192
    s_mov_b32 s30, s19
    s_waitcnt lgkmcnt(12)
    v_cmp_ne_u32 vcc, 0, v202
    v_readfirstlane_b32 s19, v203
    s_cbranch_vccnz L_OVF
    s_waitcnt lgkmcnt(9)
    s_mov_b64 exec, s[64:65]
    v_add_u32 v96, v96, v112
    ds_write2st64_b32 v96, v128, v204 offset0:148 offset1:220
    s_mov_b64 exec, s[66:67]
    v_add_u32 v97, v97, v113
    ds_write2st64_b32 v97, v129, v205 offset0:148 offset1:220
    s_mov_b64 exec, s[68:69]
    v_add_u32 v98, v98, v114
    ds_write2st64_b32 v98, v130, v206 offset0:148 offset1:220
    s_waitcnt lgkmcnt(9)
    s_mov_b64 exec, s[72:73]
    v_add_u32 v100, v100, v116
    ds_write2st64_b32 v100, v132, v208 offset0:148 offset1:220
    s_mov_b64 exec, s[74:75]
    v_add_u32 v101, v101, v117
    ds_write2st64_b32 v101, v133, v209 offset0:148 offset1:220
    s_mov_b64 exec, s[76:77]
    v_add_u32 v102, v102, v118
    ds_write2st64_b32 v102, v134, v210 offset0:148 offset1:220
    s_waitcnt lgkmcnt(9)
    s_mov_b64 exec, s[80:81]
    v_add_u32 v104, v104, v120
    ds_write2st64_b32 v104, v136, v212 offset0:148 offset1:220
    s_mov_b64 exec, s[82:83]
    v_add_u32 v105, v105, v121
    ds_write2st64_b32 v105, v137, v213 offset0:148 offset1:220
    s_mov_b64 exec, s[84:85]
    v_add_u32 v106, v106, v122
    ds_write2st64_b32 v106, v138, v214 offset0:148 offset1:220
    s_waitcnt lgkmcnt(9)
    s_mov_b64 exec, s[88:89]
    v_add_u32 v108, v108, v124
    ds_write2st64_b32 v108, v140, v216 offset0:148 offset1:220
    s_mov_b64 exec, s[90:91]
    v_add_u32 v109, v109, v125
    ds_write2st64_b32 v109, v141, v217 offset0:148 offset1:220
    s_mov_b64 exec, s[92:93]
    v_add_u32 v110, v110, v126
    ds_write2st64_b32 v110, v142, v218 offset0:148 offset1:220
    s_mov_b64 exec, -1
    s_add_u32 s10, s96, 127
    s_lshr_b32 s10, s10, 7
    s_lshl1_add_u32 s10, s10, -1
    s_add_u32 s11, s31, 127
    s_lshr_b32 s11, s11, 6
    s_and_b32 s11, s11, -2
    s_max_i32 s17, s10, s11
    s_cselect_b32 s10, s96, s31
    s_sub_u32 s10, s10, 1
    s_andn2_b32 s99, 64, s10
L_CA:
    ds_read_b64_tr_b16 v[96:97], v225 offset:0
    ds_read_b64_tr_b16 v[98:99], v225 offset:1280
    ds_read_b64_tr_b16 v[100:101], v225 offset:5120
    ds_read_b64_tr_b16 v[102:103], v225 offset:6400
    ds_read_b64_tr_b16 v[104:105], v225 offset:32
    ds_read_b64_tr_b16 v[106:107], v225 offset:1312
    ds_read_b64_tr_b16 v[108:109], v225 offset:5152
    ds_read_b64_tr_b16 v[110:111], v225 offset:6432
    ds_read_b64_tr_b16 v[112:113], v225 offset:64
    ds_read_b64_tr_b16 v[114:115], v225 offset:1344
    ds_read_b64_tr_b16 v[116:117], v225 offset:5184
    ds_read_b64_tr_b16 v[118:119], v225 offset:6464
    ds_read_b64_tr_b16 v[120:121], v225 offset:96
    ds_read_b64_tr_b16 v[122:123], v225 offset:1376
    ds_read_b64_tr_b16 v[124:125], v225 offset:5216
    ds_read_b64_tr_b16 v[126:127], v225 offset:6496
    s_cmp_eq_u32 s21, 0
    s_cbranch_scc1 L_XT2R
    s_waitcnt vmcnt(8)
L_XT2:
    s_mov_b64 s[34:35], 0
    v_cmp_ne_u32 vcc, s6, v65
    s_and_b64 vcc, vcc, s[70:71]
    s_or_b64 s[34:35], s[34:35], vcc
    v_cmp_ne_u32 vcc, s6, v69
    s_and_b64 vcc, vcc, s[78:79]
    s_or_b64 s[34:35], s[34:35], vcc
    v_cmp_ne_u32 vcc, s6, v73
    s_and_b64 vcc, vcc, s[86:87]
    s_or_b64 s[34:35], s[34:35], vcc
    v_cmp_ne_u32 vcc, s6, v77
    s_and_b64 vcc, vcc, s[94:95]
    s_or_b64 s[34:35], s[34:35], vcc
    s_cbranch_scc1 L_XT2B
    s_cmp_eq_u32 s20, 0
    s_cbranch_scc1 L_XT2R
    s_mov_b64 exec, s[70:71]
    s_cbranch_execz L_XS0
    v_bfe_u32 v65, v64, 18, 8
    v_lshlrev_b32 v65, 2, v65
    v_add_u32 v67, 153728, v65
    ds_read_b32 v67, v67
    v_add_u32_sdwa v66, v66, v156 dst_sel:DWORD dst_unused:UNUSED_PAD src0_sel:BYTE_0 src1_sel:DWORD
    v_lshrrev_b32 v189, 28, v64
    v_lshl_add_u32 v66, v189, 8, v66
    v_and_b32 v189, 60, v65
    v_and_b32 v64, 0xffff, v64
    v_lshl_or_b32 v64, v189, 19, v64
    s_waitcnt lgkmcnt(0)
    ds_add_rtn_u32 v67, v67, v184 offset:576
    s_waitcnt lgkmcnt(0)
    ds_write2st64_b32 v67, v64, v66 offset0:148 offset1:220
L_XS0:
    s_mov_b64 exec, s[78:79]
    s_cbranch_execz L_XS1
    v_bfe_u32 v69, v68, 18, 8
    v_lshlrev_b32 v69, 2, v69
    v_add_u32 v71, 153728, v69
    ds_read_b32 v71, v71
    v_add_u32_sdwa v70, v70, v157 dst_sel:DWORD dst_unused:UNUSED_PAD src0_sel:BYTE_0 src1_sel:DWORD
    v_lshrrev_b32 v189, 28, v68
    v_lshl_add_u32 v70, v189, 8, v70
    v_and_b32 v189, 60, v69
    v_and_b32 v68, 0xffff, v68
    v_lshl_or_b32 v68, v189, 19, v68
    s_waitcnt lgkmcnt(0)
    ds_add_rtn_u32 v71, v71, v184 offset:576
    s_waitcnt lgkmcnt(0)
    ds_write2st64_b32 v71, v68, v70 offset0:148 offset1:220
L_XS1:
    s_mov_b64 exec, s[86:87]
    s_cbranch_execz L_XS2
    v_bfe_u32 v73, v72, 18, 8
    v_lshlrev_b32 v73, 2, v73
    v_add_u32 v75, 153728, v73
    ds_read_b32 v75, v75
    v_add_u32_sdwa v74, v74, v158 dst_sel:DWORD dst_unused:UNUSED_PAD src0_sel:BYTE_0 src1_sel:DWORD
    v_lshrrev_b32 v189, 28, v72
    v_lshl_add_u32 v74, v189, 8, v74
    v_and_b32 v189, 60, v73
    v_and_b32 v72, 0xffff, v72
    v_lshl_or_b32 v72, v189, 19, v72
    s_waitcnt lgkmcnt(0)
    ds_add_rtn_u32 v75, v75, v184 offset:576
    s_waitcnt lgkmcnt(0)
    ds_write2st64_b32 v75, v72, v74 offset0:148 offset1:220
L_XS2:
    s_mov_b64 exec, s[94:95]
    s_cbranch_execz L_XS3
    v_bfe_u32 v77, v76, 18, 8
    v_lshlrev_b32 v77, 2, v77
    v_add_u32 v79, 153728, v77
    ds_read_b32 v79, v79
    v_add_u32_sdwa v78, v78, v159 dst_sel:DWORD dst_unused:UNUSED_PAD src0_sel:BYTE_0 src1_sel:DWORD
    v_lshrrev_b32 v189, 28, v76
    v_lshl_add_u32 v78, v189, 8, v78
    v_and_b32 v189, 60, v77
    v_and_b32 v76, 0xffff, v76
    v_lshl_or_b32 v76, v189, 19, v76
    s_waitcnt lgkmcnt(0)
    ds_add_rtn_u32 v79, v79, v184 offset:576
    s_waitcnt lgkmcnt(0)
    ds_write2st64_b32 v79, v76, v78 offset0:148 offset1:220
L_XS3:
    s_mov_b64 exec, -1
L_XT2R:
    s_lshl_b32 s34, s22, 5
    s_lshl_b32 s35, s23, 5
    s_mov_b32 vcc_lo, 0xff00ff00
    s_mov_b32 vcc_hi, 0xff00ff00
    v_mov_b32 v176, s35
    v_mov_b32 v177, s34
    v_cndmask_b32 v176, v176, v177, vcc
    v_and_b32 v177, 4, v247
    v_lshlrev_b32 v177, 6, v177
    v_lshl_add_u32 v177, v246, 2, v177
    v_sub_u32 v177, v177, v176
    v_and_b32 v178, 48, v247
    s_movk_i32 s34, 832
    v_mad_u32_u24 v178, v246, s34, v178
    s_mov_b32 s34, 116736
    v_add3_u32 v178, v178, v176, s34
    v_and_b32 v176, 0x1ff, v177
    v_add_u32 v176, v176, v178
    v_add_u32 v177, 0x80, v177
    v_and_b32 v177, 0x1ff, v177
    v_add_u32 v177, v177, v178
    v_mov_b64 v[184:185], 0
    v_mov_b64 v[186:187], 0
    v_lshrrev_b32 v188, 2, v247
    v_and_b32 v188, 12, v188
    v_subrev_u32 v188, s25, v188
    v_mov_b32 v189, 0x358637bd
    v_mfma_f32_32x32x16_bf16 v[144:159], v[184:187], v[184:187], 0
    v_cmp_ne_u32 s[80:81], 0, v188
    v_cmp_ne_u32 s[82:83], -1, v188
    v_cmp_ne_u32 s[84:85], -2, v188
    v_cmp_ne_u32 s[86:87], -3, v188
    v_cndmask_b32 v128, 0, v189, s[80:81]
    v_cndmask_b32 v129, 0, v189, s[82:83]
    v_cndmask_b32 v130, 0, v189, s[84:85]
    v_cndmask_b32 v131, 0, v189, s[86:87]
    v_mov_b64 v[132:133], v[128:129]
    v_mov_b64 v[134:135], v[130:131]
    v_mov_b64 v[136:137], v[128:129]
    v_mov_b64 v[138:139], v[130:131]
    v_mov_b64 v[140:141], v[128:129]
    v_mov_b64 v[142:143], v[130:131]
    s_cmp_ge_u32 s3, 4
    s_cbranch_scc1 L_EP0
    s_lshl_b32 s72, s4, 7
    s_add_u32 s72, s72, 157824
    v_mov_b32 v190, s22
    s_mov_b32 exec_lo, 0xffff0000
    v_mov_b32 v190, s23
    s_mov_b32 exec_lo, -1
    s_mov_b32 exec_hi, 0
    v_sub_u32 v191, v247, v190
    v_and_b32 v191, 15, v191
    v_add_lshl_u32 v191, v191, v190, 5
    v_lshl_add_u32 v190, v247, 2, s72
    ds_write_b32 v190, v191
    s_mov_b32 exec_hi, -1
    s_mul_i32 s10, s5, 196
    s_add_u32 s11, s10, s7
    s_add_u32 s62, s10, s9
    s_min_u32 s11, s11, 50000
    s_min_u32 s62, s62, 50000
    s_sub_u32 s62, s62, s11
    s_lshl_b32 s11, s11, 7
    s_lshl_b32 s62, s62, 7
    s_add_u32 s60, s48, s11
    s_addc_u32 s61, s49, 0
    s_mul_i32 s74, s7, -128
    s_add_u32 s11, s10, s8
    s_add_u32 s50, s10, s24
    s_min_u32 s11, s11, 50000
    s_min_u32 s50, s50, 50000
    s_sub_u32 s50, s50, s11
    s_lshl_b32 s11, s11, 7
    s_lshl_b32 s50, s50, 7
    s_add_u32 s48, s48, s11
    s_addc_u32 s49, s49, 0
    s_mul_i32 s73, s8, -128
    s_and_b32 s10, s25, 12
    s_lshl_b32 s10, s10, 2
    s_bfm_b64 s[76:77], 16, s10
L_EP0:
    s_waitcnt vmcnt(0) lgkmcnt(0)
    s_barrier
    s_mov_b32 s10, 0x358637bd
    ds_read_b128 v[236:239], v248
    ds_read_b32 v240, v249
    ds_read_b128 v[160:163], v176 offset:0
    ds_read_b128 v[164:167], v176 offset:64
    ds_read_b128 v[168:171], v177 offset:0
    ds_read_b128 v[172:175], v177 offset:64
    s_waitcnt lgkmcnt(4)
    s_cmp_ge_u32 s3, 4
    s_cbranch_scc1 L_LATE0
    s_add_u32 m0, s13, 0
    v_mad_u32_u16 v236, v236, s15, v243
    buffer_load_dwordx4 v236, s[40:43], 0 offen lds
    s_add_u32 m0, s13, 1056
    v_mad_u32_u16 v237, v237, s15, v243
    buffer_load_dwordx4 v237, s[40:43], 0 offen lds
    s_add_u32 m0, s13, 2112
    v_mad_u32_u16 v238, v238, s15, v243
    buffer_load_dwordx4 v238, s[40:43], 0 offen lds
    s_add_u32 m0, s13, 3168
    v_mad_u32_u16 v239, v239, s15, v243
    buffer_load_dwordx4 v239, s[40:43], 0 offen lds
    s_mov_b32 m0, s14
    s_nop 0
    buffer_load_dwordx4 v[240:241], s[44:47], 0 idxen offen lds
L_LATE0:
    s_mov_b32 s34, 0xbfb8aa3b
    s_mov_b32 s35, s34
    s_waitcnt lgkmcnt(3)
    v_mfma_f32_16x16x32_bf16 v[204:207], v[160:163], v[96:99], 0
    v_mfma_f32_16x16x32_bf16 v[212:215], v[160:163], v[104:107], 0
    v_mfma_f32_16x16x32_bf16 v[220:223], v[160:163], v[112:115], 0
    v_mfma_f32_16x16x32_bf16 v[228:231], v[160:163], v[120:123], 0
    s_waitcnt lgkmcnt(2)
    v_mfma_f32_16x16x32_bf16 v[204:207], v[164:167], v[100:103], v[204:207]
    v_mfma_f32_16x16x32_bf16 v[212:215], v[164:167], v[108:111], v[212:215]
    v_mfma_f32_16x16x32_bf16 v[220:223], v[164:167], v[116:119], v[220:223]
    v_mfma_f32_16x16x32_bf16 v[228:231], v[164:167], v[124:127], v[228:231]
    s_waitcnt lgkmcnt(1)
    v_mfma_f32_16x16x32_bf16 v[208:211], v[168:171], v[96:99], 0
    v_mfma_f32_16x16x32_bf16 v[216:219], v[168:171], v[104:107], 0
    v_mfma_f32_16x16x32_bf16 v[224:227], v[168:171], v[112:115], 0
    v_mfma_f32_16x16x32_bf16 v[232:235], v[168:171], v[120:123], 0
    s_waitcnt lgkmcnt(0)
    v_mfma_f32_16x16x32_bf16 v[208:211], v[172:175], v[100:103], v[208:211]
    v_mfma_f32_16x16x32_bf16 v[216:219], v[172:175], v[108:111], v[216:219]
    v_mfma_f32_16x16x32_bf16 v[224:227], v[172:175], v[116:119], v[224:227]
    v_mfma_f32_16x16x32_bf16 v[232:235], v[172:175], v[124:127], v[232:235]
    s_mov_b32 s11, s10
    v_mov_b64 v[96:97], s[10:11]
    v_mov_b64 v[98:99], s[10:11]
    v_mov_b64 v[100:101], s[10:11]
    v_mov_b64 v[102:103], s[10:11]
    v_mov_b64 v[104:105], s[10:11]
    v_mov_b64 v[106:107], s[10:11]
    v_mov_b64 v[108:109], s[10:11]
    v_mov_b64 v[110:111], s[10:11]
    v_pk_mul_f32 v[204:205], v[204:205], s[34:35]
    v_pk_mul_f32 v[206:207], v[206:207], s[34:35]
    v_pk_mul_f32 v[208:209], v[208:209], s[34:35]
    v_pk_mul_f32 v[210:211], v[210:211], s[34:35]
    v_pk_mul_f32 v[212:213], v[212:213], s[34:35]
    v_pk_mul_f32 v[214:215], v[214:215], s[34:35]
    v_pk_mul_f32 v[216:217], v[216:217], s[34:35]
    v_pk_mul_f32 v[218:219], v[218:219], s[34:35]
    v_pk_mul_f32 v[220:221], v[220:221], s[34:35]
    v_pk_mul_f32 v[222:223], v[222:223], s[34:35]
    v_pk_mul_f32 v[224:225], v[224:225], s[34:35]
    v_pk_mul_f32 v[226:227], v[226:227], s[34:35]
    v_pk_mul_f32 v[228:229], v[228:229], s[34:35]
    v_pk_mul_f32 v[230:231], v[230:231], s[34:35]
    v_pk_mul_f32 v[232:233], v[232:233], s[34:35]
    v_pk_mul_f32 v[234:235], v[234:235], s[34:35]
    v_mfma_f32_32x32x16_bf16 v[112:127], v[184:187], v[184:187], 0
    v_cvt_pk_bf16_f32 v64, v204, v205
    v_cvt_pk_bf16_f32 v65, v206, v207
    v_cvt_pk_bf16_f32 v66, v208, v209
    v_cvt_pk_bf16_f32 v67, v210, v211
    v_cvt_pk_bf16_f32 v68, v212, v213
    v_cvt_pk_bf16_f32 v69, v214, v215
    v_cvt_pk_bf16_f32 v70, v216, v217
    v_cvt_pk_bf16_f32 v71, v218, v219
    v_cvt_pk_bf16_f32 v72, v220, v221
    v_cvt_pk_bf16_f32 v73, v222, v223
    v_cvt_pk_bf16_f32 v74, v224, v225
    v_cvt_pk_bf16_f32 v75, v226, v227
    v_cvt_pk_bf16_f32 v76, v228, v229
    v_cvt_pk_bf16_f32 v77, v230, v231
    v_cvt_pk_bf16_f32 v78, v232, v233
    v_cvt_pk_bf16_f32 v79, v234, v235
    v_permlane32_swap_b32 v80, v64
    v_permlane32_swap_b32 v81, v65
    v_permlane32_swap_b32 v82, v66
    v_permlane32_swap_b32 v83, v67
    v_permlane32_swap_b32 v84, v68
    v_permlane32_swap_b32 v85, v69
    v_permlane32_swap_b32 v86, v70
    v_permlane32_swap_b32 v87, v71
    v_permlane32_swap_b32 v88, v72
    v_permlane32_swap_b32 v89, v73
    v_permlane32_swap_b32 v90, v74
    v_permlane32_swap_b32 v91, v75
    v_permlane32_swap_b32 v92, v76
    v_permlane32_swap_b32 v93, v77
    v_permlane32_swap_b32 v94, v78
    v_permlane32_swap_b32 v95, v79
    s_mov_b32 s26, -1
    s_mov_b64 s[32:33], 0
    s_mov_b32 s28, 0
    s_mov_b32 s29, 0
    s_cmp_lt_u32 s3, 4
    s_cbranch_scc1 L_HAD0
    s_add_u32 m0, s13, 0
    v_mad_u32_u16 v236, v236, s15, v243
    buffer_load_dwordx4 v236, s[40:43], 0 offen lds
    s_add_u32 m0, s13, 1056
    v_mad_u32_u16 v237, v237, s15, v243
    buffer_load_dwordx4 v237, s[40:43], 0 offen lds
    s_add_u32 m0, s13, 2112
    v_mad_u32_u16 v238, v238, s15, v243
    buffer_load_dwordx4 v238, s[40:43], 0 offen lds
    s_add_u32 m0, s13, 3168
    v_mad_u32_u16 v239, v239, s15, v243
    buffer_load_dwordx4 v239, s[40:43], 0 offen lds
    s_mov_b32 m0, s14
    s_nop 0
    buffer_load_dwordx4 v[240:241], s[44:47], 0 idxen offen lds
    s_lshl_b32 s72, s4, 7
    s_add_u32 s72, s72, 157824
    v_mov_b32 v190, s22
    s_mov_b32 exec_lo, 0xffff0000
    v_mov_b32 v190, s23
    s_mov_b32 exec_lo, -1
    s_mov_b32 exec_hi, 0
    v_sub_u32 v191, v247, v190
    v_and_b32 v191, 15, v191
    v_add_lshl_u32 v191, v191, v190, 5
    v_lshl_add_u32 v190, v247, 2, s72
    ds_write_b32 v190, v191
    s_mov_b32 exec_hi, -1
    s_mul_i32 s10, s5, 196
    s_add_u32 s11, s10, s7
    s_add_u32 s62, s10, s9
    s_min_u32 s11, s11, 50000
    s_min_u32 s62, s62, 50000
    s_sub_u32 s62, s62, s11
    s_lshl_b32 s11, s11, 7
    s_lshl_b32 s62, s62, 7
    s_add_u32 s60, s48, s11
    s_addc_u32 s61, s49, 0
    s_mul_i32 s74, s7, -128
    s_add_u32 s11, s10, s8
    s_add_u32 s50, s10, s24
    s_min_u32 s11, s11, 50000
    s_min_u32 s50, s50, 50000
    s_sub_u32 s50, s50, s11
    s_lshl_b32 s11, s11, 7
    s_lshl_b32 s50, s50, 7
    s_add_u32 s48, s48, s11
    s_addc_u32 s49, s49, 0
    s_mul_i32 s73, s8, -128
    s_and_b32 s10, s25, 12
    s_lshl_b32 s10, s10, 2
    s_bfm_b64 s[76:77], 16, s10
L_HAD0:
    s_cmp_eq_u32 s30, 0
    s_cbranch_scc1 L_GO
    s_lshl_b32 s10, s4, 3
    v_mov_b32 v188, s10
    ds_read_b64 v[188:189], v188 offset:576
    s_waitcnt lgkmcnt(0)
    v_readfirstlane_b32 s34, v188
    v_readfirstlane_b32 s35, v189
    s_sub_u32 s10, s12, 37888
    s_sub_u32 s34, s34, s10
    s_sub_u32 s35, s35, s10
    s_sub_u32 s35, s35, 1152
    s_add_u32 s10, s34, 127
    s_lshr_b32 s10, s10, 7
    s_lshl1_add_u32 s10, s10, -1
    s_add_u32 s11, s35, 127
    s_lshr_b32 s11, s11, 6
    s_and_b32 s11, s11, -2
    s_max_i32 s17, s10, s11
    s_cselect_b32 s10, s34, s35
    s_sub_u32 s10, s10, 1
    s_andn2_b32 s99, 64, s10
L_GO:
    ds_read_u16 v252, v250 offset:0
    ds_read_u16 v253, v250 offset:64
    ds_read_b128 v[236:239], v248 offset:1152
    ds_read_b32 v240, v249 offset:1152
    s_lshr_b32 s10, s4, 1
    s_lshl_b32 s10, s10, 9
    s_add_u32 s10, s10, 155776
    v_lshl_add_u32 v246, v247, 3, s10
    s_bitcmp1_b32 s4, 0
    s_cselect_b32 s101, -1, 1
    s_mul_i32 s10, s101, 0xff000000
    s_or_b32 s10, s10, 0xdddd
    v_mov_b32 v255, s10
    s_max_i32 s10, s17, 1
    s_sub_u32 s10, s10, 1
    s_mul_i32 s10, s101, s10
    s_lshl_b32 s10, s10, 24
    v_mov_b32 v188, s10
    ds_add_u32 v246, v188
    s_movk_i32 s94, 128
    s_movk_i32 s95, 128
    v_mov_b32 v247, 0
    s_mov_b32 exec_hi, 0
    v_add_u32 v247, 0x200, v245
    s_mov_b32 exec_hi, -1
    s_waitcnt lgkmcnt(0)
    v_bfi_b32 v252, 31, v245, v252
    v_bfi_b32 v253, 31, v245, v253
    v_max_u32 v252, v252, v245
    v_max_u32 v253, v253, v247
    s_waitcnt vmcnt(0)
    ds_read_b128 v[176:179], v252
    ds_read_b128 v[180:183], v253
    ds_read_b128 v[160:163], v244 offset:0
    ds_read_b128 v[168:171], v244 offset:512
    ds_read_b128 v[164:167], v244 offset:64
    ds_read_b128 v[172:175], v244 offset:576
    s_cmp_lt_i32 s17, 1
    s_cbranch_scc1 L_DONE
    s_waitcnt lgkmcnt(4)
    v_mfma_f32_16x16x32_bf16 v[188:191], v[176:179], v[64:67], 0
    v_mfma_f32_16x16x32_bf16 v[196:199], v[176:179], v[68:71], 0
    v_mfma_f32_16x16x32_bf16 v[192:195], v[180:183], v[64:67], 0
    v_mfma_f32_16x16x32_bf16 v[200:203], v[180:183], v[68:71], 0
    s_waitcnt lgkmcnt(0)
    v_mfma_f32_16x16x32_bf16 v[188:191], v[160:163], v[0:3], v[188:191]
    v_mfma_f32_16x16x32_bf16 v[196:199], v[160:163], v[8:11], v[196:199]
    v_mfma_f32_16x16x32_bf16 v[192:195], v[168:171], v[0:3], v[192:195]
    v_mfma_f32_16x16x32_bf16 v[200:203], v[168:171], v[8:11], v[200:203]
    v_mfma_f32_16x16x32_bf16 v[188:191], v[164:167], v[4:7], v[188:191]
    v_mfma_f32_16x16x32_bf16 v[196:199], v[164:167], v[12:15], v[196:199]
    v_mfma_f32_16x16x32_bf16 v[192:195], v[172:175], v[4:7], v[192:195]
    v_mfma_f32_16x16x32_bf16 v[200:203], v[172:175], v[12:15], v[200:203]
    s_mov_b32 s16, 1
    s_cmp_eq_u32 s17, 1
    s_cbranch_scc1 L_LT0
    s_add_u32 m0, s13, 0
    v_mad_u32_u16 v236, v236, s15, v243
    buffer_load_dwordx4 v236, s[40:43], 0 offen lds
    s_add_u32 m0, s13, 1056
    v_mad_u32_u16 v237, v237, s15, v243
    buffer_load_dwordx4 v237, s[40:43], 0 offen lds
    s_add_u32 m0, s13, 2112
    v_mad_u32_u16 v238, v238, s15, v243
    buffer_load_dwordx4 v238, s[40:43], 0 offen lds
    s_add_u32 m0, s13, 3168
    v_mad_u32_u16 v239, v239, s15, v243
    buffer_load_dwordx4 v239, s[40:43], 0 offen lds
    s_mov_b32 m0, s14
    s_nop 0
    buffer_load_dwordx4 v[240:241], s[44:47], 0 idxen offen lds
.p2align 6
L_LOOP1:
    s_setprio 1
    v_smfmac_f32_16x16x64_bf16 v[152:155], v[184:187], v[204:211], v255
    ds_read_u16 v236, v251 offset:0
    ds_read_u16 v237, v251 offset:16
    ds_add_rtn_u32 v238, v246, v255
    v_exp_f32 v188, v188
    v_smfmac_f32_16x16x64_bf16 v[156:159], v[184:187], v[212:219], v255
    v_exp_f32 v189, v189
    v_mfma_f32_16x16x32_bf16 v[204:207], v[160:163], v[32:35], 0
    v_exp_f32 v190, v190
    v_mfma_f32_16x16x32_bf16 v[212:215], v[160:163], v[40:43], 0
    v_exp_f32 v191, v191
    v_mfma_f32_16x16x32_bf16 v[208:211], v[168:171], v[32:35], 0
    v_exp_f32 v192, v192
    v_mfma_f32_16x16x32_bf16 v[216:219], v[168:171], v[40:43], 0
    v_exp_f32 v193, v193
    v_mfma_f32_16x16x32_bf16 v[204:207], v[164:167], v[36:39], v[204:207]
    v_exp_f32 v194, v194
    v_mfma_f32_16x16x32_bf16 v[212:215], v[164:167], v[44:47], v[212:215]
    v_exp_f32 v195, v195
    v_mfma_f32_16x16x32_bf16 v[208:211], v[172:175], v[36:39], v[208:211]
    s_waitcnt lgkmcnt(0)
    v_bfi_b32 v236, 31, v246, v236
    v_bfi_b32 v237, 31, v246, v237
    v_readfirstlane_b32 s96, v238
    v_exp_f32 v196, v196
    v_mfma_f32_16x16x32_bf16 v[216:219], v[172:175], v[44:47], v[216:219]
    v_exp_f32 v197, v197
    v_smfmac_f32_16x16x64_bf16 v[136:139], v[184:187], v[220:227], v255
    v_exp_f32 v198, v198
    v_smfmac_f32_16x16x64_bf16 v[140:143], v[184:187], v[228:235], v255
    v_exp_f32 v199, v199
    v_mfma_f32_4x4x4_16b_bf16 v[188:191], v[242:243], v[242:243], v[188:191]
    v_exp_f32 v200, v200
    v_mfma_f32_4x4x4_16b_bf16 v[192:195], v[242:243], v[242:243], v[192:195]
    v_exp_f32 v201, v201
    v_mfma_f32_4x4x4_16b_bf16 v[196:199], v[242:243], v[242:243], v[196:199]
    v_exp_f32 v202, v202
    v_mfma_f32_16x16x32_bf16 v[220:223], v[176:179], v[72:75], 0
    ds_read_b64_tr_b16 v[184:185], v236
    ds_read_b64_tr_b16 v[186:187], v237
    ds_read_u16 v252, v250 offset:1152
    ds_read_u16 v253, v250 offset:1216
    v_exp_f32 v203, v203
    v_mfma_f32_16x16x32_bf16 v[228:231], v[176:179], v[76:79], 0
    s_ashr_i32 s96, s96, 24
    s_mul_i32 s96, s96, s101
    v_rcp_f32 v188, v188
    v_mfma_f32_16x16x32_bf16 v[224:227], v[180:183], v[72:75], 0
    v_rcp_f32 v189, v189
    v_mfma_f32_4x4x4_16b_bf16 v[200:203], v[242:243], v[242:243], v[200:203]
    v_rcp_f32 v190, v190
    v_mfma_f32_16x16x32_bf16 v[232:235], v[180:183], v[76:79], 0
    v_rcp_f32 v191, v191
    v_mfma_f32_16x16x32_bf16 v[220:223], v[160:163], v[16:19], v[220:223]
    v_rcp_f32 v192, v192
    v_mfma_f32_16x16x32_bf16 v[228:231], v[160:163], v[24:27], v[228:231]
    v_rcp_f32 v193, v193
    v_mfma_f32_16x16x32_bf16 v[224:227], v[168:171], v[16:19], v[224:227]
    s_waitcnt lgkmcnt(0)
    v_bfi_b32 v252, 31, v245, v252
    v_bfi_b32 v253, 31, v245, v253
    v_max_u32 v252, v252, v245
    v_max_u32 v253, v253, v247
    ds_read_b128 v[236:239], v248 offset:128
    ds_read_b32 v240, v249 offset:128
    s_add_u32 s16, s16, 1
    v_rcp_f32 v194, v194
    v_mfma_f32_16x16x32_bf16 v[232:235], v[168:171], v[24:27], v[232:235]
    v_rcp_f32 v195, v195
    v_mfma_f32_16x16x32_bf16 v[220:223], v[164:167], v[20:23], v[220:223]
    v_rcp_f32 v196, v196
    v_mfma_f32_16x16x32_bf16 v[228:231], v[164:167], v[28:31], v[228:231]
    v_rcp_f32 v197, v197
    s_setprio 3
    v_mfma_f32_16x16x32_bf16 v[224:227], v[172:175], v[20:23], v[224:227]
    v_rcp_f32 v198, v198
    v_mfma_f32_16x16x32_bf16 v[232:235], v[172:175], v[28:31], v[232:235]
    v_rcp_f32 v199, v199
    v_rcp_f32 v200, v200
    v_rcp_f32 v201, v201
    v_rcp_f32 v202, v202
    v_rcp_f32 v203, v203
    v_pk_mul_f32 v[204:205], v[188:189], v[204:205]
    v_pk_mul_f32 v[206:207], v[190:191], v[206:207]
    v_pk_mul_f32 v[208:209], v[192:193], v[208:209]
    v_pk_mul_f32 v[210:211], v[194:195], v[210:211]
    v_pk_mul_f32 v[212:213], v[196:197], v[212:213]
    v_pk_mul_f32 v[214:215], v[198:199], v[214:215]
    v_pk_mul_f32 v[216:217], v[200:201], v[216:217]
    v_pk_mul_f32 v[218:219], v[202:203], v[218:219]
    s_cmp_ge_i32 s96, 1
    s_cbranch_scc0 L_PB00
L_PB01:
    s_setprio 1
    v_smfmac_f32_16x16x64_bf16 v[112:115], v[184:187], v[204:211], v255
    v_exp_f32 v220, v220
    v_smfmac_f32_16x16x64_bf16 v[116:119], v[184:187], v[212:219], v255
    v_exp_f32 v221, v221
    s_waitcnt vmcnt(0)
    ds_read_b128 v[176:179], v252
    ds_read_b128 v[180:183], v253
    v_mfma_f32_16x16x32_bf16 v[204:207], v[160:163], v[48:51], 0
    v_exp_f32 v222, v222
    v_mfma_f32_16x16x32_bf16 v[212:215], v[160:163], v[56:59], 0
    ds_read_b128 v[160:163], v244 offset:0
    v_exp_f32 v223, v223
    v_mfma_f32_16x16x32_bf16 v[208:211], v[168:171], v[48:51], 0
    v_exp_f32 v224, v224
    v_mfma_f32_16x16x32_bf16 v[216:219], v[168:171], v[56:59], 0
    ds_read_b128 v[168:171], v244 offset:512
    v_exp_f32 v225, v225
    v_mfma_f32_16x16x32_bf16 v[204:207], v[164:167], v[52:55], v[204:207]
    v_exp_f32 v226, v226
    v_mfma_f32_16x16x32_bf16 v[212:215], v[164:167], v[60:63], v[212:215]
    ds_read_b128 v[164:167], v244 offset:64
    v_exp_f32 v227, v227
    v_mfma_f32_16x16x32_bf16 v[208:211], v[172:175], v[52:55], v[208:211]
    v_exp_f32 v228, v228
    v_mfma_f32_16x16x32_bf16 v[216:219], v[172:175], v[60:63], v[216:219]
    ds_read_b128 v[172:175], v244 offset:576
    v_exp_f32 v229, v229
    v_smfmac_f32_16x16x64_bf16 v[96:99], v[184:187], v[188:195], v255
    v_exp_f32 v230, v230
    v_smfmac_f32_16x16x64_bf16 v[100:103], v[184:187], v[196:203], v255
    v_exp_f32 v231, v231
    v_mfma_f32_4x4x4_16b_bf16 v[220:223], v[242:243], v[242:243], v[220:223]
    v_exp_f32 v232, v232
    v_mfma_f32_4x4x4_16b_bf16 v[224:227], v[242:243], v[242:243], v[224:227]
    v_exp_f32 v233, v233
    v_mfma_f32_4x4x4_16b_bf16 v[228:231], v[242:243], v[242:243], v[228:231]
    v_exp_f32 v234, v234
    s_waitcnt lgkmcnt(4)
    v_mfma_f32_16x16x32_bf16 v[188:191], v[176:179], v[80:83], 0
    v_exp_f32 v235, v235
    v_mfma_f32_16x16x32_bf16 v[196:199], v[176:179], v[84:87], 0
    v_rcp_f32 v220, v220
    v_mfma_f32_16x16x32_bf16 v[192:195], v[180:183], v[80:83], 0
    v_rcp_f32 v221, v221
    v_mfma_f32_4x4x4_16b_bf16 v[232:235], v[242:243], v[242:243], v[232:235]
    v_rcp_f32 v222, v222
    v_mfma_f32_16x16x32_bf16 v[200:203], v[180:183], v[84:87], 0
    v_rcp_f32 v223, v223
    s_waitcnt lgkmcnt(3)
    v_mfma_f32_16x16x32_bf16 v[188:191], v[160:163], v[0:3], v[188:191]
    v_rcp_f32 v224, v224
    v_mfma_f32_16x16x32_bf16 v[196:199], v[160:163], v[8:11], v[196:199]
    v_rcp_f32 v225, v225
    s_waitcnt lgkmcnt(2)
    v_mfma_f32_16x16x32_bf16 v[192:195], v[168:171], v[0:3], v[192:195]
    v_rcp_f32 v226, v226
    v_mfma_f32_16x16x32_bf16 v[200:203], v[168:171], v[8:11], v[200:203]
    v_rcp_f32 v227, v227
    s_waitcnt lgkmcnt(1)
    v_mfma_f32_16x16x32_bf16 v[188:191], v[164:167], v[4:7], v[188:191]
    v_rcp_f32 v228, v228
    v_mfma_f32_16x16x32_bf16 v[196:199], v[164:167], v[12:15], v[196:199]
    v_rcp_f32 v229, v229
    s_setprio 3
    s_waitcnt lgkmcnt(0)
    v_mfma_f32_16x16x32_bf16 v[192:195], v[172:175], v[4:7], v[192:195]
    s_cmp_lt_u32 s16, s17
    s_cbranch_scc0 L_ND01
    s_add_u32 m0, s13, 0
    v_mad_u32_u16 v236, v236, s15, v243
    buffer_load_dwordx4 v236, s[40:43], 0 offen lds
    s_add_u32 m0, s13, 1056
    v_mad_u32_u16 v237, v237, s15, v243
    buffer_load_dwordx4 v237, s[40:43], 0 offen lds
    s_add_u32 m0, s13, 2112
    v_mad_u32_u16 v238, v238, s15, v243
    buffer_load_dwordx4 v238, s[40:43], 0 offen lds
    s_add_u32 m0, s13, 3168
    v_mad_u32_u16 v239, v239, s15, v243
    buffer_load_dwordx4 v239, s[40:43], 0 offen lds
    s_mov_b32 m0, s14
    s_nop 0
    buffer_load_dwordx4 v[240:241], s[44:47], 0 idxen offen lds
L_ND01:
    v_rcp_f32 v230, v230
    v_mfma_f32_16x16x32_bf16 v[200:203], v[172:175], v[12:15], v[200:203]
    v_rcp_f32 v231, v231
    v_rcp_f32 v232, v232
    v_rcp_f32 v233, v233
    v_rcp_f32 v234, v234
    v_rcp_f32 v235, v235
    v_pk_mul_f32 v[204:205], v[220:221], v[204:205]
    v_pk_mul_f32 v[206:207], v[222:223], v[206:207]
    v_pk_mul_f32 v[208:209], v[224:225], v[208:209]
    v_pk_mul_f32 v[210:211], v[226:227], v[210:211]
    v_pk_mul_f32 v[212:213], v[228:229], v[212:213]
    v_pk_mul_f32 v[214:215], v[230:231], v[214:215]
    v_pk_mul_f32 v[216:217], v[232:233], v[216:217]
    v_pk_mul_f32 v[218:219], v[234:235], v[218:219]
    s_cmp_ge_u32 s16, s17
    s_cbranch_scc1 L_LT1
    s_setprio 1
    v_smfmac_f32_16x16x64_bf16 v[120:123], v[184:187], v[204:211], v255
    ds_read_u16 v236, v251 offset:1152
    ds_read_u16 v237, v251 offset:1168
    ds_add_rtn_u32 v238, v246, v255
    v_exp_f32 v188, v188
    v_smfmac_f32_16x16x64_bf16 v[124:127], v[184:187], v[212:219], v255
    v_exp_f32 v189, v189
    v_mfma_f32_16x16x32_bf16 v[204:207], v[160:163], v[32:35], 0
    v_exp_f32 v190, v190
    v_mfma_f32_16x16x32_bf16 v[212:215], v[160:163], v[40:43], 0
    v_exp_f32 v191, v191
    v_mfma_f32_16x16x32_bf16 v[208:211], v[168:171], v[32:35], 0
    v_exp_f32 v192, v192
    v_mfma_f32_16x16x32_bf16 v[216:219], v[168:171], v[40:43], 0
    v_exp_f32 v193, v193
    v_mfma_f32_16x16x32_bf16 v[204:207], v[164:167], v[36:39], v[204:207]
    v_exp_f32 v194, v194
    v_mfma_f32_16x16x32_bf16 v[212:215], v[164:167], v[44:47], v[212:215]
    v_exp_f32 v195, v195
    v_mfma_f32_16x16x32_bf16 v[208:211], v[172:175], v[36:39], v[208:211]
    s_waitcnt lgkmcnt(0)
    v_bfi_b32 v236, 31, v246, v236
    v_bfi_b32 v237, 31, v246, v237
    v_readfirstlane_b32 s96, v238
    v_exp_f32 v196, v196
    v_mfma_f32_16x16x32_bf16 v[216:219], v[172:175], v[44:47], v[216:219]
    v_exp_f32 v197, v197
    v_smfmac_f32_16x16x64_bf16 v[104:107], v[184:187], v[220:227], v255
    v_exp_f32 v198, v198
    v_smfmac_f32_16x16x64_bf16 v[108:111], v[184:187], v[228:235], v255
    v_exp_f32 v199, v199
    v_mfma_f32_4x4x4_16b_bf16 v[188:191], v[242:243], v[242:243], v[188:191]
    v_exp_f32 v200, v200
    v_mfma_f32_4x4x4_16b_bf16 v[192:195], v[242:243], v[242:243], v[192:195]
    v_exp_f32 v201, v201
    v_mfma_f32_4x4x4_16b_bf16 v[196:199], v[242:243], v[242:243], v[196:199]
    v_exp_f32 v202, v202
    v_mfma_f32_16x16x32_bf16 v[220:223], v[176:179], v[88:91], 0
    ds_read_b64_tr_b16 v[184:185], v236
    ds_read_b64_tr_b16 v[186:187], v237
    ds_read_u16 v252, v250 offset:128
    ds_read_u16 v253, v250 offset:192
    v_exp_f32 v203, v203
    v_mfma_f32_16x16x32_bf16 v[228:231], v[176:179], v[92:95], 0
    s_ashr_i32 s96, s96, 24
    s_mul_i32 s96, s96, s101
    v_rcp_f32 v188, v188
    v_mfma_f32_16x16x32_bf16 v[224:227], v[180:183], v[88:91], 0
    v_rcp_f32 v189, v189
    v_mfma_f32_4x4x4_16b_bf16 v[200:203], v[242:243], v[242:243], v[200:203]
    v_rcp_f32 v190, v190
    v_mfma_f32_16x16x32_bf16 v[232:235], v[180:183], v[92:95], 0
    v_rcp_f32 v191, v191
    v_mfma_f32_16x16x32_bf16 v[220:223], v[160:163], v[16:19], v[220:223]
    v_rcp_f32 v192, v192
    v_mfma_f32_16x16x32_bf16 v[228:231], v[160:163], v[24:27], v[228:231]
    v_rcp_f32 v193, v193
    v_mfma_f32_16x16x32_bf16 v[224:227], v[168:171], v[16:19], v[224:227]
    s_waitcnt lgkmcnt(0)
    v_bfi_b32 v252, 31, v245, v252
    v_bfi_b32 v253, 31, v245, v253
    v_max_u32 v252, v252, v245
    v_max_u32 v253, v253, v247
    ds_read_b128 v[236:239], v248 offset:1280
    ds_read_b32 v240, v249 offset:1280
    s_add_u32 s16, s16, 1
    v_rcp_f32 v194, v194
    v_mfma_f32_16x16x32_bf16 v[232:235], v[168:171], v[24:27], v[232:235]
    v_lshl_add_u64 v[248:249], v[248:249], 0, s[94:95]
    v_lshl_add_u64 v[250:251], v[250:251], 0, s[94:95]
    v_rcp_f32 v195, v195
    v_mfma_f32_16x16x32_bf16 v[220:223], v[164:167], v[20:23], v[220:223]
    v_rcp_f32 v196, v196
    v_mfma_f32_16x16x32_bf16 v[228:231], v[164:167], v[28:31], v[228:231]
    v_rcp_f32 v197, v197
    s_setprio 3
    v_mfma_f32_16x16x32_bf16 v[224:227], v[172:175], v[20:23], v[224:227]
    v_rcp_f32 v198, v198
    v_mfma_f32_16x16x32_bf16 v[232:235], v[172:175], v[28:31], v[232:235]
    v_rcp_f32 v199, v199
    v_rcp_f32 v200, v200
    v_rcp_f32 v201, v201
    v_rcp_f32 v202, v202
    v_rcp_f32 v203, v203
    v_pk_mul_f32 v[204:205], v[188:189], v[204:205]
    v_pk_mul_f32 v[206:207], v[190:191], v[206:207]
    v_pk_mul_f32 v[208:209], v[192:193], v[208:209]
    v_pk_mul_f32 v[210:211], v[194:195], v[210:211]
    v_pk_mul_f32 v[212:213], v[196:197], v[212:213]
    v_pk_mul_f32 v[214:215], v[198:199], v[214:215]
    v_pk_mul_f32 v[216:217], v[200:201], v[216:217]
    v_pk_mul_f32 v[218:219], v[202:203], v[218:219]
    s_cmp_ge_i32 s96, 1
    s_cbranch_scc0 L_PB10
L_PB11:
    s_setprio 1
    v_smfmac_f32_16x16x64_bf16 v[144:147], v[184:187], v[204:211], v255
    v_exp_f32 v220, v220
    v_smfmac_f32_16x16x64_bf16 v[148:151], v[184:187], v[212:219], v255
    v_exp_f32 v221, v221
    s_waitcnt vmcnt(0)
    ds_read_b128 v[176:179], v252
    ds_read_b128 v[180:183], v253
    v_mfma_f32_16x16x32_bf16 v[204:207], v[160:163], v[48:51], 0
    v_exp_f32 v222, v222
    v_mfma_f32_16x16x32_bf16 v[212:215], v[160:163], v[56:59], 0
    ds_read_b128 v[160:163], v244 offset:0
    v_exp_f32 v223, v223
    v_mfma_f32_16x16x32_bf16 v[208:211], v[168:171], v[48:51], 0
    v_exp_f32 v224, v224
    v_mfma_f32_16x16x32_bf16 v[216:219], v[168:171], v[56:59], 0
    ds_read_b128 v[168:171], v244 offset:512
    v_exp_f32 v225, v225
    v_mfma_f32_16x16x32_bf16 v[204:207], v[164:167], v[52:55], v[204:207]
    v_exp_f32 v226, v226
    v_mfma_f32_16x16x32_bf16 v[212:215], v[164:167], v[60:63], v[212:215]
    ds_read_b128 v[164:167], v244 offset:64
    v_exp_f32 v227, v227
    v_mfma_f32_16x16x32_bf16 v[208:211], v[172:175], v[52:55], v[208:211]
    v_exp_f32 v228, v228
    v_mfma_f32_16x16x32_bf16 v[216:219], v[172:175], v[60:63], v[216:219]
    ds_read_b128 v[172:175], v244 offset:576
    v_exp_f32 v229, v229
    v_smfmac_f32_16x16x64_bf16 v[128:131], v[184:187], v[188:195], v255
    v_exp_f32 v230, v230
    v_smfmac_f32_16x16x64_bf16 v[132:135], v[184:187], v[196:203], v255
    v_exp_f32 v231, v231
    v_mfma_f32_4x4x4_16b_bf16 v[220:223], v[242:243], v[242:243], v[220:223]
    v_exp_f32 v232, v232
    v_mfma_f32_4x4x4_16b_bf16 v[224:227], v[242:243], v[242:243], v[224:227]
    v_exp_f32 v233, v233
    v_mfma_f32_4x4x4_16b_bf16 v[228:231], v[242:243], v[242:243], v[228:231]
    v_exp_f32 v234, v234
    s_waitcnt lgkmcnt(4)
    v_mfma_f32_16x16x32_bf16 v[188:191], v[176:179], v[64:67], 0
    v_exp_f32 v235, v235
    v_mfma_f32_16x16x32_bf16 v[196:199], v[176:179], v[68:71], 0
    v_rcp_f32 v220, v220
    v_mfma_f32_16x16x32_bf16 v[192:195], v[180:183], v[64:67], 0
    v_rcp_f32 v221, v221
    v_mfma_f32_4x4x4_16b_bf16 v[232:235], v[242:243], v[242:243], v[232:235]
    v_rcp_f32 v222, v222
    v_mfma_f32_16x16x32_bf16 v[200:203], v[180:183], v[68:71], 0
    v_rcp_f32 v223, v223
    s_waitcnt lgkmcnt(3)
    v_mfma_f32_16x16x32_bf16 v[188:191], v[160:163], v[0:3], v[188:191]
    v_rcp_f32 v224, v224
    v_mfma_f32_16x16x32_bf16 v[196:199], v[160:163], v[8:11], v[196:199]
    v_rcp_f32 v225, v225
    s_waitcnt lgkmcnt(2)
    v_mfma_f32_16x16x32_bf16 v[192:195], v[168:171], v[0:3], v[192:195]
    v_rcp_f32 v226, v226
    v_mfma_f32_16x16x32_bf16 v[200:203], v[168:171], v[8:11], v[200:203]
    v_rcp_f32 v227, v227
    s_waitcnt lgkmcnt(1)
    v_mfma_f32_16x16x32_bf16 v[188:191], v[164:167], v[4:7], v[188:191]
    v_rcp_f32 v228, v228
    v_mfma_f32_16x16x32_bf16 v[196:199], v[164:167], v[12:15], v[196:199]
    v_rcp_f32 v229, v229
    s_setprio 3
    s_waitcnt lgkmcnt(0)
    v_mfma_f32_16x16x32_bf16 v[192:195], v[172:175], v[4:7], v[192:195]
    s_cmp_lt_u32 s16, s17
    s_cbranch_scc0 L_ND11
    s_add_u32 m0, s13, 0
    v_mad_u32_u16 v236, v236, s15, v243
    buffer_load_dwordx4 v236, s[40:43], 0 offen lds
    s_add_u32 m0, s13, 1056
    v_mad_u32_u16 v237, v237, s15, v243
    buffer_load_dwordx4 v237, s[40:43], 0 offen lds
    s_add_u32 m0, s13, 2112
    v_mad_u32_u16 v238, v238, s15, v243
    buffer_load_dwordx4 v238, s[40:43], 0 offen lds
    s_add_u32 m0, s13, 3168
    v_mad_u32_u16 v239, v239, s15, v243
    buffer_load_dwordx4 v239, s[40:43], 0 offen lds
    s_mov_b32 m0, s14
    s_nop 0
    buffer_load_dwordx4 v[240:241], s[44:47], 0 idxen offen lds
L_ND11:
    v_rcp_f32 v230, v230
    v_mfma_f32_16x16x32_bf16 v[200:203], v[172:175], v[12:15], v[200:203]
    v_rcp_f32 v231, v231
    v_rcp_f32 v232, v232
    v_rcp_f32 v233, v233
    v_rcp_f32 v234, v234
    v_rcp_f32 v235, v235
    v_pk_mul_f32 v[204:205], v[220:221], v[204:205]
    v_pk_mul_f32 v[206:207], v[222:223], v[206:207]
    v_pk_mul_f32 v[208:209], v[224:225], v[208:209]
    v_pk_mul_f32 v[210:211], v[226:227], v[210:211]
    v_pk_mul_f32 v[212:213], v[228:229], v[212:213]
    v_pk_mul_f32 v[214:215], v[230:231], v[214:215]
    v_pk_mul_f32 v[216:217], v[232:233], v[216:217]
    v_pk_mul_f32 v[218:219], v[234:235], v[218:219]
    s_cmp_lt_u32 s16, s17
    s_cbranch_scc1 L_LOOP1
    s_branch L_LT0
.p2align 6
L_LOOP0:
    s_setprio 0
    v_smfmac_f32_16x16x64_bf16 v[152:155], v[184:187], v[204:211], v255
    ds_read_u16 v236, v251 offset:0
    ds_read_u16 v237, v251 offset:16
    ds_add_rtn_u32 v238, v246, v255
    v_exp_f32 v188, v188
    v_smfmac_f32_16x16x64_bf16 v[156:159], v[184:187], v[212:219], v255
    v_exp_f32 v189, v189
    v_mfma_f32_16x16x32_bf16 v[204:207], v[160:163], v[32:35], 0
    v_exp_f32 v190, v190
    v_mfma_f32_16x16x32_bf16 v[212:215], v[160:163], v[40:43], 0
    v_exp_f32 v191, v191
    v_mfma_f32_16x16x32_bf16 v[208:211], v[168:171], v[32:35], 0
    v_exp_f32 v192, v192
    v_mfma_f32_16x16x32_bf16 v[216:219], v[168:171], v[40:43], 0
    v_exp_f32 v193, v193
    v_mfma_f32_16x16x32_bf16 v[204:207], v[164:167], v[36:39], v[204:207]
    v_exp_f32 v194, v194
    v_mfma_f32_16x16x32_bf16 v[212:215], v[164:167], v[44:47], v[212:215]
    v_exp_f32 v195, v195
    v_mfma_f32_16x16x32_bf16 v[208:211], v[172:175], v[36:39], v[208:211]
    s_waitcnt lgkmcnt(0)
    v_bfi_b32 v236, 31, v246, v236
    v_bfi_b32 v237, 31, v246, v237
    v_readfirstlane_b32 s96, v238
    v_exp_f32 v196, v196
    v_mfma_f32_16x16x32_bf16 v[216:219], v[172:175], v[44:47], v[216:219]
    v_exp_f32 v197, v197
    v_smfmac_f32_16x16x64_bf16 v[136:139], v[184:187], v[220:227], v255
    v_exp_f32 v198, v198
    v_smfmac_f32_16x16x64_bf16 v[140:143], v[184:187], v[228:235], v255
    v_exp_f32 v199, v199
    v_mfma_f32_4x4x4_16b_bf16 v[188:191], v[242:243], v[242:243], v[188:191]
    v_exp_f32 v200, v200
    v_mfma_f32_4x4x4_16b_bf16 v[192:195], v[242:243], v[242:243], v[192:195]
    v_exp_f32 v201, v201
    v_mfma_f32_4x4x4_16b_bf16 v[196:199], v[242:243], v[242:243], v[196:199]
    v_exp_f32 v202, v202
    v_mfma_f32_16x16x32_bf16 v[220:223], v[176:179], v[72:75], 0
    ds_read_b64_tr_b16 v[184:185], v236
    ds_read_b64_tr_b16 v[186:187], v237
    ds_read_u16 v252, v250 offset:1152
    ds_read_u16 v253, v250 offset:1216
    v_exp_f32 v203, v203
    v_mfma_f32_16x16x32_bf16 v[228:231], v[176:179], v[76:79], 0
    s_ashr_i32 s96, s96, 24
    s_mul_i32 s96, s96, s101
    v_rcp_f32 v188, v188
    v_mfma_f32_16x16x32_bf16 v[224:227], v[180:183], v[72:75], 0
    v_rcp_f32 v189, v189
    v_mfma_f32_4x4x4_16b_bf16 v[200:203], v[242:243], v[242:243], v[200:203]
    v_rcp_f32 v190, v190
    v_mfma_f32_16x16x32_bf16 v[232:235], v[180:183], v[76:79], 0
    v_rcp_f32 v191, v191
    v_mfma_f32_16x16x32_bf16 v[220:223], v[160:163], v[16:19], v[220:223]
    v_rcp_f32 v192, v192
    v_mfma_f32_16x16x32_bf16 v[228:231], v[160:163], v[24:27], v[228:231]
    v_rcp_f32 v193, v193
    v_mfma_f32_16x16x32_bf16 v[224:227], v[168:171], v[16:19], v[224:227]
    s_waitcnt lgkmcnt(0)
    v_bfi_b32 v252, 31, v245, v252
    v_bfi_b32 v253, 31, v245, v253
    v_max_u32 v252, v252, v245
    v_max_u32 v253, v253, v247
    ds_read_b128 v[236:239], v248 offset:128
    ds_read_b32 v240, v249 offset:128
    s_add_u32 s16, s16, 1
    v_rcp_f32 v194, v194
    v_mfma_f32_16x16x32_bf16 v[232:235], v[168:171], v[24:27], v[232:235]
    v_rcp_f32 v195, v195
    v_mfma_f32_16x16x32_bf16 v[220:223], v[164:167], v[20:23], v[220:223]
    v_rcp_f32 v196, v196
    v_mfma_f32_16x16x32_bf16 v[228:231], v[164:167], v[28:31], v[228:231]
    v_rcp_f32 v197, v197
    s_setprio 3
    v_mfma_f32_16x16x32_bf16 v[224:227], v[172:175], v[20:23], v[224:227]
    v_rcp_f32 v198, v198
    v_mfma_f32_16x16x32_bf16 v[232:235], v[172:175], v[28:31], v[232:235]
    v_rcp_f32 v199, v199
    v_rcp_f32 v200, v200
    v_rcp_f32 v201, v201
    v_rcp_f32 v202, v202
    v_rcp_f32 v203, v203
    v_pk_mul_f32 v[204:205], v[188:189], v[204:205]
    v_pk_mul_f32 v[206:207], v[190:191], v[206:207]
    v_pk_mul_f32 v[208:209], v[192:193], v[208:209]
    v_pk_mul_f32 v[210:211], v[194:195], v[210:211]
    v_pk_mul_f32 v[212:213], v[196:197], v[212:213]
    v_pk_mul_f32 v[214:215], v[198:199], v[214:215]
    v_pk_mul_f32 v[216:217], v[200:201], v[216:217]
    v_pk_mul_f32 v[218:219], v[202:203], v[218:219]
    s_cmp_ge_i32 s96, 1
    s_cbranch_scc1 L_PB01
L_PB00:
    s_setprio 0
    v_smfmac_f32_16x16x64_bf16 v[112:115], v[184:187], v[204:211], v255
    v_exp_f32 v220, v220
    v_smfmac_f32_16x16x64_bf16 v[116:119], v[184:187], v[212:219], v255
    v_exp_f32 v221, v221
    s_waitcnt vmcnt(0)
    ds_read_b128 v[176:179], v252
    ds_read_b128 v[180:183], v253
    v_mfma_f32_16x16x32_bf16 v[204:207], v[160:163], v[48:51], 0
    v_exp_f32 v222, v222
    v_mfma_f32_16x16x32_bf16 v[212:215], v[160:163], v[56:59], 0
    ds_read_b128 v[160:163], v244 offset:0
    v_exp_f32 v223, v223
    v_mfma_f32_16x16x32_bf16 v[208:211], v[168:171], v[48:51], 0
    v_exp_f32 v224, v224
    v_mfma_f32_16x16x32_bf16 v[216:219], v[168:171], v[56:59], 0
    ds_read_b128 v[168:171], v244 offset:512
    v_exp_f32 v225, v225
    v_mfma_f32_16x16x32_bf16 v[204:207], v[164:167], v[52:55], v[204:207]
    v_exp_f32 v226, v226
    v_mfma_f32_16x16x32_bf16 v[212:215], v[164:167], v[60:63], v[212:215]
    ds_read_b128 v[164:167], v244 offset:64
    v_exp_f32 v227, v227
    v_mfma_f32_16x16x32_bf16 v[208:211], v[172:175], v[52:55], v[208:211]
    v_exp_f32 v228, v228
    v_mfma_f32_16x16x32_bf16 v[216:219], v[172:175], v[60:63], v[216:219]
    ds_read_b128 v[172:175], v244 offset:576
    v_exp_f32 v229, v229
    v_smfmac_f32_16x16x64_bf16 v[96:99], v[184:187], v[188:195], v255
    v_exp_f32 v230, v230
    v_smfmac_f32_16x16x64_bf16 v[100:103], v[184:187], v[196:203], v255
    v_exp_f32 v231, v231
    v_mfma_f32_4x4x4_16b_bf16 v[220:223], v[242:243], v[242:243], v[220:223]
    v_exp_f32 v232, v232
    v_mfma_f32_4x4x4_16b_bf16 v[224:227], v[242:243], v[242:243], v[224:227]
    v_exp_f32 v233, v233
    v_mfma_f32_4x4x4_16b_bf16 v[228:231], v[242:243], v[242:243], v[228:231]
    v_exp_f32 v234, v234
    s_waitcnt lgkmcnt(4)
    v_mfma_f32_16x16x32_bf16 v[188:191], v[176:179], v[80:83], 0
    v_exp_f32 v235, v235
    v_mfma_f32_16x16x32_bf16 v[196:199], v[176:179], v[84:87], 0
    v_rcp_f32 v220, v220
    v_mfma_f32_16x16x32_bf16 v[192:195], v[180:183], v[80:83], 0
    v_rcp_f32 v221, v221
    v_mfma_f32_4x4x4_16b_bf16 v[232:235], v[242:243], v[242:243], v[232:235]
    v_rcp_f32 v222, v222
    v_mfma_f32_16x16x32_bf16 v[200:203], v[180:183], v[84:87], 0
    v_rcp_f32 v223, v223
    s_waitcnt lgkmcnt(3)
    v_mfma_f32_16x16x32_bf16 v[188:191], v[160:163], v[0:3], v[188:191]
    v_rcp_f32 v224, v224
    v_mfma_f32_16x16x32_bf16 v[196:199], v[160:163], v[8:11], v[196:199]
    v_rcp_f32 v225, v225
    s_waitcnt lgkmcnt(2)
    v_mfma_f32_16x16x32_bf16 v[192:195], v[168:171], v[0:3], v[192:195]
    v_rcp_f32 v226, v226
    v_mfma_f32_16x16x32_bf16 v[200:203], v[168:171], v[8:11], v[200:203]
    v_rcp_f32 v227, v227
    s_waitcnt lgkmcnt(1)
    v_mfma_f32_16x16x32_bf16 v[188:191], v[164:167], v[4:7], v[188:191]
    v_rcp_f32 v228, v228
    v_mfma_f32_16x16x32_bf16 v[196:199], v[164:167], v[12:15], v[196:199]
    v_rcp_f32 v229, v229
    s_setprio 3
    s_waitcnt lgkmcnt(0)
    v_mfma_f32_16x16x32_bf16 v[192:195], v[172:175], v[4:7], v[192:195]
    s_cmp_lt_u32 s16, s17
    s_cbranch_scc0 L_ND00
    s_add_u32 m0, s13, 0
    v_mad_u32_u16 v236, v236, s15, v243
    buffer_load_dwordx4 v236, s[40:43], 0 offen lds
    s_add_u32 m0, s13, 1056
    v_mad_u32_u16 v237, v237, s15, v243
    buffer_load_dwordx4 v237, s[40:43], 0 offen lds
    s_add_u32 m0, s13, 2112
    v_mad_u32_u16 v238, v238, s15, v243
    buffer_load_dwordx4 v238, s[40:43], 0 offen lds
    s_add_u32 m0, s13, 3168
    v_mad_u32_u16 v239, v239, s15, v243
    buffer_load_dwordx4 v239, s[40:43], 0 offen lds
    s_mov_b32 m0, s14
    s_nop 0
    buffer_load_dwordx4 v[240:241], s[44:47], 0 idxen offen lds
L_ND00:
    v_rcp_f32 v230, v230
    v_mfma_f32_16x16x32_bf16 v[200:203], v[172:175], v[12:15], v[200:203]
    v_rcp_f32 v231, v231
    v_rcp_f32 v232, v232
    v_rcp_f32 v233, v233
    v_rcp_f32 v234, v234
    v_rcp_f32 v235, v235
    v_pk_mul_f32 v[204:205], v[220:221], v[204:205]
    v_pk_mul_f32 v[206:207], v[222:223], v[206:207]
    v_pk_mul_f32 v[208:209], v[224:225], v[208:209]
    v_pk_mul_f32 v[210:211], v[226:227], v[210:211]
    v_pk_mul_f32 v[212:213], v[228:229], v[212:213]
    v_pk_mul_f32 v[214:215], v[230:231], v[214:215]
    v_pk_mul_f32 v[216:217], v[232:233], v[216:217]
    v_pk_mul_f32 v[218:219], v[234:235], v[218:219]
    s_cmp_ge_u32 s16, s17
    s_cbranch_scc1 L_LT1
    s_setprio 0
    v_smfmac_f32_16x16x64_bf16 v[120:123], v[184:187], v[204:211], v255
    ds_read_u16 v236, v251 offset:1152
    ds_read_u16 v237, v251 offset:1168
    ds_add_rtn_u32 v238, v246, v255
    v_exp_f32 v188, v188
    v_smfmac_f32_16x16x64_bf16 v[124:127], v[184:187], v[212:219], v255
    v_exp_f32 v189, v189
    v_mfma_f32_16x16x32_bf16 v[204:207], v[160:163], v[32:35], 0
    v_exp_f32 v190, v190
    v_mfma_f32_16x16x32_bf16 v[212:215], v[160:163], v[40:43], 0
    v_exp_f32 v191, v191
    v_mfma_f32_16x16x32_bf16 v[208:211], v[168:171], v[32:35], 0
    v_exp_f32 v192, v192
    v_mfma_f32_16x16x32_bf16 v[216:219], v[168:171], v[40:43], 0
    v_exp_f32 v193, v193
    v_mfma_f32_16x16x32_bf16 v[204:207], v[164:167], v[36:39], v[204:207]
    v_exp_f32 v194, v194
    v_mfma_f32_16x16x32_bf16 v[212:215], v[164:167], v[44:47], v[212:215]
    v_exp_f32 v195, v195
    v_mfma_f32_16x16x32_bf16 v[208:211], v[172:175], v[36:39], v[208:211]
    s_waitcnt lgkmcnt(0)
    v_bfi_b32 v236, 31, v246, v236
    v_bfi_b32 v237, 31, v246, v237
    v_readfirstlane_b32 s96, v238
    v_exp_f32 v196, v196
    v_mfma_f32_16x16x32_bf16 v[216:219], v[172:175], v[44:47], v[216:219]
    v_exp_f32 v197, v197
    v_smfmac_f32_16x16x64_bf16 v[104:107], v[184:187], v[220:227], v255
    v_exp_f32 v198, v198
    v_smfmac_f32_16x16x64_bf16 v[108:111], v[184:187], v[228:235], v255
    v_exp_f32 v199, v199
    v_mfma_f32_4x4x4_16b_bf16 v[188:191], v[242:243], v[242:243], v[188:191]
    v_exp_f32 v200, v200
    v_mfma_f32_4x4x4_16b_bf16 v[192:195], v[242:243], v[242:243], v[192:195]
    v_exp_f32 v201, v201
    v_mfma_f32_4x4x4_16b_bf16 v[196:199], v[242:243], v[242:243], v[196:199]
    v_exp_f32 v202, v202
    v_mfma_f32_16x16x32_bf16 v[220:223], v[176:179], v[88:91], 0
    ds_read_b64_tr_b16 v[184:185], v236
    ds_read_b64_tr_b16 v[186:187], v237
    ds_read_u16 v252, v250 offset:128
    ds_read_u16 v253, v250 offset:192
    v_exp_f32 v203, v203
    v_mfma_f32_16x16x32_bf16 v[228:231], v[176:179], v[92:95], 0
    s_ashr_i32 s96, s96, 24
    s_mul_i32 s96, s96, s101
    v_rcp_f32 v188, v188
    v_mfma_f32_16x16x32_bf16 v[224:227], v[180:183], v[88:91], 0
    v_rcp_f32 v189, v189
    v_mfma_f32_4x4x4_16b_bf16 v[200:203], v[242:243], v[242:243], v[200:203]
    v_rcp_f32 v190, v190
    v_mfma_f32_16x16x32_bf16 v[232:235], v[180:183], v[92:95], 0
    v_rcp_f32 v191, v191
    v_mfma_f32_16x16x32_bf16 v[220:223], v[160:163], v[16:19], v[220:223]
    v_rcp_f32 v192, v192
    v_mfma_f32_16x16x32_bf16 v[228:231], v[160:163], v[24:27], v[228:231]
    v_rcp_f32 v193, v193
    v_mfma_f32_16x16x32_bf16 v[224:227], v[168:171], v[16:19], v[224:227]
    s_waitcnt lgkmcnt(0)
    v_bfi_b32 v252, 31, v245, v252
    v_bfi_b32 v253, 31, v245, v253
    v_max_u32 v252, v252, v245
    v_max_u32 v253, v253, v247
    ds_read_b128 v[236:239], v248 offset:1280
    ds_read_b32 v240, v249 offset:1280
    s_add_u32 s16, s16, 1
    v_rcp_f32 v194, v194
    v_mfma_f32_16x16x32_bf16 v[232:235], v[168:171], v[24:27], v[232:235]
    v_lshl_add_u64 v[248:249], v[248:249], 0, s[94:95]
    v_lshl_add_u64 v[250:251], v[250:251], 0, s[94:95]
    v_rcp_f32 v195, v195
    v_mfma_f32_16x16x32_bf16 v[220:223], v[164:167], v[20:23], v[220:223]
    v_rcp_f32 v196, v196
    v_mfma_f32_16x16x32_bf16 v[228:231], v[164:167], v[28:31], v[228:231]
    v_rcp_f32 v197, v197
    s_setprio 3
    v_mfma_f32_16x16x32_bf16 v[224:227], v[172:175], v[20:23], v[224:227]
    v_rcp_f32 v198, v198
    v_mfma_f32_16x16x32_bf16 v[232:235], v[172:175], v[28:31], v[232:235]
    v_rcp_f32 v199, v199
    v_rcp_f32 v200, v200
    v_rcp_f32 v201, v201
    v_rcp_f32 v202, v202
    v_rcp_f32 v203, v203
    v_pk_mul_f32 v[204:205], v[188:189], v[204:205]
    v_pk_mul_f32 v[206:207], v[190:191], v[206:207]
    v_pk_mul_f32 v[208:209], v[192:193], v[208:209]
    v_pk_mul_f32 v[210:211], v[194:195], v[210:211]
    v_pk_mul_f32 v[212:213], v[196:197], v[212:213]
    v_pk_mul_f32 v[214:215], v[198:199], v[214:215]
    v_pk_mul_f32 v[216:217], v[200:201], v[216:217]
    v_pk_mul_f32 v[218:219], v[202:203], v[218:219]
    s_cmp_ge_i32 s96, 1
    s_cbranch_scc1 L_PB11
L_PB10:
    s_setprio 0
    v_smfmac_f32_16x16x64_bf16 v[144:147], v[184:187], v[204:211], v255
    v_exp_f32 v220, v220
    v_smfmac_f32_16x16x64_bf16 v[148:151], v[184:187], v[212:219], v255
    v_exp_f32 v221, v221
    s_waitcnt vmcnt(0)
    ds_read_b128 v[176:179], v252
    ds_read_b128 v[180:183], v253
    v_mfma_f32_16x16x32_bf16 v[204:207], v[160:163], v[48:51], 0
    v_exp_f32 v222, v222
    v_mfma_f32_16x16x32_bf16 v[212:215], v[160:163], v[56:59], 0
    ds_read_b128 v[160:163], v244 offset:0
    v_exp_f32 v223, v223
    v_mfma_f32_16x16x32_bf16 v[208:211], v[168:171], v[48:51], 0
    v_exp_f32 v224, v224
    v_mfma_f32_16x16x32_bf16 v[216:219], v[168:171], v[56:59], 0
    ds_read_b128 v[168:171], v244 offset:512
    v_exp_f32 v225, v225
    v_mfma_f32_16x16x32_bf16 v[204:207], v[164:167], v[52:55], v[204:207]
    v_exp_f32 v226, v226
    v_mfma_f32_16x16x32_bf16 v[212:215], v[164:167], v[60:63], v[212:215]
    ds_read_b128 v[164:167], v244 offset:64
    v_exp_f32 v227, v227
    v_mfma_f32_16x16x32_bf16 v[208:211], v[172:175], v[52:55], v[208:211]
    v_exp_f32 v228, v228
    v_mfma_f32_16x16x32_bf16 v[216:219], v[172:175], v[60:63], v[216:219]
    ds_read_b128 v[172:175], v244 offset:576
    v_exp_f32 v229, v229
    v_smfmac_f32_16x16x64_bf16 v[128:131], v[184:187], v[188:195], v255
    v_exp_f32 v230, v230
    v_smfmac_f32_16x16x64_bf16 v[132:135], v[184:187], v[196:203], v255
    v_exp_f32 v231, v231
    v_mfma_f32_4x4x4_16b_bf16 v[220:223], v[242:243], v[242:243], v[220:223]
    v_exp_f32 v232, v232
    v_mfma_f32_4x4x4_16b_bf16 v[224:227], v[242:243], v[242:243], v[224:227]
    v_exp_f32 v233, v233
    v_mfma_f32_4x4x4_16b_bf16 v[228:231], v[242:243], v[242:243], v[228:231]
    v_exp_f32 v234, v234
    s_waitcnt lgkmcnt(4)
    v_mfma_f32_16x16x32_bf16 v[188:191], v[176:179], v[64:67], 0
    v_exp_f32 v235, v235
    v_mfma_f32_16x16x32_bf16 v[196:199], v[176:179], v[68:71], 0
    v_rcp_f32 v220, v220
    v_mfma_f32_16x16x32_bf16 v[192:195], v[180:183], v[64:67], 0
    v_rcp_f32 v221, v221
    v_mfma_f32_4x4x4_16b_bf16 v[232:235], v[242:243], v[242:243], v[232:235]
    v_rcp_f32 v222, v222
    v_mfma_f32_16x16x32_bf16 v[200:203], v[180:183], v[68:71], 0
    v_rcp_f32 v223, v223
    s_waitcnt lgkmcnt(3)
    v_mfma_f32_16x16x32_bf16 v[188:191], v[160:163], v[0:3], v[188:191]
    v_rcp_f32 v224, v224
    v_mfma_f32_16x16x32_bf16 v[196:199], v[160:163], v[8:11], v[196:199]
    v_rcp_f32 v225, v225
    s_waitcnt lgkmcnt(2)
    v_mfma_f32_16x16x32_bf16 v[192:195], v[168:171], v[0:3], v[192:195]
    v_rcp_f32 v226, v226
    v_mfma_f32_16x16x32_bf16 v[200:203], v[168:171], v[8:11], v[200:203]
    v_rcp_f32 v227, v227
    s_waitcnt lgkmcnt(1)
    v_mfma_f32_16x16x32_bf16 v[188:191], v[164:167], v[4:7], v[188:191]
    v_rcp_f32 v228, v228
    v_mfma_f32_16x16x32_bf16 v[196:199], v[164:167], v[12:15], v[196:199]
    v_rcp_f32 v229, v229
    s_setprio 3
    s_waitcnt lgkmcnt(0)
    v_mfma_f32_16x16x32_bf16 v[192:195], v[172:175], v[4:7], v[192:195]
    s_cmp_lt_u32 s16, s17
    s_cbranch_scc0 L_ND10
    s_add_u32 m0, s13, 0
    v_mad_u32_u16 v236, v236, s15, v243
    buffer_load_dwordx4 v236, s[40:43], 0 offen lds
    s_add_u32 m0, s13, 1056
    v_mad_u32_u16 v237, v237, s15, v243
    buffer_load_dwordx4 v237, s[40:43], 0 offen lds
    s_add_u32 m0, s13, 2112
    v_mad_u32_u16 v238, v238, s15, v243
    buffer_load_dwordx4 v238, s[40:43], 0 offen lds
    s_add_u32 m0, s13, 3168
    v_mad_u32_u16 v239, v239, s15, v243
    buffer_load_dwordx4 v239, s[40:43], 0 offen lds
    s_mov_b32 m0, s14
    s_nop 0
    buffer_load_dwordx4 v[240:241], s[44:47], 0 idxen offen lds
L_ND10:
    v_rcp_f32 v230, v230
    v_mfma_f32_16x16x32_bf16 v[200:203], v[172:175], v[12:15], v[200:203]
    v_rcp_f32 v231, v231
    v_rcp_f32 v232, v232
    v_rcp_f32 v233, v233
    v_rcp_f32 v234, v234
    v_rcp_f32 v235, v235
    v_pk_mul_f32 v[204:205], v[220:221], v[204:205]
    v_pk_mul_f32 v[206:207], v[222:223], v[206:207]
    v_pk_mul_f32 v[208:209], v[224:225], v[208:209]
    v_pk_mul_f32 v[210:211], v[226:227], v[210:211]
    v_pk_mul_f32 v[212:213], v[228:229], v[212:213]
    v_pk_mul_f32 v[214:215], v[230:231], v[214:215]
    v_pk_mul_f32 v[216:217], v[232:233], v[216:217]
    v_pk_mul_f32 v[218:219], v[234:235], v[218:219]
    s_cmp_lt_u32 s16, s17
    s_cbranch_scc1 L_LOOP0
    s_branch L_LT0
L_LT0:
    s_cmp_lg_u32 s99, 0
    s_cbranch_scc1 L_LH0
    s_setprio 0
    v_smfmac_f32_16x16x64_bf16 v[152:155], v[184:187], v[204:211], v255
    ds_read_u16 v236, v251 offset:0
    ds_read_u16 v237, v251 offset:16
    v_exp_f32 v188, v188
    v_smfmac_f32_16x16x64_bf16 v[156:159], v[184:187], v[212:219], v255
    v_exp_f32 v189, v189
    v_mfma_f32_16x16x32_bf16 v[204:207], v[160:163], v[32:35], 0
    v_exp_f32 v190, v190
    v_mfma_f32_16x16x32_bf16 v[212:215], v[160:163], v[40:43], 0
    v_exp_f32 v191, v191
    v_mfma_f32_16x16x32_bf16 v[208:211], v[168:171], v[32:35], 0
    v_exp_f32 v192, v192
    v_mfma_f32_16x16x32_bf16 v[216:219], v[168:171], v[40:43], 0
    v_exp_f32 v193, v193
    v_mfma_f32_16x16x32_bf16 v[204:207], v[164:167], v[36:39], v[204:207]
    v_exp_f32 v194, v194
    v_mfma_f32_16x16x32_bf16 v[212:215], v[164:167], v[44:47], v[212:215]
    v_exp_f32 v195, v195
    v_mfma_f32_16x16x32_bf16 v[208:211], v[172:175], v[36:39], v[208:211]
    v_exp_f32 v196, v196
    v_mfma_f32_16x16x32_bf16 v[216:219], v[172:175], v[44:47], v[216:219]
    v_exp_f32 v197, v197
    v_smfmac_f32_16x16x64_bf16 v[136:139], v[184:187], v[220:227], v255
    s_waitcnt lgkmcnt(0)
    v_bfi_b32 v236, 31, v246, v236
    v_bfi_b32 v237, 31, v246, v237
    v_exp_f32 v198, v198
    s_setprio 3
    v_smfmac_f32_16x16x64_bf16 v[140:143], v[184:187], v[228:235], v255
    v_exp_f32 v199, v199
    v_exp_f32 v200, v200
    v_exp_f32 v201, v201
    v_exp_f32 v202, v202
    v_exp_f32 v203, v203
    v_pk_add_f32 v[188:189], v[188:189], 1.0 op_sel_hi:[1,0]
    v_pk_add_f32 v[190:191], v[190:191], 1.0 op_sel_hi:[1,0]
    v_pk_add_f32 v[192:193], v[192:193], 1.0 op_sel_hi:[1,0]
    v_pk_add_f32 v[194:195], v[194:195], 1.0 op_sel_hi:[1,0]
    v_pk_add_f32 v[196:197], v[196:197], 1.0 op_sel_hi:[1,0]
    v_pk_add_f32 v[198:199], v[198:199], 1.0 op_sel_hi:[1,0]
    v_pk_add_f32 v[200:201], v[200:201], 1.0 op_sel_hi:[1,0]
    v_pk_add_f32 v[202:203], v[202:203], 1.0 op_sel_hi:[1,0]
    s_setprio 0
    v_mfma_f32_16x16x32_bf16 v[220:223], v[176:179], v[72:75], 0
    ds_read_b64_tr_b16 v[184:185], v236
    ds_read_b64_tr_b16 v[186:187], v237
    v_rcp_f32 v188, v188
    v_mfma_f32_16x16x32_bf16 v[228:231], v[176:179], v[76:79], 0
    v_rcp_f32 v189, v189
    v_mfma_f32_16x16x32_bf16 v[224:227], v[180:183], v[72:75], 0
    v_rcp_f32 v190, v190
    v_mfma_f32_16x16x32_bf16 v[232:235], v[180:183], v[76:79], 0
    v_rcp_f32 v191, v191
    v_mfma_f32_16x16x32_bf16 v[220:223], v[160:163], v[16:19], v[220:223]
    v_rcp_f32 v192, v192
    v_mfma_f32_16x16x32_bf16 v[228:231], v[160:163], v[24:27], v[228:231]
    v_rcp_f32 v193, v193
    v_mfma_f32_16x16x32_bf16 v[224:227], v[168:171], v[16:19], v[224:227]
    v_rcp_f32 v194, v194
    v_mfma_f32_16x16x32_bf16 v[232:235], v[168:171], v[24:27], v[232:235]
    v_rcp_f32 v195, v195
    v_mfma_f32_16x16x32_bf16 v[220:223], v[164:167], v[20:23], v[220:223]
    v_rcp_f32 v196, v196
    v_mfma_f32_16x16x32_bf16 v[228:231], v[164:167], v[28:31], v[228:231]
    v_rcp_f32 v197, v197
    v_mfma_f32_16x16x32_bf16 v[224:227], v[172:175], v[20:23], v[224:227]
    v_rcp_f32 v198, v198
    s_setprio 3
    v_mfma_f32_16x16x32_bf16 v[232:235], v[172:175], v[28:31], v[232:235]
    v_rcp_f32 v199, v199
    v_rcp_f32 v200, v200
    v_rcp_f32 v201, v201
    v_rcp_f32 v202, v202
    v_rcp_f32 v203, v203
    v_pk_mul_f32 v[204:205], v[188:189], v[204:205]
    v_pk_mul_f32 v[206:207], v[190:191], v[206:207]
    v_pk_mul_f32 v[208:209], v[192:193], v[208:209]
    v_pk_mul_f32 v[210:211], v[194:195], v[210:211]
    v_pk_mul_f32 v[212:213], v[196:197], v[212:213]
    v_pk_mul_f32 v[214:215], v[198:199], v[214:215]
    v_pk_mul_f32 v[216:217], v[200:201], v[216:217]
    v_pk_mul_f32 v[218:219], v[202:203], v[218:219]
    s_setprio 0
    s_waitcnt lgkmcnt(0)
    v_smfmac_f32_16x16x64_bf16 v[112:115], v[184:187], v[204:211], v255
    v_exp_f32 v220, v220
    v_smfmac_f32_16x16x64_bf16 v[116:119], v[184:187], v[212:219], v255
    v_exp_f32 v221, v221
    v_mfma_f32_16x16x32_bf16 v[204:207], v[160:163], v[48:51], 0
    v_exp_f32 v222, v222
    v_mfma_f32_16x16x32_bf16 v[212:215], v[160:163], v[56:59], 0
    v_exp_f32 v223, v223
    v_mfma_f32_16x16x32_bf16 v[208:211], v[168:171], v[48:51], 0
    v_exp_f32 v224, v224
    v_mfma_f32_16x16x32_bf16 v[216:219], v[168:171], v[56:59], 0
    v_exp_f32 v225, v225
    v_mfma_f32_16x16x32_bf16 v[204:207], v[164:167], v[52:55], v[204:207]
    v_exp_f32 v226, v226
    v_mfma_f32_16x16x32_bf16 v[212:215], v[164:167], v[60:63], v[212:215]
    v_exp_f32 v227, v227
    v_mfma_f32_16x16x32_bf16 v[208:211], v[172:175], v[52:55], v[208:211]
    v_exp_f32 v228, v228
    v_mfma_f32_16x16x32_bf16 v[216:219], v[172:175], v[60:63], v[216:219]
    v_exp_f32 v229, v229
    v_smfmac_f32_16x16x64_bf16 v[96:99], v[184:187], v[188:195], v255
    v_exp_f32 v230, v230
    s_setprio 3
    v_smfmac_f32_16x16x64_bf16 v[100:103], v[184:187], v[196:203], v255
    v_exp_f32 v231, v231
    v_exp_f32 v232, v232
    v_exp_f32 v233, v233
    v_exp_f32 v234, v234
    v_exp_f32 v235, v235
    v_pk_add_f32 v[220:221], v[220:221], 1.0 op_sel_hi:[1,0]
    v_pk_add_f32 v[222:223], v[222:223], 1.0 op_sel_hi:[1,0]
    v_pk_add_f32 v[224:225], v[224:225], 1.0 op_sel_hi:[1,0]
    v_pk_add_f32 v[226:227], v[226:227], 1.0 op_sel_hi:[1,0]
    v_pk_add_f32 v[228:229], v[228:229], 1.0 op_sel_hi:[1,0]
    v_pk_add_f32 v[230:231], v[230:231], 1.0 op_sel_hi:[1,0]
    v_pk_add_f32 v[232:233], v[232:233], 1.0 op_sel_hi:[1,0]
    v_pk_add_f32 v[234:235], v[234:235], 1.0 op_sel_hi:[1,0]
    s_setprio 0
    v_rcp_f32 v220, v220
    v_rcp_f32 v221, v221
    v_rcp_f32 v222, v222
    v_rcp_f32 v223, v223
    v_rcp_f32 v224, v224
    v_rcp_f32 v225, v225
    v_rcp_f32 v226, v226
    v_rcp_f32 v227, v227
    v_rcp_f32 v228, v228
    v_rcp_f32 v229, v229
    v_rcp_f32 v230, v230
    v_rcp_f32 v231, v231
    v_rcp_f32 v232, v232
    v_rcp_f32 v233, v233
    v_rcp_f32 v234, v234
    v_rcp_f32 v235, v235
    v_pk_mul_f32 v[204:205], v[220:221], v[204:205]
    v_pk_mul_f32 v[206:207], v[222:223], v[206:207]
    v_pk_mul_f32 v[208:209], v[224:225], v[208:209]
    v_pk_mul_f32 v[210:211], v[226:227], v[210:211]
    v_pk_mul_f32 v[212:213], v[228:229], v[212:213]
    v_pk_mul_f32 v[214:215], v[230:231], v[214:215]
    v_pk_mul_f32 v[216:217], v[232:233], v[216:217]
    v_pk_mul_f32 v[218:219], v[234:235], v[218:219]
    v_smfmac_f32_16x16x64_bf16 v[104:107], v[184:187], v[220:227], v255
    v_smfmac_f32_16x16x64_bf16 v[108:111], v[184:187], v[228:235], v255
    v_smfmac_f32_16x16x64_bf16 v[120:123], v[184:187], v[204:211], v255
    v_smfmac_f32_16x16x64_bf16 v[124:127], v[184:187], v[212:219], v255
    s_branch L_DONE
L_LH0:
    s_setprio 0
    v_smfmac_f32_16x16x64_bf16 v[152:155], v[184:187], v[204:211], v255
    ds_read_u16 v236, v251 offset:0
    ds_read_u16 v237, v251 offset:16
    v_smfmac_f32_16x16x64_bf16 v[156:159], v[184:187], v[212:219], v255
    v_exp_f32 v188, v188
    v_mfma_f32_16x16x32_bf16 v[204:207], v[160:163], v[32:35], 0
    v_mfma_f32_16x16x32_bf16 v[212:215], v[160:163], v[40:43], 0
    v_exp_f32 v189, v189
    v_mfma_f32_16x16x32_bf16 v[204:207], v[164:167], v[36:39], v[204:207]
    v_mfma_f32_16x16x32_bf16 v[212:215], v[164:167], v[44:47], v[212:215]
    v_exp_f32 v190, v190
    v_smfmac_f32_16x16x64_bf16 v[136:139], v[184:187], v[220:227], v255
    s_waitcnt lgkmcnt(0)
    v_bfi_b32 v236, 31, v246, v236
    v_bfi_b32 v237, 31, v246, v237
    v_exp_f32 v191, v191
    s_setprio 3
    v_smfmac_f32_16x16x64_bf16 v[140:143], v[184:187], v[228:235], v255
    v_exp_f32 v196, v196
    v_exp_f32 v197, v197
    v_exp_f32 v198, v198
    v_exp_f32 v199, v199
    v_pk_add_f32 v[188:189], v[188:189], 1.0 op_sel_hi:[1,0]
    v_pk_add_f32 v[190:191], v[190:191], 1.0 op_sel_hi:[1,0]
    v_pk_add_f32 v[196:197], v[196:197], 1.0 op_sel_hi:[1,0]
    v_pk_add_f32 v[198:199], v[198:199], 1.0 op_sel_hi:[1,0]
    s_setprio 0
    v_mfma_f32_16x16x32_bf16 v[220:223], v[176:179], v[72:75], 0
    ds_read_b64_tr_b16 v[184:185], v236
    ds_read_b64_tr_b16 v[186:187], v237
    v_mfma_f32_16x16x32_bf16 v[228:231], v[176:179], v[76:79], 0
    v_rcp_f32 v188, v188
    v_mfma_f32_16x16x32_bf16 v[220:223], v[160:163], v[16:19], v[220:223]
    v_rcp_f32 v189, v189
    v_mfma_f32_16x16x32_bf16 v[228:231], v[160:163], v[24:27], v[228:231]
    v_rcp_f32 v190, v190
    v_mfma_f32_16x16x32_bf16 v[220:223], v[164:167], v[20:23], v[220:223]
    v_rcp_f32 v191, v191
    s_setprio 3
    v_mfma_f32_16x16x32_bf16 v[228:231], v[164:167], v[28:31], v[228:231]
    v_rcp_f32 v196, v196
    v_rcp_f32 v197, v197
    v_rcp_f32 v198, v198
    v_rcp_f32 v199, v199
    v_pk_mul_f32 v[204:205], v[188:189], v[204:205]
    v_pk_mul_f32 v[206:207], v[190:191], v[206:207]
    v_pk_mul_f32 v[212:213], v[196:197], v[212:213]
    v_pk_mul_f32 v[214:215], v[198:199], v[214:215]
    s_setprio 0
    s_waitcnt lgkmcnt(0)
    v_smfmac_f32_16x16x64_bf16 v[112:115], v[184:187], v[204:211], v255
    v_smfmac_f32_16x16x64_bf16 v[116:119], v[184:187], v[212:219], v255
    v_exp_f32 v220, v220
    v_mfma_f32_16x16x32_bf16 v[204:207], v[160:163], v[48:51], 0
    v_mfma_f32_16x16x32_bf16 v[212:215], v[160:163], v[56:59], 0
    v_exp_f32 v221, v221
    v_mfma_f32_16x16x32_bf16 v[204:207], v[164:167], v[52:55], v[204:207]
    v_mfma_f32_16x16x32_bf16 v[212:215], v[164:167], v[60:63], v[212:215]
    v_exp_f32 v222, v222
    v_smfmac_f32_16x16x64_bf16 v[96:99], v[184:187], v[188:195], v255
    v_exp_f32 v223, v223
    s_setprio 3
    v_smfmac_f32_16x16x64_bf16 v[100:103], v[184:187], v[196:203], v255
    v_exp_f32 v228, v228
    v_exp_f32 v229, v229
    v_exp_f32 v230, v230
    v_exp_f32 v231, v231
    v_pk_add_f32 v[220:221], v[220:221], 1.0 op_sel_hi:[1,0]
    v_pk_add_f32 v[222:223], v[222:223], 1.0 op_sel_hi:[1,0]
    v_pk_add_f32 v[228:229], v[228:229], 1.0 op_sel_hi:[1,0]
    v_pk_add_f32 v[230:231], v[230:231], 1.0 op_sel_hi:[1,0]
    s_setprio 0
    v_rcp_f32 v220, v220
    v_rcp_f32 v221, v221
    v_rcp_f32 v222, v222
    v_rcp_f32 v223, v223
    v_rcp_f32 v228, v228
    v_rcp_f32 v229, v229
    v_rcp_f32 v230, v230
    v_rcp_f32 v231, v231
    v_pk_mul_f32 v[204:205], v[220:221], v[204:205]
    v_pk_mul_f32 v[206:207], v[222:223], v[206:207]
    v_pk_mul_f32 v[212:213], v[228:229], v[212:213]
    v_pk_mul_f32 v[214:215], v[230:231], v[214:215]
    v_smfmac_f32_16x16x64_bf16 v[104:107], v[184:187], v[220:227], v255
    v_smfmac_f32_16x16x64_bf16 v[108:111], v[184:187], v[228:235], v255
    v_smfmac_f32_16x16x64_bf16 v[120:123], v[184:187], v[204:211], v255
    v_smfmac_f32_16x16x64_bf16 v[124:127], v[184:187], v[212:219], v255
    s_branch L_DONE
L_LT1:
    s_cmp_lg_u32 s99, 0
    s_cbranch_scc1 L_LH1
    s_setprio 0
    v_smfmac_f32_16x16x64_bf16 v[120:123], v[184:187], v[204:211], v255
    ds_read_u16 v236, v251 offset:1152
    ds_read_u16 v237, v251 offset:1168
    v_exp_f32 v188, v188
    v_smfmac_f32_16x16x64_bf16 v[124:127], v[184:187], v[212:219], v255
    v_exp_f32 v189, v189
    v_mfma_f32_16x16x32_bf16 v[204:207], v[160:163], v[32:35], 0
    v_exp_f32 v190, v190
    v_mfma_f32_16x16x32_bf16 v[212:215], v[160:163], v[40:43], 0
    v_exp_f32 v191, v191
    v_mfma_f32_16x16x32_bf16 v[208:211], v[168:171], v[32:35], 0
    v_exp_f32 v192, v192
    v_mfma_f32_16x16x32_bf16 v[216:219], v[168:171], v[40:43], 0
    v_exp_f32 v193, v193
    v_mfma_f32_16x16x32_bf16 v[204:207], v[164:167], v[36:39], v[204:207]
    v_exp_f32 v194, v194
    v_mfma_f32_16x16x32_bf16 v[212:215], v[164:167], v[44:47], v[212:215]
    v_exp_f32 v195, v195
    v_mfma_f32_16x16x32_bf16 v[208:211], v[172:175], v[36:39], v[208:211]
    v_exp_f32 v196, v196
    v_mfma_f32_16x16x32_bf16 v[216:219], v[172:175], v[44:47], v[216:219]
    v_exp_f32 v197, v197
    v_smfmac_f32_16x16x64_bf16 v[104:107], v[184:187], v[220:227], v255
    s_waitcnt lgkmcnt(0)
    v_bfi_b32 v236, 31, v246, v236
    v_bfi_b32 v237, 31, v246, v237
    v_exp_f32 v198, v198
    s_setprio 3
    v_smfmac_f32_16x16x64_bf16 v[108:111], v[184:187], v[228:235], v255
    v_exp_f32 v199, v199
    v_exp_f32 v200, v200
    v_exp_f32 v201, v201
    v_exp_f32 v202, v202
    v_exp_f32 v203, v203
    v_pk_add_f32 v[188:189], v[188:189], 1.0 op_sel_hi:[1,0]
    v_pk_add_f32 v[190:191], v[190:191], 1.0 op_sel_hi:[1,0]
    v_pk_add_f32 v[192:193], v[192:193], 1.0 op_sel_hi:[1,0]
    v_pk_add_f32 v[194:195], v[194:195], 1.0 op_sel_hi:[1,0]
    v_pk_add_f32 v[196:197], v[196:197], 1.0 op_sel_hi:[1,0]
    v_pk_add_f32 v[198:199], v[198:199], 1.0 op_sel_hi:[1,0]
    v_pk_add_f32 v[200:201], v[200:201], 1.0 op_sel_hi:[1,0]
    v_pk_add_f32 v[202:203], v[202:203], 1.0 op_sel_hi:[1,0]
    s_setprio 0
    v_mfma_f32_16x16x32_bf16 v[220:223], v[176:179], v[88:91], 0
    ds_read_b64_tr_b16 v[184:185], v236
    ds_read_b64_tr_b16 v[186:187], v237
    v_rcp_f32 v188, v188
    v_mfma_f32_16x16x32_bf16 v[228:231], v[176:179], v[92:95], 0
    v_rcp_f32 v189, v189
    v_mfma_f32_16x16x32_bf16 v[224:227], v[180:183], v[88:91], 0
    v_rcp_f32 v190, v190
    v_mfma_f32_16x16x32_bf16 v[232:235], v[180:183], v[92:95], 0
    v_rcp_f32 v191, v191
    v_mfma_f32_16x16x32_bf16 v[220:223], v[160:163], v[16:19], v[220:223]
    v_rcp_f32 v192, v192
    v_mfma_f32_16x16x32_bf16 v[228:231], v[160:163], v[24:27], v[228:231]
    v_rcp_f32 v193, v193
    v_mfma_f32_16x16x32_bf16 v[224:227], v[168:171], v[16:19], v[224:227]
    v_rcp_f32 v194, v194
    v_mfma_f32_16x16x32_bf16 v[232:235], v[168:171], v[24:27], v[232:235]
    v_rcp_f32 v195, v195
    v_mfma_f32_16x16x32_bf16 v[220:223], v[164:167], v[20:23], v[220:223]
    v_rcp_f32 v196, v196
    v_mfma_f32_16x16x32_bf16 v[228:231], v[164:167], v[28:31], v[228:231]
    v_rcp_f32 v197, v197
    v_mfma_f32_16x16x32_bf16 v[224:227], v[172:175], v[20:23], v[224:227]
    v_rcp_f32 v198, v198
    s_setprio 3
    v_mfma_f32_16x16x32_bf16 v[232:235], v[172:175], v[28:31], v[232:235]
    v_rcp_f32 v199, v199
    v_rcp_f32 v200, v200
    v_rcp_f32 v201, v201
    v_rcp_f32 v202, v202
    v_rcp_f32 v203, v203
    v_pk_mul_f32 v[204:205], v[188:189], v[204:205]
    v_pk_mul_f32 v[206:207], v[190:191], v[206:207]
    v_pk_mul_f32 v[208:209], v[192:193], v[208:209]
    v_pk_mul_f32 v[210:211], v[194:195], v[210:211]
    v_pk_mul_f32 v[212:213], v[196:197], v[212:213]
    v_pk_mul_f32 v[214:215], v[198:199], v[214:215]
    v_pk_mul_f32 v[216:217], v[200:201], v[216:217]
    v_pk_mul_f32 v[218:219], v[202:203], v[218:219]
    s_setprio 0
    s_waitcnt lgkmcnt(0)
    v_smfmac_f32_16x16x64_bf16 v[144:147], v[184:187], v[204:211], v255
    v_exp_f32 v220, v220
    v_smfmac_f32_16x16x64_bf16 v[148:151], v[184:187], v[212:219], v255
    v_exp_f32 v221, v221
    v_mfma_f32_16x16x32_bf16 v[204:207], v[160:163], v[48:51], 0
    v_exp_f32 v222, v222
    v_mfma_f32_16x16x32_bf16 v[212:215], v[160:163], v[56:59], 0
    v_exp_f32 v223, v223
    v_mfma_f32_16x16x32_bf16 v[208:211], v[168:171], v[48:51], 0
    v_exp_f32 v224, v224
    v_mfma_f32_16x16x32_bf16 v[216:219], v[168:171], v[56:59], 0
    v_exp_f32 v225, v225
    v_mfma_f32_16x16x32_bf16 v[204:207], v[164:167], v[52:55], v[204:207]
    v_exp_f32 v226, v226
    v_mfma_f32_16x16x32_bf16 v[212:215], v[164:167], v[60:63], v[212:215]
    v_exp_f32 v227, v227
    v_mfma_f32_16x16x32_bf16 v[208:211], v[172:175], v[52:55], v[208:211]
    v_exp_f32 v228, v228
    v_mfma_f32_16x16x32_bf16 v[216:219], v[172:175], v[60:63], v[216:219]
    v_exp_f32 v229, v229
    v_smfmac_f32_16x16x64_bf16 v[128:131], v[184:187], v[188:195], v255
    v_exp_f32 v230, v230
    s_setprio 3
    v_smfmac_f32_16x16x64_bf16 v[132:135], v[184:187], v[196:203], v255
    v_exp_f32 v231, v231
    v_exp_f32 v232, v232
    v_exp_f32 v233, v233
    v_exp_f32 v234, v234
    v_exp_f32 v235, v235
    v_pk_add_f32 v[220:221], v[220:221], 1.0 op_sel_hi:[1,0]
    v_pk_add_f32 v[222:223], v[222:223], 1.0 op_sel_hi:[1,0]
    v_pk_add_f32 v[224:225], v[224:225], 1.0 op_sel_hi:[1,0]
    v_pk_add_f32 v[226:227], v[226:227], 1.0 op_sel_hi:[1,0]
    v_pk_add_f32 v[228:229], v[228:229], 1.0 op_sel_hi:[1,0]
    v_pk_add_f32 v[230:231], v[230:231], 1.0 op_sel_hi:[1,0]
    v_pk_add_f32 v[232:233], v[232:233], 1.0 op_sel_hi:[1,0]
    v_pk_add_f32 v[234:235], v[234:235], 1.0 op_sel_hi:[1,0]
    s_setprio 0
    v_rcp_f32 v220, v220
    v_rcp_f32 v221, v221
    v_rcp_f32 v222, v222
    v_rcp_f32 v223, v223
    v_rcp_f32 v224, v224
    v_rcp_f32 v225, v225
    v_rcp_f32 v226, v226
    v_rcp_f32 v227, v227
    v_rcp_f32 v228, v228
    v_rcp_f32 v229, v229
    v_rcp_f32 v230, v230
    v_rcp_f32 v231, v231
    v_rcp_f32 v232, v232
    v_rcp_f32 v233, v233
    v_rcp_f32 v234, v234
    v_rcp_f32 v235, v235
    v_pk_mul_f32 v[204:205], v[220:221], v[204:205]
    v_pk_mul_f32 v[206:207], v[222:223], v[206:207]
    v_pk_mul_f32 v[208:209], v[224:225], v[208:209]
    v_pk_mul_f32 v[210:211], v[226:227], v[210:211]
    v_pk_mul_f32 v[212:213], v[228:229], v[212:213]
    v_pk_mul_f32 v[214:215], v[230:231], v[214:215]
    v_pk_mul_f32 v[216:217], v[232:233], v[216:217]
    v_pk_mul_f32 v[218:219], v[234:235], v[218:219]
    v_smfmac_f32_16x16x64_bf16 v[136:139], v[184:187], v[220:227], v255
    v_smfmac_f32_16x16x64_bf16 v[140:143], v[184:187], v[228:235], v255
    v_smfmac_f32_16x16x64_bf16 v[152:155], v[184:187], v[204:211], v255
    v_smfmac_f32_16x16x64_bf16 v[156:159], v[184:187], v[212:219], v255
    s_branch L_DONE
L_LH1:
    s_setprio 0
    v_smfmac_f32_16x16x64_bf16 v[120:123], v[184:187], v[204:211], v255
    ds_read_u16 v236, v251 offset:1152
    ds_read_u16 v237, v251 offset:1168
    v_smfmac_f32_16x16x64_bf16 v[124:127], v[184:187], v[212:219], v255
    v_exp_f32 v188, v188
    v_mfma_f32_16x16x32_bf16 v[204:207], v[160:163], v[32:35], 0
    v_mfma_f32_16x16x32_bf16 v[212:215], v[160:163], v[40:43], 0
    v_exp_f32 v189, v189
    v_mfma_f32_16x16x32_bf16 v[204:207], v[164:167], v[36:39], v[204:207]
    v_mfma_f32_16x16x32_bf16 v[212:215], v[164:167], v[44:47], v[212:215]
    v_exp_f32 v190, v190
    v_smfmac_f32_16x16x64_bf16 v[104:107], v[184:187], v[220:227], v255
    s_waitcnt lgkmcnt(0)
    v_bfi_b32 v236, 31, v246, v236
    v_bfi_b32 v237, 31, v246, v237
    v_exp_f32 v191, v191
    s_setprio 3
    v_smfmac_f32_16x16x64_bf16 v[108:111], v[184:187], v[228:235], v255
    v_exp_f32 v196, v196
    v_exp_f32 v197, v197
    v_exp_f32 v198, v198
    v_exp_f32 v199, v199
    v_pk_add_f32 v[188:189], v[188:189], 1.0 op_sel_hi:[1,0]
    v_pk_add_f32 v[190:191], v[190:191], 1.0 op_sel_hi:[1,0]
    v_pk_add_f32 v[196:197], v[196:197], 1.0 op_sel_hi:[1,0]
    v_pk_add_f32 v[198:199], v[198:199], 1.0 op_sel_hi:[1,0]
    s_setprio 0
    v_mfma_f32_16x16x32_bf16 v[220:223], v[176:179], v[88:91], 0
    ds_read_b64_tr_b16 v[184:185], v236
    ds_read_b64_tr_b16 v[186:187], v237
    v_mfma_f32_16x16x32_bf16 v[228:231], v[176:179], v[92:95], 0
    v_rcp_f32 v188, v188
    v_mfma_f32_16x16x32_bf16 v[220:223], v[160:163], v[16:19], v[220:223]
    v_rcp_f32 v189, v189
    v_mfma_f32_16x16x32_bf16 v[228:231], v[160:163], v[24:27], v[228:231]
    v_rcp_f32 v190, v190
    v_mfma_f32_16x16x32_bf16 v[220:223], v[164:167], v[20:23], v[220:223]
    v_rcp_f32 v191, v191
    s_setprio 3
    v_mfma_f32_16x16x32_bf16 v[228:231], v[164:167], v[28:31], v[228:231]
    v_rcp_f32 v196, v196
    v_rcp_f32 v197, v197
    v_rcp_f32 v198, v198
    v_rcp_f32 v199, v199
    v_pk_mul_f32 v[204:205], v[188:189], v[204:205]
    v_pk_mul_f32 v[206:207], v[190:191], v[206:207]
    v_pk_mul_f32 v[212:213], v[196:197], v[212:213]
    v_pk_mul_f32 v[214:215], v[198:199], v[214:215]
    s_setprio 0
    s_waitcnt lgkmcnt(0)
    v_smfmac_f32_16x16x64_bf16 v[144:147], v[184:187], v[204:211], v255
    v_smfmac_f32_16x16x64_bf16 v[148:151], v[184:187], v[212:219], v255
    v_exp_f32 v220, v220
    v_mfma_f32_16x16x32_bf16 v[204:207], v[160:163], v[48:51], 0
    v_mfma_f32_16x16x32_bf16 v[212:215], v[160:163], v[56:59], 0
    v_exp_f32 v221, v221
    v_mfma_f32_16x16x32_bf16 v[204:207], v[164:167], v[52:55], v[204:207]
    v_mfma_f32_16x16x32_bf16 v[212:215], v[164:167], v[60:63], v[212:215]
    v_exp_f32 v222, v222
    v_smfmac_f32_16x16x64_bf16 v[128:131], v[184:187], v[188:195], v255
    v_exp_f32 v223, v223
    s_setprio 3
    v_smfmac_f32_16x16x64_bf16 v[132:135], v[184:187], v[196:203], v255
    v_exp_f32 v228, v228
    v_exp_f32 v229, v229
    v_exp_f32 v230, v230
    v_exp_f32 v231, v231
    v_pk_add_f32 v[220:221], v[220:221], 1.0 op_sel_hi:[1,0]
    v_pk_add_f32 v[222:223], v[222:223], 1.0 op_sel_hi:[1,0]
    v_pk_add_f32 v[228:229], v[228:229], 1.0 op_sel_hi:[1,0]
    v_pk_add_f32 v[230:231], v[230:231], 1.0 op_sel_hi:[1,0]
    s_setprio 0
    v_rcp_f32 v220, v220
    v_rcp_f32 v221, v221
    v_rcp_f32 v222, v222
    v_rcp_f32 v223, v223
    v_rcp_f32 v228, v228
    v_rcp_f32 v229, v229
    v_rcp_f32 v230, v230
    v_rcp_f32 v231, v231
    v_pk_mul_f32 v[204:205], v[220:221], v[204:205]
    v_pk_mul_f32 v[206:207], v[222:223], v[206:207]
    v_pk_mul_f32 v[212:213], v[228:229], v[212:213]
    v_pk_mul_f32 v[214:215], v[230:231], v[214:215]
    v_smfmac_f32_16x16x64_bf16 v[136:139], v[184:187], v[220:227], v255
    v_smfmac_f32_16x16x64_bf16 v[140:143], v[184:187], v[228:235], v255
    v_smfmac_f32_16x16x64_bf16 v[152:155], v[184:187], v[204:211], v255
    v_smfmac_f32_16x16x64_bf16 v[156:159], v[184:187], v[212:219], v255
    s_branch L_DONE
L_DONE:
    v_mbcnt_lo_u32_b32 v247, -1, 0
    v_mbcnt_hi_u32_b32 v247, -1, v247
    v_and_b32 v246, 24, v246
    s_cmp_lg_u32 s19, 0
    s_cbranch_scc1 L_SLOW
L_EPI:
    s_waitcnt lgkmcnt(0)
    v_and_b32 v64, 48, v247
    v_and_b32 v67, 15, v247
    v_add_u32 v69, s72, v64
    v_lshl_add_u32 v70, v67, 2, s72
    ds_read_b128 v[80:83], v69 offset:0
    ds_read_b128 v[84:87], v69 offset:64
    ds_read2_b32 v[72:73], v70 offset0:0 offset1:16
    v_bfe_u32 v65, v247, 2, 3
    v_lshrrev_b32 v66, 5, v247
    v_lshl_add_u32 v65, v66, 4, v65
    v_mul_u32_u24 v65, 160, v65
    s_mov_b32 s10, 143488
    v_add3_u32 v65, v65, v246, s10
    ds_read_b64_tr_b16 v[0:1], v65 offset:0
    ds_read_b64_tr_b16 v[2:3], v65 offset:1280
    ds_read_b64_tr_b16 v[8:9], v65 offset:32
    ds_read_b64_tr_b16 v[10:11], v65 offset:1312
    ds_read_b64_tr_b16 v[16:17], v65 offset:64
    ds_read_b64_tr_b16 v[18:19], v65 offset:1344
    ds_read_b64_tr_b16 v[24:25], v65 offset:96
    ds_read_b64_tr_b16 v[26:27], v65 offset:1376
    ds_read_b64_tr_b16 v[4:5], v65 offset:5120
    ds_read_b64_tr_b16 v[6:7], v65 offset:6400
    ds_read_b64_tr_b16 v[12:13], v65 offset:5152
    ds_read_b64_tr_b16 v[14:15], v65 offset:6432
    s_movk_i32 s10, 832
    v_mad_u32_u24 v64, v246, s10, v64
    s_mov_b32 s10, 116736
    v_lshl_add_u32 v69, v67, 3, s10
    v_lshl_add_u32 v74, v67, 3, s73
    v_lshl_add_u32 v75, v67, 3, s74
    s_waitcnt lgkmcnt(8)
    ds_read_b64_tr_b16 v[20:21], v65 offset:5184
    ds_read_b64_tr_b16 v[22:23], v65 offset:6464
    ds_read_b64_tr_b16 v[28:29], v65 offset:5216
    ds_read_b64_tr_b16 v[30:31], v65 offset:6496
    v_add_u32 v76, v80, v69
    ds_read_b64 v[32:33], v76 offset:0
    v_add_u32 v76, v81, v69
    ds_read_b64 v[34:35], v76 offset:6656
    v_add_u32 v76, v82, v69
    ds_read_b64 v[36:37], v76 offset:13312
    v_add_u32 v76, v83, v69
    ds_read_b64 v[38:39], v76 offset:19968
    v_add_u32 v76, v84, v69
    ds_read_b64 v[40:41], v76 offset:0
    v_add_u32 v76, v85, v69
    ds_read_b64 v[42:43], v76 offset:6656
    v_add_u32 v76, v86, v69
    ds_read_b64 v[44:45], v76 offset:13312
    v_add_u32 v76, v87, v69
    ds_read_b64 v[46:47], v76 offset:19968
    v_add3_u32 v72, v72, v64, s10
    ds_read_b128 v[160:163], v72 offset:0
    ds_read_b128 v[164:167], v72 offset:64
    v_add3_u32 v73, v73, v64, s10
    ds_read_b128 v[168:171], v73 offset:0
    ds_read_b128 v[172:175], v73 offset:64
    s_waitcnt lgkmcnt(0)
    v_lshlrev_b32 v188, 16, v32
    v_lshlrev_b32 v189, 16, v34
    v_lshlrev_b32 v190, 16, v36
    v_lshlrev_b32 v191, 16, v38
    v_and_b32 v192, 0xffff0000, v32
    v_and_b32 v193, 0xffff0000, v34
    v_and_b32 v194, 0xffff0000, v36
    v_and_b32 v195, 0xffff0000, v38
    v_mfma_f32_16x16x32_bf16 v[188:191], v[160:163], v[0:3], v[188:191]
    v_lshlrev_b32 v196, 16, v33
    v_lshlrev_b32 v197, 16, v35
    v_lshlrev_b32 v198, 16, v37
    v_lshlrev_b32 v199, 16, v39
    v_lshl_add_u32 v80, v80, 2, v74
    v_mfma_f32_16x16x32_bf16 v[188:191], v[164:167], v[4:7], v[188:191]
    v_mfma_f32_16x16x32_bf16 v[192:195], v[160:163], v[8:11], v[192:195]
    v_and_b32 v200, 0xffff0000, v33
    v_and_b32 v201, 0xffff0000, v35
    v_and_b32 v202, 0xffff0000, v37
    v_and_b32 v203, 0xffff0000, v39
    v_lshl_add_u32 v81, v81, 2, v74
    v_mfma_f32_16x16x32_bf16 v[192:195], v[164:167], v[12:15], v[192:195]
    v_mfma_f32_16x16x32_bf16 v[196:199], v[160:163], v[16:19], v[196:199]
    v_lshlrev_b32 v48, 16, v40
    v_lshlrev_b32 v49, 16, v42
    v_lshlrev_b32 v50, 16, v44
    v_lshlrev_b32 v51, 16, v46
    v_lshl_add_u32 v82, v82, 2, v74
    v_mfma_f32_16x16x32_bf16 v[196:199], v[164:167], v[20:23], v[196:199]
    v_mfma_f32_16x16x32_bf16 v[200:203], v[160:163], v[24:27], v[200:203]
    v_and_b32 v52, 0xffff0000, v40
    v_and_b32 v53, 0xffff0000, v42
    v_and_b32 v54, 0xffff0000, v44
    v_and_b32 v55, 0xffff0000, v46
    v_lshl_add_u32 v83, v83, 2, v74
    v_mfma_f32_16x16x32_bf16 v[200:203], v[164:167], v[28:31], v[200:203]
    v_mfma_f32_16x16x32_bf16 v[48:51], v[168:171], v[0:3], v[48:51]
    v_lshlrev_b32 v56, 16, v41
    v_lshlrev_b32 v57, 16, v43
    v_lshlrev_b32 v58, 16, v45
    v_lshlrev_b32 v59, 16, v47
    v_lshl_add_u32 v84, v84, 2, v75
    v_mfma_f32_16x16x32_bf16 v[48:51], v[172:175], v[4:7], v[48:51]
    v_mfma_f32_16x16x32_bf16 v[52:55], v[168:171], v[8:11], v[52:55]
    v_and_b32 v60, 0xffff0000, v41
    v_and_b32 v61, 0xffff0000, v43
    v_and_b32 v62, 0xffff0000, v45
    v_and_b32 v63, 0xffff0000, v47
    v_lshl_add_u32 v85, v85, 2, v75
    v_mfma_f32_16x16x32_bf16 v[52:55], v[172:175], v[12:15], v[52:55]
    v_mfma_f32_16x16x32_bf16 v[56:59], v[168:171], v[16:19], v[56:59]
    v_lshl_add_u32 v86, v86, 2, v75
    v_mfma_f32_16x16x32_bf16 v[56:59], v[172:175], v[20:23], v[56:59]
    v_mfma_f32_16x16x32_bf16 v[60:63], v[168:171], v[24:27], v[60:63]
    v_lshl_add_u32 v87, v87, 2, v75
    v_mfma_f32_16x16x32_bf16 v[60:63], v[172:175], v[28:31], v[60:63]
L_EPB:
    s_setprio 0
    s_mov_b64 exec, s[76:77]
    s_and_b32 s11, s25, 19
    s_nop 2
    s_cmp_eq_u32 s11, 0
    s_cbranch_scc1 L_NS0
    s_cmp_eq_u32 s11, 1
    s_cbranch_scc1 L_NS1
    s_cmp_eq_u32 s11, 2
    s_cbranch_scc1 L_NS2
    s_cmp_eq_u32 s11, 3
    s_cbranch_scc1 L_NS3
L_NSR:
    s_mov_b64 exec, -1
    v_rcp_f32 v96, v96
    v_rcp_f32 v97, v97
    v_rcp_f32 v98, v98
    v_rcp_f32 v99, v99
    v_rcp_f32 v100, v100
    v_rcp_f32 v101, v101
    v_rcp_f32 v102, v102
    v_rcp_f32 v103, v103
    v_rcp_f32 v104, v104
    v_rcp_f32 v105, v105
    v_rcp_f32 v106, v106
    v_rcp_f32 v107, v107
    v_rcp_f32 v108, v108
    v_rcp_f32 v109, v109
    v_rcp_f32 v110, v110
    v_rcp_f32 v111, v111
    v_pk_fma_f32 v[112:113], v[112:113], v[96:97], v[188:189]
    v_pk_fma_f32 v[114:115], v[114:115], v[98:99], v[190:191]
    v_pk_fma_f32 v[116:117], v[116:117], v[100:101], v[192:193]
    v_pk_fma_f32 v[118:119], v[118:119], v[102:103], v[194:195]
    v_pk_fma_f32 v[120:121], v[120:121], v[104:105], v[196:197]
    v_pk_fma_f32 v[122:123], v[122:123], v[106:107], v[198:199]
    v_pk_fma_f32 v[124:125], v[124:125], v[108:109], v[200:201]
    v_pk_fma_f32 v[126:127], v[126:127], v[110:111], v[202:203]
    v_cvt_pk_bf16_f32 v96, v112, v116
    v_cvt_pk_bf16_f32 v97, v120, v124
    v_pk_max_f16 v96, v96, v32
    v_pk_max_f16 v97, v97, v33
    buffer_store_dwordx2 v[96:97], v80, s[48:51], 0 offen sc1
    v_cvt_pk_bf16_f32 v98, v113, v117
    v_cvt_pk_bf16_f32 v99, v121, v125
    v_pk_max_f16 v98, v98, v34
    v_pk_max_f16 v99, v99, v35
    buffer_store_dwordx2 v[98:99], v81, s[48:51], 0 offen sc1
    v_cvt_pk_bf16_f32 v100, v114, v118
    v_cvt_pk_bf16_f32 v101, v122, v126
    v_pk_max_f16 v100, v100, v36
    v_pk_max_f16 v101, v101, v37
    buffer_store_dwordx2 v[100:101], v82, s[48:51], 0 offen sc1
    v_cvt_pk_bf16_f32 v102, v115, v119
    v_cvt_pk_bf16_f32 v103, v123, v127
    v_pk_max_f16 v102, v102, v38
    v_pk_max_f16 v103, v103, v39
    buffer_store_dwordx2 v[102:103], v83, s[48:51], 0 offen sc1
    v_rcp_f32 v128, v128
    v_rcp_f32 v129, v129
    v_rcp_f32 v130, v130
    v_rcp_f32 v131, v131
    v_rcp_f32 v132, v132
    v_rcp_f32 v133, v133
    v_rcp_f32 v134, v134
    v_rcp_f32 v135, v135
    v_rcp_f32 v136, v136
    v_rcp_f32 v137, v137
    v_rcp_f32 v138, v138
    v_rcp_f32 v139, v139
    v_rcp_f32 v140, v140
    v_rcp_f32 v141, v141
    v_rcp_f32 v142, v142
    v_rcp_f32 v143, v143
    v_pk_fma_f32 v[144:145], v[144:145], v[128:129], v[48:49]
    v_pk_fma_f32 v[146:147], v[146:147], v[130:131], v[50:51]
    v_pk_fma_f32 v[148:149], v[148:149], v[132:133], v[52:53]
    v_pk_fma_f32 v[150:151], v[150:151], v[134:135], v[54:55]
    v_pk_fma_f32 v[152:153], v[152:153], v[136:137], v[56:57]
    v_pk_fma_f32 v[154:155], v[154:155], v[138:139], v[58:59]
    v_pk_fma_f32 v[156:157], v[156:157], v[140:141], v[60:61]
    v_pk_fma_f32 v[158:159], v[158:159], v[142:143], v[62:63]
    v_cvt_pk_bf16_f32 v128, v144, v148
    v_cvt_pk_bf16_f32 v129, v152, v156
    v_pk_max_f16 v128, v128, v40
    v_pk_max_f16 v129, v129, v41
    buffer_store_dwordx2 v[128:129], v84, s[60:63], 0 offen sc1
    v_cvt_pk_bf16_f32 v130, v145, v149
    v_cvt_pk_bf16_f32 v131, v153, v157
    v_pk_max_f16 v130, v130, v42
    v_pk_max_f16 v131, v131, v43
    buffer_store_dwordx2 v[130:131], v85, s[60:63], 0 offen sc1
    v_cvt_pk_bf16_f32 v132, v146, v150
    v_cvt_pk_bf16_f32 v133, v154, v158
    v_pk_max_f16 v132, v132, v44
    v_pk_max_f16 v133, v133, v45
    buffer_store_dwordx2 v[132:133], v86, s[60:63], 0 offen sc1
    v_cvt_pk_bf16_f32 v134, v147, v151
    v_cvt_pk_bf16_f32 v135, v155, v159
    v_pk_max_f16 v134, v134, v46
    v_pk_max_f16 v135, v135, v47
    buffer_store_dwordx2 v[134:135], v87, s[60:63], 0 offen sc1
L_END:
    s_endpgm
L_NS0:
    v_add_f32 v96, v96, v128
    v_add_f32 v100, v100, v132
    v_add_f32 v104, v104, v136
    v_add_f32 v108, v108, v140
    v_add_f32 v112, v112, v144
    v_add_f32 v116, v116, v148
    v_add_f32 v120, v120, v152
    v_add_f32 v124, v124, v156
    s_branch L_NSR
L_NS1:
    v_add_f32 v97, v97, v129
    v_add_f32 v101, v101, v133
    v_add_f32 v105, v105, v137
    v_add_f32 v109, v109, v141
    v_add_f32 v113, v113, v145
    v_add_f32 v117, v117, v149
    v_add_f32 v121, v121, v153
    v_add_f32 v125, v125, v157
    s_branch L_NSR
L_NS2:
    v_add_f32 v98, v98, v130
    v_add_f32 v102, v102, v134
    v_add_f32 v106, v106, v138
    v_add_f32 v110, v110, v142
    v_add_f32 v114, v114, v146
    v_add_f32 v118, v118, v150
    v_add_f32 v122, v122, v154
    v_add_f32 v126, v126, v158
    s_branch L_NSR
L_NS3:
    v_add_f32 v99, v99, v131
    v_add_f32 v103, v103, v135
    v_add_f32 v107, v107, v139
    v_add_f32 v111, v111, v143
    v_add_f32 v115, v115, v147
    v_add_f32 v119, v119, v151
    v_add_f32 v123, v123, v155
    v_add_f32 v127, v127, v159
    s_branch L_NSR
L_RT0:
    s_waitcnt vmcnt(0)
    s_add_u32 s100, s100, 1
    s_cmp_gt_u32 s100, 200000
    s_cbranch_scc1 L_END
    s_sleep 1
    buffer_load_dwordx4 v[128:131], v232, s[56:59], s26 offen sc1
    buffer_load_dwordx4 v[132:135], v232, s[56:59], s27 offen sc1
    buffer_load_dwordx4 v[136:139], v232, s[56:59], s28 offen sc1
    buffer_load_dwordx4 v[140:143], v232, s[56:59], s29 offen sc1
    s_waitcnt vmcnt(0)
    s_branch L_PW0
L_RT1:
    s_waitcnt vmcnt(0)
    s_add_u32 s100, s100, 1
    s_cmp_gt_u32 s100, 200000
    s_cbranch_scc1 L_END
    s_sleep 1
    buffer_load_dwordx4 v[132:135], v232, s[56:59], s27 offen sc1
    buffer_load_dwordx4 v[136:139], v232, s[56:59], s28 offen sc1
    buffer_load_dwordx4 v[140:143], v232, s[56:59], s29 offen sc1
    s_waitcnt vmcnt(0)
    s_branch L_PW1
L_RT2:
    s_waitcnt vmcnt(0)
    s_add_u32 s100, s100, 1
    s_cmp_gt_u32 s100, 200000
    s_cbranch_scc1 L_END
    s_sleep 1
    buffer_load_dwordx4 v[136:139], v232, s[56:59], s28 offen sc1
    buffer_load_dwordx4 v[140:143], v232, s[56:59], s29 offen sc1
    s_waitcnt vmcnt(0)
    s_branch L_PW2
L_RT3:
    s_waitcnt vmcnt(0)
    s_add_u32 s100, s100, 1
    s_cmp_gt_u32 s100, 200000
    s_cbranch_scc1 L_END
    s_sleep 1
    buffer_load_dwordx4 v[140:143], v232, s[56:59], s29 offen sc1
    s_waitcnt vmcnt(0)
    s_branch L_PW3
L_XT2B:
    s_add_u32 s100, s100, 1
    s_cmp_gt_u32 s100, 200000
    s_cbranch_scc1 L_END
    s_sleep 1
    s_mov_b64 exec, s[70:71]
    s_cbranch_execz L_XLb0
    s_movk_i32 s10, 0
    buffer_load_dwordx4 v[64:67], v232, s[60:63], s10 offen sc1
L_XLb0:
    s_mov_b64 exec, s[78:79]
    s_cbranch_execz L_XLb1
    s_movk_i32 s10, 8192
    buffer_load_dwordx4 v[68:71], v232, s[60:63], s10 offen sc1
L_XLb1:
    s_mov_b64 exec, s[86:87]
    s_cbranch_execz L_XLb2
    s_movk_i32 s10, 16384
    buffer_load_dwordx4 v[72:75], v232, s[60:63], s10 offen sc1
L_XLb2:
    s_mov_b64 exec, s[94:95]
    s_cbranch_execz L_XLb3
    s_movk_i32 s10, 24576
    buffer_load_dwordx4 v[76:79], v232, s[60:63], s10 offen sc1
L_XLb3:
    s_mov_b64 exec, -1
    s_waitcnt vmcnt(0)
    s_branch L_XT2
L_OVF:
    s_mov_b32 s20, 0
    s_mov_b32 s17, 0
    s_mov_b32 s30, 0
    s_mov_b32 s19, 4
    s_waitcnt lgkmcnt(0)
    s_branch L_CA
L_POVF:
    s_movk_i32 s11, 1986
    v_mul_u32_u24 v64, s11, v192
    v_lshrrev_b32 v64, 16, v64
    v_mul_u32_u24 v65, s11, v193
    v_lshrrev_b32 v65, 16, v65
    v_mul_u32_u24 v66, s11, v194
    v_lshrrev_b32 v66, 16, v66
    v_mul_u32_u24 v67, s11, v195
    v_lshrrev_b32 v67, 16, v67
    v_add_u32 v69, v64, v65
    v_add_u32 v70, v69, v66
    v_add_u32 v71, v70, v67
    v_mov_b32 v72, v71
    s_nop 1
    v_add_u32_dpp v72, v72, v72 row_shr:1 row_mask:0xf bank_mask:0xf bound_ctrl:0
    s_nop 1
    v_add_u32_dpp v72, v72, v72 row_shr:2 row_mask:0xf bank_mask:0xf bound_ctrl:0
    s_nop 1
    v_add_u32_dpp v72, v72, v72 row_shr:4 row_mask:0xf bank_mask:0xf bound_ctrl:0
    s_nop 1
    v_add_u32_dpp v72, v72, v72 row_shr:8 row_mask:0xf bank_mask:0xf bound_ctrl:0
    s_nop 1
    v_add_u32_dpp v72, v72, v72 row_bcast:15 row_mask:0xa bank_mask:0xf
    s_nop 1
    v_add_u32_dpp v72, v72, v72 row_bcast:31 row_mask:0xc bank_mask:0xf
    s_nop 0
    v_sub_u32 v68, v72, v71
    v_add_u32 v71, v68, v70
    v_add_u32 v70, v68, v69
    v_add_u32 v69, v68, v64
    v_lshl_or_b32 v68, v64, 16, v68
    v_lshl_or_b32 v69, v65, 16, v69
    v_lshl_or_b32 v70, v66, 16, v70
    v_lshl_or_b32 v71, v67, 16, v71
    v_add_u32 v72, 154752, v185
    ds_write_b128 v72, v[68:71]
    s_lshl_b32 s10, s2, 10
    s_add_u32 s10, s10, 24772608
    buffer_store_dwordx4 v[68:71], v185, s[52:55], s10 offen sc1
    v_and_b32 v74, 0x3fc, v136
    v_add_u32 v74, 154752, v74
    ds_read_u16 v74, v74
    v_and_b32 v75, 0x3fc, v137
    v_add_u32 v75, 154752, v75
    ds_read_u16 v75, v75
    v_and_b32 v76, 0x3fc, v138
    v_add_u32 v76, 154752, v76
    ds_read_u16 v76, v76
    v_and_b32 v77, 0x3fc, v139
    v_add_u32 v77, 154752, v77
    ds_read_u16 v77, v77
    v_and_b32 v78, 0x3fc, v140
    v_add_u32 v78, 154752, v78
    ds_read_u16 v78, v78
    v_and_b32 v79, 0x3fc, v141
    v_add_u32 v79, 154752, v79
    ds_read_u16 v79, v79
    v_and_b32 v80, 0x3fc, v142
    v_add_u32 v80, 154752, v80
    ds_read_u16 v80, v80
    v_and_b32 v81, 0x3fc, v143
    v_add_u32 v81, 154752, v81
    ds_read_u16 v81, v81
    s_waitcnt lgkmcnt(0)
    v_cmpx_lt_u32 vcc, 1056, v228
    v_or_b32 v205, 0x10000, v205
    s_mov_b64 exec, -1
    v_cmpx_lt_u32 vcc, 1056, v229
    v_or_b32 v209, 0x10000, v209
    s_mov_b64 exec, -1
    v_cmpx_lt_u32 vcc, 1056, v230
    v_or_b32 v213, 0x10000, v213
    s_mov_b64 exec, -1
    v_cmpx_lt_u32 vcc, 1056, v231
    v_or_b32 v217, 0x10000, v217
    s_mov_b64 exec, -1
    s_mul_i32 s10, s2, 4152
    s_mov_b32 s34, 18874368
    s_mov_b32 s35, 23592960
    v_mul_u32_u24 v64, s11, v112
    v_lshrrev_b32 v64, 16, v64
    v_add3_u32 v64, v64, v74, s10
    v_lshlrev_b32 v65, 2, v64
    v_cmpx_le_u32 vcc, 1056, v112
    s_cbranch_execz L_PO0
    buffer_store_byte v120, v64, s[52:55], s35 offen sc1
    buffer_store_dword v96, v65, s[52:55], s34 offen sc1
L_PO0:
    s_mov_b64 exec, -1
    v_mul_u32_u24 v64, s11, v113
    v_lshrrev_b32 v64, 16, v64
    v_add3_u32 v64, v64, v75, s10
    v_lshlrev_b32 v65, 2, v64
    v_cmpx_le_u32 vcc, 1056, v113
    s_cbranch_execz L_PO1
    buffer_store_byte v121, v64, s[52:55], s35 offen sc1
    buffer_store_dword v97, v65, s[52:55], s34 offen sc1
L_PO1:
    s_mov_b64 exec, -1
    v_mul_u32_u24 v64, s11, v114
    v_lshrrev_b32 v64, 16, v64
    v_add3_u32 v64, v64, v76, s10
    v_lshlrev_b32 v65, 2, v64
    v_cmpx_le_u32 vcc, 1056, v114
    s_cbranch_execz L_PO2
    buffer_store_byte v122, v64, s[52:55], s35 offen sc1
    buffer_store_dword v98, v65, s[52:55], s34 offen sc1
L_PO2:
    s_mov_b64 exec, -1
    v_mul_u32_u24 v64, s11, v115
    v_lshrrev_b32 v64, 16, v64
    v_add3_u32 v64, v64, v77, s10
    v_lshlrev_b32 v65, 2, v64
    v_cmpx_le_u32 vcc, 1056, v115
    s_cbranch_execz L_PO3
    buffer_store_byte v123, v64, s[52:55], s35 offen sc1
    buffer_store_dword v99, v65, s[52:55], s34 offen sc1
L_PO3:
    s_mov_b64 exec, -1
    v_mul_u32_u24 v64, s11, v116
    v_lshrrev_b32 v64, 16, v64
    v_add3_u32 v64, v64, v78, s10
    v_lshlrev_b32 v65, 2, v64
    v_cmpx_le_u32 vcc, 1056, v116
    s_cbranch_execz L_PO4
    buffer_store_byte v120, v64, s[52:55], s35 offen sc1
    buffer_store_dword v100, v65, s[52:55], s34 offen sc1
L_PO4:
    s_mov_b64 exec, -1
    v_mul_u32_u24 v64, s11, v117
    v_lshrrev_b32 v64, 16, v64
    v_add3_u32 v64, v64, v79, s10
    v_lshlrev_b32 v65, 2, v64
    v_cmpx_le_u32 vcc, 1056, v117
    s_cbranch_execz L_PO5
    buffer_store_byte v121, v64, s[52:55], s35 offen sc1
    buffer_store_dword v101, v65, s[52:55], s34 offen sc1
L_PO5:
    s_mov_b64 exec, -1
    v_mul_u32_u24 v64, s11, v118
    v_lshrrev_b32 v64, 16, v64
    v_add3_u32 v64, v64, v80, s10
    v_lshlrev_b32 v65, 2, v64
    v_cmpx_le_u32 vcc, 1056, v118
    s_cbranch_execz L_PO6
    buffer_store_byte v122, v64, s[52:55], s35 offen sc1
    buffer_store_dword v102, v65, s[52:55], s34 offen sc1
L_PO6:
    s_mov_b64 exec, -1
    v_mul_u32_u24 v64, s11, v119
    v_lshrrev_b32 v64, 16, v64
    v_add3_u32 v64, v64, v81, s10
    v_lshlrev_b32 v65, 2, v64
    v_cmpx_le_u32 vcc, 1056, v119
    s_cbranch_execz L_PO7
    buffer_store_byte v123, v64, s[52:55], s35 offen sc1
    buffer_store_dword v103, v65, s[52:55], s34 offen sc1
L_PO7:
    s_mov_b64 exec, -1
    s_waitcnt vmcnt(0) lgkmcnt(0)
    s_barrier
    s_branch L_POUT
L_SLOW:
    s_setprio 0
    s_lshl_b32 s10, s3, 6
    v_add_u32 v255, s10, v247
    s_cmp_lg_u32 s19, 4
    s_cbranch_scc1 L_SL1
    s_mov_b32 s19, 1
    v_and_b32 v188, 0xff, v255
    v_lshlrev_b32 v189, 7, v188
    buffer_load_dword v190, v189, s[56:59], 0 offen offset:4 sc1
    v_lshlrev_b32 v189, 10, v188
    s_lshl_b32 s10, s5, 2
    s_add_u32 s10, s10, 24772608
    buffer_load_dword v191, v189, s[52:55], s10 offen sc1
    v_lshlrev_b32 v188, 2, v188
    v_add_u32 v188, 154752, v188
    s_waitcnt vmcnt(0)
    v_and_b32 v190, 0x10000, v190
    v_cmp_ne_u32 vcc, 0, v190
    v_mov_b32 v190, 2097152
    s_nop 0
    v_cndmask_b32 v190, v190, v191, vcc
    ds_write_b32 v188, v190
    s_waitcnt lgkmcnt(0)
    s_barrier
L_SL1:
    s_add_u32 s28, s28, 288
    s_cmp_lt_u32 s28, s29
    s_cbranch_scc1 L_BATCH
L_FIND:
    s_cmp_lg_u64 s[32:33], 0
    s_cbranch_scc1 L_GOT
    s_add_u32 s26, s26, 1
    s_cmp_ge_u32 s26, 4
    s_cbranch_scc1 L_EPI
    s_lshl_b32 s10, s26, 8
    s_add_u32 s10, s10, 154752
    v_lshl_add_u32 v188, v247, 2, s10
    ds_read_u16 v188, v188 offset:2
    s_waitcnt lgkmcnt(0)
    v_cmp_lt_u32 s[32:33], s20, v188
    s_nop 3
    s_branch L_FIND
L_GOT:
    s_ff1_i32_b64 s10, s[32:33]
    s_bitset0_b64 s[32:33], s10
    s_lshl_b32 s11, s26, 6
    s_add_u32 s27, s10, s11
    s_lshl_b32 s10, s27, 2
    s_add_u32 s10, s10, 154752
    v_mov_b32 v188, s10
    ds_read_b32 v188, v188
    s_waitcnt lgkmcnt(0)
    v_readfirstlane_b32 s10, v188
    s_nop 3
    s_lshr_b32 s29, s10, 16
    s_and_b32 s30, s10, 0xffff
    s_mov_b32 s28, s20
L_BATCH:
    s_waitcnt vmcnt(0)
    s_barrier
    v_mov_b32 v192, 0x2000000
    v_mov_b32 v193, 0x2000000
    v_mov_b32 v194, 0x2000000
    v_mov_b32 v195, 0x2000000
    v_mov_b32 v196, 0xfffff
    v_mov_b32 v197, 0xfffff
    v_mov_b32 v198, 0xfffff
    v_mov_b32 v199, 0xfffff
    v_lshl_add_u32 v200, v247, 4, s12
    ds_write_b128 v200, v[192:195] offset:0
    ds_write_b128 v200, v[196:199] offset:18432
    ds_write_b128 v200, v[192:195] offset:1024
    ds_write_b128 v200, v[196:199] offset:19456
    ds_write_b128 v200, v[192:195] offset:1280
    ds_write_b128 v200, v[196:199] offset:19712
    v_and_b32 v188, 15, v247
    v_mul_u32_u24 v189, 1152, v188
    v_add_u32 v189, 8192, v189
    v_lshlrev_b32 v188, 2, v188
    ds_write_b32 v188, v189 offset:576
    v_add_u32 v188, s28, v255
    s_mul_i32 s36, s27, 3128
    s_mul_i32 s11, s27, 4152
    s_add_u32 s11, s11, s30
    s_lshl_b32 s34, s11, 2
    s_add_u32 s34, s34, 18874368
    v_lshl_add_u32 v190, v188, 2, s34
    s_add_u32 s34, s11, 23592960
    v_add_u32 v191, s34, v188
    s_mul_i32 s10, s5, 32896
    s_lshl_b32 s34, s27, 7
    s_add_u32 s10, s10, s34
    s_add_u32 s10, s10, 65536
    v_and_b32 v206, 7, v188
    v_lshl_add_u32 v206, v206, 4, s10
    v_lshrrev_b32 v207, 3, v188
    v_cmpx_gt_u32 vcc, 32, v188
    v_add_u32 v190, 8421376, v206
    v_add_u32 v191, 8, v190
    v_cmpx_gt_u32 vcc, 24, v188
    v_lshl_add_u32 v190, v207, 2, v206
    v_add3_u32 v191, v206, v207, 12
    s_mov_b64 exec, -1
    s_add_u32 s10, s28, 288
    s_min_u32 s10, s10, s29
    v_cmp_gt_u32 vcc, s10, v188
    v_mov_b32 v206, 0x7ffffff0
    s_nop 0
    v_cndmask_b32 v190, v206, v190, vcc
    v_cndmask_b32 v191, v206, v191, vcc
    buffer_load_dwordx2 v[204:205], v190, s[52:55], 0 offen sc1
    buffer_load_ubyte v191, v191, s[52:55], 0 offen sc1
    s_waitcnt lgkmcnt(0)
    s_barrier
    s_waitcnt vmcnt(0)
    v_cmp_ne_u32 vcc, 3, v207
    v_cmp_eq_u32 s[10:11], s6, v205
    v_mov_b32 v206, s36
    s_or_b64 exec, vcc, s[10:11]
    v_cmpx_ne_u32 vcc, 0, v204
    v_bfe_u32 v190, v204, 18, 8
    v_lshlrev_b32 v190, 2, v190
    v_add_u32 v188, 153728, v190
    ds_read_b32 v188, v188
    v_add_u32_sdwa v191, v191, v206 dst_sel:DWORD dst_unused:UNUSED_PAD src0_sel:BYTE_0 src1_sel:DWORD
    v_lshrrev_b32 v189, 28, v204
    v_lshl_add_u32 v191, v189, 8, v191
    v_and_b32 v189, 60, v190
    v_and_b32 v204, 0xffff, v204
    v_lshl_or_b32 v204, v189, 19, v204
    v_mov_b32 v190, 4
    s_waitcnt lgkmcnt(0)
    ds_add_rtn_u32 v188, v188, v190 offset:576
    s_waitcnt lgkmcnt(0)
    ds_write2st64_b32 v188, v204, v191 offset0:148 offset1:220
    s_mov_b64 exec, -1
    s_waitcnt lgkmcnt(0)
    s_barrier
    v_lshrrev_b32 v190, 3, v247
    v_lshl_add_u32 v248, v190, 4, s12
    s_add_u32 s10, s12, 18432
    v_lshrrev_b32 v190, 1, v247
    v_lshl_add_u32 v249, v190, 2, s10
    s_add_u32 s10, s10, 2
    v_lshrrev_b32 v190, 5, v247
    v_mul_i32_i24 v250, 0xffffb800, v190
    v_and_b32 v190, 15, v247
    v_lshl_add_u32 v250, v190, 2, v250
    v_add_u32 v250, s10, v250
    s_add_u32 s10, s12, 2
    v_and_b32 v190, 48, v247
    v_lshl_add_u32 v251, v190, 1, s10
    v_and_b32 v190, 12, v247
    v_add_u32 v251, v251, v190
    ds_read_b128 v[236:239], v248
    ds_read_b32 v240, v249
    s_lshl_b32 s10, s4, 3
    v_mov_b32 v190, s10
    ds_read_b64 v[190:191], v190 offset:576
    s_waitcnt lgkmcnt(0)
    v_readfirstlane_b32 s34, v190
    v_readfirstlane_b32 s35, v191
    s_sub_u32 s10, s12, 37888
    s_sub_u32 s34, s34, s10
    s_sub_u32 s35, s35, s10
    s_sub_u32 s35, s35, 1152
    s_add_u32 s10, s34, 127
    s_lshr_b32 s10, s10, 7
    s_lshl1_add_u32 s10, s10, -1
    s_add_u32 s11, s35, 127
    s_lshr_b32 s11, s11, 6
    s_and_b32 s11, s11, -2
    s_max_i32 s17, s10, s11
    s_cselect_b32 s10, s34, s35
    s_sub_u32 s10, s10, 1
    s_andn2_b32 s99, 64, s10
    v_mov_b64 v[204:205], 0
    v_mov_b64 v[206:207], 0
    v_mov_b64 v[184:185], 0
    v_mov_b64 v[186:187], 0
    s_add_u32 m0, s13, 0
    v_mad_u32_u16 v236, v236, s15, v243
    buffer_load_dwordx4 v236, s[40:43], 0 offen lds
    s_add_u32 m0, s13, 1056
    v_mad_u32_u16 v237, v237, s15, v243
    buffer_load_dwordx4 v237, s[40:43], 0 offen lds
    s_add_u32 m0, s13, 2112
    v_mad_u32_u16 v238, v238, s15, v243
    buffer_load_dwordx4 v238, s[40:43], 0 offen lds
    s_add_u32 m0, s13, 3168
    v_mad_u32_u16 v239, v239, s15, v243
    buffer_load_dwordx4 v239, s[40:43], 0 offen lds
    s_mov_b32 m0, s14
    s_nop 0
    buffer_load_dwordx4 v[240:241], s[44:47], 0 idxen offen lds
L_LAST:
    s_branch L_GO
.section .rodata,"a"
.p2align 6
.amdhsa_kernel standalone__edge_featured_mpnn_gatedgcn__graph_kernel
  .amdhsa_next_free_vgpr 256
  .amdhsa_next_free_sgpr 102
  .amdhsa_accum_offset 256
  .amdhsa_group_segment_fixed_size 0
  .amdhsa_kernarg_size 96
  .amdhsa_user_sgpr_count 2
  .amdhsa_user_sgpr_kernarg_segment_ptr 1
  .amdhsa_system_sgpr_workgroup_id_x 1
.end_amdhsa_kernel
```

```asm
; @launch grid=(256,1,1) block=(512,1,1) lds=158848
.amdgcn_target "amdgcn-amd-amdhsa--gfx950"
.text
.globl standalone__edge_featured_mpnn_gatedgcn__graph_kernel
.p2align 8
.type standalone__edge_featured_mpnn_gatedgcn__graph_kernel,@function
standalone__edge_featured_mpnn_gatedgcn__graph_kernel:
    s_load_dwordx16 s[16:31], s[0:1], 0
    s_load_dwordx8 s[32:39], s[0:1], 64
    s_getpc_b64 s[64:65]
L_PC:
    s_and_b32 s3, s2, -8
    v_add_lshl_u32 v1, v0, s3, 7
    v_min_u32 v1, L_LAST-L_PC, v1
    v_cmpx_gt_u32 vcc, 8, v0
    s_cbranch_execz L_NOCPF
    global_load_dword v252, v1, s[64:65]
L_NOCPF:
    s_mov_b64 exec, -1
    s_cmp_ge_u32 s2, 256
    s_cbranch_scc1 L_END
    s_mul_i32 s10, s2, 12512
    v_lshl_add_u32 v1, v0, 4, s10
    s_add_u32 s11, s10, 12512
    s_min_u32 s11, s11, 3200000
    v_add_u32 v2, 0x2000, v1
    s_waitcnt lgkmcnt(0)
    global_load_dwordx4 v[128:131], v1, s[22:23] nt
    global_load_dwordx4 v[96:99], v1, s[20:21] nt
    v_cmpx_gt_u32 s[70:71], s11, v2
    s_cbranch_execz L_NO8
    global_load_dwordx4 v[132:135], v2, s[22:23] nt
    global_load_dwordx4 v[100:103], v2, s[20:21] nt
L_NO8:
    s_mov_b64 exec, -1
L_NO7:
    s_mov_b64 exec, -1
    s_load_dword s6, s[38:39], 0
    v_mov_b32 v255, v0
    v_lshrrev_b32 v188, 6, v0
    v_and_b32 v247, 63, v0
    v_readfirstlane_b32 s3, v188
    v_lshlrev_b32 v232, 4, v0
    v_lshlrev_b32 v190, 3, v0
    v_lshlrev_b32 v191, 2, v0
    v_and_b32 v192, 0x3fc, v191
    s_and_b32 s5, s2, 7
    s_lshr_b32 s4, s2, 3
    s_lshl_b32 s5, s5, 5
    s_add_u32 s5, s5, s4
    s_mul_i32 s9, s5, 196
    s_cmp_eq_u32 s3, 7
    s_cselect_b32 s101, 0, s3
    s_lshl_b32 s12, s101, 5
    s_add_u32 s9, s9, s12
    v_lshrrev_b32 v193, 3, v247
    v_lshl_add_u32 v193, v193, 2, s9
    v_and_b32 v243, 7, v247
    v_lshlrev_b32 v243, 4, v243
    v_lshl_add_u32 v234, v193, 7, v243
    s_lshl_b32 s101, s101, 10
    s_add_u32 s101, s101, 116736
    v_mov_b64 v[196:197], 0
    v_mov_b64 v[198:199], 0
    v_mov_b32 v194, 132
    ds_write2st64_b32 v192, v194, v196 offset0:20 offset1:24
    v_add_u32 v193, 46080, v232
    ds_write_b128 v193, v[196:199] offset:0
    ds_write_b128 v193, v[196:199] offset:8192
    ds_write_b128 v193, v[196:199] offset:16384
    ds_write_b128 v193, v[196:199] offset:24576
    ds_write_b128 v193, v[196:199] offset:32768
    s_mov_b32 s44, s18
    s_or_b32 s45, s19, 0x200000
    s_mov_b32 s46, 800000
    s_mov_b32 s47, 0x20000
    s_mov_b32 s48, s34
    s_mov_b32 s49, s35
    s_mov_b32 s50, 6400000
    s_mov_b32 s51, 0x20000
    s_mov_b32 s40, s16
    s_mov_b32 s41, s17
    s_mov_b32 s42, 6400000
    s_mov_b32 s43, 0x20000
    s_mov_b32 s52, s38
    s_mov_b32 s53, s39
    s_mov_b32 s54, 25165824
    s_mov_b32 s55, 0x20000
    s_lshl_b32 s12, s2, 7
    s_add_u32 s12, s12, 65536
    s_add_u32 s56, s38, s12
    s_addc_u32 s57, s39, 0
    s_mov_b32 s58, 16809984
    s_mov_b32 s59, 0x20000
    s_mov_b32 s64, 85599
    s_mov_b32 s65, 4294967100
    s_movk_i32 s66, 5368
    s_mov_b32 s67, 0xc000000
    s_mov_b32 s68, 32896
    v_add_u32 v120, 0, v191
    v_add_u32 v121, 1, v191
    v_add_u32 v122, 2, v191
    v_add_u32 v123, 3, v191
    s_lshl_b32 s10, s3, 28
    s_or_b32 s10, s10, 0x20000
    v_mov_b32 v144, s10
    v_or_b32 v145, 0x80000000, v144
    v_mov_b32 v184, 33
    v_mov_b32 v146, 0x400
    s_and_b32 s10, s3, 3
    s_lshr_b32 s4, s3, 2
    s_lshl1_add_u32 s4, s10, s4
    s_xor_b32 s4, s4, 1
    s_mul_i32 s10, s4, 49
    s_sub_i32 s10, s10, 6
    s_ashr_i32 s10, s10, 1
    s_max_i32 s7, s10, 0
    s_mul_i32 s13, s4, 4224
    s_add_u32 s13, s13, 82944
    s_lshl_b32 s14, s4, 10
    s_add_u32 s14, s14, 5120
    s_mul_i32 s12, s4, 2304
    s_add_u32 s12, s12, 46080
    s_movk_i32 s15, 128
    v_bfe_u32 v194, v255, 4, 4
    v_and_b32 v195, 7, v255
    v_cmp_eq_u32 vcc, v194, v195
    v_and_b32 v194, 8, v255
    v_lshlrev_b32 v194, 1, v194
    v_mov_b32 v196, 0x3f80
    v_lshlrev_b32 v196, v194, v196
    v_cndmask_b32 v196, 0, v196, vcc
    ds_write_b32 v192, v196 offset:0
    v_mov_b64 v[196:197], 0
    ds_write_b64 v190, v[196:197] offset:1024
    v_add_u32 v194, 155776, v191
    ds_write_b32 v194, v196
    v_lshrrev_b32 v223, 3, v255
    v_mul_u32_u24 v224, 160, v223
    v_mad_u32_u24 v220, v223, s68, v243
    v_add_u32 v221, v224, v243
    v_add_u32 v221, 46080, v221
    v_bfe_u32 v194, v255, 5, 1
    v_bfe_u32 v196, v255, 6, 1
    v_sub_u32 v194, v194, v196
    v_mul_i32_i24 v194, 640, v194
    v_add_u32 v224, v224, v194
    v_lshl_add_u32 v224, v195, 2, v224
    v_add_u32 v224, 13312, v224
    v_lshlrev_b32 v185, 4, v247
    v_and_b32 v194, 3, v247
    v_lshlrev_b32 v246, 3, v194
    v_bfe_u32 v197, v247, 2, 3
    v_lshrrev_b32 v196, 5, v247
    v_lshl_add_u32 v197, v196, 4, v197
    v_mul_u32_u24 v225, 160, v197
    v_add_u32 v225, v225, v246
    s_movk_i32 s69, 11520
    v_mov_b64 v[116:117], 0
    v_mov_b64 v[118:119], 0
    s_waitcnt lgkmcnt(0)
    s_barrier
    s_cmp_eq_u64 s[70:71], 0
    s_cbranch_scc1 L_R4
    s_waitcnt vmcnt(3)
    v_mul_u32_u24 v104, s64, v128
    v_mul_u32_u24 v105, s64, v129
    v_mul_u32_u24 v106, s64, v130
    v_mul_u32_u24 v107, s64, v131
    v_lshrrev_b32 v136, 29, v104
    v_lshrrev_b32 v137, 29, v105
    v_lshrrev_b32 v138, 29, v106
    v_lshrrev_b32 v139, 29, v107
    v_cmp_eq_u32 s[72:73], v136, v137
    v_cmp_eq_u32 s[76:77], v138, v139
    v_cmp_eq_u32 vcc, v136, v138
    v_cmp_eq_u32 s[88:89], v137, v139
    v_cmp_eq_u32 s[90:91], v136, v139
    v_cmp_eq_u32 s[10:11], v137, v138
    v_lshrrev_b32 v104, 24, v104
    v_lshrrev_b32 v105, 24, v105
    v_lshrrev_b32 v106, 24, v106
    v_lshrrev_b32 v107, 24, v107
    s_or_b64 s[74:75], s[72:73], s[88:89]
    s_or_b64 s[78:79], s[76:77], s[88:89]
    s_or_b64 s[72:73], s[72:73], vcc
    s_or_b64 s[76:77], s[76:77], vcc
    s_or_b64 s[72:73], s[72:73], s[90:91]
    s_or_b64 s[74:75], s[74:75], s[10:11]
    s_or_b64 s[76:77], s[76:77], s[10:11]
    s_or_b64 s[78:79], s[78:79], s[90:91]
    v_cndmask_b32 v136, 0, v146, s[72:73]
    v_lshl_add_u32 v136, v104, 2, v136
    ds_add_rtn_u32 v112, v136, v184 offset:5120
    v_cndmask_b32 v137, 0, v146, s[74:75]
    v_lshl_add_u32 v137, v105, 2, v137
    ds_add_rtn_u32 v113, v137, v184 offset:5120
    v_cndmask_b32 v138, 0, v146, s[76:77]
    v_lshl_add_u32 v138, v106, 2, v138
    ds_add_rtn_u32 v114, v138, v184 offset:5120
    v_cndmask_b32 v139, 0, v146, s[78:79]
    v_lshl_add_u32 v139, v107, 2, v139
    ds_add_rtn_u32 v115, v139, v184 offset:5120
    s_waitcnt vmcnt(1)
    s_mov_b64 exec, s[70:71]
    v_mul_u32_u24 v108, s64, v132
    v_mul_u32_u24 v109, s64, v133
    v_mul_u32_u24 v110, s64, v134
    v_mul_u32_u24 v111, s64, v135
    v_lshrrev_b32 v108, 24, v108
    v_lshrrev_b32 v109, 24, v109
    v_lshrrev_b32 v110, 24, v110
    v_lshrrev_b32 v111, 24, v111
    v_lshlrev_b32 v140, 2, v108
    ds_add_rtn_u32 v116, v140, v184 offset:5120
    v_lshlrev_b32 v141, 2, v109
    ds_add_rtn_u32 v117, v141, v184 offset:5120
    v_lshlrev_b32 v142, 2, v110
    ds_add_rtn_u32 v118, v142, v184 offset:5120
    v_lshlrev_b32 v143, 2, v111
    ds_add_rtn_u32 v119, v143, v184 offset:5120
    s_waitcnt lgkmcnt(7)
    s_mov_b64 exec, s[72:73]
    v_cmpx_le_u32 vcc, 132, v112
    ds_add_rtn_u32 v112, v136, v184 offset:4096
    s_waitcnt lgkmcnt(7)
    s_mov_b64 exec, s[74:75]
    v_cmpx_le_u32 vcc, 132, v113
    ds_add_rtn_u32 v113, v137, v184 offset:4096
    s_waitcnt lgkmcnt(7)
    s_mov_b64 exec, s[76:77]
    v_cmpx_le_u32 vcc, 132, v114
    ds_add_rtn_u32 v114, v138, v184 offset:4096
    s_waitcnt lgkmcnt(7)
    s_mov_b64 exec, s[78:79]
    v_cmpx_le_u32 vcc, 132, v115
    ds_add_rtn_u32 v115, v139, v184 offset:4096
    s_mov_b64 exec, s[70:71]
    s_waitcnt vmcnt(0)
    v_mad_i32_i24 v132, v108, s65, v132
    v_mul_u32_u24 v194, s66, v100
    v_lshl_or_b32 v100, v132, 18, v100
    v_and_or_b32 v194, v194, s67, v145
    v_mad_u32_u24 v132, v108, 40, s69
    v_or_b32 v100, v100, v194
    v_mad_i32_i24 v133, v109, s65, v133
    v_mul_u32_u24 v194, s66, v101
    v_lshl_or_b32 v101, v133, 18, v101
    v_and_or_b32 v194, v194, s67, v145
    v_mad_u32_u24 v133, v109, 40, s69
    v_or_b32 v101, v101, v194
    v_mad_i32_i24 v134, v110, s65, v134
    v_mul_u32_u24 v194, s66, v102
    v_lshl_or_b32 v102, v134, 18, v102
    v_and_or_b32 v194, v194, s67, v145
    v_mad_u32_u24 v134, v110, 40, s69
    v_or_b32 v102, v102, v194
    v_mad_i32_i24 v135, v111, s65, v135
    v_mul_u32_u24 v194, s66, v103
    v_lshl_or_b32 v103, v135, 18, v103
    v_and_or_b32 v194, v194, s67, v145
    v_mad_u32_u24 v135, v111, 40, s69
    v_or_b32 v103, v103, v194
    s_waitcnt lgkmcnt(7)
    v_bfe_u32 v194, v116, 3, 5
    v_add_lshl_u32 v132, v194, v132, 2
    v_and_b32 v194, 3, v194
    v_mad_i32_i24 v194, v194, -3, v132
    v_cmpx_gt_u32 vcc, 792, v116
    ds_write_b32 v132, v100
    ds_write_b8 v194, v120 offset:12
    s_mov_b64 exec, s[70:71]
    s_waitcnt lgkmcnt(8)
    v_bfe_u32 v194, v117, 3, 5
    v_add_lshl_u32 v133, v194, v133, 2
    v_and_b32 v194, 3, v194
    v_mad_i32_i24 v194, v194, -3, v133
    v_cmpx_gt_u32 vcc, 792, v117
    ds_write_b32 v133, v101
    ds_write_b8 v194, v121 offset:12
    s_mov_b64 exec, s[70:71]
    s_waitcnt lgkmcnt(9)
    v_bfe_u32 v194, v118, 3, 5
    v_add_lshl_u32 v134, v194, v134, 2
    v_and_b32 v194, 3, v194
    v_mad_i32_i24 v194, v194, -3, v134
    v_cmpx_gt_u32 vcc, 792, v118
    ds_write_b32 v134, v102
    ds_write_b8 v194, v122 offset:12
    s_mov_b64 exec, s[70:71]
    s_waitcnt lgkmcnt(10)
    v_bfe_u32 v194, v119, 3, 5
    v_add_lshl_u32 v135, v194, v135, 2
    v_and_b32 v194, 3, v194
    v_mad_i32_i24 v194, v194, -3, v135
    v_cmpx_gt_u32 vcc, 792, v119
    ds_write_b32 v135, v103
    ds_write_b8 v194, v123 offset:12
    s_mov_b64 exec, -1
    v_mad_i32_i24 v128, v104, s65, v128
    v_mul_u32_u24 v194, s66, v96
    v_lshl_or_b32 v96, v128, 18, v96
    v_and_or_b32 v194, v194, s67, v144
    v_mad_u32_u24 v128, v104, 40, s69
    v_or_b32 v96, v96, v194
    v_mad_i32_i24 v129, v105, s65, v129
    v_mul_u32_u24 v194, s66, v97
    v_lshl_or_b32 v97, v129, 18, v97
    v_and_or_b32 v194, v194, s67, v144
    v_mad_u32_u24 v129, v105, 40, s69
    v_or_b32 v97, v97, v194
    v_mad_i32_i24 v130, v106, s65, v130
    v_mul_u32_u24 v194, s66, v98
    v_lshl_or_b32 v98, v130, 18, v98
    v_and_or_b32 v194, v194, s67, v144
    v_mad_u32_u24 v130, v106, 40, s69
    v_or_b32 v98, v98, v194
    v_mad_i32_i24 v131, v107, s65, v131
    v_mul_u32_u24 v194, s66, v99
    v_lshl_or_b32 v99, v131, 18, v99
    v_and_or_b32 v194, v194, s67, v144
    v_mad_u32_u24 v131, v107, 40, s69
    v_or_b32 v99, v99, v194
    s_waitcnt lgkmcnt(11)
    v_bfe_u32 v194, v112, 3, 5
    v_add_lshl_u32 v128, v194, v128, 2
    v_and_b32 v194, 3, v194
    v_mad_i32_i24 v194, v194, -3, v128
    v_cmpx_gt_u32 vcc, 792, v112
    ds_write_b32 v128, v96
    ds_write_b8 v194, v120 offset:12
    s_mov_b64 exec, -1
    s_waitcnt lgkmcnt(12)
    v_bfe_u32 v194, v113, 3, 5
    v_add_lshl_u32 v129, v194, v129, 2
    v_and_b32 v194, 3, v194
    v_mad_i32_i24 v194, v194, -3, v129
    v_cmpx_gt_u32 vcc, 792, v113
    ds_write_b32 v129, v97
    ds_write_b8 v194, v121 offset:12
    s_mov_b64 exec, -1
    s_waitcnt lgkmcnt(13)
    v_bfe_u32 v194, v114, 3, 5
    v_add_lshl_u32 v130, v194, v130, 2
    v_and_b32 v194, 3, v194
    v_mad_i32_i24 v194, v194, -3, v130
    v_cmpx_gt_u32 vcc, 792, v114
    ds_write_b32 v130, v98
    ds_write_b8 v194, v122 offset:12
    s_mov_b64 exec, -1
    s_waitcnt lgkmcnt(14)
    v_bfe_u32 v194, v115, 3, 5
    v_add_lshl_u32 v131, v194, v131, 2
    v_and_b32 v194, 3, v194
    v_mad_i32_i24 v194, v194, -3, v131
    v_cmpx_gt_u32 vcc, 792, v115
    ds_write_b32 v131, v99
    ds_write_b8 v194, v123 offset:12
    s_mov_b64 exec, -1
    s_branch L_B1
L_R4:
    s_waitcnt vmcnt(1)
    v_mul_u32_u24 v104, s64, v128
    v_mul_u32_u24 v105, s64, v129
    v_mul_u32_u24 v106, s64, v130
    v_mul_u32_u24 v107, s64, v131
    v_lshrrev_b32 v136, 29, v104
    v_lshrrev_b32 v137, 29, v105
    v_lshrrev_b32 v138, 29, v106
    v_lshrrev_b32 v139, 29, v107
    v_cmp_eq_u32 s[72:73], v136, v137
    v_cmp_eq_u32 s[76:77], v138, v139
    v_cmp_eq_u32 vcc, v136, v138
    v_cmp_eq_u32 s[88:89], v137, v139
    v_cmp_eq_u32 s[90:91], v136, v139
    v_cmp_eq_u32 s[10:11], v137, v138
    v_lshrrev_b32 v104, 24, v104
    v_lshrrev_b32 v105, 24, v105
    v_lshrrev_b32 v106, 24, v106
    v_lshrrev_b32 v107, 24, v107
    s_or_b64 s[74:75], s[72:73], s[88:89]
    s_or_b64 s[78:79], s[76:77], s[88:89]
    s_or_b64 s[72:73], s[72:73], vcc
    s_or_b64 s[76:77], s[76:77], vcc
    s_or_b64 s[72:73], s[72:73], s[90:91]
    s_or_b64 s[74:75], s[74:75], s[10:11]
    s_or_b64 s[76:77], s[76:77], s[10:11]
    s_or_b64 s[78:79], s[78:79], s[90:91]
    v_cndmask_b32 v136, 0, v146, s[72:73]
    v_lshl_add_u32 v136, v104, 2, v136
    ds_add_rtn_u32 v112, v136, v184 offset:5120
    v_cndmask_b32 v137, 0, v146, s[74:75]
    v_lshl_add_u32 v137, v105, 2, v137
    ds_add_rtn_u32 v113, v137, v184 offset:5120
    v_cndmask_b32 v138, 0, v146, s[76:77]
    v_lshl_add_u32 v138, v106, 2, v138
    ds_add_rtn_u32 v114, v138, v184 offset:5120
    v_cndmask_b32 v139, 0, v146, s[78:79]
    v_lshl_add_u32 v139, v107, 2, v139
    ds_add_rtn_u32 v115, v139, v184 offset:5120
    s_waitcnt vmcnt(0)
    v_mad_i32_i24 v128, v104, s65, v128
    v_mul_u32_u24 v194, s66, v96
    v_lshl_or_b32 v96, v128, 18, v96
    v_and_or_b32 v194, v194, s67, v144
    v_mad_u32_u24 v128, v104, 40, s69
    v_or_b32 v96, v96, v194
    v_mad_i32_i24 v129, v105, s65, v129
    v_mul_u32_u24 v194, s66, v97
    v_lshl_or_b32 v97, v129, 18, v97
    v_and_or_b32 v194, v194, s67, v144
    v_mad_u32_u24 v129, v105, 40, s69
    v_or_b32 v97, v97, v194
    s_waitcnt lgkmcnt(3)
    s_mov_b64 exec, s[72:73]
    v_cmpx_le_u32 vcc, 132, v112
    ds_add_rtn_u32 v112, v136, v184 offset:4096
    s_waitcnt lgkmcnt(3)
    s_mov_b64 exec, s[74:75]
    v_cmpx_le_u32 vcc, 132, v113
    ds_add_rtn_u32 v113, v137, v184 offset:4096
    s_waitcnt lgkmcnt(3)
    s_mov_b64 exec, s[76:77]
    v_cmpx_le_u32 vcc, 132, v114
    ds_add_rtn_u32 v114, v138, v184 offset:4096
    s_waitcnt lgkmcnt(3)
    s_mov_b64 exec, s[78:79]
    v_cmpx_le_u32 vcc, 132, v115
    ds_add_rtn_u32 v115, v139, v184 offset:4096
    s_mov_b64 exec, -1
    v_mad_i32_i24 v130, v106, s65, v130
    v_mul_u32_u24 v194, s66, v98
    v_lshl_or_b32 v98, v130, 18, v98
    v_and_or_b32 v194, v194, s67, v144
    v_mad_u32_u24 v130, v106, 40, s69
    v_or_b32 v98, v98, v194
    v_mad_i32_i24 v131, v107, s65, v131
    v_mul_u32_u24 v194, s66, v99
    v_lshl_or_b32 v99, v131, 18, v99
    v_and_or_b32 v194, v194, s67, v144
    v_mad_u32_u24 v131, v107, 40, s69
    v_or_b32 v99, v99, v194
    s_waitcnt lgkmcnt(3)
    v_bfe_u32 v194, v112, 3, 5
    v_add_lshl_u32 v128, v194, v128, 2
    v_and_b32 v194, 3, v194
    v_mad_i32_i24 v194, v194, -3, v128
    v_cmpx_gt_u32 vcc, 792, v112
    ds_write_b32 v128, v96
    ds_write_b8 v194, v120 offset:12
    s_mov_b64 exec, -1
    s_waitcnt lgkmcnt(4)
    v_bfe_u32 v194, v113, 3, 5
    v_add_lshl_u32 v129, v194, v129, 2
    v_and_b32 v194, 3, v194
    v_mad_i32_i24 v194, v194, -3, v129
    v_cmpx_gt_u32 vcc, 792, v113
    ds_write_b32 v129, v97
    ds_write_b8 v194, v121 offset:12
    s_mov_b64 exec, -1
    s_waitcnt lgkmcnt(5)
    v_bfe_u32 v194, v114, 3, 5
    v_add_lshl_u32 v130, v194, v130, 2
    v_and_b32 v194, 3, v194
    v_mad_i32_i24 v194, v194, -3, v130
    v_cmpx_gt_u32 vcc, 792, v114
    ds_write_b32 v130, v98
    ds_write_b8 v194, v122 offset:12
    s_mov_b64 exec, -1
    s_waitcnt lgkmcnt(6)
    v_bfe_u32 v194, v115, 3, 5
    v_add_lshl_u32 v131, v194, v131, 2
    v_and_b32 v194, 3, v194
    v_mad_i32_i24 v194, v194, -3, v131
    v_cmpx_gt_u32 vcc, 792, v115
    ds_write_b32 v131, v99
    ds_write_b8 v194, v123 offset:12
    s_mov_b64 exec, -1
L_B1:
    s_cmp_ge_u32 s3, 2
    s_cbranch_scc1 L_NOC
    global_load_dwordx4 v[176:179], v232, s[28:29]
L_NOC:
    global_load_dwordx4 v[160:163], v232, s[26:27]
    global_load_dwordx4 v[164:167], v232, s[32:33]
    global_load_dwordx4 v[168:171], v232, s[24:25]
    global_load_dwordx4 v[172:175], v232, s[30:31]
    s_add_u32 s6, s6, 0x2020202
    v_lshlrev_b32 v186, v246, s6
    v_and_b32 v189, 4, v247
    v_mul_u32_u24 v189, 1212416, v189
    v_lshl_add_u32 v186, v189, 8, v186
    v_and_b32 v186, 0xfe000000, v186
    v_and_b32 v187, 7, v247
    v_mul_u32_u24 v187, 33, v187
    v_add_u32 v187, 792, v187
    v_lshlrev_b32 v222, 2, v223
    s_mov_b32 s64, 0x1000000
    s_waitcnt lgkmcnt(0)
    s_barrier
    ds_read_b128 v[192:195], v185 offset:5120
    ds_read_b32 v228, v222 offset:5120
    ds_read_b128 v[204:207], v221 offset:0
    ds_read_b32 v229, v222 offset:5376
    ds_read_b128 v[208:211], v221 offset:10240
    ds_read_b32 v230, v222 offset:5632
    ds_read_b128 v[212:215], v221 offset:20480
    ds_read_b32 v231, v222 offset:5888
    ds_read_b128 v[216:219], v221 offset:30720
    s_mov_b32 s80, 2105344
    s_mov_b32 s81, 4210688
    s_mov_b32 s82, 6316032
    s_waitcnt lgkmcnt(8)
    v_max3_u32 v188, v192, v193, v194
    v_max_u32 v188, v188, v195
    v_cmp_lt_u32 vcc, 1056, v188
    s_cbranch_vccnz L_POVF
L_POUT:
    s_waitcnt lgkmcnt(7)
    v_sub_u32 v228, v187, v228
    v_and_or_b32 v228, v228, s64, v186
    s_waitcnt lgkmcnt(6)
    v_or_b32 v207, v207, v228
    buffer_store_dwordx4 v[204:207], v220, s[56:59], 0 offen sc1
    s_waitcnt lgkmcnt(5)
    v_sub_u32 v229, v187, v229
    v_and_or_b32 v229, v229, s64, v186
    s_waitcnt lgkmcnt(4)
    v_or_b32 v211, v211, v229
    buffer_store_dwordx4 v[208:211], v220, s[56:59], s80 offen sc1
    s_waitcnt lgkmcnt(3)
    v_sub_u32 v230, v187, v230
    v_and_or_b32 v230, v230, s64, v186
    s_waitcnt lgkmcnt(2)
    v_or_b32 v215, v215, v230
    buffer_store_dwordx4 v[212:215], v220, s[56:59], s81 offen sc1
    s_waitcnt lgkmcnt(1)
    v_sub_u32 v231, v187, v231
    v_and_or_b32 v231, v231, s64, v186
    s_waitcnt lgkmcnt(0)
    v_or_b32 v219, v219, v231
    buffer_store_dwordx4 v[216:219], v220, s[56:59], s82 offen sc1
    s_mov_b32 s10, 0xbfb8aa3b
    s_mov_b32 s11, s10
    s_mov_b32 s64, 0x05040100
    s_mov_b32 s66, 0x07060302
    s_waitcnt vmcnt(4)
    v_perm_b32 v144, v170, v168, s64
    v_perm_b32 v145, v170, v168, s66
    v_perm_b32 v146, v171, v169, s64
    v_perm_b32 v147, v171, v169, s66
    v_add_u32 v148, 77824, v224
    ds_write2_b32 v148, v144, v145 offset0:0 offset1:8
    ds_write2_b32 v148, v146, v147 offset0:16 offset1:24
    v_lshlrev_b32 v128, 16, v160
    v_and_b32 v129, 0xffff0000, v160
    v_lshlrev_b32 v130, 16, v161
    v_and_b32 v131, 0xffff0000, v161
    v_lshlrev_b32 v132, 16, v162
    v_and_b32 v133, 0xffff0000, v162
    v_lshlrev_b32 v134, 16, v163
    v_and_b32 v135, 0xffff0000, v163
    v_pk_mul_f32 v[128:129], v[128:129], s[10:11]
    v_pk_mul_f32 v[130:131], v[130:131], s[10:11]
    v_pk_mul_f32 v[132:133], v[132:133], s[10:11]
    v_pk_mul_f32 v[134:135], v[134:135], s[10:11]
    v_cvt_pk_bf16_f32 v136, v128, v132
    v_cvt_pk_bf16_f32 v137, v129, v133
    v_cvt_pk_bf16_f32 v138, v130, v134
    v_cvt_pk_bf16_f32 v139, v131, v135
    ds_write2_b32 v224, v136, v137 offset0:0 offset1:8
    ds_write2_b32 v224, v138, v139 offset0:16 offset1:24
    v_perm_b32 v152, v166, v164, s64
    v_perm_b32 v153, v166, v164, s66
    v_perm_b32 v154, v167, v165, s64
    v_perm_b32 v155, v167, v165, s66
    v_add_u32 v156, 10240, v224
    ds_write2_b32 v156, v152, v153 offset0:0 offset1:8
    ds_write2_b32 v156, v154, v155 offset0:16 offset1:24
    v_perm_b32 v144, v174, v172, s64
    v_perm_b32 v145, v174, v172, s66
    v_perm_b32 v146, v175, v173, s64
    v_perm_b32 v147, v175, v173, s66
    v_add_u32 v148, 130176, v224
    ds_write2_b32 v148, v144, v145 offset0:0 offset1:8
    ds_write2_b32 v148, v146, v147 offset0:16 offset1:24
    s_cmp_ge_u32 s3, 2
    s_cbranch_scc1 L_NOWC
    v_lshlrev_b32 v128, 16, v176
    v_and_b32 v129, 0xffff0000, v176
    v_lshlrev_b32 v130, 16, v177
    v_and_b32 v131, 0xffff0000, v177
    v_lshlrev_b32 v132, 16, v178
    v_and_b32 v133, 0xffff0000, v178
    v_lshlrev_b32 v134, 16, v179
    v_and_b32 v135, 0xffff0000, v179
    v_pk_mul_f32 v[128:129], v[128:129], s[10:11]
    v_pk_mul_f32 v[130:131], v[130:131], s[10:11]
    v_pk_mul_f32 v[132:133], v[132:133], s[10:11]
    v_pk_mul_f32 v[134:135], v[134:135], s[10:11]
    v_cvt_pk_bf16_f32 v136, v128, v132
    v_cvt_pk_bf16_f32 v137, v129, v133
    v_cvt_pk_bf16_f32 v138, v130, v134
    v_cvt_pk_bf16_f32 v139, v131, v135
    v_add_u32 v140, 20480, v224
    ds_write2_b32 v140, v136, v137 offset0:0 offset1:8
    ds_write2_b32 v140, v138, v139 offset0:16 offset1:24
L_NOWC:
    s_mul_i32 s34, s5, 32896
    s_add_u32 s34, s34, 65536
    s_add_u32 s56, s38, s34
    s_addc_u32 s57, s39, 0
    s_mov_b32 s58, 32768
    s_mov_b32 s59, 0x20000
    s_add_u32 s34, s34, 8421376
    s_add_u32 s60, s38, s34
    s_addc_u32 s61, s39, 0
    s_mov_b32 s62, 32768
    s_mov_b32 s63, 0x20000
    s_movk_i32 s26, 0
    s_movk_i32 s27, 8192
    s_movk_i32 s28, 16384
    s_movk_i32 s29, 24576
    s_waitcnt lgkmcnt(0)
    s_barrier
    v_add_u32 v225, 13312, v225
    ds_read_b64_tr_b16 v[0:1], v225 offset:0
    ds_read_b64_tr_b16 v[2:3], v225 offset:1280
    ds_read_b64_tr_b16 v[4:5], v225 offset:5120
    ds_read_b64_tr_b16 v[6:7], v225 offset:6400
    ds_read_b64_tr_b16 v[8:9], v225 offset:32
    ds_read_b64_tr_b16 v[10:11], v225 offset:1312
    ds_read_b64_tr_b16 v[12:13], v225 offset:5152
    ds_read_b64_tr_b16 v[14:15], v225 offset:6432
    ds_read_b64_tr_b16 v[16:17], v225 offset:64
    ds_read_b64_tr_b16 v[18:19], v225 offset:1344
    ds_read_b64_tr_b16 v[20:21], v225 offset:5184
    ds_read_b64_tr_b16 v[22:23], v225 offset:6464
    ds_read_b64_tr_b16 v[24:25], v225 offset:96
    ds_read_b64_tr_b16 v[26:27], v225 offset:1376
    v_mov_b32 v64, 0x2000000
    v_mov_b32 v65, 0x2000000
    v_mov_b32 v66, 0x2000000
    v_mov_b32 v67, 0x2000000
    v_mov_b32 v68, 0xfffff
    v_mov_b32 v69, 0xfffff
    v_mov_b32 v70, 0xfffff
    v_mov_b32 v71, 0xfffff
    v_lshl_add_u32 v72, v247, 4, s12
    ds_write_b128 v72, v[64:67] offset:0
    ds_write_b128 v72, v[68:71] offset:18432
    ds_write_b128 v72, v[64:67] offset:1024
    ds_write_b128 v72, v[68:71] offset:19456
    ds_write_b128 v72, v[64:67] offset:1280
    ds_write_b128 v72, v[68:71] offset:19712
    ds_read_b64_tr_b16 v[28:29], v225 offset:5216
    ds_read_b64_tr_b16 v[30:31], v225 offset:6496
    ds_read_b64_tr_b16 v[32:33], v225 offset:10240
    ds_read_b64_tr_b16 v[34:35], v225 offset:11520
    ds_read_b64_tr_b16 v[36:37], v225 offset:15360
    ds_read_b64_tr_b16 v[38:39], v225 offset:16640
    ds_read_b64_tr_b16 v[40:41], v225 offset:10272
    ds_read_b64_tr_b16 v[42:43], v225 offset:11552
    ds_read_b64_tr_b16 v[44:45], v225 offset:15392
    ds_read_b64_tr_b16 v[46:47], v225 offset:16672
    v_mov_b32 v192, v225
    s_mov_b32 exec_lo, 0
    v_subrev_u32 v192, 2560, v225
    s_mov_b32 exec_lo, -1
    s_waitcnt lgkmcnt(4)
    ds_read_b64_tr_b16 v[48:49], v225 offset:10304
    ds_read_b64_tr_b16 v[50:51], v225 offset:11584
    ds_read_b64_tr_b16 v[52:53], v225 offset:15424
    ds_read_b64_tr_b16 v[54:55], v225 offset:16704
    ds_read_b64_tr_b16 v[56:57], v225 offset:10336
    ds_read_b64_tr_b16 v[58:59], v225 offset:11616
    ds_read_b64_tr_b16 v[60:61], v225 offset:15456
    ds_read_b64_tr_b16 v[62:63], v225 offset:16736
    ds_read_b64_tr_b16 v[80:81], v192 offset:20480
    ds_read_b64_tr_b16 v[82:83], v192 offset:21760
    ds_read_b64_tr_b16 v[84:85], v192 offset:20512
    ds_read_b64_tr_b16 v[86:87], v192 offset:21792
    ds_read_b64_tr_b16 v[88:89], v192 offset:20544
    ds_read_b64_tr_b16 v[90:91], v192 offset:21824
    ds_read_b64_tr_b16 v[92:93], v192 offset:20576
    ds_read_b64_tr_b16 v[94:95], v192 offset:21856
    v_add_u32 v225, 77824, v225
    v_and_b32 v241, 1, v247
    v_lshlrev_b32 v241, 4, v241
    v_mov_b32 v242, 0x3f80
    v_and_b32 v245, 16, v247
    v_and_b32 v194, 15, v247
    v_lshl_add_u32 v194, v194, 5, s14
    s_mov_b32 exec_hi, 0
    v_add_u32 v245, v245, v194
    s_mov_b32 exec_hi, -1
    v_and_b32 v194, 3, v247
    v_bfe_u32 v196, v247, 2, 2
    v_and_b32 v197, 48, v247
    v_lshl_add_u32 v198, v196, 7, v197
    v_mul_u32_u24 v244, 1056, v194
    v_add3_u32 v244, v244, v198, s13
    v_lshrrev_b32 v194, 3, v247
    v_lshl_add_u32 v248, v194, 4, s12
    s_add_u32 s10, s12, 18432
    v_lshrrev_b32 v194, 1, v247
    v_lshl_add_u32 v249, v194, 2, s10
    s_add_u32 s10, s10, 2
    v_lshrrev_b32 v194, 5, v247
    v_mul_i32_i24 v250, 0xffffb800, v194
    v_and_b32 v194, 15, v247
    v_lshl_add_u32 v250, v194, 2, v250
    v_add_u32 v250, s10, v250
    s_add_u32 s10, s12, 2
    v_and_b32 v194, 48, v247
    v_lshl_add_u32 v251, v194, 1, s10
    v_and_b32 v194, 12, v247
    v_add_u32 v251, v251, v194
    v_mul_u32_u24 v159, 3128, v223
    v_add_u32 v156, 0, v159
    v_add_u32 v157, 200192, v159
    v_add_u32 v158, 400384, v159
    v_add_u32 v159, 600576, v159
    s_mov_b32 s98, 0xf0f0f0f
    s_mov_b32 s99, 0xf0f0f0f
    v_mov_b32 v180, 0xfffff
    v_mov_b32 v176, 0
    v_add_lshl_u32 v191, v232, v243, 16
    v_add_u32 v152, 0x34000000, v191
    v_cndmask_b32 v152, 0, v152, s[98:99]
    v_add_u32 v153, 0x54000000, v191
    v_cndmask_b32 v153, 0, v153, s[98:99]
    v_add_u32 v154, 0x74000000, v191
    v_cndmask_b32 v154, 0, v154, s[98:99]
    v_add_u32 v155, 0x94000000, v191
    v_cndmask_b32 v155, 0, v155, s[98:99]
    v_mov_b32 v184, 4
    v_and_b32 v177, 31, v247
    v_add_lshl_u32 v179, v177, s7, 2
    v_lshrrev_b32 v191, 5, v247
    v_lshl_add_u32 v178, v191, 11, v179
    v_add_u32 v179, 153728, v179
    v_lshlrev_b32 v191, 2, v247
    v_subrev_u32 v191, s7, v191
    s_mov_b32 s10, 0x10000
    v_add_u32 v228, 0, v191
    v_and_or_b32 v228, v228, s10, 1
    v_add_u32 v229, 1, v191
    v_and_or_b32 v229, v229, s10, 1
    v_add_u32 v230, 2, v191
    v_and_or_b32 v230, v230, s10, 1
    v_add_u32 v231, 3, v191
    v_and_or_b32 v231, v231, s10, 1
    s_movk_i32 s18, 0xffc
    s_movk_i32 s20, 32
    s_mov_b32 s21, 0
    s_mov_b32 s100, 0
    s_mov_b32 s16, 0x1ffffff
    s_mov_b32 s17, 0xffff
    s_mul_i32 s10, s4, 49
    s_sub_i32 s22, s10, 6
    s_ashr_i32 s22, s22, 1
    s_add_i32 s23, s10, 7
    s_ashr_i32 s23, s23, 1
    s_add_i32 s24, s10, 43
    s_ashr_i32 s24, s24, 1
    s_add_i32 s25, s22, 31
    s_cmp_eq_u32 s4, 7
    s_cselect_b32 s24, 196, s24
    s_cselect_b32 s25, 196, s25
    s_sub_i32 s23, s23, s7
    s_sub_i32 s24, s24, s7
    s_sub_i32 s25, s25, s7
    s_waitcnt vmcnt(0)
    buffer_load_dwordx4 v[128:131], v232, s[56:59], s26 offen sc1
    buffer_load_dwordx4 v[132:135], v232, s[56:59], s27 offen sc1
    buffer_load_dwordx4 v[136:139], v232, s[56:59], s28 offen sc1
    buffer_load_dwordx4 v[140:143], v232, s[56:59], s29 offen sc1
    v_max3_u32 v188, v112, v113, v114
    v_max3_u32 v189, v115, v116, v117
    v_max3_u32 v188, v188, v118, v119
    v_max_u32 v188, v188, v189
    v_cmp_le_u32 vcc, 792, v188
    s_cbranch_vccz L_PEXTR
    v_mov_b32 v65, s6
    s_lshl_b32 s34, s2, 7
    s_add_u32 s34, s34, 8486912
    v_subrev_u32 v68, 792, v112
    v_cmpx_gt_u32 vcc, 264, v68
    s_cbranch_execz L_PE0
    v_mov_b32 v64, v96
    v_mov_b32 v66, v120
    v_bfe_u32 v68, v112, 5, 3
    v_lshlrev_b32 v68, 4, v68
    v_mad_u32_u24 v68, v104, s68, v68
    buffer_store_dwordx4 v[64:67], v68, s[52:55], s34 offen sc1
L_PE0:
    s_mov_b64 exec, -1
    v_subrev_u32 v68, 792, v113
    v_cmpx_gt_u32 vcc, 264, v68
    s_cbranch_execz L_PE1
    v_mov_b32 v64, v97
    v_mov_b32 v66, v121
    v_bfe_u32 v68, v113, 5, 3
    v_lshlrev_b32 v68, 4, v68
    v_mad_u32_u24 v68, v105, s68, v68
    buffer_store_dwordx4 v[64:67], v68, s[52:55], s34 offen sc1
L_PE1:
    s_mov_b64 exec, -1
    v_subrev_u32 v68, 792, v114
    v_cmpx_gt_u32 vcc, 264, v68
    s_cbranch_execz L_PE2
    v_mov_b32 v64, v98
    v_mov_b32 v66, v122
    v_bfe_u32 v68, v114, 5, 3
    v_lshlrev_b32 v68, 4, v68
    v_mad_u32_u24 v68, v106, s68, v68
    buffer_store_dwordx4 v[64:67], v68, s[52:55], s34 offen sc1
L_PE2:
    s_mov_b64 exec, -1
    v_subrev_u32 v68, 792, v115
    v_cmpx_gt_u32 vcc, 264, v68
    s_cbranch_execz L_PE3
    v_mov_b32 v64, v99
    v_mov_b32 v66, v123
    v_bfe_u32 v68, v115, 5, 3
    v_lshlrev_b32 v68, 4, v68
    v_mad_u32_u24 v68, v107, s68, v68
    buffer_store_dwordx4 v[64:67], v68, s[52:55], s34 offen sc1
L_PE3:
    s_mov_b64 exec, -1
    v_subrev_u32 v68, 792, v116
    v_cmpx_gt_u32 vcc, 264, v68
    s_cbranch_execz L_PE4
    v_mov_b32 v64, v100
    v_mov_b32 v66, v120
    v_bfe_u32 v68, v116, 5, 3
    v_lshlrev_b32 v68, 4, v68
    v_mad_u32_u24 v68, v108, s68, v68
    buffer_store_dwordx4 v[64:67], v68, s[52:55], s34 offen sc1
L_PE4:
    s_mov_b64 exec, -1
    v_subrev_u32 v68, 792, v117
    v_cmpx_gt_u32 vcc, 264, v68
    s_cbranch_execz L_PE5
    v_mov_b32 v64, v101
    v_mov_b32 v66, v121
    v_bfe_u32 v68, v117, 5, 3
    v_lshlrev_b32 v68, 4, v68
    v_mad_u32_u24 v68, v109, s68, v68
    buffer_store_dwordx4 v[64:67], v68, s[52:55], s34 offen sc1
L_PE5:
    s_mov_b64 exec, -1
    v_subrev_u32 v68, 792, v118
    v_cmpx_gt_u32 vcc, 264, v68
    s_cbranch_execz L_PE6
    v_mov_b32 v64, v102
    v_mov_b32 v66, v122
    v_bfe_u32 v68, v118, 5, 3
    v_lshlrev_b32 v68, 4, v68
    v_mad_u32_u24 v68, v110, s68, v68
    buffer_store_dwordx4 v[64:67], v68, s[52:55], s34 offen sc1
L_PE6:
    s_mov_b64 exec, -1
    v_subrev_u32 v68, 792, v119
    v_cmpx_gt_u32 vcc, 264, v68
    s_cbranch_execz L_PE7
    v_mov_b32 v64, v103
    v_mov_b32 v66, v123
    v_bfe_u32 v68, v119, 5, 3
    v_lshlrev_b32 v68, 4, v68
    v_mad_u32_u24 v68, v111, s68, v68
    buffer_store_dwordx4 v[64:67], v68, s[52:55], s34 offen sc1
L_PE7:
    s_mov_b64 exec, -1
L_PEXTR:
L_PW0:
    s_waitcnt vmcnt(3)
    v_xor_b32 v188, v131, v186
    v_and_b32_sdwa v96, v128, s18 dst_sel:DWORD dst_unused:UNUSED_PAD src0_sel:WORD_1 src1_sel:DWORD
    v_and_b32_sdwa v97, v129, s18 dst_sel:DWORD dst_unused:UNUSED_PAD src0_sel:WORD_1 src1_sel:DWORD
    v_and_b32_sdwa v98, v130, s18 dst_sel:DWORD dst_unused:UNUSED_PAD src0_sel:WORD_1 src1_sel:DWORD
    v_cmp_lt_u32 vcc, s16, v188
    v_cmp_ne_u32 s[64:65], 0, v128
    v_cmp_ne_u32 s[66:67], 0, v129
    v_cmp_ne_u32 s[68:69], 0, v130
    s_cbranch_vccnz L_RT0
    s_mov_b64 exec, s[64:65]
    ds_add_rtn_u32 v112, v96, v184 offset:1024
    s_mov_b64 exec, s[66:67]
    ds_add_rtn_u32 v113, v97, v184 offset:1024
    s_mov_b64 exec, s[68:69]
    ds_add_rtn_u32 v114, v98, v184 offset:1024
    s_mov_b64 exec, -1
    v_or_b32 v176, v176, v129
    v_add_u32_sdwa v204, v131, v156 dst_sel:DWORD dst_unused:UNUSED_PAD src0_sel:BYTE_0 src1_sel:DWORD
    v_lshrrev_b32 v189, 28, v128
    v_lshl_add_u32 v204, v189, 8, v204
    v_and_b32 v189, 60, v96
    v_and_b32 v128, 0xffff, v128
    v_lshl_or_b32 v128, v189, 19, v128
    v_cndmask_b32 v188, v180, v204, s[64:65]
    v_max_u32 v204, v204, v152
    v_add_u32_sdwa v205, v131, v156 dst_sel:DWORD dst_unused:UNUSED_PAD src0_sel:BYTE_1 src1_sel:DWORD
    v_lshrrev_b32 v189, 28, v129
    v_lshl_add_u32 v205, v189, 8, v205
    v_and_b32 v189, 60, v97
    v_and_b32 v129, 0xffff, v129
    v_lshl_or_b32 v129, v189, 19, v129
    v_mov_b32_dpp v190, v188 quad_perm:[2,2,3,3] row_mask:0xf bank_mask:0xf
    v_mov_b32_dpp v207, v188 quad_perm:[0,0,1,1] row_mask:0xf bank_mask:0xf
    v_add_u32_sdwa v206, v131, v156 dst_sel:DWORD dst_unused:UNUSED_PAD src0_sel:BYTE_2 src1_sel:DWORD
    v_lshrrev_b32 v189, 28, v130
    v_lshl_add_u32 v206, v189, 8, v206
    v_and_b32 v189, 60, v98
    v_and_b32 v130, 0xffff, v130
    v_lshl_or_b32 v130, v189, 19, v130
    v_mov_b32_dpp v207, v190 row_shr:4 row_mask:0xf bank_mask:0xa
L_PW1:
    s_waitcnt vmcnt(2)
    v_xor_b32 v188, v135, v186
    v_and_b32_sdwa v100, v132, s18 dst_sel:DWORD dst_unused:UNUSED_PAD src0_sel:WORD_1 src1_sel:DWORD
    v_and_b32_sdwa v101, v133, s18 dst_sel:DWORD dst_unused:UNUSED_PAD src0_sel:WORD_1 src1_sel:DWORD
    v_and_b32_sdwa v102, v134, s18 dst_sel:DWORD dst_unused:UNUSED_PAD src0_sel:WORD_1 src1_sel:DWORD
    v_cmp_lt_u32 vcc, s16, v188
    v_cmp_ne_u32 s[72:73], 0, v132
    v_cmp_ne_u32 s[74:75], 0, v133
    v_cmp_ne_u32 s[76:77], 0, v134
    s_cbranch_vccnz L_RT1
    s_mov_b64 exec, s[72:73]
    ds_add_rtn_u32 v116, v100, v184 offset:1024
    s_mov_b64 exec, s[74:75]
    ds_add_rtn_u32 v117, v101, v184 offset:1024
    s_mov_b64 exec, s[76:77]
    ds_add_rtn_u32 v118, v102, v184 offset:1024
    s_mov_b64 exec, -1
    v_or_b32 v176, v176, v133
    v_add_u32_sdwa v208, v135, v157 dst_sel:DWORD dst_unused:UNUSED_PAD src0_sel:BYTE_0 src1_sel:DWORD
    v_lshrrev_b32 v189, 28, v132
    v_lshl_add_u32 v208, v189, 8, v208
    v_and_b32 v189, 60, v100
    v_and_b32 v132, 0xffff, v132
    v_lshl_or_b32 v132, v189, 19, v132
    v_cndmask_b32 v188, v180, v208, s[72:73]
    v_max_u32 v208, v208, v153
    v_add_u32_sdwa v209, v135, v157 dst_sel:DWORD dst_unused:UNUSED_PAD src0_sel:BYTE_1 src1_sel:DWORD
    v_lshrrev_b32 v189, 28, v133
    v_lshl_add_u32 v209, v189, 8, v209
    v_and_b32 v189, 60, v101
    v_and_b32 v133, 0xffff, v133
    v_lshl_or_b32 v133, v189, 19, v133
    v_mov_b32_dpp v190, v188 quad_perm:[2,2,3,3] row_mask:0xf bank_mask:0xf
    v_mov_b32_dpp v211, v188 quad_perm:[0,0,1,1] row_mask:0xf bank_mask:0xf
    v_add_u32_sdwa v210, v135, v157 dst_sel:DWORD dst_unused:UNUSED_PAD src0_sel:BYTE_2 src1_sel:DWORD
    v_lshrrev_b32 v189, 28, v134
    v_lshl_add_u32 v210, v189, 8, v210
    v_and_b32 v189, 60, v102
    v_and_b32 v134, 0xffff, v134
    v_lshl_or_b32 v134, v189, 19, v134
    v_mov_b32_dpp v211, v190 row_shr:4 row_mask:0xf bank_mask:0xa
L_PW2:
    s_waitcnt vmcnt(1)
    v_xor_b32 v188, v139, v186
    v_and_b32_sdwa v104, v136, s18 dst_sel:DWORD dst_unused:UNUSED_PAD src0_sel:WORD_1 src1_sel:DWORD
    v_and_b32_sdwa v105, v137, s18 dst_sel:DWORD dst_unused:UNUSED_PAD src0_sel:WORD_1 src1_sel:DWORD
    v_and_b32_sdwa v106, v138, s18 dst_sel:DWORD dst_unused:UNUSED_PAD src0_sel:WORD_1 src1_sel:DWORD
    v_cmp_lt_u32 vcc, s16, v188
    v_cmp_ne_u32 s[80:81], 0, v136
    v_cmp_ne_u32 s[82:83], 0, v137
    v_cmp_ne_u32 s[84:85], 0, v138
    s_cbranch_vccnz L_RT2
    s_mov_b64 exec, s[80:81]
    ds_add_rtn_u32 v120, v104, v184 offset:1024
    s_mov_b64 exec, s[82:83]
    ds_add_rtn_u32 v121, v105, v184 offset:1024
    s_mov_b64 exec, s[84:85]
    ds_add_rtn_u32 v122, v106, v184 offset:1024
    s_mov_b64 exec, -1
    v_or_b32 v176, v176, v137
    v_add_u32_sdwa v212, v139, v158 dst_sel:DWORD dst_unused:UNUSED_PAD src0_sel:BYTE_0 src1_sel:DWORD
    v_lshrrev_b32 v189, 28, v136
    v_lshl_add_u32 v212, v189, 8, v212
    v_and_b32 v189, 60, v104
    v_and_b32 v136, 0xffff, v136
    v_lshl_or_b32 v136, v189, 19, v136
    v_cndmask_b32 v188, v180, v212, s[80:81]
    v_max_u32 v212, v212, v154
    v_add_u32_sdwa v213, v139, v158 dst_sel:DWORD dst_unused:UNUSED_PAD src0_sel:BYTE_1 src1_sel:DWORD
    v_lshrrev_b32 v189, 28, v137
    v_lshl_add_u32 v213, v189, 8, v213
    v_and_b32 v189, 60, v105
    v_and_b32 v137, 0xffff, v137
    v_lshl_or_b32 v137, v189, 19, v137
    v_mov_b32_dpp v190, v188 quad_perm:[2,2,3,3] row_mask:0xf bank_mask:0xf
    v_mov_b32_dpp v215, v188 quad_perm:[0,0,1,1] row_mask:0xf bank_mask:0xf
    v_add_u32_sdwa v214, v139, v158 dst_sel:DWORD dst_unused:UNUSED_PAD src0_sel:BYTE_2 src1_sel:DWORD
    v_lshrrev_b32 v189, 28, v138
    v_lshl_add_u32 v214, v189, 8, v214
    v_and_b32 v189, 60, v106
    v_and_b32 v138, 0xffff, v138
    v_lshl_or_b32 v138, v189, 19, v138
    v_mov_b32_dpp v215, v190 row_shr:4 row_mask:0xf bank_mask:0xa
L_PW3:
    s_waitcnt vmcnt(0)
    v_xor_b32 v188, v143, v186
    v_and_b32_sdwa v108, v140, s18 dst_sel:DWORD dst_unused:UNUSED_PAD src0_sel:WORD_1 src1_sel:DWORD
    v_and_b32_sdwa v109, v141, s18 dst_sel:DWORD dst_unused:UNUSED_PAD src0_sel:WORD_1 src1_sel:DWORD
    v_and_b32_sdwa v110, v142, s18 dst_sel:DWORD dst_unused:UNUSED_PAD src0_sel:WORD_1 src1_sel:DWORD
    v_cmp_lt_u32 vcc, s16, v188
    v_cmp_ne_u32 s[88:89], 0, v140
    v_cmp_ne_u32 s[90:91], 0, v141
    v_cmp_ne_u32 s[92:93], 0, v142
    s_cbranch_vccnz L_RT3
    s_mov_b64 exec, s[88:89]
    ds_add_rtn_u32 v124, v108, v184 offset:1024
    s_mov_b64 exec, s[90:91]
    ds_add_rtn_u32 v125, v109, v184 offset:1024
    s_mov_b64 exec, s[92:93]
    ds_add_rtn_u32 v126, v110, v184 offset:1024
    s_mov_b64 exec, -1
    v_or_b32 v176, v176, v141
    v_or3_b32 v190, v131, v135, v139
    v_or_b32 v190, v190, v143
    v_and_b32 v190, 0x1000000, v190
    v_cmp_ne_u32 vcc, 0, v190
    s_cbranch_vccz L_XT1R
    v_and_b32 v190, 0x1000000, v131
    v_cmp_ne_u32 s[70:71], 0, v190
    s_bcnt1_i32_b64 s10, s[70:71]
    s_lshl2_add_u32 s21, s10, s21
    v_and_b32 v190, 0x1000000, v135
    v_cmp_ne_u32 s[78:79], 0, v190
    s_bcnt1_i32_b64 s10, s[78:79]
    s_lshl2_add_u32 s21, s10, s21
    v_and_b32 v190, 0x1000000, v139
    v_cmp_ne_u32 s[86:87], 0, v190
    s_bcnt1_i32_b64 s10, s[86:87]
    s_lshl2_add_u32 s21, s10, s21
    v_and_b32 v190, 0x1000000, v143
    v_cmp_ne_u32 s[94:95], 0, v190
    s_bcnt1_i32_b64 s10, s[94:95]
    s_lshl2_add_u32 s21, s10, s21
    s_mov_b64 exec, s[70:71]
    s_cbranch_execz L_XLa0
    s_movk_i32 s10, 0
    buffer_load_dwordx4 v[64:67], v232, s[60:63], s10 offen sc1
L_XLa0:
    s_mov_b64 exec, s[78:79]
    s_cbranch_execz L_XLa1
    s_movk_i32 s10, 8192
    buffer_load_dwordx4 v[68:71], v232, s[60:63], s10 offen sc1
L_XLa1:
    s_mov_b64 exec, s[86:87]
    s_cbranch_execz L_XLa2
    s_movk_i32 s10, 16384
    buffer_load_dwordx4 v[72:75], v232, s[60:63], s10 offen sc1
L_XLa2:
    s_mov_b64 exec, s[94:95]
    s_cbranch_execz L_XLa3
    s_movk_i32 s10, 24576
    buffer_load_dwordx4 v[76:79], v232, s[60:63], s10 offen sc1
L_XLa3:
    s_mov_b64 exec, -1
    v_and_b32 v190, 0x10000, v176
    v_mov_b32 v191, 640
    v_cmpx_ne_u32 vcc, 0, v190
    ds_write_b32 v191, v184 offset:4
    s_mov_b64 exec, 1
    v_mov_b32 v190, s21
    ds_add_u32 v191, v190 offset:8
    s_mov_b64 exec, -1
L_XT1R:
    v_add_u32_sdwa v216, v143, v159 dst_sel:DWORD dst_unused:UNUSED_PAD src0_sel:BYTE_0 src1_sel:DWORD
    v_lshrrev_b32 v189, 28, v140
    v_lshl_add_u32 v216, v189, 8, v216
    v_and_b32 v189, 60, v108
    v_and_b32 v140, 0xffff, v140
    v_lshl_or_b32 v140, v189, 19, v140
    v_cndmask_b32 v188, v180, v216, s[88:89]
    v_max_u32 v216, v216, v155
    v_add_u32_sdwa v217, v143, v159 dst_sel:DWORD dst_unused:UNUSED_PAD src0_sel:BYTE_1 src1_sel:DWORD
    v_lshrrev_b32 v189, 28, v141
    v_lshl_add_u32 v217, v189, 8, v217
    v_and_b32 v189, 60, v109
    v_and_b32 v141, 0xffff, v141
    v_lshl_or_b32 v141, v189, 19, v141
    v_mov_b32_dpp v190, v188 quad_perm:[2,2,3,3] row_mask:0xf bank_mask:0xf
    v_mov_b32_dpp v219, v188 quad_perm:[0,0,1,1] row_mask:0xf bank_mask:0xf
    v_add_u32_sdwa v218, v143, v159 dst_sel:DWORD dst_unused:UNUSED_PAD src0_sel:BYTE_2 src1_sel:DWORD
    v_lshrrev_b32 v189, 28, v142
    v_lshl_add_u32 v218, v189, 8, v218
    v_mov_b32_dpp v219, v190 row_shr:4 row_mask:0xf bank_mask:0xa
    v_mov_b32 v197, 640
    s_cmp_eq_u32 s3, 6
    s_cselect_b32 exec_hi, 0, -1
    s_cmp_eq_u32 s3, 7
    s_cselect_b64 exec, 1, exec
    s_add_u32 m0, s101, 0
    s_nop 0
    buffer_load_dwordx4 v234, s[40:43], 0 offen offset:0 lds
    s_add_u32 m0, s101, 6560
    s_nop 0
    buffer_load_dwordx4 v234, s[40:43], 0 offen offset:128 lds
    s_add_u32 m0, s101, 13120
    s_nop 0
    buffer_load_dwordx4 v234, s[40:43], 0 offen offset:256 lds
    s_add_u32 m0, s101, 19680
    s_nop 0
    buffer_load_dwordx4 v234, s[40:43], 0 offen offset:384 lds
    s_mov_b64 exec, -1
    s_waitcnt lgkmcnt(0)
    s_barrier
    ds_read_u16 v198, v178 offset:1024
    ds_read_u16 v199, v178 offset:2048
    ds_read_b128 v[160:163], v185 offset:1024
    ds_read_b128 v[164:167], v185 offset:2048
    ds_read_b128 v[168:171], v185 offset:3072
    ds_read_b128 v[172:175], v185 offset:4096
    ds_read_b32 v236, v197 offset:8
    s_lshl_b32 m0, s3, 10
    v_mov_b32 v240, v207
    s_add_u32 m0, m0, 13312
    s_nop 0
    buffer_load_dwordx4 v[240:241], s[44:47], 0 idxen offen lds
    s_cmp_lg_u32 s2, 0
    s_cbranch_scc1 L_NOK
    v_mov_b32 v237, s6
    v_mov_b32 v238, 0
    buffer_store_dword v237, v238, s[52:55], 0 offen sc1
L_NOK:
    s_waitcnt lgkmcnt(5)
    v_lshl_or_b32 v198, v199, 16, v198
    v_mov_b32 v199, v198
    s_waitcnt lgkmcnt(0)
    v_add_u32_sdwa v188, v160, v164 dst_sel:DWORD dst_unused:UNUSED_PAD src0_sel:WORD_0 src1_sel:WORD_0
    v_add_u32_sdwa v192, v168, v172 dst_sel:DWORD dst_unused:UNUSED_PAD src0_sel:WORD_0 src1_sel:WORD_0
    v_add_u32_dpp v199, v199, v199 row_shr:1 row_mask:0xf bank_mask:0xf bound_ctrl:0
    v_add_u32_sdwa v189, v161, v165 dst_sel:DWORD dst_unused:UNUSED_PAD src0_sel:WORD_0 src1_sel:WORD_0
    v_add_u32_sdwa v193, v169, v173 dst_sel:DWORD dst_unused:UNUSED_PAD src0_sel:WORD_0 src1_sel:WORD_0
    v_add_u32_dpp v199, v199, v199 row_shr:2 row_mask:0xf bank_mask:0xf bound_ctrl:0
    v_add_u32_sdwa v190, v162, v166 dst_sel:DWORD dst_unused:UNUSED_PAD src0_sel:WORD_0 src1_sel:WORD_0
    v_add_u32_sdwa v194, v170, v174 dst_sel:DWORD dst_unused:UNUSED_PAD src0_sel:WORD_0 src1_sel:WORD_0
    v_add_u32_dpp v199, v199, v199 row_shr:4 row_mask:0xf bank_mask:0xf bound_ctrl:0
    v_add_u32_sdwa v191, v163, v167 dst_sel:DWORD dst_unused:UNUSED_PAD src0_sel:WORD_0 src1_sel:WORD_0
    v_add_u32_sdwa v195, v171, v175 dst_sel:DWORD dst_unused:UNUSED_PAD src0_sel:WORD_0 src1_sel:WORD_0
    v_add_u32_dpp v199, v199, v199 row_shr:8 row_mask:0xf bank_mask:0xf bound_ctrl:0
    v_add_u32 v188, v188, v192
    v_add_u32 v189, v189, v193
    v_add_u32_dpp v199, v199, v199 row_bcast:15 row_mask:0xa bank_mask:0xf
    v_add_u32 v190, v190, v194
    v_add_u32 v191, v191, v195
    v_mul_u32_u24 v196, v188, v228
    v_mad_u32_u24 v196, v189, v229, v196
    v_mad_u32_u24 v196, v190, v230, v196
    v_mad_u32_u24 v196, v191, v231, v196
    s_mov_b32 s96, -1
    s_mov_b32 s97, 0
    v_sub_u32 v200, v199, v198
    v_add_u32_sdwa v202, v199, v199 dst_sel:DWORD dst_unused:UNUSED_PAD src0_sel:WORD_0 src1_sel:WORD_1
    v_add_u32_dpp v196, v196, v196 row_shr:1 row_mask:0xf bank_mask:0xf bound_ctrl:0
    v_add_u32_sdwa v201, v200, v200 dst_sel:DWORD dst_unused:UNUSED_PAD src0_sel:WORD_0 src1_sel:WORD_1
    v_add_u32_sdwa v203, v198, v198 dst_sel:DWORD dst_unused:UNUSED_PAD src0_sel:WORD_0 src1_sel:WORD_1
    v_add_u32_dpp v196, v196, v196 row_shr:2 row_mask:0xf bank_mask:0xf bound_ctrl:0
    v_and_b32 v239, 60, v110
    v_readfirstlane_b32 s19, v236
    v_add_u32_dpp v196, v196, v196 row_shr:4 row_mask:0xf bank_mask:0xf bound_ctrl:0
    v_permlane32_swap_b32 v201, v202
    v_cndmask_b32 v203, 0, v203, s[96:97]
    v_add_u32_dpp v196, v196, v196 row_shr:8 row_mask:0xf bank_mask:0xf bound_ctrl:0
    v_add_u32 v201, v201, v202
    v_and_b32 v142, 0xffff, v142
    v_add_u32_dpp v196, v196, v196 row_bcast:15 row_mask:0xa bank_mask:0xf
    v_add_u32 v202, v201, v203
    v_lshl_or_b32 v142, v239, 19, v142
    v_add_u32_dpp v196, v196, v196 row_bcast:31 row_mask:0xc bank_mask:0xf
    v_sub_u32_sdwa v203, v202, v198 dst_sel:DWORD dst_unused:UNUSED_PAD src0_sel:DWORD src1_sel:WORD_1
    v_readlane_b32 s16, v196, 63
    s_lshl_b32 m0, s3, 10
    v_mov_b32 v240, v211
    s_add_u32 m0, m0, 21504
    s_nop 0
    buffer_load_dwordx4 v[240:241], s[44:47], 0 idxen offen lds
    s_bfe_u32 s10, s16, 0xe0002
    s_lshr_b32 s16, s16, 16
    s_lshr_b32 s11, s10, 1
    s_add_u32 s11, s11, 48
    s_and_b32 s11, s11, -128
    s_lshr_b32 s8, s4, 1
    s_mul_i32 s8, s8, s10
    s_sub_i32 s11, s11, 48
    s_sub_i32 s8, s8, s16
    s_add_i32 s11, s11, s8
    s_add_i32 s10, s10, s8
    s_bitcmp1_b32 s4, 0
    s_cselect_b32 s31, s11, s8
    s_cselect_b32 s10, s10, s11
    v_cmp_gt_i32 vcc, s31, v202
    v_cmp_gt_i32 s[34:35], s10, v202
    s_bcnt1_i32_b32 s22, vcc_lo
    s_bcnt1_i32_b32 s10, s34
    s_min_i32 s22, s22, s23
    s_max_i32 s10, s10, s24
    s_min_i32 s23, s10, s25
    v_readlane_b32 s16, v201, s22
    v_readlane_b32 s30, v201, s23
    s_add_u32 s8, s22, s7
    s_add_u32 s9, s23, s7
    s_add_u32 s10, s22, 32
    s_add_u32 s11, s23, 32
    v_readlane_b32 s26, v200, s22
    v_readlane_b32 s28, v200, s23
    v_readlane_b32 s27, v200, s10
    v_readlane_b32 s29, v200, s11
    s_sub_u32 s31, s30, s16
    s_add_u32 s10, s31, 255
    s_sub_i32 s11, s23, 16
    s_max_i32 s11, s11, s22
    v_readlane_b32 s11, v201, s11
    s_add_u32 vcc_lo, s31, 127
    s_and_b32 vcc_hi, vcc_lo, 127
    s_add_u32 vcc_hi, vcc_hi, s19
    s_cmp_lt_u32 vcc_hi, 55
    s_cselect_b32 vcc_lo, vcc_lo, s10
    s_sub_u32 s11, s11, s16
    s_add_u32 s11, s11, s19
    s_lshl_b32 s11, s11, 1
    s_and_b32 vcc_lo, vcc_lo, -256
    s_cmp_le_u32 s11, vcc_lo
    s_cselect_b32 s10, vcc_lo, s10
    s_lshr_b32 s10, s10, 8
    s_lshl_b32 s10, s10, 7
    s_sub_u32 s10, s10, s19
    s_max_i32 s10, s10, 0
    s_add_u32 s16, s16, s10
    s_add_u32 s10, s22, 16
    s_min_u32 s10, s10, s23
    s_sub_i32 s11, s23, 16
    v_cmp_ge_u32 s[34:35], s16, v203
    v_cmp_ge_u32 s[36:37], s16, v202
    v_cmp_gt_i32 vcc, s10, v177
    v_cmp_gt_i32 s[10:11], s11, v177
    v_cmp_le_u32 s[32:33], s22, v177
    v_cmp_gt_u32 s[96:97], s23, v177
    s_and_b64 s[34:35], s[34:35], vcc
    s_and_b64 s[36:37], s[36:37], vcc
    s_or_b64 s[34:35], s[34:35], s[10:11]
    s_or_b64 s[36:37], s[36:37], s[10:11]
    s_bcnt1_i32_b32 s24, s34
    s_bcnt1_i32_b32 s10, s36
    s_bcnt1_i32_b32 s11, s35
    s_bcnt1_i32_b32 s25, s37
    v_readlane_b32 s22, v200, s24
    v_readlane_b32 s10, v200, s10
    s_add_u32 s11, s11, 32
    s_add_u32 s16, s25, 32
    v_readlane_b32 s23, v200, s11
    v_readlane_b32 s11, v200, s16
    v_mov_b32 v188, s17
    v_cndmask_b32 v189, 0, v188, s[34:35]
    v_cndmask_b32 v188, 0, v188, s[36:37]
    s_and_b64 s[32:33], s[32:33], s[96:97]
    s_pack_lh_b32_b16 s22, s22, s10
    s_pack_lh_b32_b16 s23, s23, s11
    v_lshl_or_b32 v188, v188, 16, v189
    s_sub_u32 s16, s12, 37888
    s_pack_ll_b32_b16 s16, s16, s16
    s_sub_u32 s10, s22, s26
    s_sub_u32 s11, s23, s27
    s_mul_i32 s10, s10, 0x10001
    s_lshl_b32 vcc_lo, s10, 16
    s_pack_hh_b32_b16 s10, s10, s10
    s_lshl_b32 vcc_hi, s11, 16
    s_add_u32 vcc_hi, vcc_hi, s10
    s_add_u32 s96, vcc_hi, s11
    s_lshr_b32 s96, s96, 16
    s_sub_u32 s31, s31, s96
    s_cmp_gt_u32 s31, s96
    s_cselect_b32 s97, 0x4800480, 0
    s_add_u32 s16, s16, s97
    s_sub_u32 s10, s16, s26
    s_sub_u32 s11, s16, s27
    s_add_u32 s10, s10, vcc_lo
    s_add_u32 s11, s11, vcc_hi
    v_mov_b32 v192, s10
    v_mov_b32 v193, s11
    s_add_u32 s16, s16, 0x4800480
    s_sub_u32 s16, s16, s97
    s_sub_u32 s16, s16, s97
    s_sub_u32 s10, s28, s22
    s_sub_u32 s11, s29, s23
    s_mul_i32 s10, s10, 0x10001
    s_lshl_b32 vcc_lo, s10, 16
    s_pack_hh_b32_b16 s10, s10, s10
    s_lshl_b32 vcc_hi, s11, 16
    s_add_u32 vcc_hi, vcc_hi, s10
    s_sub_u32 s10, s16, s22
    s_sub_u32 s11, s16, s23
    s_add_u32 s10, s10, vcc_lo
    s_add_u32 s11, s11, vcc_hi
    v_mov_b32 v194, s10
    v_mov_b32 v195, s11
    v_bfi_b32 v192, v188, v192, v194
    v_bfi_b32 v193, v188, v193, v195
    s_mov_b32 exec_hi, 0
    v_mov_b32 v193, v192
    s_mov_b64 exec, s[32:33]
    v_add_u32 v200, v200, v193
    s_bfe_u32 s10, s97, 0x10007
    s_lshl1_add_u32 s10, s4, s10
    s_lshl_b32 s10, s10, 2
    v_cndmask_b32 v188, 4, 0, s[34:35]
    ds_write_b16 v178, v200 offset:1026
    ds_write_b16_d16_hi v178, v200 offset:2050
    s_mov_b32 exec_hi, 0
    v_xor_b32 v188, s10, v188
    ds_write_b32 v179, v188
    s_mov_b64 exec, -1
    s_min_u32 s10, s31, s96
    s_max_u32 s96, s31, s96
    s_mov_b32 s31, s10
    s_add_u32 s10, s96, s19
    s_mul_i32 s11, s30, 9216
    s_lshr_b32 s11, s11, 16
    s_max_u32 s10, s10, s11
    s_cmp_lt_u32 s10, 1152
    s_cbranch_scc1 L_LFIT
    ds_write_b32 v197, v184
L_LFIT:
    s_cmp_eq_u32 s19, 0
    s_cbranch_scc1 L_XCNR
    s_sub_u32 s10, s12, 37888
    s_add_u32 s11, s10, s96
    v_mov_b32 v188, s11
    s_add_u32 s11, s10, s31
    s_add_u32 s11, s11, 1152
    v_mov_b32 v189, s11
    s_lshl_b32 s10, s4, 3
    v_mov_b32 v190, s10
    ds_write_b64 v190, v[188:189] offset:576
L_XCNR:
    s_lshl_b32 m0, s3, 10
    v_mov_b32 v240, v215
    s_add_u32 m0, m0, 29696
    s_nop 0
    buffer_load_dwordx4 v[240:241], s[44:47], 0 idxen offen lds
    s_waitcnt lgkmcnt(0)
    s_barrier
    ds_read_b64 v[202:203], v197
    ds_read_u16 v96, v96 offset:1026
    ds_read_u16 v97, v97 offset:1026
    ds_read_u16 v98, v98 offset:1026
    ds_read_u16 v100, v100 offset:1026
    ds_read_u16 v101, v101 offset:1026
    ds_read_u16 v102, v102 offset:1026
    ds_read_u16 v104, v104 offset:1026
    ds_read_u16 v105, v105 offset:1026
    ds_read_u16 v106, v106 offset:1026
    ds_read_u16 v108, v108 offset:1026
    ds_read_u16 v109, v109 offset:1026
    ds_read_u16 v110, v110 offset:1026
    s_lshl_b32 m0, s3, 10
    v_mov_b32 v240, v219
    s_add_u32 m0, m0, 37888
    s_nop 0
    buffer_load_dwordx4 v[240:241], s[44:47], 0 idxen offen lds
    s_add_u32 s24, s24, s7
    s_add_u32 s11, s25, s7
    s_and_b32 s10, s11, 15
    s_cmp_lt_u32 s11, s24
    s_cselect_b32 s25, s10, 16
    s_cmp_lg_u32 s97, 0
    s_cselect_b32 s23, s8, s11
    s_cselect_b32 s7, s8, s24
    s_cselect_b32 s8, s11, s8
    s_cselect_b32 s24, s9, s24
    s_cselect_b32 s9, s11, s9
    s_min_u32 s22, s8, 192
    s_min_u32 s23, s23, 192
    s_mov_b32 s30, s19
    s_waitcnt lgkmcnt(12)
    v_cmp_ne_u32 vcc, 0, v202
    v_readfirstlane_b32 s19, v203
    s_cbranch_vccnz L_OVF
    s_waitcnt lgkmcnt(9)
    s_mov_b64 exec, s[64:65]
    v_add_u32 v96, v96, v112
    ds_write2st64_b32 v96, v128, v204 offset0:148 offset1:220
    s_mov_b64 exec, s[66:67]
    v_add_u32 v97, v97, v113
    ds_write2st64_b32 v97, v129, v205 offset0:148 offset1:220
    s_mov_b64 exec, s[68:69]
    v_add_u32 v98, v98, v114
    ds_write2st64_b32 v98, v130, v206 offset0:148 offset1:220
    s_waitcnt lgkmcnt(9)
    s_mov_b64 exec, s[72:73]
    v_add_u32 v100, v100, v116
    ds_write2st64_b32 v100, v132, v208 offset0:148 offset1:220
    s_mov_b64 exec, s[74:75]
    v_add_u32 v101, v101, v117
    ds_write2st64_b32 v101, v133, v209 offset0:148 offset1:220
    s_mov_b64 exec, s[76:77]
    v_add_u32 v102, v102, v118
    ds_write2st64_b32 v102, v134, v210 offset0:148 offset1:220
    s_waitcnt lgkmcnt(9)
    s_mov_b64 exec, s[80:81]
    v_add_u32 v104, v104, v120
    ds_write2st64_b32 v104, v136, v212 offset0:148 offset1:220
    s_mov_b64 exec, s[82:83]
    v_add_u32 v105, v105, v121
    ds_write2st64_b32 v105, v137, v213 offset0:148 offset1:220
    s_mov_b64 exec, s[84:85]
    v_add_u32 v106, v106, v122
    ds_write2st64_b32 v106, v138, v214 offset0:148 offset1:220
    s_waitcnt lgkmcnt(9)
    s_mov_b64 exec, s[88:89]
    v_add_u32 v108, v108, v124
    ds_write2st64_b32 v108, v140, v216 offset0:148 offset1:220
    s_mov_b64 exec, s[90:91]
    v_add_u32 v109, v109, v125
    ds_write2st64_b32 v109, v141, v217 offset0:148 offset1:220
    s_mov_b64 exec, s[92:93]
    v_add_u32 v110, v110, v126
    ds_write2st64_b32 v110, v142, v218 offset0:148 offset1:220
    s_mov_b64 exec, -1
    s_add_u32 s10, s96, 127
    s_lshr_b32 s10, s10, 7
    s_lshl1_add_u32 s10, s10, -1
    s_add_u32 s11, s31, 127
    s_lshr_b32 s11, s11, 6
    s_and_b32 s11, s11, -2
    s_max_i32 s17, s10, s11
    s_cselect_b32 s10, s96, s31
    s_sub_u32 s10, s10, 1
    s_andn2_b32 s99, 64, s10
L_CA:
    ds_read_b64_tr_b16 v[96:97], v225 offset:0
    ds_read_b64_tr_b16 v[98:99], v225 offset:1280
    ds_read_b64_tr_b16 v[100:101], v225 offset:5120
    ds_read_b64_tr_b16 v[102:103], v225 offset:6400
    ds_read_b64_tr_b16 v[104:105], v225 offset:32
    ds_read_b64_tr_b16 v[106:107], v225 offset:1312
    ds_read_b64_tr_b16 v[108:109], v225 offset:5152
    ds_read_b64_tr_b16 v[110:111], v225 offset:6432
    ds_read_b64_tr_b16 v[112:113], v225 offset:64
    ds_read_b64_tr_b16 v[114:115], v225 offset:1344
    ds_read_b64_tr_b16 v[116:117], v225 offset:5184
    ds_read_b64_tr_b16 v[118:119], v225 offset:6464
    ds_read_b64_tr_b16 v[120:121], v225 offset:96
    ds_read_b64_tr_b16 v[122:123], v225 offset:1376
    ds_read_b64_tr_b16 v[124:125], v225 offset:5216
    ds_read_b64_tr_b16 v[126:127], v225 offset:6496
    s_cmp_eq_u32 s21, 0
    s_cbranch_scc1 L_XT2R
    s_waitcnt vmcnt(8)
L_XT2:
    s_mov_b64 s[34:35], 0
    v_cmp_ne_u32 vcc, s6, v65
    s_and_b64 vcc, vcc, s[70:71]
    s_or_b64 s[34:35], s[34:35], vcc
    v_cmp_ne_u32 vcc, s6, v69
    s_and_b64 vcc, vcc, s[78:79]
    s_or_b64 s[34:35], s[34:35], vcc
    v_cmp_ne_u32 vcc, s6, v73
    s_and_b64 vcc, vcc, s[86:87]
    s_or_b64 s[34:35], s[34:35], vcc
    v_cmp_ne_u32 vcc, s6, v77
    s_and_b64 vcc, vcc, s[94:95]
    s_or_b64 s[34:35], s[34:35], vcc
    s_cbranch_scc1 L_XT2B
    s_cmp_eq_u32 s20, 0
    s_cbranch_scc1 L_XT2R
    s_mov_b64 exec, s[70:71]
    s_cbranch_execz L_XS0
    v_bfe_u32 v65, v64, 18, 8
    v_lshlrev_b32 v65, 2, v65
    v_add_u32 v67, 153728, v65
    ds_read_b32 v67, v67
    v_add_u32_sdwa v66, v66, v156 dst_sel:DWORD dst_unused:UNUSED_PAD src0_sel:BYTE_0 src1_sel:DWORD
    v_lshrrev_b32 v189, 28, v64
    v_lshl_add_u32 v66, v189, 8, v66
    v_and_b32 v189, 60, v65
    v_and_b32 v64, 0xffff, v64
    v_lshl_or_b32 v64, v189, 19, v64
    s_waitcnt lgkmcnt(0)
    ds_add_rtn_u32 v67, v67, v184 offset:576
    s_waitcnt lgkmcnt(0)
    ds_write2st64_b32 v67, v64, v66 offset0:148 offset1:220
L_XS0:
    s_mov_b64 exec, s[78:79]
    s_cbranch_execz L_XS1
    v_bfe_u32 v69, v68, 18, 8
    v_lshlrev_b32 v69, 2, v69
    v_add_u32 v71, 153728, v69
    ds_read_b32 v71, v71
    v_add_u32_sdwa v70, v70, v157 dst_sel:DWORD dst_unused:UNUSED_PAD src0_sel:BYTE_0 src1_sel:DWORD
    v_lshrrev_b32 v189, 28, v68
    v_lshl_add_u32 v70, v189, 8, v70
    v_and_b32 v189, 60, v69
    v_and_b32 v68, 0xffff, v68
    v_lshl_or_b32 v68, v189, 19, v68
    s_waitcnt lgkmcnt(0)
    ds_add_rtn_u32 v71, v71, v184 offset:576
    s_waitcnt lgkmcnt(0)
    ds_write2st64_b32 v71, v68, v70 offset0:148 offset1:220
L_XS1:
    s_mov_b64 exec, s[86:87]
    s_cbranch_execz L_XS2
    v_bfe_u32 v73, v72, 18, 8
    v_lshlrev_b32 v73, 2, v73
    v_add_u32 v75, 153728, v73
    ds_read_b32 v75, v75
    v_add_u32_sdwa v74, v74, v158 dst_sel:DWORD dst_unused:UNUSED_PAD src0_sel:BYTE_0 src1_sel:DWORD
    v_lshrrev_b32 v189, 28, v72
    v_lshl_add_u32 v74, v189, 8, v74
    v_and_b32 v189, 60, v73
    v_and_b32 v72, 0xffff, v72
    v_lshl_or_b32 v72, v189, 19, v72
    s_waitcnt lgkmcnt(0)
    ds_add_rtn_u32 v75, v75, v184 offset:576
    s_waitcnt lgkmcnt(0)
    ds_write2st64_b32 v75, v72, v74 offset0:148 offset1:220
L_XS2:
    s_mov_b64 exec, s[94:95]
    s_cbranch_execz L_XS3
    v_bfe_u32 v77, v76, 18, 8
    v_lshlrev_b32 v77, 2, v77
    v_add_u32 v79, 153728, v77
    ds_read_b32 v79, v79
    v_add_u32_sdwa v78, v78, v159 dst_sel:DWORD dst_unused:UNUSED_PAD src0_sel:BYTE_0 src1_sel:DWORD
    v_lshrrev_b32 v189, 28, v76
    v_lshl_add_u32 v78, v189, 8, v78
    v_and_b32 v189, 60, v77
    v_and_b32 v76, 0xffff, v76
    v_lshl_or_b32 v76, v189, 19, v76
    s_waitcnt lgkmcnt(0)
    ds_add_rtn_u32 v79, v79, v184 offset:576
    s_waitcnt lgkmcnt(0)
    ds_write2st64_b32 v79, v76, v78 offset0:148 offset1:220
L_XS3:
    s_mov_b64 exec, -1
L_XT2R:
    s_lshl_b32 s34, s22, 5
    s_lshl_b32 s35, s23, 5
    s_mov_b32 vcc_lo, 0xff00ff00
    s_mov_b32 vcc_hi, 0xff00ff00
    v_mov_b32 v176, s35
    v_mov_b32 v177, s34
    v_cndmask_b32 v176, v176, v177, vcc
    v_and_b32 v177, 4, v247
    v_lshlrev_b32 v177, 6, v177
    v_lshl_add_u32 v177, v246, 2, v177
    v_sub_u32 v177, v177, v176
    v_and_b32 v178, 48, v247
    s_movk_i32 s34, 832
    v_mad_u32_u24 v178, v246, s34, v178
    s_mov_b32 s34, 116736
    v_add3_u32 v178, v178, v176, s34
    v_and_b32 v176, 0x1ff, v177
    v_add_u32 v176, v176, v178
    v_add_u32 v177, 0x80, v177
    v_and_b32 v177, 0x1ff, v177
    v_add_u32 v177, v177, v178
    v_mov_b64 v[184:185], 0
    v_mov_b64 v[186:187], 0
    v_lshrrev_b32 v188, 2, v247
    v_and_b32 v188, 12, v188
    v_subrev_u32 v188, s25, v188
    v_mov_b32 v189, 0x358637bd
    v_mfma_f32_32x32x16_bf16 v[144:159], v[184:187], v[184:187], 0
    v_cmp_ne_u32 s[80:81], 0, v188
    v_cmp_ne_u32 s[82:83], -1, v188
    v_cmp_ne_u32 s[84:85], -2, v188
    v_cmp_ne_u32 s[86:87], -3, v188
    v_cndmask_b32 v128, 0, v189, s[80:81]
    v_cndmask_b32 v129, 0, v189, s[82:83]
    v_cndmask_b32 v130, 0, v189, s[84:85]
    v_cndmask_b32 v131, 0, v189, s[86:87]
    v_mov_b64 v[132:133], v[128:129]
    v_mov_b64 v[134:135], v[130:131]
    v_mov_b64 v[136:137], v[128:129]
    v_mov_b64 v[138:139], v[130:131]
    v_mov_b64 v[140:141], v[128:129]
    v_mov_b64 v[142:143], v[130:131]
    s_cmp_ge_u32 s3, 4
    s_cbranch_scc1 L_EP0
    s_lshl_b32 s72, s4, 7
    s_add_u32 s72, s72, 157824
    v_mov_b32 v190, s22
    s_mov_b32 exec_lo, 0xffff0000
    v_mov_b32 v190, s23
    s_mov_b32 exec_lo, -1
    s_mov_b32 exec_hi, 0
    v_sub_u32 v191, v247, v190
    v_and_b32 v191, 15, v191
    v_add_lshl_u32 v191, v191, v190, 5
    v_lshl_add_u32 v190, v247, 2, s72
    ds_write_b32 v190, v191
    s_mov_b32 exec_hi, -1
    s_mul_i32 s10, s5, 196
    s_add_u32 s11, s10, s7
    s_add_u32 s62, s10, s9
    s_min_u32 s11, s11, 50000
    s_min_u32 s62, s62, 50000
    s_sub_u32 s62, s62, s11
    s_lshl_b32 s11, s11, 7
    s_lshl_b32 s62, s62, 7
    s_add_u32 s60, s48, s11
    s_addc_u32 s61, s49, 0
    s_mul_i32 s74, s7, -128
    s_add_u32 s11, s10, s8
    s_add_u32 s50, s10, s24
    s_min_u32 s11, s11, 50000
    s_min_u32 s50, s50, 50000
    s_sub_u32 s50, s50, s11
    s_lshl_b32 s11, s11, 7
    s_lshl_b32 s50, s50, 7
    s_add_u32 s48, s48, s11
    s_addc_u32 s49, s49, 0
    s_mul_i32 s73, s8, -128
    s_and_b32 s10, s25, 12
    s_lshl_b32 s10, s10, 2
    s_bfm_b64 s[76:77], 16, s10
L_EP0:
    s_waitcnt vmcnt(0) lgkmcnt(0)
    s_barrier
    s_mov_b32 s10, 0x358637bd
    ds_read_b128 v[236:239], v248
    ds_read_b32 v240, v249
    ds_read_b128 v[160:163], v176 offset:0
    ds_read_b128 v[164:167], v176 offset:64
    ds_read_b128 v[168:171], v177 offset:0
    ds_read_b128 v[172:175], v177 offset:64
    s_waitcnt lgkmcnt(4)
    s_cmp_ge_u32 s3, 4
    s_cbranch_scc1 L_LATE0
    s_add_u32 m0, s13, 0
    v_mad_u32_u16 v236, v236, s15, v243
    buffer_load_dwordx4 v236, s[40:43], 0 offen lds
    s_add_u32 m0, s13, 1056
    v_mad_u32_u16 v237, v237, s15, v243
    buffer_load_dwordx4 v237, s[40:43], 0 offen lds
    s_add_u32 m0, s13, 2112
    v_mad_u32_u16 v238, v238, s15, v243
    buffer_load_dwordx4 v238, s[40:43], 0 offen lds
    s_add_u32 m0, s13, 3168
    v_mad_u32_u16 v239, v239, s15, v243
    buffer_load_dwordx4 v239, s[40:43], 0 offen lds
    s_mov_b32 m0, s14
    s_nop 0
    buffer_load_dwordx4 v[240:241], s[44:47], 0 idxen offen lds
L_LATE0:
    s_mov_b32 s34, 0xbfb8aa3b
    s_mov_b32 s35, s34
    s_waitcnt lgkmcnt(3)
    v_mfma_f32_16x16x32_bf16 v[204:207], v[160:163], v[96:99], 0
    v_mfma_f32_16x16x32_bf16 v[212:215], v[160:163], v[104:107], 0
    v_mfma_f32_16x16x32_bf16 v[220:223], v[160:163], v[112:115], 0
    v_mfma_f32_16x16x32_bf16 v[228:231], v[160:163], v[120:123], 0
    s_waitcnt lgkmcnt(2)
    v_mfma_f32_16x16x32_bf16 v[204:207], v[164:167], v[100:103], v[204:207]
    v_mfma_f32_16x16x32_bf16 v[212:215], v[164:167], v[108:111], v[212:215]
    v_mfma_f32_16x16x32_bf16 v[220:223], v[164:167], v[116:119], v[220:223]
    v_mfma_f32_16x16x32_bf16 v[228:231], v[164:167], v[124:127], v[228:231]
    s_waitcnt lgkmcnt(1)
    v_mfma_f32_16x16x32_bf16 v[208:211], v[168:171], v[96:99], 0
    v_mfma_f32_16x16x32_bf16 v[216:219], v[168:171], v[104:107], 0
    v_mfma_f32_16x16x32_bf16 v[224:227], v[168:171], v[112:115], 0
    v_mfma_f32_16x16x32_bf16 v[232:235], v[168:171], v[120:123], 0
    s_waitcnt lgkmcnt(0)
    v_mfma_f32_16x16x32_bf16 v[208:211], v[172:175], v[100:103], v[208:211]
    v_mfma_f32_16x16x32_bf16 v[216:219], v[172:175], v[108:111], v[216:219]
    v_mfma_f32_16x16x32_bf16 v[224:227], v[172:175], v[116:119], v[224:227]
    v_mfma_f32_16x16x32_bf16 v[232:235], v[172:175], v[124:127], v[232:235]
    s_mov_b32 s11, s10
    v_mov_b64 v[96:97], s[10:11]
    v_mov_b64 v[98:99], s[10:11]
    v_mov_b64 v[100:101], s[10:11]
    v_mov_b64 v[102:103], s[10:11]
    v_mov_b64 v[104:105], s[10:11]
    v_mov_b64 v[106:107], s[10:11]
    v_mov_b64 v[108:109], s[10:11]
    v_mov_b64 v[110:111], s[10:11]
    v_pk_mul_f32 v[204:205], v[204:205], s[34:35]
    v_pk_mul_f32 v[206:207], v[206:207], s[34:35]
    v_pk_mul_f32 v[208:209], v[208:209], s[34:35]
    v_pk_mul_f32 v[210:211], v[210:211], s[34:35]
    v_pk_mul_f32 v[212:213], v[212:213], s[34:35]
    v_pk_mul_f32 v[214:215], v[214:215], s[34:35]
    v_pk_mul_f32 v[216:217], v[216:217], s[34:35]
    v_pk_mul_f32 v[218:219], v[218:219], s[34:35]
    v_pk_mul_f32 v[220:221], v[220:221], s[34:35]
    v_pk_mul_f32 v[222:223], v[222:223], s[34:35]
    v_pk_mul_f32 v[224:225], v[224:225], s[34:35]
    v_pk_mul_f32 v[226:227], v[226:227], s[34:35]
    v_pk_mul_f32 v[228:229], v[228:229], s[34:35]
    v_pk_mul_f32 v[230:231], v[230:231], s[34:35]
    v_pk_mul_f32 v[232:233], v[232:233], s[34:35]
    v_pk_mul_f32 v[234:235], v[234:235], s[34:35]
    v_mfma_f32_32x32x16_bf16 v[112:127], v[184:187], v[184:187], 0
    v_cvt_pk_bf16_f32 v64, v204, v205
    v_cvt_pk_bf16_f32 v65, v206, v207
    v_cvt_pk_bf16_f32 v66, v208, v209
    v_cvt_pk_bf16_f32 v67, v210, v211
    v_cvt_pk_bf16_f32 v68, v212, v213
    v_cvt_pk_bf16_f32 v69, v214, v215
    v_cvt_pk_bf16_f32 v70, v216, v217
    v_cvt_pk_bf16_f32 v71, v218, v219
    v_cvt_pk_bf16_f32 v72, v220, v221
    v_cvt_pk_bf16_f32 v73, v222, v223
    v_cvt_pk_bf16_f32 v74, v224, v225
    v_cvt_pk_bf16_f32 v75, v226, v227
    v_cvt_pk_bf16_f32 v76, v228, v229
    v_cvt_pk_bf16_f32 v77, v230, v231
    v_cvt_pk_bf16_f32 v78, v232, v233
    v_cvt_pk_bf16_f32 v79, v234, v235
    v_permlane32_swap_b32 v80, v64
    v_permlane32_swap_b32 v81, v65
    v_permlane32_swap_b32 v82, v66
    v_permlane32_swap_b32 v83, v67
    v_permlane32_swap_b32 v84, v68
    v_permlane32_swap_b32 v85, v69
    v_permlane32_swap_b32 v86, v70
    v_permlane32_swap_b32 v87, v71
    v_permlane32_swap_b32 v88, v72
    v_permlane32_swap_b32 v89, v73
    v_permlane32_swap_b32 v90, v74
    v_permlane32_swap_b32 v91, v75
    v_permlane32_swap_b32 v92, v76
    v_permlane32_swap_b32 v93, v77
    v_permlane32_swap_b32 v94, v78
    v_permlane32_swap_b32 v95, v79
    s_mov_b32 s26, -1
    s_mov_b64 s[32:33], 0
    s_mov_b32 s28, 0
    s_mov_b32 s29, 0
    s_cmp_lt_u32 s3, 4
    s_cbranch_scc1 L_HAD0
    s_add_u32 m0, s13, 0
    v_mad_u32_u16 v236, v236, s15, v243
    buffer_load_dwordx4 v236, s[40:43], 0 offen lds
    s_add_u32 m0, s13, 1056
    v_mad_u32_u16 v237, v237, s15, v243
    buffer_load_dwordx4 v237, s[40:43], 0 offen lds
    s_add_u32 m0, s13, 2112
    v_mad_u32_u16 v238, v238, s15, v243
    buffer_load_dwordx4 v238, s[40:43], 0 offen lds
    s_add_u32 m0, s13, 3168
    v_mad_u32_u16 v239, v239, s15, v243
    buffer_load_dwordx4 v239, s[40:43], 0 offen lds
    s_mov_b32 m0, s14
    s_nop 0
    buffer_load_dwordx4 v[240:241], s[44:47], 0 idxen offen lds
    s_lshl_b32 s72, s4, 7
    s_add_u32 s72, s72, 157824
    v_mov_b32 v190, s22
    s_mov_b32 exec_lo, 0xffff0000
    v_mov_b32 v190, s23
    s_mov_b32 exec_lo, -1
    s_mov_b32 exec_hi, 0
    v_sub_u32 v191, v247, v190
    v_and_b32 v191, 15, v191
    v_add_lshl_u32 v191, v191, v190, 5
    v_lshl_add_u32 v190, v247, 2, s72
    ds_write_b32 v190, v191
    s_mov_b32 exec_hi, -1
    s_mul_i32 s10, s5, 196
    s_add_u32 s11, s10, s7
    s_add_u32 s62, s10, s9
    s_min_u32 s11, s11, 50000
    s_min_u32 s62, s62, 50000
    s_sub_u32 s62, s62, s11
    s_lshl_b32 s11, s11, 7
    s_lshl_b32 s62, s62, 7
    s_add_u32 s60, s48, s11
    s_addc_u32 s61, s49, 0
    s_mul_i32 s74, s7, -128
    s_add_u32 s11, s10, s8
    s_add_u32 s50, s10, s24
    s_min_u32 s11, s11, 50000
    s_min_u32 s50, s50, 50000
    s_sub_u32 s50, s50, s11
    s_lshl_b32 s11, s11, 7
    s_lshl_b32 s50, s50, 7
    s_add_u32 s48, s48, s11
    s_addc_u32 s49, s49, 0
    s_mul_i32 s73, s8, -128
    s_and_b32 s10, s25, 12
    s_lshl_b32 s10, s10, 2
    s_bfm_b64 s[76:77], 16, s10
L_HAD0:
    s_cmp_eq_u32 s30, 0
    s_cbranch_scc1 L_GO
    s_lshl_b32 s10, s4, 3
    v_mov_b32 v188, s10
    ds_read_b64 v[188:189], v188 offset:576
    s_waitcnt lgkmcnt(0)
    v_readfirstlane_b32 s34, v188
    v_readfirstlane_b32 s35, v189
    s_sub_u32 s10, s12, 37888
    s_sub_u32 s34, s34, s10
    s_sub_u32 s35, s35, s10
    s_sub_u32 s35, s35, 1152
    s_add_u32 s10, s34, 127
    s_lshr_b32 s10, s10, 7
    s_lshl1_add_u32 s10, s10, -1
    s_add_u32 s11, s35, 127
    s_lshr_b32 s11, s11, 6
    s_and_b32 s11, s11, -2
    s_max_i32 s17, s10, s11
    s_cselect_b32 s10, s34, s35
    s_sub_u32 s10, s10, 1
    s_andn2_b32 s99, 64, s10
L_GO:
    ds_read_u16 v252, v250 offset:0
    ds_read_u16 v253, v250 offset:64
    ds_read_b128 v[236:239], v248 offset:1152
    ds_read_b32 v240, v249 offset:1152
    s_lshr_b32 s10, s4, 1
    s_lshl_b32 s10, s10, 9
    s_add_u32 s10, s10, 155776
    v_lshl_add_u32 v246, v247, 3, s10
    s_bitcmp1_b32 s4, 0
    s_cselect_b32 s101, -1, 1
    s_mul_i32 s10, s101, 0xff000000
    s_or_b32 s10, s10, 0xdddd
    v_mov_b32 v255, s10
    s_max_i32 s10, s17, 1
    s_sub_u32 s10, s10, 1
    s_mul_i32 s10, s101, s10
    s_lshl_b32 s10, s10, 24
    v_mov_b32 v188, s10
    ds_add_u32 v246, v188
    s_movk_i32 s94, 128
    s_movk_i32 s95, 128
    v_mov_b32 v247, 0
    s_mov_b32 exec_hi, 0
    v_add_u32 v247, 0x200, v245
    s_mov_b32 exec_hi, -1
    s_waitcnt lgkmcnt(0)
    v_bfi_b32 v252, 31, v245, v252
    v_bfi_b32 v253, 31, v245, v253
    v_max_u32 v252, v252, v245
    v_max_u32 v253, v253, v247
    s_waitcnt vmcnt(0)
    ds_read_b128 v[176:179], v252
    ds_read_b128 v[180:183], v253
    ds_read_b128 v[160:163], v244 offset:0
    ds_read_b128 v[168:171], v244 offset:512
    ds_read_b128 v[164:167], v244 offset:64
    ds_read_b128 v[172:175], v244 offset:576
    s_cmp_lt_i32 s17, 1
    s_cbranch_scc1 L_DONE
    s_waitcnt lgkmcnt(4)
    v_mfma_f32_16x16x32_bf16 v[188:191], v[176:179], v[64:67], 0
    v_mfma_f32_16x16x32_bf16 v[196:199], v[176:179], v[68:71], 0
    v_mfma_f32_16x16x32_bf16 v[192:195], v[180:183], v[64:67], 0
    v_mfma_f32_16x16x32_bf16 v[200:203], v[180:183], v[68:71], 0
    s_waitcnt lgkmcnt(0)
    v_mfma_f32_16x16x32_bf16 v[188:191], v[160:163], v[0:3], v[188:191]
    v_mfma_f32_16x16x32_bf16 v[196:199], v[160:163], v[8:11], v[196:199]
    v_mfma_f32_16x16x32_bf16 v[192:195], v[168:171], v[0:3], v[192:195]
    v_mfma_f32_16x16x32_bf16 v[200:203], v[168:171], v[8:11], v[200:203]
    v_mfma_f32_16x16x32_bf16 v[188:191], v[164:167], v[4:7], v[188:191]
    v_mfma_f32_16x16x32_bf16 v[196:199], v[164:167], v[12:15], v[196:199]
    v_mfma_f32_16x16x32_bf16 v[192:195], v[172:175], v[4:7], v[192:195]
    v_mfma_f32_16x16x32_bf16 v[200:203], v[172:175], v[12:15], v[200:203]
    s_mov_b32 s16, 1
    s_cmp_eq_u32 s17, 1
    s_cbranch_scc1 L_LT0
    s_add_u32 m0, s13, 0
    v_mad_u32_u16 v236, v236, s15, v243
    buffer_load_dwordx4 v236, s[40:43], 0 offen lds
    s_add_u32 m0, s13, 1056
    v_mad_u32_u16 v237, v237, s15, v243
    buffer_load_dwordx4 v237, s[40:43], 0 offen lds
    s_add_u32 m0, s13, 2112
    v_mad_u32_u16 v238, v238, s15, v243
    buffer_load_dwordx4 v238, s[40:43], 0 offen lds
    s_add_u32 m0, s13, 3168
    v_mad_u32_u16 v239, v239, s15, v243
    buffer_load_dwordx4 v239, s[40:43], 0 offen lds
    s_mov_b32 m0, s14
    s_nop 0
    buffer_load_dwordx4 v[240:241], s[44:47], 0 idxen offen lds
.p2align 6
L_LOOP1:
    s_setprio 1
    v_smfmac_f32_16x16x64_bf16 v[152:155], v[184:187], v[204:211], v255
    ds_read_u16 v236, v251 offset:0
    ds_read_u16 v237, v251 offset:16
    ds_add_rtn_u32 v238, v246, v255
    v_exp_f32 v188, v188
    v_smfmac_f32_16x16x64_bf16 v[156:159], v[184:187], v[212:219], v255
    v_exp_f32 v189, v189
    v_mfma_f32_16x16x32_bf16 v[204:207], v[160:163], v[32:35], 0
    v_exp_f32 v190, v190
    v_mfma_f32_16x16x32_bf16 v[212:215], v[160:163], v[40:43], 0
    v_exp_f32 v191, v191
    v_mfma_f32_16x16x32_bf16 v[208:211], v[168:171], v[32:35], 0
    v_exp_f32 v192, v192
    v_mfma_f32_16x16x32_bf16 v[216:219], v[168:171], v[40:43], 0
    v_exp_f32 v193, v193
    v_mfma_f32_16x16x32_bf16 v[204:207], v[164:167], v[36:39], v[204:207]
    v_exp_f32 v194, v194
    v_mfma_f32_16x16x32_bf16 v[212:215], v[164:167], v[44:47], v[212:215]
    v_exp_f32 v195, v195
    v_mfma_f32_16x16x32_bf16 v[208:211], v[172:175], v[36:39], v[208:211]
    s_waitcnt lgkmcnt(0)
    v_bfi_b32 v236, 31, v246, v236
    v_bfi_b32 v237, 31, v246, v237
    v_readfirstlane_b32 s96, v238
    v_exp_f32 v196, v196
    v_mfma_f32_16x16x32_bf16 v[216:219], v[172:175], v[44:47], v[216:219]
    v_exp_f32 v197, v197
    v_smfmac_f32_16x16x64_bf16 v[136:139], v[184:187], v[220:227], v255
    v_exp_f32 v198, v198
    v_smfmac_f32_16x16x64_bf16 v[140:143], v[184:187], v[228:235], v255
    v_exp_f32 v199, v199
    v_mfma_f32_4x4x4_16b_bf16 v[188:191], v[242:243], v[242:243], v[188:191]
    v_exp_f32 v200, v200
    v_mfma_f32_4x4x4_16b_bf16 v[192:195], v[242:243], v[242:243], v[192:195]
    v_exp_f32 v201, v201
    v_mfma_f32_4x4x4_16b_bf16 v[196:199], v[242:243], v[242:243], v[196:199]
    v_exp_f32 v202, v202
    v_mfma_f32_16x16x32_bf16 v[220:223], v[176:179], v[72:75], 0
    ds_read_b64_tr_b16 v[184:185], v236
    ds_read_b64_tr_b16 v[186:187], v237
    ds_read_u16 v252, v250 offset:1152
    ds_read_u16 v253, v250 offset:1216
    v_exp_f32 v203, v203
    v_mfma_f32_16x16x32_bf16 v[228:231], v[176:179], v[76:79], 0
    s_ashr_i32 s96, s96, 24
    s_mul_i32 s96, s96, s101
    v_rcp_f32 v188, v188
    v_mfma_f32_16x16x32_bf16 v[224:227], v[180:183], v[72:75], 0
    v_rcp_f32 v189, v189
    v_mfma_f32_4x4x4_16b_bf16 v[200:203], v[242:243], v[242:243], v[200:203]
    v_rcp_f32 v190, v190
    v_mfma_f32_16x16x32_bf16 v[232:235], v[180:183], v[76:79], 0
    v_rcp_f32 v191, v191
    v_mfma_f32_16x16x32_bf16 v[220:223], v[160:163], v[16:19], v[220:223]
    v_rcp_f32 v192, v192
    v_mfma_f32_16x16x32_bf16 v[228:231], v[160:163], v[24:27], v[228:231]
    v_rcp_f32 v193, v193
    v_mfma_f32_16x16x32_bf16 v[224:227], v[168:171], v[16:19], v[224:227]
    s_waitcnt lgkmcnt(0)
    v_bfi_b32 v252, 31, v245, v252
    v_bfi_b32 v253, 31, v245, v253
    v_max_u32 v252, v252, v245
    v_max_u32 v253, v253, v247
    ds_read_b128 v[236:239], v248 offset:128
    ds_read_b32 v240, v249 offset:128
    s_add_u32 s16, s16, 1
    v_rcp_f32 v194, v194
    v_mfma_f32_16x16x32_bf16 v[232:235], v[168:171], v[24:27], v[232:235]
    v_rcp_f32 v195, v195
    v_mfma_f32_16x16x32_bf16 v[220:223], v[164:167], v[20:23], v[220:223]
    v_rcp_f32 v196, v196
    v_mfma_f32_16x16x32_bf16 v[228:231], v[164:167], v[28:31], v[228:231]
    v_rcp_f32 v197, v197
    s_setprio 3
    v_mfma_f32_16x16x32_bf16 v[224:227], v[172:175], v[20:23], v[224:227]
    v_rcp_f32 v198, v198
    v_mfma_f32_16x16x32_bf16 v[232:235], v[172:175], v[28:31], v[232:235]
    v_rcp_f32 v199, v199
    v_rcp_f32 v200, v200
    v_rcp_f32 v201, v201
    v_rcp_f32 v202, v202
    v_rcp_f32 v203, v203
    v_pk_mul_f32 v[204:205], v[188:189], v[204:205]
    v_pk_mul_f32 v[206:207], v[190:191], v[206:207]
    v_pk_mul_f32 v[208:209], v[192:193], v[208:209]
    v_pk_mul_f32 v[210:211], v[194:195], v[210:211]
    v_pk_mul_f32 v[212:213], v[196:197], v[212:213]
    v_pk_mul_f32 v[214:215], v[198:199], v[214:215]
    v_pk_mul_f32 v[216:217], v[200:201], v[216:217]
    v_pk_mul_f32 v[218:219], v[202:203], v[218:219]
    s_cmp_ge_i32 s96, 1
    s_cbranch_scc0 L_PB00
L_PB01:
    s_setprio 1
    v_smfmac_f32_16x16x64_bf16 v[112:115], v[184:187], v[204:211], v255
    v_exp_f32 v220, v220
    v_smfmac_f32_16x16x64_bf16 v[116:119], v[184:187], v[212:219], v255
    v_exp_f32 v221, v221
    s_waitcnt vmcnt(0)
    ds_read_b128 v[176:179], v252
    ds_read_b128 v[180:183], v253
    v_mfma_f32_16x16x32_bf16 v[204:207], v[160:163], v[48:51], 0
    v_exp_f32 v222, v222
    v_mfma_f32_16x16x32_bf16 v[212:215], v[160:163], v[56:59], 0
    ds_read_b128 v[160:163], v244 offset:0
    v_exp_f32 v223, v223
    v_mfma_f32_16x16x32_bf16 v[208:211], v[168:171], v[48:51], 0
    v_exp_f32 v224, v224
    v_mfma_f32_16x16x32_bf16 v[216:219], v[168:171], v[56:59], 0
    ds_read_b128 v[168:171], v244 offset:512
    v_exp_f32 v225, v225
    v_mfma_f32_16x16x32_bf16 v[204:207], v[164:167], v[52:55], v[204:207]
    v_exp_f32 v226, v226
    v_mfma_f32_16x16x32_bf16 v[212:215], v[164:167], v[60:63], v[212:215]
    ds_read_b128 v[164:167], v244 offset:64
    v_exp_f32 v227, v227
    v_mfma_f32_16x16x32_bf16 v[208:211], v[172:175], v[52:55], v[208:211]
    v_exp_f32 v228, v228
    v_mfma_f32_16x16x32_bf16 v[216:219], v[172:175], v[60:63], v[216:219]
    ds_read_b128 v[172:175], v244 offset:576
    v_exp_f32 v229, v229
    v_smfmac_f32_16x16x64_bf16 v[96:99], v[184:187], v[188:195], v255
    v_exp_f32 v230, v230
    v_smfmac_f32_16x16x64_bf16 v[100:103], v[184:187], v[196:203], v255
    v_exp_f32 v231, v231
    v_mfma_f32_4x4x4_16b_bf16 v[220:223], v[242:243], v[242:243], v[220:223]
    v_exp_f32 v232, v232
    v_mfma_f32_4x4x4_16b_bf16 v[224:227], v[242:243], v[242:243], v[224:227]
    v_exp_f32 v233, v233
    v_mfma_f32_4x4x4_16b_bf16 v[228:231], v[242:243], v[242:243], v[228:231]
    v_exp_f32 v234, v234
    s_waitcnt lgkmcnt(4)
    v_mfma_f32_16x16x32_bf16 v[188:191], v[176:179], v[80:83], 0
    v_exp_f32 v235, v235
    v_mfma_f32_16x16x32_bf16 v[196:199], v[176:179], v[84:87], 0
    v_rcp_f32 v220, v220
    v_mfma_f32_16x16x32_bf16 v[192:195], v[180:183], v[80:83], 0
    v_rcp_f32 v221, v221
    v_mfma_f32_4x4x4_16b_bf16 v[232:235], v[242:243], v[242:243], v[232:235]
    v_rcp_f32 v222, v222
    v_mfma_f32_16x16x32_bf16 v[200:203], v[180:183], v[84:87], 0
    v_rcp_f32 v223, v223
    s_waitcnt lgkmcnt(3)
    v_mfma_f32_16x16x32_bf16 v[188:191], v[160:163], v[0:3], v[188:191]
    v_rcp_f32 v224, v224
    v_mfma_f32_16x16x32_bf16 v[196:199], v[160:163], v[8:11], v[196:199]
    v_rcp_f32 v225, v225
    s_waitcnt lgkmcnt(2)
    v_mfma_f32_16x16x32_bf16 v[192:195], v[168:171], v[0:3], v[192:195]
    v_rcp_f32 v226, v226
    v_mfma_f32_16x16x32_bf16 v[200:203], v[168:171], v[8:11], v[200:203]
    v_rcp_f32 v227, v227
    s_waitcnt lgkmcnt(1)
    v_mfma_f32_16x16x32_bf16 v[188:191], v[164:167], v[4:7], v[188:191]
    v_rcp_f32 v228, v228
    v_mfma_f32_16x16x32_bf16 v[196:199], v[164:167], v[12:15], v[196:199]
    v_rcp_f32 v229, v229
    s_setprio 3
    s_waitcnt lgkmcnt(0)
    v_mfma_f32_16x16x32_bf16 v[192:195], v[172:175], v[4:7], v[192:195]
    s_cmp_lt_u32 s16, s17
    s_cbranch_scc0 L_ND01
    s_add_u32 m0, s13, 0
    v_mad_u32_u16 v236, v236, s15, v243
    buffer_load_dwordx4 v236, s[40:43], 0 offen lds
    s_add_u32 m0, s13, 1056
    v_mad_u32_u16 v237, v237, s15, v243
    buffer_load_dwordx4 v237, s[40:43], 0 offen lds
    s_add_u32 m0, s13, 2112
    v_mad_u32_u16 v238, v238, s15, v243
    buffer_load_dwordx4 v238, s[40:43], 0 offen lds
    s_add_u32 m0, s13, 3168
    v_mad_u32_u16 v239, v239, s15, v243
    buffer_load_dwordx4 v239, s[40:43], 0 offen lds
    s_mov_b32 m0, s14
    s_nop 0
    buffer_load_dwordx4 v[240:241], s[44:47], 0 idxen offen lds
L_ND01:
    v_rcp_f32 v230, v230
    v_mfma_f32_16x16x32_bf16 v[200:203], v[172:175], v[12:15], v[200:203]
    v_rcp_f32 v231, v231
    v_rcp_f32 v232, v232
    v_rcp_f32 v233, v233
    v_rcp_f32 v234, v234
    v_rcp_f32 v235, v235
    v_pk_mul_f32 v[204:205], v[220:221], v[204:205]
    v_pk_mul_f32 v[206:207], v[222:223], v[206:207]
    v_pk_mul_f32 v[208:209], v[224:225], v[208:209]
    v_pk_mul_f32 v[210:211], v[226:227], v[210:211]
    v_pk_mul_f32 v[212:213], v[228:229], v[212:213]
    v_pk_mul_f32 v[214:215], v[230:231], v[214:215]
    v_pk_mul_f32 v[216:217], v[232:233], v[216:217]
    v_pk_mul_f32 v[218:219], v[234:235], v[218:219]
    s_cmp_ge_u32 s16, s17
    s_cbranch_scc1 L_LT1
    s_setprio 1
    v_smfmac_f32_16x16x64_bf16 v[120:123], v[184:187], v[204:211], v255
    ds_read_u16 v236, v251 offset:1152
    ds_read_u16 v237, v251 offset:1168
    ds_add_rtn_u32 v238, v246, v255
    v_exp_f32 v188, v188
    v_smfmac_f32_16x16x64_bf16 v[124:127], v[184:187], v[212:219], v255
    v_exp_f32 v189, v189
    v_mfma_f32_16x16x32_bf16 v[204:207], v[160:163], v[32:35], 0
    v_exp_f32 v190, v190
    v_mfma_f32_16x16x32_bf16 v[212:215], v[160:163], v[40:43], 0
    v_exp_f32 v191, v191
    v_mfma_f32_16x16x32_bf16 v[208:211], v[168:171], v[32:35], 0
    v_exp_f32 v192, v192
    v_mfma_f32_16x16x32_bf16 v[216:219], v[168:171], v[40:43], 0
    v_exp_f32 v193, v193
    v_mfma_f32_16x16x32_bf16 v[204:207], v[164:167], v[36:39], v[204:207]
    v_exp_f32 v194, v194
    v_mfma_f32_16x16x32_bf16 v[212:215], v[164:167], v[44:47], v[212:215]
    v_exp_f32 v195, v195
    v_mfma_f32_16x16x32_bf16 v[208:211], v[172:175], v[36:39], v[208:211]
    s_waitcnt lgkmcnt(0)
    v_bfi_b32 v236, 31, v246, v236
    v_bfi_b32 v237, 31, v246, v237
    v_readfirstlane_b32 s96, v238
    v_exp_f32 v196, v196
    v_mfma_f32_16x16x32_bf16 v[216:219], v[172:175], v[44:47], v[216:219]
    v_exp_f32 v197, v197
    v_smfmac_f32_16x16x64_bf16 v[104:107], v[184:187], v[220:227], v255
    v_exp_f32 v198, v198
    v_smfmac_f32_16x16x64_bf16 v[108:111], v[184:187], v[228:235], v255
    v_exp_f32 v199, v199
    v_mfma_f32_4x4x4_16b_bf16 v[188:191], v[242:243], v[242:243], v[188:191]
    v_exp_f32 v200, v200
    v_mfma_f32_4x4x4_16b_bf16 v[192:195], v[242:243], v[242:243], v[192:195]
    v_exp_f32 v201, v201
    v_mfma_f32_4x4x4_16b_bf16 v[196:199], v[242:243], v[242:243], v[196:199]
    v_exp_f32 v202, v202
    v_mfma_f32_16x16x32_bf16 v[220:223], v[176:179], v[88:91], 0
    ds_read_b64_tr_b16 v[184:185], v236
    ds_read_b64_tr_b16 v[186:187], v237
    ds_read_u16 v252, v250 offset:128
    ds_read_u16 v253, v250 offset:192
    v_exp_f32 v203, v203
    v_mfma_f32_16x16x32_bf16 v[228:231], v[176:179], v[92:95], 0
    s_ashr_i32 s96, s96, 24
    s_mul_i32 s96, s96, s101
    v_rcp_f32 v188, v188
    v_mfma_f32_16x16x32_bf16 v[224:227], v[180:183], v[88:91], 0
    v_rcp_f32 v189, v189
    v_mfma_f32_4x4x4_16b_bf16 v[200:203], v[242:243], v[242:243], v[200:203]
    v_rcp_f32 v190, v190
    v_mfma_f32_16x16x32_bf16 v[232:235], v[180:183], v[92:95], 0
    v_rcp_f32 v191, v191
    v_mfma_f32_16x16x32_bf16 v[220:223], v[160:163], v[16:19], v[220:223]
    v_rcp_f32 v192, v192
    v_mfma_f32_16x16x32_bf16 v[228:231], v[160:163], v[24:27], v[228:231]
    v_rcp_f32 v193, v193
    v_mfma_f32_16x16x32_bf16 v[224:227], v[168:171], v[16:19], v[224:227]
    s_waitcnt lgkmcnt(0)
    v_bfi_b32 v252, 31, v245, v252
    v_bfi_b32 v253, 31, v245, v253
    v_max_u32 v252, v252, v245
    v_max_u32 v253, v253, v247
    ds_read_b128 v[236:239], v248 offset:1280
    ds_read_b32 v240, v249 offset:1280
    s_add_u32 s16, s16, 1
    v_rcp_f32 v194, v194
    v_mfma_f32_16x16x32_bf16 v[232:235], v[168:171], v[24:27], v[232:235]
    v_lshl_add_u64 v[248:249], v[248:249], 0, s[94:95]
    v_lshl_add_u64 v[250:251], v[250:251], 0, s[94:95]
    v_rcp_f32 v195, v195
    v_mfma_f32_16x16x32_bf16 v[220:223], v[164:167], v[20:23], v[220:223]
    v_rcp_f32 v196, v196
    v_mfma_f32_16x16x32_bf16 v[228:231], v[164:167], v[28:31], v[228:231]
    v_rcp_f32 v197, v197
    s_setprio 3
    v_mfma_f32_16x16x32_bf16 v[224:227], v[172:175], v[20:23], v[224:227]
    v_rcp_f32 v198, v198
    v_mfma_f32_16x16x32_bf16 v[232:235], v[172:175], v[28:31], v[232:235]
    v_rcp_f32 v199, v199
    v_rcp_f32 v200, v200
    v_rcp_f32 v201, v201
    v_rcp_f32 v202, v202
    v_rcp_f32 v203, v203
    v_pk_mul_f32 v[204:205], v[188:189], v[204:205]
    v_pk_mul_f32 v[206:207], v[190:191], v[206:207]
    v_pk_mul_f32 v[208:209], v[192:193], v[208:209]
    v_pk_mul_f32 v[210:211], v[194:195], v[210:211]
    v_pk_mul_f32 v[212:213], v[196:197], v[212:213]
    v_pk_mul_f32 v[214:215], v[198:199], v[214:215]
    v_pk_mul_f32 v[216:217], v[200:201], v[216:217]
    v_pk_mul_f32 v[218:219], v[202:203], v[218:219]
    s_cmp_ge_i32 s96, 1
    s_cbranch_scc0 L_PB10
L_PB11:
    s_setprio 1
    v_smfmac_f32_16x16x64_bf16 v[144:147], v[184:187], v[204:211], v255
    v_exp_f32 v220, v220
    v_smfmac_f32_16x16x64_bf16 v[148:151], v[184:187], v[212:219], v255
    v_exp_f32 v221, v221
    s_waitcnt vmcnt(0)
    ds_read_b128 v[176:179], v252
    ds_read_b128 v[180:183], v253
    v_mfma_f32_16x16x32_bf16 v[204:207], v[160:163], v[48:51], 0
    v_exp_f32 v222, v222
    v_mfma_f32_16x16x32_bf16 v[212:215], v[160:163], v[56:59], 0
    ds_read_b128 v[160:163], v244 offset:0
    v_exp_f32 v223, v223
    v_mfma_f32_16x16x32_bf16 v[208:211], v[168:171], v[48:51], 0
    v_exp_f32 v224, v224
    v_mfma_f32_16x16x32_bf16 v[216:219], v[168:171], v[56:59], 0
    ds_read_b128 v[168:171], v244 offset:512
    v_exp_f32 v225, v225
    v_mfma_f32_16x16x32_bf16 v[204:207], v[164:167], v[52:55], v[204:207]
    v_exp_f32 v226, v226
    v_mfma_f32_16x16x32_bf16 v[212:215], v[164:167], v[60:63], v[212:215]
    ds_read_b128 v[164:167], v244 offset:64
    v_exp_f32 v227, v227
    v_mfma_f32_16x16x32_bf16 v[208:211], v[172:175], v[52:55], v[208:211]
    v_exp_f32 v228, v228
    v_mfma_f32_16x16x32_bf16 v[216:219], v[172:175], v[60:63], v[216:219]
    ds_read_b128 v[172:175], v244 offset:576
    v_exp_f32 v229, v229
    v_smfmac_f32_16x16x64_bf16 v[128:131], v[184:187], v[188:195], v255
    v_exp_f32 v230, v230
    v_smfmac_f32_16x16x64_bf16 v[132:135], v[184:187], v[196:203], v255
    v_exp_f32 v231, v231
    v_mfma_f32_4x4x4_16b_bf16 v[220:223], v[242:243], v[242:243], v[220:223]
    v_exp_f32 v232, v232
    v_mfma_f32_4x4x4_16b_bf16 v[224:227], v[242:243], v[242:243], v[224:227]
    v_exp_f32 v233, v233
    v_mfma_f32_4x4x4_16b_bf16 v[228:231], v[242:243], v[242:243], v[228:231]
    v_exp_f32 v234, v234
    s_waitcnt lgkmcnt(4)
    v_mfma_f32_16x16x32_bf16 v[188:191], v[176:179], v[64:67], 0
    v_exp_f32 v235, v235
    v_mfma_f32_16x16x32_bf16 v[196:199], v[176:179], v[68:71], 0
    v_rcp_f32 v220, v220
    v_mfma_f32_16x16x32_bf16 v[192:195], v[180:183], v[64:67], 0
    v_rcp_f32 v221, v221
    v_mfma_f32_4x4x4_16b_bf16 v[232:235], v[242:243], v[242:243], v[232:235]
    v_rcp_f32 v222, v222
    v_mfma_f32_16x16x32_bf16 v[200:203], v[180:183], v[68:71], 0
    v_rcp_f32 v223, v223
    s_waitcnt lgkmcnt(3)
    v_mfma_f32_16x16x32_bf16 v[188:191], v[160:163], v[0:3], v[188:191]
    v_rcp_f32 v224, v224
    v_mfma_f32_16x16x32_bf16 v[196:199], v[160:163], v[8:11], v[196:199]
    v_rcp_f32 v225, v225
    s_waitcnt lgkmcnt(2)
    v_mfma_f32_16x16x32_bf16 v[192:195], v[168:171], v[0:3], v[192:195]
    v_rcp_f32 v226, v226
    v_mfma_f32_16x16x32_bf16 v[200:203], v[168:171], v[8:11], v[200:203]
    v_rcp_f32 v227, v227
    s_waitcnt lgkmcnt(1)
    v_mfma_f32_16x16x32_bf16 v[188:191], v[164:167], v[4:7], v[188:191]
    v_rcp_f32 v228, v228
    v_mfma_f32_16x16x32_bf16 v[196:199], v[164:167], v[12:15], v[196:199]
    v_rcp_f32 v229, v229
    s_setprio 3
    s_waitcnt lgkmcnt(0)
    v_mfma_f32_16x16x32_bf16 v[192:195], v[172:175], v[4:7], v[192:195]
    s_cmp_lt_u32 s16, s17
    s_cbranch_scc0 L_ND11
    s_add_u32 m0, s13, 0
    v_mad_u32_u16 v236, v236, s15, v243
    buffer_load_dwordx4 v236, s[40:43], 0 offen lds
    s_add_u32 m0, s13, 1056
    v_mad_u32_u16 v237, v237, s15, v243
    buffer_load_dwordx4 v237, s[40:43], 0 offen lds
    s_add_u32 m0, s13, 2112
    v_mad_u32_u16 v238, v238, s15, v243
    buffer_load_dwordx4 v238, s[40:43], 0 offen lds
    s_add_u32 m0, s13, 3168
    v_mad_u32_u16 v239, v239, s15, v243
    buffer_load_dwordx4 v239, s[40:43], 0 offen lds
    s_mov_b32 m0, s14
    s_nop 0
    buffer_load_dwordx4 v[240:241], s[44:47], 0 idxen offen lds
L_ND11:
    v_rcp_f32 v230, v230
    v_mfma_f32_16x16x32_bf16 v[200:203], v[172:175], v[12:15], v[200:203]
    v_rcp_f32 v231, v231
    v_rcp_f32 v232, v232
    v_rcp_f32 v233, v233
    v_rcp_f32 v234, v234
    v_rcp_f32 v235, v235
    v_pk_mul_f32 v[204:205], v[220:221], v[204:205]
    v_pk_mul_f32 v[206:207], v[222:223], v[206:207]
    v_pk_mul_f32 v[208:209], v[224:225], v[208:209]
    v_pk_mul_f32 v[210:211], v[226:227], v[210:211]
    v_pk_mul_f32 v[212:213], v[228:229], v[212:213]
    v_pk_mul_f32 v[214:215], v[230:231], v[214:215]
    v_pk_mul_f32 v[216:217], v[232:233], v[216:217]
    v_pk_mul_f32 v[218:219], v[234:235], v[218:219]
    s_cmp_lt_u32 s16, s17
    s_cbranch_scc1 L_LOOP1
    s_branch L_LT0
.p2align 6
L_LOOP0:
    s_setprio 0
    v_smfmac_f32_16x16x64_bf16 v[152:155], v[184:187], v[204:211], v255
    ds_read_u16 v236, v251 offset:0
    ds_read_u16 v237, v251 offset:16
    ds_add_rtn_u32 v238, v246, v255
    v_exp_f32 v188, v188
    v_smfmac_f32_16x16x64_bf16 v[156:159], v[184:187], v[212:219], v255
    v_exp_f32 v189, v189
    v_mfma_f32_16x16x32_bf16 v[204:207], v[160:163], v[32:35], 0
    v_exp_f32 v190, v190
    v_mfma_f32_16x16x32_bf16 v[212:215], v[160:163], v[40:43], 0
    v_exp_f32 v191, v191
    v_mfma_f32_16x16x32_bf16 v[208:211], v[168:171], v[32:35], 0
    v_exp_f32 v192, v192
    v_mfma_f32_16x16x32_bf16 v[216:219], v[168:171], v[40:43], 0
    v_exp_f32 v193, v193
    v_mfma_f32_16x16x32_bf16 v[204:207], v[164:167], v[36:39], v[204:207]
    v_exp_f32 v194, v194
    v_mfma_f32_16x16x32_bf16 v[212:215], v[164:167], v[44:47], v[212:215]
    v_exp_f32 v195, v195
    v_mfma_f32_16x16x32_bf16 v[208:211], v[172:175], v[36:39], v[208:211]
    s_waitcnt lgkmcnt(0)
    v_bfi_b32 v236, 31, v246, v236
    v_bfi_b32 v237, 31, v246, v237
    v_readfirstlane_b32 s96, v238
    v_exp_f32 v196, v196
    v_mfma_f32_16x16x32_bf16 v[216:219], v[172:175], v[44:47], v[216:219]
    v_exp_f32 v197, v197
    v_smfmac_f32_16x16x64_bf16 v[136:139], v[184:187], v[220:227], v255
    v_exp_f32 v198, v198
    v_smfmac_f32_16x16x64_bf16 v[140:143], v[184:187], v[228:235], v255
    v_exp_f32 v199, v199
    v_mfma_f32_4x4x4_16b_bf16 v[188:191], v[242:243], v[242:243], v[188:191]
    v_exp_f32 v200, v200
    v_mfma_f32_4x4x4_16b_bf16 v[192:195], v[242:243], v[242:243], v[192:195]
    v_exp_f32 v201, v201
    v_mfma_f32_4x4x4_16b_bf16 v[196:199], v[242:243], v[242:243], v[196:199]
    v_exp_f32 v202, v202
    v_mfma_f32_16x16x32_bf16 v[220:223], v[176:179], v[72:75], 0
    ds_read_b64_tr_b16 v[184:185], v236
    ds_read_b64_tr_b16 v[186:187], v237
    ds_read_u16 v252, v250 offset:1152
    ds_read_u16 v253, v250 offset:1216
    v_exp_f32 v203, v203
    v_mfma_f32_16x16x32_bf16 v[228:231], v[176:179], v[76:79], 0
    s_ashr_i32 s96, s96, 24
    s_mul_i32 s96, s96, s101
    v_rcp_f32 v188, v188
    v_mfma_f32_16x16x32_bf16 v[224:227], v[180:183], v[72:75], 0
    v_rcp_f32 v189, v189
    v_mfma_f32_4x4x4_16b_bf16 v[200:203], v[242:243], v[242:243], v[200:203]
    v_rcp_f32 v190, v190
    v_mfma_f32_16x16x32_bf16 v[232:235], v[180:183], v[76:79], 0
    v_rcp_f32 v191, v191
    v_mfma_f32_16x16x32_bf16 v[220:223], v[160:163], v[16:19], v[220:223]
    v_rcp_f32 v192, v192
    v_mfma_f32_16x16x32_bf16 v[228:231], v[160:163], v[24:27], v[228:231]
    v_rcp_f32 v193, v193
    v_mfma_f32_16x16x32_bf16 v[224:227], v[168:171], v[16:19], v[224:227]
    s_waitcnt lgkmcnt(0)
    v_bfi_b32 v252, 31, v245, v252
    v_bfi_b32 v253, 31, v245, v253
    v_max_u32 v252, v252, v245
    v_max_u32 v253, v253, v247
    ds_read_b128 v[236:239], v248 offset:128
    ds_read_b32 v240, v249 offset:128
    s_add_u32 s16, s16, 1
    v_rcp_f32 v194, v194
    v_mfma_f32_16x16x32_bf16 v[232:235], v[168:171], v[24:27], v[232:235]
    v_rcp_f32 v195, v195
    v_mfma_f32_16x16x32_bf16 v[220:223], v[164:167], v[20:23], v[220:223]
    v_rcp_f32 v196, v196
    v_mfma_f32_16x16x32_bf16 v[228:231], v[164:167], v[28:31], v[228:231]
    v_rcp_f32 v197, v197
    s_setprio 3
    v_mfma_f32_16x16x32_bf16 v[224:227], v[172:175], v[20:23], v[224:227]
    v_rcp_f32 v198, v198
    v_mfma_f32_16x16x32_bf16 v[232:235], v[172:175], v[28:31], v[232:235]
    v_rcp_f32 v199, v199
    v_rcp_f32 v200, v200
    v_rcp_f32 v201, v201
    v_rcp_f32 v202, v202
    v_rcp_f32 v203, v203
    v_pk_mul_f32 v[204:205], v[188:189], v[204:205]
    v_pk_mul_f32 v[206:207], v[190:191], v[206:207]
    v_pk_mul_f32 v[208:209], v[192:193], v[208:209]
    v_pk_mul_f32 v[210:211], v[194:195], v[210:211]
    v_pk_mul_f32 v[212:213], v[196:197], v[212:213]
    v_pk_mul_f32 v[214:215], v[198:199], v[214:215]
    v_pk_mul_f32 v[216:217], v[200:201], v[216:217]
    v_pk_mul_f32 v[218:219], v[202:203], v[218:219]
    s_cmp_ge_i32 s96, 1
    s_cbranch_scc1 L_PB01
L_PB00:
    s_setprio 0
    v_smfmac_f32_16x16x64_bf16 v[112:115], v[184:187], v[204:211], v255
    v_exp_f32 v220, v220
    v_smfmac_f32_16x16x64_bf16 v[116:119], v[184:187], v[212:219], v255
    v_exp_f32 v221, v221
    s_waitcnt vmcnt(0)
    ds_read_b128 v[176:179], v252
    ds_read_b128 v[180:183], v253
    v_mfma_f32_16x16x32_bf16 v[204:207], v[160:163], v[48:51], 0
    v_exp_f32 v222, v222
    v_mfma_f32_16x16x32_bf16 v[212:215], v[160:163], v[56:59], 0
    ds_read_b128 v[160:163], v244 offset:0
    v_exp_f32 v223, v223
    v_mfma_f32_16x16x32_bf16 v[208:211], v[168:171], v[48:51], 0
    v_exp_f32 v224, v224
    v_mfma_f32_16x16x32_bf16 v[216:219], v[168:171], v[56:59], 0
    ds_read_b128 v[168:171], v244 offset:512
    v_exp_f32 v225, v225
    v_mfma_f32_16x16x32_bf16 v[204:207], v[164:167], v[52:55], v[204:207]
    v_exp_f32 v226, v226
    v_mfma_f32_16x16x32_bf16 v[212:215], v[164:167], v[60:63], v[212:215]
    ds_read_b128 v[164:167], v244 offset:64
    v_exp_f32 v227, v227
    v_mfma_f32_16x16x32_bf16 v[208:211], v[172:175], v[52:55], v[208:211]
    v_exp_f32 v228, v228
    v_mfma_f32_16x16x32_bf16 v[216:219], v[172:175], v[60:63], v[216:219]
    ds_read_b128 v[172:175], v244 offset:576
    v_exp_f32 v229, v229
    v_smfmac_f32_16x16x64_bf16 v[96:99], v[184:187], v[188:195], v255
    v_exp_f32 v230, v230
    v_smfmac_f32_16x16x64_bf16 v[100:103], v[184:187], v[196:203], v255
    v_exp_f32 v231, v231
    v_mfma_f32_4x4x4_16b_bf16 v[220:223], v[242:243], v[242:243], v[220:223]
    v_exp_f32 v232, v232
    v_mfma_f32_4x4x4_16b_bf16 v[224:227], v[242:243], v[242:243], v[224:227]
    v_exp_f32 v233, v233
    v_mfma_f32_4x4x4_16b_bf16 v[228:231], v[242:243], v[242:243], v[228:231]
    v_exp_f32 v234, v234
    s_waitcnt lgkmcnt(4)
    v_mfma_f32_16x16x32_bf16 v[188:191], v[176:179], v[80:83], 0
    v_exp_f32 v235, v235
    v_mfma_f32_16x16x32_bf16 v[196:199], v[176:179], v[84:87], 0
    v_rcp_f32 v220, v220
    v_mfma_f32_16x16x32_bf16 v[192:195], v[180:183], v[80:83], 0
    v_rcp_f32 v221, v221
    v_mfma_f32_4x4x4_16b_bf16 v[232:235], v[242:243], v[242:243], v[232:235]
    v_rcp_f32 v222, v222
    v_mfma_f32_16x16x32_bf16 v[200:203], v[180:183], v[84:87], 0
    v_rcp_f32 v223, v223
    s_waitcnt lgkmcnt(3)
    v_mfma_f32_16x16x32_bf16 v[188:191], v[160:163], v[0:3], v[188:191]
    v_rcp_f32 v224, v224
    v_mfma_f32_16x16x32_bf16 v[196:199], v[160:163], v[8:11], v[196:199]
    v_rcp_f32 v225, v225
    s_waitcnt lgkmcnt(2)
    v_mfma_f32_16x16x32_bf16 v[192:195], v[168:171], v[0:3], v[192:195]
    v_rcp_f32 v226, v226
    v_mfma_f32_16x16x32_bf16 v[200:203], v[168:171], v[8:11], v[200:203]
    v_rcp_f32 v227, v227
    s_waitcnt lgkmcnt(1)
    v_mfma_f32_16x16x32_bf16 v[188:191], v[164:167], v[4:7], v[188:191]
    v_rcp_f32 v228, v228
    v_mfma_f32_16x16x32_bf16 v[196:199], v[164:167], v[12:15], v[196:199]
    v_rcp_f32 v229, v229
    s_setprio 3
    s_waitcnt lgkmcnt(0)
    v_mfma_f32_16x16x32_bf16 v[192:195], v[172:175], v[4:7], v[192:195]
    s_cmp_lt_u32 s16, s17
    s_cbranch_scc0 L_ND00
    s_add_u32 m0, s13, 0
    v_mad_u32_u16 v236, v236, s15, v243
    buffer_load_dwordx4 v236, s[40:43], 0 offen lds
    s_add_u32 m0, s13, 1056
    v_mad_u32_u16 v237, v237, s15, v243
    buffer_load_dwordx4 v237, s[40:43], 0 offen lds
    s_add_u32 m0, s13, 2112
    v_mad_u32_u16 v238, v238, s15, v243
    buffer_load_dwordx4 v238, s[40:43], 0 offen lds
    s_add_u32 m0, s13, 3168
    v_mad_u32_u16 v239, v239, s15, v243
    buffer_load_dwordx4 v239, s[40:43], 0 offen lds
    s_mov_b32 m0, s14
    s_nop 0
    buffer_load_dwordx4 v[240:241], s[44:47], 0 idxen offen lds
L_ND00:
    v_rcp_f32 v230, v230
    v_mfma_f32_16x16x32_bf16 v[200:203], v[172:175], v[12:15], v[200:203]
    v_rcp_f32 v231, v231
    v_rcp_f32 v232, v232
    v_rcp_f32 v233, v233
    v_rcp_f32 v234, v234
    v_rcp_f32 v235, v235
    v_pk_mul_f32 v[204:205], v[220:221], v[204:205]
    v_pk_mul_f32 v[206:207], v[222:223], v[206:207]
    v_pk_mul_f32 v[208:209], v[224:225], v[208:209]
    v_pk_mul_f32 v[210:211], v[226:227], v[210:211]
    v_pk_mul_f32 v[212:213], v[228:229], v[212:213]
    v_pk_mul_f32 v[214:215], v[230:231], v[214:215]
    v_pk_mul_f32 v[216:217], v[232:233], v[216:217]
    v_pk_mul_f32 v[218:219], v[234:235], v[218:219]
    s_cmp_ge_u32 s16, s17
    s_cbranch_scc1 L_LT1
    s_setprio 0
    v_smfmac_f32_16x16x64_bf16 v[120:123], v[184:187], v[204:211], v255
    ds_read_u16 v236, v251 offset:1152
    ds_read_u16 v237, v251 offset:1168
    ds_add_rtn_u32 v238, v246, v255
    v_exp_f32 v188, v188
    v_smfmac_f32_16x16x64_bf16 v[124:127], v[184:187], v[212:219], v255
    v_exp_f32 v189, v189
    v_mfma_f32_16x16x32_bf16 v[204:207], v[160:163], v[32:35], 0
    v_exp_f32 v190, v190
    v_mfma_f32_16x16x32_bf16 v[212:215], v[160:163], v[40:43], 0
    v_exp_f32 v191, v191
    v_mfma_f32_16x16x32_bf16 v[208:211], v[168:171], v[32:35], 0
    v_exp_f32 v192, v192
    v_mfma_f32_16x16x32_bf16 v[216:219], v[168:171], v[40:43], 0
    v_exp_f32 v193, v193
    v_mfma_f32_16x16x32_bf16 v[204:207], v[164:167], v[36:39], v[204:207]
    v_exp_f32 v194, v194
    v_mfma_f32_16x16x32_bf16 v[212:215], v[164:167], v[44:47], v[212:215]
    v_exp_f32 v195, v195
    v_mfma_f32_16x16x32_bf16 v[208:211], v[172:175], v[36:39], v[208:211]
    s_waitcnt lgkmcnt(0)
    v_bfi_b32 v236, 31, v246, v236
    v_bfi_b32 v237, 31, v246, v237
    v_readfirstlane_b32 s96, v238
    v_exp_f32 v196, v196
    v_mfma_f32_16x16x32_bf16 v[216:219], v[172:175], v[44:47], v[216:219]
    v_exp_f32 v197, v197
    v_smfmac_f32_16x16x64_bf16 v[104:107], v[184:187], v[220:227], v255
    v_exp_f32 v198, v198
    v_smfmac_f32_16x16x64_bf16 v[108:111], v[184:187], v[228:235], v255
    v_exp_f32 v199, v199
    v_mfma_f32_4x4x4_16b_bf16 v[188:191], v[242:243], v[242:243], v[188:191]
    v_exp_f32 v200, v200
    v_mfma_f32_4x4x4_16b_bf16 v[192:195], v[242:243], v[242:243], v[192:195]
    v_exp_f32 v201, v201
    v_mfma_f32_4x4x4_16b_bf16 v[196:199], v[242:243], v[242:243], v[196:199]
    v_exp_f32 v202, v202
    v_mfma_f32_16x16x32_bf16 v[220:223], v[176:179], v[88:91], 0
    ds_read_b64_tr_b16 v[184:185], v236
    ds_read_b64_tr_b16 v[186:187], v237
    ds_read_u16 v252, v250 offset:128
    ds_read_u16 v253, v250 offset:192
    v_exp_f32 v203, v203
    v_mfma_f32_16x16x32_bf16 v[228:231], v[176:179], v[92:95], 0
    s_ashr_i32 s96, s96, 24
    s_mul_i32 s96, s96, s101
    v_rcp_f32 v188, v188
    v_mfma_f32_16x16x32_bf16 v[224:227], v[180:183], v[88:91], 0
    v_rcp_f32 v189, v189
    v_mfma_f32_4x4x4_16b_bf16 v[200:203], v[242:243], v[242:243], v[200:203]
    v_rcp_f32 v190, v190
    v_mfma_f32_16x16x32_bf16 v[232:235], v[180:183], v[92:95], 0
    v_rcp_f32 v191, v191
    v_mfma_f32_16x16x32_bf16 v[220:223], v[160:163], v[16:19], v[220:223]
    v_rcp_f32 v192, v192
    v_mfma_f32_16x16x32_bf16 v[228:231], v[160:163], v[24:27], v[228:231]
    v_rcp_f32 v193, v193
    v_mfma_f32_16x16x32_bf16 v[224:227], v[168:171], v[16:19], v[224:227]
    s_waitcnt lgkmcnt(0)
    v_bfi_b32 v252, 31, v245, v252
    v_bfi_b32 v253, 31, v245, v253
    v_max_u32 v252, v252, v245
    v_max_u32 v253, v253, v247
    ds_read_b128 v[236:239], v248 offset:1280
    ds_read_b32 v240, v249 offset:1280
    s_add_u32 s16, s16, 1
    v_rcp_f32 v194, v194
    v_mfma_f32_16x16x32_bf16 v[232:235], v[168:171], v[24:27], v[232:235]
    v_lshl_add_u64 v[248:249], v[248:249], 0, s[94:95]
    v_lshl_add_u64 v[250:251], v[250:251], 0, s[94:95]
    v_rcp_f32 v195, v195
    v_mfma_f32_16x16x32_bf16 v[220:223], v[164:167], v[20:23], v[220:223]
    v_rcp_f32 v196, v196
    v_mfma_f32_16x16x32_bf16 v[228:231], v[164:167], v[28:31], v[228:231]
    v_rcp_f32 v197, v197
    s_setprio 3
    v_mfma_f32_16x16x32_bf16 v[224:227], v[172:175], v[20:23], v[224:227]
    v_rcp_f32 v198, v198
    v_mfma_f32_16x16x32_bf16 v[232:235], v[172:175], v[28:31], v[232:235]
    v_rcp_f32 v199, v199
    v_rcp_f32 v200, v200
    v_rcp_f32 v201, v201
    v_rcp_f32 v202, v202
    v_rcp_f32 v203, v203
    v_pk_mul_f32 v[204:205], v[188:189], v[204:205]
    v_pk_mul_f32 v[206:207], v[190:191], v[206:207]
    v_pk_mul_f32 v[208:209], v[192:193], v[208:209]
    v_pk_mul_f32 v[210:211], v[194:195], v[210:211]
    v_pk_mul_f32 v[212:213], v[196:197], v[212:213]
    v_pk_mul_f32 v[214:215], v[198:199], v[214:215]
    v_pk_mul_f32 v[216:217], v[200:201], v[216:217]
    v_pk_mul_f32 v[218:219], v[202:203], v[218:219]
    s_cmp_ge_i32 s96, 1
    s_cbranch_scc1 L_PB11
L_PB10:
    s_setprio 0
    v_smfmac_f32_16x16x64_bf16 v[144:147], v[184:187], v[204:211], v255
    v_exp_f32 v220, v220
    v_smfmac_f32_16x16x64_bf16 v[148:151], v[184:187], v[212:219], v255
    v_exp_f32 v221, v221
    s_waitcnt vmcnt(0)
    ds_read_b128 v[176:179], v252
    ds_read_b128 v[180:183], v253
    v_mfma_f32_16x16x32_bf16 v[204:207], v[160:163], v[48:51], 0
    v_exp_f32 v222, v222
    v_mfma_f32_16x16x32_bf16 v[212:215], v[160:163], v[56:59], 0
    ds_read_b128 v[160:163], v244 offset:0
    v_exp_f32 v223, v223
    v_mfma_f32_16x16x32_bf16 v[208:211], v[168:171], v[48:51], 0
    v_exp_f32 v224, v224
    v_mfma_f32_16x16x32_bf16 v[216:219], v[168:171], v[56:59], 0
    ds_read_b128 v[168:171], v244 offset:512
    v_exp_f32 v225, v225
    v_mfma_f32_16x16x32_bf16 v[204:207], v[164:167], v[52:55], v[204:207]
    v_exp_f32 v226, v226
    v_mfma_f32_16x16x32_bf16 v[212:215], v[164:167], v[60:63], v[212:215]
    ds_read_b128 v[164:167], v244 offset:64
    v_exp_f32 v227, v227
    v_mfma_f32_16x16x32_bf16 v[208:211], v[172:175], v[52:55], v[208:211]
    v_exp_f32 v228, v228
    v_mfma_f32_16x16x32_bf16 v[216:219], v[172:175], v[60:63], v[216:219]
    ds_read_b128 v[172:175], v244 offset:576
    v_exp_f32 v229, v229
    v_smfmac_f32_16x16x64_bf16 v[128:131], v[184:187], v[188:195], v255
    v_exp_f32 v230, v230
    v_smfmac_f32_16x16x64_bf16 v[132:135], v[184:187], v[196:203], v255
    v_exp_f32 v231, v231
    v_mfma_f32_4x4x4_16b_bf16 v[220:223], v[242:243], v[242:243], v[220:223]
    v_exp_f32 v232, v232
    v_mfma_f32_4x4x4_16b_bf16 v[224:227], v[242:243], v[242:243], v[224:227]
    v_exp_f32 v233, v233
    v_mfma_f32_4x4x4_16b_bf16 v[228:231], v[242:243], v[242:243], v[228:231]
    v_exp_f32 v234, v234
    s_waitcnt lgkmcnt(4)
    v_mfma_f32_16x16x32_bf16 v[188:191], v[176:179], v[64:67], 0
    v_exp_f32 v235, v235
    v_mfma_f32_16x16x32_bf16 v[196:199], v[176:179], v[68:71], 0
    v_rcp_f32 v220, v220
    v_mfma_f32_16x16x32_bf16 v[192:195], v[180:183], v[64:67], 0
    v_rcp_f32 v221, v221
    v_mfma_f32_4x4x4_16b_bf16 v[232:235], v[242:243], v[242:243], v[232:235]
    v_rcp_f32 v222, v222
    v_mfma_f32_16x16x32_bf16 v[200:203], v[180:183], v[68:71], 0
    v_rcp_f32 v223, v223
    s_waitcnt lgkmcnt(3)
    v_mfma_f32_16x16x32_bf16 v[188:191], v[160:163], v[0:3], v[188:191]
    v_rcp_f32 v224, v224
    v_mfma_f32_16x16x32_bf16 v[196:199], v[160:163], v[8:11], v[196:199]
    v_rcp_f32 v225, v225
    s_waitcnt lgkmcnt(2)
    v_mfma_f32_16x16x32_bf16 v[192:195], v[168:171], v[0:3], v[192:195]
    v_rcp_f32 v226, v226
    v_mfma_f32_16x16x32_bf16 v[200:203], v[168:171], v[8:11], v[200:203]
    v_rcp_f32 v227, v227
    s_waitcnt lgkmcnt(1)
    v_mfma_f32_16x16x32_bf16 v[188:191], v[164:167], v[4:7], v[188:191]
    v_rcp_f32 v228, v228
    v_mfma_f32_16x16x32_bf16 v[196:199], v[164:167], v[12:15], v[196:199]
    v_rcp_f32 v229, v229
    s_setprio 3
    s_waitcnt lgkmcnt(0)
    v_mfma_f32_16x16x32_bf16 v[192:195], v[172:175], v[4:7], v[192:195]
    s_cmp_lt_u32 s16, s17
    s_cbranch_scc0 L_ND10
    s_add_u32 m0, s13, 0
    v_mad_u32_u16 v236, v236, s15, v243
    buffer_load_dwordx4 v236, s[40:43], 0 offen lds
    s_add_u32 m0, s13, 1056
    v_mad_u32_u16 v237, v237, s15, v243
    buffer_load_dwordx4 v237, s[40:43], 0 offen lds
    s_add_u32 m0, s13, 2112
    v_mad_u32_u16 v238, v238, s15, v243
    buffer_load_dwordx4 v238, s[40:43], 0 offen lds
    s_add_u32 m0, s13, 3168
    v_mad_u32_u16 v239, v239, s15, v243
    buffer_load_dwordx4 v239, s[40:43], 0 offen lds
    s_mov_b32 m0, s14
    s_nop 0
    buffer_load_dwordx4 v[240:241], s[44:47], 0 idxen offen lds
L_ND10:
    v_rcp_f32 v230, v230
    v_mfma_f32_16x16x32_bf16 v[200:203], v[172:175], v[12:15], v[200:203]
    v_rcp_f32 v231, v231
    v_rcp_f32 v232, v232
    v_rcp_f32 v233, v233
    v_rcp_f32 v234, v234
    v_rcp_f32 v235, v235
    v_pk_mul_f32 v[204:205], v[220:221], v[204:205]
    v_pk_mul_f32 v[206:207], v[222:223], v[206:207]
    v_pk_mul_f32 v[208:209], v[224:225], v[208:209]
    v_pk_mul_f32 v[210:211], v[226:227], v[210:211]
    v_pk_mul_f32 v[212:213], v[228:229], v[212:213]
    v_pk_mul_f32 v[214:215], v[230:231], v[214:215]
    v_pk_mul_f32 v[216:217], v[232:233], v[216:217]
    v_pk_mul_f32 v[218:219], v[234:235], v[218:219]
    s_cmp_lt_u32 s16, s17
    s_cbranch_scc1 L_LOOP0
    s_branch L_LT0
L_LT0:
    s_cmp_lg_u32 s99, 0
    s_cbranch_scc1 L_LH0
    s_setprio 0
    v_smfmac_f32_16x16x64_bf16 v[152:155], v[184:187], v[204:211], v255
    ds_read_u16 v236, v251 offset:0
    ds_read_u16 v237, v251 offset:16
    v_exp_f32 v188, v188
    v_smfmac_f32_16x16x64_bf16 v[156:159], v[184:187], v[212:219], v255
    v_exp_f32 v189, v189
    v_mfma_f32_16x16x32_bf16 v[204:207], v[160:163], v[32:35], 0
    v_exp_f32 v190, v190
    v_mfma_f32_16x16x32_bf16 v[212:215], v[160:163], v[40:43], 0
    v_exp_f32 v191, v191
    v_mfma_f32_16x16x32_bf16 v[208:211], v[168:171], v[32:35], 0
    v_exp_f32 v192, v192
    v_mfma_f32_16x16x32_bf16 v[216:219], v[168:171], v[40:43], 0
    v_exp_f32 v193, v193
    v_mfma_f32_16x16x32_bf16 v[204:207], v[164:167], v[36:39], v[204:207]
    v_exp_f32 v194, v194
    v_mfma_f32_16x16x32_bf16 v[212:215], v[164:167], v[44:47], v[212:215]
    v_exp_f32 v195, v195
    v_mfma_f32_16x16x32_bf16 v[208:211], v[172:175], v[36:39], v[208:211]
    v_exp_f32 v196, v196
    v_mfma_f32_16x16x32_bf16 v[216:219], v[172:175], v[44:47], v[216:219]
    v_exp_f32 v197, v197
    v_smfmac_f32_16x16x64_bf16 v[136:139], v[184:187], v[220:227], v255
    s_waitcnt lgkmcnt(0)
    v_bfi_b32 v236, 31, v246, v236
    v_bfi_b32 v237, 31, v246, v237
    v_exp_f32 v198, v198
    s_setprio 3
    v_smfmac_f32_16x16x64_bf16 v[140:143], v[184:187], v[228:235], v255
    v_exp_f32 v199, v199
    v_exp_f32 v200, v200
    v_exp_f32 v201, v201
    v_exp_f32 v202, v202
    v_exp_f32 v203, v203
    v_pk_add_f32 v[188:189], v[188:189], 1.0 op_sel_hi:[1,0]
    v_pk_add_f32 v[190:191], v[190:191], 1.0 op_sel_hi:[1,0]
    v_pk_add_f32 v[192:193], v[192:193], 1.0 op_sel_hi:[1,0]
    v_pk_add_f32 v[194:195], v[194:195], 1.0 op_sel_hi:[1,0]
    v_pk_add_f32 v[196:197], v[196:197], 1.0 op_sel_hi:[1,0]
    v_pk_add_f32 v[198:199], v[198:199], 1.0 op_sel_hi:[1,0]
    v_pk_add_f32 v[200:201], v[200:201], 1.0 op_sel_hi:[1,0]
    v_pk_add_f32 v[202:203], v[202:203], 1.0 op_sel_hi:[1,0]
    s_setprio 0
    v_mfma_f32_16x16x32_bf16 v[220:223], v[176:179], v[72:75], 0
    ds_read_b64_tr_b16 v[184:185], v236
    ds_read_b64_tr_b16 v[186:187], v237
    v_rcp_f32 v188, v188
    v_mfma_f32_16x16x32_bf16 v[228:231], v[176:179], v[76:79], 0
    v_rcp_f32 v189, v189
    v_mfma_f32_16x16x32_bf16 v[224:227], v[180:183], v[72:75], 0
    v_rcp_f32 v190, v190
    v_mfma_f32_16x16x32_bf16 v[232:235], v[180:183], v[76:79], 0
    v_rcp_f32 v191, v191
    v_mfma_f32_16x16x32_bf16 v[220:223], v[160:163], v[16:19], v[220:223]
    v_rcp_f32 v192, v192
    v_mfma_f32_16x16x32_bf16 v[228:231], v[160:163], v[24:27], v[228:231]
    v_rcp_f32 v193, v193
    v_mfma_f32_16x16x32_bf16 v[224:227], v[168:171], v[16:19], v[224:227]
    v_rcp_f32 v194, v194
    v_mfma_f32_16x16x32_bf16 v[232:235], v[168:171], v[24:27], v[232:235]
    v_rcp_f32 v195, v195
    v_mfma_f32_16x16x32_bf16 v[220:223], v[164:167], v[20:23], v[220:223]
    v_rcp_f32 v196, v196
    v_mfma_f32_16x16x32_bf16 v[228:231], v[164:167], v[28:31], v[228:231]
    v_rcp_f32 v197, v197
    v_mfma_f32_16x16x32_bf16 v[224:227], v[172:175], v[20:23], v[224:227]
    v_rcp_f32 v198, v198
    s_setprio 3
    v_mfma_f32_16x16x32_bf16 v[232:235], v[172:175], v[28:31], v[232:235]
    v_rcp_f32 v199, v199
    v_rcp_f32 v200, v200
    v_rcp_f32 v201, v201
    v_rcp_f32 v202, v202
    v_rcp_f32 v203, v203
    v_pk_mul_f32 v[204:205], v[188:189], v[204:205]
    v_pk_mul_f32 v[206:207], v[190:191], v[206:207]
    v_pk_mul_f32 v[208:209], v[192:193], v[208:209]
    v_pk_mul_f32 v[210:211], v[194:195], v[210:211]
    v_pk_mul_f32 v[212:213], v[196:197], v[212:213]
    v_pk_mul_f32 v[214:215], v[198:199], v[214:215]
    v_pk_mul_f32 v[216:217], v[200:201], v[216:217]
    v_pk_mul_f32 v[218:219], v[202:203], v[218:219]
    s_setprio 0
    s_waitcnt lgkmcnt(0)
    v_smfmac_f32_16x16x64_bf16 v[112:115], v[184:187], v[204:211], v255
    v_exp_f32 v220, v220
    v_smfmac_f32_16x16x64_bf16 v[116:119], v[184:187], v[212:219], v255
    v_exp_f32 v221, v221
    v_mfma_f32_16x16x32_bf16 v[204:207], v[160:163], v[48:51], 0
    v_exp_f32 v222, v222
    v_mfma_f32_16x16x32_bf16 v[212:215], v[160:163], v[56:59], 0
    v_exp_f32 v223, v223
    v_mfma_f32_16x16x32_bf16 v[208:211], v[168:171], v[48:51], 0
    v_exp_f32 v224, v224
    v_mfma_f32_16x16x32_bf16 v[216:219], v[168:171], v[56:59], 0
    v_exp_f32 v225, v225
    v_mfma_f32_16x16x32_bf16 v[204:207], v[164:167], v[52:55], v[204:207]
    v_exp_f32 v226, v226
    v_mfma_f32_16x16x32_bf16 v[212:215], v[164:167], v[60:63], v[212:215]
    v_exp_f32 v227, v227
    v_mfma_f32_16x16x32_bf16 v[208:211], v[172:175], v[52:55], v[208:211]
    v_exp_f32 v228, v228
    v_mfma_f32_16x16x32_bf16 v[216:219], v[172:175], v[60:63], v[216:219]
    v_exp_f32 v229, v229
    v_smfmac_f32_16x16x64_bf16 v[96:99], v[184:187], v[188:195], v255
    v_exp_f32 v230, v230
    s_setprio 3
    v_smfmac_f32_16x16x64_bf16 v[100:103], v[184:187], v[196:203], v255
    v_exp_f32 v231, v231
    v_exp_f32 v232, v232
    v_exp_f32 v233, v233
    v_exp_f32 v234, v234
    v_exp_f32 v235, v235
    v_pk_add_f32 v[220:221], v[220:221], 1.0 op_sel_hi:[1,0]
    v_pk_add_f32 v[222:223], v[222:223], 1.0 op_sel_hi:[1,0]
    v_pk_add_f32 v[224:225], v[224:225], 1.0 op_sel_hi:[1,0]
    v_pk_add_f32 v[226:227], v[226:227], 1.0 op_sel_hi:[1,0]
    v_pk_add_f32 v[228:229], v[228:229], 1.0 op_sel_hi:[1,0]
    v_pk_add_f32 v[230:231], v[230:231], 1.0 op_sel_hi:[1,0]
    v_pk_add_f32 v[232:233], v[232:233], 1.0 op_sel_hi:[1,0]
    v_pk_add_f32 v[234:235], v[234:235], 1.0 op_sel_hi:[1,0]
    s_setprio 0
    v_rcp_f32 v220, v220
    v_rcp_f32 v221, v221
    v_rcp_f32 v222, v222
    v_rcp_f32 v223, v223
    v_rcp_f32 v224, v224
    v_rcp_f32 v225, v225
    v_rcp_f32 v226, v226
    v_rcp_f32 v227, v227
    v_rcp_f32 v228, v228
    v_rcp_f32 v229, v229
    v_rcp_f32 v230, v230
    v_rcp_f32 v231, v231
    v_rcp_f32 v232, v232
    v_rcp_f32 v233, v233
    v_rcp_f32 v234, v234
    v_rcp_f32 v235, v235
    v_pk_mul_f32 v[204:205], v[220:221], v[204:205]
    v_pk_mul_f32 v[206:207], v[222:223], v[206:207]
    v_pk_mul_f32 v[208:209], v[224:225], v[208:209]
    v_pk_mul_f32 v[210:211], v[226:227], v[210:211]
    v_pk_mul_f32 v[212:213], v[228:229], v[212:213]
    v_pk_mul_f32 v[214:215], v[230:231], v[214:215]
    v_pk_mul_f32 v[216:217], v[232:233], v[216:217]
    v_pk_mul_f32 v[218:219], v[234:235], v[218:219]
    v_smfmac_f32_16x16x64_bf16 v[104:107], v[184:187], v[220:227], v255
    v_smfmac_f32_16x16x64_bf16 v[108:111], v[184:187], v[228:235], v255
    v_smfmac_f32_16x16x64_bf16 v[120:123], v[184:187], v[204:211], v255
    v_smfmac_f32_16x16x64_bf16 v[124:127], v[184:187], v[212:219], v255
    s_branch L_DONE
L_LH0:
    s_setprio 0
    v_smfmac_f32_16x16x64_bf16 v[152:155], v[184:187], v[204:211], v255
    ds_read_u16 v236, v251 offset:0
    ds_read_u16 v237, v251 offset:16
    v_smfmac_f32_16x16x64_bf16 v[156:159], v[184:187], v[212:219], v255
    v_exp_f32 v188, v188
    v_mfma_f32_16x16x32_bf16 v[204:207], v[160:163], v[32:35], 0
    v_mfma_f32_16x16x32_bf16 v[212:215], v[160:163], v[40:43], 0
    v_exp_f32 v189, v189
    v_mfma_f32_16x16x32_bf16 v[204:207], v[164:167], v[36:39], v[204:207]
    v_mfma_f32_16x16x32_bf16 v[212:215], v[164:167], v[44:47], v[212:215]
    v_exp_f32 v190, v190
    v_smfmac_f32_16x16x64_bf16 v[136:139], v[184:187], v[220:227], v255
    s_waitcnt lgkmcnt(0)
    v_bfi_b32 v236, 31, v246, v236
    v_bfi_b32 v237, 31, v246, v237
    v_exp_f32 v191, v191
    s_setprio 3
    v_smfmac_f32_16x16x64_bf16 v[140:143], v[184:187], v[228:235], v255
    v_exp_f32 v196, v196
    v_exp_f32 v197, v197
    v_exp_f32 v198, v198
    v_exp_f32 v199, v199
    v_pk_add_f32 v[188:189], v[188:189], 1.0 op_sel_hi:[1,0]
    v_pk_add_f32 v[190:191], v[190:191], 1.0 op_sel_hi:[1,0]
    v_pk_add_f32 v[196:197], v[196:197], 1.0 op_sel_hi:[1,0]
    v_pk_add_f32 v[198:199], v[198:199], 1.0 op_sel_hi:[1,0]
    s_setprio 0
    v_mfma_f32_16x16x32_bf16 v[220:223], v[176:179], v[72:75], 0
    ds_read_b64_tr_b16 v[184:185], v236
    ds_read_b64_tr_b16 v[186:187], v237
    v_mfma_f32_16x16x32_bf16 v[228:231], v[176:179], v[76:79], 0
    v_rcp_f32 v188, v188
    v_mfma_f32_16x16x32_bf16 v[220:223], v[160:163], v[16:19], v[220:223]
    v_rcp_f32 v189, v189
    v_mfma_f32_16x16x32_bf16 v[228:231], v[160:163], v[24:27], v[228:231]
    v_rcp_f32 v190, v190
    v_mfma_f32_16x16x32_bf16 v[220:223], v[164:167], v[20:23], v[220:223]
    v_rcp_f32 v191, v191
    s_setprio 3
    v_mfma_f32_16x16x32_bf16 v[228:231], v[164:167], v[28:31], v[228:231]
    v_rcp_f32 v196, v196
    v_rcp_f32 v197, v197
    v_rcp_f32 v198, v198
    v_rcp_f32 v199, v199
    v_pk_mul_f32 v[204:205], v[188:189], v[204:205]
    v_pk_mul_f32 v[206:207], v[190:191], v[206:207]
    v_pk_mul_f32 v[212:213], v[196:197], v[212:213]
    v_pk_mul_f32 v[214:215], v[198:199], v[214:215]
    s_setprio 0
    s_waitcnt lgkmcnt(0)
    v_smfmac_f32_16x16x64_bf16 v[112:115], v[184:187], v[204:211], v255
    v_smfmac_f32_16x16x64_bf16 v[116:119], v[184:187], v[212:219], v255
    v_exp_f32 v220, v220
    v_mfma_f32_16x16x32_bf16 v[204:207], v[160:163], v[48:51], 0
    v_mfma_f32_16x16x32_bf16 v[212:215], v[160:163], v[56:59], 0
    v_exp_f32 v221, v221
    v_mfma_f32_16x16x32_bf16 v[204:207], v[164:167], v[52:55], v[204:207]
    v_mfma_f32_16x16x32_bf16 v[212:215], v[164:167], v[60:63], v[212:215]
    v_exp_f32 v222, v222
    v_smfmac_f32_16x16x64_bf16 v[96:99], v[184:187], v[188:195], v255
    v_exp_f32 v223, v223
    s_setprio 3
    v_smfmac_f32_16x16x64_bf16 v[100:103], v[184:187], v[196:203], v255
    v_exp_f32 v228, v228
    v_exp_f32 v229, v229
    v_exp_f32 v230, v230
    v_exp_f32 v231, v231
    v_pk_add_f32 v[220:221], v[220:221], 1.0 op_sel_hi:[1,0]
    v_pk_add_f32 v[222:223], v[222:223], 1.0 op_sel_hi:[1,0]
    v_pk_add_f32 v[228:229], v[228:229], 1.0 op_sel_hi:[1,0]
    v_pk_add_f32 v[230:231], v[230:231], 1.0 op_sel_hi:[1,0]
    s_setprio 0
    v_rcp_f32 v220, v220
    v_rcp_f32 v221, v221
    v_rcp_f32 v222, v222
    v_rcp_f32 v223, v223
    v_rcp_f32 v228, v228
    v_rcp_f32 v229, v229
    v_rcp_f32 v230, v230
    v_rcp_f32 v231, v231
    v_pk_mul_f32 v[204:205], v[220:221], v[204:205]
    v_pk_mul_f32 v[206:207], v[222:223], v[206:207]
    v_pk_mul_f32 v[212:213], v[228:229], v[212:213]
    v_pk_mul_f32 v[214:215], v[230:231], v[214:215]
    v_smfmac_f32_16x16x64_bf16 v[104:107], v[184:187], v[220:227], v255
    v_smfmac_f32_16x16x64_bf16 v[108:111], v[184:187], v[228:235], v255
    v_smfmac_f32_16x16x64_bf16 v[120:123], v[184:187], v[204:211], v255
    v_smfmac_f32_16x16x64_bf16 v[124:127], v[184:187], v[212:219], v255
    s_branch L_DONE
L_LT1:
    s_cmp_lg_u32 s99, 0
    s_cbranch_scc1 L_LH1
    s_setprio 0
    v_smfmac_f32_16x16x64_bf16 v[120:123], v[184:187], v[204:211], v255
    ds_read_u16 v236, v251 offset:1152
    ds_read_u16 v237, v251 offset:1168
    v_exp_f32 v188, v188
    v_smfmac_f32_16x16x64_bf16 v[124:127], v[184:187], v[212:219], v255
    v_exp_f32 v189, v189
    v_mfma_f32_16x16x32_bf16 v[204:207], v[160:163], v[32:35], 0
    v_exp_f32 v190, v190
    v_mfma_f32_16x16x32_bf16 v[212:215], v[160:163], v[40:43], 0
    v_exp_f32 v191, v191
    v_mfma_f32_16x16x32_bf16 v[208:211], v[168:171], v[32:35], 0
    v_exp_f32 v192, v192
    v_mfma_f32_16x16x32_bf16 v[216:219], v[168:171], v[40:43], 0
    v_exp_f32 v193, v193
    v_mfma_f32_16x16x32_bf16 v[204:207], v[164:167], v[36:39], v[204:207]
    v_exp_f32 v194, v194
    v_mfma_f32_16x16x32_bf16 v[212:215], v[164:167], v[44:47], v[212:215]
    v_exp_f32 v195, v195
    v_mfma_f32_16x16x32_bf16 v[208:211], v[172:175], v[36:39], v[208:211]
    v_exp_f32 v196, v196
    v_mfma_f32_16x16x32_bf16 v[216:219], v[172:175], v[44:47], v[216:219]
    v_exp_f32 v197, v197
    v_smfmac_f32_16x16x64_bf16 v[104:107], v[184:187], v[220:227], v255
    s_waitcnt lgkmcnt(0)
    v_bfi_b32 v236, 31, v246, v236
    v_bfi_b32 v237, 31, v246, v237
    v_exp_f32 v198, v198
    s_setprio 3
    v_smfmac_f32_16x16x64_bf16 v[108:111], v[184:187], v[228:235], v255
    v_exp_f32 v199, v199
    v_exp_f32 v200, v200
    v_exp_f32 v201, v201
    v_exp_f32 v202, v202
    v_exp_f32 v203, v203
    v_pk_add_f32 v[188:189], v[188:189], 1.0 op_sel_hi:[1,0]
    v_pk_add_f32 v[190:191], v[190:191], 1.0 op_sel_hi:[1,0]
    v_pk_add_f32 v[192:193], v[192:193], 1.0 op_sel_hi:[1,0]
    v_pk_add_f32 v[194:195], v[194:195], 1.0 op_sel_hi:[1,0]
    v_pk_add_f32 v[196:197], v[196:197], 1.0 op_sel_hi:[1,0]
    v_pk_add_f32 v[198:199], v[198:199], 1.0 op_sel_hi:[1,0]
    v_pk_add_f32 v[200:201], v[200:201], 1.0 op_sel_hi:[1,0]
    v_pk_add_f32 v[202:203], v[202:203], 1.0 op_sel_hi:[1,0]
    s_setprio 0
    v_mfma_f32_16x16x32_bf16 v[220:223], v[176:179], v[88:91], 0
    ds_read_b64_tr_b16 v[184:185], v236
    ds_read_b64_tr_b16 v[186:187], v237
    v_rcp_f32 v188, v188
    v_mfma_f32_16x16x32_bf16 v[228:231], v[176:179], v[92:95], 0
    v_rcp_f32 v189, v189
    v_mfma_f32_16x16x32_bf16 v[224:227], v[180:183], v[88:91], 0
    v_rcp_f32 v190, v190
    v_mfma_f32_16x16x32_bf16 v[232:235], v[180:183], v[92:95], 0
    v_rcp_f32 v191, v191
    v_mfma_f32_16x16x32_bf16 v[220:223], v[160:163], v[16:19], v[220:223]
    v_rcp_f32 v192, v192
    v_mfma_f32_16x16x32_bf16 v[228:231], v[160:163], v[24:27], v[228:231]
    v_rcp_f32 v193, v193
    v_mfma_f32_16x16x32_bf16 v[224:227], v[168:171], v[16:19], v[224:227]
    v_rcp_f32 v194, v194
    v_mfma_f32_16x16x32_bf16 v[232:235], v[168:171], v[24:27], v[232:235]
    v_rcp_f32 v195, v195
    v_mfma_f32_16x16x32_bf16 v[220:223], v[164:167], v[20:23], v[220:223]
    v_rcp_f32 v196, v196
    v_mfma_f32_16x16x32_bf16 v[228:231], v[164:167], v[28:31], v[228:231]
    v_rcp_f32 v197, v197
    v_mfma_f32_16x16x32_bf16 v[224:227], v[172:175], v[20:23], v[224:227]
    v_rcp_f32 v198, v198
    s_setprio 3
    v_mfma_f32_16x16x32_bf16 v[232:235], v[172:175], v[28:31], v[232:235]
    v_rcp_f32 v199, v199
    v_rcp_f32 v200, v200
    v_rcp_f32 v201, v201
    v_rcp_f32 v202, v202
    v_rcp_f32 v203, v203
    v_pk_mul_f32 v[204:205], v[188:189], v[204:205]
    v_pk_mul_f32 v[206:207], v[190:191], v[206:207]
    v_pk_mul_f32 v[208:209], v[192:193], v[208:209]
    v_pk_mul_f32 v[210:211], v[194:195], v[210:211]
    v_pk_mul_f32 v[212:213], v[196:197], v[212:213]
    v_pk_mul_f32 v[214:215], v[198:199], v[214:215]
    v_pk_mul_f32 v[216:217], v[200:201], v[216:217]
    v_pk_mul_f32 v[218:219], v[202:203], v[218:219]
    s_setprio 0
    s_waitcnt lgkmcnt(0)
    v_smfmac_f32_16x16x64_bf16 v[144:147], v[184:187], v[204:211], v255
    v_exp_f32 v220, v220
    v_smfmac_f32_16x16x64_bf16 v[148:151], v[184:187], v[212:219], v255
    v_exp_f32 v221, v221
    v_mfma_f32_16x16x32_bf16 v[204:207], v[160:163], v[48:51], 0
    v_exp_f32 v222, v222
    v_mfma_f32_16x16x32_bf16 v[212:215], v[160:163], v[56:59], 0
    v_exp_f32 v223, v223
    v_mfma_f32_16x16x32_bf16 v[208:211], v[168:171], v[48:51], 0
    v_exp_f32 v224, v224
    v_mfma_f32_16x16x32_bf16 v[216:219], v[168:171], v[56:59], 0
    v_exp_f32 v225, v225
    v_mfma_f32_16x16x32_bf16 v[204:207], v[164:167], v[52:55], v[204:207]
    v_exp_f32 v226, v226
    v_mfma_f32_16x16x32_bf16 v[212:215], v[164:167], v[60:63], v[212:215]
    v_exp_f32 v227, v227
    v_mfma_f32_16x16x32_bf16 v[208:211], v[172:175], v[52:55], v[208:211]
    v_exp_f32 v228, v228
    v_mfma_f32_16x16x32_bf16 v[216:219], v[172:175], v[60:63], v[216:219]
    v_exp_f32 v229, v229
    v_smfmac_f32_16x16x64_bf16 v[128:131], v[184:187], v[188:195], v255
    v_exp_f32 v230, v230
    s_setprio 3
    v_smfmac_f32_16x16x64_bf16 v[132:135], v[184:187], v[196:203], v255
    v_exp_f32 v231, v231
    v_exp_f32 v232, v232
    v_exp_f32 v233, v233
    v_exp_f32 v234, v234
    v_exp_f32 v235, v235
    v_pk_add_f32 v[220:221], v[220:221], 1.0 op_sel_hi:[1,0]
    v_pk_add_f32 v[222:223], v[222:223], 1.0 op_sel_hi:[1,0]
    v_pk_add_f32 v[224:225], v[224:225], 1.0 op_sel_hi:[1,0]
    v_pk_add_f32 v[226:227], v[226:227], 1.0 op_sel_hi:[1,0]
    v_pk_add_f32 v[228:229], v[228:229], 1.0 op_sel_hi:[1,0]
    v_pk_add_f32 v[230:231], v[230:231], 1.0 op_sel_hi:[1,0]
    v_pk_add_f32 v[232:233], v[232:233], 1.0 op_sel_hi:[1,0]
    v_pk_add_f32 v[234:235], v[234:235], 1.0 op_sel_hi:[1,0]
    s_setprio 0
    v_rcp_f32 v220, v220
    v_rcp_f32 v221, v221
    v_rcp_f32 v222, v222
    v_rcp_f32 v223, v223
    v_rcp_f32 v224, v224
    v_rcp_f32 v225, v225
    v_rcp_f32 v226, v226
    v_rcp_f32 v227, v227
    v_rcp_f32 v228, v228
    v_rcp_f32 v229, v229
    v_rcp_f32 v230, v230
    v_rcp_f32 v231, v231
    v_rcp_f32 v232, v232
    v_rcp_f32 v233, v233
    v_rcp_f32 v234, v234
    v_rcp_f32 v235, v235
    v_pk_mul_f32 v[204:205], v[220:221], v[204:205]
    v_pk_mul_f32 v[206:207], v[222:223], v[206:207]
    v_pk_mul_f32 v[208:209], v[224:225], v[208:209]
    v_pk_mul_f32 v[210:211], v[226:227], v[210:211]
    v_pk_mul_f32 v[212:213], v[228:229], v[212:213]
    v_pk_mul_f32 v[214:215], v[230:231], v[214:215]
    v_pk_mul_f32 v[216:217], v[232:233], v[216:217]
    v_pk_mul_f32 v[218:219], v[234:235], v[218:219]
    v_smfmac_f32_16x16x64_bf16 v[136:139], v[184:187], v[220:227], v255
    v_smfmac_f32_16x16x64_bf16 v[140:143], v[184:187], v[228:235], v255
    v_smfmac_f32_16x16x64_bf16 v[152:155], v[184:187], v[204:211], v255
    v_smfmac_f32_16x16x64_bf16 v[156:159], v[184:187], v[212:219], v255
    s_branch L_DONE
L_LH1:
    s_setprio 0
    v_smfmac_f32_16x16x64_bf16 v[120:123], v[184:187], v[204:211], v255
    ds_read_u16 v236, v251 offset:1152
    ds_read_u16 v237, v251 offset:1168
    v_smfmac_f32_16x16x64_bf16 v[124:127], v[184:187], v[212:219], v255
    v_exp_f32 v188, v188
    v_mfma_f32_16x16x32_bf16 v[204:207], v[160:163], v[32:35], 0
    v_mfma_f32_16x16x32_bf16 v[212:215], v[160:163], v[40:43], 0
    v_exp_f32 v189, v189
    v_mfma_f32_16x16x32_bf16 v[204:207], v[164:167], v[36:39], v[204:207]
    v_mfma_f32_16x16x32_bf16 v[212:215], v[164:167], v[44:47], v[212:215]
    v_exp_f32 v190, v190
    v_smfmac_f32_16x16x64_bf16 v[104:107], v[184:187], v[220:227], v255
    s_waitcnt lgkmcnt(0)
    v_bfi_b32 v236, 31, v246, v236
    v_bfi_b32 v237, 31, v246, v237
    v_exp_f32 v191, v191
    s_setprio 3
    v_smfmac_f32_16x16x64_bf16 v[108:111], v[184:187], v[228:235], v255
    v_exp_f32 v196, v196
    v_exp_f32 v197, v197
    v_exp_f32 v198, v198
    v_exp_f32 v199, v199
    v_pk_add_f32 v[188:189], v[188:189], 1.0 op_sel_hi:[1,0]
    v_pk_add_f32 v[190:191], v[190:191], 1.0 op_sel_hi:[1,0]
    v_pk_add_f32 v[196:197], v[196:197], 1.0 op_sel_hi:[1,0]
    v_pk_add_f32 v[198:199], v[198:199], 1.0 op_sel_hi:[1,0]
    s_setprio 0
    v_mfma_f32_16x16x32_bf16 v[220:223], v[176:179], v[88:91], 0
    ds_read_b64_tr_b16 v[184:185], v236
    ds_read_b64_tr_b16 v[186:187], v237
    v_mfma_f32_16x16x32_bf16 v[228:231], v[176:179], v[92:95], 0
    v_rcp_f32 v188, v188
    v_mfma_f32_16x16x32_bf16 v[220:223], v[160:163], v[16:19], v[220:223]
    v_rcp_f32 v189, v189
    v_mfma_f32_16x16x32_bf16 v[228:231], v[160:163], v[24:27], v[228:231]
    v_rcp_f32 v190, v190
    v_mfma_f32_16x16x32_bf16 v[220:223], v[164:167], v[20:23], v[220:223]
    v_rcp_f32 v191, v191
    s_setprio 3
    v_mfma_f32_16x16x32_bf16 v[228:231], v[164:167], v[28:31], v[228:231]
    v_rcp_f32 v196, v196
    v_rcp_f32 v197, v197
    v_rcp_f32 v198, v198
    v_rcp_f32 v199, v199
    v_pk_mul_f32 v[204:205], v[188:189], v[204:205]
    v_pk_mul_f32 v[206:207], v[190:191], v[206:207]
    v_pk_mul_f32 v[212:213], v[196:197], v[212:213]
    v_pk_mul_f32 v[214:215], v[198:199], v[214:215]
    s_setprio 0
    s_waitcnt lgkmcnt(0)
    v_smfmac_f32_16x16x64_bf16 v[144:147], v[184:187], v[204:211], v255
    v_smfmac_f32_16x16x64_bf16 v[148:151], v[184:187], v[212:219], v255
    v_exp_f32 v220, v220
    v_mfma_f32_16x16x32_bf16 v[204:207], v[160:163], v[48:51], 0
    v_mfma_f32_16x16x32_bf16 v[212:215], v[160:163], v[56:59], 0
    v_exp_f32 v221, v221
    v_mfma_f32_16x16x32_bf16 v[204:207], v[164:167], v[52:55], v[204:207]
    v_mfma_f32_16x16x32_bf16 v[212:215], v[164:167], v[60:63], v[212:215]
    v_exp_f32 v222, v222
    v_smfmac_f32_16x16x64_bf16 v[128:131], v[184:187], v[188:195], v255
    v_exp_f32 v223, v223
    s_setprio 3
    v_smfmac_f32_16x16x64_bf16 v[132:135], v[184:187], v[196:203], v255
    v_exp_f32 v228, v228
    v_exp_f32 v229, v229
    v_exp_f32 v230, v230
    v_exp_f32 v231, v231
    v_pk_add_f32 v[220:221], v[220:221], 1.0 op_sel_hi:[1,0]
    v_pk_add_f32 v[222:223], v[222:223], 1.0 op_sel_hi:[1,0]
    v_pk_add_f32 v[228:229], v[228:229], 1.0 op_sel_hi:[1,0]
    v_pk_add_f32 v[230:231], v[230:231], 1.0 op_sel_hi:[1,0]
    s_setprio 0
    v_rcp_f32 v220, v220
    v_rcp_f32 v221, v221
    v_rcp_f32 v222, v222
    v_rcp_f32 v223, v223
    v_rcp_f32 v228, v228
    v_rcp_f32 v229, v229
    v_rcp_f32 v230, v230
    v_rcp_f32 v231, v231
    v_pk_mul_f32 v[204:205], v[220:221], v[204:205]
    v_pk_mul_f32 v[206:207], v[222:223], v[206:207]
    v_pk_mul_f32 v[212:213], v[228:229], v[212:213]
    v_pk_mul_f32 v[214:215], v[230:231], v[214:215]
    v_smfmac_f32_16x16x64_bf16 v[136:139], v[184:187], v[220:227], v255
    v_smfmac_f32_16x16x64_bf16 v[140:143], v[184:187], v[228:235], v255
    v_smfmac_f32_16x16x64_bf16 v[152:155], v[184:187], v[204:211], v255
    v_smfmac_f32_16x16x64_bf16 v[156:159], v[184:187], v[212:219], v255
    s_branch L_DONE
L_DONE:
    v_mbcnt_lo_u32_b32 v247, -1, 0
    v_mbcnt_hi_u32_b32 v247, -1, v247
    v_and_b32 v246, 24, v246
    s_cmp_lg_u32 s19, 0
    s_cbranch_scc1 L_SLOW
L_EPI:
    s_waitcnt lgkmcnt(0)
    v_and_b32 v64, 48, v247
    v_and_b32 v67, 15, v247
    v_add_u32 v69, s72, v64
    v_lshl_add_u32 v70, v67, 2, s72
    ds_read_b128 v[80:83], v69 offset:0
    ds_read_b128 v[84:87], v69 offset:64
    ds_read2_b32 v[72:73], v70 offset0:0 offset1:16
    v_bfe_u32 v65, v247, 2, 3
    v_lshrrev_b32 v66, 5, v247
    v_lshl_add_u32 v65, v66, 4, v65
    v_mul_u32_u24 v65, 160, v65
    s_mov_b32 s10, 143488
    v_add3_u32 v65, v65, v246, s10
    ds_read_b64_tr_b16 v[0:1], v65 offset:0
    ds_read_b64_tr_b16 v[2:3], v65 offset:1280
    ds_read_b64_tr_b16 v[8:9], v65 offset:32
    ds_read_b64_tr_b16 v[10:11], v65 offset:1312
    ds_read_b64_tr_b16 v[16:17], v65 offset:64
    ds_read_b64_tr_b16 v[18:19], v65 offset:1344
    ds_read_b64_tr_b16 v[24:25], v65 offset:96
    ds_read_b64_tr_b16 v[26:27], v65 offset:1376
    ds_read_b64_tr_b16 v[4:5], v65 offset:5120
    ds_read_b64_tr_b16 v[6:7], v65 offset:6400
    ds_read_b64_tr_b16 v[12:13], v65 offset:5152
    ds_read_b64_tr_b16 v[14:15], v65 offset:6432
    s_movk_i32 s10, 832
    v_mad_u32_u24 v64, v246, s10, v64
    s_mov_b32 s10, 116736
    v_lshl_add_u32 v69, v67, 3, s10
    v_lshl_add_u32 v74, v67, 3, s73
    v_lshl_add_u32 v75, v67, 3, s74
    s_waitcnt lgkmcnt(8)
    ds_read_b64_tr_b16 v[20:21], v65 offset:5184
    ds_read_b64_tr_b16 v[22:23], v65 offset:6464
    ds_read_b64_tr_b16 v[28:29], v65 offset:5216
    ds_read_b64_tr_b16 v[30:31], v65 offset:6496
    v_add_u32 v76, v80, v69
    ds_read_b64 v[32:33], v76 offset:0
    v_add_u32 v76, v81, v69
    ds_read_b64 v[34:35], v76 offset:6656
    v_add_u32 v76, v82, v69
    ds_read_b64 v[36:37], v76 offset:13312
    v_add_u32 v76, v83, v69
    ds_read_b64 v[38:39], v76 offset:19968
    v_add_u32 v76, v84, v69
    ds_read_b64 v[40:41], v76 offset:0
    v_add_u32 v76, v85, v69
    ds_read_b64 v[42:43], v76 offset:6656
    v_add_u32 v76, v86, v69
    ds_read_b64 v[44:45], v76 offset:13312
    v_add_u32 v76, v87, v69
    ds_read_b64 v[46:47], v76 offset:19968
    v_add3_u32 v72, v72, v64, s10
    ds_read_b128 v[160:163], v72 offset:0
    ds_read_b128 v[164:167], v72 offset:64
    v_add3_u32 v73, v73, v64, s10
    ds_read_b128 v[168:171], v73 offset:0
    ds_read_b128 v[172:175], v73 offset:64
    s_waitcnt lgkmcnt(0)
    v_lshlrev_b32 v188, 16, v32
    v_lshlrev_b32 v189, 16, v34
    v_lshlrev_b32 v190, 16, v36
    v_lshlrev_b32 v191, 16, v38
    v_and_b32 v192, 0xffff0000, v32
    v_and_b32 v193, 0xffff0000, v34
    v_and_b32 v194, 0xffff0000, v36
    v_and_b32 v195, 0xffff0000, v38
    v_mfma_f32_16x16x32_bf16 v[188:191], v[160:163], v[0:3], v[188:191]
    v_lshlrev_b32 v196, 16, v33
    v_lshlrev_b32 v197, 16, v35
    v_lshlrev_b32 v198, 16, v37
    v_lshlrev_b32 v199, 16, v39
    v_lshl_add_u32 v80, v80, 2, v74
    v_mfma_f32_16x16x32_bf16 v[188:191], v[164:167], v[4:7], v[188:191]
    v_mfma_f32_16x16x32_bf16 v[192:195], v[160:163], v[8:11], v[192:195]
    v_and_b32 v200, 0xffff0000, v33
    v_and_b32 v201, 0xffff0000, v35
    v_and_b32 v202, 0xffff0000, v37
    v_and_b32 v203, 0xffff0000, v39
    v_lshl_add_u32 v81, v81, 2, v74
    v_mfma_f32_16x16x32_bf16 v[192:195], v[164:167], v[12:15], v[192:195]
    v_mfma_f32_16x16x32_bf16 v[196:199], v[160:163], v[16:19], v[196:199]
    v_lshlrev_b32 v48, 16, v40
    v_lshlrev_b32 v49, 16, v42
    v_lshlrev_b32 v50, 16, v44
    v_lshlrev_b32 v51, 16, v46
    v_lshl_add_u32 v82, v82, 2, v74
    v_mfma_f32_16x16x32_bf16 v[196:199], v[164:167], v[20:23], v[196:199]
    v_mfma_f32_16x16x32_bf16 v[200:203], v[160:163], v[24:27], v[200:203]
    v_and_b32 v52, 0xffff0000, v40
    v_and_b32 v53, 0xffff0000, v42
    v_and_b32 v54, 0xffff0000, v44
    v_and_b32 v55, 0xffff0000, v46
    v_lshl_add_u32 v83, v83, 2, v74
    v_mfma_f32_16x16x32_bf16 v[200:203], v[164:167], v[28:31], v[200:203]
    v_mfma_f32_16x16x32_bf16 v[48:51], v[168:171], v[0:3], v[48:51]
    v_lshlrev_b32 v56, 16, v41
    v_lshlrev_b32 v57, 16, v43
    v_lshlrev_b32 v58, 16, v45
    v_lshlrev_b32 v59, 16, v47
    v_lshl_add_u32 v84, v84, 2, v75
    v_mfma_f32_16x16x32_bf16 v[48:51], v[172:175], v[4:7], v[48:51]
    v_mfma_f32_16x16x32_bf16 v[52:55], v[168:171], v[8:11], v[52:55]
    v_and_b32 v60, 0xffff0000, v41
    v_and_b32 v61, 0xffff0000, v43
    v_and_b32 v62, 0xffff0000, v45
    v_and_b32 v63, 0xffff0000, v47
    v_lshl_add_u32 v85, v85, 2, v75
    v_mfma_f32_16x16x32_bf16 v[52:55], v[172:175], v[12:15], v[52:55]
    v_mfma_f32_16x16x32_bf16 v[56:59], v[168:171], v[16:19], v[56:59]
    v_lshl_add_u32 v86, v86, 2, v75
    v_mfma_f32_16x16x32_bf16 v[56:59], v[172:175], v[20:23], v[56:59]
    v_mfma_f32_16x16x32_bf16 v[60:63], v[168:171], v[24:27], v[60:63]
    v_lshl_add_u32 v87, v87, 2, v75
    v_mfma_f32_16x16x32_bf16 v[60:63], v[172:175], v[28:31], v[60:63]
L_EPB:
    s_setprio 0
    s_mov_b64 exec, s[76:77]
    s_and_b32 s11, s25, 19
    s_nop 2
    s_cmp_eq_u32 s11, 0
    s_cbranch_scc1 L_NS0
    s_cmp_eq_u32 s11, 1
    s_cbranch_scc1 L_NS1
    s_cmp_eq_u32 s11, 2
    s_cbranch_scc1 L_NS2
    s_cmp_eq_u32 s11, 3
    s_cbranch_scc1 L_NS3
L_NSR:
    s_mov_b64 exec, -1
    v_rcp_f32 v96, v96
    v_rcp_f32 v97, v97
    v_rcp_f32 v98, v98
    v_rcp_f32 v99, v99
    v_rcp_f32 v100, v100
    v_rcp_f32 v101, v101
    v_rcp_f32 v102, v102
    v_rcp_f32 v103, v103
    v_rcp_f32 v104, v104
    v_rcp_f32 v105, v105
    v_rcp_f32 v106, v106
    v_rcp_f32 v107, v107
    v_rcp_f32 v108, v108
    v_rcp_f32 v109, v109
    v_rcp_f32 v110, v110
    v_rcp_f32 v111, v111
    v_pk_fma_f32 v[112:113], v[112:113], v[96:97], v[188:189]
    v_pk_fma_f32 v[114:115], v[114:115], v[98:99], v[190:191]
    v_pk_fma_f32 v[116:117], v[116:117], v[100:101], v[192:193]
    v_pk_fma_f32 v[118:119], v[118:119], v[102:103], v[194:195]
    v_pk_fma_f32 v[120:121], v[120:121], v[104:105], v[196:197]
    v_pk_fma_f32 v[122:123], v[122:123], v[106:107], v[198:199]
    v_pk_fma_f32 v[124:125], v[124:125], v[108:109], v[200:201]
    v_pk_fma_f32 v[126:127], v[126:127], v[110:111], v[202:203]
    v_cvt_pk_bf16_f32 v96, v112, v116
    v_cvt_pk_bf16_f32 v97, v120, v124
    v_pk_max_f16 v96, v96, v32
    v_pk_max_f16 v97, v97, v33
    buffer_store_dwordx2 v[96:97], v80, s[48:51], 0 offen sc1
    v_cvt_pk_bf16_f32 v98, v113, v117
    v_cvt_pk_bf16_f32 v99, v121, v125
    v_pk_max_f16 v98, v98, v34
    v_pk_max_f16 v99, v99, v35
    buffer_store_dwordx2 v[98:99], v81, s[48:51], 0 offen sc1
    v_cvt_pk_bf16_f32 v100, v114, v118
    v_cvt_pk_bf16_f32 v101, v122, v126
    v_pk_max_f16 v100, v100, v36
    v_pk_max_f16 v101, v101, v37
    buffer_store_dwordx2 v[100:101], v82, s[48:51], 0 offen sc1
    v_cvt_pk_bf16_f32 v102, v115, v119
    v_cvt_pk_bf16_f32 v103, v123, v127
    v_pk_max_f16 v102, v102, v38
    v_pk_max_f16 v103, v103, v39
    buffer_store_dwordx2 v[102:103], v83, s[48:51], 0 offen sc1
    v_rcp_f32 v128, v128
    v_rcp_f32 v129, v129
    v_rcp_f32 v130, v130
    v_rcp_f32 v131, v131
    v_rcp_f32 v132, v132
    v_rcp_f32 v133, v133
    v_rcp_f32 v134, v134
    v_rcp_f32 v135, v135
    v_rcp_f32 v136, v136
    v_rcp_f32 v137, v137
    v_rcp_f32 v138, v138
    v_rcp_f32 v139, v139
    v_rcp_f32 v140, v140
    v_rcp_f32 v141, v141
    v_rcp_f32 v142, v142
    v_rcp_f32 v143, v143
    v_pk_fma_f32 v[144:145], v[144:145], v[128:129], v[48:49]
    v_pk_fma_f32 v[146:147], v[146:147], v[130:131], v[50:51]
    v_pk_fma_f32 v[148:149], v[148:149], v[132:133], v[52:53]
    v_pk_fma_f32 v[150:151], v[150:151], v[134:135], v[54:55]
    v_pk_fma_f32 v[152:153], v[152:153], v[136:137], v[56:57]
    v_pk_fma_f32 v[154:155], v[154:155], v[138:139], v[58:59]
    v_pk_fma_f32 v[156:157], v[156:157], v[140:141], v[60:61]
    v_pk_fma_f32 v[158:159], v[158:159], v[142:143], v[62:63]
    v_cvt_pk_bf16_f32 v128, v144, v148
    v_cvt_pk_bf16_f32 v129, v152, v156
    v_pk_max_f16 v128, v128, v40
    v_pk_max_f16 v129, v129, v41
    buffer_store_dwordx2 v[128:129], v84, s[60:63], 0 offen sc1
    v_cvt_pk_bf16_f32 v130, v145, v149
    v_cvt_pk_bf16_f32 v131, v153, v157
    v_pk_max_f16 v130, v130, v42
    v_pk_max_f16 v131, v131, v43
    buffer_store_dwordx2 v[130:131], v85, s[60:63], 0 offen sc1
    v_cvt_pk_bf16_f32 v132, v146, v150
    v_cvt_pk_bf16_f32 v133, v154, v158
    v_pk_max_f16 v132, v132, v44
    v_pk_max_f16 v133, v133, v45
    buffer_store_dwordx2 v[132:133], v86, s[60:63], 0 offen sc1
    v_cvt_pk_bf16_f32 v134, v147, v151
    v_cvt_pk_bf16_f32 v135, v155, v159
    v_pk_max_f16 v134, v134, v46
    v_pk_max_f16 v135, v135, v47
    buffer_store_dwordx2 v[134:135], v87, s[60:63], 0 offen sc1
L_END:
    s_endpgm
L_NS0:
    v_add_f32 v96, v96, v128
    v_add_f32 v100, v100, v132
    v_add_f32 v104, v104, v136
    v_add_f32 v108, v108, v140
    v_add_f32 v112, v112, v144
    v_add_f32 v116, v116, v148
    v_add_f32 v120, v120, v152
    v_add_f32 v124, v124, v156
    s_branch L_NSR
L_NS1:
    v_add_f32 v97, v97, v129
    v_add_f32 v101, v101, v133
    v_add_f32 v105, v105, v137
    v_add_f32 v109, v109, v141
    v_add_f32 v113, v113, v145
    v_add_f32 v117, v117, v149
    v_add_f32 v121, v121, v153
    v_add_f32 v125, v125, v157
    s_branch L_NSR
L_NS2:
    v_add_f32 v98, v98, v130
    v_add_f32 v102, v102, v134
    v_add_f32 v106, v106, v138
    v_add_f32 v110, v110, v142
    v_add_f32 v114, v114, v146
    v_add_f32 v118, v118, v150
    v_add_f32 v122, v122, v154
    v_add_f32 v126, v126, v158
    s_branch L_NSR
L_NS3:
    v_add_f32 v99, v99, v131
    v_add_f32 v103, v103, v135
    v_add_f32 v107, v107, v139
    v_add_f32 v111, v111, v143
    v_add_f32 v115, v115, v147
    v_add_f32 v119, v119, v151
    v_add_f32 v123, v123, v155
    v_add_f32 v127, v127, v159
    s_branch L_NSR
L_RT0:
    s_waitcnt vmcnt(0)
    s_add_u32 s100, s100, 1
    s_cmp_gt_u32 s100, 200000
    s_cbranch_scc1 L_END
    s_sleep 1
    buffer_load_dwordx4 v[128:131], v232, s[56:59], s26 offen sc1
    buffer_load_dwordx4 v[132:135], v232, s[56:59], s27 offen sc1
    buffer_load_dwordx4 v[136:139], v232, s[56:59], s28 offen sc1
    buffer_load_dwordx4 v[140:143], v232, s[56:59], s29 offen sc1
    s_waitcnt vmcnt(0)
    s_branch L_PW0
L_RT1:
    s_waitcnt vmcnt(0)
    s_add_u32 s100, s100, 1
    s_cmp_gt_u32 s100, 200000
    s_cbranch_scc1 L_END
    s_sleep 1
    buffer_load_dwordx4 v[132:135], v232, s[56:59], s27 offen sc1
    buffer_load_dwordx4 v[136:139], v232, s[56:59], s28 offen sc1
    buffer_load_dwordx4 v[140:143], v232, s[56:59], s29 offen sc1
    s_waitcnt vmcnt(0)
    s_branch L_PW1
L_RT2:
    s_waitcnt vmcnt(0)
    s_add_u32 s100, s100, 1
    s_cmp_gt_u32 s100, 200000
    s_cbranch_scc1 L_END
    s_sleep 1
    buffer_load_dwordx4 v[136:139], v232, s[56:59], s28 offen sc1
    buffer_load_dwordx4 v[140:143], v232, s[56:59], s29 offen sc1
    s_waitcnt vmcnt(0)
    s_branch L_PW2
L_RT3:
    s_waitcnt vmcnt(0)
    s_add_u32 s100, s100, 1
    s_cmp_gt_u32 s100, 200000
    s_cbranch_scc1 L_END
    s_sleep 1
    buffer_load_dwordx4 v[140:143], v232, s[56:59], s29 offen sc1
    s_waitcnt vmcnt(0)
    s_branch L_PW3
L_XT2B:
    s_add_u32 s100, s100, 1
    s_cmp_gt_u32 s100, 200000
    s_cbranch_scc1 L_END
    s_sleep 1
    s_mov_b64 exec, s[70:71]
    s_cbranch_execz L_XLb0
    s_movk_i32 s10, 0
    buffer_load_dwordx4 v[64:67], v232, s[60:63], s10 offen sc1
L_XLb0:
    s_mov_b64 exec, s[78:79]
    s_cbranch_execz L_XLb1
    s_movk_i32 s10, 8192
    buffer_load_dwordx4 v[68:71], v232, s[60:63], s10 offen sc1
L_XLb1:
    s_mov_b64 exec, s[86:87]
    s_cbranch_execz L_XLb2
    s_movk_i32 s10, 16384
    buffer_load_dwordx4 v[72:75], v232, s[60:63], s10 offen sc1
L_XLb2:
    s_mov_b64 exec, s[94:95]
    s_cbranch_execz L_XLb3
    s_movk_i32 s10, 24576
    buffer_load_dwordx4 v[76:79], v232, s[60:63], s10 offen sc1
L_XLb3:
    s_mov_b64 exec, -1
    s_waitcnt vmcnt(0)
    s_branch L_XT2
L_OVF:
    s_mov_b32 s20, 0
    s_mov_b32 s17, 0
    s_mov_b32 s30, 0
    s_mov_b32 s19, 4
    s_waitcnt lgkmcnt(0)
    s_branch L_CA
L_POVF:
    s_movk_i32 s11, 1986
    v_mul_u32_u24 v64, s11, v192
    v_lshrrev_b32 v64, 16, v64
    v_mul_u32_u24 v65, s11, v193
    v_lshrrev_b32 v65, 16, v65
    v_mul_u32_u24 v66, s11, v194
    v_lshrrev_b32 v66, 16, v66
    v_mul_u32_u24 v67, s11, v195
    v_lshrrev_b32 v67, 16, v67
    v_add_u32 v69, v64, v65
    v_add_u32 v70, v69, v66
    v_add_u32 v71, v70, v67
    v_mov_b32 v72, v71
    s_nop 1
    v_add_u32_dpp v72, v72, v72 row_shr:1 row_mask:0xf bank_mask:0xf bound_ctrl:0
    s_nop 1
    v_add_u32_dpp v72, v72, v72 row_shr:2 row_mask:0xf bank_mask:0xf bound_ctrl:0
    s_nop 1
    v_add_u32_dpp v72, v72, v72 row_shr:4 row_mask:0xf bank_mask:0xf bound_ctrl:0
    s_nop 1
    v_add_u32_dpp v72, v72, v72 row_shr:8 row_mask:0xf bank_mask:0xf bound_ctrl:0
    s_nop 1
    v_add_u32_dpp v72, v72, v72 row_bcast:15 row_mask:0xa bank_mask:0xf
    s_nop 1
    v_add_u32_dpp v72, v72, v72 row_bcast:31 row_mask:0xc bank_mask:0xf
    s_nop 0
    v_sub_u32 v68, v72, v71
    v_add_u32 v71, v68, v70
    v_add_u32 v70, v68, v69
    v_add_u32 v69, v68, v64
    v_lshl_or_b32 v68, v64, 16, v68
    v_lshl_or_b32 v69, v65, 16, v69
    v_lshl_or_b32 v70, v66, 16, v70
    v_lshl_or_b32 v71, v67, 16, v71
    v_add_u32 v72, 154752, v185
    ds_write_b128 v72, v[68:71]
    s_lshl_b32 s10, s2, 10
    s_add_u32 s10, s10, 24772608
    buffer_store_dwordx4 v[68:71], v185, s[52:55], s10 offen sc1
    v_and_b32 v74, 0x3fc, v136
    v_add_u32 v74, 154752, v74
    ds_read_u16 v74, v74
    v_and_b32 v75, 0x3fc, v137
    v_add_u32 v75, 154752, v75
    ds_read_u16 v75, v75
    v_and_b32 v76, 0x3fc, v138
    v_add_u32 v76, 154752, v76
    ds_read_u16 v76, v76
    v_and_b32 v77, 0x3fc, v139
    v_add_u32 v77, 154752, v77
    ds_read_u16 v77, v77
    v_and_b32 v78, 0x3fc, v140
    v_add_u32 v78, 154752, v78
    ds_read_u16 v78, v78
    v_and_b32 v79, 0x3fc, v141
    v_add_u32 v79, 154752, v79
    ds_read_u16 v79, v79
    v_and_b32 v80, 0x3fc, v142
    v_add_u32 v80, 154752, v80
    ds_read_u16 v80, v80
    v_and_b32 v81, 0x3fc, v143
    v_add_u32 v81, 154752, v81
    ds_read_u16 v81, v81
    s_waitcnt lgkmcnt(0)
    v_cmpx_lt_u32 vcc, 1056, v228
    v_or_b32 v205, 0x10000, v205
    s_mov_b64 exec, -1
    v_cmpx_lt_u32 vcc, 1056, v229
    v_or_b32 v209, 0x10000, v209
    s_mov_b64 exec, -1
    v_cmpx_lt_u32 vcc, 1056, v230
    v_or_b32 v213, 0x10000, v213
    s_mov_b64 exec, -1
    v_cmpx_lt_u32 vcc, 1056, v231
    v_or_b32 v217, 0x10000, v217
    s_mov_b64 exec, -1
    s_mul_i32 s10, s2, 4152
    s_mov_b32 s34, 18874368
    s_mov_b32 s35, 23592960
    v_mul_u32_u24 v64, s11, v112
    v_lshrrev_b32 v64, 16, v64
    v_add3_u32 v64, v64, v74, s10
    v_lshlrev_b32 v65, 2, v64
    v_cmpx_le_u32 vcc, 1056, v112
    s_cbranch_execz L_PO0
    buffer_store_byte v120, v64, s[52:55], s35 offen sc1
    buffer_store_dword v96, v65, s[52:55], s34 offen sc1
L_PO0:
    s_mov_b64 exec, -1
    v_mul_u32_u24 v64, s11, v113
    v_lshrrev_b32 v64, 16, v64
    v_add3_u32 v64, v64, v75, s10
    v_lshlrev_b32 v65, 2, v64
    v_cmpx_le_u32 vcc, 1056, v113
    s_cbranch_execz L_PO1
    buffer_store_byte v121, v64, s[52:55], s35 offen sc1
    buffer_store_dword v97, v65, s[52:55], s34 offen sc1
L_PO1:
    s_mov_b64 exec, -1
    v_mul_u32_u24 v64, s11, v114
    v_lshrrev_b32 v64, 16, v64
    v_add3_u32 v64, v64, v76, s10
    v_lshlrev_b32 v65, 2, v64
    v_cmpx_le_u32 vcc, 1056, v114
    s_cbranch_execz L_PO2
    buffer_store_byte v122, v64, s[52:55], s35 offen sc1
    buffer_store_dword v98, v65, s[52:55], s34 offen sc1
L_PO2:
    s_mov_b64 exec, -1
    v_mul_u32_u24 v64, s11, v115
    v_lshrrev_b32 v64, 16, v64
    v_add3_u32 v64, v64, v77, s10
    v_lshlrev_b32 v65, 2, v64
    v_cmpx_le_u32 vcc, 1056, v115
    s_cbranch_execz L_PO3
    buffer_store_byte v123, v64, s[52:55], s35 offen sc1
    buffer_store_dword v99, v65, s[52:55], s34 offen sc1
L_PO3:
    s_mov_b64 exec, -1
    v_mul_u32_u24 v64, s11, v116
    v_lshrrev_b32 v64, 16, v64
    v_add3_u32 v64, v64, v78, s10
    v_lshlrev_b32 v65, 2, v64
    v_cmpx_le_u32 vcc, 1056, v116
    s_cbranch_execz L_PO4
    buffer_store_byte v120, v64, s[52:55], s35 offen sc1
    buffer_store_dword v100, v65, s[52:55], s34 offen sc1
L_PO4:
    s_mov_b64 exec, -1
    v_mul_u32_u24 v64, s11, v117
    v_lshrrev_b32 v64, 16, v64
    v_add3_u32 v64, v64, v79, s10
    v_lshlrev_b32 v65, 2, v64
    v_cmpx_le_u32 vcc, 1056, v117
    s_cbranch_execz L_PO5
    buffer_store_byte v121, v64, s[52:55], s35 offen sc1
    buffer_store_dword v101, v65, s[52:55], s34 offen sc1
L_PO5:
    s_mov_b64 exec, -1
    v_mul_u32_u24 v64, s11, v118
    v_lshrrev_b32 v64, 16, v64
    v_add3_u32 v64, v64, v80, s10
    v_lshlrev_b32 v65, 2, v64
    v_cmpx_le_u32 vcc, 1056, v118
    s_cbranch_execz L_PO6
    buffer_store_byte v122, v64, s[52:55], s35 offen sc1
    buffer_store_dword v102, v65, s[52:55], s34 offen sc1
L_PO6:
    s_mov_b64 exec, -1
    v_mul_u32_u24 v64, s11, v119
    v_lshrrev_b32 v64, 16, v64
    v_add3_u32 v64, v64, v81, s10
    v_lshlrev_b32 v65, 2, v64
    v_cmpx_le_u32 vcc, 1056, v119
    s_cbranch_execz L_PO7
    buffer_store_byte v123, v64, s[52:55], s35 offen sc1
    buffer_store_dword v103, v65, s[52:55], s34 offen sc1
L_PO7:
    s_mov_b64 exec, -1
    s_waitcnt vmcnt(0) lgkmcnt(0)
    s_barrier
    s_branch L_POUT
L_SLOW:
    s_setprio 0
    s_lshl_b32 s10, s3, 6
    v_add_u32 v255, s10, v247
    s_cmp_lg_u32 s19, 4
    s_cbranch_scc1 L_SL1
    s_mov_b32 s19, 1
    v_and_b32 v188, 0xff, v255
    v_lshlrev_b32 v189, 7, v188
    buffer_load_dword v190, v189, s[56:59], 0 offen offset:4 sc1
    v_lshlrev_b32 v189, 10, v188
    s_lshl_b32 s10, s5, 2
    s_add_u32 s10, s10, 24772608
    buffer_load_dword v191, v189, s[52:55], s10 offen sc1
    v_lshlrev_b32 v188, 2, v188
    v_add_u32 v188, 154752, v188
    s_waitcnt vmcnt(0)
    v_and_b32 v190, 0x10000, v190
    v_cmp_ne_u32 vcc, 0, v190
    v_mov_b32 v190, 2097152
    s_nop 0
    v_cndmask_b32 v190, v190, v191, vcc
    ds_write_b32 v188, v190
    s_waitcnt lgkmcnt(0)
    s_barrier
L_SL1:
    s_add_u32 s28, s28, 288
    s_cmp_lt_u32 s28, s29
    s_cbranch_scc1 L_BATCH
L_FIND:
    s_cmp_lg_u64 s[32:33], 0
    s_cbranch_scc1 L_GOT
    s_add_u32 s26, s26, 1
    s_cmp_ge_u32 s26, 4
    s_cbranch_scc1 L_EPI
    s_lshl_b32 s10, s26, 8
    s_add_u32 s10, s10, 154752
    v_lshl_add_u32 v188, v247, 2, s10
    ds_read_u16 v188, v188 offset:2
    s_waitcnt lgkmcnt(0)
    v_cmp_lt_u32 s[32:33], s20, v188
    s_nop 3
    s_branch L_FIND
L_GOT:
    s_ff1_i32_b64 s10, s[32:33]
    s_bitset0_b64 s[32:33], s10
    s_lshl_b32 s11, s26, 6
    s_add_u32 s27, s10, s11
    s_lshl_b32 s10, s27, 2
    s_add_u32 s10, s10, 154752
    v_mov_b32 v188, s10
    ds_read_b32 v188, v188
    s_waitcnt lgkmcnt(0)
    v_readfirstlane_b32 s10, v188
    s_nop 3
    s_lshr_b32 s29, s10, 16
    s_and_b32 s30, s10, 0xffff
    s_mov_b32 s28, s20
L_BATCH:
    s_waitcnt vmcnt(0)
    s_barrier
    v_mov_b32 v192, 0x2000000
    v_mov_b32 v193, 0x2000000
    v_mov_b32 v194, 0x2000000
    v_mov_b32 v195, 0x2000000
    v_mov_b32 v196, 0xfffff
    v_mov_b32 v197, 0xfffff
    v_mov_b32 v198, 0xfffff
    v_mov_b32 v199, 0xfffff
    v_lshl_add_u32 v200, v247, 4, s12
    ds_write_b128 v200, v[192:195] offset:0
    ds_write_b128 v200, v[196:199] offset:18432
    ds_write_b128 v200, v[192:195] offset:1024
    ds_write_b128 v200, v[196:199] offset:19456
    ds_write_b128 v200, v[192:195] offset:1280
    ds_write_b128 v200, v[196:199] offset:19712
    v_and_b32 v188, 15, v247
    v_mul_u32_u24 v189, 1152, v188
    v_add_u32 v189, 8192, v189
    v_lshlrev_b32 v188, 2, v188
    ds_write_b32 v188, v189 offset:576
    v_add_u32 v188, s28, v255
    s_mul_i32 s36, s27, 3128
    s_mul_i32 s11, s27, 4152
    s_add_u32 s11, s11, s30
    s_lshl_b32 s34, s11, 2
    s_add_u32 s34, s34, 18874368
    v_lshl_add_u32 v190, v188, 2, s34
    s_add_u32 s34, s11, 23592960
    v_add_u32 v191, s34, v188
    s_mul_i32 s10, s5, 32896
    s_lshl_b32 s34, s27, 7
    s_add_u32 s10, s10, s34
    s_add_u32 s10, s10, 65536
    v_and_b32 v206, 7, v188
    v_lshl_add_u32 v206, v206, 4, s10
    v_lshrrev_b32 v207, 3, v188
    v_cmpx_gt_u32 vcc, 32, v188
    v_add_u32 v190, 8421376, v206
    v_add_u32 v191, 8, v190
    v_cmpx_gt_u32 vcc, 24, v188
    v_lshl_add_u32 v190, v207, 2, v206
    v_add3_u32 v191, v206, v207, 12
    s_mov_b64 exec, -1
    s_add_u32 s10, s28, 288
    s_min_u32 s10, s10, s29
    v_cmp_gt_u32 vcc, s10, v188
    v_mov_b32 v206, 0x7ffffff0
    s_nop 0
    v_cndmask_b32 v190, v206, v190, vcc
    v_cndmask_b32 v191, v206, v191, vcc
    buffer_load_dwordx2 v[204:205], v190, s[52:55], 0 offen sc1
    buffer_load_ubyte v191, v191, s[52:55], 0 offen sc1
    s_waitcnt lgkmcnt(0)
    s_barrier
    s_waitcnt vmcnt(0)
    v_cmp_ne_u32 vcc, 3, v207
    v_cmp_eq_u32 s[10:11], s6, v205
    v_mov_b32 v206, s36
    s_or_b64 exec, vcc, s[10:11]
    v_cmpx_ne_u32 vcc, 0, v204
    v_bfe_u32 v190, v204, 18, 8
    v_lshlrev_b32 v190, 2, v190
    v_add_u32 v188, 153728, v190
    ds_read_b32 v188, v188
    v_add_u32_sdwa v191, v191, v206 dst_sel:DWORD dst_unused:UNUSED_PAD src0_sel:BYTE_0 src1_sel:DWORD
    v_lshrrev_b32 v189, 28, v204
    v_lshl_add_u32 v191, v189, 8, v191
    v_and_b32 v189, 60, v190
    v_and_b32 v204, 0xffff, v204
    v_lshl_or_b32 v204, v189, 19, v204
    v_mov_b32 v190, 4
    s_waitcnt lgkmcnt(0)
    ds_add_rtn_u32 v188, v188, v190 offset:576
    s_waitcnt lgkmcnt(0)
    ds_write2st64_b32 v188, v204, v191 offset0:148 offset1:220
    s_mov_b64 exec, -1
    s_waitcnt lgkmcnt(0)
    s_barrier
    v_lshrrev_b32 v190, 3, v247
    v_lshl_add_u32 v248, v190, 4, s12
    s_add_u32 s10, s12, 18432
    v_lshrrev_b32 v190, 1, v247
    v_lshl_add_u32 v249, v190, 2, s10
    s_add_u32 s10, s10, 2
    v_lshrrev_b32 v190, 5, v247
    v_mul_i32_i24 v250, 0xffffb800, v190
    v_and_b32 v190, 15, v247
    v_lshl_add_u32 v250, v190, 2, v250
    v_add_u32 v250, s10, v250
    s_add_u32 s10, s12, 2
    v_and_b32 v190, 48, v247
    v_lshl_add_u32 v251, v190, 1, s10
    v_and_b32 v190, 12, v247
    v_add_u32 v251, v251, v190
    ds_read_b128 v[236:239], v248
    ds_read_b32 v240, v249
    s_lshl_b32 s10, s4, 3
    v_mov_b32 v190, s10
    ds_read_b64 v[190:191], v190 offset:576
    s_waitcnt lgkmcnt(0)
    v_readfirstlane_b32 s34, v190
    v_readfirstlane_b32 s35, v191
    s_sub_u32 s10, s12, 37888
    s_sub_u32 s34, s34, s10
    s_sub_u32 s35, s35, s10
    s_sub_u32 s35, s35, 1152
    s_add_u32 s10, s34, 127
    s_lshr_b32 s10, s10, 7
    s_lshl1_add_u32 s10, s10, -1
    s_add_u32 s11, s35, 127
    s_lshr_b32 s11, s11, 6
    s_and_b32 s11, s11, -2
    s_max_i32 s17, s10, s11
    s_cselect_b32 s10, s34, s35
    s_sub_u32 s10, s10, 1
    s_andn2_b32 s99, 64, s10
    v_mov_b64 v[204:205], 0
    v_mov_b64 v[206:207], 0
    v_mov_b64 v[184:185], 0
    v_mov_b64 v[186:187], 0
    s_add_u32 m0, s13, 0
    v_mad_u32_u16 v236, v236, s15, v243
    buffer_load_dwordx4 v236, s[40:43], 0 offen lds
    s_add_u32 m0, s13, 1056
    v_mad_u32_u16 v237, v237, s15, v243
    buffer_load_dwordx4 v237, s[40:43], 0 offen lds
    s_add_u32 m0, s13, 2112
    v_mad_u32_u16 v238, v238, s15, v243
    buffer_load_dwordx4 v238, s[40:43], 0 offen lds
    s_add_u32 m0, s13, 3168
    v_mad_u32_u16 v239, v239, s15, v243
    buffer_load_dwordx4 v239, s[40:43], 0 offen lds
    s_mov_b32 m0, s14
    s_nop 0
    buffer_load_dwordx4 v[240:241], s[44:47], 0 idxen offen lds
L_LAST:
    s_branch L_GO
.section .rodata,"a"
.p2align 6
.amdhsa_kernel standalone__edge_featured_mpnn_gatedgcn__graph_kernel
  .amdhsa_next_free_vgpr 256
  .amdhsa_next_free_sgpr 102
  .amdhsa_accum_offset 256
  .amdhsa_group_segment_fixed_size 0
  .amdhsa_kernarg_size 96
  .amdhsa_user_sgpr_count 2
  .amdhsa_user_sgpr_kernarg_segment_ptr 1
  .amdhsa_system_sgpr_workgroup_id_x 1
.end_amdhsa_kernel
```

```asm
; @launch grid=(256,1,1) block=(512,1,1) lds=158848
.amdgcn_target "amdgcn-amd-amdhsa--gfx950"
.text
.globl standalone__edge_featured_mpnn_gatedgcn__graph_kernel
.p2align 8
.type standalone__edge_featured_mpnn_gatedgcn__graph_kernel,@function
standalone__edge_featured_mpnn_gatedgcn__graph_kernel:
    s_load_dwordx16 s[16:31], s[0:1], 0
    s_load_dwordx8 s[32:39], s[0:1], 64
    s_getpc_b64 s[64:65]
L_PC:
    s_and_b32 s3, s2, -8
    v_add_lshl_u32 v1, v0, s3, 7
    v_min_u32 v1, L_LAST-L_PC, v1
    v_cmpx_gt_u32 vcc, 8, v0
    s_cbranch_execz L_NOCPF
    global_load_dword v252, v1, s[64:65]
L_NOCPF:
    s_mov_b64 exec, -1
    s_cmp_ge_u32 s2, 256
    s_cbranch_scc1 L_END
    s_mul_i32 s10, s2, 12512
    v_lshl_add_u32 v1, v0, 4, s10
    s_add_u32 s11, s10, 12512
    s_min_u32 s11, s11, 3200000
    v_add_u32 v2, 0x2000, v1
    s_waitcnt lgkmcnt(0)
    global_load_dwordx4 v[128:131], v1, s[22:23] nt
    global_load_dwordx4 v[96:99], v1, s[20:21] nt
    v_cmpx_gt_u32 s[70:71], s11, v2
    s_cbranch_execz L_NO8
    global_load_dwordx4 v[132:135], v2, s[22:23] nt
    global_load_dwordx4 v[100:103], v2, s[20:21] nt
L_NO8:
    s_mov_b64 exec, -1
L_NO7:
    s_mov_b64 exec, -1
    s_load_dword s6, s[38:39], 0
    v_mov_b32 v255, v0
    v_lshrrev_b32 v188, 6, v0
    v_and_b32 v247, 63, v0
    v_readfirstlane_b32 s3, v188
    v_lshlrev_b32 v232, 4, v0
    v_lshlrev_b32 v190, 3, v0
    v_lshlrev_b32 v191, 2, v0
    v_and_b32 v192, 0x3fc, v191
    s_and_b32 s5, s2, 7
    s_lshr_b32 s4, s2, 3
    s_lshl_b32 s5, s5, 5
    s_add_u32 s5, s5, s4
    s_mul_i32 s9, s5, 196
    s_cmp_eq_u32 s3, 7
    s_cselect_b32 s101, 0, s3
    s_lshl_b32 s12, s101, 5
    s_add_u32 s9, s9, s12
    v_lshrrev_b32 v193, 3, v247
    v_lshl_add_u32 v193, v193, 2, s9
    v_and_b32 v243, 7, v247
    v_lshlrev_b32 v243, 4, v243
    v_lshl_add_u32 v234, v193, 7, v243
    s_lshl_b32 s101, s101, 10
    s_add_u32 s101, s101, 116736
    v_mov_b64 v[196:197], 0
    v_mov_b64 v[198:199], 0
    v_mov_b32 v194, 132
    ds_write2st64_b32 v192, v194, v196 offset0:20 offset1:24
    v_add_u32 v193, 46080, v232
    ds_write_b128 v193, v[196:199] offset:0
    ds_write_b128 v193, v[196:199] offset:8192
    ds_write_b128 v193, v[196:199] offset:16384
    ds_write_b128 v193, v[196:199] offset:24576
    ds_write_b128 v193, v[196:199] offset:32768
    s_mov_b32 s44, s18
    s_or_b32 s45, s19, 0x200000
    s_mov_b32 s46, 800000
    s_mov_b32 s47, 0x20000
    s_mov_b32 s48, s34
    s_mov_b32 s49, s35
    s_mov_b32 s50, 6400000
    s_mov_b32 s51, 0x20000
    s_mov_b32 s40, s16
    s_mov_b32 s41, s17
    s_mov_b32 s42, 6400000
    s_mov_b32 s43, 0x20000
    s_mov_b32 s52, s38
    s_mov_b32 s53, s39
    s_mov_b32 s54, 25165824
    s_mov_b32 s55, 0x20000
    s_lshl_b32 s12, s2, 7
    s_add_u32 s12, s12, 65536
    s_add_u32 s56, s38, s12
    s_addc_u32 s57, s39, 0
    s_mov_b32 s58, 16809984
    s_mov_b32 s59, 0x20000
    s_mov_b32 s64, 85599
    s_mov_b32 s65, 4294967100
    s_movk_i32 s66, 5368
    s_mov_b32 s67, 0xc000000
    s_mov_b32 s68, 32896
    s_mov_b32 s100, 0xffeff220
    v_add_u32 v120, 0, v191
    v_add_u32 v121, 1, v191
    v_add_u32 v122, 2, v191
    v_add_u32 v123, 3, v191
    s_lshl_b32 s10, s3, 28
    s_or_b32 s10, s10, 0x20000
    v_mov_b32 v144, s10
    v_or_b32 v145, 0x80000000, v144
    v_mov_b32 v184, 33
    v_mov_b32 v146, 0x400
    s_and_b32 s10, s3, 3
    s_lshr_b32 s4, s3, 2
    s_lshl1_add_u32 s4, s10, s4
    s_xor_b32 s4, s4, 1
    s_mul_i32 s10, s4, 49
    s_sub_i32 s10, s10, 6
    s_ashr_i32 s10, s10, 1
    s_max_i32 s7, s10, 0
    s_mul_i32 s13, s4, 4224
    s_add_u32 s13, s13, 82944
    s_lshl_b32 s14, s4, 10
    s_add_u32 s14, s14, 5120
    s_mul_i32 s12, s4, 2304
    s_add_u32 s12, s12, 46080
    s_movk_i32 s15, 128
    v_bfe_u32 v194, v255, 4, 4
    v_and_b32 v195, 7, v255
    v_cmp_eq_u32 vcc, v194, v195
    v_and_b32 v194, 8, v255
    v_lshlrev_b32 v194, 1, v194
    v_mov_b32 v196, 0x3f80
    v_lshlrev_b32 v196, v194, v196
    v_cndmask_b32 v196, 0, v196, vcc
    ds_write_b32 v192, v196 offset:0
    v_mov_b64 v[196:197], 0
    ds_write_b64 v190, v[196:197] offset:1024
    v_add_u32 v194, 155776, v191
    ds_write_b32 v194, v196
    v_lshrrev_b32 v223, 3, v255
    v_mul_u32_u24 v224, 160, v223
    v_mad_u32_u24 v220, v223, s68, v243
    v_add_u32 v221, v224, v243
    v_add_u32 v221, 46080, v221
    v_bfe_u32 v194, v255, 5, 1
    v_bfe_u32 v196, v255, 6, 1
    v_sub_u32 v194, v194, v196
    v_mul_i32_i24 v194, 640, v194
    v_add_u32 v224, v224, v194
    v_lshl_add_u32 v224, v195, 2, v224
    v_add_u32 v224, 13312, v224
    v_lshlrev_b32 v185, 4, v247
    v_and_b32 v194, 3, v247
    v_lshlrev_b32 v246, 3, v194
    v_bfe_u32 v197, v247, 2, 3
    v_lshrrev_b32 v196, 5, v247
    v_lshl_add_u32 v197, v196, 4, v197
    v_mul_u32_u24 v225, 160, v197
    v_add_u32 v225, v225, v246
    s_movk_i32 s69, 11520
    v_mov_b64 v[116:117], 0
    v_mov_b64 v[118:119], 0
    s_waitcnt lgkmcnt(0)
    s_barrier
    s_cmp_eq_u64 s[70:71], 0
    s_cbranch_scc1 L_R4
    s_waitcnt vmcnt(3)
    v_mul_u32_u24 v104, s64, v128
    v_mul_u32_u24 v105, s64, v129
    v_mul_u32_u24 v106, s64, v130
    v_mul_u32_u24 v107, s64, v131
    v_lshrrev_b32 v136, 29, v104
    v_lshrrev_b32 v137, 29, v105
    v_lshrrev_b32 v138, 29, v106
    v_lshrrev_b32 v139, 29, v107
    v_cmp_eq_u32 s[72:73], v136, v137
    v_cmp_eq_u32 s[76:77], v138, v139
    v_cmp_eq_u32 vcc, v136, v138
    v_cmp_eq_u32 s[88:89], v137, v139
    v_cmp_eq_u32 s[90:91], v136, v139
    v_cmp_eq_u32 s[10:11], v137, v138
    v_lshrrev_b32 v104, 24, v104
    v_lshrrev_b32 v105, 24, v105
    v_lshrrev_b32 v106, 24, v106
    v_lshrrev_b32 v107, 24, v107
    s_or_b64 s[74:75], s[72:73], s[88:89]
    s_or_b64 s[78:79], s[76:77], s[88:89]
    s_or_b64 s[72:73], s[72:73], vcc
    s_or_b64 s[76:77], s[76:77], vcc
    s_or_b64 s[72:73], s[72:73], s[90:91]
    s_or_b64 s[74:75], s[74:75], s[10:11]
    s_or_b64 s[76:77], s[76:77], s[10:11]
    s_or_b64 s[78:79], s[78:79], s[90:91]
    v_cndmask_b32 v136, 0, v146, s[72:73]
    v_lshl_add_u32 v136, v104, 2, v136
    ds_add_rtn_u32 v112, v136, v184 offset:5120
    v_cndmask_b32 v137, 0, v146, s[74:75]
    v_lshl_add_u32 v137, v105, 2, v137
    ds_add_rtn_u32 v113, v137, v184 offset:5120
    v_cndmask_b32 v138, 0, v146, s[76:77]
    v_lshl_add_u32 v138, v106, 2, v138
    ds_add_rtn_u32 v114, v138, v184 offset:5120
    v_cndmask_b32 v139, 0, v146, s[78:79]
    v_lshl_add_u32 v139, v107, 2, v139
    ds_add_rtn_u32 v115, v139, v184 offset:5120
    s_waitcnt vmcnt(1)
    s_mov_b64 exec, s[70:71]
    v_mul_u32_u24 v108, s64, v132
    v_mul_u32_u24 v109, s64, v133
    v_mul_u32_u24 v110, s64, v134
    v_mul_u32_u24 v111, s64, v135
    v_lshrrev_b32 v108, 24, v108
    v_lshrrev_b32 v109, 24, v109
    v_lshrrev_b32 v110, 24, v110
    v_lshrrev_b32 v111, 24, v111
    v_lshlrev_b32 v140, 2, v108
    ds_add_rtn_u32 v116, v140, v184 offset:5120
    v_lshlrev_b32 v141, 2, v109
    ds_add_rtn_u32 v117, v141, v184 offset:5120
    v_lshlrev_b32 v142, 2, v110
    ds_add_rtn_u32 v118, v142, v184 offset:5120
    v_lshlrev_b32 v143, 2, v111
    ds_add_rtn_u32 v119, v143, v184 offset:5120
    s_waitcnt lgkmcnt(7)
    s_mov_b64 exec, s[72:73]
    v_cmpx_le_u32 vcc, 132, v112
    ds_add_rtn_u32 v112, v136, v184 offset:4096
    s_waitcnt lgkmcnt(7)
    s_mov_b64 exec, s[74:75]
    v_cmpx_le_u32 vcc, 132, v113
    ds_add_rtn_u32 v113, v137, v184 offset:4096
    s_waitcnt lgkmcnt(7)
    s_mov_b64 exec, s[76:77]
    v_cmpx_le_u32 vcc, 132, v114
    ds_add_rtn_u32 v114, v138, v184 offset:4096
    s_waitcnt lgkmcnt(7)
    s_mov_b64 exec, s[78:79]
    v_cmpx_le_u32 vcc, 132, v115
    ds_add_rtn_u32 v115, v139, v184 offset:4096
    s_mov_b64 exec, s[70:71]
    s_waitcnt vmcnt(0)
    v_mad_i32_i24 v132, v108, s65, v132
    v_mul_u32_u24 v194, s66, v100
    v_lshl_or_b32 v100, v132, 18, v100
    v_and_b32 v132, 0xe0, v108
    v_mad_i32_i24 v194, v132, s100, v194
    v_and_or_b32 v194, v194, s67, v145
    v_mad_u32_u24 v132, v108, 40, s69
    v_or_b32 v100, v100, v194
    v_mad_i32_i24 v133, v109, s65, v133
    v_mul_u32_u24 v194, s66, v101
    v_lshl_or_b32 v101, v133, 18, v101
    v_and_b32 v133, 0xe0, v109
    v_mad_i32_i24 v194, v133, s100, v194
    v_and_or_b32 v194, v194, s67, v145
    v_mad_u32_u24 v133, v109, 40, s69
    v_or_b32 v101, v101, v194
    v_mad_i32_i24 v134, v110, s65, v134
    v_mul_u32_u24 v194, s66, v102
    v_lshl_or_b32 v102, v134, 18, v102
    v_and_b32 v134, 0xe0, v110
    v_mad_i32_i24 v194, v134, s100, v194
    v_and_or_b32 v194, v194, s67, v145
    v_mad_u32_u24 v134, v110, 40, s69
    v_or_b32 v102, v102, v194
    v_mad_i32_i24 v135, v111, s65, v135
    v_mul_u32_u24 v194, s66, v103
    v_lshl_or_b32 v103, v135, 18, v103
    v_and_b32 v135, 0xe0, v111
    v_mad_i32_i24 v194, v135, s100, v194
    v_and_or_b32 v194, v194, s67, v145
    v_mad_u32_u24 v135, v111, 40, s69
    v_or_b32 v103, v103, v194
    s_waitcnt lgkmcnt(7)
    v_bfe_u32 v194, v116, 3, 5
    v_add_lshl_u32 v132, v194, v132, 2
    v_and_b32 v194, 3, v194
    v_mad_i32_i24 v194, v194, -3, v132
    v_cmpx_gt_u32 vcc, 792, v116
    ds_write_b32 v132, v100
    ds_write_b8 v194, v120 offset:12
    s_mov_b64 exec, s[70:71]
    s_waitcnt lgkmcnt(8)
    v_bfe_u32 v194, v117, 3, 5
    v_add_lshl_u32 v133, v194, v133, 2
    v_and_b32 v194, 3, v194
    v_mad_i32_i24 v194, v194, -3, v133
    v_cmpx_gt_u32 vcc, 792, v117
    ds_write_b32 v133, v101
    ds_write_b8 v194, v121 offset:12
    s_mov_b64 exec, s[70:71]
    s_waitcnt lgkmcnt(9)
    v_bfe_u32 v194, v118, 3, 5
    v_add_lshl_u32 v134, v194, v134, 2
    v_and_b32 v194, 3, v194
    v_mad_i32_i24 v194, v194, -3, v134
    v_cmpx_gt_u32 vcc, 792, v118
    ds_write_b32 v134, v102
    ds_write_b8 v194, v122 offset:12
    s_mov_b64 exec, s[70:71]
    s_waitcnt lgkmcnt(10)
    v_bfe_u32 v194, v119, 3, 5
    v_add_lshl_u32 v135, v194, v135, 2
    v_and_b32 v194, 3, v194
    v_mad_i32_i24 v194, v194, -3, v135
    v_cmpx_gt_u32 vcc, 792, v119
    ds_write_b32 v135, v103
    ds_write_b8 v194, v123 offset:12
    s_mov_b64 exec, -1
    v_mad_i32_i24 v128, v104, s65, v128
    v_mul_u32_u24 v194, s66, v96
    v_lshl_or_b32 v96, v128, 18, v96
    v_and_b32 v128, 0xe0, v104
    v_mad_i32_i24 v194, v128, s100, v194
    v_and_or_b32 v194, v194, s67, v144
    v_mad_u32_u24 v128, v104, 40, s69
    v_or_b32 v96, v96, v194
    v_mad_i32_i24 v129, v105, s65, v129
    v_mul_u32_u24 v194, s66, v97
    v_lshl_or_b32 v97, v129, 18, v97
    v_and_b32 v129, 0xe0, v105
    v_mad_i32_i24 v194, v129, s100, v194
    v_and_or_b32 v194, v194, s67, v144
    v_mad_u32_u24 v129, v105, 40, s69
    v_or_b32 v97, v97, v194
    v_mad_i32_i24 v130, v106, s65, v130
    v_mul_u32_u24 v194, s66, v98
    v_lshl_or_b32 v98, v130, 18, v98
    v_and_b32 v130, 0xe0, v106
    v_mad_i32_i24 v194, v130, s100, v194
    v_and_or_b32 v194, v194, s67, v144
    v_mad_u32_u24 v130, v106, 40, s69
    v_or_b32 v98, v98, v194
    v_mad_i32_i24 v131, v107, s65, v131
    v_mul_u32_u24 v194, s66, v99
    v_lshl_or_b32 v99, v131, 18, v99
    v_and_b32 v131, 0xe0, v107
    v_mad_i32_i24 v194, v131, s100, v194
    v_and_or_b32 v194, v194, s67, v144
    v_mad_u32_u24 v131, v107, 40, s69
    v_or_b32 v99, v99, v194
    s_waitcnt lgkmcnt(11)
    v_bfe_u32 v194, v112, 3, 5
    v_add_lshl_u32 v128, v194, v128, 2
    v_and_b32 v194, 3, v194
    v_mad_i32_i24 v194, v194, -3, v128
    v_cmpx_gt_u32 vcc, 792, v112
    ds_write_b32 v128, v96
    ds_write_b8 v194, v120 offset:12
    s_mov_b64 exec, -1
    s_waitcnt lgkmcnt(12)
    v_bfe_u32 v194, v113, 3, 5
    v_add_lshl_u32 v129, v194, v129, 2
    v_and_b32 v194, 3, v194
    v_mad_i32_i24 v194, v194, -3, v129
    v_cmpx_gt_u32 vcc, 792, v113
    ds_write_b32 v129, v97
    ds_write_b8 v194, v121 offset:12
    s_mov_b64 exec, -1
    s_waitcnt lgkmcnt(13)
    v_bfe_u32 v194, v114, 3, 5
    v_add_lshl_u32 v130, v194, v130, 2
    v_and_b32 v194, 3, v194
    v_mad_i32_i24 v194, v194, -3, v130
    v_cmpx_gt_u32 vcc, 792, v114
    ds_write_b32 v130, v98
    ds_write_b8 v194, v122 offset:12
    s_mov_b64 exec, -1
    s_waitcnt lgkmcnt(14)
    v_bfe_u32 v194, v115, 3, 5
    v_add_lshl_u32 v131, v194, v131, 2
    v_and_b32 v194, 3, v194
    v_mad_i32_i24 v194, v194, -3, v131
    v_cmpx_gt_u32 vcc, 792, v115
    ds_write_b32 v131, v99
    ds_write_b8 v194, v123 offset:12
    s_mov_b64 exec, -1
    s_branch L_B1
L_R4:
    s_waitcnt vmcnt(1)
    v_mul_u32_u24 v104, s64, v128
    v_mul_u32_u24 v105, s64, v129
    v_mul_u32_u24 v106, s64, v130
    v_mul_u32_u24 v107, s64, v131
    v_lshrrev_b32 v136, 29, v104
    v_lshrrev_b32 v137, 29, v105
    v_lshrrev_b32 v138, 29, v106
    v_lshrrev_b32 v139, 29, v107
    v_cmp_eq_u32 s[72:73], v136, v137
    v_cmp_eq_u32 s[76:77], v138, v139
    v_cmp_eq_u32 vcc, v136, v138
    v_cmp_eq_u32 s[88:89], v137, v139
    v_cmp_eq_u32 s[90:91], v136, v139
    v_cmp_eq_u32 s[10:11], v137, v138
    v_lshrrev_b32 v104, 24, v104
    v_lshrrev_b32 v105, 24, v105
    v_lshrrev_b32 v106, 24, v106
    v_lshrrev_b32 v107, 24, v107
    s_or_b64 s[74:75], s[72:73], s[88:89]
    s_or_b64 s[78:79], s[76:77], s[88:89]
    s_or_b64 s[72:73], s[72:73], vcc
    s_or_b64 s[76:77], s[76:77], vcc
    s_or_b64 s[72:73], s[72:73], s[90:91]
    s_or_b64 s[74:75], s[74:75], s[10:11]
    s_or_b64 s[76:77], s[76:77], s[10:11]
    s_or_b64 s[78:79], s[78:79], s[90:91]
    v_cndmask_b32 v136, 0, v146, s[72:73]
    v_lshl_add_u32 v136, v104, 2, v136
    ds_add_rtn_u32 v112, v136, v184 offset:5120
    v_cndmask_b32 v137, 0, v146, s[74:75]
    v_lshl_add_u32 v137, v105, 2, v137
    ds_add_rtn_u32 v113, v137, v184 offset:5120
    v_cndmask_b32 v138, 0, v146, s[76:77]
    v_lshl_add_u32 v138, v106, 2, v138
    ds_add_rtn_u32 v114, v138, v184 offset:5120
    v_cndmask_b32 v139, 0, v146, s[78:79]
    v_lshl_add_u32 v139, v107, 2, v139
    ds_add_rtn_u32 v115, v139, v184 offset:5120
    s_waitcnt vmcnt(0)
    v_mad_i32_i24 v128, v104, s65, v128
    v_mul_u32_u24 v194, s66, v96
    v_lshl_or_b32 v96, v128, 18, v96
    v_and_b32 v128, 0xe0, v104
    v_mad_i32_i24 v194, v128, s100, v194
    v_and_or_b32 v194, v194, s67, v144
    v_mad_u32_u24 v128, v104, 40, s69
    v_or_b32 v96, v96, v194
    v_mad_i32_i24 v129, v105, s65, v129
    v_mul_u32_u24 v194, s66, v97
    v_lshl_or_b32 v97, v129, 18, v97
    v_and_b32 v129, 0xe0, v105
    v_mad_i32_i24 v194, v129, s100, v194
    v_and_or_b32 v194, v194, s67, v144
    v_mad_u32_u24 v129, v105, 40, s69
    v_or_b32 v97, v97, v194
    s_waitcnt lgkmcnt(3)
    s_mov_b64 exec, s[72:73]
    v_cmpx_le_u32 vcc, 132, v112
    ds_add_rtn_u32 v112, v136, v184 offset:4096
    s_waitcnt lgkmcnt(3)
    s_mov_b64 exec, s[74:75]
    v_cmpx_le_u32 vcc, 132, v113
    ds_add_rtn_u32 v113, v137, v184 offset:4096
    s_waitcnt lgkmcnt(3)
    s_mov_b64 exec, s[76:77]
    v_cmpx_le_u32 vcc, 132, v114
    ds_add_rtn_u32 v114, v138, v184 offset:4096
    s_waitcnt lgkmcnt(3)
    s_mov_b64 exec, s[78:79]
    v_cmpx_le_u32 vcc, 132, v115
    ds_add_rtn_u32 v115, v139, v184 offset:4096
    s_mov_b64 exec, -1
    v_mad_i32_i24 v130, v106, s65, v130
    v_mul_u32_u24 v194, s66, v98
    v_lshl_or_b32 v98, v130, 18, v98
    v_and_b32 v130, 0xe0, v106
    v_mad_i32_i24 v194, v130, s100, v194
    v_and_or_b32 v194, v194, s67, v144
    v_mad_u32_u24 v130, v106, 40, s69
    v_or_b32 v98, v98, v194
    v_mad_i32_i24 v131, v107, s65, v131
    v_mul_u32_u24 v194, s66, v99
    v_lshl_or_b32 v99, v131, 18, v99
    v_and_b32 v131, 0xe0, v107
    v_mad_i32_i24 v194, v131, s100, v194
    v_and_or_b32 v194, v194, s67, v144
    v_mad_u32_u24 v131, v107, 40, s69
    v_or_b32 v99, v99, v194
    s_waitcnt lgkmcnt(3)
    v_bfe_u32 v194, v112, 3, 5
    v_add_lshl_u32 v128, v194, v128, 2
    v_and_b32 v194, 3, v194
    v_mad_i32_i24 v194, v194, -3, v128
    v_cmpx_gt_u32 vcc, 792, v112
    ds_write_b32 v128, v96
    ds_write_b8 v194, v120 offset:12
    s_mov_b64 exec, -1
    s_waitcnt lgkmcnt(4)
    v_bfe_u32 v194, v113, 3, 5
    v_add_lshl_u32 v129, v194, v129, 2
    v_and_b32 v194, 3, v194
    v_mad_i32_i24 v194, v194, -3, v129
    v_cmpx_gt_u32 vcc, 792, v113
    ds_write_b32 v129, v97
    ds_write_b8 v194, v121 offset:12
    s_mov_b64 exec, -1
    s_waitcnt lgkmcnt(5)
    v_bfe_u32 v194, v114, 3, 5
    v_add_lshl_u32 v130, v194, v130, 2
    v_and_b32 v194, 3, v194
    v_mad_i32_i24 v194, v194, -3, v130
    v_cmpx_gt_u32 vcc, 792, v114
    ds_write_b32 v130, v98
    ds_write_b8 v194, v122 offset:12
    s_mov_b64 exec, -1
    s_waitcnt lgkmcnt(6)
    v_bfe_u32 v194, v115, 3, 5
    v_add_lshl_u32 v131, v194, v131, 2
    v_and_b32 v194, 3, v194
    v_mad_i32_i24 v194, v194, -3, v131
    v_cmpx_gt_u32 vcc, 792, v115
    ds_write_b32 v131, v99
    ds_write_b8 v194, v123 offset:12
    s_mov_b64 exec, -1
L_B1:
    s_cmp_ge_u32 s3, 2
    s_cbranch_scc1 L_NOC
    global_load_dwordx4 v[176:179], v232, s[28:29]
L_NOC:
    global_load_dwordx4 v[160:163], v232, s[26:27]
    global_load_dwordx4 v[164:167], v232, s[32:33]
    global_load_dwordx4 v[168:171], v232, s[24:25]
    global_load_dwordx4 v[172:175], v232, s[30:31]
    s_add_u32 s6, s6, 0x2020202
    v_lshlrev_b32 v186, v246, s6
    v_and_b32 v189, 4, v247
    v_mul_u32_u24 v189, 1212416, v189
    v_lshl_add_u32 v186, v189, 8, v186
    v_and_b32 v186, 0xfe000000, v186
    v_and_b32 v187, 7, v247
    v_mul_u32_u24 v187, 33, v187
    v_add_u32 v187, 792, v187
    v_lshlrev_b32 v222, 2, v223
    s_mov_b32 s64, 0x1000000
    s_waitcnt lgkmcnt(0)
    s_barrier
    ds_read_b128 v[192:195], v185 offset:5120
    ds_read_b32 v228, v222 offset:5120
    ds_read_b128 v[204:207], v221 offset:0
    ds_read_b32 v229, v222 offset:5376
    ds_read_b128 v[208:211], v221 offset:10240
    ds_read_b32 v230, v222 offset:5632
    ds_read_b128 v[212:215], v221 offset:20480
    ds_read_b32 v231, v222 offset:5888
    ds_read_b128 v[216:219], v221 offset:30720
    s_mov_b32 s80, 2105344
    s_mov_b32 s81, 4210688
    s_mov_b32 s82, 6316032
    s_waitcnt lgkmcnt(8)
    v_max3_u32 v188, v192, v193, v194
    v_max_u32 v188, v188, v195
    v_cmp_lt_u32 vcc, 1056, v188
    s_cbranch_vccnz L_POVF
L_POUT:
    s_waitcnt lgkmcnt(7)
    v_sub_u32 v228, v187, v228
    v_and_or_b32 v228, v228, s64, v186
    s_waitcnt lgkmcnt(6)
    v_or_b32 v207, v207, v228
    buffer_store_dwordx4 v[204:207], v220, s[56:59], 0 offen sc1
    s_waitcnt lgkmcnt(5)
    v_sub_u32 v229, v187, v229
    v_and_or_b32 v229, v229, s64, v186
    s_waitcnt lgkmcnt(4)
    v_or_b32 v211, v211, v229
    buffer_store_dwordx4 v[208:211], v220, s[56:59], s80 offen sc1
    s_waitcnt lgkmcnt(3)
    v_sub_u32 v230, v187, v230
    v_and_or_b32 v230, v230, s64, v186
    s_waitcnt lgkmcnt(2)
    v_or_b32 v215, v215, v230
    buffer_store_dwordx4 v[212:215], v220, s[56:59], s81 offen sc1
    s_waitcnt lgkmcnt(1)
    v_sub_u32 v231, v187, v231
    v_and_or_b32 v231, v231, s64, v186
    s_waitcnt lgkmcnt(0)
    v_or_b32 v219, v219, v231
    buffer_store_dwordx4 v[216:219], v220, s[56:59], s82 offen sc1
    s_mov_b32 s10, 0xbfb8aa3b
    s_mov_b32 s11, s10
    s_mov_b32 s64, 0x05040100
    s_mov_b32 s66, 0x07060302
    s_waitcnt vmcnt(4)
    v_perm_b32 v144, v170, v168, s64
    v_perm_b32 v145, v170, v168, s66
    v_perm_b32 v146, v171, v169, s64
    v_perm_b32 v147, v171, v169, s66
    v_add_u32 v148, 77824, v224
    ds_write2_b32 v148, v144, v145 offset0:0 offset1:8
    ds_write2_b32 v148, v146, v147 offset0:16 offset1:24
    v_lshlrev_b32 v128, 16, v160
    v_and_b32 v129, 0xffff0000, v160
    v_lshlrev_b32 v130, 16, v161
    v_and_b32 v131, 0xffff0000, v161
    v_lshlrev_b32 v132, 16, v162
    v_and_b32 v133, 0xffff0000, v162
    v_lshlrev_b32 v134, 16, v163
    v_and_b32 v135, 0xffff0000, v163
    v_pk_mul_f32 v[128:129], v[128:129], s[10:11]
    v_pk_mul_f32 v[130:131], v[130:131], s[10:11]
    v_pk_mul_f32 v[132:133], v[132:133], s[10:11]
    v_pk_mul_f32 v[134:135], v[134:135], s[10:11]
    v_cvt_pk_bf16_f32 v136, v128, v132
    v_cvt_pk_bf16_f32 v137, v129, v133
    v_cvt_pk_bf16_f32 v138, v130, v134
    v_cvt_pk_bf16_f32 v139, v131, v135
    ds_write2_b32 v224, v136, v137 offset0:0 offset1:8
    ds_write2_b32 v224, v138, v139 offset0:16 offset1:24
    v_perm_b32 v152, v166, v164, s64
    v_perm_b32 v153, v166, v164, s66
    v_perm_b32 v154, v167, v165, s64
    v_perm_b32 v155, v167, v165, s66
    v_add_u32 v156, 10240, v224
    ds_write2_b32 v156, v152, v153 offset0:0 offset1:8
    ds_write2_b32 v156, v154, v155 offset0:16 offset1:24
    v_perm_b32 v144, v174, v172, s64
    v_perm_b32 v145, v174, v172, s66
    v_perm_b32 v146, v175, v173, s64
    v_perm_b32 v147, v175, v173, s66
    v_add_u32 v148, 130176, v224
    ds_write2_b32 v148, v144, v145 offset0:0 offset1:8
    ds_write2_b32 v148, v146, v147 offset0:16 offset1:24
    s_cmp_ge_u32 s3, 2
    s_cbranch_scc1 L_NOWC
    v_lshlrev_b32 v128, 16, v176
    v_and_b32 v129, 0xffff0000, v176
    v_lshlrev_b32 v130, 16, v177
    v_and_b32 v131, 0xffff0000, v177
    v_lshlrev_b32 v132, 16, v178
    v_and_b32 v133, 0xffff0000, v178
    v_lshlrev_b32 v134, 16, v179
    v_and_b32 v135, 0xffff0000, v179
    v_pk_mul_f32 v[128:129], v[128:129], s[10:11]
    v_pk_mul_f32 v[130:131], v[130:131], s[10:11]
    v_pk_mul_f32 v[132:133], v[132:133], s[10:11]
    v_pk_mul_f32 v[134:135], v[134:135], s[10:11]
    v_cvt_pk_bf16_f32 v136, v128, v132
    v_cvt_pk_bf16_f32 v137, v129, v133
    v_cvt_pk_bf16_f32 v138, v130, v134
    v_cvt_pk_bf16_f32 v139, v131, v135
    v_add_u32 v140, 20480, v224
    ds_write2_b32 v140, v136, v137 offset0:0 offset1:8
    ds_write2_b32 v140, v138, v139 offset0:16 offset1:24
L_NOWC:
    s_mul_i32 s34, s5, 32896
    s_add_u32 s34, s34, 65536
    s_add_u32 s56, s38, s34
    s_addc_u32 s57, s39, 0
    s_mov_b32 s58, 32768
    s_mov_b32 s59, 0x20000
    s_add_u32 s34, s34, 8421376
    s_add_u32 s60, s38, s34
    s_addc_u32 s61, s39, 0
    s_mov_b32 s62, 32768
    s_mov_b32 s63, 0x20000
    s_movk_i32 s26, 0
    s_movk_i32 s27, 8192
    s_movk_i32 s28, 16384
    s_movk_i32 s29, 24576
    s_waitcnt lgkmcnt(0)
    s_barrier
    v_add_u32 v225, 13312, v225
    ds_read_b64_tr_b16 v[0:1], v225 offset:0
    ds_read_b64_tr_b16 v[2:3], v225 offset:1280
    ds_read_b64_tr_b16 v[4:5], v225 offset:5120
    ds_read_b64_tr_b16 v[6:7], v225 offset:6400
    ds_read_b64_tr_b16 v[8:9], v225 offset:32
    ds_read_b64_tr_b16 v[10:11], v225 offset:1312
    ds_read_b64_tr_b16 v[12:13], v225 offset:5152
    ds_read_b64_tr_b16 v[14:15], v225 offset:6432
    ds_read_b64_tr_b16 v[16:17], v225 offset:64
    ds_read_b64_tr_b16 v[18:19], v225 offset:1344
    ds_read_b64_tr_b16 v[20:21], v225 offset:5184
    ds_read_b64_tr_b16 v[22:23], v225 offset:6464
    ds_read_b64_tr_b16 v[24:25], v225 offset:96
    ds_read_b64_tr_b16 v[26:27], v225 offset:1376
    v_mov_b32 v64, 0x2000000
    v_mov_b32 v65, 0x2000000
    v_mov_b32 v66, 0x2000000
    v_mov_b32 v67, 0x2000000
    v_mov_b32 v68, 0xfffff
    v_mov_b32 v69, 0xfffff
    v_mov_b32 v70, 0xfffff
    v_mov_b32 v71, 0xfffff
    v_lshl_add_u32 v72, v247, 4, s12
    ds_write_b128 v72, v[64:67] offset:0
    ds_write_b128 v72, v[68:71] offset:18432
    ds_write_b128 v72, v[64:67] offset:1024
    ds_write_b128 v72, v[68:71] offset:19456
    ds_write_b128 v72, v[64:67] offset:1280
    ds_write_b128 v72, v[68:71] offset:19712
    ds_read_b64_tr_b16 v[28:29], v225 offset:5216
    ds_read_b64_tr_b16 v[30:31], v225 offset:6496
    ds_read_b64_tr_b16 v[32:33], v225 offset:10240
    ds_read_b64_tr_b16 v[34:35], v225 offset:11520
    ds_read_b64_tr_b16 v[36:37], v225 offset:15360
    ds_read_b64_tr_b16 v[38:39], v225 offset:16640
    ds_read_b64_tr_b16 v[40:41], v225 offset:10272
    ds_read_b64_tr_b16 v[42:43], v225 offset:11552
    ds_read_b64_tr_b16 v[44:45], v225 offset:15392
    ds_read_b64_tr_b16 v[46:47], v225 offset:16672
    v_mov_b32 v192, v225
    s_mov_b32 exec_lo, 0
    v_subrev_u32 v192, 2560, v225
    s_mov_b32 exec_lo, -1
    s_waitcnt lgkmcnt(4)
    ds_read_b64_tr_b16 v[48:49], v225 offset:10304
    ds_read_b64_tr_b16 v[50:51], v225 offset:11584
    ds_read_b64_tr_b16 v[52:53], v225 offset:15424
    ds_read_b64_tr_b16 v[54:55], v225 offset:16704
    ds_read_b64_tr_b16 v[56:57], v225 offset:10336
    ds_read_b64_tr_b16 v[58:59], v225 offset:11616
    ds_read_b64_tr_b16 v[60:61], v225 offset:15456
    ds_read_b64_tr_b16 v[62:63], v225 offset:16736
    ds_read_b64_tr_b16 v[80:81], v192 offset:20480
    ds_read_b64_tr_b16 v[82:83], v192 offset:21760
    ds_read_b64_tr_b16 v[84:85], v192 offset:20512
    ds_read_b64_tr_b16 v[86:87], v192 offset:21792
    ds_read_b64_tr_b16 v[88:89], v192 offset:20544
    ds_read_b64_tr_b16 v[90:91], v192 offset:21824
    ds_read_b64_tr_b16 v[92:93], v192 offset:20576
    ds_read_b64_tr_b16 v[94:95], v192 offset:21856
    v_add_u32 v225, 77824, v225
    v_and_b32 v241, 1, v247
    v_lshlrev_b32 v241, 4, v241
    v_mov_b32 v242, 0x3f80
    v_and_b32 v245, 16, v247
    v_and_b32 v194, 15, v247
    v_lshl_add_u32 v194, v194, 5, s14
    s_mov_b32 exec_hi, 0
    v_add_u32 v245, v245, v194
    s_mov_b32 exec_hi, -1
    v_and_b32 v194, 3, v247
    v_bfe_u32 v196, v247, 2, 2
    v_and_b32 v197, 48, v247
    v_lshl_add_u32 v198, v196, 7, v197
    v_mul_u32_u24 v244, 1056, v194
    v_add3_u32 v244, v244, v198, s13
    v_lshrrev_b32 v194, 3, v247
    v_lshl_add_u32 v248, v194, 4, s12
    s_add_u32 s10, s12, 18432
    v_lshrrev_b32 v194, 1, v247
    v_lshl_add_u32 v249, v194, 2, s10
    s_add_u32 s10, s10, 2
    v_lshrrev_b32 v194, 5, v247
    v_mul_i32_i24 v250, 0xffffb800, v194
    v_and_b32 v194, 15, v247
    v_lshl_add_u32 v250, v194, 2, v250
    v_add_u32 v250, s10, v250
    s_add_u32 s10, s12, 2
    v_and_b32 v194, 48, v247
    v_lshl_add_u32 v251, v194, 1, s10
    v_and_b32 v194, 12, v247
    v_add_u32 v251, v251, v194
    v_mul_u32_u24 v159, 3128, v223
    v_add_u32 v156, 0, v159
    v_add_u32 v157, 200192, v159
    v_add_u32 v158, 400384, v159
    v_add_u32 v159, 600576, v159
    s_mov_b32 s98, 0xf0f0f0f
    s_mov_b32 s99, 0xf0f0f0f
    v_mov_b32 v180, 0xfffff
    v_mov_b32 v176, 0
    v_add_lshl_u32 v191, v232, v243, 16
    v_add_u32 v152, 0x34000000, v191
    v_cndmask_b32 v152, 0, v152, s[98:99]
    v_add_u32 v153, 0x54000000, v191
    v_cndmask_b32 v153, 0, v153, s[98:99]
    v_add_u32 v154, 0x74000000, v191
    v_cndmask_b32 v154, 0, v154, s[98:99]
    v_add_u32 v155, 0x94000000, v191
    v_cndmask_b32 v155, 0, v155, s[98:99]
    v_mov_b32 v184, 4
    v_and_b32 v177, 31, v247
    v_add_lshl_u32 v179, v177, s7, 2
    v_lshrrev_b32 v191, 5, v247
    v_lshl_add_u32 v178, v191, 11, v179
    v_add_u32 v179, 153728, v179
    v_lshlrev_b32 v191, 2, v247
    v_subrev_u32 v191, s7, v191
    s_mov_b32 s10, 0x10000
    v_add_u32 v228, 0, v191
    v_and_or_b32 v228, v228, s10, 1
    v_add_u32 v229, 1, v191
    v_and_or_b32 v229, v229, s10, 1
    v_add_u32 v230, 2, v191
    v_and_or_b32 v230, v230, s10, 1
    v_add_u32 v231, 3, v191
    v_and_or_b32 v231, v231, s10, 1
    s_movk_i32 s18, 0xffc
    s_movk_i32 s20, 32
    s_mov_b32 s21, 0
    s_mov_b32 s100, 0
    s_mov_b32 s16, 0x1ffffff
    s_mov_b32 s17, 0xffff
    s_mul_i32 s10, s4, 49
    s_sub_i32 s22, s10, 6
    s_ashr_i32 s22, s22, 1
    s_add_i32 s23, s10, 7
    s_ashr_i32 s23, s23, 1
    s_add_i32 s24, s10, 43
    s_ashr_i32 s24, s24, 1
    s_add_i32 s25, s22, 31
    s_cmp_eq_u32 s4, 7
    s_cselect_b32 s24, 196, s24
    s_cselect_b32 s25, 196, s25
    s_sub_i32 s23, s23, s7
    s_sub_i32 s24, s24, s7
    s_sub_i32 s25, s25, s7
    s_waitcnt vmcnt(0)
    buffer_load_dwordx4 v[128:131], v232, s[56:59], s26 offen sc1
    buffer_load_dwordx4 v[132:135], v232, s[56:59], s27 offen sc1
    buffer_load_dwordx4 v[136:139], v232, s[56:59], s28 offen sc1
    buffer_load_dwordx4 v[140:143], v232, s[56:59], s29 offen sc1
    v_max3_u32 v188, v112, v113, v114
    v_max3_u32 v189, v115, v116, v117
    v_max3_u32 v188, v188, v118, v119
    v_max_u32 v188, v188, v189
    v_cmp_le_u32 vcc, 792, v188
    s_cbranch_vccz L_PEXTR
    v_mov_b32 v65, s6
    s_lshl_b32 s34, s2, 7
    s_add_u32 s34, s34, 8486912
    v_subrev_u32 v68, 792, v112
    v_cmpx_gt_u32 vcc, 264, v68
    s_cbranch_execz L_PE0
    v_mov_b32 v64, v96
    v_mov_b32 v66, v120
    v_bfe_u32 v68, v112, 5, 3
    v_lshlrev_b32 v68, 4, v68
    v_mad_u32_u24 v68, v104, s68, v68
    buffer_store_dwordx4 v[64:67], v68, s[52:55], s34 offen sc1
L_PE0:
    s_mov_b64 exec, -1
    v_subrev_u32 v68, 792, v113
    v_cmpx_gt_u32 vcc, 264, v68
    s_cbranch_execz L_PE1
    v_mov_b32 v64, v97
    v_mov_b32 v66, v121
    v_bfe_u32 v68, v113, 5, 3
    v_lshlrev_b32 v68, 4, v68
    v_mad_u32_u24 v68, v105, s68, v68
    buffer_store_dwordx4 v[64:67], v68, s[52:55], s34 offen sc1
L_PE1:
    s_mov_b64 exec, -1
    v_subrev_u32 v68, 792, v114
    v_cmpx_gt_u32 vcc, 264, v68
    s_cbranch_execz L_PE2
    v_mov_b32 v64, v98
    v_mov_b32 v66, v122
    v_bfe_u32 v68, v114, 5, 3
    v_lshlrev_b32 v68, 4, v68
    v_mad_u32_u24 v68, v106, s68, v68
    buffer_store_dwordx4 v[64:67], v68, s[52:55], s34 offen sc1
L_PE2:
    s_mov_b64 exec, -1
    v_subrev_u32 v68, 792, v115
    v_cmpx_gt_u32 vcc, 264, v68
    s_cbranch_execz L_PE3
    v_mov_b32 v64, v99
    v_mov_b32 v66, v123
    v_bfe_u32 v68, v115, 5, 3
    v_lshlrev_b32 v68, 4, v68
    v_mad_u32_u24 v68, v107, s68, v68
    buffer_store_dwordx4 v[64:67], v68, s[52:55], s34 offen sc1
L_PE3:
    s_mov_b64 exec, -1
    v_subrev_u32 v68, 792, v116
    v_cmpx_gt_u32 vcc, 264, v68
    s_cbranch_execz L_PE4
    v_mov_b32 v64, v100
    v_mov_b32 v66, v120
    v_bfe_u32 v68, v116, 5, 3
    v_lshlrev_b32 v68, 4, v68
    v_mad_u32_u24 v68, v108, s68, v68
    buffer_store_dwordx4 v[64:67], v68, s[52:55], s34 offen sc1
L_PE4:
    s_mov_b64 exec, -1
    v_subrev_u32 v68, 792, v117
    v_cmpx_gt_u32 vcc, 264, v68
    s_cbranch_execz L_PE5
    v_mov_b32 v64, v101
    v_mov_b32 v66, v121
    v_bfe_u32 v68, v117, 5, 3
    v_lshlrev_b32 v68, 4, v68
    v_mad_u32_u24 v68, v109, s68, v68
    buffer_store_dwordx4 v[64:67], v68, s[52:55], s34 offen sc1
L_PE5:
    s_mov_b64 exec, -1
    v_subrev_u32 v68, 792, v118
    v_cmpx_gt_u32 vcc, 264, v68
    s_cbranch_execz L_PE6
    v_mov_b32 v64, v102
    v_mov_b32 v66, v122
    v_bfe_u32 v68, v118, 5, 3
    v_lshlrev_b32 v68, 4, v68
    v_mad_u32_u24 v68, v110, s68, v68
    buffer_store_dwordx4 v[64:67], v68, s[52:55], s34 offen sc1
L_PE6:
    s_mov_b64 exec, -1
    v_subrev_u32 v68, 792, v119
    v_cmpx_gt_u32 vcc, 264, v68
    s_cbranch_execz L_PE7
    v_mov_b32 v64, v103
    v_mov_b32 v66, v123
    v_bfe_u32 v68, v119, 5, 3
    v_lshlrev_b32 v68, 4, v68
    v_mad_u32_u24 v68, v111, s68, v68
    buffer_store_dwordx4 v[64:67], v68, s[52:55], s34 offen sc1
L_PE7:
    s_mov_b64 exec, -1
L_PEXTR:
L_PW0:
    s_waitcnt vmcnt(3)
    v_xor_b32 v188, v131, v186
    v_and_b32_sdwa v96, v128, s18 dst_sel:DWORD dst_unused:UNUSED_PAD src0_sel:WORD_1 src1_sel:DWORD
    v_and_b32_sdwa v97, v129, s18 dst_sel:DWORD dst_unused:UNUSED_PAD src0_sel:WORD_1 src1_sel:DWORD
    v_and_b32_sdwa v98, v130, s18 dst_sel:DWORD dst_unused:UNUSED_PAD src0_sel:WORD_1 src1_sel:DWORD
    v_cmp_lt_u32 vcc, s16, v188
    v_cmp_ne_u32 s[64:65], 0, v128
    v_cmp_ne_u32 s[66:67], 0, v129
    v_cmp_ne_u32 s[68:69], 0, v130
    s_cbranch_vccnz L_RT0
    s_mov_b64 exec, s[64:65]
    ds_add_rtn_u32 v112, v96, v184 offset:1024
    s_mov_b64 exec, s[66:67]
    ds_add_rtn_u32 v113, v97, v184 offset:1024
    s_mov_b64 exec, s[68:69]
    ds_add_rtn_u32 v114, v98, v184 offset:1024
    s_mov_b64 exec, -1
    v_or_b32 v176, v176, v129
    v_add_u32_sdwa v204, v131, v156 dst_sel:DWORD dst_unused:UNUSED_PAD src0_sel:BYTE_0 src1_sel:DWORD
    v_lshrrev_b32 v189, 28, v128
    v_lshl_add_u32 v204, v189, 8, v204
    v_and_b32 v189, 60, v96
    v_and_b32 v128, 0xffff, v128
    v_lshl_or_b32 v128, v189, 19, v128
    v_cndmask_b32 v188, v180, v204, s[64:65]
    v_max_u32 v204, v204, v152
    v_add_u32_sdwa v205, v131, v156 dst_sel:DWORD dst_unused:UNUSED_PAD src0_sel:BYTE_1 src1_sel:DWORD
    v_lshrrev_b32 v189, 28, v129
    v_lshl_add_u32 v205, v189, 8, v205
    v_and_b32 v189, 60, v97
    v_and_b32 v129, 0xffff, v129
    v_lshl_or_b32 v129, v189, 19, v129
    v_mov_b32_dpp v190, v188 quad_perm:[2,2,3,3] row_mask:0xf bank_mask:0xf
    v_mov_b32_dpp v207, v188 quad_perm:[0,0,1,1] row_mask:0xf bank_mask:0xf
    v_add_u32_sdwa v206, v131, v156 dst_sel:DWORD dst_unused:UNUSED_PAD src0_sel:BYTE_2 src1_sel:DWORD
    v_lshrrev_b32 v189, 28, v130
    v_lshl_add_u32 v206, v189, 8, v206
    v_and_b32 v189, 60, v98
    v_and_b32 v130, 0xffff, v130
    v_lshl_or_b32 v130, v189, 19, v130
    v_mov_b32_dpp v207, v190 row_shr:4 row_mask:0xf bank_mask:0xa
L_PW1:
    s_waitcnt vmcnt(2)
    v_xor_b32 v188, v135, v186
    v_and_b32_sdwa v100, v132, s18 dst_sel:DWORD dst_unused:UNUSED_PAD src0_sel:WORD_1 src1_sel:DWORD
    v_and_b32_sdwa v101, v133, s18 dst_sel:DWORD dst_unused:UNUSED_PAD src0_sel:WORD_1 src1_sel:DWORD
    v_and_b32_sdwa v102, v134, s18 dst_sel:DWORD dst_unused:UNUSED_PAD src0_sel:WORD_1 src1_sel:DWORD
    v_cmp_lt_u32 vcc, s16, v188
    v_cmp_ne_u32 s[72:73], 0, v132
    v_cmp_ne_u32 s[74:75], 0, v133
    v_cmp_ne_u32 s[76:77], 0, v134
    s_cbranch_vccnz L_RT1
    s_mov_b64 exec, s[72:73]
    ds_add_rtn_u32 v116, v100, v184 offset:1024
    s_mov_b64 exec, s[74:75]
    ds_add_rtn_u32 v117, v101, v184 offset:1024
    s_mov_b64 exec, s[76:77]
    ds_add_rtn_u32 v118, v102, v184 offset:1024
    s_mov_b64 exec, -1
    v_or_b32 v176, v176, v133
    v_add_u32_sdwa v208, v135, v157 dst_sel:DWORD dst_unused:UNUSED_PAD src0_sel:BYTE_0 src1_sel:DWORD
    v_lshrrev_b32 v189, 28, v132
    v_lshl_add_u32 v208, v189, 8, v208
    v_and_b32 v189, 60, v100
    v_and_b32 v132, 0xffff, v132
    v_lshl_or_b32 v132, v189, 19, v132
    v_cndmask_b32 v188, v180, v208, s[72:73]
    v_max_u32 v208, v208, v153
    v_add_u32_sdwa v209, v135, v157 dst_sel:DWORD dst_unused:UNUSED_PAD src0_sel:BYTE_1 src1_sel:DWORD
    v_lshrrev_b32 v189, 28, v133
    v_lshl_add_u32 v209, v189, 8, v209
    v_and_b32 v189, 60, v101
    v_and_b32 v133, 0xffff, v133
    v_lshl_or_b32 v133, v189, 19, v133
    v_mov_b32_dpp v190, v188 quad_perm:[2,2,3,3] row_mask:0xf bank_mask:0xf
    v_mov_b32_dpp v211, v188 quad_perm:[0,0,1,1] row_mask:0xf bank_mask:0xf
    v_add_u32_sdwa v210, v135, v157 dst_sel:DWORD dst_unused:UNUSED_PAD src0_sel:BYTE_2 src1_sel:DWORD
    v_lshrrev_b32 v189, 28, v134
    v_lshl_add_u32 v210, v189, 8, v210
    v_and_b32 v189, 60, v102
    v_and_b32 v134, 0xffff, v134
    v_lshl_or_b32 v134, v189, 19, v134
    v_mov_b32_dpp v211, v190 row_shr:4 row_mask:0xf bank_mask:0xa
L_PW2:
    s_waitcnt vmcnt(1)
    v_xor_b32 v188, v139, v186
    v_and_b32_sdwa v104, v136, s18 dst_sel:DWORD dst_unused:UNUSED_PAD src0_sel:WORD_1 src1_sel:DWORD
    v_and_b32_sdwa v105, v137, s18 dst_sel:DWORD dst_unused:UNUSED_PAD src0_sel:WORD_1 src1_sel:DWORD
    v_and_b32_sdwa v106, v138, s18 dst_sel:DWORD dst_unused:UNUSED_PAD src0_sel:WORD_1 src1_sel:DWORD
    v_cmp_lt_u32 vcc, s16, v188
    v_cmp_ne_u32 s[80:81], 0, v136
    v_cmp_ne_u32 s[82:83], 0, v137
    v_cmp_ne_u32 s[84:85], 0, v138
    s_cbranch_vccnz L_RT2
    s_mov_b64 exec, s[80:81]
    ds_add_rtn_u32 v120, v104, v184 offset:1024
    s_mov_b64 exec, s[82:83]
    ds_add_rtn_u32 v121, v105, v184 offset:1024
    s_mov_b64 exec, s[84:85]
    ds_add_rtn_u32 v122, v106, v184 offset:1024
    s_mov_b64 exec, -1
    v_or_b32 v176, v176, v137
    v_add_u32_sdwa v212, v139, v158 dst_sel:DWORD dst_unused:UNUSED_PAD src0_sel:BYTE_0 src1_sel:DWORD
    v_lshrrev_b32 v189, 28, v136
    v_lshl_add_u32 v212, v189, 8, v212
    v_and_b32 v189, 60, v104
    v_and_b32 v136, 0xffff, v136
    v_lshl_or_b32 v136, v189, 19, v136
    v_cndmask_b32 v188, v180, v212, s[80:81]
    v_max_u32 v212, v212, v154
    v_add_u32_sdwa v213, v139, v158 dst_sel:DWORD dst_unused:UNUSED_PAD src0_sel:BYTE_1 src1_sel:DWORD
    v_lshrrev_b32 v189, 28, v137
    v_lshl_add_u32 v213, v189, 8, v213
    v_and_b32 v189, 60, v105
    v_and_b32 v137, 0xffff, v137
    v_lshl_or_b32 v137, v189, 19, v137
    v_mov_b32_dpp v190, v188 quad_perm:[2,2,3,3] row_mask:0xf bank_mask:0xf
    v_mov_b32_dpp v215, v188 quad_perm:[0,0,1,1] row_mask:0xf bank_mask:0xf
    v_add_u32_sdwa v214, v139, v158 dst_sel:DWORD dst_unused:UNUSED_PAD src0_sel:BYTE_2 src1_sel:DWORD
    v_lshrrev_b32 v189, 28, v138
    v_lshl_add_u32 v214, v189, 8, v214
    v_and_b32 v189, 60, v106
    v_and_b32 v138, 0xffff, v138
    v_lshl_or_b32 v138, v189, 19, v138
    v_mov_b32_dpp v215, v190 row_shr:4 row_mask:0xf bank_mask:0xa
L_PW3:
    s_waitcnt vmcnt(0)
    v_xor_b32 v188, v143, v186
    v_and_b32_sdwa v108, v140, s18 dst_sel:DWORD dst_unused:UNUSED_PAD src0_sel:WORD_1 src1_sel:DWORD
    v_and_b32_sdwa v109, v141, s18 dst_sel:DWORD dst_unused:UNUSED_PAD src0_sel:WORD_1 src1_sel:DWORD
    v_and_b32_sdwa v110, v142, s18 dst_sel:DWORD dst_unused:UNUSED_PAD src0_sel:WORD_1 src1_sel:DWORD
    v_cmp_lt_u32 vcc, s16, v188
    v_cmp_ne_u32 s[88:89], 0, v140
    v_cmp_ne_u32 s[90:91], 0, v141
    v_cmp_ne_u32 s[92:93], 0, v142
    s_cbranch_vccnz L_RT3
    s_mov_b64 exec, s[88:89]
    ds_add_rtn_u32 v124, v108, v184 offset:1024
    s_mov_b64 exec, s[90:91]
    ds_add_rtn_u32 v125, v109, v184 offset:1024
    s_mov_b64 exec, s[92:93]
    ds_add_rtn_u32 v126, v110, v184 offset:1024
    s_mov_b64 exec, -1
    v_or_b32 v176, v176, v141
    v_or3_b32 v190, v131, v135, v139
    v_or_b32 v190, v190, v143
    v_and_b32 v190, 0x1000000, v190
    v_cmp_ne_u32 vcc, 0, v190
    s_cbranch_vccz L_XT1R
    v_and_b32 v190, 0x1000000, v131
    v_cmp_ne_u32 s[70:71], 0, v190
    s_bcnt1_i32_b64 s10, s[70:71]
    s_lshl2_add_u32 s21, s10, s21
    v_and_b32 v190, 0x1000000, v135
    v_cmp_ne_u32 s[78:79], 0, v190
    s_bcnt1_i32_b64 s10, s[78:79]
    s_lshl2_add_u32 s21, s10, s21
    v_and_b32 v190, 0x1000000, v139
    v_cmp_ne_u32 s[86:87], 0, v190
    s_bcnt1_i32_b64 s10, s[86:87]
    s_lshl2_add_u32 s21, s10, s21
    v_and_b32 v190, 0x1000000, v143
    v_cmp_ne_u32 s[94:95], 0, v190
    s_bcnt1_i32_b64 s10, s[94:95]
    s_lshl2_add_u32 s21, s10, s21
    s_mov_b64 exec, s[70:71]
    s_cbranch_execz L_XLa0
    s_movk_i32 s10, 0
    buffer_load_dwordx4 v[64:67], v232, s[60:63], s10 offen sc1
L_XLa0:
    s_mov_b64 exec, s[78:79]
    s_cbranch_execz L_XLa1
    s_movk_i32 s10, 8192
    buffer_load_dwordx4 v[68:71], v232, s[60:63], s10 offen sc1
L_XLa1:
    s_mov_b64 exec, s[86:87]
    s_cbranch_execz L_XLa2
    s_movk_i32 s10, 16384
    buffer_load_dwordx4 v[72:75], v232, s[60:63], s10 offen sc1
L_XLa2:
    s_mov_b64 exec, s[94:95]
    s_cbranch_execz L_XLa3
    s_movk_i32 s10, 24576
    buffer_load_dwordx4 v[76:79], v232, s[60:63], s10 offen sc1
L_XLa3:
    s_mov_b64 exec, -1
    v_and_b32 v190, 0x10000, v176
    v_mov_b32 v191, 640
    v_cmpx_ne_u32 vcc, 0, v190
    ds_write_b32 v191, v184 offset:4
    s_mov_b64 exec, 1
    v_mov_b32 v190, s21
    ds_add_u32 v191, v190 offset:8
    s_mov_b64 exec, -1
L_XT1R:
    v_add_u32_sdwa v216, v143, v159 dst_sel:DWORD dst_unused:UNUSED_PAD src0_sel:BYTE_0 src1_sel:DWORD
    v_lshrrev_b32 v189, 28, v140
    v_lshl_add_u32 v216, v189, 8, v216
    v_and_b32 v189, 60, v108
    v_and_b32 v140, 0xffff, v140
    v_lshl_or_b32 v140, v189, 19, v140
    v_cndmask_b32 v188, v180, v216, s[88:89]
    v_max_u32 v216, v216, v155
    v_add_u32_sdwa v217, v143, v159 dst_sel:DWORD dst_unused:UNUSED_PAD src0_sel:BYTE_1 src1_sel:DWORD
    v_lshrrev_b32 v189, 28, v141
    v_lshl_add_u32 v217, v189, 8, v217
    v_and_b32 v189, 60, v109
    v_and_b32 v141, 0xffff, v141
    v_lshl_or_b32 v141, v189, 19, v141
    v_mov_b32_dpp v190, v188 quad_perm:[2,2,3,3] row_mask:0xf bank_mask:0xf
    v_mov_b32_dpp v219, v188 quad_perm:[0,0,1,1] row_mask:0xf bank_mask:0xf
    v_add_u32_sdwa v218, v143, v159 dst_sel:DWORD dst_unused:UNUSED_PAD src0_sel:BYTE_2 src1_sel:DWORD
    v_lshrrev_b32 v189, 28, v142
    v_lshl_add_u32 v218, v189, 8, v218
    v_mov_b32_dpp v219, v190 row_shr:4 row_mask:0xf bank_mask:0xa
    v_mov_b32 v197, 640
    s_cmp_eq_u32 s3, 6
    s_cselect_b32 exec_hi, 0, -1
    s_cmp_eq_u32 s3, 7
    s_cselect_b64 exec, 1, exec
    s_add_u32 m0, s101, 0
    s_nop 0
    buffer_load_dwordx4 v234, s[40:43], 0 offen offset:0 lds
    s_add_u32 m0, s101, 6560
    s_nop 0
    buffer_load_dwordx4 v234, s[40:43], 0 offen offset:128 lds
    s_add_u32 m0, s101, 13120
    s_nop 0
    buffer_load_dwordx4 v234, s[40:43], 0 offen offset:256 lds
    s_add_u32 m0, s101, 19680
    s_nop 0
    buffer_load_dwordx4 v234, s[40:43], 0 offen offset:384 lds
    s_mov_b64 exec, -1
    s_waitcnt lgkmcnt(0)
    s_barrier
    ds_read_u16 v198, v178 offset:1024
    ds_read_u16 v199, v178 offset:2048
    ds_read_b128 v[160:163], v185 offset:1024
    ds_read_b128 v[164:167], v185 offset:2048
    ds_read_b128 v[168:171], v185 offset:3072
    ds_read_b128 v[172:175], v185 offset:4096
    ds_read_b32 v236, v197 offset:8
    s_lshl_b32 m0, s3, 10
    v_mov_b32 v240, v207
    s_add_u32 m0, m0, 13312
    s_nop 0
    buffer_load_dwordx4 v[240:241], s[44:47], 0 idxen offen lds
    s_cmp_lg_u32 s2, 0
    s_cbranch_scc1 L_NOK
    v_mov_b32 v237, s6
    v_mov_b32 v238, 0
    buffer_store_dword v237, v238, s[52:55], 0 offen sc1
L_NOK:
    s_waitcnt lgkmcnt(5)
    v_lshl_or_b32 v198, v199, 16, v198
    v_mov_b32 v199, v198
    s_waitcnt lgkmcnt(0)
    v_add_u32_sdwa v188, v160, v164 dst_sel:DWORD dst_unused:UNUSED_PAD src0_sel:WORD_0 src1_sel:WORD_0
    v_add_u32_sdwa v192, v168, v172 dst_sel:DWORD dst_unused:UNUSED_PAD src0_sel:WORD_0 src1_sel:WORD_0
    v_add_u32_dpp v199, v199, v199 row_shr:1 row_mask:0xf bank_mask:0xf bound_ctrl:0
    v_add_u32_sdwa v189, v161, v165 dst_sel:DWORD dst_unused:UNUSED_PAD src0_sel:WORD_0 src1_sel:WORD_0
    v_add_u32_sdwa v193, v169, v173 dst_sel:DWORD dst_unused:UNUSED_PAD src0_sel:WORD_0 src1_sel:WORD_0
    v_add_u32_dpp v199, v199, v199 row_shr:2 row_mask:0xf bank_mask:0xf bound_ctrl:0
    v_add_u32_sdwa v190, v162, v166 dst_sel:DWORD dst_unused:UNUSED_PAD src0_sel:WORD_0 src1_sel:WORD_0
    v_add_u32_sdwa v194, v170, v174 dst_sel:DWORD dst_unused:UNUSED_PAD src0_sel:WORD_0 src1_sel:WORD_0
    v_add_u32_dpp v199, v199, v199 row_shr:4 row_mask:0xf bank_mask:0xf bound_ctrl:0
    v_add_u32_sdwa v191, v163, v167 dst_sel:DWORD dst_unused:UNUSED_PAD src0_sel:WORD_0 src1_sel:WORD_0
    v_add_u32_sdwa v195, v171, v175 dst_sel:DWORD dst_unused:UNUSED_PAD src0_sel:WORD_0 src1_sel:WORD_0
    v_add_u32_dpp v199, v199, v199 row_shr:8 row_mask:0xf bank_mask:0xf bound_ctrl:0
    v_add_u32 v188, v188, v192
    v_add_u32 v189, v189, v193
    v_add_u32_dpp v199, v199, v199 row_bcast:15 row_mask:0xa bank_mask:0xf
    v_add_u32 v190, v190, v194
    v_add_u32 v191, v191, v195
    v_mul_u32_u24 v196, v188, v228
    v_mad_u32_u24 v196, v189, v229, v196
    v_mad_u32_u24 v196, v190, v230, v196
    v_mad_u32_u24 v196, v191, v231, v196
    s_mov_b32 s96, -1
    s_mov_b32 s97, 0
    v_sub_u32 v200, v199, v198
    v_add_u32_sdwa v202, v199, v199 dst_sel:DWORD dst_unused:UNUSED_PAD src0_sel:WORD_0 src1_sel:WORD_1
    v_add_u32_dpp v196, v196, v196 row_shr:1 row_mask:0xf bank_mask:0xf bound_ctrl:0
    v_add_u32_sdwa v201, v200, v200 dst_sel:DWORD dst_unused:UNUSED_PAD src0_sel:WORD_0 src1_sel:WORD_1
    v_add_u32_sdwa v203, v198, v198 dst_sel:DWORD dst_unused:UNUSED_PAD src0_sel:WORD_0 src1_sel:WORD_1
    v_add_u32_dpp v196, v196, v196 row_shr:2 row_mask:0xf bank_mask:0xf bound_ctrl:0
    v_and_b32 v239, 60, v110
    v_readfirstlane_b32 s19, v236
    v_add_u32_dpp v196, v196, v196 row_shr:4 row_mask:0xf bank_mask:0xf bound_ctrl:0
    v_permlane32_swap_b32 v201, v202
    v_cndmask_b32 v203, 0, v203, s[96:97]
    v_add_u32_dpp v196, v196, v196 row_shr:8 row_mask:0xf bank_mask:0xf bound_ctrl:0
    v_add_u32 v201, v201, v202
    v_and_b32 v142, 0xffff, v142
    v_add_u32_dpp v196, v196, v196 row_bcast:15 row_mask:0xa bank_mask:0xf
    v_add_u32 v202, v201, v203
    v_lshl_or_b32 v142, v239, 19, v142
    v_add_u32_dpp v196, v196, v196 row_bcast:31 row_mask:0xc bank_mask:0xf
    v_sub_u32_sdwa v203, v202, v198 dst_sel:DWORD dst_unused:UNUSED_PAD src0_sel:DWORD src1_sel:WORD_1
    v_readlane_b32 s16, v196, 63
    s_lshl_b32 m0, s3, 10
    v_mov_b32 v240, v211
    s_add_u32 m0, m0, 21504
    s_nop 0
    buffer_load_dwordx4 v[240:241], s[44:47], 0 idxen offen lds
    s_bfe_u32 s10, s16, 0xe0002
    s_lshr_b32 s16, s16, 16
    s_lshr_b32 s11, s10, 1
    s_add_u32 s11, s11, 48
    s_and_b32 s11, s11, -128
    s_lshr_b32 s8, s4, 1
    s_mul_i32 s8, s8, s10
    s_sub_i32 s11, s11, 48
    s_sub_i32 s8, s8, s16
    s_add_i32 s11, s11, s8
    s_add_i32 s10, s10, s8
    s_bitcmp1_b32 s4, 0
    s_cselect_b32 s31, s11, s8
    s_cselect_b32 s10, s10, s11
    v_cmp_gt_i32 vcc, s31, v202
    v_cmp_gt_i32 s[34:35], s10, v202
    s_bcnt1_i32_b32 s22, vcc_lo
    s_bcnt1_i32_b32 s10, s34
    s_min_i32 s22, s22, s23
    s_max_i32 s10, s10, s24
    s_min_i32 s23, s10, s25
    v_readlane_b32 s16, v201, s22
    v_readlane_b32 s30, v201, s23
    s_add_u32 s8, s22, s7
    s_add_u32 s9, s23, s7
    s_add_u32 s10, s22, 32
    s_add_u32 s11, s23, 32
    v_readlane_b32 s26, v200, s22
    v_readlane_b32 s28, v200, s23
    v_readlane_b32 s27, v200, s10
    v_readlane_b32 s29, v200, s11
    s_sub_u32 s31, s30, s16
    s_add_u32 s10, s31, 255
    s_sub_i32 s11, s23, 16
    s_max_i32 s11, s11, s22
    v_readlane_b32 s11, v201, s11
    s_add_u32 vcc_lo, s31, 127
    s_and_b32 vcc_hi, vcc_lo, 127
    s_add_u32 vcc_hi, vcc_hi, s19
    s_cmp_lt_u32 vcc_hi, 55
    s_cselect_b32 vcc_lo, vcc_lo, s10
    s_sub_u32 s11, s11, s16
    s_add_u32 s11, s11, s19
    s_lshl_b32 s11, s11, 1
    s_and_b32 vcc_lo, vcc_lo, -256
    s_cmp_le_u32 s11, vcc_lo
    s_cselect_b32 s10, vcc_lo, s10
    s_lshr_b32 s10, s10, 8
    s_lshl_b32 s10, s10, 7
    s_sub_u32 s10, s10, s19
    s_max_i32 s10, s10, 0
    s_add_u32 s16, s16, s10
    s_add_u32 s10, s22, 16
    s_min_u32 s10, s10, s23
    s_sub_i32 s11, s23, 16
    v_cmp_ge_u32 s[34:35], s16, v203
    v_cmp_ge_u32 s[36:37], s16, v202
    v_cmp_gt_i32 vcc, s10, v177
    v_cmp_gt_i32 s[10:11], s11, v177
    v_cmp_le_u32 s[32:33], s22, v177
    v_cmp_gt_u32 s[96:97], s23, v177
    s_and_b64 s[34:35], s[34:35], vcc
    s_and_b64 s[36:37], s[36:37], vcc
    s_or_b64 s[34:35], s[34:35], s[10:11]
    s_or_b64 s[36:37], s[36:37], s[10:11]
    s_bcnt1_i32_b32 s24, s34
    s_bcnt1_i32_b32 s10, s36
    s_bcnt1_i32_b32 s11, s35
    s_bcnt1_i32_b32 s25, s37
    v_readlane_b32 s22, v200, s24
    v_readlane_b32 s10, v200, s10
    s_add_u32 s11, s11, 32
    s_add_u32 s16, s25, 32
    v_readlane_b32 s23, v200, s11
    v_readlane_b32 s11, v200, s16
    v_mov_b32 v188, s17
    v_cndmask_b32 v189, 0, v188, s[34:35]
    v_cndmask_b32 v188, 0, v188, s[36:37]
    s_and_b64 s[32:33], s[32:33], s[96:97]
    s_pack_lh_b32_b16 s22, s22, s10
    s_pack_lh_b32_b16 s23, s23, s11
    v_lshl_or_b32 v188, v188, 16, v189
    s_sub_u32 s16, s12, 37888
    s_pack_ll_b32_b16 s16, s16, s16
    s_sub_u32 s10, s22, s26
    s_sub_u32 s11, s23, s27
    s_mul_i32 s10, s10, 0x10001
    s_lshl_b32 vcc_lo, s10, 16
    s_pack_hh_b32_b16 s10, s10, s10
    s_lshl_b32 vcc_hi, s11, 16
    s_add_u32 vcc_hi, vcc_hi, s10
    s_add_u32 s96, vcc_hi, s11
    s_lshr_b32 s96, s96, 16
    s_sub_u32 s31, s31, s96
    s_cmp_gt_u32 s31, s96
    s_cselect_b32 s97, 0x4800480, 0
    s_add_u32 s16, s16, s97
    s_sub_u32 s10, s16, s26
    s_sub_u32 s11, s16, s27
    s_add_u32 s10, s10, vcc_lo
    s_add_u32 s11, s11, vcc_hi
    v_mov_b32 v192, s10
    v_mov_b32 v193, s11
    s_add_u32 s16, s16, 0x4800480
    s_sub_u32 s16, s16, s97
    s_sub_u32 s16, s16, s97
    s_sub_u32 s10, s28, s22
    s_sub_u32 s11, s29, s23
    s_mul_i32 s10, s10, 0x10001
    s_lshl_b32 vcc_lo, s10, 16
    s_pack_hh_b32_b16 s10, s10, s10
    s_lshl_b32 vcc_hi, s11, 16
    s_add_u32 vcc_hi, vcc_hi, s10
    s_sub_u32 s10, s16, s22
    s_sub_u32 s11, s16, s23
    s_add_u32 s10, s10, vcc_lo
    s_add_u32 s11, s11, vcc_hi
    v_mov_b32 v194, s10
    v_mov_b32 v195, s11
    v_bfi_b32 v192, v188, v192, v194
    v_bfi_b32 v193, v188, v193, v195
    s_mov_b32 exec_hi, 0
    v_mov_b32 v193, v192
    s_mov_b64 exec, s[32:33]
    v_add_u32 v200, v200, v193
    s_bfe_u32 s10, s97, 0x10007
    s_lshl1_add_u32 s10, s4, s10
    s_lshl_b32 s10, s10, 2
    v_cndmask_b32 v188, 4, 0, s[34:35]
    ds_write_b16 v178, v200 offset:1026
    ds_write_b16_d16_hi v178, v200 offset:2050
    s_mov_b32 exec_hi, 0
    v_xor_b32 v188, s10, v188
    ds_write_b32 v179, v188
    s_mov_b64 exec, -1
    s_min_u32 s10, s31, s96
    s_max_u32 s96, s31, s96
    s_mov_b32 s31, s10
    s_add_u32 s10, s96, s19
    s_mul_i32 s11, s30, 9216
    s_lshr_b32 s11, s11, 16
    s_max_u32 s10, s10, s11
    s_cmp_lt_u32 s10, 1152
    s_cbranch_scc1 L_LFIT
    ds_write_b32 v197, v184
L_LFIT:
    s_cmp_eq_u32 s19, 0
    s_cbranch_scc1 L_XCNR
    s_sub_u32 s10, s12, 37888
    s_add_u32 s11, s10, s96
    v_mov_b32 v188, s11
    s_add_u32 s11, s10, s31
    s_add_u32 s11, s11, 1152
    v_mov_b32 v189, s11
    s_lshl_b32 s10, s4, 3
    v_mov_b32 v190, s10
    ds_write_b64 v190, v[188:189] offset:576
L_XCNR:
    s_lshl_b32 m0, s3, 10
    v_mov_b32 v240, v215
    s_add_u32 m0, m0, 29696
    s_nop 0
    buffer_load_dwordx4 v[240:241], s[44:47], 0 idxen offen lds
    s_waitcnt lgkmcnt(0)
    s_barrier
    ds_read_b64 v[202:203], v197
    ds_read_u16 v96, v96 offset:1026
    ds_read_u16 v97, v97 offset:1026
    ds_read_u16 v98, v98 offset:1026
    ds_read_u16 v100, v100 offset:1026
    ds_read_u16 v101, v101 offset:1026
    ds_read_u16 v102, v102 offset:1026
    ds_read_u16 v104, v104 offset:1026
    ds_read_u16 v105, v105 offset:1026
    ds_read_u16 v106, v106 offset:1026
    ds_read_u16 v108, v108 offset:1026
    ds_read_u16 v109, v109 offset:1026
    ds_read_u16 v110, v110 offset:1026
    s_lshl_b32 m0, s3, 10
    v_mov_b32 v240, v219
    s_add_u32 m0, m0, 37888
    s_nop 0
    buffer_load_dwordx4 v[240:241], s[44:47], 0 idxen offen lds
    s_add_u32 s24, s24, s7
    s_add_u32 s11, s25, s7
    s_and_b32 s10, s11, 15
    s_cmp_lt_u32 s11, s24
    s_cselect_b32 s25, s10, 16
    s_cmp_lg_u32 s97, 0
    s_cselect_b32 s23, s8, s11
    s_cselect_b32 s7, s8, s24
    s_cselect_b32 s8, s11, s8
    s_cselect_b32 s24, s9, s24
    s_cselect_b32 s9, s11, s9
    s_min_u32 s22, s8, 192
    s_min_u32 s23, s23, 192
    s_mov_b32 s30, s19
    s_waitcnt lgkmcnt(12)
    v_cmp_ne_u32 vcc, 0, v202
    v_readfirstlane_b32 s19, v203
    s_cbranch_vccnz L_OVF
    s_waitcnt lgkmcnt(9)
    s_mov_b64 exec, s[64:65]
    v_add_u32 v96, v96, v112
    ds_write2st64_b32 v96, v128, v204 offset0:148 offset1:220
    s_mov_b64 exec, s[66:67]
    v_add_u32 v97, v97, v113
    ds_write2st64_b32 v97, v129, v205 offset0:148 offset1:220
    s_mov_b64 exec, s[68:69]
    v_add_u32 v98, v98, v114
    ds_write2st64_b32 v98, v130, v206 offset0:148 offset1:220
    s_waitcnt lgkmcnt(9)
    s_mov_b64 exec, s[72:73]
    v_add_u32 v100, v100, v116
    ds_write2st64_b32 v100, v132, v208 offset0:148 offset1:220
    s_mov_b64 exec, s[74:75]
    v_add_u32 v101, v101, v117
    ds_write2st64_b32 v101, v133, v209 offset0:148 offset1:220
    s_mov_b64 exec, s[76:77]
    v_add_u32 v102, v102, v118
    ds_write2st64_b32 v102, v134, v210 offset0:148 offset1:220
    s_waitcnt lgkmcnt(9)
    s_mov_b64 exec, s[80:81]
    v_add_u32 v104, v104, v120
    ds_write2st64_b32 v104, v136, v212 offset0:148 offset1:220
    s_mov_b64 exec, s[82:83]
    v_add_u32 v105, v105, v121
    ds_write2st64_b32 v105, v137, v213 offset0:148 offset1:220
    s_mov_b64 exec, s[84:85]
    v_add_u32 v106, v106, v122
    ds_write2st64_b32 v106, v138, v214 offset0:148 offset1:220
    s_waitcnt lgkmcnt(9)
    s_mov_b64 exec, s[88:89]
    v_add_u32 v108, v108, v124
    ds_write2st64_b32 v108, v140, v216 offset0:148 offset1:220
    s_mov_b64 exec, s[90:91]
    v_add_u32 v109, v109, v125
    ds_write2st64_b32 v109, v141, v217 offset0:148 offset1:220
    s_mov_b64 exec, s[92:93]
    v_add_u32 v110, v110, v126
    ds_write2st64_b32 v110, v142, v218 offset0:148 offset1:220
    s_mov_b64 exec, -1
    s_add_u32 s10, s96, 127
    s_lshr_b32 s10, s10, 7
    s_lshl1_add_u32 s10, s10, -1
    s_add_u32 s11, s31, 127
    s_lshr_b32 s11, s11, 6
    s_and_b32 s11, s11, -2
    s_max_i32 s17, s10, s11
    s_cselect_b32 s10, s96, s31
    s_sub_u32 s10, s10, 1
    s_andn2_b32 s99, 64, s10
L_CA:
    ds_read_b64_tr_b16 v[96:97], v225 offset:0
    ds_read_b64_tr_b16 v[98:99], v225 offset:1280
    ds_read_b64_tr_b16 v[100:101], v225 offset:5120
    ds_read_b64_tr_b16 v[102:103], v225 offset:6400
    ds_read_b64_tr_b16 v[104:105], v225 offset:32
    ds_read_b64_tr_b16 v[106:107], v225 offset:1312
    ds_read_b64_tr_b16 v[108:109], v225 offset:5152
    ds_read_b64_tr_b16 v[110:111], v225 offset:6432
    ds_read_b64_tr_b16 v[112:113], v225 offset:64
    ds_read_b64_tr_b16 v[114:115], v225 offset:1344
    ds_read_b64_tr_b16 v[116:117], v225 offset:5184
    ds_read_b64_tr_b16 v[118:119], v225 offset:6464
    ds_read_b64_tr_b16 v[120:121], v225 offset:96
    ds_read_b64_tr_b16 v[122:123], v225 offset:1376
    ds_read_b64_tr_b16 v[124:125], v225 offset:5216
    ds_read_b64_tr_b16 v[126:127], v225 offset:6496
    s_cmp_eq_u32 s21, 0
    s_cbranch_scc1 L_XT2R
    s_waitcnt vmcnt(8)
L_XT2:
    s_mov_b64 s[34:35], 0
    v_cmp_ne_u32 vcc, s6, v65
    s_and_b64 vcc, vcc, s[70:71]
    s_or_b64 s[34:35], s[34:35], vcc
    v_cmp_ne_u32 vcc, s6, v69
    s_and_b64 vcc, vcc, s[78:79]
    s_or_b64 s[34:35], s[34:35], vcc
    v_cmp_ne_u32 vcc, s6, v73
    s_and_b64 vcc, vcc, s[86:87]
    s_or_b64 s[34:35], s[34:35], vcc
    v_cmp_ne_u32 vcc, s6, v77
    s_and_b64 vcc, vcc, s[94:95]
    s_or_b64 s[34:35], s[34:35], vcc
    s_cbranch_scc1 L_XT2B
    s_cmp_eq_u32 s20, 0
    s_cbranch_scc1 L_XT2R
    s_mov_b64 exec, s[70:71]
    s_cbranch_execz L_XS0
    v_bfe_u32 v65, v64, 18, 8
    v_lshlrev_b32 v65, 2, v65
    v_add_u32 v67, 153728, v65
    ds_read_b32 v67, v67
    v_add_u32_sdwa v66, v66, v156 dst_sel:DWORD dst_unused:UNUSED_PAD src0_sel:BYTE_0 src1_sel:DWORD
    v_lshrrev_b32 v189, 28, v64
    v_lshl_add_u32 v66, v189, 8, v66
    v_and_b32 v189, 60, v65
    v_and_b32 v64, 0xffff, v64
    v_lshl_or_b32 v64, v189, 19, v64
    s_waitcnt lgkmcnt(0)
    ds_add_rtn_u32 v67, v67, v184 offset:576
    s_waitcnt lgkmcnt(0)
    ds_write2st64_b32 v67, v64, v66 offset0:148 offset1:220
L_XS0:
    s_mov_b64 exec, s[78:79]
    s_cbranch_execz L_XS1
    v_bfe_u32 v69, v68, 18, 8
    v_lshlrev_b32 v69, 2, v69
    v_add_u32 v71, 153728, v69
    ds_read_b32 v71, v71
    v_add_u32_sdwa v70, v70, v157 dst_sel:DWORD dst_unused:UNUSED_PAD src0_sel:BYTE_0 src1_sel:DWORD
    v_lshrrev_b32 v189, 28, v68
    v_lshl_add_u32 v70, v189, 8, v70
    v_and_b32 v189, 60, v69
    v_and_b32 v68, 0xffff, v68
    v_lshl_or_b32 v68, v189, 19, v68
    s_waitcnt lgkmcnt(0)
    ds_add_rtn_u32 v71, v71, v184 offset:576
    s_waitcnt lgkmcnt(0)
    ds_write2st64_b32 v71, v68, v70 offset0:148 offset1:220
L_XS1:
    s_mov_b64 exec, s[86:87]
    s_cbranch_execz L_XS2
    v_bfe_u32 v73, v72, 18, 8
    v_lshlrev_b32 v73, 2, v73
    v_add_u32 v75, 153728, v73
    ds_read_b32 v75, v75
    v_add_u32_sdwa v74, v74, v158 dst_sel:DWORD dst_unused:UNUSED_PAD src0_sel:BYTE_0 src1_sel:DWORD
    v_lshrrev_b32 v189, 28, v72
    v_lshl_add_u32 v74, v189, 8, v74
    v_and_b32 v189, 60, v73
    v_and_b32 v72, 0xffff, v72
    v_lshl_or_b32 v72, v189, 19, v72
    s_waitcnt lgkmcnt(0)
    ds_add_rtn_u32 v75, v75, v184 offset:576
    s_waitcnt lgkmcnt(0)
    ds_write2st64_b32 v75, v72, v74 offset0:148 offset1:220
L_XS2:
    s_mov_b64 exec, s[94:95]
    s_cbranch_execz L_XS3
    v_bfe_u32 v77, v76, 18, 8
    v_lshlrev_b32 v77, 2, v77
    v_add_u32 v79, 153728, v77
    ds_read_b32 v79, v79
    v_add_u32_sdwa v78, v78, v159 dst_sel:DWORD dst_unused:UNUSED_PAD src0_sel:BYTE_0 src1_sel:DWORD
    v_lshrrev_b32 v189, 28, v76
    v_lshl_add_u32 v78, v189, 8, v78
    v_and_b32 v189, 60, v77
    v_and_b32 v76, 0xffff, v76
    v_lshl_or_b32 v76, v189, 19, v76
    s_waitcnt lgkmcnt(0)
    ds_add_rtn_u32 v79, v79, v184 offset:576
    s_waitcnt lgkmcnt(0)
    ds_write2st64_b32 v79, v76, v78 offset0:148 offset1:220
L_XS3:
    s_mov_b64 exec, -1
L_XT2R:
    s_lshl_b32 s34, s22, 5
    s_lshl_b32 s35, s23, 5
    s_mov_b32 vcc_lo, 0xff00ff00
    s_mov_b32 vcc_hi, 0xff00ff00
    v_mov_b32 v176, s35
    v_mov_b32 v177, s34
    v_cndmask_b32 v176, v176, v177, vcc
    v_and_b32 v177, 4, v247
    v_lshlrev_b32 v177, 6, v177
    v_lshl_add_u32 v177, v246, 2, v177
    v_sub_u32 v177, v177, v176
    v_and_b32 v178, 48, v247
    s_movk_i32 s34, 832
    v_mad_u32_u24 v178, v246, s34, v178
    s_mov_b32 s34, 116736
    v_add3_u32 v178, v178, v176, s34
    v_and_b32 v176, 0x1ff, v177
    v_add_u32 v176, v176, v178
    v_add_u32 v177, 0x80, v177
    v_and_b32 v177, 0x1ff, v177
    v_add_u32 v177, v177, v178
    v_mov_b64 v[184:185], 0
    v_mov_b64 v[186:187], 0
    v_lshrrev_b32 v188, 2, v247
    v_and_b32 v188, 12, v188
    v_subrev_u32 v188, s25, v188
    v_mov_b32 v189, 0x358637bd
    v_mfma_f32_32x32x16_bf16 v[144:159], v[184:187], v[184:187], 0
    v_cmp_ne_u32 s[80:81], 0, v188
    v_cmp_ne_u32 s[82:83], -1, v188
    v_cmp_ne_u32 s[84:85], -2, v188
    v_cmp_ne_u32 s[86:87], -3, v188
    v_cndmask_b32 v128, 0, v189, s[80:81]
    v_cndmask_b32 v129, 0, v189, s[82:83]
    v_cndmask_b32 v130, 0, v189, s[84:85]
    v_cndmask_b32 v131, 0, v189, s[86:87]
    v_mov_b64 v[132:133], v[128:129]
    v_mov_b64 v[134:135], v[130:131]
    v_mov_b64 v[136:137], v[128:129]
    v_mov_b64 v[138:139], v[130:131]
    v_mov_b64 v[140:141], v[128:129]
    v_mov_b64 v[142:143], v[130:131]
    s_cmp_ge_u32 s3, 4
    s_cbranch_scc1 L_EP0
    s_lshl_b32 s72, s4, 7
    s_add_u32 s72, s72, 157824
    v_mov_b32 v190, s22
    s_mov_b32 exec_lo, 0xffff0000
    v_mov_b32 v190, s23
    s_mov_b32 exec_lo, -1
    s_mov_b32 exec_hi, 0
    v_sub_u32 v191, v247, v190
    v_and_b32 v191, 15, v191
    v_add_lshl_u32 v191, v191, v190, 5
    v_lshl_add_u32 v190, v247, 2, s72
    ds_write_b32 v190, v191
    s_mov_b32 exec_hi, -1
    s_mul_i32 s10, s5, 196
    s_add_u32 s11, s10, s7
    s_add_u32 s62, s10, s9
    s_min_u32 s11, s11, 50000
    s_min_u32 s62, s62, 50000
    s_sub_u32 s62, s62, s11
    s_lshl_b32 s11, s11, 7
    s_lshl_b32 s62, s62, 7
    s_add_u32 s60, s48, s11
    s_addc_u32 s61, s49, 0
    s_mul_i32 s74, s7, -128
    s_add_u32 s11, s10, s8
    s_add_u32 s50, s10, s24
    s_min_u32 s11, s11, 50000
    s_min_u32 s50, s50, 50000
    s_sub_u32 s50, s50, s11
    s_lshl_b32 s11, s11, 7
    s_lshl_b32 s50, s50, 7
    s_add_u32 s48, s48, s11
    s_addc_u32 s49, s49, 0
    s_mul_i32 s73, s8, -128
    s_and_b32 s10, s25, 12
    s_lshl_b32 s10, s10, 2
    s_bfm_b64 s[76:77], 16, s10
L_EP0:
    s_waitcnt vmcnt(0) lgkmcnt(0)
    s_barrier
    s_mov_b32 s10, 0x358637bd
    ds_read_b128 v[236:239], v248
    ds_read_b32 v240, v249
    ds_read_b128 v[160:163], v176 offset:0
    ds_read_b128 v[164:167], v176 offset:64
    ds_read_b128 v[168:171], v177 offset:0
    ds_read_b128 v[172:175], v177 offset:64
    s_waitcnt lgkmcnt(4)
    s_cmp_ge_u32 s3, 4
    s_cbranch_scc1 L_LATE0
    s_add_u32 m0, s13, 0
    v_mad_u32_u16 v236, v236, s15, v243
    buffer_load_dwordx4 v236, s[40:43], 0 offen lds
    s_add_u32 m0, s13, 1056
    v_mad_u32_u16 v237, v237, s15, v243
    buffer_load_dwordx4 v237, s[40:43], 0 offen lds
    s_add_u32 m0, s13, 2112
    v_mad_u32_u16 v238, v238, s15, v243
    buffer_load_dwordx4 v238, s[40:43], 0 offen lds
    s_add_u32 m0, s13, 3168
    v_mad_u32_u16 v239, v239, s15, v243
    buffer_load_dwordx4 v239, s[40:43], 0 offen lds
    s_mov_b32 m0, s14
    s_nop 0
    buffer_load_dwordx4 v[240:241], s[44:47], 0 idxen offen lds
L_LATE0:
    s_mov_b32 s34, 0xbfb8aa3b
    s_mov_b32 s35, s34
    s_waitcnt lgkmcnt(3)
    v_mfma_f32_16x16x32_bf16 v[204:207], v[160:163], v[96:99], 0
    v_mfma_f32_16x16x32_bf16 v[212:215], v[160:163], v[104:107], 0
    v_mfma_f32_16x16x32_bf16 v[220:223], v[160:163], v[112:115], 0
    v_mfma_f32_16x16x32_bf16 v[228:231], v[160:163], v[120:123], 0
    s_waitcnt lgkmcnt(2)
    v_mfma_f32_16x16x32_bf16 v[204:207], v[164:167], v[100:103], v[204:207]
    v_mfma_f32_16x16x32_bf16 v[212:215], v[164:167], v[108:111], v[212:215]
    v_mfma_f32_16x16x32_bf16 v[220:223], v[164:167], v[116:119], v[220:223]
    v_mfma_f32_16x16x32_bf16 v[228:231], v[164:167], v[124:127], v[228:231]
    s_waitcnt lgkmcnt(1)
    v_mfma_f32_16x16x32_bf16 v[208:211], v[168:171], v[96:99], 0
    v_mfma_f32_16x16x32_bf16 v[216:219], v[168:171], v[104:107], 0
    v_mfma_f32_16x16x32_bf16 v[224:227], v[168:171], v[112:115], 0
    v_mfma_f32_16x16x32_bf16 v[232:235], v[168:171], v[120:123], 0
    s_waitcnt lgkmcnt(0)
    v_mfma_f32_16x16x32_bf16 v[208:211], v[172:175], v[100:103], v[208:211]
    v_mfma_f32_16x16x32_bf16 v[216:219], v[172:175], v[108:111], v[216:219]
    v_mfma_f32_16x16x32_bf16 v[224:227], v[172:175], v[116:119], v[224:227]
    v_mfma_f32_16x16x32_bf16 v[232:235], v[172:175], v[124:127], v[232:235]
    s_mov_b32 s11, s10
    v_mov_b64 v[96:97], s[10:11]
    v_mov_b64 v[98:99], s[10:11]
    v_mov_b64 v[100:101], s[10:11]
    v_mov_b64 v[102:103], s[10:11]
    v_mov_b64 v[104:105], s[10:11]
    v_mov_b64 v[106:107], s[10:11]
    v_mov_b64 v[108:109], s[10:11]
    v_mov_b64 v[110:111], s[10:11]
    v_pk_mul_f32 v[204:205], v[204:205], s[34:35]
    v_pk_mul_f32 v[206:207], v[206:207], s[34:35]
    v_pk_mul_f32 v[208:209], v[208:209], s[34:35]
    v_pk_mul_f32 v[210:211], v[210:211], s[34:35]
    v_pk_mul_f32 v[212:213], v[212:213], s[34:35]
    v_pk_mul_f32 v[214:215], v[214:215], s[34:35]
    v_pk_mul_f32 v[216:217], v[216:217], s[34:35]
    v_pk_mul_f32 v[218:219], v[218:219], s[34:35]
    v_pk_mul_f32 v[220:221], v[220:221], s[34:35]
    v_pk_mul_f32 v[222:223], v[222:223], s[34:35]
    v_pk_mul_f32 v[224:225], v[224:225], s[34:35]
    v_pk_mul_f32 v[226:227], v[226:227], s[34:35]
    v_pk_mul_f32 v[228:229], v[228:229], s[34:35]
    v_pk_mul_f32 v[230:231], v[230:231], s[34:35]
    v_pk_mul_f32 v[232:233], v[232:233], s[34:35]
    v_pk_mul_f32 v[234:235], v[234:235], s[34:35]
    v_mfma_f32_32x32x16_bf16 v[112:127], v[184:187], v[184:187], 0
    v_cvt_pk_bf16_f32 v64, v204, v205
    v_cvt_pk_bf16_f32 v65, v206, v207
    v_cvt_pk_bf16_f32 v66, v208, v209
    v_cvt_pk_bf16_f32 v67, v210, v211
    v_cvt_pk_bf16_f32 v68, v212, v213
    v_cvt_pk_bf16_f32 v69, v214, v215
    v_cvt_pk_bf16_f32 v70, v216, v217
    v_cvt_pk_bf16_f32 v71, v218, v219
    v_cvt_pk_bf16_f32 v72, v220, v221
    v_cvt_pk_bf16_f32 v73, v222, v223
    v_cvt_pk_bf16_f32 v74, v224, v225
    v_cvt_pk_bf16_f32 v75, v226, v227
    v_cvt_pk_bf16_f32 v76, v228, v229
    v_cvt_pk_bf16_f32 v77, v230, v231
    v_cvt_pk_bf16_f32 v78, v232, v233
    v_cvt_pk_bf16_f32 v79, v234, v235
    v_permlane32_swap_b32 v80, v64
    v_permlane32_swap_b32 v81, v65
    v_permlane32_swap_b32 v82, v66
    v_permlane32_swap_b32 v83, v67
    v_permlane32_swap_b32 v84, v68
    v_permlane32_swap_b32 v85, v69
    v_permlane32_swap_b32 v86, v70
    v_permlane32_swap_b32 v87, v71
    v_permlane32_swap_b32 v88, v72
    v_permlane32_swap_b32 v89, v73
    v_permlane32_swap_b32 v90, v74
    v_permlane32_swap_b32 v91, v75
    v_permlane32_swap_b32 v92, v76
    v_permlane32_swap_b32 v93, v77
    v_permlane32_swap_b32 v94, v78
    v_permlane32_swap_b32 v95, v79
    s_mov_b32 s26, -1
    s_mov_b64 s[32:33], 0
    s_mov_b32 s28, 0
    s_mov_b32 s29, 0
    s_cmp_lt_u32 s3, 4
    s_cbranch_scc1 L_HAD0
    s_lshl_b32 s72, s4, 7
    s_add_u32 s72, s72, 157824
    v_mov_b32 v190, s22
    s_mov_b32 exec_lo, 0xffff0000
    v_mov_b32 v190, s23
    s_mov_b32 exec_lo, -1
    s_mov_b32 exec_hi, 0
    v_sub_u32 v191, v247, v190
    v_and_b32 v191, 15, v191
    v_add_lshl_u32 v191, v191, v190, 5
    v_lshl_add_u32 v190, v247, 2, s72
    ds_write_b32 v190, v191
    s_mov_b32 exec_hi, -1
    s_mul_i32 s10, s5, 196
    s_add_u32 s11, s10, s7
    s_add_u32 s62, s10, s9
    s_min_u32 s11, s11, 50000
    s_min_u32 s62, s62, 50000
    s_sub_u32 s62, s62, s11
    s_lshl_b32 s11, s11, 7
    s_lshl_b32 s62, s62, 7
    s_add_u32 s60, s48, s11
    s_addc_u32 s61, s49, 0
    s_mul_i32 s74, s7, -128
    s_add_u32 s11, s10, s8
    s_add_u32 s50, s10, s24
    s_min_u32 s11, s11, 50000
    s_min_u32 s50, s50, 50000
    s_sub_u32 s50, s50, s11
    s_lshl_b32 s11, s11, 7
    s_lshl_b32 s50, s50, 7
    s_add_u32 s48, s48, s11
    s_addc_u32 s49, s49, 0
    s_mul_i32 s73, s8, -128
    s_and_b32 s10, s25, 12
    s_lshl_b32 s10, s10, 2
    s_bfm_b64 s[76:77], 16, s10
    s_add_u32 m0, s13, 0
    v_mad_u32_u16 v236, v236, s15, v243
    buffer_load_dwordx4 v236, s[40:43], 0 offen lds
    s_add_u32 m0, s13, 1056
    v_mad_u32_u16 v237, v237, s15, v243
    buffer_load_dwordx4 v237, s[40:43], 0 offen lds
    s_add_u32 m0, s13, 2112
    v_mad_u32_u16 v238, v238, s15, v243
    buffer_load_dwordx4 v238, s[40:43], 0 offen lds
    s_add_u32 m0, s13, 3168
    v_mad_u32_u16 v239, v239, s15, v243
    buffer_load_dwordx4 v239, s[40:43], 0 offen lds
    s_mov_b32 m0, s14
    s_nop 0
    buffer_load_dwordx4 v[240:241], s[44:47], 0 idxen offen lds
L_HAD0:
    s_cmp_eq_u32 s30, 0
    s_cbranch_scc1 L_GO
    s_lshl_b32 s10, s4, 3
    v_mov_b32 v188, s10
    ds_read_b64 v[188:189], v188 offset:576
    s_waitcnt lgkmcnt(0)
    v_readfirstlane_b32 s34, v188
    v_readfirstlane_b32 s35, v189
    s_sub_u32 s10, s12, 37888
    s_sub_u32 s34, s34, s10
    s_sub_u32 s35, s35, s10
    s_sub_u32 s35, s35, 1152
    s_add_u32 s10, s34, 127
    s_lshr_b32 s10, s10, 7
    s_lshl1_add_u32 s10, s10, -1
    s_add_u32 s11, s35, 127
    s_lshr_b32 s11, s11, 6
    s_and_b32 s11, s11, -2
    s_max_i32 s17, s10, s11
    s_cselect_b32 s10, s34, s35
    s_sub_u32 s10, s10, 1
    s_andn2_b32 s99, 64, s10
L_GO:
    ds_read_u16 v252, v250 offset:0
    ds_read_u16 v253, v250 offset:64
    ds_read_b128 v[236:239], v248 offset:1152
    ds_read_b32 v240, v249 offset:1152
    s_lshr_b32 s10, s4, 1
    s_lshl_b32 s10, s10, 9
    s_add_u32 s10, s10, 155776
    v_lshl_add_u32 v246, v247, 3, s10
    s_bitcmp1_b32 s4, 0
    s_cselect_b32 s101, -1, 1
    s_mul_i32 s10, s101, 0xff000000
    s_or_b32 s10, s10, 0xdddd
    v_mov_b32 v255, s10
    s_max_i32 s10, s17, 1
    s_sub_u32 s10, s10, 1
    s_mul_i32 s10, s101, s10
    s_lshl_b32 s10, s10, 24
    v_mov_b32 v188, s10
    ds_add_u32 v246, v188
    s_movk_i32 s94, 128
    s_movk_i32 s95, 128
    v_mov_b32 v247, 0
    s_mov_b32 exec_hi, 0
    v_add_u32 v247, 0x200, v245
    s_mov_b32 exec_hi, -1
    s_waitcnt lgkmcnt(0)
    v_bfi_b32 v252, 31, v245, v252
    v_bfi_b32 v253, 31, v245, v253
    v_max_u32 v252, v252, v245
    v_max_u32 v253, v253, v247
    s_waitcnt vmcnt(0)
    ds_read_b128 v[176:179], v252
    ds_read_b128 v[180:183], v253
    ds_read_b128 v[160:163], v244 offset:0
    ds_read_b128 v[168:171], v244 offset:512
    ds_read_b128 v[164:167], v244 offset:64
    ds_read_b128 v[172:175], v244 offset:576
    s_cmp_lt_i32 s17, 1
    s_cbranch_scc1 L_DONE
    s_waitcnt lgkmcnt(4)
    v_mfma_f32_16x16x32_bf16 v[188:191], v[176:179], v[64:67], 0
    v_mfma_f32_16x16x32_bf16 v[196:199], v[176:179], v[68:71], 0
    v_mfma_f32_16x16x32_bf16 v[192:195], v[180:183], v[64:67], 0
    v_mfma_f32_16x16x32_bf16 v[200:203], v[180:183], v[68:71], 0
    s_waitcnt lgkmcnt(0)
    v_mfma_f32_16x16x32_bf16 v[188:191], v[160:163], v[0:3], v[188:191]
    v_mfma_f32_16x16x32_bf16 v[196:199], v[160:163], v[8:11], v[196:199]
    v_mfma_f32_16x16x32_bf16 v[192:195], v[168:171], v[0:3], v[192:195]
    v_mfma_f32_16x16x32_bf16 v[200:203], v[168:171], v[8:11], v[200:203]
    v_mfma_f32_16x16x32_bf16 v[188:191], v[164:167], v[4:7], v[188:191]
    v_mfma_f32_16x16x32_bf16 v[196:199], v[164:167], v[12:15], v[196:199]
    v_mfma_f32_16x16x32_bf16 v[192:195], v[172:175], v[4:7], v[192:195]
    v_mfma_f32_16x16x32_bf16 v[200:203], v[172:175], v[12:15], v[200:203]
    s_mov_b32 s16, 1
    s_cmp_eq_u32 s17, 1
    s_cbranch_scc1 L_LT0
    s_add_u32 m0, s13, 0
    v_mad_u32_u16 v236, v236, s15, v243
    buffer_load_dwordx4 v236, s[40:43], 0 offen lds
    s_add_u32 m0, s13, 1056
    v_mad_u32_u16 v237, v237, s15, v243
    buffer_load_dwordx4 v237, s[40:43], 0 offen lds
    s_add_u32 m0, s13, 2112
    v_mad_u32_u16 v238, v238, s15, v243
    buffer_load_dwordx4 v238, s[40:43], 0 offen lds
    s_add_u32 m0, s13, 3168
    v_mad_u32_u16 v239, v239, s15, v243
    buffer_load_dwordx4 v239, s[40:43], 0 offen lds
    s_mov_b32 m0, s14
    s_nop 0
    buffer_load_dwordx4 v[240:241], s[44:47], 0 idxen offen lds
.p2align 6
L_LOOP1:
    s_setprio 1
    v_smfmac_f32_16x16x64_bf16 v[152:155], v[184:187], v[204:211], v255
    ds_read_u16 v236, v251 offset:0
    ds_read_u16 v237, v251 offset:16
    ds_add_rtn_u32 v238, v246, v255
    v_exp_f32 v188, v188
    v_smfmac_f32_16x16x64_bf16 v[156:159], v[184:187], v[212:219], v255
    v_exp_f32 v189, v189
    v_mfma_f32_16x16x32_bf16 v[204:207], v[160:163], v[32:35], 0
    v_exp_f32 v190, v190
    v_mfma_f32_16x16x32_bf16 v[212:215], v[160:163], v[40:43], 0
    v_exp_f32 v191, v191
    v_mfma_f32_16x16x32_bf16 v[208:211], v[168:171], v[32:35], 0
    v_exp_f32 v192, v192
    v_mfma_f32_16x16x32_bf16 v[216:219], v[168:171], v[40:43], 0
    v_exp_f32 v193, v193
    v_mfma_f32_16x16x32_bf16 v[204:207], v[164:167], v[36:39], v[204:207]
    v_exp_f32 v194, v194
    v_mfma_f32_16x16x32_bf16 v[212:215], v[164:167], v[44:47], v[212:215]
    v_exp_f32 v195, v195
    v_mfma_f32_16x16x32_bf16 v[208:211], v[172:175], v[36:39], v[208:211]
    s_waitcnt lgkmcnt(0)
    v_bfi_b32 v236, 31, v246, v236
    v_bfi_b32 v237, 31, v246, v237
    v_readfirstlane_b32 s96, v238
    v_exp_f32 v196, v196
    v_mfma_f32_16x16x32_bf16 v[216:219], v[172:175], v[44:47], v[216:219]
    v_exp_f32 v197, v197
    v_smfmac_f32_16x16x64_bf16 v[136:139], v[184:187], v[220:227], v255
    v_exp_f32 v198, v198
    v_smfmac_f32_16x16x64_bf16 v[140:143], v[184:187], v[228:235], v255
    v_exp_f32 v199, v199
    v_mfma_f32_4x4x4_16b_bf16 v[188:191], v[242:243], v[242:243], v[188:191]
    v_exp_f32 v200, v200
    v_mfma_f32_4x4x4_16b_bf16 v[192:195], v[242:243], v[242:243], v[192:195]
    v_exp_f32 v201, v201
    v_mfma_f32_4x4x4_16b_bf16 v[196:199], v[242:243], v[242:243], v[196:199]
    v_exp_f32 v202, v202
    v_mfma_f32_16x16x32_bf16 v[220:223], v[176:179], v[72:75], 0
    ds_read_b64_tr_b16 v[184:185], v236
    ds_read_b64_tr_b16 v[186:187], v237
    ds_read_u16 v252, v250 offset:1152
    ds_read_u16 v253, v250 offset:1216
    v_exp_f32 v203, v203
    v_mfma_f32_16x16x32_bf16 v[228:231], v[176:179], v[76:79], 0
    s_ashr_i32 s96, s96, 24
    s_mul_i32 s96, s96, s101
    v_rcp_f32 v188, v188
    v_mfma_f32_16x16x32_bf16 v[224:227], v[180:183], v[72:75], 0
    v_rcp_f32 v189, v189
    v_mfma_f32_4x4x4_16b_bf16 v[200:203], v[242:243], v[242:243], v[200:203]
    v_rcp_f32 v190, v190
    v_mfma_f32_16x16x32_bf16 v[232:235], v[180:183], v[76:79], 0
    v_rcp_f32 v191, v191
    v_mfma_f32_16x16x32_bf16 v[220:223], v[160:163], v[16:19], v[220:223]
    v_rcp_f32 v192, v192
    v_mfma_f32_16x16x32_bf16 v[228:231], v[160:163], v[24:27], v[228:231]
    v_rcp_f32 v193, v193
    v_mfma_f32_16x16x32_bf16 v[224:227], v[168:171], v[16:19], v[224:227]
    s_waitcnt lgkmcnt(0)
    v_bfi_b32 v252, 31, v245, v252
    v_bfi_b32 v253, 31, v245, v253
    v_max_u32 v252, v252, v245
    v_max_u32 v253, v253, v247
    ds_read_b128 v[236:239], v248 offset:128
    ds_read_b32 v240, v249 offset:128
    s_add_u32 s16, s16, 1
    v_rcp_f32 v194, v194
    v_mfma_f32_16x16x32_bf16 v[232:235], v[168:171], v[24:27], v[232:235]
    v_rcp_f32 v195, v195
    v_mfma_f32_16x16x32_bf16 v[220:223], v[164:167], v[20:23], v[220:223]
    v_rcp_f32 v196, v196
    v_mfma_f32_16x16x32_bf16 v[228:231], v[164:167], v[28:31], v[228:231]
    v_rcp_f32 v197, v197
    s_setprio 3
    v_mfma_f32_16x16x32_bf16 v[224:227], v[172:175], v[20:23], v[224:227]
    v_rcp_f32 v198, v198
    v_mfma_f32_16x16x32_bf16 v[232:235], v[172:175], v[28:31], v[232:235]
    v_rcp_f32 v199, v199
    v_rcp_f32 v200, v200
    v_rcp_f32 v201, v201
    v_rcp_f32 v202, v202
    v_rcp_f32 v203, v203
    v_pk_mul_f32 v[204:205], v[188:189], v[204:205]
    v_pk_mul_f32 v[206:207], v[190:191], v[206:207]
    v_pk_mul_f32 v[208:209], v[192:193], v[208:209]
    v_pk_mul_f32 v[210:211], v[194:195], v[210:211]
    v_pk_mul_f32 v[212:213], v[196:197], v[212:213]
    v_pk_mul_f32 v[214:215], v[198:199], v[214:215]
    v_pk_mul_f32 v[216:217], v[200:201], v[216:217]
    v_pk_mul_f32 v[218:219], v[202:203], v[218:219]
    s_cmp_ge_i32 s96, 1
    s_cbranch_scc0 L_PB00
L_PB01:
    s_setprio 1
    v_smfmac_f32_16x16x64_bf16 v[112:115], v[184:187], v[204:211], v255
    v_exp_f32 v220, v220
    v_smfmac_f32_16x16x64_bf16 v[116:119], v[184:187], v[212:219], v255
    v_exp_f32 v221, v221
    s_waitcnt vmcnt(0)
    ds_read_b128 v[176:179], v252
    ds_read_b128 v[180:183], v253
    v_mfma_f32_16x16x32_bf16 v[204:207], v[160:163], v[48:51], 0
    v_exp_f32 v222, v222
    v_mfma_f32_16x16x32_bf16 v[212:215], v[160:163], v[56:59], 0
    ds_read_b128 v[160:163], v244 offset:0
    v_exp_f32 v223, v223
    v_mfma_f32_16x16x32_bf16 v[208:211], v[168:171], v[48:51], 0
    v_exp_f32 v224, v224
    v_mfma_f32_16x16x32_bf16 v[216:219], v[168:171], v[56:59], 0
    ds_read_b128 v[168:171], v244 offset:512
    v_exp_f32 v225, v225
    v_mfma_f32_16x16x32_bf16 v[204:207], v[164:167], v[52:55], v[204:207]
    v_exp_f32 v226, v226
    v_mfma_f32_16x16x32_bf16 v[212:215], v[164:167], v[60:63], v[212:215]
    ds_read_b128 v[164:167], v244 offset:64
    v_exp_f32 v227, v227
    v_mfma_f32_16x16x32_bf16 v[208:211], v[172:175], v[52:55], v[208:211]
    v_exp_f32 v228, v228
    v_mfma_f32_16x16x32_bf16 v[216:219], v[172:175], v[60:63], v[216:219]
    ds_read_b128 v[172:175], v244 offset:576
    v_exp_f32 v229, v229
    v_smfmac_f32_16x16x64_bf16 v[96:99], v[184:187], v[188:195], v255
    v_exp_f32 v230, v230
    v_smfmac_f32_16x16x64_bf16 v[100:103], v[184:187], v[196:203], v255
    v_exp_f32 v231, v231
    v_mfma_f32_4x4x4_16b_bf16 v[220:223], v[242:243], v[242:243], v[220:223]
    v_exp_f32 v232, v232
    v_mfma_f32_4x4x4_16b_bf16 v[224:227], v[242:243], v[242:243], v[224:227]
    v_exp_f32 v233, v233
    v_mfma_f32_4x4x4_16b_bf16 v[228:231], v[242:243], v[242:243], v[228:231]
    v_exp_f32 v234, v234
    s_waitcnt lgkmcnt(4)
    v_mfma_f32_16x16x32_bf16 v[188:191], v[176:179], v[80:83], 0
    v_exp_f32 v235, v235
    v_mfma_f32_16x16x32_bf16 v[196:199], v[176:179], v[84:87], 0
    v_rcp_f32 v220, v220
    v_mfma_f32_16x16x32_bf16 v[192:195], v[180:183], v[80:83], 0
    v_rcp_f32 v221, v221
    v_mfma_f32_4x4x4_16b_bf16 v[232:235], v[242:243], v[242:243], v[232:235]
    v_rcp_f32 v222, v222
    v_mfma_f32_16x16x32_bf16 v[200:203], v[180:183], v[84:87], 0
    v_rcp_f32 v223, v223
    s_waitcnt lgkmcnt(3)
    v_mfma_f32_16x16x32_bf16 v[188:191], v[160:163], v[0:3], v[188:191]
    v_rcp_f32 v224, v224
    v_mfma_f32_16x16x32_bf16 v[196:199], v[160:163], v[8:11], v[196:199]
    v_rcp_f32 v225, v225
    s_waitcnt lgkmcnt(2)
    v_mfma_f32_16x16x32_bf16 v[192:195], v[168:171], v[0:3], v[192:195]
    v_rcp_f32 v226, v226
    v_mfma_f32_16x16x32_bf16 v[200:203], v[168:171], v[8:11], v[200:203]
    v_rcp_f32 v227, v227
    s_waitcnt lgkmcnt(1)
    v_mfma_f32_16x16x32_bf16 v[188:191], v[164:167], v[4:7], v[188:191]
    v_rcp_f32 v228, v228
    v_mfma_f32_16x16x32_bf16 v[196:199], v[164:167], v[12:15], v[196:199]
    v_rcp_f32 v229, v229
    s_setprio 3
    s_waitcnt lgkmcnt(0)
    v_mfma_f32_16x16x32_bf16 v[192:195], v[172:175], v[4:7], v[192:195]
    s_cmp_lt_u32 s16, s17
    s_cbranch_scc0 L_ND01
    s_add_u32 m0, s13, 0
    v_mad_u32_u16 v236, v236, s15, v243
    buffer_load_dwordx4 v236, s[40:43], 0 offen lds
    s_add_u32 m0, s13, 1056
    v_mad_u32_u16 v237, v237, s15, v243
    buffer_load_dwordx4 v237, s[40:43], 0 offen lds
    s_add_u32 m0, s13, 2112
    v_mad_u32_u16 v238, v238, s15, v243
    buffer_load_dwordx4 v238, s[40:43], 0 offen lds
    s_add_u32 m0, s13, 3168
    v_mad_u32_u16 v239, v239, s15, v243
    buffer_load_dwordx4 v239, s[40:43], 0 offen lds
    s_mov_b32 m0, s14
    s_nop 0
    buffer_load_dwordx4 v[240:241], s[44:47], 0 idxen offen lds
L_ND01:
    v_rcp_f32 v230, v230
    v_mfma_f32_16x16x32_bf16 v[200:203], v[172:175], v[12:15], v[200:203]
    v_rcp_f32 v231, v231
    v_rcp_f32 v232, v232
    v_rcp_f32 v233, v233
    v_rcp_f32 v234, v234
    v_rcp_f32 v235, v235
    v_pk_mul_f32 v[204:205], v[220:221], v[204:205]
    v_pk_mul_f32 v[206:207], v[222:223], v[206:207]
    v_pk_mul_f32 v[208:209], v[224:225], v[208:209]
    v_pk_mul_f32 v[210:211], v[226:227], v[210:211]
    v_pk_mul_f32 v[212:213], v[228:229], v[212:213]
    v_pk_mul_f32 v[214:215], v[230:231], v[214:215]
    v_pk_mul_f32 v[216:217], v[232:233], v[216:217]
    v_pk_mul_f32 v[218:219], v[234:235], v[218:219]
    s_cmp_ge_u32 s16, s17
    s_cbranch_scc1 L_LT1
    s_setprio 1
    v_smfmac_f32_16x16x64_bf16 v[120:123], v[184:187], v[204:211], v255
    ds_read_u16 v236, v251 offset:1152
    ds_read_u16 v237, v251 offset:1168
    ds_add_rtn_u32 v238, v246, v255
    v_exp_f32 v188, v188
    v_smfmac_f32_16x16x64_bf16 v[124:127], v[184:187], v[212:219], v255
    v_exp_f32 v189, v189
    v_mfma_f32_16x16x32_bf16 v[204:207], v[160:163], v[32:35], 0
    v_exp_f32 v190, v190
    v_mfma_f32_16x16x32_bf16 v[212:215], v[160:163], v[40:43], 0
    v_exp_f32 v191, v191
    v_mfma_f32_16x16x32_bf16 v[208:211], v[168:171], v[32:35], 0
    v_exp_f32 v192, v192
    v_mfma_f32_16x16x32_bf16 v[216:219], v[168:171], v[40:43], 0
    v_exp_f32 v193, v193
    v_mfma_f32_16x16x32_bf16 v[204:207], v[164:167], v[36:39], v[204:207]
    v_exp_f32 v194, v194
    v_mfma_f32_16x16x32_bf16 v[212:215], v[164:167], v[44:47], v[212:215]
    v_exp_f32 v195, v195
    v_mfma_f32_16x16x32_bf16 v[208:211], v[172:175], v[36:39], v[208:211]
    s_waitcnt lgkmcnt(0)
    v_bfi_b32 v236, 31, v246, v236
    v_bfi_b32 v237, 31, v246, v237
    v_readfirstlane_b32 s96, v238
    v_exp_f32 v196, v196
    v_mfma_f32_16x16x32_bf16 v[216:219], v[172:175], v[44:47], v[216:219]
    v_exp_f32 v197, v197
    v_smfmac_f32_16x16x64_bf16 v[104:107], v[184:187], v[220:227], v255
    v_exp_f32 v198, v198
    v_smfmac_f32_16x16x64_bf16 v[108:111], v[184:187], v[228:235], v255
    v_exp_f32 v199, v199
    v_mfma_f32_4x4x4_16b_bf16 v[188:191], v[242:243], v[242:243], v[188:191]
    v_exp_f32 v200, v200
    v_mfma_f32_4x4x4_16b_bf16 v[192:195], v[242:243], v[242:243], v[192:195]
    v_exp_f32 v201, v201
    v_mfma_f32_4x4x4_16b_bf16 v[196:199], v[242:243], v[242:243], v[196:199]
    v_exp_f32 v202, v202
    v_mfma_f32_16x16x32_bf16 v[220:223], v[176:179], v[88:91], 0
    ds_read_b64_tr_b16 v[184:185], v236
    ds_read_b64_tr_b16 v[186:187], v237
    ds_read_u16 v252, v250 offset:128
    ds_read_u16 v253, v250 offset:192
    v_exp_f32 v203, v203
    v_mfma_f32_16x16x32_bf16 v[228:231], v[176:179], v[92:95], 0
    s_ashr_i32 s96, s96, 24
    s_mul_i32 s96, s96, s101
    v_rcp_f32 v188, v188
    v_mfma_f32_16x16x32_bf16 v[224:227], v[180:183], v[88:91], 0
    v_rcp_f32 v189, v189
    v_mfma_f32_4x4x4_16b_bf16 v[200:203], v[242:243], v[242:243], v[200:203]
    v_rcp_f32 v190, v190
    v_mfma_f32_16x16x32_bf16 v[232:235], v[180:183], v[92:95], 0
    v_rcp_f32 v191, v191
    v_mfma_f32_16x16x32_bf16 v[220:223], v[160:163], v[16:19], v[220:223]
    v_rcp_f32 v192, v192
    v_mfma_f32_16x16x32_bf16 v[228:231], v[160:163], v[24:27], v[228:231]
    v_rcp_f32 v193, v193
    v_mfma_f32_16x16x32_bf16 v[224:227], v[168:171], v[16:19], v[224:227]
    s_waitcnt lgkmcnt(0)
    v_bfi_b32 v252, 31, v245, v252
    v_bfi_b32 v253, 31, v245, v253
    v_max_u32 v252, v252, v245
    v_max_u32 v253, v253, v247
    ds_read_b128 v[236:239], v248 offset:1280
    ds_read_b32 v240, v249 offset:1280
    s_add_u32 s16, s16, 1
    v_rcp_f32 v194, v194
    v_mfma_f32_16x16x32_bf16 v[232:235], v[168:171], v[24:27], v[232:235]
    v_lshl_add_u64 v[248:249], v[248:249], 0, s[94:95]
    v_lshl_add_u64 v[250:251], v[250:251], 0, s[94:95]
    v_rcp_f32 v195, v195
    v_mfma_f32_16x16x32_bf16 v[220:223], v[164:167], v[20:23], v[220:223]
    v_rcp_f32 v196, v196
    v_mfma_f32_16x16x32_bf16 v[228:231], v[164:167], v[28:31], v[228:231]
    v_rcp_f32 v197, v197
    s_setprio 3
    v_mfma_f32_16x16x32_bf16 v[224:227], v[172:175], v[20:23], v[224:227]
    v_rcp_f32 v198, v198
    v_mfma_f32_16x16x32_bf16 v[232:235], v[172:175], v[28:31], v[232:235]
    v_rcp_f32 v199, v199
    v_rcp_f32 v200, v200
    v_rcp_f32 v201, v201
    v_rcp_f32 v202, v202
    v_rcp_f32 v203, v203
    v_pk_mul_f32 v[204:205], v[188:189], v[204:205]
    v_pk_mul_f32 v[206:207], v[190:191], v[206:207]
    v_pk_mul_f32 v[208:209], v[192:193], v[208:209]
    v_pk_mul_f32 v[210:211], v[194:195], v[210:211]
    v_pk_mul_f32 v[212:213], v[196:197], v[212:213]
    v_pk_mul_f32 v[214:215], v[198:199], v[214:215]
    v_pk_mul_f32 v[216:217], v[200:201], v[216:217]
    v_pk_mul_f32 v[218:219], v[202:203], v[218:219]
    s_cmp_ge_i32 s96, 1
    s_cbranch_scc0 L_PB10
L_PB11:
    s_setprio 1
    v_smfmac_f32_16x16x64_bf16 v[144:147], v[184:187], v[204:211], v255
    v_exp_f32 v220, v220
    v_smfmac_f32_16x16x64_bf16 v[148:151], v[184:187], v[212:219], v255
    v_exp_f32 v221, v221
    s_waitcnt vmcnt(0)
    ds_read_b128 v[176:179], v252
    ds_read_b128 v[180:183], v253
    v_mfma_f32_16x16x32_bf16 v[204:207], v[160:163], v[48:51], 0
    v_exp_f32 v222, v222
    v_mfma_f32_16x16x32_bf16 v[212:215], v[160:163], v[56:59], 0
    ds_read_b128 v[160:163], v244 offset:0
    v_exp_f32 v223, v223
    v_mfma_f32_16x16x32_bf16 v[208:211], v[168:171], v[48:51], 0
    v_exp_f32 v224, v224
    v_mfma_f32_16x16x32_bf16 v[216:219], v[168:171], v[56:59], 0
    ds_read_b128 v[168:171], v244 offset:512
    v_exp_f32 v225, v225
    v_mfma_f32_16x16x32_bf16 v[204:207], v[164:167], v[52:55], v[204:207]
    v_exp_f32 v226, v226
    v_mfma_f32_16x16x32_bf16 v[212:215], v[164:167], v[60:63], v[212:215]
    ds_read_b128 v[164:167], v244 offset:64
    v_exp_f32 v227, v227
    v_mfma_f32_16x16x32_bf16 v[208:211], v[172:175], v[52:55], v[208:211]
    v_exp_f32 v228, v228
    v_mfma_f32_16x16x32_bf16 v[216:219], v[172:175], v[60:63], v[216:219]
    ds_read_b128 v[172:175], v244 offset:576
    v_exp_f32 v229, v229
    v_smfmac_f32_16x16x64_bf16 v[128:131], v[184:187], v[188:195], v255
    v_exp_f32 v230, v230
    v_smfmac_f32_16x16x64_bf16 v[132:135], v[184:187], v[196:203], v255
    v_exp_f32 v231, v231
    v_mfma_f32_4x4x4_16b_bf16 v[220:223], v[242:243], v[242:243], v[220:223]
    v_exp_f32 v232, v232
    v_mfma_f32_4x4x4_16b_bf16 v[224:227], v[242:243], v[242:243], v[224:227]
    v_exp_f32 v233, v233
    v_mfma_f32_4x4x4_16b_bf16 v[228:231], v[242:243], v[242:243], v[228:231]
    v_exp_f32 v234, v234
    s_waitcnt lgkmcnt(4)
    v_mfma_f32_16x16x32_bf16 v[188:191], v[176:179], v[64:67], 0
    v_exp_f32 v235, v235
    v_mfma_f32_16x16x32_bf16 v[196:199], v[176:179], v[68:71], 0
    v_rcp_f32 v220, v220
    v_mfma_f32_16x16x32_bf16 v[192:195], v[180:183], v[64:67], 0
    v_rcp_f32 v221, v221
    v_mfma_f32_4x4x4_16b_bf16 v[232:235], v[242:243], v[242:243], v[232:235]
    v_rcp_f32 v222, v222
    v_mfma_f32_16x16x32_bf16 v[200:203], v[180:183], v[68:71], 0
    v_rcp_f32 v223, v223
    s_waitcnt lgkmcnt(3)
    v_mfma_f32_16x16x32_bf16 v[188:191], v[160:163], v[0:3], v[188:191]
    v_rcp_f32 v224, v224
    v_mfma_f32_16x16x32_bf16 v[196:199], v[160:163], v[8:11], v[196:199]
    v_rcp_f32 v225, v225
    s_waitcnt lgkmcnt(2)
    v_mfma_f32_16x16x32_bf16 v[192:195], v[168:171], v[0:3], v[192:195]
    v_rcp_f32 v226, v226
    v_mfma_f32_16x16x32_bf16 v[200:203], v[168:171], v[8:11], v[200:203]
    v_rcp_f32 v227, v227
    s_waitcnt lgkmcnt(1)
    v_mfma_f32_16x16x32_bf16 v[188:191], v[164:167], v[4:7], v[188:191]
    v_rcp_f32 v228, v228
    v_mfma_f32_16x16x32_bf16 v[196:199], v[164:167], v[12:15], v[196:199]
    v_rcp_f32 v229, v229
    s_setprio 3
    s_waitcnt lgkmcnt(0)
    v_mfma_f32_16x16x32_bf16 v[192:195], v[172:175], v[4:7], v[192:195]
    s_cmp_lt_u32 s16, s17
    s_cbranch_scc0 L_ND11
    s_add_u32 m0, s13, 0
    v_mad_u32_u16 v236, v236, s15, v243
    buffer_load_dwordx4 v236, s[40:43], 0 offen lds
    s_add_u32 m0, s13, 1056
    v_mad_u32_u16 v237, v237, s15, v243
    buffer_load_dwordx4 v237, s[40:43], 0 offen lds
    s_add_u32 m0, s13, 2112
    v_mad_u32_u16 v238, v238, s15, v243
    buffer_load_dwordx4 v238, s[40:43], 0 offen lds
    s_add_u32 m0, s13, 3168
    v_mad_u32_u16 v239, v239, s15, v243
    buffer_load_dwordx4 v239, s[40:43], 0 offen lds
    s_mov_b32 m0, s14
    s_nop 0
    buffer_load_dwordx4 v[240:241], s[44:47], 0 idxen offen lds
L_ND11:
    v_rcp_f32 v230, v230
    v_mfma_f32_16x16x32_bf16 v[200:203], v[172:175], v[12:15], v[200:203]
    v_rcp_f32 v231, v231
    v_rcp_f32 v232, v232
    v_rcp_f32 v233, v233
    v_rcp_f32 v234, v234
    v_rcp_f32 v235, v235
    v_pk_mul_f32 v[204:205], v[220:221], v[204:205]
    v_pk_mul_f32 v[206:207], v[222:223], v[206:207]
    v_pk_mul_f32 v[208:209], v[224:225], v[208:209]
    v_pk_mul_f32 v[210:211], v[226:227], v[210:211]
    v_pk_mul_f32 v[212:213], v[228:229], v[212:213]
    v_pk_mul_f32 v[214:215], v[230:231], v[214:215]
    v_pk_mul_f32 v[216:217], v[232:233], v[216:217]
    v_pk_mul_f32 v[218:219], v[234:235], v[218:219]
    s_cmp_lt_u32 s16, s17
    s_cbranch_scc1 L_LOOP1
    s_branch L_LT0
.p2align 6
L_LOOP0:
    s_setprio 0
    v_smfmac_f32_16x16x64_bf16 v[152:155], v[184:187], v[204:211], v255
    ds_read_u16 v236, v251 offset:0
    ds_read_u16 v237, v251 offset:16
    ds_add_rtn_u32 v238, v246, v255
    v_exp_f32 v188, v188
    v_smfmac_f32_16x16x64_bf16 v[156:159], v[184:187], v[212:219], v255
    v_exp_f32 v189, v189
    v_mfma_f32_16x16x32_bf16 v[204:207], v[160:163], v[32:35], 0
    v_exp_f32 v190, v190
    v_mfma_f32_16x16x32_bf16 v[212:215], v[160:163], v[40:43], 0
    v_exp_f32 v191, v191
    v_mfma_f32_16x16x32_bf16 v[208:211], v[168:171], v[32:35], 0
    v_exp_f32 v192, v192
    v_mfma_f32_16x16x32_bf16 v[216:219], v[168:171], v[40:43], 0
    v_exp_f32 v193, v193
    v_mfma_f32_16x16x32_bf16 v[204:207], v[164:167], v[36:39], v[204:207]
    v_exp_f32 v194, v194
    v_mfma_f32_16x16x32_bf16 v[212:215], v[164:167], v[44:47], v[212:215]
    v_exp_f32 v195, v195
    v_mfma_f32_16x16x32_bf16 v[208:211], v[172:175], v[36:39], v[208:211]
    s_waitcnt lgkmcnt(0)
    v_bfi_b32 v236, 31, v246, v236
    v_bfi_b32 v237, 31, v246, v237
    v_readfirstlane_b32 s96, v238
    v_exp_f32 v196, v196
    v_mfma_f32_16x16x32_bf16 v[216:219], v[172:175], v[44:47], v[216:219]
    v_exp_f32 v197, v197
    v_smfmac_f32_16x16x64_bf16 v[136:139], v[184:187], v[220:227], v255
    v_exp_f32 v198, v198
    v_smfmac_f32_16x16x64_bf16 v[140:143], v[184:187], v[228:235], v255
    v_exp_f32 v199, v199
    v_mfma_f32_4x4x4_16b_bf16 v[188:191], v[242:243], v[242:243], v[188:191]
    v_exp_f32 v200, v200
    v_mfma_f32_4x4x4_16b_bf16 v[192:195], v[242:243], v[242:243], v[192:195]
    v_exp_f32 v201, v201
    v_mfma_f32_4x4x4_16b_bf16 v[196:199], v[242:243], v[242:243], v[196:199]
    v_exp_f32 v202, v202
    v_mfma_f32_16x16x32_bf16 v[220:223], v[176:179], v[72:75], 0
    ds_read_b64_tr_b16 v[184:185], v236
    ds_read_b64_tr_b16 v[186:187], v237
    ds_read_u16 v252, v250 offset:1152
    ds_read_u16 v253, v250 offset:1216
    v_exp_f32 v203, v203
    v_mfma_f32_16x16x32_bf16 v[228:231], v[176:179], v[76:79], 0
    s_ashr_i32 s96, s96, 24
    s_mul_i32 s96, s96, s101
    v_rcp_f32 v188, v188
    v_mfma_f32_16x16x32_bf16 v[224:227], v[180:183], v[72:75], 0
    v_rcp_f32 v189, v189
    v_mfma_f32_4x4x4_16b_bf16 v[200:203], v[242:243], v[242:243], v[200:203]
    v_rcp_f32 v190, v190
    v_mfma_f32_16x16x32_bf16 v[232:235], v[180:183], v[76:79], 0
    v_rcp_f32 v191, v191
    v_mfma_f32_16x16x32_bf16 v[220:223], v[160:163], v[16:19], v[220:223]
    v_rcp_f32 v192, v192
    v_mfma_f32_16x16x32_bf16 v[228:231], v[160:163], v[24:27], v[228:231]
    v_rcp_f32 v193, v193
    v_mfma_f32_16x16x32_bf16 v[224:227], v[168:171], v[16:19], v[224:227]
    s_waitcnt lgkmcnt(0)
    v_bfi_b32 v252, 31, v245, v252
    v_bfi_b32 v253, 31, v245, v253
    v_max_u32 v252, v252, v245
    v_max_u32 v253, v253, v247
    ds_read_b128 v[236:239], v248 offset:128
    ds_read_b32 v240, v249 offset:128
    s_add_u32 s16, s16, 1
    v_rcp_f32 v194, v194
    v_mfma_f32_16x16x32_bf16 v[232:235], v[168:171], v[24:27], v[232:235]
    v_rcp_f32 v195, v195
    v_mfma_f32_16x16x32_bf16 v[220:223], v[164:167], v[20:23], v[220:223]
    v_rcp_f32 v196, v196
    v_mfma_f32_16x16x32_bf16 v[228:231], v[164:167], v[28:31], v[228:231]
    v_rcp_f32 v197, v197
    s_setprio 3
    v_mfma_f32_16x16x32_bf16 v[224:227], v[172:175], v[20:23], v[224:227]
    v_rcp_f32 v198, v198
    v_mfma_f32_16x16x32_bf16 v[232:235], v[172:175], v[28:31], v[232:235]
    v_rcp_f32 v199, v199
    v_rcp_f32 v200, v200
    v_rcp_f32 v201, v201
    v_rcp_f32 v202, v202
    v_rcp_f32 v203, v203
    v_pk_mul_f32 v[204:205], v[188:189], v[204:205]
    v_pk_mul_f32 v[206:207], v[190:191], v[206:207]
    v_pk_mul_f32 v[208:209], v[192:193], v[208:209]
    v_pk_mul_f32 v[210:211], v[194:195], v[210:211]
    v_pk_mul_f32 v[212:213], v[196:197], v[212:213]
    v_pk_mul_f32 v[214:215], v[198:199], v[214:215]
    v_pk_mul_f32 v[216:217], v[200:201], v[216:217]
    v_pk_mul_f32 v[218:219], v[202:203], v[218:219]
    s_cmp_ge_i32 s96, 1
    s_cbranch_scc1 L_PB01
L_PB00:
    s_setprio 0
    v_smfmac_f32_16x16x64_bf16 v[112:115], v[184:187], v[204:211], v255
    v_exp_f32 v220, v220
    v_smfmac_f32_16x16x64_bf16 v[116:119], v[184:187], v[212:219], v255
    v_exp_f32 v221, v221
    s_waitcnt vmcnt(0)
    ds_read_b128 v[176:179], v252
    ds_read_b128 v[180:183], v253
    v_mfma_f32_16x16x32_bf16 v[204:207], v[160:163], v[48:51], 0
    v_exp_f32 v222, v222
    v_mfma_f32_16x16x32_bf16 v[212:215], v[160:163], v[56:59], 0
    ds_read_b128 v[160:163], v244 offset:0
    v_exp_f32 v223, v223
    v_mfma_f32_16x16x32_bf16 v[208:211], v[168:171], v[48:51], 0
    v_exp_f32 v224, v224
    v_mfma_f32_16x16x32_bf16 v[216:219], v[168:171], v[56:59], 0
    ds_read_b128 v[168:171], v244 offset:512
    v_exp_f32 v225, v225
    v_mfma_f32_16x16x32_bf16 v[204:207], v[164:167], v[52:55], v[204:207]
    v_exp_f32 v226, v226
    v_mfma_f32_16x16x32_bf16 v[212:215], v[164:167], v[60:63], v[212:215]
    ds_read_b128 v[164:167], v244 offset:64
    v_exp_f32 v227, v227
    v_mfma_f32_16x16x32_bf16 v[208:211], v[172:175], v[52:55], v[208:211]
    v_exp_f32 v228, v228
    v_mfma_f32_16x16x32_bf16 v[216:219], v[172:175], v[60:63], v[216:219]
    ds_read_b128 v[172:175], v244 offset:576
    v_exp_f32 v229, v229
    v_smfmac_f32_16x16x64_bf16 v[96:99], v[184:187], v[188:195], v255
    v_exp_f32 v230, v230
    v_smfmac_f32_16x16x64_bf16 v[100:103], v[184:187], v[196:203], v255
    v_exp_f32 v231, v231
    v_mfma_f32_4x4x4_16b_bf16 v[220:223], v[242:243], v[242:243], v[220:223]
    v_exp_f32 v232, v232
    v_mfma_f32_4x4x4_16b_bf16 v[224:227], v[242:243], v[242:243], v[224:227]
    v_exp_f32 v233, v233
    v_mfma_f32_4x4x4_16b_bf16 v[228:231], v[242:243], v[242:243], v[228:231]
    v_exp_f32 v234, v234
    s_waitcnt lgkmcnt(4)
    v_mfma_f32_16x16x32_bf16 v[188:191], v[176:179], v[80:83], 0
    v_exp_f32 v235, v235
    v_mfma_f32_16x16x32_bf16 v[196:199], v[176:179], v[84:87], 0
    v_rcp_f32 v220, v220
    v_mfma_f32_16x16x32_bf16 v[192:195], v[180:183], v[80:83], 0
    v_rcp_f32 v221, v221
    v_mfma_f32_4x4x4_16b_bf16 v[232:235], v[242:243], v[242:243], v[232:235]
    v_rcp_f32 v222, v222
    v_mfma_f32_16x16x32_bf16 v[200:203], v[180:183], v[84:87], 0
    v_rcp_f32 v223, v223
    s_waitcnt lgkmcnt(3)
    v_mfma_f32_16x16x32_bf16 v[188:191], v[160:163], v[0:3], v[188:191]
    v_rcp_f32 v224, v224
    v_mfma_f32_16x16x32_bf16 v[196:199], v[160:163], v[8:11], v[196:199]
    v_rcp_f32 v225, v225
    s_waitcnt lgkmcnt(2)
    v_mfma_f32_16x16x32_bf16 v[192:195], v[168:171], v[0:3], v[192:195]
    v_rcp_f32 v226, v226
    v_mfma_f32_16x16x32_bf16 v[200:203], v[168:171], v[8:11], v[200:203]
    v_rcp_f32 v227, v227
    s_waitcnt lgkmcnt(1)
    v_mfma_f32_16x16x32_bf16 v[188:191], v[164:167], v[4:7], v[188:191]
    v_rcp_f32 v228, v228
    v_mfma_f32_16x16x32_bf16 v[196:199], v[164:167], v[12:15], v[196:199]
    v_rcp_f32 v229, v229
    s_setprio 3
    s_waitcnt lgkmcnt(0)
    v_mfma_f32_16x16x32_bf16 v[192:195], v[172:175], v[4:7], v[192:195]
    s_cmp_lt_u32 s16, s17
    s_cbranch_scc0 L_ND00
    s_add_u32 m0, s13, 0
    v_mad_u32_u16 v236, v236, s15, v243
    buffer_load_dwordx4 v236, s[40:43], 0 offen lds
    s_add_u32 m0, s13, 1056
    v_mad_u32_u16 v237, v237, s15, v243
    buffer_load_dwordx4 v237, s[40:43], 0 offen lds
    s_add_u32 m0, s13, 2112
    v_mad_u32_u16 v238, v238, s15, v243
    buffer_load_dwordx4 v238, s[40:43], 0 offen lds
    s_add_u32 m0, s13, 3168
    v_mad_u32_u16 v239, v239, s15, v243
    buffer_load_dwordx4 v239, s[40:43], 0 offen lds
    s_mov_b32 m0, s14
    s_nop 0
    buffer_load_dwordx4 v[240:241], s[44:47], 0 idxen offen lds
L_ND00:
    v_rcp_f32 v230, v230
    v_mfma_f32_16x16x32_bf16 v[200:203], v[172:175], v[12:15], v[200:203]
    v_rcp_f32 v231, v231
    v_rcp_f32 v232, v232
    v_rcp_f32 v233, v233
    v_rcp_f32 v234, v234
    v_rcp_f32 v235, v235
    v_pk_mul_f32 v[204:205], v[220:221], v[204:205]
    v_pk_mul_f32 v[206:207], v[222:223], v[206:207]
    v_pk_mul_f32 v[208:209], v[224:225], v[208:209]
    v_pk_mul_f32 v[210:211], v[226:227], v[210:211]
    v_pk_mul_f32 v[212:213], v[228:229], v[212:213]
    v_pk_mul_f32 v[214:215], v[230:231], v[214:215]
    v_pk_mul_f32 v[216:217], v[232:233], v[216:217]
    v_pk_mul_f32 v[218:219], v[234:235], v[218:219]
    s_cmp_ge_u32 s16, s17
    s_cbranch_scc1 L_LT1
    s_setprio 0
    v_smfmac_f32_16x16x64_bf16 v[120:123], v[184:187], v[204:211], v255
    ds_read_u16 v236, v251 offset:1152
    ds_read_u16 v237, v251 offset:1168
    ds_add_rtn_u32 v238, v246, v255
    v_exp_f32 v188, v188
    v_smfmac_f32_16x16x64_bf16 v[124:127], v[184:187], v[212:219], v255
    v_exp_f32 v189, v189
    v_mfma_f32_16x16x32_bf16 v[204:207], v[160:163], v[32:35], 0
    v_exp_f32 v190, v190
    v_mfma_f32_16x16x32_bf16 v[212:215], v[160:163], v[40:43], 0
    v_exp_f32 v191, v191
    v_mfma_f32_16x16x32_bf16 v[208:211], v[168:171], v[32:35], 0
    v_exp_f32 v192, v192
    v_mfma_f32_16x16x32_bf16 v[216:219], v[168:171], v[40:43], 0
    v_exp_f32 v193, v193
    v_mfma_f32_16x16x32_bf16 v[204:207], v[164:167], v[36:39], v[204:207]
    v_exp_f32 v194, v194
    v_mfma_f32_16x16x32_bf16 v[212:215], v[164:167], v[44:47], v[212:215]
    v_exp_f32 v195, v195
    v_mfma_f32_16x16x32_bf16 v[208:211], v[172:175], v[36:39], v[208:211]
    s_waitcnt lgkmcnt(0)
    v_bfi_b32 v236, 31, v246, v236
    v_bfi_b32 v237, 31, v246, v237
    v_readfirstlane_b32 s96, v238
    v_exp_f32 v196, v196
    v_mfma_f32_16x16x32_bf16 v[216:219], v[172:175], v[44:47], v[216:219]
    v_exp_f32 v197, v197
    v_smfmac_f32_16x16x64_bf16 v[104:107], v[184:187], v[220:227], v255
    v_exp_f32 v198, v198
    v_smfmac_f32_16x16x64_bf16 v[108:111], v[184:187], v[228:235], v255
    v_exp_f32 v199, v199
    v_mfma_f32_4x4x4_16b_bf16 v[188:191], v[242:243], v[242:243], v[188:191]
    v_exp_f32 v200, v200
    v_mfma_f32_4x4x4_16b_bf16 v[192:195], v[242:243], v[242:243], v[192:195]
    v_exp_f32 v201, v201
    v_mfma_f32_4x4x4_16b_bf16 v[196:199], v[242:243], v[242:243], v[196:199]
    v_exp_f32 v202, v202
    v_mfma_f32_16x16x32_bf16 v[220:223], v[176:179], v[88:91], 0
    ds_read_b64_tr_b16 v[184:185], v236
    ds_read_b64_tr_b16 v[186:187], v237
    ds_read_u16 v252, v250 offset:128
    ds_read_u16 v253, v250 offset:192
    v_exp_f32 v203, v203
    v_mfma_f32_16x16x32_bf16 v[228:231], v[176:179], v[92:95], 0
    s_ashr_i32 s96, s96, 24
    s_mul_i32 s96, s96, s101
    v_rcp_f32 v188, v188
    v_mfma_f32_16x16x32_bf16 v[224:227], v[180:183], v[88:91], 0
    v_rcp_f32 v189, v189
    v_mfma_f32_4x4x4_16b_bf16 v[200:203], v[242:243], v[242:243], v[200:203]
    v_rcp_f32 v190, v190
    v_mfma_f32_16x16x32_bf16 v[232:235], v[180:183], v[92:95], 0
    v_rcp_f32 v191, v191
    v_mfma_f32_16x16x32_bf16 v[220:223], v[160:163], v[16:19], v[220:223]
    v_rcp_f32 v192, v192
    v_mfma_f32_16x16x32_bf16 v[228:231], v[160:163], v[24:27], v[228:231]
    v_rcp_f32 v193, v193
    v_mfma_f32_16x16x32_bf16 v[224:227], v[168:171], v[16:19], v[224:227]
    s_waitcnt lgkmcnt(0)
    v_bfi_b32 v252, 31, v245, v252
    v_bfi_b32 v253, 31, v245, v253
    v_max_u32 v252, v252, v245
    v_max_u32 v253, v253, v247
    ds_read_b128 v[236:239], v248 offset:1280
    ds_read_b32 v240, v249 offset:1280
    s_add_u32 s16, s16, 1
    v_rcp_f32 v194, v194
    v_mfma_f32_16x16x32_bf16 v[232:235], v[168:171], v[24:27], v[232:235]
    v_lshl_add_u64 v[248:249], v[248:249], 0, s[94:95]
    v_lshl_add_u64 v[250:251], v[250:251], 0, s[94:95]
    v_rcp_f32 v195, v195
    v_mfma_f32_16x16x32_bf16 v[220:223], v[164:167], v[20:23], v[220:223]
    v_rcp_f32 v196, v196
    v_mfma_f32_16x16x32_bf16 v[228:231], v[164:167], v[28:31], v[228:231]
    v_rcp_f32 v197, v197
    s_setprio 3
    v_mfma_f32_16x16x32_bf16 v[224:227], v[172:175], v[20:23], v[224:227]
    v_rcp_f32 v198, v198
    v_mfma_f32_16x16x32_bf16 v[232:235], v[172:175], v[28:31], v[232:235]
    v_rcp_f32 v199, v199
    v_rcp_f32 v200, v200
    v_rcp_f32 v201, v201
    v_rcp_f32 v202, v202
    v_rcp_f32 v203, v203
    v_pk_mul_f32 v[204:205], v[188:189], v[204:205]
    v_pk_mul_f32 v[206:207], v[190:191], v[206:207]
    v_pk_mul_f32 v[208:209], v[192:193], v[208:209]
    v_pk_mul_f32 v[210:211], v[194:195], v[210:211]
    v_pk_mul_f32 v[212:213], v[196:197], v[212:213]
    v_pk_mul_f32 v[214:215], v[198:199], v[214:215]
    v_pk_mul_f32 v[216:217], v[200:201], v[216:217]
    v_pk_mul_f32 v[218:219], v[202:203], v[218:219]
    s_cmp_ge_i32 s96, 1
    s_cbranch_scc1 L_PB11
L_PB10:
    s_setprio 0
    v_smfmac_f32_16x16x64_bf16 v[144:147], v[184:187], v[204:211], v255
    v_exp_f32 v220, v220
    v_smfmac_f32_16x16x64_bf16 v[148:151], v[184:187], v[212:219], v255
    v_exp_f32 v221, v221
    s_waitcnt vmcnt(0)
    ds_read_b128 v[176:179], v252
    ds_read_b128 v[180:183], v253
    v_mfma_f32_16x16x32_bf16 v[204:207], v[160:163], v[48:51], 0
    v_exp_f32 v222, v222
    v_mfma_f32_16x16x32_bf16 v[212:215], v[160:163], v[56:59], 0
    ds_read_b128 v[160:163], v244 offset:0
    v_exp_f32 v223, v223
    v_mfma_f32_16x16x32_bf16 v[208:211], v[168:171], v[48:51], 0
    v_exp_f32 v224, v224
    v_mfma_f32_16x16x32_bf16 v[216:219], v[168:171], v[56:59], 0
    ds_read_b128 v[168:171], v244 offset:512
    v_exp_f32 v225, v225
    v_mfma_f32_16x16x32_bf16 v[204:207], v[164:167], v[52:55], v[204:207]
    v_exp_f32 v226, v226
    v_mfma_f32_16x16x32_bf16 v[212:215], v[164:167], v[60:63], v[212:215]
    ds_read_b128 v[164:167], v244 offset:64
    v_exp_f32 v227, v227
    v_mfma_f32_16x16x32_bf16 v[208:211], v[172:175], v[52:55], v[208:211]
    v_exp_f32 v228, v228
    v_mfma_f32_16x16x32_bf16 v[216:219], v[172:175], v[60:63], v[216:219]
    ds_read_b128 v[172:175], v244 offset:576
    v_exp_f32 v229, v229
    v_smfmac_f32_16x16x64_bf16 v[128:131], v[184:187], v[188:195], v255
    v_exp_f32 v230, v230
    v_smfmac_f32_16x16x64_bf16 v[132:135], v[184:187], v[196:203], v255
    v_exp_f32 v231, v231
    v_mfma_f32_4x4x4_16b_bf16 v[220:223], v[242:243], v[242:243], v[220:223]
    v_exp_f32 v232, v232
    v_mfma_f32_4x4x4_16b_bf16 v[224:227], v[242:243], v[242:243], v[224:227]
    v_exp_f32 v233, v233
    v_mfma_f32_4x4x4_16b_bf16 v[228:231], v[242:243], v[242:243], v[228:231]
    v_exp_f32 v234, v234
    s_waitcnt lgkmcnt(4)
    v_mfma_f32_16x16x32_bf16 v[188:191], v[176:179], v[64:67], 0
    v_exp_f32 v235, v235
    v_mfma_f32_16x16x32_bf16 v[196:199], v[176:179], v[68:71], 0
    v_rcp_f32 v220, v220
    v_mfma_f32_16x16x32_bf16 v[192:195], v[180:183], v[64:67], 0
    v_rcp_f32 v221, v221
    v_mfma_f32_4x4x4_16b_bf16 v[232:235], v[242:243], v[242:243], v[232:235]
    v_rcp_f32 v222, v222
    v_mfma_f32_16x16x32_bf16 v[200:203], v[180:183], v[68:71], 0
    v_rcp_f32 v223, v223
    s_waitcnt lgkmcnt(3)
    v_mfma_f32_16x16x32_bf16 v[188:191], v[160:163], v[0:3], v[188:191]
    v_rcp_f32 v224, v224
    v_mfma_f32_16x16x32_bf16 v[196:199], v[160:163], v[8:11], v[196:199]
    v_rcp_f32 v225, v225
    s_waitcnt lgkmcnt(2)
    v_mfma_f32_16x16x32_bf16 v[192:195], v[168:171], v[0:3], v[192:195]
    v_rcp_f32 v226, v226
    v_mfma_f32_16x16x32_bf16 v[200:203], v[168:171], v[8:11], v[200:203]
    v_rcp_f32 v227, v227
    s_waitcnt lgkmcnt(1)
    v_mfma_f32_16x16x32_bf16 v[188:191], v[164:167], v[4:7], v[188:191]
    v_rcp_f32 v228, v228
    v_mfma_f32_16x16x32_bf16 v[196:199], v[164:167], v[12:15], v[196:199]
    v_rcp_f32 v229, v229
    s_setprio 3
    s_waitcnt lgkmcnt(0)
    v_mfma_f32_16x16x32_bf16 v[192:195], v[172:175], v[4:7], v[192:195]
    s_cmp_lt_u32 s16, s17
    s_cbranch_scc0 L_ND10
    s_add_u32 m0, s13, 0
    v_mad_u32_u16 v236, v236, s15, v243
    buffer_load_dwordx4 v236, s[40:43], 0 offen lds
    s_add_u32 m0, s13, 1056
    v_mad_u32_u16 v237, v237, s15, v243
    buffer_load_dwordx4 v237, s[40:43], 0 offen lds
    s_add_u32 m0, s13, 2112
    v_mad_u32_u16 v238, v238, s15, v243
    buffer_load_dwordx4 v238, s[40:43], 0 offen lds
    s_add_u32 m0, s13, 3168
    v_mad_u32_u16 v239, v239, s15, v243
    buffer_load_dwordx4 v239, s[40:43], 0 offen lds
    s_mov_b32 m0, s14
    s_nop 0
    buffer_load_dwordx4 v[240:241], s[44:47], 0 idxen offen lds
L_ND10:
    v_rcp_f32 v230, v230
    v_mfma_f32_16x16x32_bf16 v[200:203], v[172:175], v[12:15], v[200:203]
    v_rcp_f32 v231, v231
    v_rcp_f32 v232, v232
    v_rcp_f32 v233, v233
    v_rcp_f32 v234, v234
    v_rcp_f32 v235, v235
    v_pk_mul_f32 v[204:205], v[220:221], v[204:205]
    v_pk_mul_f32 v[206:207], v[222:223], v[206:207]
    v_pk_mul_f32 v[208:209], v[224:225], v[208:209]
    v_pk_mul_f32 v[210:211], v[226:227], v[210:211]
    v_pk_mul_f32 v[212:213], v[228:229], v[212:213]
    v_pk_mul_f32 v[214:215], v[230:231], v[214:215]
    v_pk_mul_f32 v[216:217], v[232:233], v[216:217]
    v_pk_mul_f32 v[218:219], v[234:235], v[218:219]
    s_cmp_lt_u32 s16, s17
    s_cbranch_scc1 L_LOOP0
    s_branch L_LT0
L_LT0:
    s_cmp_lg_u32 s99, 0
    s_cbranch_scc1 L_LH0
    s_setprio 0
    v_smfmac_f32_16x16x64_bf16 v[152:155], v[184:187], v[204:211], v255
    ds_read_u16 v236, v251 offset:0
    ds_read_u16 v237, v251 offset:16
    v_exp_f32 v188, v188
    v_smfmac_f32_16x16x64_bf16 v[156:159], v[184:187], v[212:219], v255
    v_exp_f32 v189, v189
    v_mfma_f32_16x16x32_bf16 v[204:207], v[160:163], v[32:35], 0
    v_exp_f32 v190, v190
    v_mfma_f32_16x16x32_bf16 v[212:215], v[160:163], v[40:43], 0
    v_exp_f32 v191, v191
    v_mfma_f32_16x16x32_bf16 v[208:211], v[168:171], v[32:35], 0
    v_exp_f32 v192, v192
    v_mfma_f32_16x16x32_bf16 v[216:219], v[168:171], v[40:43], 0
    v_exp_f32 v193, v193
    v_mfma_f32_16x16x32_bf16 v[204:207], v[164:167], v[36:39], v[204:207]
    v_exp_f32 v194, v194
    v_mfma_f32_16x16x32_bf16 v[212:215], v[164:167], v[44:47], v[212:215]
    v_exp_f32 v195, v195
    v_mfma_f32_16x16x32_bf16 v[208:211], v[172:175], v[36:39], v[208:211]
    v_exp_f32 v196, v196
    v_mfma_f32_16x16x32_bf16 v[216:219], v[172:175], v[44:47], v[216:219]
    v_exp_f32 v197, v197
    v_smfmac_f32_16x16x64_bf16 v[136:139], v[184:187], v[220:227], v255
    s_waitcnt lgkmcnt(0)
    v_bfi_b32 v236, 31, v246, v236
    v_bfi_b32 v237, 31, v246, v237
    v_exp_f32 v198, v198
    s_setprio 3
    v_smfmac_f32_16x16x64_bf16 v[140:143], v[184:187], v[228:235], v255
    v_exp_f32 v199, v199
    v_exp_f32 v200, v200
    v_exp_f32 v201, v201
    v_exp_f32 v202, v202
    v_exp_f32 v203, v203
    v_pk_add_f32 v[188:189], v[188:189], 1.0 op_sel_hi:[1,0]
    v_pk_add_f32 v[190:191], v[190:191], 1.0 op_sel_hi:[1,0]
    v_pk_add_f32 v[192:193], v[192:193], 1.0 op_sel_hi:[1,0]
    v_pk_add_f32 v[194:195], v[194:195], 1.0 op_sel_hi:[1,0]
    v_pk_add_f32 v[196:197], v[196:197], 1.0 op_sel_hi:[1,0]
    v_pk_add_f32 v[198:199], v[198:199], 1.0 op_sel_hi:[1,0]
    v_pk_add_f32 v[200:201], v[200:201], 1.0 op_sel_hi:[1,0]
    v_pk_add_f32 v[202:203], v[202:203], 1.0 op_sel_hi:[1,0]
    s_setprio 0
    v_mfma_f32_16x16x32_bf16 v[220:223], v[176:179], v[72:75], 0
    ds_read_b64_tr_b16 v[184:185], v236
    ds_read_b64_tr_b16 v[186:187], v237
    v_rcp_f32 v188, v188
    v_mfma_f32_16x16x32_bf16 v[228:231], v[176:179], v[76:79], 0
    v_rcp_f32 v189, v189
    v_mfma_f32_16x16x32_bf16 v[224:227], v[180:183], v[72:75], 0
    v_rcp_f32 v190, v190
    v_mfma_f32_16x16x32_bf16 v[232:235], v[180:183], v[76:79], 0
    v_rcp_f32 v191, v191
    v_mfma_f32_16x16x32_bf16 v[220:223], v[160:163], v[16:19], v[220:223]
    v_rcp_f32 v192, v192
    v_mfma_f32_16x16x32_bf16 v[228:231], v[160:163], v[24:27], v[228:231]
    v_rcp_f32 v193, v193
    v_mfma_f32_16x16x32_bf16 v[224:227], v[168:171], v[16:19], v[224:227]
    v_rcp_f32 v194, v194
    v_mfma_f32_16x16x32_bf16 v[232:235], v[168:171], v[24:27], v[232:235]
    v_rcp_f32 v195, v195
    v_mfma_f32_16x16x32_bf16 v[220:223], v[164:167], v[20:23], v[220:223]
    v_rcp_f32 v196, v196
    v_mfma_f32_16x16x32_bf16 v[228:231], v[164:167], v[28:31], v[228:231]
    v_rcp_f32 v197, v197
    v_mfma_f32_16x16x32_bf16 v[224:227], v[172:175], v[20:23], v[224:227]
    v_rcp_f32 v198, v198
    s_setprio 3
    v_mfma_f32_16x16x32_bf16 v[232:235], v[172:175], v[28:31], v[232:235]
    v_rcp_f32 v199, v199
    v_rcp_f32 v200, v200
    v_rcp_f32 v201, v201
    v_rcp_f32 v202, v202
    v_rcp_f32 v203, v203
    v_pk_mul_f32 v[204:205], v[188:189], v[204:205]
    v_pk_mul_f32 v[206:207], v[190:191], v[206:207]
    v_pk_mul_f32 v[208:209], v[192:193], v[208:209]
    v_pk_mul_f32 v[210:211], v[194:195], v[210:211]
    v_pk_mul_f32 v[212:213], v[196:197], v[212:213]
    v_pk_mul_f32 v[214:215], v[198:199], v[214:215]
    v_pk_mul_f32 v[216:217], v[200:201], v[216:217]
    v_pk_mul_f32 v[218:219], v[202:203], v[218:219]
    s_setprio 0
    s_waitcnt lgkmcnt(0)
    v_smfmac_f32_16x16x64_bf16 v[112:115], v[184:187], v[204:211], v255
    v_exp_f32 v220, v220
    v_smfmac_f32_16x16x64_bf16 v[116:119], v[184:187], v[212:219], v255
    v_exp_f32 v221, v221
    v_mfma_f32_16x16x32_bf16 v[204:207], v[160:163], v[48:51], 0
    v_exp_f32 v222, v222
    v_mfma_f32_16x16x32_bf16 v[212:215], v[160:163], v[56:59], 0
    v_exp_f32 v223, v223
    v_mfma_f32_16x16x32_bf16 v[208:211], v[168:171], v[48:51], 0
    v_exp_f32 v224, v224
    v_mfma_f32_16x16x32_bf16 v[216:219], v[168:171], v[56:59], 0
    v_exp_f32 v225, v225
    v_mfma_f32_16x16x32_bf16 v[204:207], v[164:167], v[52:55], v[204:207]
    v_exp_f32 v226, v226
    v_mfma_f32_16x16x32_bf16 v[212:215], v[164:167], v[60:63], v[212:215]
    v_exp_f32 v227, v227
    v_mfma_f32_16x16x32_bf16 v[208:211], v[172:175], v[52:55], v[208:211]
    v_exp_f32 v228, v228
    v_mfma_f32_16x16x32_bf16 v[216:219], v[172:175], v[60:63], v[216:219]
    v_exp_f32 v229, v229
    v_smfmac_f32_16x16x64_bf16 v[96:99], v[184:187], v[188:195], v255
    v_exp_f32 v230, v230
    s_setprio 3
    v_smfmac_f32_16x16x64_bf16 v[100:103], v[184:187], v[196:203], v255
    v_exp_f32 v231, v231
    v_exp_f32 v232, v232
    v_exp_f32 v233, v233
    v_exp_f32 v234, v234
    v_exp_f32 v235, v235
    v_pk_add_f32 v[220:221], v[220:221], 1.0 op_sel_hi:[1,0]
    v_pk_add_f32 v[222:223], v[222:223], 1.0 op_sel_hi:[1,0]
    v_pk_add_f32 v[224:225], v[224:225], 1.0 op_sel_hi:[1,0]
    v_pk_add_f32 v[226:227], v[226:227], 1.0 op_sel_hi:[1,0]
    v_pk_add_f32 v[228:229], v[228:229], 1.0 op_sel_hi:[1,0]
    v_pk_add_f32 v[230:231], v[230:231], 1.0 op_sel_hi:[1,0]
    v_pk_add_f32 v[232:233], v[232:233], 1.0 op_sel_hi:[1,0]
    v_pk_add_f32 v[234:235], v[234:235], 1.0 op_sel_hi:[1,0]
    s_setprio 0
    v_rcp_f32 v220, v220
    v_rcp_f32 v221, v221
    v_rcp_f32 v222, v222
    v_rcp_f32 v223, v223
    v_rcp_f32 v224, v224
    v_rcp_f32 v225, v225
    v_rcp_f32 v226, v226
    v_rcp_f32 v227, v227
    v_rcp_f32 v228, v228
    v_rcp_f32 v229, v229
    v_rcp_f32 v230, v230
    v_rcp_f32 v231, v231
    v_rcp_f32 v232, v232
    v_rcp_f32 v233, v233
    v_rcp_f32 v234, v234
    v_rcp_f32 v235, v235
    v_pk_mul_f32 v[204:205], v[220:221], v[204:205]
    v_pk_mul_f32 v[206:207], v[222:223], v[206:207]
    v_pk_mul_f32 v[208:209], v[224:225], v[208:209]
    v_pk_mul_f32 v[210:211], v[226:227], v[210:211]
    v_pk_mul_f32 v[212:213], v[228:229], v[212:213]
    v_pk_mul_f32 v[214:215], v[230:231], v[214:215]
    v_pk_mul_f32 v[216:217], v[232:233], v[216:217]
    v_pk_mul_f32 v[218:219], v[234:235], v[218:219]
    v_smfmac_f32_16x16x64_bf16 v[104:107], v[184:187], v[220:227], v255
    v_smfmac_f32_16x16x64_bf16 v[108:111], v[184:187], v[228:235], v255
    v_smfmac_f32_16x16x64_bf16 v[120:123], v[184:187], v[204:211], v255
    v_smfmac_f32_16x16x64_bf16 v[124:127], v[184:187], v[212:219], v255
    s_branch L_DONE
L_LH0:
    s_setprio 0
    v_smfmac_f32_16x16x64_bf16 v[152:155], v[184:187], v[204:211], v255
    ds_read_u16 v236, v251 offset:0
    ds_read_u16 v237, v251 offset:16
    v_smfmac_f32_16x16x64_bf16 v[156:159], v[184:187], v[212:219], v255
    v_exp_f32 v188, v188
    v_mfma_f32_16x16x32_bf16 v[204:207], v[160:163], v[32:35], 0
    v_mfma_f32_16x16x32_bf16 v[212:215], v[160:163], v[40:43], 0
    v_exp_f32 v189, v189
    v_mfma_f32_16x16x32_bf16 v[204:207], v[164:167], v[36:39], v[204:207]
    v_mfma_f32_16x16x32_bf16 v[212:215], v[164:167], v[44:47], v[212:215]
    v_exp_f32 v190, v190
    v_smfmac_f32_16x16x64_bf16 v[136:139], v[184:187], v[220:227], v255
    s_waitcnt lgkmcnt(0)
    v_bfi_b32 v236, 31, v246, v236
    v_bfi_b32 v237, 31, v246, v237
    v_exp_f32 v191, v191
    s_setprio 3
    v_smfmac_f32_16x16x64_bf16 v[140:143], v[184:187], v[228:235], v255
    v_exp_f32 v196, v196
    v_exp_f32 v197, v197
    v_exp_f32 v198, v198
    v_exp_f32 v199, v199
    v_pk_add_f32 v[188:189], v[188:189], 1.0 op_sel_hi:[1,0]
    v_pk_add_f32 v[190:191], v[190:191], 1.0 op_sel_hi:[1,0]
    v_pk_add_f32 v[196:197], v[196:197], 1.0 op_sel_hi:[1,0]
    v_pk_add_f32 v[198:199], v[198:199], 1.0 op_sel_hi:[1,0]
    s_setprio 0
    v_mfma_f32_16x16x32_bf16 v[220:223], v[176:179], v[72:75], 0
    ds_read_b64_tr_b16 v[184:185], v236
    ds_read_b64_tr_b16 v[186:187], v237
    v_mfma_f32_16x16x32_bf16 v[228:231], v[176:179], v[76:79], 0
    v_rcp_f32 v188, v188
    v_mfma_f32_16x16x32_bf16 v[220:223], v[160:163], v[16:19], v[220:223]
    v_rcp_f32 v189, v189
    v_mfma_f32_16x16x32_bf16 v[228:231], v[160:163], v[24:27], v[228:231]
    v_rcp_f32 v190, v190
    v_mfma_f32_16x16x32_bf16 v[220:223], v[164:167], v[20:23], v[220:223]
    v_rcp_f32 v191, v191
    s_setprio 3
    v_mfma_f32_16x16x32_bf16 v[228:231], v[164:167], v[28:31], v[228:231]
    v_rcp_f32 v196, v196
    v_rcp_f32 v197, v197
    v_rcp_f32 v198, v198
    v_rcp_f32 v199, v199
    v_pk_mul_f32 v[204:205], v[188:189], v[204:205]
    v_pk_mul_f32 v[206:207], v[190:191], v[206:207]
    v_pk_mul_f32 v[212:213], v[196:197], v[212:213]
    v_pk_mul_f32 v[214:215], v[198:199], v[214:215]
    s_setprio 0
    s_waitcnt lgkmcnt(0)
    v_smfmac_f32_16x16x64_bf16 v[112:115], v[184:187], v[204:211], v255
    v_smfmac_f32_16x16x64_bf16 v[116:119], v[184:187], v[212:219], v255
    v_exp_f32 v220, v220
    v_mfma_f32_16x16x32_bf16 v[204:207], v[160:163], v[48:51], 0
    v_mfma_f32_16x16x32_bf16 v[212:215], v[160:163], v[56:59], 0
    v_exp_f32 v221, v221
    v_mfma_f32_16x16x32_bf16 v[204:207], v[164:167], v[52:55], v[204:207]
    v_mfma_f32_16x16x32_bf16 v[212:215], v[164:167], v[60:63], v[212:215]
    v_exp_f32 v222, v222
    v_smfmac_f32_16x16x64_bf16 v[96:99], v[184:187], v[188:195], v255
    v_exp_f32 v223, v223
    s_setprio 3
    v_smfmac_f32_16x16x64_bf16 v[100:103], v[184:187], v[196:203], v255
    v_exp_f32 v228, v228
    v_exp_f32 v229, v229
    v_exp_f32 v230, v230
    v_exp_f32 v231, v231
    v_pk_add_f32 v[220:221], v[220:221], 1.0 op_sel_hi:[1,0]
    v_pk_add_f32 v[222:223], v[222:223], 1.0 op_sel_hi:[1,0]
    v_pk_add_f32 v[228:229], v[228:229], 1.0 op_sel_hi:[1,0]
    v_pk_add_f32 v[230:231], v[230:231], 1.0 op_sel_hi:[1,0]
    s_setprio 0
    v_rcp_f32 v220, v220
    v_rcp_f32 v221, v221
    v_rcp_f32 v222, v222
    v_rcp_f32 v223, v223
    v_rcp_f32 v228, v228
    v_rcp_f32 v229, v229
    v_rcp_f32 v230, v230
    v_rcp_f32 v231, v231
    v_pk_mul_f32 v[204:205], v[220:221], v[204:205]
    v_pk_mul_f32 v[206:207], v[222:223], v[206:207]
    v_pk_mul_f32 v[212:213], v[228:229], v[212:213]
    v_pk_mul_f32 v[214:215], v[230:231], v[214:215]
    v_smfmac_f32_16x16x64_bf16 v[104:107], v[184:187], v[220:227], v255
    v_smfmac_f32_16x16x64_bf16 v[108:111], v[184:187], v[228:235], v255
    v_smfmac_f32_16x16x64_bf16 v[120:123], v[184:187], v[204:211], v255
    v_smfmac_f32_16x16x64_bf16 v[124:127], v[184:187], v[212:219], v255
    s_branch L_DONE
L_LT1:
    s_cmp_lg_u32 s99, 0
    s_cbranch_scc1 L_LH1
    s_setprio 0
    v_smfmac_f32_16x16x64_bf16 v[120:123], v[184:187], v[204:211], v255
    ds_read_u16 v236, v251 offset:1152
    ds_read_u16 v237, v251 offset:1168
    v_exp_f32 v188, v188
    v_smfmac_f32_16x16x64_bf16 v[124:127], v[184:187], v[212:219], v255
    v_exp_f32 v189, v189
    v_mfma_f32_16x16x32_bf16 v[204:207], v[160:163], v[32:35], 0
    v_exp_f32 v190, v190
    v_mfma_f32_16x16x32_bf16 v[212:215], v[160:163], v[40:43], 0
    v_exp_f32 v191, v191
    v_mfma_f32_16x16x32_bf16 v[208:211], v[168:171], v[32:35], 0
    v_exp_f32 v192, v192
    v_mfma_f32_16x16x32_bf16 v[216:219], v[168:171], v[40:43], 0
    v_exp_f32 v193, v193
    v_mfma_f32_16x16x32_bf16 v[204:207], v[164:167], v[36:39], v[204:207]
    v_exp_f32 v194, v194
    v_mfma_f32_16x16x32_bf16 v[212:215], v[164:167], v[44:47], v[212:215]
    v_exp_f32 v195, v195
    v_mfma_f32_16x16x32_bf16 v[208:211], v[172:175], v[36:39], v[208:211]
    v_exp_f32 v196, v196
    v_mfma_f32_16x16x32_bf16 v[216:219], v[172:175], v[44:47], v[216:219]
    v_exp_f32 v197, v197
    v_smfmac_f32_16x16x64_bf16 v[104:107], v[184:187], v[220:227], v255
    s_waitcnt lgkmcnt(0)
    v_bfi_b32 v236, 31, v246, v236
    v_bfi_b32 v237, 31, v246, v237
    v_exp_f32 v198, v198
    s_setprio 3
    v_smfmac_f32_16x16x64_bf16 v[108:111], v[184:187], v[228:235], v255
    v_exp_f32 v199, v199
    v_exp_f32 v200, v200
    v_exp_f32 v201, v201
    v_exp_f32 v202, v202
    v_exp_f32 v203, v203
    v_pk_add_f32 v[188:189], v[188:189], 1.0 op_sel_hi:[1,0]
    v_pk_add_f32 v[190:191], v[190:191], 1.0 op_sel_hi:[1,0]
    v_pk_add_f32 v[192:193], v[192:193], 1.0 op_sel_hi:[1,0]
    v_pk_add_f32 v[194:195], v[194:195], 1.0 op_sel_hi:[1,0]
    v_pk_add_f32 v[196:197], v[196:197], 1.0 op_sel_hi:[1,0]
    v_pk_add_f32 v[198:199], v[198:199], 1.0 op_sel_hi:[1,0]
    v_pk_add_f32 v[200:201], v[200:201], 1.0 op_sel_hi:[1,0]
    v_pk_add_f32 v[202:203], v[202:203], 1.0 op_sel_hi:[1,0]
    s_setprio 0
    v_mfma_f32_16x16x32_bf16 v[220:223], v[176:179], v[88:91], 0
    ds_read_b64_tr_b16 v[184:185], v236
    ds_read_b64_tr_b16 v[186:187], v237
    v_rcp_f32 v188, v188
    v_mfma_f32_16x16x32_bf16 v[228:231], v[176:179], v[92:95], 0
    v_rcp_f32 v189, v189
    v_mfma_f32_16x16x32_bf16 v[224:227], v[180:183], v[88:91], 0
    v_rcp_f32 v190, v190
    v_mfma_f32_16x16x32_bf16 v[232:235], v[180:183], v[92:95], 0
    v_rcp_f32 v191, v191
    v_mfma_f32_16x16x32_bf16 v[220:223], v[160:163], v[16:19], v[220:223]
    v_rcp_f32 v192, v192
    v_mfma_f32_16x16x32_bf16 v[228:231], v[160:163], v[24:27], v[228:231]
    v_rcp_f32 v193, v193
    v_mfma_f32_16x16x32_bf16 v[224:227], v[168:171], v[16:19], v[224:227]
    v_rcp_f32 v194, v194
    v_mfma_f32_16x16x32_bf16 v[232:235], v[168:171], v[24:27], v[232:235]
    v_rcp_f32 v195, v195
    v_mfma_f32_16x16x32_bf16 v[220:223], v[164:167], v[20:23], v[220:223]
    v_rcp_f32 v196, v196
    v_mfma_f32_16x16x32_bf16 v[228:231], v[164:167], v[28:31], v[228:231]
    v_rcp_f32 v197, v197
    v_mfma_f32_16x16x32_bf16 v[224:227], v[172:175], v[20:23], v[224:227]
    v_rcp_f32 v198, v198
    s_setprio 3
    v_mfma_f32_16x16x32_bf16 v[232:235], v[172:175], v[28:31], v[232:235]
    v_rcp_f32 v199, v199
    v_rcp_f32 v200, v200
    v_rcp_f32 v201, v201
    v_rcp_f32 v202, v202
    v_rcp_f32 v203, v203
    v_pk_mul_f32 v[204:205], v[188:189], v[204:205]
    v_pk_mul_f32 v[206:207], v[190:191], v[206:207]
    v_pk_mul_f32 v[208:209], v[192:193], v[208:209]
    v_pk_mul_f32 v[210:211], v[194:195], v[210:211]
    v_pk_mul_f32 v[212:213], v[196:197], v[212:213]
    v_pk_mul_f32 v[214:215], v[198:199], v[214:215]
    v_pk_mul_f32 v[216:217], v[200:201], v[216:217]
    v_pk_mul_f32 v[218:219], v[202:203], v[218:219]
    s_setprio 0
    s_waitcnt lgkmcnt(0)
    v_smfmac_f32_16x16x64_bf16 v[144:147], v[184:187], v[204:211], v255
    v_exp_f32 v220, v220
    v_smfmac_f32_16x16x64_bf16 v[148:151], v[184:187], v[212:219], v255
    v_exp_f32 v221, v221
    v_mfma_f32_16x16x32_bf16 v[204:207], v[160:163], v[48:51], 0
    v_exp_f32 v222, v222
    v_mfma_f32_16x16x32_bf16 v[212:215], v[160:163], v[56:59], 0
    v_exp_f32 v223, v223
    v_mfma_f32_16x16x32_bf16 v[208:211], v[168:171], v[48:51], 0
    v_exp_f32 v224, v224
    v_mfma_f32_16x16x32_bf16 v[216:219], v[168:171], v[56:59], 0
    v_exp_f32 v225, v225
    v_mfma_f32_16x16x32_bf16 v[204:207], v[164:167], v[52:55], v[204:207]
    v_exp_f32 v226, v226
    v_mfma_f32_16x16x32_bf16 v[212:215], v[164:167], v[60:63], v[212:215]
    v_exp_f32 v227, v227
    v_mfma_f32_16x16x32_bf16 v[208:211], v[172:175], v[52:55], v[208:211]
    v_exp_f32 v228, v228
    v_mfma_f32_16x16x32_bf16 v[216:219], v[172:175], v[60:63], v[216:219]
    v_exp_f32 v229, v229
    v_smfmac_f32_16x16x64_bf16 v[128:131], v[184:187], v[188:195], v255
    v_exp_f32 v230, v230
    s_setprio 3
    v_smfmac_f32_16x16x64_bf16 v[132:135], v[184:187], v[196:203], v255
    v_exp_f32 v231, v231
    v_exp_f32 v232, v232
    v_exp_f32 v233, v233
    v_exp_f32 v234, v234
    v_exp_f32 v235, v235
    v_pk_add_f32 v[220:221], v[220:221], 1.0 op_sel_hi:[1,0]
    v_pk_add_f32 v[222:223], v[222:223], 1.0 op_sel_hi:[1,0]
    v_pk_add_f32 v[224:225], v[224:225], 1.0 op_sel_hi:[1,0]
    v_pk_add_f32 v[226:227], v[226:227], 1.0 op_sel_hi:[1,0]
    v_pk_add_f32 v[228:229], v[228:229], 1.0 op_sel_hi:[1,0]
    v_pk_add_f32 v[230:231], v[230:231], 1.0 op_sel_hi:[1,0]
    v_pk_add_f32 v[232:233], v[232:233], 1.0 op_sel_hi:[1,0]
    v_pk_add_f32 v[234:235], v[234:235], 1.0 op_sel_hi:[1,0]
    s_setprio 0
    v_rcp_f32 v220, v220
    v_rcp_f32 v221, v221
    v_rcp_f32 v222, v222
    v_rcp_f32 v223, v223
    v_rcp_f32 v224, v224
    v_rcp_f32 v225, v225
    v_rcp_f32 v226, v226
    v_rcp_f32 v227, v227
    v_rcp_f32 v228, v228
    v_rcp_f32 v229, v229
    v_rcp_f32 v230, v230
    v_rcp_f32 v231, v231
    v_rcp_f32 v232, v232
    v_rcp_f32 v233, v233
    v_rcp_f32 v234, v234
    v_rcp_f32 v235, v235
    v_pk_mul_f32 v[204:205], v[220:221], v[204:205]
    v_pk_mul_f32 v[206:207], v[222:223], v[206:207]
    v_pk_mul_f32 v[208:209], v[224:225], v[208:209]
    v_pk_mul_f32 v[210:211], v[226:227], v[210:211]
    v_pk_mul_f32 v[212:213], v[228:229], v[212:213]
    v_pk_mul_f32 v[214:215], v[230:231], v[214:215]
    v_pk_mul_f32 v[216:217], v[232:233], v[216:217]
    v_pk_mul_f32 v[218:219], v[234:235], v[218:219]
    v_smfmac_f32_16x16x64_bf16 v[136:139], v[184:187], v[220:227], v255
    v_smfmac_f32_16x16x64_bf16 v[140:143], v[184:187], v[228:235], v255
    v_smfmac_f32_16x16x64_bf16 v[152:155], v[184:187], v[204:211], v255
    v_smfmac_f32_16x16x64_bf16 v[156:159], v[184:187], v[212:219], v255
    s_branch L_DONE
L_LH1:
    s_setprio 0
    v_smfmac_f32_16x16x64_bf16 v[120:123], v[184:187], v[204:211], v255
    ds_read_u16 v236, v251 offset:1152
    ds_read_u16 v237, v251 offset:1168
    v_smfmac_f32_16x16x64_bf16 v[124:127], v[184:187], v[212:219], v255
    v_exp_f32 v188, v188
    v_mfma_f32_16x16x32_bf16 v[204:207], v[160:163], v[32:35], 0
    v_mfma_f32_16x16x32_bf16 v[212:215], v[160:163], v[40:43], 0
    v_exp_f32 v189, v189
    v_mfma_f32_16x16x32_bf16 v[204:207], v[164:167], v[36:39], v[204:207]
    v_mfma_f32_16x16x32_bf16 v[212:215], v[164:167], v[44:47], v[212:215]
    v_exp_f32 v190, v190
    v_smfmac_f32_16x16x64_bf16 v[104:107], v[184:187], v[220:227], v255
    s_waitcnt lgkmcnt(0)
    v_bfi_b32 v236, 31, v246, v236
    v_bfi_b32 v237, 31, v246, v237
    v_exp_f32 v191, v191
    s_setprio 3
    v_smfmac_f32_16x16x64_bf16 v[108:111], v[184:187], v[228:235], v255
    v_exp_f32 v196, v196
    v_exp_f32 v197, v197
    v_exp_f32 v198, v198
    v_exp_f32 v199, v199
    v_pk_add_f32 v[188:189], v[188:189], 1.0 op_sel_hi:[1,0]
    v_pk_add_f32 v[190:191], v[190:191], 1.0 op_sel_hi:[1,0]
    v_pk_add_f32 v[196:197], v[196:197], 1.0 op_sel_hi:[1,0]
    v_pk_add_f32 v[198:199], v[198:199], 1.0 op_sel_hi:[1,0]
    s_setprio 0
    v_mfma_f32_16x16x32_bf16 v[220:223], v[176:179], v[88:91], 0
    ds_read_b64_tr_b16 v[184:185], v236
    ds_read_b64_tr_b16 v[186:187], v237
    v_mfma_f32_16x16x32_bf16 v[228:231], v[176:179], v[92:95], 0
    v_rcp_f32 v188, v188
    v_mfma_f32_16x16x32_bf16 v[220:223], v[160:163], v[16:19], v[220:223]
    v_rcp_f32 v189, v189
    v_mfma_f32_16x16x32_bf16 v[228:231], v[160:163], v[24:27], v[228:231]
    v_rcp_f32 v190, v190
    v_mfma_f32_16x16x32_bf16 v[220:223], v[164:167], v[20:23], v[220:223]
    v_rcp_f32 v191, v191
    s_setprio 3
    v_mfma_f32_16x16x32_bf16 v[228:231], v[164:167], v[28:31], v[228:231]
    v_rcp_f32 v196, v196
    v_rcp_f32 v197, v197
    v_rcp_f32 v198, v198
    v_rcp_f32 v199, v199
    v_pk_mul_f32 v[204:205], v[188:189], v[204:205]
    v_pk_mul_f32 v[206:207], v[190:191], v[206:207]
    v_pk_mul_f32 v[212:213], v[196:197], v[212:213]
    v_pk_mul_f32 v[214:215], v[198:199], v[214:215]
    s_setprio 0
    s_waitcnt lgkmcnt(0)
    v_smfmac_f32_16x16x64_bf16 v[144:147], v[184:187], v[204:211], v255
    v_smfmac_f32_16x16x64_bf16 v[148:151], v[184:187], v[212:219], v255
    v_exp_f32 v220, v220
    v_mfma_f32_16x16x32_bf16 v[204:207], v[160:163], v[48:51], 0
    v_mfma_f32_16x16x32_bf16 v[212:215], v[160:163], v[56:59], 0
    v_exp_f32 v221, v221
    v_mfma_f32_16x16x32_bf16 v[204:207], v[164:167], v[52:55], v[204:207]
    v_mfma_f32_16x16x32_bf16 v[212:215], v[164:167], v[60:63], v[212:215]
    v_exp_f32 v222, v222
    v_smfmac_f32_16x16x64_bf16 v[128:131], v[184:187], v[188:195], v255
    v_exp_f32 v223, v223
    s_setprio 3
    v_smfmac_f32_16x16x64_bf16 v[132:135], v[184:187], v[196:203], v255
    v_exp_f32 v228, v228
    v_exp_f32 v229, v229
    v_exp_f32 v230, v230
    v_exp_f32 v231, v231
    v_pk_add_f32 v[220:221], v[220:221], 1.0 op_sel_hi:[1,0]
    v_pk_add_f32 v[222:223], v[222:223], 1.0 op_sel_hi:[1,0]
    v_pk_add_f32 v[228:229], v[228:229], 1.0 op_sel_hi:[1,0]
    v_pk_add_f32 v[230:231], v[230:231], 1.0 op_sel_hi:[1,0]
    s_setprio 0
    v_rcp_f32 v220, v220
    v_rcp_f32 v221, v221
    v_rcp_f32 v222, v222
    v_rcp_f32 v223, v223
    v_rcp_f32 v228, v228
    v_rcp_f32 v229, v229
    v_rcp_f32 v230, v230
    v_rcp_f32 v231, v231
    v_pk_mul_f32 v[204:205], v[220:221], v[204:205]
    v_pk_mul_f32 v[206:207], v[222:223], v[206:207]
    v_pk_mul_f32 v[212:213], v[228:229], v[212:213]
    v_pk_mul_f32 v[214:215], v[230:231], v[214:215]
    v_smfmac_f32_16x16x64_bf16 v[136:139], v[184:187], v[220:227], v255
    v_smfmac_f32_16x16x64_bf16 v[140:143], v[184:187], v[228:235], v255
    v_smfmac_f32_16x16x64_bf16 v[152:155], v[184:187], v[204:211], v255
    v_smfmac_f32_16x16x64_bf16 v[156:159], v[184:187], v[212:219], v255
    s_branch L_DONE
L_DONE:
    v_mbcnt_lo_u32_b32 v247, -1, 0
    v_mbcnt_hi_u32_b32 v247, -1, v247
    v_and_b32 v246, 24, v246
    s_cmp_lg_u32 s19, 0
    s_cbranch_scc1 L_SLOW
L_EPI:
    s_waitcnt lgkmcnt(0)
    v_and_b32 v64, 48, v247
    v_and_b32 v67, 15, v247
    v_add_u32 v69, s72, v64
    v_lshl_add_u32 v70, v67, 2, s72
    ds_read_b128 v[80:83], v69 offset:0
    ds_read_b128 v[84:87], v69 offset:64
    ds_read2_b32 v[72:73], v70 offset0:0 offset1:16
    v_bfe_u32 v65, v247, 2, 3
    v_lshrrev_b32 v66, 5, v247
    v_lshl_add_u32 v65, v66, 4, v65
    v_mul_u32_u24 v65, 160, v65
    s_mov_b32 s10, 143488
    v_add3_u32 v65, v65, v246, s10
    ds_read_b64_tr_b16 v[0:1], v65 offset:0
    ds_read_b64_tr_b16 v[2:3], v65 offset:1280
    ds_read_b64_tr_b16 v[8:9], v65 offset:32
    ds_read_b64_tr_b16 v[10:11], v65 offset:1312
    ds_read_b64_tr_b16 v[16:17], v65 offset:64
    ds_read_b64_tr_b16 v[18:19], v65 offset:1344
    ds_read_b64_tr_b16 v[24:25], v65 offset:96
    ds_read_b64_tr_b16 v[26:27], v65 offset:1376
    ds_read_b64_tr_b16 v[4:5], v65 offset:5120
    ds_read_b64_tr_b16 v[6:7], v65 offset:6400
    ds_read_b64_tr_b16 v[12:13], v65 offset:5152
    ds_read_b64_tr_b16 v[14:15], v65 offset:6432
    s_movk_i32 s10, 832
    v_mad_u32_u24 v64, v246, s10, v64
    s_mov_b32 s10, 116736
    v_lshl_add_u32 v69, v67, 3, s10
    v_lshl_add_u32 v74, v67, 3, s73
    v_lshl_add_u32 v75, v67, 3, s74
    s_waitcnt lgkmcnt(8)
    ds_read_b64_tr_b16 v[20:21], v65 offset:5184
    ds_read_b64_tr_b16 v[22:23], v65 offset:6464
    ds_read_b64_tr_b16 v[28:29], v65 offset:5216
    ds_read_b64_tr_b16 v[30:31], v65 offset:6496
    v_add_u32 v76, v80, v69
    ds_read_b64 v[32:33], v76 offset:0
    v_add_u32 v76, v81, v69
    ds_read_b64 v[34:35], v76 offset:6656
    v_add_u32 v76, v82, v69
    ds_read_b64 v[36:37], v76 offset:13312
    v_add_u32 v76, v83, v69
    ds_read_b64 v[38:39], v76 offset:19968
    v_add_u32 v76, v84, v69
    ds_read_b64 v[40:41], v76 offset:0
    v_add_u32 v76, v85, v69
    ds_read_b64 v[42:43], v76 offset:6656
    v_add_u32 v76, v86, v69
    ds_read_b64 v[44:45], v76 offset:13312
    v_add_u32 v76, v87, v69
    ds_read_b64 v[46:47], v76 offset:19968
    v_add3_u32 v72, v72, v64, s10
    ds_read_b128 v[160:163], v72 offset:0
    ds_read_b128 v[164:167], v72 offset:64
    v_add3_u32 v73, v73, v64, s10
    ds_read_b128 v[168:171], v73 offset:0
    ds_read_b128 v[172:175], v73 offset:64
    s_waitcnt lgkmcnt(0)
    v_lshlrev_b32 v188, 16, v32
    v_lshlrev_b32 v189, 16, v34
    v_lshlrev_b32 v190, 16, v36
    v_lshlrev_b32 v191, 16, v38
    v_and_b32 v192, 0xffff0000, v32
    v_and_b32 v193, 0xffff0000, v34
    v_and_b32 v194, 0xffff0000, v36
    v_and_b32 v195, 0xffff0000, v38
    v_mfma_f32_16x16x32_bf16 v[188:191], v[160:163], v[0:3], v[188:191]
    v_lshlrev_b32 v196, 16, v33
    v_lshlrev_b32 v197, 16, v35
    v_lshlrev_b32 v198, 16, v37
    v_lshlrev_b32 v199, 16, v39
    v_lshl_add_u32 v80, v80, 2, v74
    v_mfma_f32_16x16x32_bf16 v[188:191], v[164:167], v[4:7], v[188:191]
    v_mfma_f32_16x16x32_bf16 v[192:195], v[160:163], v[8:11], v[192:195]
    v_and_b32 v200, 0xffff0000, v33
    v_and_b32 v201, 0xffff0000, v35
    v_and_b32 v202, 0xffff0000, v37
    v_and_b32 v203, 0xffff0000, v39
    v_lshl_add_u32 v81, v81, 2, v74
    v_mfma_f32_16x16x32_bf16 v[192:195], v[164:167], v[12:15], v[192:195]
    v_mfma_f32_16x16x32_bf16 v[196:199], v[160:163], v[16:19], v[196:199]
    v_lshlrev_b32 v48, 16, v40
    v_lshlrev_b32 v49, 16, v42
    v_lshlrev_b32 v50, 16, v44
    v_lshlrev_b32 v51, 16, v46
    v_lshl_add_u32 v82, v82, 2, v74
    v_mfma_f32_16x16x32_bf16 v[196:199], v[164:167], v[20:23], v[196:199]
    v_mfma_f32_16x16x32_bf16 v[200:203], v[160:163], v[24:27], v[200:203]
    v_and_b32 v52, 0xffff0000, v40
    v_and_b32 v53, 0xffff0000, v42
    v_and_b32 v54, 0xffff0000, v44
    v_and_b32 v55, 0xffff0000, v46
    v_lshl_add_u32 v83, v83, 2, v74
    v_mfma_f32_16x16x32_bf16 v[200:203], v[164:167], v[28:31], v[200:203]
    v_mfma_f32_16x16x32_bf16 v[48:51], v[168:171], v[0:3], v[48:51]
    v_lshlrev_b32 v56, 16, v41
    v_lshlrev_b32 v57, 16, v43
    v_lshlrev_b32 v58, 16, v45
    v_lshlrev_b32 v59, 16, v47
    v_lshl_add_u32 v84, v84, 2, v75
    v_mfma_f32_16x16x32_bf16 v[48:51], v[172:175], v[4:7], v[48:51]
    v_mfma_f32_16x16x32_bf16 v[52:55], v[168:171], v[8:11], v[52:55]
    v_and_b32 v60, 0xffff0000, v41
    v_and_b32 v61, 0xffff0000, v43
    v_and_b32 v62, 0xffff0000, v45
    v_and_b32 v63, 0xffff0000, v47
    v_lshl_add_u32 v85, v85, 2, v75
    v_mfma_f32_16x16x32_bf16 v[52:55], v[172:175], v[12:15], v[52:55]
    v_mfma_f32_16x16x32_bf16 v[56:59], v[168:171], v[16:19], v[56:59]
    v_lshl_add_u32 v86, v86, 2, v75
    v_mfma_f32_16x16x32_bf16 v[56:59], v[172:175], v[20:23], v[56:59]
    v_mfma_f32_16x16x32_bf16 v[60:63], v[168:171], v[24:27], v[60:63]
    v_lshl_add_u32 v87, v87, 2, v75
    v_mfma_f32_16x16x32_bf16 v[60:63], v[172:175], v[28:31], v[60:63]
L_EPB:
    s_setprio 0
    s_mov_b64 exec, s[76:77]
    s_and_b32 s11, s25, 19
    s_nop 2
    s_cmp_eq_u32 s11, 0
    s_cbranch_scc1 L_NS0
    s_cmp_eq_u32 s11, 1
    s_cbranch_scc1 L_NS1
    s_cmp_eq_u32 s11, 2
    s_cbranch_scc1 L_NS2
    s_cmp_eq_u32 s11, 3
    s_cbranch_scc1 L_NS3
L_NSR:
    s_mov_b64 exec, -1
    v_rcp_f32 v96, v96
    v_rcp_f32 v97, v97
    v_rcp_f32 v98, v98
    v_rcp_f32 v99, v99
    v_rcp_f32 v100, v100
    v_rcp_f32 v101, v101
    v_rcp_f32 v102, v102
    v_rcp_f32 v103, v103
    v_rcp_f32 v104, v104
    v_rcp_f32 v105, v105
    v_rcp_f32 v106, v106
    v_rcp_f32 v107, v107
    v_rcp_f32 v108, v108
    v_rcp_f32 v109, v109
    v_rcp_f32 v110, v110
    v_rcp_f32 v111, v111
    v_pk_fma_f32 v[112:113], v[112:113], v[96:97], v[188:189]
    v_pk_fma_f32 v[114:115], v[114:115], v[98:99], v[190:191]
    v_pk_fma_f32 v[116:117], v[116:117], v[100:101], v[192:193]
    v_pk_fma_f32 v[118:119], v[118:119], v[102:103], v[194:195]
    v_pk_fma_f32 v[120:121], v[120:121], v[104:105], v[196:197]
    v_pk_fma_f32 v[122:123], v[122:123], v[106:107], v[198:199]
    v_pk_fma_f32 v[124:125], v[124:125], v[108:109], v[200:201]
    v_pk_fma_f32 v[126:127], v[126:127], v[110:111], v[202:203]
    v_cvt_pk_bf16_f32 v96, v112, v116
    v_cvt_pk_bf16_f32 v97, v120, v124
    v_pk_max_f16 v96, v96, v32
    v_pk_max_f16 v97, v97, v33
    buffer_store_dwordx2 v[96:97], v80, s[48:51], 0 offen sc1
    v_cvt_pk_bf16_f32 v98, v113, v117
    v_cvt_pk_bf16_f32 v99, v121, v125
    v_pk_max_f16 v98, v98, v34
    v_pk_max_f16 v99, v99, v35
    buffer_store_dwordx2 v[98:99], v81, s[48:51], 0 offen sc1
    v_cvt_pk_bf16_f32 v100, v114, v118
    v_cvt_pk_bf16_f32 v101, v122, v126
    v_pk_max_f16 v100, v100, v36
    v_pk_max_f16 v101, v101, v37
    buffer_store_dwordx2 v[100:101], v82, s[48:51], 0 offen sc1
    v_cvt_pk_bf16_f32 v102, v115, v119
    v_cvt_pk_bf16_f32 v103, v123, v127
    v_pk_max_f16 v102, v102, v38
    v_pk_max_f16 v103, v103, v39
    buffer_store_dwordx2 v[102:103], v83, s[48:51], 0 offen sc1
    v_rcp_f32 v128, v128
    v_rcp_f32 v129, v129
    v_rcp_f32 v130, v130
    v_rcp_f32 v131, v131
    v_rcp_f32 v132, v132
    v_rcp_f32 v133, v133
    v_rcp_f32 v134, v134
    v_rcp_f32 v135, v135
    v_rcp_f32 v136, v136
    v_rcp_f32 v137, v137
    v_rcp_f32 v138, v138
    v_rcp_f32 v139, v139
    v_rcp_f32 v140, v140
    v_rcp_f32 v141, v141
    v_rcp_f32 v142, v142
    v_rcp_f32 v143, v143
    v_pk_fma_f32 v[144:145], v[144:145], v[128:129], v[48:49]
    v_pk_fma_f32 v[146:147], v[146:147], v[130:131], v[50:51]
    v_pk_fma_f32 v[148:149], v[148:149], v[132:133], v[52:53]
    v_pk_fma_f32 v[150:151], v[150:151], v[134:135], v[54:55]
    v_pk_fma_f32 v[152:153], v[152:153], v[136:137], v[56:57]
    v_pk_fma_f32 v[154:155], v[154:155], v[138:139], v[58:59]
    v_pk_fma_f32 v[156:157], v[156:157], v[140:141], v[60:61]
    v_pk_fma_f32 v[158:159], v[158:159], v[142:143], v[62:63]
    v_cvt_pk_bf16_f32 v128, v144, v148
    v_cvt_pk_bf16_f32 v129, v152, v156
    v_pk_max_f16 v128, v128, v40
    v_pk_max_f16 v129, v129, v41
    buffer_store_dwordx2 v[128:129], v84, s[60:63], 0 offen sc1
    v_cvt_pk_bf16_f32 v130, v145, v149
    v_cvt_pk_bf16_f32 v131, v153, v157
    v_pk_max_f16 v130, v130, v42
    v_pk_max_f16 v131, v131, v43
    buffer_store_dwordx2 v[130:131], v85, s[60:63], 0 offen sc1
    v_cvt_pk_bf16_f32 v132, v146, v150
    v_cvt_pk_bf16_f32 v133, v154, v158
    v_pk_max_f16 v132, v132, v44
    v_pk_max_f16 v133, v133, v45
    buffer_store_dwordx2 v[132:133], v86, s[60:63], 0 offen sc1
    v_cvt_pk_bf16_f32 v134, v147, v151
    v_cvt_pk_bf16_f32 v135, v155, v159
    v_pk_max_f16 v134, v134, v46
    v_pk_max_f16 v135, v135, v47
    buffer_store_dwordx2 v[134:135], v87, s[60:63], 0 offen sc1
L_END:
    s_endpgm
L_NS0:
    v_add_f32 v96, v96, v128
    v_add_f32 v100, v100, v132
    v_add_f32 v104, v104, v136
    v_add_f32 v108, v108, v140
    v_add_f32 v112, v112, v144
    v_add_f32 v116, v116, v148
    v_add_f32 v120, v120, v152
    v_add_f32 v124, v124, v156
    s_branch L_NSR
L_NS1:
    v_add_f32 v97, v97, v129
    v_add_f32 v101, v101, v133
    v_add_f32 v105, v105, v137
    v_add_f32 v109, v109, v141
    v_add_f32 v113, v113, v145
    v_add_f32 v117, v117, v149
    v_add_f32 v121, v121, v153
    v_add_f32 v125, v125, v157
    s_branch L_NSR
L_NS2:
    v_add_f32 v98, v98, v130
    v_add_f32 v102, v102, v134
    v_add_f32 v106, v106, v138
    v_add_f32 v110, v110, v142
    v_add_f32 v114, v114, v146
    v_add_f32 v118, v118, v150
    v_add_f32 v122, v122, v154
    v_add_f32 v126, v126, v158
    s_branch L_NSR
L_NS3:
    v_add_f32 v99, v99, v131
    v_add_f32 v103, v103, v135
    v_add_f32 v107, v107, v139
    v_add_f32 v111, v111, v143
    v_add_f32 v115, v115, v147
    v_add_f32 v119, v119, v151
    v_add_f32 v123, v123, v155
    v_add_f32 v127, v127, v159
    s_branch L_NSR
L_RT0:
    s_waitcnt vmcnt(0)
    s_add_u32 s100, s100, 1
    s_cmp_gt_u32 s100, 200000
    s_cbranch_scc1 L_END
    s_sleep 1
    buffer_load_dwordx4 v[128:131], v232, s[56:59], s26 offen sc1
    buffer_load_dwordx4 v[132:135], v232, s[56:59], s27 offen sc1
    buffer_load_dwordx4 v[136:139], v232, s[56:59], s28 offen sc1
    buffer_load_dwordx4 v[140:143], v232, s[56:59], s29 offen sc1
    s_waitcnt vmcnt(0)
    s_branch L_PW0
L_RT1:
    s_waitcnt vmcnt(0)
    s_add_u32 s100, s100, 1
    s_cmp_gt_u32 s100, 200000
    s_cbranch_scc1 L_END
    s_sleep 1
    buffer_load_dwordx4 v[132:135], v232, s[56:59], s27 offen sc1
    buffer_load_dwordx4 v[136:139], v232, s[56:59], s28 offen sc1
    buffer_load_dwordx4 v[140:143], v232, s[56:59], s29 offen sc1
    s_waitcnt vmcnt(0)
    s_branch L_PW1
L_RT2:
    s_waitcnt vmcnt(0)
    s_add_u32 s100, s100, 1
    s_cmp_gt_u32 s100, 200000
    s_cbranch_scc1 L_END
    s_sleep 1
    buffer_load_dwordx4 v[136:139], v232, s[56:59], s28 offen sc1
    buffer_load_dwordx4 v[140:143], v232, s[56:59], s29 offen sc1
    s_waitcnt vmcnt(0)
    s_branch L_PW2
L_RT3:
    s_waitcnt vmcnt(0)
    s_add_u32 s100, s100, 1
    s_cmp_gt_u32 s100, 200000
    s_cbranch_scc1 L_END
    s_sleep 1
    buffer_load_dwordx4 v[140:143], v232, s[56:59], s29 offen sc1
    s_waitcnt vmcnt(0)
    s_branch L_PW3
L_XT2B:
    s_add_u32 s100, s100, 1
    s_cmp_gt_u32 s100, 200000
    s_cbranch_scc1 L_END
    s_sleep 1
    s_mov_b64 exec, s[70:71]
    s_cbranch_execz L_XLb0
    s_movk_i32 s10, 0
    buffer_load_dwordx4 v[64:67], v232, s[60:63], s10 offen sc1
L_XLb0:
    s_mov_b64 exec, s[78:79]
    s_cbranch_execz L_XLb1
    s_movk_i32 s10, 8192
    buffer_load_dwordx4 v[68:71], v232, s[60:63], s10 offen sc1
L_XLb1:
    s_mov_b64 exec, s[86:87]
    s_cbranch_execz L_XLb2
    s_movk_i32 s10, 16384
    buffer_load_dwordx4 v[72:75], v232, s[60:63], s10 offen sc1
L_XLb2:
    s_mov_b64 exec, s[94:95]
    s_cbranch_execz L_XLb3
    s_movk_i32 s10, 24576
    buffer_load_dwordx4 v[76:79], v232, s[60:63], s10 offen sc1
L_XLb3:
    s_mov_b64 exec, -1
    s_waitcnt vmcnt(0)
    s_branch L_XT2
L_OVF:
    s_mov_b32 s20, 0
    s_mov_b32 s17, 0
    s_mov_b32 s30, 0
    s_mov_b32 s19, 4
    s_waitcnt lgkmcnt(0)
    s_branch L_CA
L_POVF:
    s_movk_i32 s11, 1986
    v_mul_u32_u24 v64, s11, v192
    v_lshrrev_b32 v64, 16, v64
    v_mul_u32_u24 v65, s11, v193
    v_lshrrev_b32 v65, 16, v65
    v_mul_u32_u24 v66, s11, v194
    v_lshrrev_b32 v66, 16, v66
    v_mul_u32_u24 v67, s11, v195
    v_lshrrev_b32 v67, 16, v67
    v_add_u32 v69, v64, v65
    v_add_u32 v70, v69, v66
    v_add_u32 v71, v70, v67
    v_mov_b32 v72, v71
    s_nop 1
    v_add_u32_dpp v72, v72, v72 row_shr:1 row_mask:0xf bank_mask:0xf bound_ctrl:0
    s_nop 1
    v_add_u32_dpp v72, v72, v72 row_shr:2 row_mask:0xf bank_mask:0xf bound_ctrl:0
    s_nop 1
    v_add_u32_dpp v72, v72, v72 row_shr:4 row_mask:0xf bank_mask:0xf bound_ctrl:0
    s_nop 1
    v_add_u32_dpp v72, v72, v72 row_shr:8 row_mask:0xf bank_mask:0xf bound_ctrl:0
    s_nop 1
    v_add_u32_dpp v72, v72, v72 row_bcast:15 row_mask:0xa bank_mask:0xf
    s_nop 1
    v_add_u32_dpp v72, v72, v72 row_bcast:31 row_mask:0xc bank_mask:0xf
    s_nop 0
    v_sub_u32 v68, v72, v71
    v_add_u32 v71, v68, v70
    v_add_u32 v70, v68, v69
    v_add_u32 v69, v68, v64
    v_lshl_or_b32 v68, v64, 16, v68
    v_lshl_or_b32 v69, v65, 16, v69
    v_lshl_or_b32 v70, v66, 16, v70
    v_lshl_or_b32 v71, v67, 16, v71
    v_add_u32 v72, 154752, v185
    ds_write_b128 v72, v[68:71]
    s_lshl_b32 s10, s2, 10
    s_add_u32 s10, s10, 24772608
    buffer_store_dwordx4 v[68:71], v185, s[52:55], s10 offen sc1
    v_and_b32 v74, 0x3fc, v136
    v_add_u32 v74, 154752, v74
    ds_read_u16 v74, v74
    v_and_b32 v75, 0x3fc, v137
    v_add_u32 v75, 154752, v75
    ds_read_u16 v75, v75
    v_and_b32 v76, 0x3fc, v138
    v_add_u32 v76, 154752, v76
    ds_read_u16 v76, v76
    v_and_b32 v77, 0x3fc, v139
    v_add_u32 v77, 154752, v77
    ds_read_u16 v77, v77
    v_and_b32 v78, 0x3fc, v140
    v_add_u32 v78, 154752, v78
    ds_read_u16 v78, v78
    v_and_b32 v79, 0x3fc, v141
    v_add_u32 v79, 154752, v79
    ds_read_u16 v79, v79
    v_and_b32 v80, 0x3fc, v142
    v_add_u32 v80, 154752, v80
    ds_read_u16 v80, v80
    v_and_b32 v81, 0x3fc, v143
    v_add_u32 v81, 154752, v81
    ds_read_u16 v81, v81
    s_waitcnt lgkmcnt(0)
    v_cmpx_lt_u32 vcc, 1056, v228
    v_or_b32 v205, 0x10000, v205
    s_mov_b64 exec, -1
    v_cmpx_lt_u32 vcc, 1056, v229
    v_or_b32 v209, 0x10000, v209
    s_mov_b64 exec, -1
    v_cmpx_lt_u32 vcc, 1056, v230
    v_or_b32 v213, 0x10000, v213
    s_mov_b64 exec, -1
    v_cmpx_lt_u32 vcc, 1056, v231
    v_or_b32 v217, 0x10000, v217
    s_mov_b64 exec, -1
    s_mul_i32 s10, s2, 4152
    s_mov_b32 s34, 18874368
    s_mov_b32 s35, 23592960
    v_mul_u32_u24 v64, s11, v112
    v_lshrrev_b32 v64, 16, v64
    v_add3_u32 v64, v64, v74, s10
    v_lshlrev_b32 v65, 2, v64
    v_cmpx_le_u32 vcc, 1056, v112
    s_cbranch_execz L_PO0
    buffer_store_byte v120, v64, s[52:55], s35 offen sc1
    buffer_store_dword v96, v65, s[52:55], s34 offen sc1
L_PO0:
    s_mov_b64 exec, -1
    v_mul_u32_u24 v64, s11, v113
    v_lshrrev_b32 v64, 16, v64
    v_add3_u32 v64, v64, v75, s10
    v_lshlrev_b32 v65, 2, v64
    v_cmpx_le_u32 vcc, 1056, v113
    s_cbranch_execz L_PO1
    buffer_store_byte v121, v64, s[52:55], s35 offen sc1
    buffer_store_dword v97, v65, s[52:55], s34 offen sc1
L_PO1:
    s_mov_b64 exec, -1
    v_mul_u32_u24 v64, s11, v114
    v_lshrrev_b32 v64, 16, v64
    v_add3_u32 v64, v64, v76, s10
    v_lshlrev_b32 v65, 2, v64
    v_cmpx_le_u32 vcc, 1056, v114
    s_cbranch_execz L_PO2
    buffer_store_byte v122, v64, s[52:55], s35 offen sc1
    buffer_store_dword v98, v65, s[52:55], s34 offen sc1
L_PO2:
    s_mov_b64 exec, -1
    v_mul_u32_u24 v64, s11, v115
    v_lshrrev_b32 v64, 16, v64
    v_add3_u32 v64, v64, v77, s10
    v_lshlrev_b32 v65, 2, v64
    v_cmpx_le_u32 vcc, 1056, v115
    s_cbranch_execz L_PO3
    buffer_store_byte v123, v64, s[52:55], s35 offen sc1
    buffer_store_dword v99, v65, s[52:55], s34 offen sc1
L_PO3:
    s_mov_b64 exec, -1
    v_mul_u32_u24 v64, s11, v116
    v_lshrrev_b32 v64, 16, v64
    v_add3_u32 v64, v64, v78, s10
    v_lshlrev_b32 v65, 2, v64
    v_cmpx_le_u32 vcc, 1056, v116
    s_cbranch_execz L_PO4
    buffer_store_byte v120, v64, s[52:55], s35 offen sc1
    buffer_store_dword v100, v65, s[52:55], s34 offen sc1
L_PO4:
    s_mov_b64 exec, -1
    v_mul_u32_u24 v64, s11, v117
    v_lshrrev_b32 v64, 16, v64
    v_add3_u32 v64, v64, v79, s10
    v_lshlrev_b32 v65, 2, v64
    v_cmpx_le_u32 vcc, 1056, v117
    s_cbranch_execz L_PO5
    buffer_store_byte v121, v64, s[52:55], s35 offen sc1
    buffer_store_dword v101, v65, s[52:55], s34 offen sc1
L_PO5:
    s_mov_b64 exec, -1
    v_mul_u32_u24 v64, s11, v118
    v_lshrrev_b32 v64, 16, v64
    v_add3_u32 v64, v64, v80, s10
    v_lshlrev_b32 v65, 2, v64
    v_cmpx_le_u32 vcc, 1056, v118
    s_cbranch_execz L_PO6
    buffer_store_byte v122, v64, s[52:55], s35 offen sc1
    buffer_store_dword v102, v65, s[52:55], s34 offen sc1
L_PO6:
    s_mov_b64 exec, -1
    v_mul_u32_u24 v64, s11, v119
    v_lshrrev_b32 v64, 16, v64
    v_add3_u32 v64, v64, v81, s10
    v_lshlrev_b32 v65, 2, v64
    v_cmpx_le_u32 vcc, 1056, v119
    s_cbranch_execz L_PO7
    buffer_store_byte v123, v64, s[52:55], s35 offen sc1
    buffer_store_dword v103, v65, s[52:55], s34 offen sc1
L_PO7:
    s_mov_b64 exec, -1
    s_waitcnt vmcnt(0) lgkmcnt(0)
    s_barrier
    s_branch L_POUT
L_SLOW:
    s_setprio 0
    s_lshl_b32 s10, s3, 6
    v_add_u32 v255, s10, v247
    s_cmp_lg_u32 s19, 4
    s_cbranch_scc1 L_SL1
    s_mov_b32 s19, 1
    v_and_b32 v188, 0xff, v255
    v_lshlrev_b32 v189, 7, v188
    buffer_load_dword v190, v189, s[56:59], 0 offen offset:4 sc1
    v_lshlrev_b32 v189, 10, v188
    s_lshl_b32 s10, s5, 2
    s_add_u32 s10, s10, 24772608
    buffer_load_dword v191, v189, s[52:55], s10 offen sc1
    v_lshlrev_b32 v188, 2, v188
    v_add_u32 v188, 154752, v188
    s_waitcnt vmcnt(0)
    v_and_b32 v190, 0x10000, v190
    v_cmp_ne_u32 vcc, 0, v190
    v_mov_b32 v190, 2097152
    s_nop 0
    v_cndmask_b32 v190, v190, v191, vcc
    ds_write_b32 v188, v190
    s_waitcnt lgkmcnt(0)
    s_barrier
L_SL1:
    s_add_u32 s28, s28, 288
    s_cmp_lt_u32 s28, s29
    s_cbranch_scc1 L_BATCH
L_FIND:
    s_cmp_lg_u64 s[32:33], 0
    s_cbranch_scc1 L_GOT
    s_add_u32 s26, s26, 1
    s_cmp_ge_u32 s26, 4
    s_cbranch_scc1 L_EPI
    s_lshl_b32 s10, s26, 8
    s_add_u32 s10, s10, 154752
    v_lshl_add_u32 v188, v247, 2, s10
    ds_read_u16 v188, v188 offset:2
    s_waitcnt lgkmcnt(0)
    v_cmp_lt_u32 s[32:33], s20, v188
    s_nop 3
    s_branch L_FIND
L_GOT:
    s_ff1_i32_b64 s10, s[32:33]
    s_bitset0_b64 s[32:33], s10
    s_lshl_b32 s11, s26, 6
    s_add_u32 s27, s10, s11
    s_lshl_b32 s10, s27, 2
    s_add_u32 s10, s10, 154752
    v_mov_b32 v188, s10
    ds_read_b32 v188, v188
    s_waitcnt lgkmcnt(0)
    v_readfirstlane_b32 s10, v188
    s_nop 3
    s_lshr_b32 s29, s10, 16
    s_and_b32 s30, s10, 0xffff
    s_mov_b32 s28, s20
L_BATCH:
    s_waitcnt vmcnt(0)
    s_barrier
    v_mov_b32 v192, 0x2000000
    v_mov_b32 v193, 0x2000000
    v_mov_b32 v194, 0x2000000
    v_mov_b32 v195, 0x2000000
    v_mov_b32 v196, 0xfffff
    v_mov_b32 v197, 0xfffff
    v_mov_b32 v198, 0xfffff
    v_mov_b32 v199, 0xfffff
    v_lshl_add_u32 v200, v247, 4, s12
    ds_write_b128 v200, v[192:195] offset:0
    ds_write_b128 v200, v[196:199] offset:18432
    ds_write_b128 v200, v[192:195] offset:1024
    ds_write_b128 v200, v[196:199] offset:19456
    ds_write_b128 v200, v[192:195] offset:1280
    ds_write_b128 v200, v[196:199] offset:19712
    v_and_b32 v188, 15, v247
    v_mul_u32_u24 v189, 1152, v188
    v_add_u32 v189, 8192, v189
    v_lshlrev_b32 v188, 2, v188
    ds_write_b32 v188, v189 offset:576
    v_add_u32 v188, s28, v255
    s_mul_i32 s36, s27, 3128
    s_mul_i32 s11, s27, 4152
    s_add_u32 s11, s11, s30
    s_lshl_b32 s34, s11, 2
    s_add_u32 s34, s34, 18874368
    v_lshl_add_u32 v190, v188, 2, s34
    s_add_u32 s34, s11, 23592960
    v_add_u32 v191, s34, v188
    s_mul_i32 s10, s5, 32896
    s_lshl_b32 s34, s27, 7
    s_add_u32 s10, s10, s34
    s_add_u32 s10, s10, 65536
    v_and_b32 v206, 7, v188
    v_lshl_add_u32 v206, v206, 4, s10
    v_lshrrev_b32 v207, 3, v188
    v_cmpx_gt_u32 vcc, 32, v188
    v_add_u32 v190, 8421376, v206
    v_add_u32 v191, 8, v190
    v_cmpx_gt_u32 vcc, 24, v188
    v_lshl_add_u32 v190, v207, 2, v206
    v_add3_u32 v191, v206, v207, 12
    s_mov_b64 exec, -1
    s_add_u32 s10, s28, 288
    s_min_u32 s10, s10, s29
    v_cmp_gt_u32 vcc, s10, v188
    v_mov_b32 v206, 0x7ffffff0
    s_nop 0
    v_cndmask_b32 v190, v206, v190, vcc
    v_cndmask_b32 v191, v206, v191, vcc
    buffer_load_dwordx2 v[204:205], v190, s[52:55], 0 offen sc1
    buffer_load_ubyte v191, v191, s[52:55], 0 offen sc1
    s_waitcnt lgkmcnt(0)
    s_barrier
    s_waitcnt vmcnt(0)
    v_cmp_ne_u32 vcc, 3, v207
    v_cmp_eq_u32 s[10:11], s6, v205
    v_mov_b32 v206, s36
    s_or_b64 exec, vcc, s[10:11]
    v_cmpx_ne_u32 vcc, 0, v204
    v_bfe_u32 v190, v204, 18, 8
    v_lshlrev_b32 v190, 2, v190
    v_add_u32 v188, 153728, v190
    ds_read_b32 v188, v188
    v_add_u32_sdwa v191, v191, v206 dst_sel:DWORD dst_unused:UNUSED_PAD src0_sel:BYTE_0 src1_sel:DWORD
    v_lshrrev_b32 v189, 28, v204
    v_lshl_add_u32 v191, v189, 8, v191
    v_and_b32 v189, 60, v190
    v_and_b32 v204, 0xffff, v204
    v_lshl_or_b32 v204, v189, 19, v204
    v_mov_b32 v190, 4
    s_waitcnt lgkmcnt(0)
    ds_add_rtn_u32 v188, v188, v190 offset:576
    s_waitcnt lgkmcnt(0)
    ds_write2st64_b32 v188, v204, v191 offset0:148 offset1:220
    s_mov_b64 exec, -1
    s_waitcnt lgkmcnt(0)
    s_barrier
    v_lshrrev_b32 v190, 3, v247
    v_lshl_add_u32 v248, v190, 4, s12
    s_add_u32 s10, s12, 18432
    v_lshrrev_b32 v190, 1, v247
    v_lshl_add_u32 v249, v190, 2, s10
    s_add_u32 s10, s10, 2
    v_lshrrev_b32 v190, 5, v247
    v_mul_i32_i24 v250, 0xffffb800, v190
    v_and_b32 v190, 15, v247
    v_lshl_add_u32 v250, v190, 2, v250
    v_add_u32 v250, s10, v250
    s_add_u32 s10, s12, 2
    v_and_b32 v190, 48, v247
    v_lshl_add_u32 v251, v190, 1, s10
    v_and_b32 v190, 12, v247
    v_add_u32 v251, v251, v190
    ds_read_b128 v[236:239], v248
    ds_read_b32 v240, v249
    s_lshl_b32 s10, s4, 3
    v_mov_b32 v190, s10
    ds_read_b64 v[190:191], v190 offset:576
    s_waitcnt lgkmcnt(0)
    v_readfirstlane_b32 s34, v190
    v_readfirstlane_b32 s35, v191
    s_sub_u32 s10, s12, 37888
    s_sub_u32 s34, s34, s10
    s_sub_u32 s35, s35, s10
    s_sub_u32 s35, s35, 1152
    s_add_u32 s10, s34, 127
    s_lshr_b32 s10, s10, 7
    s_lshl1_add_u32 s10, s10, -1
    s_add_u32 s11, s35, 127
    s_lshr_b32 s11, s11, 6
    s_and_b32 s11, s11, -2
    s_max_i32 s17, s10, s11
    s_cselect_b32 s10, s34, s35
    s_sub_u32 s10, s10, 1
    s_andn2_b32 s99, 64, s10
    v_mov_b64 v[204:205], 0
    v_mov_b64 v[206:207], 0
    v_mov_b64 v[184:185], 0
    v_mov_b64 v[186:187], 0
    s_add_u32 m0, s13, 0
    v_mad_u32_u16 v236, v236, s15, v243
    buffer_load_dwordx4 v236, s[40:43], 0 offen lds
    s_add_u32 m0, s13, 1056
    v_mad_u32_u16 v237, v237, s15, v243
    buffer_load_dwordx4 v237, s[40:43], 0 offen lds
    s_add_u32 m0, s13, 2112
    v_mad_u32_u16 v238, v238, s15, v243
    buffer_load_dwordx4 v238, s[40:43], 0 offen lds
    s_add_u32 m0, s13, 3168
    v_mad_u32_u16 v239, v239, s15, v243
    buffer_load_dwordx4 v239, s[40:43], 0 offen lds
    s_mov_b32 m0, s14
    s_nop 0
    buffer_load_dwordx4 v[240:241], s[44:47], 0 idxen offen lds
L_LAST:
    s_branch L_GO
.section .rodata,"a"
.p2align 6
.amdhsa_kernel standalone__edge_featured_mpnn_gatedgcn__graph_kernel
  .amdhsa_next_free_vgpr 256
  .amdhsa_next_free_sgpr 102
  .amdhsa_accum_offset 256
  .amdhsa_group_segment_fixed_size 0
  .amdhsa_kernarg_size 96
  .amdhsa_user_sgpr_count 2
  .amdhsa_user_sgpr_kernarg_segment_ptr 1
  .amdhsa_system_sgpr_workgroup_id_x 1
.end_amdhsa_kernel
```

```asm
; @launch grid=(256,1,1) block=(512,1,1) lds=158848
.amdgcn_target "amdgcn-amd-amdhsa--gfx950"
.text
.globl standalone__edge_featured_mpnn_gatedgcn__graph_kernel
.p2align 8
.type standalone__edge_featured_mpnn_gatedgcn__graph_kernel,@function
standalone__edge_featured_mpnn_gatedgcn__graph_kernel:
    s_load_dwordx16 s[16:31], s[0:1], 0
    s_load_dwordx8 s[32:39], s[0:1], 64
    s_getpc_b64 s[64:65]
L_PC:
    s_and_b32 s3, s2, -8
    v_add_lshl_u32 v1, v0, s3, 7
    v_min_u32 v1, L_LAST-L_PC, v1
    v_cmpx_gt_u32 vcc, 8, v0
    s_cbranch_execz L_NOCPF
    global_load_dword v252, v1, s[64:65]
L_NOCPF:
    s_mov_b64 exec, -1
    s_cmp_ge_u32 s2, 256
    s_cbranch_scc1 L_END
    s_mul_i32 s10, s2, 12512
    v_lshl_add_u32 v1, v0, 4, s10
    s_add_u32 s11, s10, 12512
    s_min_u32 s11, s11, 3200000
    v_add_u32 v2, 0x2000, v1
    s_waitcnt lgkmcnt(0)
    global_load_dwordx4 v[128:131], v1, s[22:23] nt
    global_load_dwordx4 v[96:99], v1, s[20:21] nt
    v_cmpx_gt_u32 s[70:71], s11, v2
    s_cbranch_execz L_NO8
    global_load_dwordx4 v[132:135], v2, s[22:23] nt
    global_load_dwordx4 v[100:103], v2, s[20:21] nt
L_NO8:
    s_mov_b64 exec, -1
L_NO7:
    s_mov_b64 exec, -1
    s_load_dword s6, s[38:39], 0
    v_mov_b32 v255, v0
    v_lshrrev_b32 v188, 6, v0
    v_and_b32 v247, 63, v0
    v_readfirstlane_b32 s3, v188
    v_lshlrev_b32 v232, 4, v0
    v_lshlrev_b32 v190, 3, v0
    v_lshlrev_b32 v191, 2, v0
    v_and_b32 v192, 0x3fc, v191
    s_and_b32 s5, s2, 7
    s_lshr_b32 s4, s2, 3
    s_lshl_b32 s5, s5, 5
    s_add_u32 s5, s5, s4
    s_mul_i32 s9, s5, 196
    s_cmp_eq_u32 s3, 7
    s_cselect_b32 s101, 0, s3
    s_lshl_b32 s12, s101, 5
    s_add_u32 s9, s9, s12
    v_lshrrev_b32 v193, 3, v247
    v_lshl_add_u32 v193, v193, 2, s9
    v_and_b32 v243, 7, v247
    v_lshlrev_b32 v243, 4, v243
    v_lshl_add_u32 v234, v193, 7, v243
    s_lshl_b32 s101, s101, 10
    s_add_u32 s101, s101, 116736
    v_mov_b64 v[196:197], 0
    v_mov_b64 v[198:199], 0
    v_mov_b32 v194, 132
    ds_write2st64_b32 v192, v194, v196 offset0:20 offset1:24
    v_add_u32 v193, 46080, v232
    ds_write_b128 v193, v[196:199] offset:0
    ds_write_b128 v193, v[196:199] offset:8192
    ds_write_b128 v193, v[196:199] offset:16384
    ds_write_b128 v193, v[196:199] offset:24576
    ds_write_b128 v193, v[196:199] offset:32768
    s_mov_b32 s44, s18
    s_or_b32 s45, s19, 0x200000
    s_mov_b32 s46, 800000
    s_mov_b32 s47, 0x20000
    s_mov_b32 s48, s34
    s_mov_b32 s49, s35
    s_mov_b32 s50, 6400000
    s_mov_b32 s51, 0x20000
    s_mov_b32 s40, s16
    s_mov_b32 s41, s17
    s_mov_b32 s42, 6400000
    s_mov_b32 s43, 0x20000
    s_mov_b32 s52, s38
    s_mov_b32 s53, s39
    s_mov_b32 s54, 25165824
    s_mov_b32 s55, 0x20000
    s_lshl_b32 s12, s2, 7
    s_add_u32 s12, s12, 65536
    s_add_u32 s56, s38, s12
    s_addc_u32 s57, s39, 0
    s_mov_b32 s58, 16809984
    s_mov_b32 s59, 0x20000
    s_mov_b32 s64, 85599
    s_mov_b32 s65, 4294967100
    s_movk_i32 s66, 5368
    s_mov_b32 s67, 0xc000000
    s_mov_b32 s68, 32896
    s_mov_b32 s100, 0xffeff220
    v_add_u32 v120, 0, v191
    v_add_u32 v121, 1, v191
    v_add_u32 v122, 2, v191
    v_add_u32 v123, 3, v191
    s_lshl_b32 s10, s3, 28
    s_or_b32 s10, s10, 0x20000
    v_mov_b32 v144, s10
    v_or_b32 v145, 0x80000000, v144
    v_mov_b32 v184, 33
    v_mov_b32 v146, 0x400
    s_and_b32 s10, s3, 3
    s_lshr_b32 s4, s3, 2
    s_lshl1_add_u32 s4, s10, s4
    s_xor_b32 s4, s4, 1
    s_mul_i32 s10, s4, 49
    s_sub_i32 s10, s10, 6
    s_ashr_i32 s10, s10, 1
    s_max_i32 s7, s10, 0
    s_mul_i32 s13, s4, 4224
    s_add_u32 s13, s13, 82944
    s_lshl_b32 s14, s4, 10
    s_add_u32 s14, s14, 5120
    s_mul_i32 s12, s4, 2304
    s_add_u32 s12, s12, 46080
    s_movk_i32 s15, 128
    v_bfe_u32 v194, v255, 4, 4
    v_and_b32 v195, 7, v255
    v_cmp_eq_u32 vcc, v194, v195
    v_and_b32 v194, 8, v255
    v_lshlrev_b32 v194, 1, v194
    v_mov_b32 v196, 0x3f80
    v_lshlrev_b32 v196, v194, v196
    v_cndmask_b32 v196, 0, v196, vcc
    ds_write_b32 v192, v196 offset:0
    v_mov_b64 v[196:197], 0
    ds_write_b64 v190, v[196:197] offset:1024
    v_add_u32 v194, 155776, v191
    ds_write_b32 v194, v196
    v_lshrrev_b32 v223, 3, v255
    v_mul_u32_u24 v224, 160, v223
    v_mad_u32_u24 v220, v223, s68, v243
    v_add_u32 v221, v224, v243
    v_add_u32 v221, 46080, v221
    v_bfe_u32 v194, v255, 5, 1
    v_bfe_u32 v196, v255, 6, 1
    v_sub_u32 v194, v194, v196
    v_mul_i32_i24 v194, 640, v194
    v_add_u32 v224, v224, v194
    v_lshl_add_u32 v224, v195, 2, v224
    v_add_u32 v224, 13312, v224
    v_lshlrev_b32 v185, 4, v247
    v_and_b32 v194, 3, v247
    v_lshlrev_b32 v246, 3, v194
    v_bfe_u32 v197, v247, 2, 3
    v_lshrrev_b32 v196, 5, v247
    v_lshl_add_u32 v197, v196, 4, v197
    v_mul_u32_u24 v225, 160, v197
    v_add_u32 v225, v225, v246
    s_movk_i32 s69, 11520
    v_mov_b64 v[116:117], 0
    v_mov_b64 v[118:119], 0
    s_waitcnt lgkmcnt(0)
    s_barrier
    s_cmp_eq_u64 s[70:71], 0
    s_cbranch_scc1 L_R4
    s_waitcnt vmcnt(3)
    v_mul_u32_u24 v104, s64, v128
    v_mul_u32_u24 v105, s64, v129
    v_mul_u32_u24 v106, s64, v130
    v_mul_u32_u24 v107, s64, v131
    v_lshrrev_b32 v136, 29, v104
    v_lshrrev_b32 v137, 29, v105
    v_lshrrev_b32 v138, 29, v106
    v_lshrrev_b32 v139, 29, v107
    v_cmp_eq_u32 s[72:73], v136, v137
    v_cmp_eq_u32 s[76:77], v138, v139
    v_cmp_eq_u32 vcc, v136, v138
    v_cmp_eq_u32 s[88:89], v137, v139
    v_cmp_eq_u32 s[90:91], v136, v139
    v_cmp_eq_u32 s[10:11], v137, v138
    v_lshrrev_b32 v104, 24, v104
    v_lshrrev_b32 v105, 24, v105
    v_lshrrev_b32 v106, 24, v106
    v_lshrrev_b32 v107, 24, v107
    s_or_b64 s[74:75], s[72:73], s[88:89]
    s_or_b64 s[78:79], s[76:77], s[88:89]
    s_or_b64 s[72:73], s[72:73], vcc
    s_or_b64 s[76:77], s[76:77], vcc
    s_or_b64 s[72:73], s[72:73], s[90:91]
    s_or_b64 s[74:75], s[74:75], s[10:11]
    s_or_b64 s[76:77], s[76:77], s[10:11]
    s_or_b64 s[78:79], s[78:79], s[90:91]
    v_cndmask_b32 v136, 0, v146, s[72:73]
    v_lshl_add_u32 v136, v104, 2, v136
    ds_add_rtn_u32 v112, v136, v184 offset:5120
    v_cndmask_b32 v137, 0, v146, s[74:75]
    v_lshl_add_u32 v137, v105, 2, v137
    ds_add_rtn_u32 v113, v137, v184 offset:5120
    v_cndmask_b32 v138, 0, v146, s[76:77]
    v_lshl_add_u32 v138, v106, 2, v138
    ds_add_rtn_u32 v114, v138, v184 offset:5120
    v_cndmask_b32 v139, 0, v146, s[78:79]
    v_lshl_add_u32 v139, v107, 2, v139
    ds_add_rtn_u32 v115, v139, v184 offset:5120
    s_waitcnt vmcnt(1)
    s_mov_b64 exec, s[70:71]
    v_mul_u32_u24 v108, s64, v132
    v_mul_u32_u24 v109, s64, v133
    v_mul_u32_u24 v110, s64, v134
    v_mul_u32_u24 v111, s64, v135
    v_lshrrev_b32 v108, 24, v108
    v_lshrrev_b32 v109, 24, v109
    v_lshrrev_b32 v110, 24, v110
    v_lshrrev_b32 v111, 24, v111
    v_lshlrev_b32 v140, 2, v108
    ds_add_rtn_u32 v116, v140, v184 offset:5120
    v_lshlrev_b32 v141, 2, v109
    ds_add_rtn_u32 v117, v141, v184 offset:5120
    v_lshlrev_b32 v142, 2, v110
    ds_add_rtn_u32 v118, v142, v184 offset:5120
    v_lshlrev_b32 v143, 2, v111
    ds_add_rtn_u32 v119, v143, v184 offset:5120
    s_waitcnt lgkmcnt(7)
    s_mov_b64 exec, s[72:73]
    v_cmpx_le_u32 vcc, 132, v112
    ds_add_rtn_u32 v112, v136, v184 offset:4096
    s_waitcnt lgkmcnt(7)
    s_mov_b64 exec, s[74:75]
    v_cmpx_le_u32 vcc, 132, v113
    ds_add_rtn_u32 v113, v137, v184 offset:4096
    s_waitcnt lgkmcnt(7)
    s_mov_b64 exec, s[76:77]
    v_cmpx_le_u32 vcc, 132, v114
    ds_add_rtn_u32 v114, v138, v184 offset:4096
    s_waitcnt lgkmcnt(7)
    s_mov_b64 exec, s[78:79]
    v_cmpx_le_u32 vcc, 132, v115
    ds_add_rtn_u32 v115, v139, v184 offset:4096
    s_mov_b64 exec, s[70:71]
    s_waitcnt vmcnt(0)
    v_mad_i32_i24 v132, v108, s65, v132
    v_mul_u32_u24 v194, s66, v100
    v_lshl_or_b32 v100, v132, 18, v100
    v_and_b32 v132, 0xe0, v108
    v_mad_i32_i24 v194, v132, s100, v194
    v_and_or_b32 v194, v194, s67, v145
    v_mad_u32_u24 v132, v108, 40, s69
    v_or_b32 v100, v100, v194
    v_mad_i32_i24 v133, v109, s65, v133
    v_mul_u32_u24 v194, s66, v101
    v_lshl_or_b32 v101, v133, 18, v101
    v_and_b32 v133, 0xe0, v109
    v_mad_i32_i24 v194, v133, s100, v194
    v_and_or_b32 v194, v194, s67, v145
    v_mad_u32_u24 v133, v109, 40, s69
    v_or_b32 v101, v101, v194
    v_mad_i32_i24 v134, v110, s65, v134
    v_mul_u32_u24 v194, s66, v102
    v_lshl_or_b32 v102, v134, 18, v102
    v_and_b32 v134, 0xe0, v110
    v_mad_i32_i24 v194, v134, s100, v194
    v_and_or_b32 v194, v194, s67, v145
    v_mad_u32_u24 v134, v110, 40, s69
    v_or_b32 v102, v102, v194
    v_mad_i32_i24 v135, v111, s65, v135
    v_mul_u32_u24 v194, s66, v103
    v_lshl_or_b32 v103, v135, 18, v103
    v_and_b32 v135, 0xe0, v111
    v_mad_i32_i24 v194, v135, s100, v194
    v_and_or_b32 v194, v194, s67, v145
    v_mad_u32_u24 v135, v111, 40, s69
    v_or_b32 v103, v103, v194
    s_waitcnt lgkmcnt(7)
    v_bfe_u32 v194, v116, 3, 5
    v_add_lshl_u32 v132, v194, v132, 2
    v_and_b32 v194, 3, v194
    v_mad_i32_i24 v194, v194, -3, v132
    v_cmpx_gt_u32 vcc, 792, v116
    ds_write_b32 v132, v100
    ds_write_b8 v194, v120 offset:12
    s_mov_b64 exec, s[70:71]
    s_waitcnt lgkmcnt(8)
    v_bfe_u32 v194, v117, 3, 5
    v_add_lshl_u32 v133, v194, v133, 2
    v_and_b32 v194, 3, v194
    v_mad_i32_i24 v194, v194, -3, v133
    v_cmpx_gt_u32 vcc, 792, v117
    ds_write_b32 v133, v101
    ds_write_b8 v194, v121 offset:12
    s_mov_b64 exec, s[70:71]
    s_waitcnt lgkmcnt(9)
    v_bfe_u32 v194, v118, 3, 5
    v_add_lshl_u32 v134, v194, v134, 2
    v_and_b32 v194, 3, v194
    v_mad_i32_i24 v194, v194, -3, v134
    v_cmpx_gt_u32 vcc, 792, v118
    ds_write_b32 v134, v102
    ds_write_b8 v194, v122 offset:12
    s_mov_b64 exec, s[70:71]
    s_waitcnt lgkmcnt(10)
    v_bfe_u32 v194, v119, 3, 5
    v_add_lshl_u32 v135, v194, v135, 2
    v_and_b32 v194, 3, v194
    v_mad_i32_i24 v194, v194, -3, v135
    v_cmpx_gt_u32 vcc, 792, v119
    ds_write_b32 v135, v103
    ds_write_b8 v194, v123 offset:12
    s_mov_b64 exec, -1
    v_mad_i32_i24 v128, v104, s65, v128
    v_mul_u32_u24 v194, s66, v96
    v_lshl_or_b32 v96, v128, 18, v96
    v_and_b32 v128, 0xe0, v104
    v_mad_i32_i24 v194, v128, s100, v194
    v_and_or_b32 v194, v194, s67, v144
    v_mad_u32_u24 v128, v104, 40, s69
    v_or_b32 v96, v96, v194
    v_mad_i32_i24 v129, v105, s65, v129
    v_mul_u32_u24 v194, s66, v97
    v_lshl_or_b32 v97, v129, 18, v97
    v_and_b32 v129, 0xe0, v105
    v_mad_i32_i24 v194, v129, s100, v194
    v_and_or_b32 v194, v194, s67, v144
    v_mad_u32_u24 v129, v105, 40, s69
    v_or_b32 v97, v97, v194
    v_mad_i32_i24 v130, v106, s65, v130
    v_mul_u32_u24 v194, s66, v98
    v_lshl_or_b32 v98, v130, 18, v98
    v_and_b32 v130, 0xe0, v106
    v_mad_i32_i24 v194, v130, s100, v194
    v_and_or_b32 v194, v194, s67, v144
    v_mad_u32_u24 v130, v106, 40, s69
    v_or_b32 v98, v98, v194
    v_mad_i32_i24 v131, v107, s65, v131
    v_mul_u32_u24 v194, s66, v99
    v_lshl_or_b32 v99, v131, 18, v99
    v_and_b32 v131, 0xe0, v107
    v_mad_i32_i24 v194, v131, s100, v194
    v_and_or_b32 v194, v194, s67, v144
    v_mad_u32_u24 v131, v107, 40, s69
    v_or_b32 v99, v99, v194
    s_waitcnt lgkmcnt(11)
    v_bfe_u32 v194, v112, 3, 5
    v_add_lshl_u32 v128, v194, v128, 2
    v_and_b32 v194, 3, v194
    v_mad_i32_i24 v194, v194, -3, v128
    v_cmpx_gt_u32 vcc, 792, v112
    ds_write_b32 v128, v96
    ds_write_b8 v194, v120 offset:12
    s_mov_b64 exec, -1
    s_waitcnt lgkmcnt(12)
    v_bfe_u32 v194, v113, 3, 5
    v_add_lshl_u32 v129, v194, v129, 2
    v_and_b32 v194, 3, v194
    v_mad_i32_i24 v194, v194, -3, v129
    v_cmpx_gt_u32 vcc, 792, v113
    ds_write_b32 v129, v97
    ds_write_b8 v194, v121 offset:12
    s_mov_b64 exec, -1
    s_waitcnt lgkmcnt(13)
    v_bfe_u32 v194, v114, 3, 5
    v_add_lshl_u32 v130, v194, v130, 2
    v_and_b32 v194, 3, v194
    v_mad_i32_i24 v194, v194, -3, v130
    v_cmpx_gt_u32 vcc, 792, v114
    ds_write_b32 v130, v98
    ds_write_b8 v194, v122 offset:12
    s_mov_b64 exec, -1
    s_waitcnt lgkmcnt(14)
    v_bfe_u32 v194, v115, 3, 5
    v_add_lshl_u32 v131, v194, v131, 2
    v_and_b32 v194, 3, v194
    v_mad_i32_i24 v194, v194, -3, v131
    v_cmpx_gt_u32 vcc, 792, v115
    ds_write_b32 v131, v99
    ds_write_b8 v194, v123 offset:12
    s_mov_b64 exec, -1
    s_branch L_B1
L_R4:
    s_waitcnt vmcnt(1)
    v_mul_u32_u24 v104, s64, v128
    v_mul_u32_u24 v105, s64, v129
    v_mul_u32_u24 v106, s64, v130
    v_mul_u32_u24 v107, s64, v131
    v_lshrrev_b32 v136, 29, v104
    v_lshrrev_b32 v137, 29, v105
    v_lshrrev_b32 v138, 29, v106
    v_lshrrev_b32 v139, 29, v107
    v_cmp_eq_u32 s[72:73], v136, v137
    v_cmp_eq_u32 s[76:77], v138, v139
    v_cmp_eq_u32 vcc, v136, v138
    v_cmp_eq_u32 s[88:89], v137, v139
    v_cmp_eq_u32 s[90:91], v136, v139
    v_cmp_eq_u32 s[10:11], v137, v138
    v_lshrrev_b32 v104, 24, v104
    v_lshrrev_b32 v105, 24, v105
    v_lshrrev_b32 v106, 24, v106
    v_lshrrev_b32 v107, 24, v107
    s_or_b64 s[74:75], s[72:73], s[88:89]
    s_or_b64 s[78:79], s[76:77], s[88:89]
    s_or_b64 s[72:73], s[72:73], vcc
    s_or_b64 s[76:77], s[76:77], vcc
    s_or_b64 s[72:73], s[72:73], s[90:91]
    s_or_b64 s[74:75], s[74:75], s[10:11]
    s_or_b64 s[76:77], s[76:77], s[10:11]
    s_or_b64 s[78:79], s[78:79], s[90:91]
    v_cndmask_b32 v136, 0, v146, s[72:73]
    v_lshl_add_u32 v136, v104, 2, v136
    ds_add_rtn_u32 v112, v136, v184 offset:5120
    v_cndmask_b32 v137, 0, v146, s[74:75]
    v_lshl_add_u32 v137, v105, 2, v137
    ds_add_rtn_u32 v113, v137, v184 offset:5120
    v_cndmask_b32 v138, 0, v146, s[76:77]
    v_lshl_add_u32 v138, v106, 2, v138
    ds_add_rtn_u32 v114, v138, v184 offset:5120
    v_cndmask_b32 v139, 0, v146, s[78:79]
    v_lshl_add_u32 v139, v107, 2, v139
    ds_add_rtn_u32 v115, v139, v184 offset:5120
    s_waitcnt vmcnt(0)
    v_mad_i32_i24 v128, v104, s65, v128
    v_mul_u32_u24 v194, s66, v96
    v_lshl_or_b32 v96, v128, 18, v96
    v_and_b32 v128, 0xe0, v104
    v_mad_i32_i24 v194, v128, s100, v194
    v_and_or_b32 v194, v194, s67, v144
    v_mad_u32_u24 v128, v104, 40, s69
    v_or_b32 v96, v96, v194
    v_mad_i32_i24 v129, v105, s65, v129
    v_mul_u32_u24 v194, s66, v97
    v_lshl_or_b32 v97, v129, 18, v97
    v_and_b32 v129, 0xe0, v105
    v_mad_i32_i24 v194, v129, s100, v194
    v_and_or_b32 v194, v194, s67, v144
    v_mad_u32_u24 v129, v105, 40, s69
    v_or_b32 v97, v97, v194
    s_waitcnt lgkmcnt(3)
    s_mov_b64 exec, s[72:73]
    v_cmpx_le_u32 vcc, 132, v112
    ds_add_rtn_u32 v112, v136, v184 offset:4096
    s_waitcnt lgkmcnt(3)
    s_mov_b64 exec, s[74:75]
    v_cmpx_le_u32 vcc, 132, v113
    ds_add_rtn_u32 v113, v137, v184 offset:4096
    s_waitcnt lgkmcnt(3)
    s_mov_b64 exec, s[76:77]
    v_cmpx_le_u32 vcc, 132, v114
    ds_add_rtn_u32 v114, v138, v184 offset:4096
    s_waitcnt lgkmcnt(3)
    s_mov_b64 exec, s[78:79]
    v_cmpx_le_u32 vcc, 132, v115
    ds_add_rtn_u32 v115, v139, v184 offset:4096
    s_mov_b64 exec, -1
    v_mad_i32_i24 v130, v106, s65, v130
    v_mul_u32_u24 v194, s66, v98
    v_lshl_or_b32 v98, v130, 18, v98
    v_and_b32 v130, 0xe0, v106
    v_mad_i32_i24 v194, v130, s100, v194
    v_and_or_b32 v194, v194, s67, v144
    v_mad_u32_u24 v130, v106, 40, s69
    v_or_b32 v98, v98, v194
    v_mad_i32_i24 v131, v107, s65, v131
    v_mul_u32_u24 v194, s66, v99
    v_lshl_or_b32 v99, v131, 18, v99
    v_and_b32 v131, 0xe0, v107
    v_mad_i32_i24 v194, v131, s100, v194
    v_and_or_b32 v194, v194, s67, v144
    v_mad_u32_u24 v131, v107, 40, s69
    v_or_b32 v99, v99, v194
    s_waitcnt lgkmcnt(3)
    v_bfe_u32 v194, v112, 3, 5
    v_add_lshl_u32 v128, v194, v128, 2
    v_and_b32 v194, 3, v194
    v_mad_i32_i24 v194, v194, -3, v128
    v_cmpx_gt_u32 vcc, 792, v112
    ds_write_b32 v128, v96
    ds_write_b8 v194, v120 offset:12
    s_mov_b64 exec, -1
    s_waitcnt lgkmcnt(4)
    v_bfe_u32 v194, v113, 3, 5
    v_add_lshl_u32 v129, v194, v129, 2
    v_and_b32 v194, 3, v194
    v_mad_i32_i24 v194, v194, -3, v129
    v_cmpx_gt_u32 vcc, 792, v113
    ds_write_b32 v129, v97
    ds_write_b8 v194, v121 offset:12
    s_mov_b64 exec, -1
    s_waitcnt lgkmcnt(5)
    v_bfe_u32 v194, v114, 3, 5
    v_add_lshl_u32 v130, v194, v130, 2
    v_and_b32 v194, 3, v194
    v_mad_i32_i24 v194, v194, -3, v130
    v_cmpx_gt_u32 vcc, 792, v114
    ds_write_b32 v130, v98
    ds_write_b8 v194, v122 offset:12
    s_mov_b64 exec, -1
    s_waitcnt lgkmcnt(6)
    v_bfe_u32 v194, v115, 3, 5
    v_add_lshl_u32 v131, v194, v131, 2
    v_and_b32 v194, 3, v194
    v_mad_i32_i24 v194, v194, -3, v131
    v_cmpx_gt_u32 vcc, 792, v115
    ds_write_b32 v131, v99
    ds_write_b8 v194, v123 offset:12
    s_mov_b64 exec, -1
L_B1:
    s_cmp_ge_u32 s3, 2
    s_cbranch_scc1 L_NOC
    global_load_dwordx4 v[176:179], v232, s[28:29]
L_NOC:
    global_load_dwordx4 v[160:163], v232, s[26:27]
    global_load_dwordx4 v[164:167], v232, s[32:33]
    global_load_dwordx4 v[168:171], v232, s[24:25]
    global_load_dwordx4 v[172:175], v232, s[30:31]
    s_add_u32 s6, s6, 0x2020202
    v_lshlrev_b32 v186, v246, s6
    v_and_b32 v189, 4, v247
    v_mul_u32_u24 v189, 1212416, v189
    v_lshl_add_u32 v186, v189, 8, v186
    v_and_b32 v186, 0xfe000000, v186
    v_and_b32 v187, 7, v247
    v_mul_u32_u24 v187, 33, v187
    v_add_u32 v187, 792, v187
    v_lshlrev_b32 v222, 2, v223
    s_mov_b32 s64, 0x1000000
    s_waitcnt lgkmcnt(0)
    s_barrier
    ds_read_b128 v[192:195], v185 offset:5120
    ds_read_b32 v228, v222 offset:5120
    ds_read_b128 v[204:207], v221 offset:0
    ds_read_b32 v229, v222 offset:5376
    ds_read_b128 v[208:211], v221 offset:10240
    ds_read_b32 v230, v222 offset:5632
    ds_read_b128 v[212:215], v221 offset:20480
    ds_read_b32 v231, v222 offset:5888
    ds_read_b128 v[216:219], v221 offset:30720
    s_mov_b32 s80, 2105344
    s_mov_b32 s81, 4210688
    s_mov_b32 s82, 6316032
    s_waitcnt lgkmcnt(8)
    v_max3_u32 v188, v192, v193, v194
    v_max_u32 v188, v188, v195
    v_cmp_lt_u32 vcc, 1056, v188
    s_cbranch_vccnz L_POVF
L_POUT:
    s_waitcnt lgkmcnt(7)
    v_sub_u32 v228, v187, v228
    v_and_or_b32 v228, v228, s64, v186
    s_waitcnt lgkmcnt(6)
    v_or_b32 v207, v207, v228
    buffer_store_dwordx4 v[204:207], v220, s[56:59], 0 offen sc1
    s_waitcnt lgkmcnt(5)
    v_sub_u32 v229, v187, v229
    v_and_or_b32 v229, v229, s64, v186
    s_waitcnt lgkmcnt(4)
    v_or_b32 v211, v211, v229
    buffer_store_dwordx4 v[208:211], v220, s[56:59], s80 offen sc1
    s_waitcnt lgkmcnt(3)
    v_sub_u32 v230, v187, v230
    v_and_or_b32 v230, v230, s64, v186
    s_waitcnt lgkmcnt(2)
    v_or_b32 v215, v215, v230
    buffer_store_dwordx4 v[212:215], v220, s[56:59], s81 offen sc1
    s_waitcnt lgkmcnt(1)
    v_sub_u32 v231, v187, v231
    v_and_or_b32 v231, v231, s64, v186
    s_waitcnt lgkmcnt(0)
    v_or_b32 v219, v219, v231
    buffer_store_dwordx4 v[216:219], v220, s[56:59], s82 offen sc1
    s_mov_b32 s10, 0xbfb8aa3b
    s_mov_b32 s11, s10
    s_mov_b32 s64, 0x05040100
    s_mov_b32 s66, 0x07060302
    s_waitcnt vmcnt(4)
    v_perm_b32 v144, v170, v168, s64
    v_perm_b32 v145, v170, v168, s66
    v_perm_b32 v146, v171, v169, s64
    v_perm_b32 v147, v171, v169, s66
    v_add_u32 v148, 77824, v224
    ds_write2_b32 v148, v144, v145 offset0:0 offset1:8
    ds_write2_b32 v148, v146, v147 offset0:16 offset1:24
    v_lshlrev_b32 v128, 16, v160
    v_and_b32 v129, 0xffff0000, v160
    v_lshlrev_b32 v130, 16, v161
    v_and_b32 v131, 0xffff0000, v161
    v_lshlrev_b32 v132, 16, v162
    v_and_b32 v133, 0xffff0000, v162
    v_lshlrev_b32 v134, 16, v163
    v_and_b32 v135, 0xffff0000, v163
    v_pk_mul_f32 v[128:129], v[128:129], s[10:11]
    v_pk_mul_f32 v[130:131], v[130:131], s[10:11]
    v_pk_mul_f32 v[132:133], v[132:133], s[10:11]
    v_pk_mul_f32 v[134:135], v[134:135], s[10:11]
    v_cvt_pk_bf16_f32 v136, v128, v132
    v_cvt_pk_bf16_f32 v137, v129, v133
    v_cvt_pk_bf16_f32 v138, v130, v134
    v_cvt_pk_bf16_f32 v139, v131, v135
    ds_write2_b32 v224, v136, v137 offset0:0 offset1:8
    ds_write2_b32 v224, v138, v139 offset0:16 offset1:24
    v_perm_b32 v152, v166, v164, s64
    v_perm_b32 v153, v166, v164, s66
    v_perm_b32 v154, v167, v165, s64
    v_perm_b32 v155, v167, v165, s66
    v_add_u32 v156, 10240, v224
    ds_write2_b32 v156, v152, v153 offset0:0 offset1:8
    ds_write2_b32 v156, v154, v155 offset0:16 offset1:24
    v_perm_b32 v144, v174, v172, s64
    v_perm_b32 v145, v174, v172, s66
    v_perm_b32 v146, v175, v173, s64
    v_perm_b32 v147, v175, v173, s66
    v_add_u32 v148, 130176, v224
    ds_write2_b32 v148, v144, v145 offset0:0 offset1:8
    ds_write2_b32 v148, v146, v147 offset0:16 offset1:24
    s_cmp_ge_u32 s3, 2
    s_cbranch_scc1 L_NOWC
    v_lshlrev_b32 v128, 16, v176
    v_and_b32 v129, 0xffff0000, v176
    v_lshlrev_b32 v130, 16, v177
    v_and_b32 v131, 0xffff0000, v177
    v_lshlrev_b32 v132, 16, v178
    v_and_b32 v133, 0xffff0000, v178
    v_lshlrev_b32 v134, 16, v179
    v_and_b32 v135, 0xffff0000, v179
    v_pk_mul_f32 v[128:129], v[128:129], s[10:11]
    v_pk_mul_f32 v[130:131], v[130:131], s[10:11]
    v_pk_mul_f32 v[132:133], v[132:133], s[10:11]
    v_pk_mul_f32 v[134:135], v[134:135], s[10:11]
    v_cvt_pk_bf16_f32 v136, v128, v132
    v_cvt_pk_bf16_f32 v137, v129, v133
    v_cvt_pk_bf16_f32 v138, v130, v134
    v_cvt_pk_bf16_f32 v139, v131, v135
    v_add_u32 v140, 20480, v224
    ds_write2_b32 v140, v136, v137 offset0:0 offset1:8
    ds_write2_b32 v140, v138, v139 offset0:16 offset1:24
L_NOWC:
    s_mul_i32 s34, s5, 32896
    s_add_u32 s34, s34, 65536
    s_add_u32 s56, s38, s34
    s_addc_u32 s57, s39, 0
    s_mov_b32 s58, 32768
    s_mov_b32 s59, 0x20000
    s_add_u32 s34, s34, 8421376
    s_add_u32 s60, s38, s34
    s_addc_u32 s61, s39, 0
    s_mov_b32 s62, 32768
    s_mov_b32 s63, 0x20000
    s_movk_i32 s26, 0
    s_movk_i32 s27, 8192
    s_movk_i32 s28, 16384
    s_movk_i32 s29, 24576
    s_waitcnt lgkmcnt(0)
    s_barrier
    v_add_u32 v225, 13312, v225
    ds_read_b64_tr_b16 v[0:1], v225 offset:0
    ds_read_b64_tr_b16 v[2:3], v225 offset:1280
    ds_read_b64_tr_b16 v[4:5], v225 offset:5120
    ds_read_b64_tr_b16 v[6:7], v225 offset:6400
    ds_read_b64_tr_b16 v[8:9], v225 offset:32
    ds_read_b64_tr_b16 v[10:11], v225 offset:1312
    ds_read_b64_tr_b16 v[12:13], v225 offset:5152
    ds_read_b64_tr_b16 v[14:15], v225 offset:6432
    ds_read_b64_tr_b16 v[16:17], v225 offset:64
    ds_read_b64_tr_b16 v[18:19], v225 offset:1344
    ds_read_b64_tr_b16 v[20:21], v225 offset:5184
    ds_read_b64_tr_b16 v[22:23], v225 offset:6464
    ds_read_b64_tr_b16 v[24:25], v225 offset:96
    ds_read_b64_tr_b16 v[26:27], v225 offset:1376
    v_mov_b32 v64, 0x2000000
    v_mov_b32 v65, 0x2000000
    v_mov_b32 v66, 0x2000000
    v_mov_b32 v67, 0x2000000
    v_mov_b32 v68, 0xfffff
    v_mov_b32 v69, 0xfffff
    v_mov_b32 v70, 0xfffff
    v_mov_b32 v71, 0xfffff
    v_lshl_add_u32 v72, v247, 4, s12
    ds_write_b128 v72, v[64:67] offset:0
    ds_write_b128 v72, v[68:71] offset:18432
    ds_write_b128 v72, v[64:67] offset:1024
    ds_write_b128 v72, v[68:71] offset:19456
    ds_write_b128 v72, v[64:67] offset:1280
    ds_write_b128 v72, v[68:71] offset:19712
    ds_read_b64_tr_b16 v[28:29], v225 offset:5216
    ds_read_b64_tr_b16 v[30:31], v225 offset:6496
    ds_read_b64_tr_b16 v[32:33], v225 offset:10240
    ds_read_b64_tr_b16 v[34:35], v225 offset:11520
    ds_read_b64_tr_b16 v[36:37], v225 offset:15360
    ds_read_b64_tr_b16 v[38:39], v225 offset:16640
    ds_read_b64_tr_b16 v[40:41], v225 offset:10272
    ds_read_b64_tr_b16 v[42:43], v225 offset:11552
    ds_read_b64_tr_b16 v[44:45], v225 offset:15392
    ds_read_b64_tr_b16 v[46:47], v225 offset:16672
    v_mov_b32 v192, v225
    s_mov_b32 exec_lo, 0
    v_subrev_u32 v192, 2560, v225
    s_mov_b32 exec_lo, -1
    s_waitcnt lgkmcnt(4)
    ds_read_b64_tr_b16 v[48:49], v225 offset:10304
    ds_read_b64_tr_b16 v[50:51], v225 offset:11584
    ds_read_b64_tr_b16 v[52:53], v225 offset:15424
    ds_read_b64_tr_b16 v[54:55], v225 offset:16704
    ds_read_b64_tr_b16 v[56:57], v225 offset:10336
    ds_read_b64_tr_b16 v[58:59], v225 offset:11616
    ds_read_b64_tr_b16 v[60:61], v225 offset:15456
    ds_read_b64_tr_b16 v[62:63], v225 offset:16736
    ds_read_b64_tr_b16 v[80:81], v192 offset:20480
    ds_read_b64_tr_b16 v[82:83], v192 offset:21760
    ds_read_b64_tr_b16 v[84:85], v192 offset:20512
    ds_read_b64_tr_b16 v[86:87], v192 offset:21792
    ds_read_b64_tr_b16 v[88:89], v192 offset:20544
    ds_read_b64_tr_b16 v[90:91], v192 offset:21824
    ds_read_b64_tr_b16 v[92:93], v192 offset:20576
    ds_read_b64_tr_b16 v[94:95], v192 offset:21856
    v_add_u32 v225, 77824, v225
    v_and_b32 v241, 1, v247
    v_lshlrev_b32 v241, 4, v241
    v_mov_b32 v242, 0x3f80
    v_and_b32 v245, 16, v247
    v_and_b32 v194, 15, v247
    v_lshl_add_u32 v194, v194, 5, s14
    s_mov_b32 exec_hi, 0
    v_add_u32 v245, v245, v194
    s_mov_b32 exec_hi, -1
    v_and_b32 v194, 3, v247
    v_bfe_u32 v196, v247, 2, 2
    v_and_b32 v197, 48, v247
    v_lshl_add_u32 v198, v196, 7, v197
    v_mul_u32_u24 v244, 1056, v194
    v_add3_u32 v244, v244, v198, s13
    v_lshrrev_b32 v194, 3, v247
    v_lshl_add_u32 v248, v194, 4, s12
    s_add_u32 s10, s12, 18432
    v_lshrrev_b32 v194, 1, v247
    v_lshl_add_u32 v249, v194, 2, s10
    s_add_u32 s10, s10, 2
    v_lshrrev_b32 v194, 5, v247
    v_mul_i32_i24 v250, 0xffffb800, v194
    v_and_b32 v194, 15, v247
    v_lshl_add_u32 v250, v194, 2, v250
    v_add_u32 v250, s10, v250
    s_add_u32 s10, s12, 2
    v_and_b32 v194, 48, v247
    v_lshl_add_u32 v251, v194, 1, s10
    v_and_b32 v194, 12, v247
    v_add_u32 v251, v251, v194
    v_mul_u32_u24 v159, 3128, v223
    v_add_u32 v156, 0, v159
    v_add_u32 v157, 200192, v159
    v_add_u32 v158, 400384, v159
    v_add_u32 v159, 600576, v159
    s_mov_b32 s98, 0xf0f0f0f
    s_mov_b32 s99, 0xf0f0f0f
    v_mov_b32 v180, 0xfffff
    v_mov_b32 v176, 0
    v_add_lshl_u32 v191, v232, v243, 16
    v_add_u32 v152, 0x34000000, v191
    v_cndmask_b32 v152, 0, v152, s[98:99]
    v_add_u32 v153, 0x54000000, v191
    v_cndmask_b32 v153, 0, v153, s[98:99]
    v_add_u32 v154, 0x74000000, v191
    v_cndmask_b32 v154, 0, v154, s[98:99]
    v_add_u32 v155, 0x94000000, v191
    v_cndmask_b32 v155, 0, v155, s[98:99]
    v_mov_b32 v184, 4
    v_and_b32 v177, 31, v247
    v_add_lshl_u32 v179, v177, s7, 2
    v_lshrrev_b32 v191, 5, v247
    v_lshl_add_u32 v178, v191, 11, v179
    v_add_u32 v179, 153728, v179
    v_lshlrev_b32 v191, 2, v247
    v_subrev_u32 v191, s7, v191
    s_mov_b32 s10, 0x10000
    v_add_u32 v228, 0, v191
    v_and_or_b32 v228, v228, s10, 1
    v_add_u32 v229, 1, v191
    v_and_or_b32 v229, v229, s10, 1
    v_add_u32 v230, 2, v191
    v_and_or_b32 v230, v230, s10, 1
    v_add_u32 v231, 3, v191
    v_and_or_b32 v231, v231, s10, 1
    s_movk_i32 s18, 0xffc
    s_movk_i32 s20, 32
    s_mov_b32 s21, 0
    s_mov_b32 s100, 0
    s_mov_b32 s16, 0x1ffffff
    s_mov_b32 s17, 0xffff
    s_mul_i32 s10, s4, 49
    s_sub_i32 s22, s10, 6
    s_ashr_i32 s22, s22, 1
    s_add_i32 s23, s10, 7
    s_ashr_i32 s23, s23, 1
    s_add_i32 s24, s10, 43
    s_ashr_i32 s24, s24, 1
    s_add_i32 s25, s22, 31
    s_cmp_eq_u32 s4, 7
    s_cselect_b32 s24, 196, s24
    s_cselect_b32 s25, 196, s25
    s_sub_i32 s23, s23, s7
    s_sub_i32 s24, s24, s7
    s_sub_i32 s25, s25, s7
    s_waitcnt vmcnt(0)
    buffer_load_dwordx4 v[128:131], v232, s[56:59], s26 offen sc1
    buffer_load_dwordx4 v[132:135], v232, s[56:59], s27 offen sc1
    buffer_load_dwordx4 v[136:139], v232, s[56:59], s28 offen sc1
    buffer_load_dwordx4 v[140:143], v232, s[56:59], s29 offen sc1
    v_max3_u32 v188, v112, v113, v114
    v_max3_u32 v189, v115, v116, v117
    v_max3_u32 v188, v188, v118, v119
    v_max_u32 v188, v188, v189
    v_cmp_le_u32 vcc, 792, v188
    s_cbranch_vccz L_PEXTR
    v_mov_b32 v65, s6
    s_lshl_b32 s34, s2, 7
    s_add_u32 s34, s34, 8486912
    v_subrev_u32 v68, 792, v112
    v_cmpx_gt_u32 vcc, 264, v68
    s_cbranch_execz L_PE0
    v_mov_b32 v64, v96
    v_mov_b32 v66, v120
    v_bfe_u32 v68, v112, 5, 3
    v_lshlrev_b32 v68, 4, v68
    v_mad_u32_u24 v68, v104, s68, v68
    buffer_store_dwordx4 v[64:67], v68, s[52:55], s34 offen sc1
L_PE0:
    s_mov_b64 exec, -1
    v_subrev_u32 v68, 792, v113
    v_cmpx_gt_u32 vcc, 264, v68
    s_cbranch_execz L_PE1
    v_mov_b32 v64, v97
    v_mov_b32 v66, v121
    v_bfe_u32 v68, v113, 5, 3
    v_lshlrev_b32 v68, 4, v68
    v_mad_u32_u24 v68, v105, s68, v68
    buffer_store_dwordx4 v[64:67], v68, s[52:55], s34 offen sc1
L_PE1:
    s_mov_b64 exec, -1
    v_subrev_u32 v68, 792, v114
    v_cmpx_gt_u32 vcc, 264, v68
    s_cbranch_execz L_PE2
    v_mov_b32 v64, v98
    v_mov_b32 v66, v122
    v_bfe_u32 v68, v114, 5, 3
    v_lshlrev_b32 v68, 4, v68
    v_mad_u32_u24 v68, v106, s68, v68
    buffer_store_dwordx4 v[64:67], v68, s[52:55], s34 offen sc1
L_PE2:
    s_mov_b64 exec, -1
    v_subrev_u32 v68, 792, v115
    v_cmpx_gt_u32 vcc, 264, v68
    s_cbranch_execz L_PE3
    v_mov_b32 v64, v99
    v_mov_b32 v66, v123
    v_bfe_u32 v68, v115, 5, 3
    v_lshlrev_b32 v68, 4, v68
    v_mad_u32_u24 v68, v107, s68, v68
    buffer_store_dwordx4 v[64:67], v68, s[52:55], s34 offen sc1
L_PE3:
    s_mov_b64 exec, -1
    v_subrev_u32 v68, 792, v116
    v_cmpx_gt_u32 vcc, 264, v68
    s_cbranch_execz L_PE4
    v_mov_b32 v64, v100
    v_mov_b32 v66, v120
    v_bfe_u32 v68, v116, 5, 3
    v_lshlrev_b32 v68, 4, v68
    v_mad_u32_u24 v68, v108, s68, v68
    buffer_store_dwordx4 v[64:67], v68, s[52:55], s34 offen sc1
L_PE4:
    s_mov_b64 exec, -1
    v_subrev_u32 v68, 792, v117
    v_cmpx_gt_u32 vcc, 264, v68
    s_cbranch_execz L_PE5
    v_mov_b32 v64, v101
    v_mov_b32 v66, v121
    v_bfe_u32 v68, v117, 5, 3
    v_lshlrev_b32 v68, 4, v68
    v_mad_u32_u24 v68, v109, s68, v68
    buffer_store_dwordx4 v[64:67], v68, s[52:55], s34 offen sc1
L_PE5:
    s_mov_b64 exec, -1
    v_subrev_u32 v68, 792, v118
    v_cmpx_gt_u32 vcc, 264, v68
    s_cbranch_execz L_PE6
    v_mov_b32 v64, v102
    v_mov_b32 v66, v122
    v_bfe_u32 v68, v118, 5, 3
    v_lshlrev_b32 v68, 4, v68
    v_mad_u32_u24 v68, v110, s68, v68
    buffer_store_dwordx4 v[64:67], v68, s[52:55], s34 offen sc1
L_PE6:
    s_mov_b64 exec, -1
    v_subrev_u32 v68, 792, v119
    v_cmpx_gt_u32 vcc, 264, v68
    s_cbranch_execz L_PE7
    v_mov_b32 v64, v103
    v_mov_b32 v66, v123
    v_bfe_u32 v68, v119, 5, 3
    v_lshlrev_b32 v68, 4, v68
    v_mad_u32_u24 v68, v111, s68, v68
    buffer_store_dwordx4 v[64:67], v68, s[52:55], s34 offen sc1
L_PE7:
    s_mov_b64 exec, -1
L_PEXTR:
L_PW0:
    s_waitcnt vmcnt(3)
    v_xor_b32 v188, v131, v186
    v_and_b32_sdwa v96, v128, s18 dst_sel:DWORD dst_unused:UNUSED_PAD src0_sel:WORD_1 src1_sel:DWORD
    v_and_b32_sdwa v97, v129, s18 dst_sel:DWORD dst_unused:UNUSED_PAD src0_sel:WORD_1 src1_sel:DWORD
    v_and_b32_sdwa v98, v130, s18 dst_sel:DWORD dst_unused:UNUSED_PAD src0_sel:WORD_1 src1_sel:DWORD
    v_cmp_lt_u32 vcc, s16, v188
    v_cmp_ne_u32 s[64:65], 0, v128
    v_cmp_ne_u32 s[66:67], 0, v129
    v_cmp_ne_u32 s[68:69], 0, v130
    s_cbranch_vccnz L_RT0
    s_mov_b64 exec, s[64:65]
    ds_add_rtn_u32 v112, v96, v184 offset:1024
    s_mov_b64 exec, s[66:67]
    ds_add_rtn_u32 v113, v97, v184 offset:1024
    s_mov_b64 exec, s[68:69]
    ds_add_rtn_u32 v114, v98, v184 offset:1024
    s_mov_b64 exec, -1
    v_or_b32 v176, v176, v129
    v_add_u32_sdwa v204, v131, v156 dst_sel:DWORD dst_unused:UNUSED_PAD src0_sel:BYTE_0 src1_sel:DWORD
    v_lshrrev_b32 v189, 28, v128
    v_lshl_add_u32 v204, v189, 8, v204
    v_and_b32 v189, 60, v96
    v_and_b32 v128, 0xffff, v128
    v_lshl_or_b32 v128, v189, 19, v128
    v_cndmask_b32 v188, v180, v204, s[64:65]
    v_max_u32 v204, v204, v152
    v_add_u32_sdwa v205, v131, v156 dst_sel:DWORD dst_unused:UNUSED_PAD src0_sel:BYTE_1 src1_sel:DWORD
    v_lshrrev_b32 v189, 28, v129
    v_lshl_add_u32 v205, v189, 8, v205
    v_and_b32 v189, 60, v97
    v_and_b32 v129, 0xffff, v129
    v_lshl_or_b32 v129, v189, 19, v129
    v_mov_b32_dpp v190, v188 quad_perm:[2,2,3,3] row_mask:0xf bank_mask:0xf
    v_mov_b32_dpp v207, v188 quad_perm:[0,0,1,1] row_mask:0xf bank_mask:0xf
    v_add_u32_sdwa v206, v131, v156 dst_sel:DWORD dst_unused:UNUSED_PAD src0_sel:BYTE_2 src1_sel:DWORD
    v_lshrrev_b32 v189, 28, v130
    v_lshl_add_u32 v206, v189, 8, v206
    v_and_b32 v189, 60, v98
    v_and_b32 v130, 0xffff, v130
    v_lshl_or_b32 v130, v189, 19, v130
    v_mov_b32_dpp v207, v190 row_shr:4 row_mask:0xf bank_mask:0xa
L_PW1:
    s_waitcnt vmcnt(2)
    v_xor_b32 v188, v135, v186
    v_and_b32_sdwa v100, v132, s18 dst_sel:DWORD dst_unused:UNUSED_PAD src0_sel:WORD_1 src1_sel:DWORD
    v_and_b32_sdwa v101, v133, s18 dst_sel:DWORD dst_unused:UNUSED_PAD src0_sel:WORD_1 src1_sel:DWORD
    v_and_b32_sdwa v102, v134, s18 dst_sel:DWORD dst_unused:UNUSED_PAD src0_sel:WORD_1 src1_sel:DWORD
    v_cmp_lt_u32 vcc, s16, v188
    v_cmp_ne_u32 s[72:73], 0, v132
    v_cmp_ne_u32 s[74:75], 0, v133
    v_cmp_ne_u32 s[76:77], 0, v134
    s_cbranch_vccnz L_RT1
    s_mov_b64 exec, s[72:73]
    ds_add_rtn_u32 v116, v100, v184 offset:1024
    s_mov_b64 exec, s[74:75]
    ds_add_rtn_u32 v117, v101, v184 offset:1024
    s_mov_b64 exec, s[76:77]
    ds_add_rtn_u32 v118, v102, v184 offset:1024
    s_mov_b64 exec, -1
    v_or_b32 v176, v176, v133
    v_add_u32_sdwa v208, v135, v157 dst_sel:DWORD dst_unused:UNUSED_PAD src0_sel:BYTE_0 src1_sel:DWORD
    v_lshrrev_b32 v189, 28, v132
    v_lshl_add_u32 v208, v189, 8, v208
    v_and_b32 v189, 60, v100
    v_and_b32 v132, 0xffff, v132
    v_lshl_or_b32 v132, v189, 19, v132
    v_cndmask_b32 v188, v180, v208, s[72:73]
    v_max_u32 v208, v208, v153
    v_add_u32_sdwa v209, v135, v157 dst_sel:DWORD dst_unused:UNUSED_PAD src0_sel:BYTE_1 src1_sel:DWORD
    v_lshrrev_b32 v189, 28, v133
    v_lshl_add_u32 v209, v189, 8, v209
    v_and_b32 v189, 60, v101
    v_and_b32 v133, 0xffff, v133
    v_lshl_or_b32 v133, v189, 19, v133
    v_mov_b32_dpp v190, v188 quad_perm:[2,2,3,3] row_mask:0xf bank_mask:0xf
    v_mov_b32_dpp v211, v188 quad_perm:[0,0,1,1] row_mask:0xf bank_mask:0xf
    v_add_u32_sdwa v210, v135, v157 dst_sel:DWORD dst_unused:UNUSED_PAD src0_sel:BYTE_2 src1_sel:DWORD
    v_lshrrev_b32 v189, 28, v134
    v_lshl_add_u32 v210, v189, 8, v210
    v_and_b32 v189, 60, v102
    v_and_b32 v134, 0xffff, v134
    v_lshl_or_b32 v134, v189, 19, v134
    v_mov_b32_dpp v211, v190 row_shr:4 row_mask:0xf bank_mask:0xa
L_PW2:
    s_waitcnt vmcnt(1)
    v_xor_b32 v188, v139, v186
    v_and_b32_sdwa v104, v136, s18 dst_sel:DWORD dst_unused:UNUSED_PAD src0_sel:WORD_1 src1_sel:DWORD
    v_and_b32_sdwa v105, v137, s18 dst_sel:DWORD dst_unused:UNUSED_PAD src0_sel:WORD_1 src1_sel:DWORD
    v_and_b32_sdwa v106, v138, s18 dst_sel:DWORD dst_unused:UNUSED_PAD src0_sel:WORD_1 src1_sel:DWORD
    v_cmp_lt_u32 vcc, s16, v188
    v_cmp_ne_u32 s[80:81], 0, v136
    v_cmp_ne_u32 s[82:83], 0, v137
    v_cmp_ne_u32 s[84:85], 0, v138
    s_cbranch_vccnz L_RT2
    s_mov_b64 exec, s[80:81]
    ds_add_rtn_u32 v120, v104, v184 offset:1024
    s_mov_b64 exec, s[82:83]
    ds_add_rtn_u32 v121, v105, v184 offset:1024
    s_mov_b64 exec, s[84:85]
    ds_add_rtn_u32 v122, v106, v184 offset:1024
    s_mov_b64 exec, -1
    v_or_b32 v176, v176, v137
    v_add_u32_sdwa v212, v139, v158 dst_sel:DWORD dst_unused:UNUSED_PAD src0_sel:BYTE_0 src1_sel:DWORD
    v_lshrrev_b32 v189, 28, v136
    v_lshl_add_u32 v212, v189, 8, v212
    v_and_b32 v189, 60, v104
    v_and_b32 v136, 0xffff, v136
    v_lshl_or_b32 v136, v189, 19, v136
    v_cndmask_b32 v188, v180, v212, s[80:81]
    v_max_u32 v212, v212, v154
    v_add_u32_sdwa v213, v139, v158 dst_sel:DWORD dst_unused:UNUSED_PAD src0_sel:BYTE_1 src1_sel:DWORD
    v_lshrrev_b32 v189, 28, v137
    v_lshl_add_u32 v213, v189, 8, v213
    v_and_b32 v189, 60, v105
    v_and_b32 v137, 0xffff, v137
    v_lshl_or_b32 v137, v189, 19, v137
    v_mov_b32_dpp v190, v188 quad_perm:[2,2,3,3] row_mask:0xf bank_mask:0xf
    v_mov_b32_dpp v215, v188 quad_perm:[0,0,1,1] row_mask:0xf bank_mask:0xf
    v_add_u32_sdwa v214, v139, v158 dst_sel:DWORD dst_unused:UNUSED_PAD src0_sel:BYTE_2 src1_sel:DWORD
    v_lshrrev_b32 v189, 28, v138
    v_lshl_add_u32 v214, v189, 8, v214
    v_and_b32 v189, 60, v106
    v_and_b32 v138, 0xffff, v138
    v_lshl_or_b32 v138, v189, 19, v138
    v_mov_b32_dpp v215, v190 row_shr:4 row_mask:0xf bank_mask:0xa
L_PW3:
    s_waitcnt vmcnt(0)
    v_xor_b32 v188, v143, v186
    v_and_b32_sdwa v108, v140, s18 dst_sel:DWORD dst_unused:UNUSED_PAD src0_sel:WORD_1 src1_sel:DWORD
    v_and_b32_sdwa v109, v141, s18 dst_sel:DWORD dst_unused:UNUSED_PAD src0_sel:WORD_1 src1_sel:DWORD
    v_and_b32_sdwa v110, v142, s18 dst_sel:DWORD dst_unused:UNUSED_PAD src0_sel:WORD_1 src1_sel:DWORD
    v_cmp_lt_u32 vcc, s16, v188
    v_cmp_ne_u32 s[88:89], 0, v140
    v_cmp_ne_u32 s[90:91], 0, v141
    v_cmp_ne_u32 s[92:93], 0, v142
    s_cbranch_vccnz L_RT3
    s_mov_b64 exec, s[88:89]
    ds_add_rtn_u32 v124, v108, v184 offset:1024
    s_mov_b64 exec, s[90:91]
    ds_add_rtn_u32 v125, v109, v184 offset:1024
    s_mov_b64 exec, s[92:93]
    ds_add_rtn_u32 v126, v110, v184 offset:1024
    s_mov_b64 exec, -1
    v_or_b32 v176, v176, v141
    v_or3_b32 v190, v131, v135, v139
    v_or_b32 v190, v190, v143
    v_and_b32 v190, 0x1000000, v190
    v_cmp_ne_u32 vcc, 0, v190
    s_cbranch_vccz L_XT1R
    v_and_b32 v190, 0x1000000, v131
    v_cmp_ne_u32 s[70:71], 0, v190
    s_bcnt1_i32_b64 s10, s[70:71]
    s_lshl2_add_u32 s21, s10, s21
    v_and_b32 v190, 0x1000000, v135
    v_cmp_ne_u32 s[78:79], 0, v190
    s_bcnt1_i32_b64 s10, s[78:79]
    s_lshl2_add_u32 s21, s10, s21
    v_and_b32 v190, 0x1000000, v139
    v_cmp_ne_u32 s[86:87], 0, v190
    s_bcnt1_i32_b64 s10, s[86:87]
    s_lshl2_add_u32 s21, s10, s21
    v_and_b32 v190, 0x1000000, v143
    v_cmp_ne_u32 s[94:95], 0, v190
    s_bcnt1_i32_b64 s10, s[94:95]
    s_lshl2_add_u32 s21, s10, s21
    s_mov_b64 exec, s[70:71]
    s_cbranch_execz L_XLa0
    s_movk_i32 s10, 0
    buffer_load_dwordx4 v[64:67], v232, s[60:63], s10 offen sc1
L_XLa0:
    s_mov_b64 exec, s[78:79]
    s_cbranch_execz L_XLa1
    s_movk_i32 s10, 8192
    buffer_load_dwordx4 v[68:71], v232, s[60:63], s10 offen sc1
L_XLa1:
    s_mov_b64 exec, s[86:87]
    s_cbranch_execz L_XLa2
    s_movk_i32 s10, 16384
    buffer_load_dwordx4 v[72:75], v232, s[60:63], s10 offen sc1
L_XLa2:
    s_mov_b64 exec, s[94:95]
    s_cbranch_execz L_XLa3
    s_movk_i32 s10, 24576
    buffer_load_dwordx4 v[76:79], v232, s[60:63], s10 offen sc1
L_XLa3:
    s_mov_b64 exec, -1
    v_and_b32 v190, 0x10000, v176
    v_mov_b32 v191, 640
    v_cmpx_ne_u32 vcc, 0, v190
    ds_write_b32 v191, v184 offset:4
    s_mov_b64 exec, 1
    v_mov_b32 v190, s21
    ds_add_u32 v191, v190 offset:8
    s_mov_b64 exec, -1
L_XT1R:
    v_add_u32_sdwa v216, v143, v159 dst_sel:DWORD dst_unused:UNUSED_PAD src0_sel:BYTE_0 src1_sel:DWORD
    v_lshrrev_b32 v189, 28, v140
    v_lshl_add_u32 v216, v189, 8, v216
    v_and_b32 v189, 60, v108
    v_and_b32 v140, 0xffff, v140
    v_lshl_or_b32 v140, v189, 19, v140
    v_cndmask_b32 v188, v180, v216, s[88:89]
    v_max_u32 v216, v216, v155
    v_add_u32_sdwa v217, v143, v159 dst_sel:DWORD dst_unused:UNUSED_PAD src0_sel:BYTE_1 src1_sel:DWORD
    v_lshrrev_b32 v189, 28, v141
    v_lshl_add_u32 v217, v189, 8, v217
    v_and_b32 v189, 60, v109
    v_and_b32 v141, 0xffff, v141
    v_lshl_or_b32 v141, v189, 19, v141
    v_mov_b32_dpp v190, v188 quad_perm:[2,2,3,3] row_mask:0xf bank_mask:0xf
    v_mov_b32_dpp v219, v188 quad_perm:[0,0,1,1] row_mask:0xf bank_mask:0xf
    v_add_u32_sdwa v218, v143, v159 dst_sel:DWORD dst_unused:UNUSED_PAD src0_sel:BYTE_2 src1_sel:DWORD
    v_lshrrev_b32 v189, 28, v142
    v_lshl_add_u32 v218, v189, 8, v218
    v_mov_b32_dpp v219, v190 row_shr:4 row_mask:0xf bank_mask:0xa
    v_mov_b32 v197, 640
    s_cmp_eq_u32 s3, 6
    s_cselect_b32 exec_hi, 0, -1
    s_cmp_eq_u32 s3, 7
    s_cselect_b64 exec, 1, exec
    s_add_u32 m0, s101, 0
    s_nop 0
    buffer_load_dwordx4 v234, s[40:43], 0 offen offset:0 lds
    s_add_u32 m0, s101, 6560
    s_nop 0
    buffer_load_dwordx4 v234, s[40:43], 0 offen offset:128 lds
    s_add_u32 m0, s101, 13120
    s_nop 0
    buffer_load_dwordx4 v234, s[40:43], 0 offen offset:256 lds
    s_add_u32 m0, s101, 19680
    s_nop 0
    buffer_load_dwordx4 v234, s[40:43], 0 offen offset:384 lds
    s_mov_b64 exec, -1
    s_waitcnt lgkmcnt(0)
    s_barrier
    ds_read_u16 v198, v178 offset:1024
    ds_read_u16 v199, v178 offset:2048
    ds_read_b128 v[160:163], v185 offset:1024
    ds_read_b128 v[164:167], v185 offset:2048
    ds_read_b128 v[168:171], v185 offset:3072
    ds_read_b128 v[172:175], v185 offset:4096
    ds_read_b32 v236, v197 offset:8
    s_lshl_b32 m0, s3, 10
    v_mov_b32 v240, v207
    s_add_u32 m0, m0, 13312
    s_nop 0
    buffer_load_dwordx4 v[240:241], s[44:47], 0 idxen offen lds
    s_cmp_lg_u32 s2, 0
    s_cbranch_scc1 L_NOK
    v_mov_b32 v237, s6
    v_mov_b32 v238, 0
    buffer_store_dword v237, v238, s[52:55], 0 offen sc1
L_NOK:
    s_waitcnt lgkmcnt(5)
    v_lshl_or_b32 v198, v199, 16, v198
    v_mov_b32 v199, v198
    s_waitcnt lgkmcnt(0)
    v_add_u32_sdwa v188, v160, v164 dst_sel:DWORD dst_unused:UNUSED_PAD src0_sel:WORD_0 src1_sel:WORD_0
    v_add_u32_sdwa v192, v168, v172 dst_sel:DWORD dst_unused:UNUSED_PAD src0_sel:WORD_0 src1_sel:WORD_0
    v_add_u32_dpp v199, v199, v199 row_shr:1 row_mask:0xf bank_mask:0xf bound_ctrl:0
    v_add_u32_sdwa v189, v161, v165 dst_sel:DWORD dst_unused:UNUSED_PAD src0_sel:WORD_0 src1_sel:WORD_0
    v_add_u32_sdwa v193, v169, v173 dst_sel:DWORD dst_unused:UNUSED_PAD src0_sel:WORD_0 src1_sel:WORD_0
    v_add_u32_dpp v199, v199, v199 row_shr:2 row_mask:0xf bank_mask:0xf bound_ctrl:0
    v_add_u32_sdwa v190, v162, v166 dst_sel:DWORD dst_unused:UNUSED_PAD src0_sel:WORD_0 src1_sel:WORD_0
    v_add_u32_sdwa v194, v170, v174 dst_sel:DWORD dst_unused:UNUSED_PAD src0_sel:WORD_0 src1_sel:WORD_0
    v_add_u32_dpp v199, v199, v199 row_shr:4 row_mask:0xf bank_mask:0xf bound_ctrl:0
    v_add_u32_sdwa v191, v163, v167 dst_sel:DWORD dst_unused:UNUSED_PAD src0_sel:WORD_0 src1_sel:WORD_0
    v_add_u32_sdwa v195, v171, v175 dst_sel:DWORD dst_unused:UNUSED_PAD src0_sel:WORD_0 src1_sel:WORD_0
    v_add_u32_dpp v199, v199, v199 row_shr:8 row_mask:0xf bank_mask:0xf bound_ctrl:0
    v_add_u32 v188, v188, v192
    v_add_u32 v189, v189, v193
    v_add_u32_dpp v199, v199, v199 row_bcast:15 row_mask:0xa bank_mask:0xf
    v_add_u32 v190, v190, v194
    v_add_u32 v191, v191, v195
    v_mul_u32_u24 v196, v188, v228
    v_mad_u32_u24 v196, v189, v229, v196
    v_mad_u32_u24 v196, v190, v230, v196
    v_mad_u32_u24 v196, v191, v231, v196
    s_mov_b32 s96, -1
    s_mov_b32 s97, 0
    v_sub_u32 v200, v199, v198
    v_add_u32_sdwa v202, v199, v199 dst_sel:DWORD dst_unused:UNUSED_PAD src0_sel:WORD_0 src1_sel:WORD_1
    v_add_u32_dpp v196, v196, v196 row_shr:1 row_mask:0xf bank_mask:0xf bound_ctrl:0
    v_add_u32_sdwa v201, v200, v200 dst_sel:DWORD dst_unused:UNUSED_PAD src0_sel:WORD_0 src1_sel:WORD_1
    v_add_u32_sdwa v203, v198, v198 dst_sel:DWORD dst_unused:UNUSED_PAD src0_sel:WORD_0 src1_sel:WORD_1
    v_add_u32_dpp v196, v196, v196 row_shr:2 row_mask:0xf bank_mask:0xf bound_ctrl:0
    v_and_b32 v239, 60, v110
    v_readfirstlane_b32 s19, v236
    v_add_u32_dpp v196, v196, v196 row_shr:4 row_mask:0xf bank_mask:0xf bound_ctrl:0
    v_permlane32_swap_b32 v201, v202
    v_cndmask_b32 v203, 0, v203, s[96:97]
    v_add_u32_dpp v196, v196, v196 row_shr:8 row_mask:0xf bank_mask:0xf bound_ctrl:0
    v_add_u32 v201, v201, v202
    v_and_b32 v142, 0xffff, v142
    v_add_u32_dpp v196, v196, v196 row_bcast:15 row_mask:0xa bank_mask:0xf
    v_add_u32 v202, v201, v203
    v_lshl_or_b32 v142, v239, 19, v142
    v_add_u32_dpp v196, v196, v196 row_bcast:31 row_mask:0xc bank_mask:0xf
    v_sub_u32_sdwa v203, v202, v198 dst_sel:DWORD dst_unused:UNUSED_PAD src0_sel:DWORD src1_sel:WORD_1
    v_readlane_b32 s16, v196, 63
    s_lshl_b32 m0, s3, 10
    v_mov_b32 v240, v211
    s_add_u32 m0, m0, 21504
    s_nop 0
    buffer_load_dwordx4 v[240:241], s[44:47], 0 idxen offen lds
    s_bfe_u32 s10, s16, 0xe0002
    s_lshr_b32 s16, s16, 16
    s_lshr_b32 s11, s10, 1
    s_add_u32 s11, s11, 48
    s_and_b32 s11, s11, -128
    s_lshr_b32 s8, s4, 1
    s_mul_i32 s8, s8, s10
    s_sub_i32 s11, s11, 48
    s_sub_i32 s8, s8, s16
    s_add_i32 s11, s11, s8
    s_add_i32 s10, s10, s8
    s_bitcmp1_b32 s4, 0
    s_cselect_b32 s31, s11, s8
    s_cselect_b32 s10, s10, s11
    v_cmp_gt_i32 vcc, s31, v202
    v_cmp_gt_i32 s[34:35], s10, v202
    s_bcnt1_i32_b32 s22, vcc_lo
    s_bcnt1_i32_b32 s10, s34
    s_min_i32 s22, s22, s23
    s_max_i32 s10, s10, s24
    s_min_i32 s23, s10, s25
    v_readlane_b32 s16, v201, s22
    v_readlane_b32 s30, v201, s23
    s_add_u32 s8, s22, s7
    s_add_u32 s9, s23, s7
    s_add_u32 s10, s22, 32
    s_add_u32 s11, s23, 32
    v_readlane_b32 s26, v200, s22
    v_readlane_b32 s28, v200, s23
    v_readlane_b32 s27, v200, s10
    v_readlane_b32 s29, v200, s11
    s_sub_u32 s31, s30, s16
    s_add_u32 s10, s31, 255
    s_sub_i32 s11, s23, 16
    s_max_i32 s11, s11, s22
    v_readlane_b32 s11, v201, s11
    s_add_u32 vcc_lo, s31, 127
    s_and_b32 vcc_hi, vcc_lo, 127
    s_add_u32 vcc_hi, vcc_hi, s19
    s_cmp_lt_u32 vcc_hi, 55
    s_cselect_b32 vcc_lo, vcc_lo, s10
    s_sub_u32 s11, s11, s16
    s_add_u32 s11, s11, s19
    s_lshl_b32 s11, s11, 1
    s_and_b32 vcc_lo, vcc_lo, -256
    s_cmp_le_u32 s11, vcc_lo
    s_cselect_b32 s10, vcc_lo, s10
    s_lshr_b32 s10, s10, 8
    s_lshl_b32 s10, s10, 7
    s_sub_u32 s10, s10, s19
    s_max_i32 s10, s10, 0
    s_add_u32 s16, s16, s10
    s_add_u32 s10, s22, 16
    s_min_u32 s10, s10, s23
    s_sub_i32 s11, s23, 16
    v_cmp_ge_u32 s[34:35], s16, v203
    v_cmp_ge_u32 s[36:37], s16, v202
    v_cmp_gt_i32 vcc, s10, v177
    v_cmp_gt_i32 s[10:11], s11, v177
    v_cmp_le_u32 s[32:33], s22, v177
    v_cmp_gt_u32 s[96:97], s23, v177
    s_and_b64 s[34:35], s[34:35], vcc
    s_and_b64 s[36:37], s[36:37], vcc
    s_or_b64 s[34:35], s[34:35], s[10:11]
    s_or_b64 s[36:37], s[36:37], s[10:11]
    s_bcnt1_i32_b32 s24, s34
    s_bcnt1_i32_b32 s10, s36
    s_bcnt1_i32_b32 s11, s35
    s_bcnt1_i32_b32 s25, s37
    v_readlane_b32 s22, v200, s24
    v_readlane_b32 s10, v200, s10
    s_add_u32 s11, s11, 32
    s_add_u32 s16, s25, 32
    v_readlane_b32 s23, v200, s11
    v_readlane_b32 s11, v200, s16
    v_mov_b32 v188, s17
    v_cndmask_b32 v189, 0, v188, s[34:35]
    v_cndmask_b32 v188, 0, v188, s[36:37]
    s_and_b64 s[32:33], s[32:33], s[96:97]
    s_pack_lh_b32_b16 s22, s22, s10
    s_pack_lh_b32_b16 s23, s23, s11
    v_lshl_or_b32 v188, v188, 16, v189
    s_sub_u32 s16, s12, 37888
    s_pack_ll_b32_b16 s16, s16, s16
    s_sub_u32 s10, s22, s26
    s_sub_u32 s11, s23, s27
    s_mul_i32 s10, s10, 0x10001
    s_lshl_b32 vcc_lo, s10, 16
    s_pack_hh_b32_b16 s10, s10, s10
    s_lshl_b32 vcc_hi, s11, 16
    s_add_u32 vcc_hi, vcc_hi, s10
    s_add_u32 s96, vcc_hi, s11
    s_lshr_b32 s96, s96, 16
    s_sub_u32 s31, s31, s96
    s_cmp_gt_u32 s31, s96
    s_cselect_b32 s97, 0x4800480, 0
    s_add_u32 s16, s16, s97
    s_sub_u32 s10, s16, s26
    s_sub_u32 s11, s16, s27
    s_add_u32 s10, s10, vcc_lo
    s_add_u32 s11, s11, vcc_hi
    v_mov_b32 v192, s10
    v_mov_b32 v193, s11
    s_add_u32 s16, s16, 0x4800480
    s_sub_u32 s16, s16, s97
    s_sub_u32 s16, s16, s97
    s_sub_u32 s10, s28, s22
    s_sub_u32 s11, s29, s23
    s_mul_i32 s10, s10, 0x10001
    s_lshl_b32 vcc_lo, s10, 16
    s_pack_hh_b32_b16 s10, s10, s10
    s_lshl_b32 vcc_hi, s11, 16
    s_add_u32 vcc_hi, vcc_hi, s10
    s_sub_u32 s10, s16, s22
    s_sub_u32 s11, s16, s23
    s_add_u32 s10, s10, vcc_lo
    s_add_u32 s11, s11, vcc_hi
    v_mov_b32 v194, s10
    v_mov_b32 v195, s11
    v_bfi_b32 v192, v188, v192, v194
    v_bfi_b32 v193, v188, v193, v195
    s_mov_b32 exec_hi, 0
    v_mov_b32 v193, v192
    s_mov_b64 exec, s[32:33]
    v_add_u32 v200, v200, v193
    s_bfe_u32 s10, s97, 0x10007
    s_lshl1_add_u32 s10, s4, s10
    s_lshl_b32 s10, s10, 2
    v_cndmask_b32 v188, 4, 0, s[34:35]
    ds_write_b16 v178, v200 offset:1026
    ds_write_b16_d16_hi v178, v200 offset:2050
    s_mov_b32 exec_hi, 0
    v_xor_b32 v188, s10, v188
    ds_write_b32 v179, v188
    s_mov_b64 exec, -1
    s_min_u32 s10, s31, s96
    s_max_u32 s96, s31, s96
    s_mov_b32 s31, s10
    s_add_u32 s10, s96, s19
    s_mul_i32 s11, s30, 9216
    s_lshr_b32 s11, s11, 16
    s_max_u32 s10, s10, s11
    s_cmp_lt_u32 s10, 1152
    s_cbranch_scc1 L_LFIT
    ds_write_b32 v197, v184
L_LFIT:
    s_cmp_eq_u32 s19, 0
    s_cbranch_scc1 L_XCNR
    s_sub_u32 s10, s12, 37888
    s_add_u32 s11, s10, s96
    v_mov_b32 v188, s11
    s_add_u32 s11, s10, s31
    s_add_u32 s11, s11, 1152
    v_mov_b32 v189, s11
    s_lshl_b32 s10, s4, 3
    v_mov_b32 v190, s10
    ds_write_b64 v190, v[188:189] offset:576
L_XCNR:
    s_lshl_b32 m0, s3, 10
    v_mov_b32 v240, v215
    s_add_u32 m0, m0, 29696
    s_nop 0
    buffer_load_dwordx4 v[240:241], s[44:47], 0 idxen offen lds
    s_waitcnt vmcnt(3)
    s_waitcnt lgkmcnt(0)
    s_barrier
    ds_read_b64 v[202:203], v197
    ds_read_u16 v96, v96 offset:1026
    ds_read_u16 v97, v97 offset:1026
    ds_read_u16 v98, v98 offset:1026
    ds_read_u16 v100, v100 offset:1026
    ds_read_u16 v101, v101 offset:1026
    ds_read_u16 v102, v102 offset:1026
    ds_read_u16 v104, v104 offset:1026
    ds_read_u16 v105, v105 offset:1026
    ds_read_u16 v106, v106 offset:1026
    ds_read_u16 v108, v108 offset:1026
    ds_read_u16 v109, v109 offset:1026
    ds_read_u16 v110, v110 offset:1026
    s_lshl_b32 m0, s3, 10
    v_mov_b32 v240, v219
    s_add_u32 m0, m0, 37888
    s_nop 0
    buffer_load_dwordx4 v[240:241], s[44:47], 0 idxen offen lds
    s_add_u32 s24, s24, s7
    s_add_u32 s11, s25, s7
    s_and_b32 s10, s11, 15
    s_cmp_lt_u32 s11, s24
    s_cselect_b32 s25, s10, 16
    s_cmp_lg_u32 s97, 0
    s_cselect_b32 s23, s8, s11
    s_cselect_b32 s7, s8, s24
    s_cselect_b32 s8, s11, s8
    s_cselect_b32 s24, s9, s24
    s_cselect_b32 s9, s11, s9
    s_min_u32 s22, s8, 192
    s_min_u32 s23, s23, 192
    s_mov_b32 s30, s19
    s_waitcnt lgkmcnt(12)
    v_cmp_ne_u32 vcc, 0, v202
    v_readfirstlane_b32 s19, v203
    s_cbranch_vccnz L_OVF
    s_waitcnt lgkmcnt(9)
    s_mov_b64 exec, s[64:65]
    v_add_u32 v96, v96, v112
    ds_write2st64_b32 v96, v128, v204 offset0:148 offset1:220
    s_mov_b64 exec, s[66:67]
    v_add_u32 v97, v97, v113
    ds_write2st64_b32 v97, v129, v205 offset0:148 offset1:220
    s_mov_b64 exec, s[68:69]
    v_add_u32 v98, v98, v114
    ds_write2st64_b32 v98, v130, v206 offset0:148 offset1:220
    s_waitcnt lgkmcnt(9)
    s_mov_b64 exec, s[72:73]
    v_add_u32 v100, v100, v116
    ds_write2st64_b32 v100, v132, v208 offset0:148 offset1:220
    s_mov_b64 exec, s[74:75]
    v_add_u32 v101, v101, v117
    ds_write2st64_b32 v101, v133, v209 offset0:148 offset1:220
    s_mov_b64 exec, s[76:77]
    v_add_u32 v102, v102, v118
    ds_write2st64_b32 v102, v134, v210 offset0:148 offset1:220
    s_waitcnt lgkmcnt(9)
    s_mov_b64 exec, s[80:81]
    v_add_u32 v104, v104, v120
    ds_write2st64_b32 v104, v136, v212 offset0:148 offset1:220
    s_mov_b64 exec, s[82:83]
    v_add_u32 v105, v105, v121
    ds_write2st64_b32 v105, v137, v213 offset0:148 offset1:220
    s_mov_b64 exec, s[84:85]
    v_add_u32 v106, v106, v122
    ds_write2st64_b32 v106, v138, v214 offset0:148 offset1:220
    s_waitcnt lgkmcnt(9)
    s_mov_b64 exec, s[88:89]
    v_add_u32 v108, v108, v124
    ds_write2st64_b32 v108, v140, v216 offset0:148 offset1:220
    s_mov_b64 exec, s[90:91]
    v_add_u32 v109, v109, v125
    ds_write2st64_b32 v109, v141, v217 offset0:148 offset1:220
    s_mov_b64 exec, s[92:93]
    v_add_u32 v110, v110, v126
    ds_write2st64_b32 v110, v142, v218 offset0:148 offset1:220
    s_mov_b64 exec, -1
    s_add_u32 s10, s96, 127
    s_lshr_b32 s10, s10, 7
    s_lshl1_add_u32 s10, s10, -1
    s_add_u32 s11, s31, 127
    s_lshr_b32 s11, s11, 6
    s_and_b32 s11, s11, -2
    s_max_i32 s17, s10, s11
    s_cselect_b32 s10, s96, s31
    s_sub_u32 s10, s10, 1
    s_andn2_b32 s99, 64, s10
L_CA:
    ds_read_b64_tr_b16 v[96:97], v225 offset:0
    ds_read_b64_tr_b16 v[98:99], v225 offset:1280
    ds_read_b64_tr_b16 v[100:101], v225 offset:5120
    ds_read_b64_tr_b16 v[102:103], v225 offset:6400
    ds_read_b64_tr_b16 v[104:105], v225 offset:32
    ds_read_b64_tr_b16 v[106:107], v225 offset:1312
    ds_read_b64_tr_b16 v[108:109], v225 offset:5152
    ds_read_b64_tr_b16 v[110:111], v225 offset:6432
    ds_read_b64_tr_b16 v[112:113], v225 offset:64
    ds_read_b64_tr_b16 v[114:115], v225 offset:1344
    ds_read_b64_tr_b16 v[116:117], v225 offset:5184
    ds_read_b64_tr_b16 v[118:119], v225 offset:6464
    ds_read_b64_tr_b16 v[120:121], v225 offset:96
    ds_read_b64_tr_b16 v[122:123], v225 offset:1376
    ds_read_b64_tr_b16 v[124:125], v225 offset:5216
    ds_read_b64_tr_b16 v[126:127], v225 offset:6496
    s_cmp_eq_u32 s21, 0
    s_cbranch_scc1 L_XT2R
    s_waitcnt vmcnt(8)
L_XT2:
    s_mov_b64 s[34:35], 0
    v_cmp_ne_u32 vcc, s6, v65
    s_and_b64 vcc, vcc, s[70:71]
    s_or_b64 s[34:35], s[34:35], vcc
    v_cmp_ne_u32 vcc, s6, v69
    s_and_b64 vcc, vcc, s[78:79]
    s_or_b64 s[34:35], s[34:35], vcc
    v_cmp_ne_u32 vcc, s6, v73
    s_and_b64 vcc, vcc, s[86:87]
    s_or_b64 s[34:35], s[34:35], vcc
    v_cmp_ne_u32 vcc, s6, v77
    s_and_b64 vcc, vcc, s[94:95]
    s_or_b64 s[34:35], s[34:35], vcc
    s_cbranch_scc1 L_XT2B
    s_cmp_eq_u32 s20, 0
    s_cbranch_scc1 L_XT2R
    s_mov_b64 exec, s[70:71]
    s_cbranch_execz L_XS0
    v_bfe_u32 v65, v64, 18, 8
    v_lshlrev_b32 v65, 2, v65
    v_add_u32 v67, 153728, v65
    ds_read_b32 v67, v67
    v_add_u32_sdwa v66, v66, v156 dst_sel:DWORD dst_unused:UNUSED_PAD src0_sel:BYTE_0 src1_sel:DWORD
    v_lshrrev_b32 v189, 28, v64
    v_lshl_add_u32 v66, v189, 8, v66
    v_and_b32 v189, 60, v65
    v_and_b32 v64, 0xffff, v64
    v_lshl_or_b32 v64, v189, 19, v64
    s_waitcnt lgkmcnt(0)
    ds_add_rtn_u32 v67, v67, v184 offset:576
    s_waitcnt lgkmcnt(0)
    ds_write2st64_b32 v67, v64, v66 offset0:148 offset1:220
L_XS0:
    s_mov_b64 exec, s[78:79]
    s_cbranch_execz L_XS1
    v_bfe_u32 v69, v68, 18, 8
    v_lshlrev_b32 v69, 2, v69
    v_add_u32 v71, 153728, v69
    ds_read_b32 v71, v71
    v_add_u32_sdwa v70, v70, v157 dst_sel:DWORD dst_unused:UNUSED_PAD src0_sel:BYTE_0 src1_sel:DWORD
    v_lshrrev_b32 v189, 28, v68
    v_lshl_add_u32 v70, v189, 8, v70
    v_and_b32 v189, 60, v69
    v_and_b32 v68, 0xffff, v68
    v_lshl_or_b32 v68, v189, 19, v68
    s_waitcnt lgkmcnt(0)
    ds_add_rtn_u32 v71, v71, v184 offset:576
    s_waitcnt lgkmcnt(0)
    ds_write2st64_b32 v71, v68, v70 offset0:148 offset1:220
L_XS1:
    s_mov_b64 exec, s[86:87]
    s_cbranch_execz L_XS2
    v_bfe_u32 v73, v72, 18, 8
    v_lshlrev_b32 v73, 2, v73
    v_add_u32 v75, 153728, v73
    ds_read_b32 v75, v75
    v_add_u32_sdwa v74, v74, v158 dst_sel:DWORD dst_unused:UNUSED_PAD src0_sel:BYTE_0 src1_sel:DWORD
    v_lshrrev_b32 v189, 28, v72
    v_lshl_add_u32 v74, v189, 8, v74
    v_and_b32 v189, 60, v73
    v_and_b32 v72, 0xffff, v72
    v_lshl_or_b32 v72, v189, 19, v72
    s_waitcnt lgkmcnt(0)
    ds_add_rtn_u32 v75, v75, v184 offset:576
    s_waitcnt lgkmcnt(0)
    ds_write2st64_b32 v75, v72, v74 offset0:148 offset1:220
L_XS2:
    s_mov_b64 exec, s[94:95]
    s_cbranch_execz L_XS3
    v_bfe_u32 v77, v76, 18, 8
    v_lshlrev_b32 v77, 2, v77
    v_add_u32 v79, 153728, v77
    ds_read_b32 v79, v79
    v_add_u32_sdwa v78, v78, v159 dst_sel:DWORD dst_unused:UNUSED_PAD src0_sel:BYTE_0 src1_sel:DWORD
    v_lshrrev_b32 v189, 28, v76
    v_lshl_add_u32 v78, v189, 8, v78
    v_and_b32 v189, 60, v77
    v_and_b32 v76, 0xffff, v76
    v_lshl_or_b32 v76, v189, 19, v76
    s_waitcnt lgkmcnt(0)
    ds_add_rtn_u32 v79, v79, v184 offset:576
    s_waitcnt lgkmcnt(0)
    ds_write2st64_b32 v79, v76, v78 offset0:148 offset1:220
L_XS3:
    s_mov_b64 exec, -1
L_XT2R:
    s_lshl_b32 s34, s22, 5
    s_lshl_b32 s35, s23, 5
    s_mov_b32 vcc_lo, 0xff00ff00
    s_mov_b32 vcc_hi, 0xff00ff00
    v_mov_b32 v176, s35
    v_mov_b32 v177, s34
    v_cndmask_b32 v176, v176, v177, vcc
    v_and_b32 v177, 4, v247
    v_lshlrev_b32 v177, 6, v177
    v_lshl_add_u32 v177, v246, 2, v177
    v_sub_u32 v177, v177, v176
    v_and_b32 v178, 48, v247
    s_movk_i32 s34, 832
    v_mad_u32_u24 v178, v246, s34, v178
    s_mov_b32 s34, 116736
    v_add3_u32 v178, v178, v176, s34
    v_and_b32 v176, 0x1ff, v177
    v_add_u32 v176, v176, v178
    v_add_u32 v177, 0x80, v177
    v_and_b32 v177, 0x1ff, v177
    v_add_u32 v177, v177, v178
    v_mov_b64 v[184:185], 0
    v_mov_b64 v[186:187], 0
    v_lshrrev_b32 v188, 2, v247
    v_and_b32 v188, 12, v188
    v_subrev_u32 v188, s25, v188
    v_mov_b32 v189, 0x358637bd
    v_mfma_f32_32x32x16_bf16 v[144:159], v[184:187], v[184:187], 0
    v_cmp_ne_u32 s[80:81], 0, v188
    v_cmp_ne_u32 s[82:83], -1, v188
    v_cmp_ne_u32 s[84:85], -2, v188
    v_cmp_ne_u32 s[86:87], -3, v188
    v_cndmask_b32 v128, 0, v189, s[80:81]
    v_cndmask_b32 v129, 0, v189, s[82:83]
    v_cndmask_b32 v130, 0, v189, s[84:85]
    v_cndmask_b32 v131, 0, v189, s[86:87]
    v_mov_b64 v[132:133], v[128:129]
    v_mov_b64 v[134:135], v[130:131]
    v_mov_b64 v[136:137], v[128:129]
    v_mov_b64 v[138:139], v[130:131]
    v_mov_b64 v[140:141], v[128:129]
    v_mov_b64 v[142:143], v[130:131]
    s_cmp_ge_u32 s3, 4
    s_cbranch_scc1 L_EP0
    ds_read_b128 v[160:163], v176 offset:0
    ds_read_b128 v[164:167], v176 offset:64
    ds_read_b128 v[168:171], v177 offset:0
    ds_read_b128 v[172:175], v177 offset:64
    s_mov_b32 s34, 0xbfb8aa3b
    s_mov_b32 s35, s34
    s_waitcnt lgkmcnt(3)
    v_mfma_f32_16x16x32_bf16 v[204:207], v[160:163], v[96:99], 0
    v_mfma_f32_16x16x32_bf16 v[212:215], v[160:163], v[104:107], 0
    v_mfma_f32_16x16x32_bf16 v[220:223], v[160:163], v[112:115], 0
    v_mfma_f32_16x16x32_bf16 v[228:231], v[160:163], v[120:123], 0
    s_waitcnt lgkmcnt(2)
    v_mfma_f32_16x16x32_bf16 v[204:207], v[164:167], v[100:103], v[204:207]
    v_mfma_f32_16x16x32_bf16 v[212:215], v[164:167], v[108:111], v[212:215]
    v_mfma_f32_16x16x32_bf16 v[220:223], v[164:167], v[116:119], v[220:223]
    v_mfma_f32_16x16x32_bf16 v[228:231], v[164:167], v[124:127], v[228:231]
    s_waitcnt lgkmcnt(1)
    v_mfma_f32_16x16x32_bf16 v[208:211], v[168:171], v[96:99], 0
    v_mfma_f32_16x16x32_bf16 v[216:219], v[168:171], v[104:107], 0
    v_mfma_f32_16x16x32_bf16 v[224:227], v[168:171], v[112:115], 0
    v_mfma_f32_16x16x32_bf16 v[232:235], v[168:171], v[120:123], 0
    s_waitcnt lgkmcnt(0)
    v_mfma_f32_16x16x32_bf16 v[208:211], v[172:175], v[100:103], v[208:211]
    v_mfma_f32_16x16x32_bf16 v[216:219], v[172:175], v[108:111], v[216:219]
    v_mfma_f32_16x16x32_bf16 v[224:227], v[172:175], v[116:119], v[224:227]
    v_mfma_f32_16x16x32_bf16 v[232:235], v[172:175], v[124:127], v[232:235]
    s_mov_b32 s10, 0x358637bd
    s_mov_b32 s11, s10
    v_mov_b64 v[96:97], s[10:11]
    v_mov_b64 v[98:99], s[10:11]
    v_mov_b64 v[100:101], s[10:11]
    v_mov_b64 v[102:103], s[10:11]
    v_mov_b64 v[104:105], s[10:11]
    v_mov_b64 v[106:107], s[10:11]
    v_mov_b64 v[108:109], s[10:11]
    v_mov_b64 v[110:111], s[10:11]
    v_pk_mul_f32 v[204:205], v[204:205], s[34:35]
    v_pk_mul_f32 v[206:207], v[206:207], s[34:35]
    v_pk_mul_f32 v[208:209], v[208:209], s[34:35]
    v_pk_mul_f32 v[210:211], v[210:211], s[34:35]
    v_pk_mul_f32 v[212:213], v[212:213], s[34:35]
    v_pk_mul_f32 v[214:215], v[214:215], s[34:35]
    v_pk_mul_f32 v[216:217], v[216:217], s[34:35]
    v_pk_mul_f32 v[218:219], v[218:219], s[34:35]
    v_pk_mul_f32 v[220:221], v[220:221], s[34:35]
    v_pk_mul_f32 v[222:223], v[222:223], s[34:35]
    v_pk_mul_f32 v[224:225], v[224:225], s[34:35]
    v_pk_mul_f32 v[226:227], v[226:227], s[34:35]
    v_pk_mul_f32 v[228:229], v[228:229], s[34:35]
    v_pk_mul_f32 v[230:231], v[230:231], s[34:35]
    v_pk_mul_f32 v[232:233], v[232:233], s[34:35]
    v_pk_mul_f32 v[234:235], v[234:235], s[34:35]
    v_mfma_f32_32x32x16_bf16 v[112:127], v[184:187], v[184:187], 0
    v_cvt_pk_bf16_f32 v64, v204, v205
    v_cvt_pk_bf16_f32 v65, v206, v207
    v_cvt_pk_bf16_f32 v66, v208, v209
    v_cvt_pk_bf16_f32 v67, v210, v211
    v_cvt_pk_bf16_f32 v68, v212, v213
    v_cvt_pk_bf16_f32 v69, v214, v215
    v_cvt_pk_bf16_f32 v70, v216, v217
    v_cvt_pk_bf16_f32 v71, v218, v219
    v_cvt_pk_bf16_f32 v72, v220, v221
    v_cvt_pk_bf16_f32 v73, v222, v223
    v_cvt_pk_bf16_f32 v74, v224, v225
    v_cvt_pk_bf16_f32 v75, v226, v227
    v_cvt_pk_bf16_f32 v76, v228, v229
    v_cvt_pk_bf16_f32 v77, v230, v231
    v_cvt_pk_bf16_f32 v78, v232, v233
    v_cvt_pk_bf16_f32 v79, v234, v235
    v_permlane32_swap_b32 v80, v64
    v_permlane32_swap_b32 v81, v65
    v_permlane32_swap_b32 v82, v66
    v_permlane32_swap_b32 v83, v67
    v_permlane32_swap_b32 v84, v68
    v_permlane32_swap_b32 v85, v69
    v_permlane32_swap_b32 v86, v70
    v_permlane32_swap_b32 v87, v71
    v_permlane32_swap_b32 v88, v72
    v_permlane32_swap_b32 v89, v73
    v_permlane32_swap_b32 v90, v74
    v_permlane32_swap_b32 v91, v75
    v_permlane32_swap_b32 v92, v76
    v_permlane32_swap_b32 v93, v77
    v_permlane32_swap_b32 v94, v78
    v_permlane32_swap_b32 v95, v79
L_EP0:
    s_waitcnt vmcnt(0) lgkmcnt(0)
    s_barrier
    ds_read_b128 v[236:239], v248
    ds_read_b32 v240, v249
    s_cmp_ge_u32 s3, 4
    s_cbranch_scc1 L_LATE0
    s_waitcnt lgkmcnt(0)
    s_add_u32 m0, s13, 0
    v_mad_u32_u16 v236, v236, s15, v243
    buffer_load_dwordx4 v236, s[40:43], 0 offen lds
    s_add_u32 m0, s13, 1056
    v_mad_u32_u16 v237, v237, s15, v243
    buffer_load_dwordx4 v237, s[40:43], 0 offen lds
    s_add_u32 m0, s13, 2112
    v_mad_u32_u16 v238, v238, s15, v243
    buffer_load_dwordx4 v238, s[40:43], 0 offen lds
    s_add_u32 m0, s13, 3168
    v_mad_u32_u16 v239, v239, s15, v243
    buffer_load_dwordx4 v239, s[40:43], 0 offen lds
    s_mov_b32 m0, s14
    s_nop 0
    buffer_load_dwordx4 v[240:241], s[44:47], 0 idxen offen lds
    s_lshl_b32 s72, s4, 7
    s_add_u32 s72, s72, 157824
    v_mov_b32 v190, s22
    s_mov_b32 exec_lo, 0xffff0000
    v_mov_b32 v190, s23
    s_mov_b32 exec_lo, -1
    s_mov_b32 exec_hi, 0
    v_sub_u32 v191, v247, v190
    v_and_b32 v191, 15, v191
    v_add_lshl_u32 v191, v191, v190, 5
    v_lshl_add_u32 v190, v247, 2, s72
    ds_write_b32 v190, v191
    s_mov_b32 exec_hi, -1
    s_mul_i32 s10, s5, 196
    s_add_u32 s11, s10, s7
    s_add_u32 s62, s10, s9
    s_min_u32 s11, s11, 50000
    s_min_u32 s62, s62, 50000
    s_sub_u32 s62, s62, s11
    s_lshl_b32 s11, s11, 7
    s_lshl_b32 s62, s62, 7
    s_add_u32 s60, s48, s11
    s_addc_u32 s61, s49, 0
    s_mul_i32 s74, s7, -128
    s_add_u32 s11, s10, s8
    s_add_u32 s50, s10, s24
    s_min_u32 s11, s11, 50000
    s_min_u32 s50, s50, 50000
    s_sub_u32 s50, s50, s11
    s_lshl_b32 s11, s11, 7
    s_lshl_b32 s50, s50, 7
    s_add_u32 s48, s48, s11
    s_addc_u32 s49, s49, 0
    s_mul_i32 s73, s8, -128
    s_and_b32 s10, s25, 12
    s_lshl_b32 s10, s10, 2
    s_bfm_b64 s[76:77], 16, s10
    s_branch L_SET
L_LATE0:
    ds_read_b128 v[160:163], v176 offset:0
    ds_read_b128 v[164:167], v176 offset:64
    ds_read_b128 v[168:171], v177 offset:0
    ds_read_b128 v[172:175], v177 offset:64
    s_mov_b32 s34, 0xbfb8aa3b
    s_mov_b32 s35, s34
    s_waitcnt lgkmcnt(3)
    v_mfma_f32_16x16x32_bf16 v[204:207], v[160:163], v[96:99], 0
    v_mfma_f32_16x16x32_bf16 v[212:215], v[160:163], v[104:107], 0
    v_mfma_f32_16x16x32_bf16 v[220:223], v[160:163], v[112:115], 0
    v_mfma_f32_16x16x32_bf16 v[228:231], v[160:163], v[120:123], 0
    s_waitcnt lgkmcnt(2)
    v_mfma_f32_16x16x32_bf16 v[204:207], v[164:167], v[100:103], v[204:207]
    v_mfma_f32_16x16x32_bf16 v[212:215], v[164:167], v[108:111], v[212:215]
    v_mfma_f32_16x16x32_bf16 v[220:223], v[164:167], v[116:119], v[220:223]
    v_mfma_f32_16x16x32_bf16 v[228:231], v[164:167], v[124:127], v[228:231]
    s_waitcnt lgkmcnt(1)
    v_mfma_f32_16x16x32_bf16 v[208:211], v[168:171], v[96:99], 0
    v_mfma_f32_16x16x32_bf16 v[216:219], v[168:171], v[104:107], 0
    v_mfma_f32_16x16x32_bf16 v[224:227], v[168:171], v[112:115], 0
    v_mfma_f32_16x16x32_bf16 v[232:235], v[168:171], v[120:123], 0
    s_waitcnt lgkmcnt(0)
    v_mfma_f32_16x16x32_bf16 v[208:211], v[172:175], v[100:103], v[208:211]
    v_mfma_f32_16x16x32_bf16 v[216:219], v[172:175], v[108:111], v[216:219]
    v_mfma_f32_16x16x32_bf16 v[224:227], v[172:175], v[116:119], v[224:227]
    v_mfma_f32_16x16x32_bf16 v[232:235], v[172:175], v[124:127], v[232:235]
    s_mov_b32 s10, 0x358637bd
    s_mov_b32 s11, s10
    v_mov_b64 v[96:97], s[10:11]
    v_mov_b64 v[98:99], s[10:11]
    v_mov_b64 v[100:101], s[10:11]
    v_mov_b64 v[102:103], s[10:11]
    v_mov_b64 v[104:105], s[10:11]
    v_mov_b64 v[106:107], s[10:11]
    v_mov_b64 v[108:109], s[10:11]
    v_mov_b64 v[110:111], s[10:11]
    v_pk_mul_f32 v[204:205], v[204:205], s[34:35]
    v_pk_mul_f32 v[206:207], v[206:207], s[34:35]
    v_pk_mul_f32 v[208:209], v[208:209], s[34:35]
    v_pk_mul_f32 v[210:211], v[210:211], s[34:35]
    v_pk_mul_f32 v[212:213], v[212:213], s[34:35]
    v_pk_mul_f32 v[214:215], v[214:215], s[34:35]
    v_pk_mul_f32 v[216:217], v[216:217], s[34:35]
    v_pk_mul_f32 v[218:219], v[218:219], s[34:35]
    v_pk_mul_f32 v[220:221], v[220:221], s[34:35]
    v_pk_mul_f32 v[222:223], v[222:223], s[34:35]
    v_pk_mul_f32 v[224:225], v[224:225], s[34:35]
    v_pk_mul_f32 v[226:227], v[226:227], s[34:35]
    v_pk_mul_f32 v[228:229], v[228:229], s[34:35]
    v_pk_mul_f32 v[230:231], v[230:231], s[34:35]
    v_pk_mul_f32 v[232:233], v[232:233], s[34:35]
    v_pk_mul_f32 v[234:235], v[234:235], s[34:35]
    v_mfma_f32_32x32x16_bf16 v[112:127], v[184:187], v[184:187], 0
    v_cvt_pk_bf16_f32 v64, v204, v205
    v_cvt_pk_bf16_f32 v65, v206, v207
    v_cvt_pk_bf16_f32 v66, v208, v209
    v_cvt_pk_bf16_f32 v67, v210, v211
    v_cvt_pk_bf16_f32 v68, v212, v213
    v_cvt_pk_bf16_f32 v69, v214, v215
    v_cvt_pk_bf16_f32 v70, v216, v217
    v_cvt_pk_bf16_f32 v71, v218, v219
    v_cvt_pk_bf16_f32 v72, v220, v221
    v_cvt_pk_bf16_f32 v73, v222, v223
    v_cvt_pk_bf16_f32 v74, v224, v225
    v_cvt_pk_bf16_f32 v75, v226, v227
    v_cvt_pk_bf16_f32 v76, v228, v229
    v_cvt_pk_bf16_f32 v77, v230, v231
    v_cvt_pk_bf16_f32 v78, v232, v233
    v_cvt_pk_bf16_f32 v79, v234, v235
    v_permlane32_swap_b32 v80, v64
    v_permlane32_swap_b32 v81, v65
    v_permlane32_swap_b32 v82, v66
    v_permlane32_swap_b32 v83, v67
    v_permlane32_swap_b32 v84, v68
    v_permlane32_swap_b32 v85, v69
    v_permlane32_swap_b32 v86, v70
    v_permlane32_swap_b32 v87, v71
    v_permlane32_swap_b32 v88, v72
    v_permlane32_swap_b32 v89, v73
    v_permlane32_swap_b32 v90, v74
    v_permlane32_swap_b32 v91, v75
    v_permlane32_swap_b32 v92, v76
    v_permlane32_swap_b32 v93, v77
    v_permlane32_swap_b32 v94, v78
    v_permlane32_swap_b32 v95, v79
L_SET:
    s_mov_b32 s26, -1
    s_mov_b64 s[32:33], 0
    s_mov_b32 s28, 0
    s_mov_b32 s29, 0
    s_cmp_lt_u32 s3, 4
    s_cbranch_scc1 L_HAD0
    s_lshl_b32 s72, s4, 7
    s_add_u32 s72, s72, 157824
    v_mov_b32 v190, s22
    s_mov_b32 exec_lo, 0xffff0000
    v_mov_b32 v190, s23
    s_mov_b32 exec_lo, -1
    s_mov_b32 exec_hi, 0
    v_sub_u32 v191, v247, v190
    v_and_b32 v191, 15, v191
    v_add_lshl_u32 v191, v191, v190, 5
    v_lshl_add_u32 v190, v247, 2, s72
    ds_write_b32 v190, v191
    s_mov_b32 exec_hi, -1
    s_mul_i32 s10, s5, 196
    s_add_u32 s11, s10, s7
    s_add_u32 s62, s10, s9
    s_min_u32 s11, s11, 50000
    s_min_u32 s62, s62, 50000
    s_sub_u32 s62, s62, s11
    s_lshl_b32 s11, s11, 7
    s_lshl_b32 s62, s62, 7
    s_add_u32 s60, s48, s11
    s_addc_u32 s61, s49, 0
    s_mul_i32 s74, s7, -128
    s_add_u32 s11, s10, s8
    s_add_u32 s50, s10, s24
    s_min_u32 s11, s11, 50000
    s_min_u32 s50, s50, 50000
    s_sub_u32 s50, s50, s11
    s_lshl_b32 s11, s11, 7
    s_lshl_b32 s50, s50, 7
    s_add_u32 s48, s48, s11
    s_addc_u32 s49, s49, 0
    s_mul_i32 s73, s8, -128
    s_and_b32 s10, s25, 12
    s_lshl_b32 s10, s10, 2
    s_bfm_b64 s[76:77], 16, s10
    s_add_u32 m0, s13, 0
    v_mad_u32_u16 v236, v236, s15, v243
    buffer_load_dwordx4 v236, s[40:43], 0 offen lds
    s_add_u32 m0, s13, 1056
    v_mad_u32_u16 v237, v237, s15, v243
    buffer_load_dwordx4 v237, s[40:43], 0 offen lds
    s_add_u32 m0, s13, 2112
    v_mad_u32_u16 v238, v238, s15, v243
    buffer_load_dwordx4 v238, s[40:43], 0 offen lds
    s_add_u32 m0, s13, 3168
    v_mad_u32_u16 v239, v239, s15, v243
    buffer_load_dwordx4 v239, s[40:43], 0 offen lds
    s_mov_b32 m0, s14
    s_nop 0
    buffer_load_dwordx4 v[240:241], s[44:47], 0 idxen offen lds
L_HAD0:
    s_cmp_eq_u32 s30, 0
    s_cbranch_scc1 L_GO
    s_lshl_b32 s10, s4, 3
    v_mov_b32 v188, s10
    ds_read_b64 v[188:189], v188 offset:576
    s_waitcnt lgkmcnt(0)
    v_readfirstlane_b32 s34, v188
    v_readfirstlane_b32 s35, v189
    s_sub_u32 s10, s12, 37888
    s_sub_u32 s34, s34, s10
    s_sub_u32 s35, s35, s10
    s_sub_u32 s35, s35, 1152
    s_add_u32 s10, s34, 127
    s_lshr_b32 s10, s10, 7
    s_lshl1_add_u32 s10, s10, -1
    s_add_u32 s11, s35, 127
    s_lshr_b32 s11, s11, 6
    s_and_b32 s11, s11, -2
    s_max_i32 s17, s10, s11
    s_cselect_b32 s10, s34, s35
    s_sub_u32 s10, s10, 1
    s_andn2_b32 s99, 64, s10
L_GO:
    ds_read_u16 v252, v250 offset:0
    ds_read_u16 v253, v250 offset:64
    ds_read_b128 v[236:239], v248 offset:1152
    ds_read_b32 v240, v249 offset:1152
    s_lshr_b32 s10, s4, 1
    s_lshl_b32 s10, s10, 9
    s_add_u32 s10, s10, 155776
    v_lshl_add_u32 v246, v247, 3, s10
    s_bitcmp1_b32 s4, 0
    s_cselect_b32 s101, -1, 1
    s_mul_i32 s10, s101, 0xff000000
    s_or_b32 s10, s10, 0xdddd
    v_mov_b32 v255, s10
    s_max_i32 s10, s17, 1
    s_sub_u32 s10, s10, 1
    s_mul_i32 s10, s101, s10
    s_lshl_b32 s10, s10, 24
    v_mov_b32 v188, s10
    ds_add_u32 v246, v188
    s_movk_i32 s94, 128
    s_movk_i32 s95, 128
    v_mov_b32 v247, 0
    s_mov_b32 exec_hi, 0
    v_add_u32 v247, 0x200, v245
    s_mov_b32 exec_hi, -1
    s_waitcnt lgkmcnt(0)
    v_bfi_b32 v252, 31, v245, v252
    v_bfi_b32 v253, 31, v245, v253
    v_max_u32 v252, v252, v245
    v_max_u32 v253, v253, v247
    s_waitcnt vmcnt(0)
    ds_read_b128 v[176:179], v252
    ds_read_b128 v[180:183], v253
    ds_read_b128 v[160:163], v244 offset:0
    ds_read_b128 v[168:171], v244 offset:512
    ds_read_b128 v[164:167], v244 offset:64
    ds_read_b128 v[172:175], v244 offset:576
    s_cmp_lt_i32 s17, 1
    s_cbranch_scc1 L_DONE
    s_waitcnt lgkmcnt(4)
    v_mfma_f32_16x16x32_bf16 v[188:191], v[176:179], v[64:67], 0
    v_mfma_f32_16x16x32_bf16 v[196:199], v[176:179], v[68:71], 0
    v_mfma_f32_16x16x32_bf16 v[192:195], v[180:183], v[64:67], 0
    v_mfma_f32_16x16x32_bf16 v[200:203], v[180:183], v[68:71], 0
    s_waitcnt lgkmcnt(0)
    v_mfma_f32_16x16x32_bf16 v[188:191], v[160:163], v[0:3], v[188:191]
    v_mfma_f32_16x16x32_bf16 v[196:199], v[160:163], v[8:11], v[196:199]
    v_mfma_f32_16x16x32_bf16 v[192:195], v[168:171], v[0:3], v[192:195]
    v_mfma_f32_16x16x32_bf16 v[200:203], v[168:171], v[8:11], v[200:203]
    v_mfma_f32_16x16x32_bf16 v[188:191], v[164:167], v[4:7], v[188:191]
    v_mfma_f32_16x16x32_bf16 v[196:199], v[164:167], v[12:15], v[196:199]
    v_mfma_f32_16x16x32_bf16 v[192:195], v[172:175], v[4:7], v[192:195]
    v_mfma_f32_16x16x32_bf16 v[200:203], v[172:175], v[12:15], v[200:203]
    s_mov_b32 s16, 1
    s_cmp_eq_u32 s17, 1
    s_cbranch_scc1 L_LT0
    s_add_u32 m0, s13, 0
    v_mad_u32_u16 v236, v236, s15, v243
    buffer_load_dwordx4 v236, s[40:43], 0 offen lds
    s_add_u32 m0, s13, 1056
    v_mad_u32_u16 v237, v237, s15, v243
    buffer_load_dwordx4 v237, s[40:43], 0 offen lds
    s_add_u32 m0, s13, 2112
    v_mad_u32_u16 v238, v238, s15, v243
    buffer_load_dwordx4 v238, s[40:43], 0 offen lds
    s_add_u32 m0, s13, 3168
    v_mad_u32_u16 v239, v239, s15, v243
    buffer_load_dwordx4 v239, s[40:43], 0 offen lds
    s_mov_b32 m0, s14
    s_nop 0
    buffer_load_dwordx4 v[240:241], s[44:47], 0 idxen offen lds
.p2align 6
L_LOOP1:
    s_setprio 1
    v_smfmac_f32_16x16x64_bf16 v[152:155], v[184:187], v[204:211], v255
    ds_read_u16 v236, v251 offset:0
    ds_read_u16 v237, v251 offset:16
    ds_add_rtn_u32 v238, v246, v255
    v_exp_f32 v188, v188
    v_smfmac_f32_16x16x64_bf16 v[156:159], v[184:187], v[212:219], v255
    v_exp_f32 v189, v189
    v_mfma_f32_16x16x32_bf16 v[204:207], v[160:163], v[32:35], 0
    v_exp_f32 v190, v190
    v_mfma_f32_16x16x32_bf16 v[212:215], v[160:163], v[40:43], 0
    v_exp_f32 v191, v191
    v_mfma_f32_16x16x32_bf16 v[208:211], v[168:171], v[32:35], 0
    v_exp_f32 v192, v192
    v_mfma_f32_16x16x32_bf16 v[216:219], v[168:171], v[40:43], 0
    v_exp_f32 v193, v193
    v_mfma_f32_16x16x32_bf16 v[204:207], v[164:167], v[36:39], v[204:207]
    v_exp_f32 v194, v194
    v_mfma_f32_16x16x32_bf16 v[212:215], v[164:167], v[44:47], v[212:215]
    v_exp_f32 v195, v195
    v_mfma_f32_16x16x32_bf16 v[208:211], v[172:175], v[36:39], v[208:211]
    s_waitcnt lgkmcnt(0)
    v_bfi_b32 v236, 31, v246, v236
    v_bfi_b32 v237, 31, v246, v237
    v_readfirstlane_b32 s96, v238
    v_exp_f32 v196, v196
    v_mfma_f32_16x16x32_bf16 v[216:219], v[172:175], v[44:47], v[216:219]
    v_exp_f32 v197, v197
    v_smfmac_f32_16x16x64_bf16 v[136:139], v[184:187], v[220:227], v255
    v_exp_f32 v198, v198
    v_smfmac_f32_16x16x64_bf16 v[140:143], v[184:187], v[228:235], v255
    v_exp_f32 v199, v199
    v_mfma_f32_4x4x4_16b_bf16 v[188:191], v[242:243], v[242:243], v[188:191]
    v_exp_f32 v200, v200
    v_mfma_f32_4x4x4_16b_bf16 v[192:195], v[242:243], v[242:243], v[192:195]
    v_exp_f32 v201, v201
    v_mfma_f32_4x4x4_16b_bf16 v[196:199], v[242:243], v[242:243], v[196:199]
    v_exp_f32 v202, v202
    v_mfma_f32_16x16x32_bf16 v[220:223], v[176:179], v[72:75], 0
    ds_read_b64_tr_b16 v[184:185], v236
    ds_read_b64_tr_b16 v[186:187], v237
    ds_read_u16 v252, v250 offset:1152
    ds_read_u16 v253, v250 offset:1216
    v_exp_f32 v203, v203
    v_mfma_f32_16x16x32_bf16 v[228:231], v[176:179], v[76:79], 0
    s_ashr_i32 s96, s96, 24
    s_mul_i32 s96, s96, s101
    v_rcp_f32 v188, v188
    v_mfma_f32_16x16x32_bf16 v[224:227], v[180:183], v[72:75], 0
    v_rcp_f32 v189, v189
    v_mfma_f32_4x4x4_16b_bf16 v[200:203], v[242:243], v[242:243], v[200:203]
    v_rcp_f32 v190, v190
    v_mfma_f32_16x16x32_bf16 v[232:235], v[180:183], v[76:79], 0
    v_rcp_f32 v191, v191
    v_mfma_f32_16x16x32_bf16 v[220:223], v[160:163], v[16:19], v[220:223]
    v_rcp_f32 v192, v192
    v_mfma_f32_16x16x32_bf16 v[228:231], v[160:163], v[24:27], v[228:231]
    v_rcp_f32 v193, v193
    v_mfma_f32_16x16x32_bf16 v[224:227], v[168:171], v[16:19], v[224:227]
    s_waitcnt lgkmcnt(0)
    v_bfi_b32 v252, 31, v245, v252
    v_bfi_b32 v253, 31, v245, v253
    v_max_u32 v252, v252, v245
    v_max_u32 v253, v253, v247
    ds_read_b128 v[236:239], v248 offset:128
    ds_read_b32 v240, v249 offset:128
    s_add_u32 s16, s16, 1
    v_rcp_f32 v194, v194
    v_mfma_f32_16x16x32_bf16 v[232:235], v[168:171], v[24:27], v[232:235]
    v_rcp_f32 v195, v195
    v_mfma_f32_16x16x32_bf16 v[220:223], v[164:167], v[20:23], v[220:223]
    v_rcp_f32 v196, v196
    v_mfma_f32_16x16x32_bf16 v[228:231], v[164:167], v[28:31], v[228:231]
    v_rcp_f32 v197, v197
    s_setprio 3
    v_mfma_f32_16x16x32_bf16 v[224:227], v[172:175], v[20:23], v[224:227]
    v_rcp_f32 v198, v198
    v_mfma_f32_16x16x32_bf16 v[232:235], v[172:175], v[28:31], v[232:235]
    v_rcp_f32 v199, v199
    v_rcp_f32 v200, v200
    v_rcp_f32 v201, v201
    v_rcp_f32 v202, v202
    v_rcp_f32 v203, v203
    v_pk_mul_f32 v[204:205], v[188:189], v[204:205]
    v_pk_mul_f32 v[206:207], v[190:191], v[206:207]
    v_pk_mul_f32 v[208:209], v[192:193], v[208:209]
    v_pk_mul_f32 v[210:211], v[194:195], v[210:211]
    v_pk_mul_f32 v[212:213], v[196:197], v[212:213]
    v_pk_mul_f32 v[214:215], v[198:199], v[214:215]
    v_pk_mul_f32 v[216:217], v[200:201], v[216:217]
    v_pk_mul_f32 v[218:219], v[202:203], v[218:219]
    s_cmp_ge_i32 s96, 1
    s_cbranch_scc0 L_PB00
L_PB01:
    s_setprio 1
    v_smfmac_f32_16x16x64_bf16 v[112:115], v[184:187], v[204:211], v255
    v_exp_f32 v220, v220
    v_smfmac_f32_16x16x64_bf16 v[116:119], v[184:187], v[212:219], v255
    v_exp_f32 v221, v221
    s_waitcnt vmcnt(0)
    ds_read_b128 v[176:179], v252
    ds_read_b128 v[180:183], v253
    v_mfma_f32_16x16x32_bf16 v[204:207], v[160:163], v[48:51], 0
    v_exp_f32 v222, v222
    v_mfma_f32_16x16x32_bf16 v[212:215], v[160:163], v[56:59], 0
    ds_read_b128 v[160:163], v244 offset:0
    v_exp_f32 v223, v223
    v_mfma_f32_16x16x32_bf16 v[208:211], v[168:171], v[48:51], 0
    v_exp_f32 v224, v224
    v_mfma_f32_16x16x32_bf16 v[216:219], v[168:171], v[56:59], 0
    ds_read_b128 v[168:171], v244 offset:512
    v_exp_f32 v225, v225
    v_mfma_f32_16x16x32_bf16 v[204:207], v[164:167], v[52:55], v[204:207]
    v_exp_f32 v226, v226
    v_mfma_f32_16x16x32_bf16 v[212:215], v[164:167], v[60:63], v[212:215]
    ds_read_b128 v[164:167], v244 offset:64
    v_exp_f32 v227, v227
    v_mfma_f32_16x16x32_bf16 v[208:211], v[172:175], v[52:55], v[208:211]
    v_exp_f32 v228, v228
    v_mfma_f32_16x16x32_bf16 v[216:219], v[172:175], v[60:63], v[216:219]
    ds_read_b128 v[172:175], v244 offset:576
    v_exp_f32 v229, v229
    v_smfmac_f32_16x16x64_bf16 v[96:99], v[184:187], v[188:195], v255
    v_exp_f32 v230, v230
    v_smfmac_f32_16x16x64_bf16 v[100:103], v[184:187], v[196:203], v255
    v_exp_f32 v231, v231
    v_mfma_f32_4x4x4_16b_bf16 v[220:223], v[242:243], v[242:243], v[220:223]
    v_exp_f32 v232, v232
    v_mfma_f32_4x4x4_16b_bf16 v[224:227], v[242:243], v[242:243], v[224:227]
    v_exp_f32 v233, v233
    v_mfma_f32_4x4x4_16b_bf16 v[228:231], v[242:243], v[242:243], v[228:231]
    v_exp_f32 v234, v234
    s_waitcnt lgkmcnt(4)
    v_mfma_f32_16x16x32_bf16 v[188:191], v[176:179], v[80:83], 0
    v_exp_f32 v235, v235
    v_mfma_f32_16x16x32_bf16 v[196:199], v[176:179], v[84:87], 0
    v_rcp_f32 v220, v220
    v_mfma_f32_16x16x32_bf16 v[192:195], v[180:183], v[80:83], 0
    v_rcp_f32 v221, v221
    v_mfma_f32_4x4x4_16b_bf16 v[232:235], v[242:243], v[242:243], v[232:235]
    v_rcp_f32 v222, v222
    v_mfma_f32_16x16x32_bf16 v[200:203], v[180:183], v[84:87], 0
    v_rcp_f32 v223, v223
    s_waitcnt lgkmcnt(3)
    v_mfma_f32_16x16x32_bf16 v[188:191], v[160:163], v[0:3], v[188:191]
    v_rcp_f32 v224, v224
    v_mfma_f32_16x16x32_bf16 v[196:199], v[160:163], v[8:11], v[196:199]
    v_rcp_f32 v225, v225
    s_waitcnt lgkmcnt(2)
    v_mfma_f32_16x16x32_bf16 v[192:195], v[168:171], v[0:3], v[192:195]
    v_rcp_f32 v226, v226
    v_mfma_f32_16x16x32_bf16 v[200:203], v[168:171], v[8:11], v[200:203]
    v_rcp_f32 v227, v227
    s_waitcnt lgkmcnt(1)
    v_mfma_f32_16x16x32_bf16 v[188:191], v[164:167], v[4:7], v[188:191]
    v_rcp_f32 v228, v228
    v_mfma_f32_16x16x32_bf16 v[196:199], v[164:167], v[12:15], v[196:199]
    v_rcp_f32 v229, v229
    s_setprio 3
    s_waitcnt lgkmcnt(0)
    v_mfma_f32_16x16x32_bf16 v[192:195], v[172:175], v[4:7], v[192:195]
    s_cmp_lt_u32 s16, s17
    s_cbranch_scc0 L_ND01
    s_add_u32 m0, s13, 0
    v_mad_u32_u16 v236, v236, s15, v243
    buffer_load_dwordx4 v236, s[40:43], 0 offen lds
    s_add_u32 m0, s13, 1056
    v_mad_u32_u16 v237, v237, s15, v243
    buffer_load_dwordx4 v237, s[40:43], 0 offen lds
    s_add_u32 m0, s13, 2112
    v_mad_u32_u16 v238, v238, s15, v243
    buffer_load_dwordx4 v238, s[40:43], 0 offen lds
    s_add_u32 m0, s13, 3168
    v_mad_u32_u16 v239, v239, s15, v243
    buffer_load_dwordx4 v239, s[40:43], 0 offen lds
    s_mov_b32 m0, s14
    s_nop 0
    buffer_load_dwordx4 v[240:241], s[44:47], 0 idxen offen lds
L_ND01:
    v_rcp_f32 v230, v230
    v_mfma_f32_16x16x32_bf16 v[200:203], v[172:175], v[12:15], v[200:203]
    v_rcp_f32 v231, v231
    v_rcp_f32 v232, v232
    v_rcp_f32 v233, v233
    v_rcp_f32 v234, v234
    v_rcp_f32 v235, v235
    v_pk_mul_f32 v[204:205], v[220:221], v[204:205]
    v_pk_mul_f32 v[206:207], v[222:223], v[206:207]
    v_pk_mul_f32 v[208:209], v[224:225], v[208:209]
    v_pk_mul_f32 v[210:211], v[226:227], v[210:211]
    v_pk_mul_f32 v[212:213], v[228:229], v[212:213]
    v_pk_mul_f32 v[214:215], v[230:231], v[214:215]
    v_pk_mul_f32 v[216:217], v[232:233], v[216:217]
    v_pk_mul_f32 v[218:219], v[234:235], v[218:219]
    s_cmp_ge_u32 s16, s17
    s_cbranch_scc1 L_LT1
    s_setprio 1
    v_smfmac_f32_16x16x64_bf16 v[120:123], v[184:187], v[204:211], v255
    ds_read_u16 v236, v251 offset:1152
    ds_read_u16 v237, v251 offset:1168
    ds_add_rtn_u32 v238, v246, v255
    v_exp_f32 v188, v188
    v_smfmac_f32_16x16x64_bf16 v[124:127], v[184:187], v[212:219], v255
    v_exp_f32 v189, v189
    v_mfma_f32_16x16x32_bf16 v[204:207], v[160:163], v[32:35], 0
    v_exp_f32 v190, v190
    v_mfma_f32_16x16x32_bf16 v[212:215], v[160:163], v[40:43], 0
    v_exp_f32 v191, v191
    v_mfma_f32_16x16x32_bf16 v[208:211], v[168:171], v[32:35], 0
    v_exp_f32 v192, v192
    v_mfma_f32_16x16x32_bf16 v[216:219], v[168:171], v[40:43], 0
    v_exp_f32 v193, v193
    v_mfma_f32_16x16x32_bf16 v[204:207], v[164:167], v[36:39], v[204:207]
    v_exp_f32 v194, v194
    v_mfma_f32_16x16x32_bf16 v[212:215], v[164:167], v[44:47], v[212:215]
    v_exp_f32 v195, v195
    v_mfma_f32_16x16x32_bf16 v[208:211], v[172:175], v[36:39], v[208:211]
    s_waitcnt lgkmcnt(0)
    v_bfi_b32 v236, 31, v246, v236
    v_bfi_b32 v237, 31, v246, v237
    v_readfirstlane_b32 s96, v238
    v_exp_f32 v196, v196
    v_mfma_f32_16x16x32_bf16 v[216:219], v[172:175], v[44:47], v[216:219]
    v_exp_f32 v197, v197
    v_smfmac_f32_16x16x64_bf16 v[104:107], v[184:187], v[220:227], v255
    v_exp_f32 v198, v198
    v_smfmac_f32_16x16x64_bf16 v[108:111], v[184:187], v[228:235], v255
    v_exp_f32 v199, v199
    v_mfma_f32_4x4x4_16b_bf16 v[188:191], v[242:243], v[242:243], v[188:191]
    v_exp_f32 v200, v200
    v_mfma_f32_4x4x4_16b_bf16 v[192:195], v[242:243], v[242:243], v[192:195]
    v_exp_f32 v201, v201
    v_mfma_f32_4x4x4_16b_bf16 v[196:199], v[242:243], v[242:243], v[196:199]
    v_exp_f32 v202, v202
    v_mfma_f32_16x16x32_bf16 v[220:223], v[176:179], v[88:91], 0
    ds_read_b64_tr_b16 v[184:185], v236
    ds_read_b64_tr_b16 v[186:187], v237
    ds_read_u16 v252, v250 offset:128
    ds_read_u16 v253, v250 offset:192
    v_exp_f32 v203, v203
    v_mfma_f32_16x16x32_bf16 v[228:231], v[176:179], v[92:95], 0
    s_ashr_i32 s96, s96, 24
    s_mul_i32 s96, s96, s101
    v_rcp_f32 v188, v188
    v_mfma_f32_16x16x32_bf16 v[224:227], v[180:183], v[88:91], 0
    v_rcp_f32 v189, v189
    v_mfma_f32_4x4x4_16b_bf16 v[200:203], v[242:243], v[242:243], v[200:203]
    v_rcp_f32 v190, v190
    v_mfma_f32_16x16x32_bf16 v[232:235], v[180:183], v[92:95], 0
    v_rcp_f32 v191, v191
    v_mfma_f32_16x16x32_bf16 v[220:223], v[160:163], v[16:19], v[220:223]
    v_rcp_f32 v192, v192
    v_mfma_f32_16x16x32_bf16 v[228:231], v[160:163], v[24:27], v[228:231]
    v_rcp_f32 v193, v193
    v_mfma_f32_16x16x32_bf16 v[224:227], v[168:171], v[16:19], v[224:227]
    s_waitcnt lgkmcnt(0)
    v_bfi_b32 v252, 31, v245, v252
    v_bfi_b32 v253, 31, v245, v253
    v_max_u32 v252, v252, v245
    v_max_u32 v253, v253, v247
    ds_read_b128 v[236:239], v248 offset:1280
    ds_read_b32 v240, v249 offset:1280
    s_add_u32 s16, s16, 1
    v_rcp_f32 v194, v194
    v_mfma_f32_16x16x32_bf16 v[232:235], v[168:171], v[24:27], v[232:235]
    v_lshl_add_u64 v[248:249], v[248:249], 0, s[94:95]
    v_lshl_add_u64 v[250:251], v[250:251], 0, s[94:95]
    v_rcp_f32 v195, v195
    v_mfma_f32_16x16x32_bf16 v[220:223], v[164:167], v[20:23], v[220:223]
    v_rcp_f32 v196, v196
    v_mfma_f32_16x16x32_bf16 v[228:231], v[164:167], v[28:31], v[228:231]
    v_rcp_f32 v197, v197
    s_setprio 3
    v_mfma_f32_16x16x32_bf16 v[224:227], v[172:175], v[20:23], v[224:227]
    v_rcp_f32 v198, v198
    v_mfma_f32_16x16x32_bf16 v[232:235], v[172:175], v[28:31], v[232:235]
    v_rcp_f32 v199, v199
    v_rcp_f32 v200, v200
    v_rcp_f32 v201, v201
    v_rcp_f32 v202, v202
    v_rcp_f32 v203, v203
    v_pk_mul_f32 v[204:205], v[188:189], v[204:205]
    v_pk_mul_f32 v[206:207], v[190:191], v[206:207]
    v_pk_mul_f32 v[208:209], v[192:193], v[208:209]
    v_pk_mul_f32 v[210:211], v[194:195], v[210:211]
    v_pk_mul_f32 v[212:213], v[196:197], v[212:213]
    v_pk_mul_f32 v[214:215], v[198:199], v[214:215]
    v_pk_mul_f32 v[216:217], v[200:201], v[216:217]
    v_pk_mul_f32 v[218:219], v[202:203], v[218:219]
    s_cmp_ge_i32 s96, 1
    s_cbranch_scc0 L_PB10
L_PB11:
    s_setprio 1
    v_smfmac_f32_16x16x64_bf16 v[144:147], v[184:187], v[204:211], v255
    v_exp_f32 v220, v220
    v_smfmac_f32_16x16x64_bf16 v[148:151], v[184:187], v[212:219], v255
    v_exp_f32 v221, v221
    s_waitcnt vmcnt(0)
    ds_read_b128 v[176:179], v252
    ds_read_b128 v[180:183], v253
    v_mfma_f32_16x16x32_bf16 v[204:207], v[160:163], v[48:51], 0
    v_exp_f32 v222, v222
    v_mfma_f32_16x16x32_bf16 v[212:215], v[160:163], v[56:59], 0
    ds_read_b128 v[160:163], v244 offset:0
    v_exp_f32 v223, v223
    v_mfma_f32_16x16x32_bf16 v[208:211], v[168:171], v[48:51], 0
    v_exp_f32 v224, v224
    v_mfma_f32_16x16x32_bf16 v[216:219], v[168:171], v[56:59], 0
    ds_read_b128 v[168:171], v244 offset:512
    v_exp_f32 v225, v225
    v_mfma_f32_16x16x32_bf16 v[204:207], v[164:167], v[52:55], v[204:207]
    v_exp_f32 v226, v226
    v_mfma_f32_16x16x32_bf16 v[212:215], v[164:167], v[60:63], v[212:215]
    ds_read_b128 v[164:167], v244 offset:64
    v_exp_f32 v227, v227
    v_mfma_f32_16x16x32_bf16 v[208:211], v[172:175], v[52:55], v[208:211]
    v_exp_f32 v228, v228
    v_mfma_f32_16x16x32_bf16 v[216:219], v[172:175], v[60:63], v[216:219]
    ds_read_b128 v[172:175], v244 offset:576
    v_exp_f32 v229, v229
    v_smfmac_f32_16x16x64_bf16 v[128:131], v[184:187], v[188:195], v255
    v_exp_f32 v230, v230
    v_smfmac_f32_16x16x64_bf16 v[132:135], v[184:187], v[196:203], v255
    v_exp_f32 v231, v231
    v_mfma_f32_4x4x4_16b_bf16 v[220:223], v[242:243], v[242:243], v[220:223]
    v_exp_f32 v232, v232
    v_mfma_f32_4x4x4_16b_bf16 v[224:227], v[242:243], v[242:243], v[224:227]
    v_exp_f32 v233, v233
    v_mfma_f32_4x4x4_16b_bf16 v[228:231], v[242:243], v[242:243], v[228:231]
    v_exp_f32 v234, v234
    s_waitcnt lgkmcnt(4)
    v_mfma_f32_16x16x32_bf16 v[188:191], v[176:179], v[64:67], 0
    v_exp_f32 v235, v235
    v_mfma_f32_16x16x32_bf16 v[196:199], v[176:179], v[68:71], 0
    v_rcp_f32 v220, v220
    v_mfma_f32_16x16x32_bf16 v[192:195], v[180:183], v[64:67], 0
    v_rcp_f32 v221, v221
    v_mfma_f32_4x4x4_16b_bf16 v[232:235], v[242:243], v[242:243], v[232:235]
    v_rcp_f32 v222, v222
    v_mfma_f32_16x16x32_bf16 v[200:203], v[180:183], v[68:71], 0
    v_rcp_f32 v223, v223
    s_waitcnt lgkmcnt(3)
    v_mfma_f32_16x16x32_bf16 v[188:191], v[160:163], v[0:3], v[188:191]
    v_rcp_f32 v224, v224
    v_mfma_f32_16x16x32_bf16 v[196:199], v[160:163], v[8:11], v[196:199]
    v_rcp_f32 v225, v225
    s_waitcnt lgkmcnt(2)
    v_mfma_f32_16x16x32_bf16 v[192:195], v[168:171], v[0:3], v[192:195]
    v_rcp_f32 v226, v226
    v_mfma_f32_16x16x32_bf16 v[200:203], v[168:171], v[8:11], v[200:203]
    v_rcp_f32 v227, v227
    s_waitcnt lgkmcnt(1)
    v_mfma_f32_16x16x32_bf16 v[188:191], v[164:167], v[4:7], v[188:191]
    v_rcp_f32 v228, v228
    v_mfma_f32_16x16x32_bf16 v[196:199], v[164:167], v[12:15], v[196:199]
    v_rcp_f32 v229, v229
    s_setprio 3
    s_waitcnt lgkmcnt(0)
    v_mfma_f32_16x16x32_bf16 v[192:195], v[172:175], v[4:7], v[192:195]
    s_cmp_lt_u32 s16, s17
    s_cbranch_scc0 L_ND11
    s_add_u32 m0, s13, 0
    v_mad_u32_u16 v236, v236, s15, v243
    buffer_load_dwordx4 v236, s[40:43], 0 offen lds
    s_add_u32 m0, s13, 1056
    v_mad_u32_u16 v237, v237, s15, v243
    buffer_load_dwordx4 v237, s[40:43], 0 offen lds
    s_add_u32 m0, s13, 2112
    v_mad_u32_u16 v238, v238, s15, v243
    buffer_load_dwordx4 v238, s[40:43], 0 offen lds
    s_add_u32 m0, s13, 3168
    v_mad_u32_u16 v239, v239, s15, v243
    buffer_load_dwordx4 v239, s[40:43], 0 offen lds
    s_mov_b32 m0, s14
    s_nop 0
    buffer_load_dwordx4 v[240:241], s[44:47], 0 idxen offen lds
L_ND11:
    v_rcp_f32 v230, v230
    v_mfma_f32_16x16x32_bf16 v[200:203], v[172:175], v[12:15], v[200:203]
    v_rcp_f32 v231, v231
    v_rcp_f32 v232, v232
    v_rcp_f32 v233, v233
    v_rcp_f32 v234, v234
    v_rcp_f32 v235, v235
    v_pk_mul_f32 v[204:205], v[220:221], v[204:205]
    v_pk_mul_f32 v[206:207], v[222:223], v[206:207]
    v_pk_mul_f32 v[208:209], v[224:225], v[208:209]
    v_pk_mul_f32 v[210:211], v[226:227], v[210:211]
    v_pk_mul_f32 v[212:213], v[228:229], v[212:213]
    v_pk_mul_f32 v[214:215], v[230:231], v[214:215]
    v_pk_mul_f32 v[216:217], v[232:233], v[216:217]
    v_pk_mul_f32 v[218:219], v[234:235], v[218:219]
    s_cmp_lt_u32 s16, s17
    s_cbranch_scc1 L_LOOP1
    s_branch L_LT0
.p2align 6
L_LOOP0:
    s_setprio 0
    v_smfmac_f32_16x16x64_bf16 v[152:155], v[184:187], v[204:211], v255
    ds_read_u16 v236, v251 offset:0
    ds_read_u16 v237, v251 offset:16
    ds_add_rtn_u32 v238, v246, v255
    v_exp_f32 v188, v188
    v_smfmac_f32_16x16x64_bf16 v[156:159], v[184:187], v[212:219], v255
    v_exp_f32 v189, v189
    v_mfma_f32_16x16x32_bf16 v[204:207], v[160:163], v[32:35], 0
    v_exp_f32 v190, v190
    v_mfma_f32_16x16x32_bf16 v[212:215], v[160:163], v[40:43], 0
    v_exp_f32 v191, v191
    v_mfma_f32_16x16x32_bf16 v[208:211], v[168:171], v[32:35], 0
    v_exp_f32 v192, v192
    v_mfma_f32_16x16x32_bf16 v[216:219], v[168:171], v[40:43], 0
    v_exp_f32 v193, v193
    v_mfma_f32_16x16x32_bf16 v[204:207], v[164:167], v[36:39], v[204:207]
    v_exp_f32 v194, v194
    v_mfma_f32_16x16x32_bf16 v[212:215], v[164:167], v[44:47], v[212:215]
    v_exp_f32 v195, v195
    v_mfma_f32_16x16x32_bf16 v[208:211], v[172:175], v[36:39], v[208:211]
    s_waitcnt lgkmcnt(0)
    v_bfi_b32 v236, 31, v246, v236
    v_bfi_b32 v237, 31, v246, v237
    v_readfirstlane_b32 s96, v238
    v_exp_f32 v196, v196
    v_mfma_f32_16x16x32_bf16 v[216:219], v[172:175], v[44:47], v[216:219]
    v_exp_f32 v197, v197
    v_smfmac_f32_16x16x64_bf16 v[136:139], v[184:187], v[220:227], v255
    v_exp_f32 v198, v198
    v_smfmac_f32_16x16x64_bf16 v[140:143], v[184:187], v[228:235], v255
    v_exp_f32 v199, v199
    v_mfma_f32_4x4x4_16b_bf16 v[188:191], v[242:243], v[242:243], v[188:191]
    v_exp_f32 v200, v200
    v_mfma_f32_4x4x4_16b_bf16 v[192:195], v[242:243], v[242:243], v[192:195]
    v_exp_f32 v201, v201
    v_mfma_f32_4x4x4_16b_bf16 v[196:199], v[242:243], v[242:243], v[196:199]
    v_exp_f32 v202, v202
    v_mfma_f32_16x16x32_bf16 v[220:223], v[176:179], v[72:75], 0
    ds_read_b64_tr_b16 v[184:185], v236
    ds_read_b64_tr_b16 v[186:187], v237
    ds_read_u16 v252, v250 offset:1152
    ds_read_u16 v253, v250 offset:1216
    v_exp_f32 v203, v203
    v_mfma_f32_16x16x32_bf16 v[228:231], v[176:179], v[76:79], 0
    s_ashr_i32 s96, s96, 24
    s_mul_i32 s96, s96, s101
    v_rcp_f32 v188, v188
    v_mfma_f32_16x16x32_bf16 v[224:227], v[180:183], v[72:75], 0
    v_rcp_f32 v189, v189
    v_mfma_f32_4x4x4_16b_bf16 v[200:203], v[242:243], v[242:243], v[200:203]
    v_rcp_f32 v190, v190
    v_mfma_f32_16x16x32_bf16 v[232:235], v[180:183], v[76:79], 0
    v_rcp_f32 v191, v191
    v_mfma_f32_16x16x32_bf16 v[220:223], v[160:163], v[16:19], v[220:223]
    v_rcp_f32 v192, v192
    v_mfma_f32_16x16x32_bf16 v[228:231], v[160:163], v[24:27], v[228:231]
    v_rcp_f32 v193, v193
    v_mfma_f32_16x16x32_bf16 v[224:227], v[168:171], v[16:19], v[224:227]
    s_waitcnt lgkmcnt(0)
    v_bfi_b32 v252, 31, v245, v252
    v_bfi_b32 v253, 31, v245, v253
    v_max_u32 v252, v252, v245
    v_max_u32 v253, v253, v247
    ds_read_b128 v[236:239], v248 offset:128
    ds_read_b32 v240, v249 offset:128
    s_add_u32 s16, s16, 1
    v_rcp_f32 v194, v194
    v_mfma_f32_16x16x32_bf16 v[232:235], v[168:171], v[24:27], v[232:235]
    v_rcp_f32 v195, v195
    v_mfma_f32_16x16x32_bf16 v[220:223], v[164:167], v[20:23], v[220:223]
    v_rcp_f32 v196, v196
    v_mfma_f32_16x16x32_bf16 v[228:231], v[164:167], v[28:31], v[228:231]
    v_rcp_f32 v197, v197
    s_setprio 3
    v_mfma_f32_16x16x32_bf16 v[224:227], v[172:175], v[20:23], v[224:227]
    v_rcp_f32 v198, v198
    v_mfma_f32_16x16x32_bf16 v[232:235], v[172:175], v[28:31], v[232:235]
    v_rcp_f32 v199, v199
    v_rcp_f32 v200, v200
    v_rcp_f32 v201, v201
    v_rcp_f32 v202, v202
    v_rcp_f32 v203, v203
    v_pk_mul_f32 v[204:205], v[188:189], v[204:205]
    v_pk_mul_f32 v[206:207], v[190:191], v[206:207]
    v_pk_mul_f32 v[208:209], v[192:193], v[208:209]
    v_pk_mul_f32 v[210:211], v[194:195], v[210:211]
    v_pk_mul_f32 v[212:213], v[196:197], v[212:213]
    v_pk_mul_f32 v[214:215], v[198:199], v[214:215]
    v_pk_mul_f32 v[216:217], v[200:201], v[216:217]
    v_pk_mul_f32 v[218:219], v[202:203], v[218:219]
    s_cmp_ge_i32 s96, 1
    s_cbranch_scc1 L_PB01
L_PB00:
    s_setprio 0
    v_smfmac_f32_16x16x64_bf16 v[112:115], v[184:187], v[204:211], v255
    v_exp_f32 v220, v220
    v_smfmac_f32_16x16x64_bf16 v[116:119], v[184:187], v[212:219], v255
    v_exp_f32 v221, v221
    s_waitcnt vmcnt(0)
    ds_read_b128 v[176:179], v252
    ds_read_b128 v[180:183], v253
    v_mfma_f32_16x16x32_bf16 v[204:207], v[160:163], v[48:51], 0
    v_exp_f32 v222, v222
    v_mfma_f32_16x16x32_bf16 v[212:215], v[160:163], v[56:59], 0
    ds_read_b128 v[160:163], v244 offset:0
    v_exp_f32 v223, v223
    v_mfma_f32_16x16x32_bf16 v[208:211], v[168:171], v[48:51], 0
    v_exp_f32 v224, v224
    v_mfma_f32_16x16x32_bf16 v[216:219], v[168:171], v[56:59], 0
    ds_read_b128 v[168:171], v244 offset:512
    v_exp_f32 v225, v225
    v_mfma_f32_16x16x32_bf16 v[204:207], v[164:167], v[52:55], v[204:207]
    v_exp_f32 v226, v226
    v_mfma_f32_16x16x32_bf16 v[212:215], v[164:167], v[60:63], v[212:215]
    ds_read_b128 v[164:167], v244 offset:64
    v_exp_f32 v227, v227
    v_mfma_f32_16x16x32_bf16 v[208:211], v[172:175], v[52:55], v[208:211]
    v_exp_f32 v228, v228
    v_mfma_f32_16x16x32_bf16 v[216:219], v[172:175], v[60:63], v[216:219]
    ds_read_b128 v[172:175], v244 offset:576
    v_exp_f32 v229, v229
    v_smfmac_f32_16x16x64_bf16 v[96:99], v[184:187], v[188:195], v255
    v_exp_f32 v230, v230
    v_smfmac_f32_16x16x64_bf16 v[100:103], v[184:187], v[196:203], v255
    v_exp_f32 v231, v231
    v_mfma_f32_4x4x4_16b_bf16 v[220:223], v[242:243], v[242:243], v[220:223]
    v_exp_f32 v232, v232
    v_mfma_f32_4x4x4_16b_bf16 v[224:227], v[242:243], v[242:243], v[224:227]
    v_exp_f32 v233, v233
    v_mfma_f32_4x4x4_16b_bf16 v[228:231], v[242:243], v[242:243], v[228:231]
    v_exp_f32 v234, v234
    s_waitcnt lgkmcnt(4)
    v_mfma_f32_16x16x32_bf16 v[188:191], v[176:179], v[80:83], 0
    v_exp_f32 v235, v235
    v_mfma_f32_16x16x32_bf16 v[196:199], v[176:179], v[84:87], 0
    v_rcp_f32 v220, v220
    v_mfma_f32_16x16x32_bf16 v[192:195], v[180:183], v[80:83], 0
    v_rcp_f32 v221, v221
    v_mfma_f32_4x4x4_16b_bf16 v[232:235], v[242:243], v[242:243], v[232:235]
    v_rcp_f32 v222, v222
    v_mfma_f32_16x16x32_bf16 v[200:203], v[180:183], v[84:87], 0
    v_rcp_f32 v223, v223
    s_waitcnt lgkmcnt(3)
    v_mfma_f32_16x16x32_bf16 v[188:191], v[160:163], v[0:3], v[188:191]
    v_rcp_f32 v224, v224
    v_mfma_f32_16x16x32_bf16 v[196:199], v[160:163], v[8:11], v[196:199]
    v_rcp_f32 v225, v225
    s_waitcnt lgkmcnt(2)
    v_mfma_f32_16x16x32_bf16 v[192:195], v[168:171], v[0:3], v[192:195]
    v_rcp_f32 v226, v226
    v_mfma_f32_16x16x32_bf16 v[200:203], v[168:171], v[8:11], v[200:203]
    v_rcp_f32 v227, v227
    s_waitcnt lgkmcnt(1)
    v_mfma_f32_16x16x32_bf16 v[188:191], v[164:167], v[4:7], v[188:191]
    v_rcp_f32 v228, v228
    v_mfma_f32_16x16x32_bf16 v[196:199], v[164:167], v[12:15], v[196:199]
    v_rcp_f32 v229, v229
    s_setprio 3
    s_waitcnt lgkmcnt(0)
    v_mfma_f32_16x16x32_bf16 v[192:195], v[172:175], v[4:7], v[192:195]
    s_cmp_lt_u32 s16, s17
    s_cbranch_scc0 L_ND00
    s_add_u32 m0, s13, 0
    v_mad_u32_u16 v236, v236, s15, v243
    buffer_load_dwordx4 v236, s[40:43], 0 offen lds
    s_add_u32 m0, s13, 1056
    v_mad_u32_u16 v237, v237, s15, v243
    buffer_load_dwordx4 v237, s[40:43], 0 offen lds
    s_add_u32 m0, s13, 2112
    v_mad_u32_u16 v238, v238, s15, v243
    buffer_load_dwordx4 v238, s[40:43], 0 offen lds
    s_add_u32 m0, s13, 3168
    v_mad_u32_u16 v239, v239, s15, v243
    buffer_load_dwordx4 v239, s[40:43], 0 offen lds
    s_mov_b32 m0, s14
    s_nop 0
    buffer_load_dwordx4 v[240:241], s[44:47], 0 idxen offen lds
L_ND00:
    v_rcp_f32 v230, v230
    v_mfma_f32_16x16x32_bf16 v[200:203], v[172:175], v[12:15], v[200:203]
    v_rcp_f32 v231, v231
    v_rcp_f32 v232, v232
    v_rcp_f32 v233, v233
    v_rcp_f32 v234, v234
    v_rcp_f32 v235, v235
    v_pk_mul_f32 v[204:205], v[220:221], v[204:205]
    v_pk_mul_f32 v[206:207], v[222:223], v[206:207]
    v_pk_mul_f32 v[208:209], v[224:225], v[208:209]
    v_pk_mul_f32 v[210:211], v[226:227], v[210:211]
    v_pk_mul_f32 v[212:213], v[228:229], v[212:213]
    v_pk_mul_f32 v[214:215], v[230:231], v[214:215]
    v_pk_mul_f32 v[216:217], v[232:233], v[216:217]
    v_pk_mul_f32 v[218:219], v[234:235], v[218:219]
    s_cmp_ge_u32 s16, s17
    s_cbranch_scc1 L_LT1
    s_setprio 0
    v_smfmac_f32_16x16x64_bf16 v[120:123], v[184:187], v[204:211], v255
    ds_read_u16 v236, v251 offset:1152
    ds_read_u16 v237, v251 offset:1168
    ds_add_rtn_u32 v238, v246, v255
    v_exp_f32 v188, v188
    v_smfmac_f32_16x16x64_bf16 v[124:127], v[184:187], v[212:219], v255
    v_exp_f32 v189, v189
    v_mfma_f32_16x16x32_bf16 v[204:207], v[160:163], v[32:35], 0
    v_exp_f32 v190, v190
    v_mfma_f32_16x16x32_bf16 v[212:215], v[160:163], v[40:43], 0
    v_exp_f32 v191, v191
    v_mfma_f32_16x16x32_bf16 v[208:211], v[168:171], v[32:35], 0
    v_exp_f32 v192, v192
    v_mfma_f32_16x16x32_bf16 v[216:219], v[168:171], v[40:43], 0
    v_exp_f32 v193, v193
    v_mfma_f32_16x16x32_bf16 v[204:207], v[164:167], v[36:39], v[204:207]
    v_exp_f32 v194, v194
    v_mfma_f32_16x16x32_bf16 v[212:215], v[164:167], v[44:47], v[212:215]
    v_exp_f32 v195, v195
    v_mfma_f32_16x16x32_bf16 v[208:211], v[172:175], v[36:39], v[208:211]
    s_waitcnt lgkmcnt(0)
    v_bfi_b32 v236, 31, v246, v236
    v_bfi_b32 v237, 31, v246, v237
    v_readfirstlane_b32 s96, v238
    v_exp_f32 v196, v196
    v_mfma_f32_16x16x32_bf16 v[216:219], v[172:175], v[44:47], v[216:219]
    v_exp_f32 v197, v197
    v_smfmac_f32_16x16x64_bf16 v[104:107], v[184:187], v[220:227], v255
    v_exp_f32 v198, v198
    v_smfmac_f32_16x16x64_bf16 v[108:111], v[184:187], v[228:235], v255
    v_exp_f32 v199, v199
    v_mfma_f32_4x4x4_16b_bf16 v[188:191], v[242:243], v[242:243], v[188:191]
    v_exp_f32 v200, v200
    v_mfma_f32_4x4x4_16b_bf16 v[192:195], v[242:243], v[242:243], v[192:195]
    v_exp_f32 v201, v201
    v_mfma_f32_4x4x4_16b_bf16 v[196:199], v[242:243], v[242:243], v[196:199]
    v_exp_f32 v202, v202
    v_mfma_f32_16x16x32_bf16 v[220:223], v[176:179], v[88:91], 0
    ds_read_b64_tr_b16 v[184:185], v236
    ds_read_b64_tr_b16 v[186:187], v237
    ds_read_u16 v252, v250 offset:128
    ds_read_u16 v253, v250 offset:192
    v_exp_f32 v203, v203
    v_mfma_f32_16x16x32_bf16 v[228:231], v[176:179], v[92:95], 0
    s_ashr_i32 s96, s96, 24
    s_mul_i32 s96, s96, s101
    v_rcp_f32 v188, v188
    v_mfma_f32_16x16x32_bf16 v[224:227], v[180:183], v[88:91], 0
    v_rcp_f32 v189, v189
    v_mfma_f32_4x4x4_16b_bf16 v[200:203], v[242:243], v[242:243], v[200:203]
    v_rcp_f32 v190, v190
    v_mfma_f32_16x16x32_bf16 v[232:235], v[180:183], v[92:95], 0
    v_rcp_f32 v191, v191
    v_mfma_f32_16x16x32_bf16 v[220:223], v[160:163], v[16:19], v[220:223]
    v_rcp_f32 v192, v192
    v_mfma_f32_16x16x32_bf16 v[228:231], v[160:163], v[24:27], v[228:231]
    v_rcp_f32 v193, v193
    v_mfma_f32_16x16x32_bf16 v[224:227], v[168:171], v[16:19], v[224:227]
    s_waitcnt lgkmcnt(0)
    v_bfi_b32 v252, 31, v245, v252
    v_bfi_b32 v253, 31, v245, v253
    v_max_u32 v252, v252, v245
    v_max_u32 v253, v253, v247
    ds_read_b128 v[236:239], v248 offset:1280
    ds_read_b32 v240, v249 offset:1280
    s_add_u32 s16, s16, 1
    v_rcp_f32 v194, v194
    v_mfma_f32_16x16x32_bf16 v[232:235], v[168:171], v[24:27], v[232:235]
    v_lshl_add_u64 v[248:249], v[248:249], 0, s[94:95]
    v_lshl_add_u64 v[250:251], v[250:251], 0, s[94:95]
    v_rcp_f32 v195, v195
    v_mfma_f32_16x16x32_bf16 v[220:223], v[164:167], v[20:23], v[220:223]
    v_rcp_f32 v196, v196
    v_mfma_f32_16x16x32_bf16 v[228:231], v[164:167], v[28:31], v[228:231]
    v_rcp_f32 v197, v197
    s_setprio 3
    v_mfma_f32_16x16x32_bf16 v[224:227], v[172:175], v[20:23], v[224:227]
    v_rcp_f32 v198, v198
    v_mfma_f32_16x16x32_bf16 v[232:235], v[172:175], v[28:31], v[232:235]
    v_rcp_f32 v199, v199
    v_rcp_f32 v200, v200
    v_rcp_f32 v201, v201
    v_rcp_f32 v202, v202
    v_rcp_f32 v203, v203
    v_pk_mul_f32 v[204:205], v[188:189], v[204:205]
    v_pk_mul_f32 v[206:207], v[190:191], v[206:207]
    v_pk_mul_f32 v[208:209], v[192:193], v[208:209]
    v_pk_mul_f32 v[210:211], v[194:195], v[210:211]
    v_pk_mul_f32 v[212:213], v[196:197], v[212:213]
    v_pk_mul_f32 v[214:215], v[198:199], v[214:215]
    v_pk_mul_f32 v[216:217], v[200:201], v[216:217]
    v_pk_mul_f32 v[218:219], v[202:203], v[218:219]
    s_cmp_ge_i32 s96, 1
    s_cbranch_scc1 L_PB11
L_PB10:
    s_setprio 0
    v_smfmac_f32_16x16x64_bf16 v[144:147], v[184:187], v[204:211], v255
    v_exp_f32 v220, v220
    v_smfmac_f32_16x16x64_bf16 v[148:151], v[184:187], v[212:219], v255
    v_exp_f32 v221, v221
    s_waitcnt vmcnt(0)
    ds_read_b128 v[176:179], v252
    ds_read_b128 v[180:183], v253
    v_mfma_f32_16x16x32_bf16 v[204:207], v[160:163], v[48:51], 0
    v_exp_f32 v222, v222
    v_mfma_f32_16x16x32_bf16 v[212:215], v[160:163], v[56:59], 0
    ds_read_b128 v[160:163], v244 offset:0
    v_exp_f32 v223, v223
    v_mfma_f32_16x16x32_bf16 v[208:211], v[168:171], v[48:51], 0
    v_exp_f32 v224, v224
    v_mfma_f32_16x16x32_bf16 v[216:219], v[168:171], v[56:59], 0
    ds_read_b128 v[168:171], v244 offset:512
    v_exp_f32 v225, v225
    v_mfma_f32_16x16x32_bf16 v[204:207], v[164:167], v[52:55], v[204:207]
    v_exp_f32 v226, v226
    v_mfma_f32_16x16x32_bf16 v[212:215], v[164:167], v[60:63], v[212:215]
    ds_read_b128 v[164:167], v244 offset:64
    v_exp_f32 v227, v227
    v_mfma_f32_16x16x32_bf16 v[208:211], v[172:175], v[52:55], v[208:211]
    v_exp_f32 v228, v228
    v_mfma_f32_16x16x32_bf16 v[216:219], v[172:175], v[60:63], v[216:219]
    ds_read_b128 v[172:175], v244 offset:576
    v_exp_f32 v229, v229
    v_smfmac_f32_16x16x64_bf16 v[128:131], v[184:187], v[188:195], v255
    v_exp_f32 v230, v230
    v_smfmac_f32_16x16x64_bf16 v[132:135], v[184:187], v[196:203], v255
    v_exp_f32 v231, v231
    v_mfma_f32_4x4x4_16b_bf16 v[220:223], v[242:243], v[242:243], v[220:223]
    v_exp_f32 v232, v232
    v_mfma_f32_4x4x4_16b_bf16 v[224:227], v[242:243], v[242:243], v[224:227]
    v_exp_f32 v233, v233
    v_mfma_f32_4x4x4_16b_bf16 v[228:231], v[242:243], v[242:243], v[228:231]
    v_exp_f32 v234, v234
    s_waitcnt lgkmcnt(4)
    v_mfma_f32_16x16x32_bf16 v[188:191], v[176:179], v[64:67], 0
    v_exp_f32 v235, v235
    v_mfma_f32_16x16x32_bf16 v[196:199], v[176:179], v[68:71], 0
    v_rcp_f32 v220, v220
    v_mfma_f32_16x16x32_bf16 v[192:195], v[180:183], v[64:67], 0
    v_rcp_f32 v221, v221
    v_mfma_f32_4x4x4_16b_bf16 v[232:235], v[242:243], v[242:243], v[232:235]
    v_rcp_f32 v222, v222
    v_mfma_f32_16x16x32_bf16 v[200:203], v[180:183], v[68:71], 0
    v_rcp_f32 v223, v223
    s_waitcnt lgkmcnt(3)
    v_mfma_f32_16x16x32_bf16 v[188:191], v[160:163], v[0:3], v[188:191]
    v_rcp_f32 v224, v224
    v_mfma_f32_16x16x32_bf16 v[196:199], v[160:163], v[8:11], v[196:199]
    v_rcp_f32 v225, v225
    s_waitcnt lgkmcnt(2)
    v_mfma_f32_16x16x32_bf16 v[192:195], v[168:171], v[0:3], v[192:195]
    v_rcp_f32 v226, v226
    v_mfma_f32_16x16x32_bf16 v[200:203], v[168:171], v[8:11], v[200:203]
    v_rcp_f32 v227, v227
    s_waitcnt lgkmcnt(1)
    v_mfma_f32_16x16x32_bf16 v[188:191], v[164:167], v[4:7], v[188:191]
    v_rcp_f32 v228, v228
    v_mfma_f32_16x16x32_bf16 v[196:199], v[164:167], v[12:15], v[196:199]
    v_rcp_f32 v229, v229
    s_setprio 3
    s_waitcnt lgkmcnt(0)
    v_mfma_f32_16x16x32_bf16 v[192:195], v[172:175], v[4:7], v[192:195]
    s_cmp_lt_u32 s16, s17
    s_cbranch_scc0 L_ND10
    s_add_u32 m0, s13, 0
    v_mad_u32_u16 v236, v236, s15, v243
    buffer_load_dwordx4 v236, s[40:43], 0 offen lds
    s_add_u32 m0, s13, 1056
    v_mad_u32_u16 v237, v237, s15, v243
    buffer_load_dwordx4 v237, s[40:43], 0 offen lds
    s_add_u32 m0, s13, 2112
    v_mad_u32_u16 v238, v238, s15, v243
    buffer_load_dwordx4 v238, s[40:43], 0 offen lds
    s_add_u32 m0, s13, 3168
    v_mad_u32_u16 v239, v239, s15, v243
    buffer_load_dwordx4 v239, s[40:43], 0 offen lds
    s_mov_b32 m0, s14
    s_nop 0
    buffer_load_dwordx4 v[240:241], s[44:47], 0 idxen offen lds
L_ND10:
    v_rcp_f32 v230, v230
    v_mfma_f32_16x16x32_bf16 v[200:203], v[172:175], v[12:15], v[200:203]
    v_rcp_f32 v231, v231
    v_rcp_f32 v232, v232
    v_rcp_f32 v233, v233
    v_rcp_f32 v234, v234
    v_rcp_f32 v235, v235
    v_pk_mul_f32 v[204:205], v[220:221], v[204:205]
    v_pk_mul_f32 v[206:207], v[222:223], v[206:207]
    v_pk_mul_f32 v[208:209], v[224:225], v[208:209]
    v_pk_mul_f32 v[210:211], v[226:227], v[210:211]
    v_pk_mul_f32 v[212:213], v[228:229], v[212:213]
    v_pk_mul_f32 v[214:215], v[230:231], v[214:215]
    v_pk_mul_f32 v[216:217], v[232:233], v[216:217]
    v_pk_mul_f32 v[218:219], v[234:235], v[218:219]
    s_cmp_lt_u32 s16, s17
    s_cbranch_scc1 L_LOOP0
    s_branch L_LT0
L_LT0:
    s_cmp_lg_u32 s99, 0
    s_cbranch_scc1 L_LH0
    s_setprio 0
    v_smfmac_f32_16x16x64_bf16 v[152:155], v[184:187], v[204:211], v255
    ds_read_u16 v236, v251 offset:0
    ds_read_u16 v237, v251 offset:16
    v_exp_f32 v188, v188
    v_smfmac_f32_16x16x64_bf16 v[156:159], v[184:187], v[212:219], v255
    v_exp_f32 v189, v189
    v_mfma_f32_16x16x32_bf16 v[204:207], v[160:163], v[32:35], 0
    v_exp_f32 v190, v190
    v_mfma_f32_16x16x32_bf16 v[212:215], v[160:163], v[40:43], 0
    v_exp_f32 v191, v191
    v_mfma_f32_16x16x32_bf16 v[208:211], v[168:171], v[32:35], 0
    v_exp_f32 v192, v192
    v_mfma_f32_16x16x32_bf16 v[216:219], v[168:171], v[40:43], 0
    v_exp_f32 v193, v193
    v_mfma_f32_16x16x32_bf16 v[204:207], v[164:167], v[36:39], v[204:207]
    v_exp_f32 v194, v194
    v_mfma_f32_16x16x32_bf16 v[212:215], v[164:167], v[44:47], v[212:215]
    v_exp_f32 v195, v195
    v_mfma_f32_16x16x32_bf16 v[208:211], v[172:175], v[36:39], v[208:211]
    v_exp_f32 v196, v196
    v_mfma_f32_16x16x32_bf16 v[216:219], v[172:175], v[44:47], v[216:219]
    v_exp_f32 v197, v197
    v_smfmac_f32_16x16x64_bf16 v[136:139], v[184:187], v[220:227], v255
    s_waitcnt lgkmcnt(0)
    v_bfi_b32 v236, 31, v246, v236
    v_bfi_b32 v237, 31, v246, v237
    v_exp_f32 v198, v198
    s_setprio 3
    v_smfmac_f32_16x16x64_bf16 v[140:143], v[184:187], v[228:235], v255
    v_exp_f32 v199, v199
    v_exp_f32 v200, v200
    v_exp_f32 v201, v201
    v_exp_f32 v202, v202
    v_exp_f32 v203, v203
    v_pk_add_f32 v[188:189], v[188:189], 1.0 op_sel_hi:[1,0]
    v_pk_add_f32 v[190:191], v[190:191], 1.0 op_sel_hi:[1,0]
    v_pk_add_f32 v[192:193], v[192:193], 1.0 op_sel_hi:[1,0]
    v_pk_add_f32 v[194:195], v[194:195], 1.0 op_sel_hi:[1,0]
    v_pk_add_f32 v[196:197], v[196:197], 1.0 op_sel_hi:[1,0]
    v_pk_add_f32 v[198:199], v[198:199], 1.0 op_sel_hi:[1,0]
    v_pk_add_f32 v[200:201], v[200:201], 1.0 op_sel_hi:[1,0]
    v_pk_add_f32 v[202:203], v[202:203], 1.0 op_sel_hi:[1,0]
    s_setprio 0
    v_mfma_f32_16x16x32_bf16 v[220:223], v[176:179], v[72:75], 0
    ds_read_b64_tr_b16 v[184:185], v236
    ds_read_b64_tr_b16 v[186:187], v237
    v_rcp_f32 v188, v188
    v_mfma_f32_16x16x32_bf16 v[228:231], v[176:179], v[76:79], 0
    v_rcp_f32 v189, v189
    v_mfma_f32_16x16x32_bf16 v[224:227], v[180:183], v[72:75], 0
    v_rcp_f32 v190, v190
    v_mfma_f32_16x16x32_bf16 v[232:235], v[180:183], v[76:79], 0
    v_rcp_f32 v191, v191
    v_mfma_f32_16x16x32_bf16 v[220:223], v[160:163], v[16:19], v[220:223]
    v_rcp_f32 v192, v192
    v_mfma_f32_16x16x32_bf16 v[228:231], v[160:163], v[24:27], v[228:231]
    v_rcp_f32 v193, v193
    v_mfma_f32_16x16x32_bf16 v[224:227], v[168:171], v[16:19], v[224:227]
    v_rcp_f32 v194, v194
    v_mfma_f32_16x16x32_bf16 v[232:235], v[168:171], v[24:27], v[232:235]
    v_rcp_f32 v195, v195
    v_mfma_f32_16x16x32_bf16 v[220:223], v[164:167], v[20:23], v[220:223]
    v_rcp_f32 v196, v196
    v_mfma_f32_16x16x32_bf16 v[228:231], v[164:167], v[28:31], v[228:231]
    v_rcp_f32 v197, v197
    v_mfma_f32_16x16x32_bf16 v[224:227], v[172:175], v[20:23], v[224:227]
    v_rcp_f32 v198, v198
    s_setprio 3
    v_mfma_f32_16x16x32_bf16 v[232:235], v[172:175], v[28:31], v[232:235]
    v_rcp_f32 v199, v199
    v_rcp_f32 v200, v200
    v_rcp_f32 v201, v201
    v_rcp_f32 v202, v202
    v_rcp_f32 v203, v203
    v_pk_mul_f32 v[204:205], v[188:189], v[204:205]
    v_pk_mul_f32 v[206:207], v[190:191], v[206:207]
    v_pk_mul_f32 v[208:209], v[192:193], v[208:209]
    v_pk_mul_f32 v[210:211], v[194:195], v[210:211]
    v_pk_mul_f32 v[212:213], v[196:197], v[212:213]
    v_pk_mul_f32 v[214:215], v[198:199], v[214:215]
    v_pk_mul_f32 v[216:217], v[200:201], v[216:217]
    v_pk_mul_f32 v[218:219], v[202:203], v[218:219]
    s_setprio 0
    s_waitcnt lgkmcnt(0)
    v_smfmac_f32_16x16x64_bf16 v[112:115], v[184:187], v[204:211], v255
    v_exp_f32 v220, v220
    v_smfmac_f32_16x16x64_bf16 v[116:119], v[184:187], v[212:219], v255
    v_exp_f32 v221, v221
    v_mfma_f32_16x16x32_bf16 v[204:207], v[160:163], v[48:51], 0
    v_exp_f32 v222, v222
    v_mfma_f32_16x16x32_bf16 v[212:215], v[160:163], v[56:59], 0
    v_exp_f32 v223, v223
    v_mfma_f32_16x16x32_bf16 v[208:211], v[168:171], v[48:51], 0
    v_exp_f32 v224, v224
    v_mfma_f32_16x16x32_bf16 v[216:219], v[168:171], v[56:59], 0
    v_exp_f32 v225, v225
    v_mfma_f32_16x16x32_bf16 v[204:207], v[164:167], v[52:55], v[204:207]
    v_exp_f32 v226, v226
    v_mfma_f32_16x16x32_bf16 v[212:215], v[164:167], v[60:63], v[212:215]
    v_exp_f32 v227, v227
    v_mfma_f32_16x16x32_bf16 v[208:211], v[172:175], v[52:55], v[208:211]
    v_exp_f32 v228, v228
    v_mfma_f32_16x16x32_bf16 v[216:219], v[172:175], v[60:63], v[216:219]
    v_exp_f32 v229, v229
    v_smfmac_f32_16x16x64_bf16 v[96:99], v[184:187], v[188:195], v255
    v_exp_f32 v230, v230
    s_setprio 3
    v_smfmac_f32_16x16x64_bf16 v[100:103], v[184:187], v[196:203], v255
    v_exp_f32 v231, v231
    v_exp_f32 v232, v232
    v_exp_f32 v233, v233
    v_exp_f32 v234, v234
    v_exp_f32 v235, v235
    v_pk_add_f32 v[220:221], v[220:221], 1.0 op_sel_hi:[1,0]
    v_pk_add_f32 v[222:223], v[222:223], 1.0 op_sel_hi:[1,0]
    v_pk_add_f32 v[224:225], v[224:225], 1.0 op_sel_hi:[1,0]
    v_pk_add_f32 v[226:227], v[226:227], 1.0 op_sel_hi:[1,0]
    v_pk_add_f32 v[228:229], v[228:229], 1.0 op_sel_hi:[1,0]
    v_pk_add_f32 v[230:231], v[230:231], 1.0 op_sel_hi:[1,0]
    v_pk_add_f32 v[232:233], v[232:233], 1.0 op_sel_hi:[1,0]
    v_pk_add_f32 v[234:235], v[234:235], 1.0 op_sel_hi:[1,0]
    s_setprio 0
    v_rcp_f32 v220, v220
    v_rcp_f32 v221, v221
    v_rcp_f32 v222, v222
    v_rcp_f32 v223, v223
    v_rcp_f32 v224, v224
    v_rcp_f32 v225, v225
    v_rcp_f32 v226, v226
    v_rcp_f32 v227, v227
    v_rcp_f32 v228, v228
    v_rcp_f32 v229, v229
    v_rcp_f32 v230, v230
    v_rcp_f32 v231, v231
    v_rcp_f32 v232, v232
    v_rcp_f32 v233, v233
    v_rcp_f32 v234, v234
    v_rcp_f32 v235, v235
    v_pk_mul_f32 v[204:205], v[220:221], v[204:205]
    v_pk_mul_f32 v[206:207], v[222:223], v[206:207]
    v_pk_mul_f32 v[208:209], v[224:225], v[208:209]
    v_pk_mul_f32 v[210:211], v[226:227], v[210:211]
    v_pk_mul_f32 v[212:213], v[228:229], v[212:213]
    v_pk_mul_f32 v[214:215], v[230:231], v[214:215]
    v_pk_mul_f32 v[216:217], v[232:233], v[216:217]
    v_pk_mul_f32 v[218:219], v[234:235], v[218:219]
    v_smfmac_f32_16x16x64_bf16 v[104:107], v[184:187], v[220:227], v255
    v_smfmac_f32_16x16x64_bf16 v[108:111], v[184:187], v[228:235], v255
    v_smfmac_f32_16x16x64_bf16 v[120:123], v[184:187], v[204:211], v255
    v_smfmac_f32_16x16x64_bf16 v[124:127], v[184:187], v[212:219], v255
    s_branch L_DONE
L_LH0:
    s_setprio 0
    v_smfmac_f32_16x16x64_bf16 v[152:155], v[184:187], v[204:211], v255
    ds_read_u16 v236, v251 offset:0
    ds_read_u16 v237, v251 offset:16
    v_smfmac_f32_16x16x64_bf16 v[156:159], v[184:187], v[212:219], v255
    v_exp_f32 v188, v188
    v_mfma_f32_16x16x32_bf16 v[204:207], v[160:163], v[32:35], 0
    v_mfma_f32_16x16x32_bf16 v[212:215], v[160:163], v[40:43], 0
    v_exp_f32 v189, v189
    v_mfma_f32_16x16x32_bf16 v[204:207], v[164:167], v[36:39], v[204:207]
    v_mfma_f32_16x16x32_bf16 v[212:215], v[164:167], v[44:47], v[212:215]
    v_exp_f32 v190, v190
    v_smfmac_f32_16x16x64_bf16 v[136:139], v[184:187], v[220:227], v255
    s_waitcnt lgkmcnt(0)
    v_bfi_b32 v236, 31, v246, v236
    v_bfi_b32 v237, 31, v246, v237
    v_exp_f32 v191, v191
    s_setprio 3
    v_smfmac_f32_16x16x64_bf16 v[140:143], v[184:187], v[228:235], v255
    v_exp_f32 v196, v196
    v_exp_f32 v197, v197
    v_exp_f32 v198, v198
    v_exp_f32 v199, v199
    v_pk_add_f32 v[188:189], v[188:189], 1.0 op_sel_hi:[1,0]
    v_pk_add_f32 v[190:191], v[190:191], 1.0 op_sel_hi:[1,0]
    v_pk_add_f32 v[196:197], v[196:197], 1.0 op_sel_hi:[1,0]
    v_pk_add_f32 v[198:199], v[198:199], 1.0 op_sel_hi:[1,0]
    s_setprio 0
    v_mfma_f32_16x16x32_bf16 v[220:223], v[176:179], v[72:75], 0
    ds_read_b64_tr_b16 v[184:185], v236
    ds_read_b64_tr_b16 v[186:187], v237
    v_mfma_f32_16x16x32_bf16 v[228:231], v[176:179], v[76:79], 0
    v_rcp_f32 v188, v188
    v_mfma_f32_16x16x32_bf16 v[220:223], v[160:163], v[16:19], v[220:223]
    v_rcp_f32 v189, v189
    v_mfma_f32_16x16x32_bf16 v[228:231], v[160:163], v[24:27], v[228:231]
    v_rcp_f32 v190, v190
    v_mfma_f32_16x16x32_bf16 v[220:223], v[164:167], v[20:23], v[220:223]
    v_rcp_f32 v191, v191
    s_setprio 3
    v_mfma_f32_16x16x32_bf16 v[228:231], v[164:167], v[28:31], v[228:231]
    v_rcp_f32 v196, v196
    v_rcp_f32 v197, v197
    v_rcp_f32 v198, v198
    v_rcp_f32 v199, v199
    v_pk_mul_f32 v[204:205], v[188:189], v[204:205]
    v_pk_mul_f32 v[206:207], v[190:191], v[206:207]
    v_pk_mul_f32 v[212:213], v[196:197], v[212:213]
    v_pk_mul_f32 v[214:215], v[198:199], v[214:215]
    s_setprio 0
    s_waitcnt lgkmcnt(0)
    v_smfmac_f32_16x16x64_bf16 v[112:115], v[184:187], v[204:211], v255
    v_smfmac_f32_16x16x64_bf16 v[116:119], v[184:187], v[212:219], v255
    v_exp_f32 v220, v220
    v_mfma_f32_16x16x32_bf16 v[204:207], v[160:163], v[48:51], 0
    v_mfma_f32_16x16x32_bf16 v[212:215], v[160:163], v[56:59], 0
    v_exp_f32 v221, v221
    v_mfma_f32_16x16x32_bf16 v[204:207], v[164:167], v[52:55], v[204:207]
    v_mfma_f32_16x16x32_bf16 v[212:215], v[164:167], v[60:63], v[212:215]
    v_exp_f32 v222, v222
    v_smfmac_f32_16x16x64_bf16 v[96:99], v[184:187], v[188:195], v255
    v_exp_f32 v223, v223
    s_setprio 3
    v_smfmac_f32_16x16x64_bf16 v[100:103], v[184:187], v[196:203], v255
    v_exp_f32 v228, v228
    v_exp_f32 v229, v229
    v_exp_f32 v230, v230
    v_exp_f32 v231, v231
    v_pk_add_f32 v[220:221], v[220:221], 1.0 op_sel_hi:[1,0]
    v_pk_add_f32 v[222:223], v[222:223], 1.0 op_sel_hi:[1,0]
    v_pk_add_f32 v[228:229], v[228:229], 1.0 op_sel_hi:[1,0]
    v_pk_add_f32 v[230:231], v[230:231], 1.0 op_sel_hi:[1,0]
    s_setprio 0
    v_rcp_f32 v220, v220
    v_rcp_f32 v221, v221
    v_rcp_f32 v222, v222
    v_rcp_f32 v223, v223
    v_rcp_f32 v228, v228
    v_rcp_f32 v229, v229
    v_rcp_f32 v230, v230
    v_rcp_f32 v231, v231
    v_pk_mul_f32 v[204:205], v[220:221], v[204:205]
    v_pk_mul_f32 v[206:207], v[222:223], v[206:207]
    v_pk_mul_f32 v[212:213], v[228:229], v[212:213]
    v_pk_mul_f32 v[214:215], v[230:231], v[214:215]
    v_smfmac_f32_16x16x64_bf16 v[104:107], v[184:187], v[220:227], v255
    v_smfmac_f32_16x16x64_bf16 v[108:111], v[184:187], v[228:235], v255
    v_smfmac_f32_16x16x64_bf16 v[120:123], v[184:187], v[204:211], v255
    v_smfmac_f32_16x16x64_bf16 v[124:127], v[184:187], v[212:219], v255
    s_branch L_DONE
L_LT1:
    s_cmp_lg_u32 s99, 0
    s_cbranch_scc1 L_LH1
    s_setprio 0
    v_smfmac_f32_16x16x64_bf16 v[120:123], v[184:187], v[204:211], v255
    ds_read_u16 v236, v251 offset:1152
    ds_read_u16 v237, v251 offset:1168
    v_exp_f32 v188, v188
    v_smfmac_f32_16x16x64_bf16 v[124:127], v[184:187], v[212:219], v255
    v_exp_f32 v189, v189
    v_mfma_f32_16x16x32_bf16 v[204:207], v[160:163], v[32:35], 0
    v_exp_f32 v190, v190
    v_mfma_f32_16x16x32_bf16 v[212:215], v[160:163], v[40:43], 0
    v_exp_f32 v191, v191
    v_mfma_f32_16x16x32_bf16 v[208:211], v[168:171], v[32:35], 0
    v_exp_f32 v192, v192
    v_mfma_f32_16x16x32_bf16 v[216:219], v[168:171], v[40:43], 0
    v_exp_f32 v193, v193
    v_mfma_f32_16x16x32_bf16 v[204:207], v[164:167], v[36:39], v[204:207]
    v_exp_f32 v194, v194
    v_mfma_f32_16x16x32_bf16 v[212:215], v[164:167], v[44:47], v[212:215]
    v_exp_f32 v195, v195
    v_mfma_f32_16x16x32_bf16 v[208:211], v[172:175], v[36:39], v[208:211]
    v_exp_f32 v196, v196
    v_mfma_f32_16x16x32_bf16 v[216:219], v[172:175], v[44:47], v[216:219]
    v_exp_f32 v197, v197
    v_smfmac_f32_16x16x64_bf16 v[104:107], v[184:187], v[220:227], v255
    s_waitcnt lgkmcnt(0)
    v_bfi_b32 v236, 31, v246, v236
    v_bfi_b32 v237, 31, v246, v237
    v_exp_f32 v198, v198
    s_setprio 3
    v_smfmac_f32_16x16x64_bf16 v[108:111], v[184:187], v[228:235], v255
    v_exp_f32 v199, v199
    v_exp_f32 v200, v200
    v_exp_f32 v201, v201
    v_exp_f32 v202, v202
    v_exp_f32 v203, v203
    v_pk_add_f32 v[188:189], v[188:189], 1.0 op_sel_hi:[1,0]
    v_pk_add_f32 v[190:191], v[190:191], 1.0 op_sel_hi:[1,0]
    v_pk_add_f32 v[192:193], v[192:193], 1.0 op_sel_hi:[1,0]
    v_pk_add_f32 v[194:195], v[194:195], 1.0 op_sel_hi:[1,0]
    v_pk_add_f32 v[196:197], v[196:197], 1.0 op_sel_hi:[1,0]
    v_pk_add_f32 v[198:199], v[198:199], 1.0 op_sel_hi:[1,0]
    v_pk_add_f32 v[200:201], v[200:201], 1.0 op_sel_hi:[1,0]
    v_pk_add_f32 v[202:203], v[202:203], 1.0 op_sel_hi:[1,0]
    s_setprio 0
    v_mfma_f32_16x16x32_bf16 v[220:223], v[176:179], v[88:91], 0
    ds_read_b64_tr_b16 v[184:185], v236
    ds_read_b64_tr_b16 v[186:187], v237
    v_rcp_f32 v188, v188
    v_mfma_f32_16x16x32_bf16 v[228:231], v[176:179], v[92:95], 0
    v_rcp_f32 v189, v189
    v_mfma_f32_16x16x32_bf16 v[224:227], v[180:183], v[88:91], 0
    v_rcp_f32 v190, v190
    v_mfma_f32_16x16x32_bf16 v[232:235], v[180:183], v[92:95], 0
    v_rcp_f32 v191, v191
    v_mfma_f32_16x16x32_bf16 v[220:223], v[160:163], v[16:19], v[220:223]
    v_rcp_f32 v192, v192
    v_mfma_f32_16x16x32_bf16 v[228:231], v[160:163], v[24:27], v[228:231]
    v_rcp_f32 v193, v193
    v_mfma_f32_16x16x32_bf16 v[224:227], v[168:171], v[16:19], v[224:227]
    v_rcp_f32 v194, v194
    v_mfma_f32_16x16x32_bf16 v[232:235], v[168:171], v[24:27], v[232:235]
    v_rcp_f32 v195, v195
    v_mfma_f32_16x16x32_bf16 v[220:223], v[164:167], v[20:23], v[220:223]
    v_rcp_f32 v196, v196
    v_mfma_f32_16x16x32_bf16 v[228:231], v[164:167], v[28:31], v[228:231]
    v_rcp_f32 v197, v197
    v_mfma_f32_16x16x32_bf16 v[224:227], v[172:175], v[20:23], v[224:227]
    v_rcp_f32 v198, v198
    s_setprio 3
    v_mfma_f32_16x16x32_bf16 v[232:235], v[172:175], v[28:31], v[232:235]
    v_rcp_f32 v199, v199
    v_rcp_f32 v200, v200
    v_rcp_f32 v201, v201
    v_rcp_f32 v202, v202
    v_rcp_f32 v203, v203
    v_pk_mul_f32 v[204:205], v[188:189], v[204:205]
    v_pk_mul_f32 v[206:207], v[190:191], v[206:207]
    v_pk_mul_f32 v[208:209], v[192:193], v[208:209]
    v_pk_mul_f32 v[210:211], v[194:195], v[210:211]
    v_pk_mul_f32 v[212:213], v[196:197], v[212:213]
    v_pk_mul_f32 v[214:215], v[198:199], v[214:215]
    v_pk_mul_f32 v[216:217], v[200:201], v[216:217]
    v_pk_mul_f32 v[218:219], v[202:203], v[218:219]
    s_setprio 0
    s_waitcnt lgkmcnt(0)
    v_smfmac_f32_16x16x64_bf16 v[144:147], v[184:187], v[204:211], v255
    v_exp_f32 v220, v220
    v_smfmac_f32_16x16x64_bf16 v[148:151], v[184:187], v[212:219], v255
    v_exp_f32 v221, v221
    v_mfma_f32_16x16x32_bf16 v[204:207], v[160:163], v[48:51], 0
    v_exp_f32 v222, v222
    v_mfma_f32_16x16x32_bf16 v[212:215], v[160:163], v[56:59], 0
    v_exp_f32 v223, v223
    v_mfma_f32_16x16x32_bf16 v[208:211], v[168:171], v[48:51], 0
    v_exp_f32 v224, v224
    v_mfma_f32_16x16x32_bf16 v[216:219], v[168:171], v[56:59], 0
    v_exp_f32 v225, v225
    v_mfma_f32_16x16x32_bf16 v[204:207], v[164:167], v[52:55], v[204:207]
    v_exp_f32 v226, v226
    v_mfma_f32_16x16x32_bf16 v[212:215], v[164:167], v[60:63], v[212:215]
    v_exp_f32 v227, v227
    v_mfma_f32_16x16x32_bf16 v[208:211], v[172:175], v[52:55], v[208:211]
    v_exp_f32 v228, v228
    v_mfma_f32_16x16x32_bf16 v[216:219], v[172:175], v[60:63], v[216:219]
    v_exp_f32 v229, v229
    v_smfmac_f32_16x16x64_bf16 v[128:131], v[184:187], v[188:195], v255
    v_exp_f32 v230, v230
    s_setprio 3
    v_smfmac_f32_16x16x64_bf16 v[132:135], v[184:187], v[196:203], v255
    v_exp_f32 v231, v231
    v_exp_f32 v232, v232
    v_exp_f32 v233, v233
    v_exp_f32 v234, v234
    v_exp_f32 v235, v235
    v_pk_add_f32 v[220:221], v[220:221], 1.0 op_sel_hi:[1,0]
    v_pk_add_f32 v[222:223], v[222:223], 1.0 op_sel_hi:[1,0]
    v_pk_add_f32 v[224:225], v[224:225], 1.0 op_sel_hi:[1,0]
    v_pk_add_f32 v[226:227], v[226:227], 1.0 op_sel_hi:[1,0]
    v_pk_add_f32 v[228:229], v[228:229], 1.0 op_sel_hi:[1,0]
    v_pk_add_f32 v[230:231], v[230:231], 1.0 op_sel_hi:[1,0]
    v_pk_add_f32 v[232:233], v[232:233], 1.0 op_sel_hi:[1,0]
    v_pk_add_f32 v[234:235], v[234:235], 1.0 op_sel_hi:[1,0]
    s_setprio 0
    v_rcp_f32 v220, v220
    v_rcp_f32 v221, v221
    v_rcp_f32 v222, v222
    v_rcp_f32 v223, v223
    v_rcp_f32 v224, v224
    v_rcp_f32 v225, v225
    v_rcp_f32 v226, v226
    v_rcp_f32 v227, v227
    v_rcp_f32 v228, v228
    v_rcp_f32 v229, v229
    v_rcp_f32 v230, v230
    v_rcp_f32 v231, v231
    v_rcp_f32 v232, v232
    v_rcp_f32 v233, v233
    v_rcp_f32 v234, v234
    v_rcp_f32 v235, v235
    v_pk_mul_f32 v[204:205], v[220:221], v[204:205]
    v_pk_mul_f32 v[206:207], v[222:223], v[206:207]
    v_pk_mul_f32 v[208:209], v[224:225], v[208:209]
    v_pk_mul_f32 v[210:211], v[226:227], v[210:211]
    v_pk_mul_f32 v[212:213], v[228:229], v[212:213]
    v_pk_mul_f32 v[214:215], v[230:231], v[214:215]
    v_pk_mul_f32 v[216:217], v[232:233], v[216:217]
    v_pk_mul_f32 v[218:219], v[234:235], v[218:219]
    v_smfmac_f32_16x16x64_bf16 v[136:139], v[184:187], v[220:227], v255
    v_smfmac_f32_16x16x64_bf16 v[140:143], v[184:187], v[228:235], v255
    v_smfmac_f32_16x16x64_bf16 v[152:155], v[184:187], v[204:211], v255
    v_smfmac_f32_16x16x64_bf16 v[156:159], v[184:187], v[212:219], v255
    s_branch L_DONE
L_LH1:
    s_setprio 0
    v_smfmac_f32_16x16x64_bf16 v[120:123], v[184:187], v[204:211], v255
    ds_read_u16 v236, v251 offset:1152
    ds_read_u16 v237, v251 offset:1168
    v_smfmac_f32_16x16x64_bf16 v[124:127], v[184:187], v[212:219], v255
    v_exp_f32 v188, v188
    v_mfma_f32_16x16x32_bf16 v[204:207], v[160:163], v[32:35], 0
    v_mfma_f32_16x16x32_bf16 v[212:215], v[160:163], v[40:43], 0
    v_exp_f32 v189, v189
    v_mfma_f32_16x16x32_bf16 v[204:207], v[164:167], v[36:39], v[204:207]
    v_mfma_f32_16x16x32_bf16 v[212:215], v[164:167], v[44:47], v[212:215]
    v_exp_f32 v190, v190
    v_smfmac_f32_16x16x64_bf16 v[104:107], v[184:187], v[220:227], v255
    s_waitcnt lgkmcnt(0)
    v_bfi_b32 v236, 31, v246, v236
    v_bfi_b32 v237, 31, v246, v237
    v_exp_f32 v191, v191
    s_setprio 3
    v_smfmac_f32_16x16x64_bf16 v[108:111], v[184:187], v[228:235], v255
    v_exp_f32 v196, v196
    v_exp_f32 v197, v197
    v_exp_f32 v198, v198
    v_exp_f32 v199, v199
    v_pk_add_f32 v[188:189], v[188:189], 1.0 op_sel_hi:[1,0]
    v_pk_add_f32 v[190:191], v[190:191], 1.0 op_sel_hi:[1,0]
    v_pk_add_f32 v[196:197], v[196:197], 1.0 op_sel_hi:[1,0]
    v_pk_add_f32 v[198:199], v[198:199], 1.0 op_sel_hi:[1,0]
    s_setprio 0
    v_mfma_f32_16x16x32_bf16 v[220:223], v[176:179], v[88:91], 0
    ds_read_b64_tr_b16 v[184:185], v236
    ds_read_b64_tr_b16 v[186:187], v237
    v_mfma_f32_16x16x32_bf16 v[228:231], v[176:179], v[92:95], 0
    v_rcp_f32 v188, v188
    v_mfma_f32_16x16x32_bf16 v[220:223], v[160:163], v[16:19], v[220:223]
    v_rcp_f32 v189, v189
    v_mfma_f32_16x16x32_bf16 v[228:231], v[160:163], v[24:27], v[228:231]
    v_rcp_f32 v190, v190
    v_mfma_f32_16x16x32_bf16 v[220:223], v[164:167], v[20:23], v[220:223]
    v_rcp_f32 v191, v191
    s_setprio 3
    v_mfma_f32_16x16x32_bf16 v[228:231], v[164:167], v[28:31], v[228:231]
    v_rcp_f32 v196, v196
    v_rcp_f32 v197, v197
    v_rcp_f32 v198, v198
    v_rcp_f32 v199, v199
    v_pk_mul_f32 v[204:205], v[188:189], v[204:205]
    v_pk_mul_f32 v[206:207], v[190:191], v[206:207]
    v_pk_mul_f32 v[212:213], v[196:197], v[212:213]
    v_pk_mul_f32 v[214:215], v[198:199], v[214:215]
    s_setprio 0
    s_waitcnt lgkmcnt(0)
    v_smfmac_f32_16x16x64_bf16 v[144:147], v[184:187], v[204:211], v255
    v_smfmac_f32_16x16x64_bf16 v[148:151], v[184:187], v[212:219], v255
    v_exp_f32 v220, v220
    v_mfma_f32_16x16x32_bf16 v[204:207], v[160:163], v[48:51], 0
    v_mfma_f32_16x16x32_bf16 v[212:215], v[160:163], v[56:59], 0
    v_exp_f32 v221, v221
    v_mfma_f32_16x16x32_bf16 v[204:207], v[164:167], v[52:55], v[204:207]
    v_mfma_f32_16x16x32_bf16 v[212:215], v[164:167], v[60:63], v[212:215]
    v_exp_f32 v222, v222
    v_smfmac_f32_16x16x64_bf16 v[128:131], v[184:187], v[188:195], v255
    v_exp_f32 v223, v223
    s_setprio 3
    v_smfmac_f32_16x16x64_bf16 v[132:135], v[184:187], v[196:203], v255
    v_exp_f32 v228, v228
    v_exp_f32 v229, v229
    v_exp_f32 v230, v230
    v_exp_f32 v231, v231
    v_pk_add_f32 v[220:221], v[220:221], 1.0 op_sel_hi:[1,0]
    v_pk_add_f32 v[222:223], v[222:223], 1.0 op_sel_hi:[1,0]
    v_pk_add_f32 v[228:229], v[228:229], 1.0 op_sel_hi:[1,0]
    v_pk_add_f32 v[230:231], v[230:231], 1.0 op_sel_hi:[1,0]
    s_setprio 0
    v_rcp_f32 v220, v220
    v_rcp_f32 v221, v221
    v_rcp_f32 v222, v222
    v_rcp_f32 v223, v223
    v_rcp_f32 v228, v228
    v_rcp_f32 v229, v229
    v_rcp_f32 v230, v230
    v_rcp_f32 v231, v231
    v_pk_mul_f32 v[204:205], v[220:221], v[204:205]
    v_pk_mul_f32 v[206:207], v[222:223], v[206:207]
    v_pk_mul_f32 v[212:213], v[228:229], v[212:213]
    v_pk_mul_f32 v[214:215], v[230:231], v[214:215]
    v_smfmac_f32_16x16x64_bf16 v[136:139], v[184:187], v[220:227], v255
    v_smfmac_f32_16x16x64_bf16 v[140:143], v[184:187], v[228:235], v255
    v_smfmac_f32_16x16x64_bf16 v[152:155], v[184:187], v[204:211], v255
    v_smfmac_f32_16x16x64_bf16 v[156:159], v[184:187], v[212:219], v255
    s_branch L_DONE
L_DONE:
    v_mbcnt_lo_u32_b32 v247, -1, 0
    v_mbcnt_hi_u32_b32 v247, -1, v247
    v_and_b32 v246, 24, v246
    s_cmp_lg_u32 s19, 0
    s_cbranch_scc1 L_SLOW
L_EPI:
    s_waitcnt lgkmcnt(0)
    v_and_b32 v64, 48, v247
    v_and_b32 v67, 15, v247
    v_add_u32 v69, s72, v64
    v_lshl_add_u32 v70, v67, 2, s72
    ds_read_b128 v[80:83], v69 offset:0
    ds_read_b128 v[84:87], v69 offset:64
    ds_read2_b32 v[72:73], v70 offset0:0 offset1:16
    v_bfe_u32 v65, v247, 2, 3
    v_lshrrev_b32 v66, 5, v247
    v_lshl_add_u32 v65, v66, 4, v65
    v_mul_u32_u24 v65, 160, v65
    s_mov_b32 s10, 143488
    v_add3_u32 v65, v65, v246, s10
    ds_read_b64_tr_b16 v[0:1], v65 offset:0
    ds_read_b64_tr_b16 v[2:3], v65 offset:1280
    ds_read_b64_tr_b16 v[8:9], v65 offset:32
    ds_read_b64_tr_b16 v[10:11], v65 offset:1312
    ds_read_b64_tr_b16 v[16:17], v65 offset:64
    ds_read_b64_tr_b16 v[18:19], v65 offset:1344
    ds_read_b64_tr_b16 v[24:25], v65 offset:96
    ds_read_b64_tr_b16 v[26:27], v65 offset:1376
    ds_read_b64_tr_b16 v[4:5], v65 offset:5120
    ds_read_b64_tr_b16 v[6:7], v65 offset:6400
    ds_read_b64_tr_b16 v[12:13], v65 offset:5152
    ds_read_b64_tr_b16 v[14:15], v65 offset:6432
    s_movk_i32 s10, 832
    v_mad_u32_u24 v64, v246, s10, v64
    s_mov_b32 s10, 116736
    v_lshl_add_u32 v69, v67, 3, s10
    v_lshl_add_u32 v74, v67, 3, s73
    v_lshl_add_u32 v75, v67, 3, s74
    s_waitcnt lgkmcnt(8)
    ds_read_b64_tr_b16 v[20:21], v65 offset:5184
    ds_read_b64_tr_b16 v[22:23], v65 offset:6464
    ds_read_b64_tr_b16 v[28:29], v65 offset:5216
    ds_read_b64_tr_b16 v[30:31], v65 offset:6496
    v_add_u32 v76, v80, v69
    ds_read_b64 v[32:33], v76 offset:0
    v_add_u32 v76, v81, v69
    ds_read_b64 v[34:35], v76 offset:6656
    v_add_u32 v76, v82, v69
    ds_read_b64 v[36:37], v76 offset:13312
    v_add_u32 v76, v83, v69
    ds_read_b64 v[38:39], v76 offset:19968
    v_add_u32 v76, v84, v69
    ds_read_b64 v[40:41], v76 offset:0
    v_add_u32 v76, v85, v69
    ds_read_b64 v[42:43], v76 offset:6656
    v_add_u32 v76, v86, v69
    ds_read_b64 v[44:45], v76 offset:13312
    v_add_u32 v76, v87, v69
    ds_read_b64 v[46:47], v76 offset:19968
    v_add3_u32 v72, v72, v64, s10
    ds_read_b128 v[160:163], v72 offset:0
    ds_read_b128 v[164:167], v72 offset:64
    v_add3_u32 v73, v73, v64, s10
    ds_read_b128 v[168:171], v73 offset:0
    ds_read_b128 v[172:175], v73 offset:64
    s_waitcnt lgkmcnt(0)
    v_lshlrev_b32 v188, 16, v32
    v_lshlrev_b32 v189, 16, v34
    v_lshlrev_b32 v190, 16, v36
    v_lshlrev_b32 v191, 16, v38
    v_and_b32 v192, 0xffff0000, v32
    v_and_b32 v193, 0xffff0000, v34
    v_and_b32 v194, 0xffff0000, v36
    v_and_b32 v195, 0xffff0000, v38
    v_mfma_f32_16x16x32_bf16 v[188:191], v[160:163], v[0:3], v[188:191]
    v_lshlrev_b32 v196, 16, v33
    v_lshlrev_b32 v197, 16, v35
    v_lshlrev_b32 v198, 16, v37
    v_lshlrev_b32 v199, 16, v39
    v_lshl_add_u32 v80, v80, 2, v74
    v_mfma_f32_16x16x32_bf16 v[188:191], v[164:167], v[4:7], v[188:191]
    v_mfma_f32_16x16x32_bf16 v[192:195], v[160:163], v[8:11], v[192:195]
    v_and_b32 v200, 0xffff0000, v33
    v_and_b32 v201, 0xffff0000, v35
    v_and_b32 v202, 0xffff0000, v37
    v_and_b32 v203, 0xffff0000, v39
    v_lshl_add_u32 v81, v81, 2, v74
    v_mfma_f32_16x16x32_bf16 v[192:195], v[164:167], v[12:15], v[192:195]
    v_mfma_f32_16x16x32_bf16 v[196:199], v[160:163], v[16:19], v[196:199]
    v_lshlrev_b32 v48, 16, v40
    v_lshlrev_b32 v49, 16, v42
    v_lshlrev_b32 v50, 16, v44
    v_lshlrev_b32 v51, 16, v46
    v_lshl_add_u32 v82, v82, 2, v74
    v_mfma_f32_16x16x32_bf16 v[196:199], v[164:167], v[20:23], v[196:199]
    v_mfma_f32_16x16x32_bf16 v[200:203], v[160:163], v[24:27], v[200:203]
    v_and_b32 v52, 0xffff0000, v40
    v_and_b32 v53, 0xffff0000, v42
    v_and_b32 v54, 0xffff0000, v44
    v_and_b32 v55, 0xffff0000, v46
    v_lshl_add_u32 v83, v83, 2, v74
    v_mfma_f32_16x16x32_bf16 v[200:203], v[164:167], v[28:31], v[200:203]
    v_mfma_f32_16x16x32_bf16 v[48:51], v[168:171], v[0:3], v[48:51]
    v_lshlrev_b32 v56, 16, v41
    v_lshlrev_b32 v57, 16, v43
    v_lshlrev_b32 v58, 16, v45
    v_lshlrev_b32 v59, 16, v47
    v_lshl_add_u32 v84, v84, 2, v75
    v_mfma_f32_16x16x32_bf16 v[48:51], v[172:175], v[4:7], v[48:51]
    v_mfma_f32_16x16x32_bf16 v[52:55], v[168:171], v[8:11], v[52:55]
    v_and_b32 v60, 0xffff0000, v41
    v_and_b32 v61, 0xffff0000, v43
    v_and_b32 v62, 0xffff0000, v45
    v_and_b32 v63, 0xffff0000, v47
    v_lshl_add_u32 v85, v85, 2, v75
    v_mfma_f32_16x16x32_bf16 v[52:55], v[172:175], v[12:15], v[52:55]
    v_mfma_f32_16x16x32_bf16 v[56:59], v[168:171], v[16:19], v[56:59]
    v_lshl_add_u32 v86, v86, 2, v75
    v_mfma_f32_16x16x32_bf16 v[56:59], v[172:175], v[20:23], v[56:59]
    v_mfma_f32_16x16x32_bf16 v[60:63], v[168:171], v[24:27], v[60:63]
    v_lshl_add_u32 v87, v87, 2, v75
    v_mfma_f32_16x16x32_bf16 v[60:63], v[172:175], v[28:31], v[60:63]
L_EPB:
    s_setprio 0
    s_mov_b64 exec, s[76:77]
    s_and_b32 s11, s25, 19
    s_nop 2
    s_cmp_eq_u32 s11, 0
    s_cbranch_scc1 L_NS0
    s_cmp_eq_u32 s11, 1
    s_cbranch_scc1 L_NS1
    s_cmp_eq_u32 s11, 2
    s_cbranch_scc1 L_NS2
    s_cmp_eq_u32 s11, 3
    s_cbranch_scc1 L_NS3
L_NSR:
    s_mov_b64 exec, -1
    v_rcp_f32 v96, v96
    v_rcp_f32 v97, v97
    v_rcp_f32 v98, v98
    v_rcp_f32 v99, v99
    v_rcp_f32 v100, v100
    v_rcp_f32 v101, v101
    v_rcp_f32 v102, v102
    v_rcp_f32 v103, v103
    v_rcp_f32 v104, v104
    v_rcp_f32 v105, v105
    v_rcp_f32 v106, v106
    v_rcp_f32 v107, v107
    v_rcp_f32 v108, v108
    v_rcp_f32 v109, v109
    v_rcp_f32 v110, v110
    v_rcp_f32 v111, v111
    v_pk_fma_f32 v[112:113], v[112:113], v[96:97], v[188:189]
    v_pk_fma_f32 v[114:115], v[114:115], v[98:99], v[190:191]
    v_pk_fma_f32 v[116:117], v[116:117], v[100:101], v[192:193]
    v_pk_fma_f32 v[118:119], v[118:119], v[102:103], v[194:195]
    v_pk_fma_f32 v[120:121], v[120:121], v[104:105], v[196:197]
    v_pk_fma_f32 v[122:123], v[122:123], v[106:107], v[198:199]
    v_pk_fma_f32 v[124:125], v[124:125], v[108:109], v[200:201]
    v_pk_fma_f32 v[126:127], v[126:127], v[110:111], v[202:203]
    v_cvt_pk_bf16_f32 v96, v112, v116
    v_cvt_pk_bf16_f32 v97, v120, v124
    v_pk_max_f16 v96, v96, v32
    v_pk_max_f16 v97, v97, v33
    buffer_store_dwordx2 v[96:97], v80, s[48:51], 0 offen sc1
    v_cvt_pk_bf16_f32 v98, v113, v117
    v_cvt_pk_bf16_f32 v99, v121, v125
    v_pk_max_f16 v98, v98, v34
    v_pk_max_f16 v99, v99, v35
    buffer_store_dwordx2 v[98:99], v81, s[48:51], 0 offen sc1
    v_cvt_pk_bf16_f32 v100, v114, v118
    v_cvt_pk_bf16_f32 v101, v122, v126
    v_pk_max_f16 v100, v100, v36
    v_pk_max_f16 v101, v101, v37
    buffer_store_dwordx2 v[100:101], v82, s[48:51], 0 offen sc1
    v_cvt_pk_bf16_f32 v102, v115, v119
    v_cvt_pk_bf16_f32 v103, v123, v127
    v_pk_max_f16 v102, v102, v38
    v_pk_max_f16 v103, v103, v39
    buffer_store_dwordx2 v[102:103], v83, s[48:51], 0 offen sc1
    v_rcp_f32 v128, v128
    v_rcp_f32 v129, v129
    v_rcp_f32 v130, v130
    v_rcp_f32 v131, v131
    v_rcp_f32 v132, v132
    v_rcp_f32 v133, v133
    v_rcp_f32 v134, v134
    v_rcp_f32 v135, v135
    v_rcp_f32 v136, v136
    v_rcp_f32 v137, v137
    v_rcp_f32 v138, v138
    v_rcp_f32 v139, v139
    v_rcp_f32 v140, v140
    v_rcp_f32 v141, v141
    v_rcp_f32 v142, v142
    v_rcp_f32 v143, v143
    v_pk_fma_f32 v[144:145], v[144:145], v[128:129], v[48:49]
    v_pk_fma_f32 v[146:147], v[146:147], v[130:131], v[50:51]
    v_pk_fma_f32 v[148:149], v[148:149], v[132:133], v[52:53]
    v_pk_fma_f32 v[150:151], v[150:151], v[134:135], v[54:55]
    v_pk_fma_f32 v[152:153], v[152:153], v[136:137], v[56:57]
    v_pk_fma_f32 v[154:155], v[154:155], v[138:139], v[58:59]
    v_pk_fma_f32 v[156:157], v[156:157], v[140:141], v[60:61]
    v_pk_fma_f32 v[158:159], v[158:159], v[142:143], v[62:63]
    v_cvt_pk_bf16_f32 v128, v144, v148
    v_cvt_pk_bf16_f32 v129, v152, v156
    v_pk_max_f16 v128, v128, v40
    v_pk_max_f16 v129, v129, v41
    buffer_store_dwordx2 v[128:129], v84, s[60:63], 0 offen sc1
    v_cvt_pk_bf16_f32 v130, v145, v149
    v_cvt_pk_bf16_f32 v131, v153, v157
    v_pk_max_f16 v130, v130, v42
    v_pk_max_f16 v131, v131, v43
    buffer_store_dwordx2 v[130:131], v85, s[60:63], 0 offen sc1
    v_cvt_pk_bf16_f32 v132, v146, v150
    v_cvt_pk_bf16_f32 v133, v154, v158
    v_pk_max_f16 v132, v132, v44
    v_pk_max_f16 v133, v133, v45
    buffer_store_dwordx2 v[132:133], v86, s[60:63], 0 offen sc1
    v_cvt_pk_bf16_f32 v134, v147, v151
    v_cvt_pk_bf16_f32 v135, v155, v159
    v_pk_max_f16 v134, v134, v46
    v_pk_max_f16 v135, v135, v47
    buffer_store_dwordx2 v[134:135], v87, s[60:63], 0 offen sc1
L_END:
    s_endpgm
L_NS0:
    v_add_f32 v96, v96, v128
    v_add_f32 v100, v100, v132
    v_add_f32 v104, v104, v136
    v_add_f32 v108, v108, v140
    v_add_f32 v112, v112, v144
    v_add_f32 v116, v116, v148
    v_add_f32 v120, v120, v152
    v_add_f32 v124, v124, v156
    s_branch L_NSR
L_NS1:
    v_add_f32 v97, v97, v129
    v_add_f32 v101, v101, v133
    v_add_f32 v105, v105, v137
    v_add_f32 v109, v109, v141
    v_add_f32 v113, v113, v145
    v_add_f32 v117, v117, v149
    v_add_f32 v121, v121, v153
    v_add_f32 v125, v125, v157
    s_branch L_NSR
L_NS2:
    v_add_f32 v98, v98, v130
    v_add_f32 v102, v102, v134
    v_add_f32 v106, v106, v138
    v_add_f32 v110, v110, v142
    v_add_f32 v114, v114, v146
    v_add_f32 v118, v118, v150
    v_add_f32 v122, v122, v154
    v_add_f32 v126, v126, v158
    s_branch L_NSR
L_NS3:
    v_add_f32 v99, v99, v131
    v_add_f32 v103, v103, v135
    v_add_f32 v107, v107, v139
    v_add_f32 v111, v111, v143
    v_add_f32 v115, v115, v147
    v_add_f32 v119, v119, v151
    v_add_f32 v123, v123, v155
    v_add_f32 v127, v127, v159
    s_branch L_NSR
L_RT0:
    s_waitcnt vmcnt(0)
    s_add_u32 s100, s100, 1
    s_cmp_gt_u32 s100, 200000
    s_cbranch_scc1 L_END
    s_sleep 1
    buffer_load_dwordx4 v[128:131], v232, s[56:59], s26 offen sc1
    buffer_load_dwordx4 v[132:135], v232, s[56:59], s27 offen sc1
    buffer_load_dwordx4 v[136:139], v232, s[56:59], s28 offen sc1
    buffer_load_dwordx4 v[140:143], v232, s[56:59], s29 offen sc1
    s_waitcnt vmcnt(0)
    s_branch L_PW0
L_RT1:
    s_waitcnt vmcnt(0)
    s_add_u32 s100, s100, 1
    s_cmp_gt_u32 s100, 200000
    s_cbranch_scc1 L_END
    s_sleep 1
    buffer_load_dwordx4 v[132:135], v232, s[56:59], s27 offen sc1
    buffer_load_dwordx4 v[136:139], v232, s[56:59], s28 offen sc1
    buffer_load_dwordx4 v[140:143], v232, s[56:59], s29 offen sc1
    s_waitcnt vmcnt(0)
    s_branch L_PW1
L_RT2:
    s_waitcnt vmcnt(0)
    s_add_u32 s100, s100, 1
    s_cmp_gt_u32 s100, 200000
    s_cbranch_scc1 L_END
    s_sleep 1
    buffer_load_dwordx4 v[136:139], v232, s[56:59], s28 offen sc1
    buffer_load_dwordx4 v[140:143], v232, s[56:59], s29 offen sc1
    s_waitcnt vmcnt(0)
    s_branch L_PW2
L_RT3:
    s_waitcnt vmcnt(0)
    s_add_u32 s100, s100, 1
    s_cmp_gt_u32 s100, 200000
    s_cbranch_scc1 L_END
    s_sleep 1
    buffer_load_dwordx4 v[140:143], v232, s[56:59], s29 offen sc1
    s_waitcnt vmcnt(0)
    s_branch L_PW3
L_XT2B:
    s_add_u32 s100, s100, 1
    s_cmp_gt_u32 s100, 200000
    s_cbranch_scc1 L_END
    s_sleep 1
    s_mov_b64 exec, s[70:71]
    s_cbranch_execz L_XLb0
    s_movk_i32 s10, 0
    buffer_load_dwordx4 v[64:67], v232, s[60:63], s10 offen sc1
L_XLb0:
    s_mov_b64 exec, s[78:79]
    s_cbranch_execz L_XLb1
    s_movk_i32 s10, 8192
    buffer_load_dwordx4 v[68:71], v232, s[60:63], s10 offen sc1
L_XLb1:
    s_mov_b64 exec, s[86:87]
    s_cbranch_execz L_XLb2
    s_movk_i32 s10, 16384
    buffer_load_dwordx4 v[72:75], v232, s[60:63], s10 offen sc1
L_XLb2:
    s_mov_b64 exec, s[94:95]
    s_cbranch_execz L_XLb3
    s_movk_i32 s10, 24576
    buffer_load_dwordx4 v[76:79], v232, s[60:63], s10 offen sc1
L_XLb3:
    s_mov_b64 exec, -1
    s_waitcnt vmcnt(0)
    s_branch L_XT2
L_OVF:
    s_mov_b32 s20, 0
    s_mov_b32 s17, 0
    s_mov_b32 s30, 0
    s_mov_b32 s19, 4
    s_waitcnt lgkmcnt(0)
    s_branch L_CA
L_POVF:
    s_movk_i32 s11, 1986
    v_mul_u32_u24 v64, s11, v192
    v_lshrrev_b32 v64, 16, v64
    v_mul_u32_u24 v65, s11, v193
    v_lshrrev_b32 v65, 16, v65
    v_mul_u32_u24 v66, s11, v194
    v_lshrrev_b32 v66, 16, v66
    v_mul_u32_u24 v67, s11, v195
    v_lshrrev_b32 v67, 16, v67
    v_add_u32 v69, v64, v65
    v_add_u32 v70, v69, v66
    v_add_u32 v71, v70, v67
    v_mov_b32 v72, v71
    s_nop 1
    v_add_u32_dpp v72, v72, v72 row_shr:1 row_mask:0xf bank_mask:0xf bound_ctrl:0
    s_nop 1
    v_add_u32_dpp v72, v72, v72 row_shr:2 row_mask:0xf bank_mask:0xf bound_ctrl:0
    s_nop 1
    v_add_u32_dpp v72, v72, v72 row_shr:4 row_mask:0xf bank_mask:0xf bound_ctrl:0
    s_nop 1
    v_add_u32_dpp v72, v72, v72 row_shr:8 row_mask:0xf bank_mask:0xf bound_ctrl:0
    s_nop 1
    v_add_u32_dpp v72, v72, v72 row_bcast:15 row_mask:0xa bank_mask:0xf
    s_nop 1
    v_add_u32_dpp v72, v72, v72 row_bcast:31 row_mask:0xc bank_mask:0xf
    s_nop 0
    v_sub_u32 v68, v72, v71
    v_add_u32 v71, v68, v70
    v_add_u32 v70, v68, v69
    v_add_u32 v69, v68, v64
    v_lshl_or_b32 v68, v64, 16, v68
    v_lshl_or_b32 v69, v65, 16, v69
    v_lshl_or_b32 v70, v66, 16, v70
    v_lshl_or_b32 v71, v67, 16, v71
    v_add_u32 v72, 154752, v185
    ds_write_b128 v72, v[68:71]
    s_lshl_b32 s10, s2, 10
    s_add_u32 s10, s10, 24772608
    buffer_store_dwordx4 v[68:71], v185, s[52:55], s10 offen sc1
    v_and_b32 v74, 0x3fc, v136
    v_add_u32 v74, 154752, v74
    ds_read_u16 v74, v74
    v_and_b32 v75, 0x3fc, v137
    v_add_u32 v75, 154752, v75
    ds_read_u16 v75, v75
    v_and_b32 v76, 0x3fc, v138
    v_add_u32 v76, 154752, v76
    ds_read_u16 v76, v76
    v_and_b32 v77, 0x3fc, v139
    v_add_u32 v77, 154752, v77
    ds_read_u16 v77, v77
    v_and_b32 v78, 0x3fc, v140
    v_add_u32 v78, 154752, v78
    ds_read_u16 v78, v78
    v_and_b32 v79, 0x3fc, v141
    v_add_u32 v79, 154752, v79
    ds_read_u16 v79, v79
    v_and_b32 v80, 0x3fc, v142
    v_add_u32 v80, 154752, v80
    ds_read_u16 v80, v80
    v_and_b32 v81, 0x3fc, v143
    v_add_u32 v81, 154752, v81
    ds_read_u16 v81, v81
    s_waitcnt lgkmcnt(0)
    v_cmpx_lt_u32 vcc, 1056, v228
    v_or_b32 v205, 0x10000, v205
    s_mov_b64 exec, -1
    v_cmpx_lt_u32 vcc, 1056, v229
    v_or_b32 v209, 0x10000, v209
    s_mov_b64 exec, -1
    v_cmpx_lt_u32 vcc, 1056, v230
    v_or_b32 v213, 0x10000, v213
    s_mov_b64 exec, -1
    v_cmpx_lt_u32 vcc, 1056, v231
    v_or_b32 v217, 0x10000, v217
    s_mov_b64 exec, -1
    s_mul_i32 s10, s2, 4152
    s_mov_b32 s34, 18874368
    s_mov_b32 s35, 23592960
    v_mul_u32_u24 v64, s11, v112
    v_lshrrev_b32 v64, 16, v64
    v_add3_u32 v64, v64, v74, s10
    v_lshlrev_b32 v65, 2, v64
    v_cmpx_le_u32 vcc, 1056, v112
    s_cbranch_execz L_PO0
    buffer_store_byte v120, v64, s[52:55], s35 offen sc1
    buffer_store_dword v96, v65, s[52:55], s34 offen sc1
L_PO0:
    s_mov_b64 exec, -1
    v_mul_u32_u24 v64, s11, v113
    v_lshrrev_b32 v64, 16, v64
    v_add3_u32 v64, v64, v75, s10
    v_lshlrev_b32 v65, 2, v64
    v_cmpx_le_u32 vcc, 1056, v113
    s_cbranch_execz L_PO1
    buffer_store_byte v121, v64, s[52:55], s35 offen sc1
    buffer_store_dword v97, v65, s[52:55], s34 offen sc1
L_PO1:
    s_mov_b64 exec, -1
    v_mul_u32_u24 v64, s11, v114
    v_lshrrev_b32 v64, 16, v64
    v_add3_u32 v64, v64, v76, s10
    v_lshlrev_b32 v65, 2, v64
    v_cmpx_le_u32 vcc, 1056, v114
    s_cbranch_execz L_PO2
    buffer_store_byte v122, v64, s[52:55], s35 offen sc1
    buffer_store_dword v98, v65, s[52:55], s34 offen sc1
L_PO2:
    s_mov_b64 exec, -1
    v_mul_u32_u24 v64, s11, v115
    v_lshrrev_b32 v64, 16, v64
    v_add3_u32 v64, v64, v77, s10
    v_lshlrev_b32 v65, 2, v64
    v_cmpx_le_u32 vcc, 1056, v115
    s_cbranch_execz L_PO3
    buffer_store_byte v123, v64, s[52:55], s35 offen sc1
    buffer_store_dword v99, v65, s[52:55], s34 offen sc1
L_PO3:
    s_mov_b64 exec, -1
    v_mul_u32_u24 v64, s11, v116
    v_lshrrev_b32 v64, 16, v64
    v_add3_u32 v64, v64, v78, s10
    v_lshlrev_b32 v65, 2, v64
    v_cmpx_le_u32 vcc, 1056, v116
    s_cbranch_execz L_PO4
    buffer_store_byte v120, v64, s[52:55], s35 offen sc1
    buffer_store_dword v100, v65, s[52:55], s34 offen sc1
L_PO4:
    s_mov_b64 exec, -1
    v_mul_u32_u24 v64, s11, v117
    v_lshrrev_b32 v64, 16, v64
    v_add3_u32 v64, v64, v79, s10
    v_lshlrev_b32 v65, 2, v64
    v_cmpx_le_u32 vcc, 1056, v117
    s_cbranch_execz L_PO5
    buffer_store_byte v121, v64, s[52:55], s35 offen sc1
    buffer_store_dword v101, v65, s[52:55], s34 offen sc1
L_PO5:
    s_mov_b64 exec, -1
    v_mul_u32_u24 v64, s11, v118
    v_lshrrev_b32 v64, 16, v64
    v_add3_u32 v64, v64, v80, s10
    v_lshlrev_b32 v65, 2, v64
    v_cmpx_le_u32 vcc, 1056, v118
    s_cbranch_execz L_PO6
    buffer_store_byte v122, v64, s[52:55], s35 offen sc1
    buffer_store_dword v102, v65, s[52:55], s34 offen sc1
L_PO6:
    s_mov_b64 exec, -1
    v_mul_u32_u24 v64, s11, v119
    v_lshrrev_b32 v64, 16, v64
    v_add3_u32 v64, v64, v81, s10
    v_lshlrev_b32 v65, 2, v64
    v_cmpx_le_u32 vcc, 1056, v119
    s_cbranch_execz L_PO7
    buffer_store_byte v123, v64, s[52:55], s35 offen sc1
    buffer_store_dword v103, v65, s[52:55], s34 offen sc1
L_PO7:
    s_mov_b64 exec, -1
    s_waitcnt vmcnt(0) lgkmcnt(0)
    s_barrier
    s_branch L_POUT
L_SLOW:
    s_setprio 0
    s_lshl_b32 s10, s3, 6
    v_add_u32 v255, s10, v247
    s_cmp_lg_u32 s19, 4
    s_cbranch_scc1 L_SL1
    s_mov_b32 s19, 1
    v_and_b32 v188, 0xff, v255
    v_lshlrev_b32 v189, 7, v188
    buffer_load_dword v190, v189, s[56:59], 0 offen offset:4 sc1
    v_lshlrev_b32 v189, 10, v188
    s_lshl_b32 s10, s5, 2
    s_add_u32 s10, s10, 24772608
    buffer_load_dword v191, v189, s[52:55], s10 offen sc1
    v_lshlrev_b32 v188, 2, v188
    v_add_u32 v188, 154752, v188
    s_waitcnt vmcnt(0)
    v_and_b32 v190, 0x10000, v190
    v_cmp_ne_u32 vcc, 0, v190
    v_mov_b32 v190, 2097152
    s_nop 0
    v_cndmask_b32 v190, v190, v191, vcc
    ds_write_b32 v188, v190
    s_waitcnt lgkmcnt(0)
    s_barrier
L_SL1:
    s_add_u32 s28, s28, 288
    s_cmp_lt_u32 s28, s29
    s_cbranch_scc1 L_BATCH
L_FIND:
    s_cmp_lg_u64 s[32:33], 0
    s_cbranch_scc1 L_GOT
    s_add_u32 s26, s26, 1
    s_cmp_ge_u32 s26, 4
    s_cbranch_scc1 L_EPI
    s_lshl_b32 s10, s26, 8
    s_add_u32 s10, s10, 154752
    v_lshl_add_u32 v188, v247, 2, s10
    ds_read_u16 v188, v188 offset:2
    s_waitcnt lgkmcnt(0)
    v_cmp_lt_u32 s[32:33], s20, v188
    s_nop 3
    s_branch L_FIND
L_GOT:
    s_ff1_i32_b64 s10, s[32:33]
    s_bitset0_b64 s[32:33], s10
    s_lshl_b32 s11, s26, 6
    s_add_u32 s27, s10, s11
    s_lshl_b32 s10, s27, 2
    s_add_u32 s10, s10, 154752
    v_mov_b32 v188, s10
    ds_read_b32 v188, v188
    s_waitcnt lgkmcnt(0)
    v_readfirstlane_b32 s10, v188
    s_nop 3
    s_lshr_b32 s29, s10, 16
    s_and_b32 s30, s10, 0xffff
    s_mov_b32 s28, s20
L_BATCH:
    s_waitcnt vmcnt(0)
    s_barrier
    v_mov_b32 v192, 0x2000000
    v_mov_b32 v193, 0x2000000
    v_mov_b32 v194, 0x2000000
    v_mov_b32 v195, 0x2000000
    v_mov_b32 v196, 0xfffff
    v_mov_b32 v197, 0xfffff
    v_mov_b32 v198, 0xfffff
    v_mov_b32 v199, 0xfffff
    v_lshl_add_u32 v200, v247, 4, s12
    ds_write_b128 v200, v[192:195] offset:0
    ds_write_b128 v200, v[196:199] offset:18432
    ds_write_b128 v200, v[192:195] offset:1024
    ds_write_b128 v200, v[196:199] offset:19456
    ds_write_b128 v200, v[192:195] offset:1280
    ds_write_b128 v200, v[196:199] offset:19712
    v_and_b32 v188, 15, v247
    v_mul_u32_u24 v189, 1152, v188
    v_add_u32 v189, 8192, v189
    v_lshlrev_b32 v188, 2, v188
    ds_write_b32 v188, v189 offset:576
    v_add_u32 v188, s28, v255
    s_mul_i32 s36, s27, 3128
    s_mul_i32 s11, s27, 4152
    s_add_u32 s11, s11, s30
    s_lshl_b32 s34, s11, 2
    s_add_u32 s34, s34, 18874368
    v_lshl_add_u32 v190, v188, 2, s34
    s_add_u32 s34, s11, 23592960
    v_add_u32 v191, s34, v188
    s_mul_i32 s10, s5, 32896
    s_lshl_b32 s34, s27, 7
    s_add_u32 s10, s10, s34
    s_add_u32 s10, s10, 65536
    v_and_b32 v206, 7, v188
    v_lshl_add_u32 v206, v206, 4, s10
    v_lshrrev_b32 v207, 3, v188
    v_cmpx_gt_u32 vcc, 32, v188
    v_add_u32 v190, 8421376, v206
    v_add_u32 v191, 8, v190
    v_cmpx_gt_u32 vcc, 24, v188
    v_lshl_add_u32 v190, v207, 2, v206
    v_add3_u32 v191, v206, v207, 12
    s_mov_b64 exec, -1
    s_add_u32 s10, s28, 288
    s_min_u32 s10, s10, s29
    v_cmp_gt_u32 vcc, s10, v188
    v_mov_b32 v206, 0x7ffffff0
    s_nop 0
    v_cndmask_b32 v190, v206, v190, vcc
    v_cndmask_b32 v191, v206, v191, vcc
    buffer_load_dwordx2 v[204:205], v190, s[52:55], 0 offen sc1
    buffer_load_ubyte v191, v191, s[52:55], 0 offen sc1
    s_waitcnt lgkmcnt(0)
    s_barrier
    s_waitcnt vmcnt(0)
    v_cmp_ne_u32 vcc, 3, v207
    v_cmp_eq_u32 s[10:11], s6, v205
    v_mov_b32 v206, s36
    s_or_b64 exec, vcc, s[10:11]
    v_cmpx_ne_u32 vcc, 0, v204
    v_bfe_u32 v190, v204, 18, 8
    v_lshlrev_b32 v190, 2, v190
    v_add_u32 v188, 153728, v190
    ds_read_b32 v188, v188
    v_add_u32_sdwa v191, v191, v206 dst_sel:DWORD dst_unused:UNUSED_PAD src0_sel:BYTE_0 src1_sel:DWORD
    v_lshrrev_b32 v189, 28, v204
    v_lshl_add_u32 v191, v189, 8, v191
    v_and_b32 v189, 60, v190
    v_and_b32 v204, 0xffff, v204
    v_lshl_or_b32 v204, v189, 19, v204
    v_mov_b32 v190, 4
    s_waitcnt lgkmcnt(0)
    ds_add_rtn_u32 v188, v188, v190 offset:576
    s_waitcnt lgkmcnt(0)
    ds_write2st64_b32 v188, v204, v191 offset0:148 offset1:220
    s_mov_b64 exec, -1
    s_waitcnt lgkmcnt(0)
    s_barrier
    v_lshrrev_b32 v190, 3, v247
    v_lshl_add_u32 v248, v190, 4, s12
    s_add_u32 s10, s12, 18432
    v_lshrrev_b32 v190, 1, v247
    v_lshl_add_u32 v249, v190, 2, s10
    s_add_u32 s10, s10, 2
    v_lshrrev_b32 v190, 5, v247
    v_mul_i32_i24 v250, 0xffffb800, v190
    v_and_b32 v190, 15, v247
    v_lshl_add_u32 v250, v190, 2, v250
    v_add_u32 v250, s10, v250
    s_add_u32 s10, s12, 2
    v_and_b32 v190, 48, v247
    v_lshl_add_u32 v251, v190, 1, s10
    v_and_b32 v190, 12, v247
    v_add_u32 v251, v251, v190
    ds_read_b128 v[236:239], v248
    ds_read_b32 v240, v249
    s_lshl_b32 s10, s4, 3
    v_mov_b32 v190, s10
    ds_read_b64 v[190:191], v190 offset:576
    s_waitcnt lgkmcnt(0)
    v_readfirstlane_b32 s34, v190
    v_readfirstlane_b32 s35, v191
    s_sub_u32 s10, s12, 37888
    s_sub_u32 s34, s34, s10
    s_sub_u32 s35, s35, s10
    s_sub_u32 s35, s35, 1152
    s_add_u32 s10, s34, 127
    s_lshr_b32 s10, s10, 7
    s_lshl1_add_u32 s10, s10, -1
    s_add_u32 s11, s35, 127
    s_lshr_b32 s11, s11, 6
    s_and_b32 s11, s11, -2
    s_max_i32 s17, s10, s11
    s_cselect_b32 s10, s34, s35
    s_sub_u32 s10, s10, 1
    s_andn2_b32 s99, 64, s10
    v_mov_b64 v[204:205], 0
    v_mov_b64 v[206:207], 0
    v_mov_b64 v[184:185], 0
    v_mov_b64 v[186:187], 0
    s_add_u32 m0, s13, 0
    v_mad_u32_u16 v236, v236, s15, v243
    buffer_load_dwordx4 v236, s[40:43], 0 offen lds
    s_add_u32 m0, s13, 1056
    v_mad_u32_u16 v237, v237, s15, v243
    buffer_load_dwordx4 v237, s[40:43], 0 offen lds
    s_add_u32 m0, s13, 2112
    v_mad_u32_u16 v238, v238, s15, v243
    buffer_load_dwordx4 v238, s[40:43], 0 offen lds
    s_add_u32 m0, s13, 3168
    v_mad_u32_u16 v239, v239, s15, v243
    buffer_load_dwordx4 v239, s[40:43], 0 offen lds
    s_mov_b32 m0, s14
    s_nop 0
    buffer_load_dwordx4 v[240:241], s[44:47], 0 idxen offen lds
L_LAST:
    s_branch L_GO
.section .rodata,"a"
.p2align 6
.amdhsa_kernel standalone__edge_featured_mpnn_gatedgcn__graph_kernel
  .amdhsa_next_free_vgpr 256
  .amdhsa_next_free_sgpr 102
  .amdhsa_accum_offset 256
  .amdhsa_group_segment_fixed_size 0
  .amdhsa_kernarg_size 96
  .amdhsa_user_sgpr_count 2
  .amdhsa_user_sgpr_kernarg_segment_ptr 1
  .amdhsa_system_sgpr_workgroup_id_x 1
.end_amdhsa_kernel
```

```asm
; @launch grid=(256,1,1) block=(512,1,1) lds=158848
.amdgcn_target "amdgcn-amd-amdhsa--gfx950"
.text
.globl standalone__edge_featured_mpnn_gatedgcn__graph_kernel
.p2align 8
.type standalone__edge_featured_mpnn_gatedgcn__graph_kernel,@function
standalone__edge_featured_mpnn_gatedgcn__graph_kernel:
    s_load_dwordx16 s[16:31], s[0:1], 0
    s_load_dwordx8 s[32:39], s[0:1], 64
    s_getpc_b64 s[64:65]
L_PC:
    s_and_b32 s3, s2, -8
    v_add_lshl_u32 v1, v0, s3, 7
    v_min_u32 v1, L_LAST-L_PC, v1
    v_cmpx_gt_u32 vcc, 8, v0
    s_cbranch_execz L_NOCPF
    global_load_dword v252, v1, s[64:65]
L_NOCPF:
    s_mov_b64 exec, -1
    s_cmp_ge_u32 s2, 256
    s_cbranch_scc1 L_END
    s_mul_i32 s10, s2, 12512
    v_lshl_add_u32 v1, v0, 4, s10
    s_add_u32 s11, s10, 12512
    s_min_u32 s11, s11, 3200000
    v_add_u32 v2, 0x2000, v1
    s_waitcnt lgkmcnt(0)
    global_load_dwordx4 v[128:131], v1, s[22:23] nt
    global_load_dwordx4 v[96:99], v1, s[20:21] nt
    v_cmpx_gt_u32 s[70:71], s11, v2
    s_cbranch_execz L_NO8
    global_load_dwordx4 v[132:135], v2, s[22:23] nt
    global_load_dwordx4 v[100:103], v2, s[20:21] nt
L_NO8:
    s_mov_b64 exec, -1
L_NO7:
    s_mov_b64 exec, -1
    s_load_dword s6, s[38:39], 0
    v_mov_b32 v255, v0
    v_lshrrev_b32 v188, 6, v0
    v_and_b32 v247, 63, v0
    v_readfirstlane_b32 s3, v188
    v_lshlrev_b32 v232, 4, v0
    v_lshlrev_b32 v190, 3, v0
    v_lshlrev_b32 v191, 2, v0
    v_and_b32 v192, 0x3fc, v191
    s_and_b32 s5, s2, 7
    s_lshr_b32 s4, s2, 3
    s_lshl_b32 s5, s5, 5
    s_add_u32 s5, s5, s4
    s_mul_i32 s9, s5, 196
    s_cmp_eq_u32 s3, 7
    s_cselect_b32 s101, 0, s3
    s_lshl_b32 s12, s101, 5
    s_add_u32 s9, s9, s12
    v_lshrrev_b32 v193, 3, v247
    v_lshl_add_u32 v193, v193, 2, s9
    v_and_b32 v243, 7, v247
    v_lshlrev_b32 v243, 4, v243
    v_lshl_add_u32 v234, v193, 7, v243
    s_lshl_b32 s101, s101, 10
    s_add_u32 s101, s101, 116736
    v_mov_b64 v[196:197], 0
    v_mov_b64 v[198:199], 0
    v_mov_b32 v194, 132
    ds_write2st64_b32 v192, v194, v196 offset0:20 offset1:24
    v_add_u32 v193, 46080, v232
    ds_write_b128 v193, v[196:199] offset:0
    ds_write_b128 v193, v[196:199] offset:8192
    ds_write_b128 v193, v[196:199] offset:16384
    ds_write_b128 v193, v[196:199] offset:24576
    ds_write_b128 v193, v[196:199] offset:32768
    s_mov_b32 s44, s18
    s_or_b32 s45, s19, 0x200000
    s_mov_b32 s46, 800000
    s_mov_b32 s47, 0x20000
    s_mov_b32 s48, s34
    s_mov_b32 s49, s35
    s_mov_b32 s50, 6400000
    s_mov_b32 s51, 0x20000
    s_mov_b32 s40, s16
    s_mov_b32 s41, s17
    s_mov_b32 s42, 6400000
    s_mov_b32 s43, 0x20000
    s_mov_b32 s52, s38
    s_mov_b32 s53, s39
    s_mov_b32 s54, 25165824
    s_mov_b32 s55, 0x20000
    s_lshl_b32 s12, s2, 7
    s_add_u32 s12, s12, 65536
    s_add_u32 s56, s38, s12
    s_addc_u32 s57, s39, 0
    s_mov_b32 s58, 16809984
    s_mov_b32 s59, 0x20000
    s_mov_b32 s64, 85599
    s_mov_b32 s65, 4294967100
    s_movk_i32 s66, 5368
    s_mov_b32 s67, 0xc000000
    s_mov_b32 s68, 32896
    s_mov_b32 s100, 0xffeff220
    v_add_u32 v120, 0, v191
    v_add_u32 v121, 1, v191
    v_add_u32 v122, 2, v191
    v_add_u32 v123, 3, v191
    s_lshl_b32 s10, s3, 28
    s_or_b32 s10, s10, 0x20000
    v_mov_b32 v144, s10
    v_or_b32 v145, 0x80000000, v144
    v_mov_b32 v184, 33
    v_mov_b32 v146, 0x400
    s_and_b32 s10, s3, 3
    s_lshr_b32 s4, s3, 2
    s_lshl1_add_u32 s4, s10, s4
    s_xor_b32 s4, s4, 1
    s_mul_i32 s10, s4, 49
    s_sub_i32 s10, s10, 6
    s_ashr_i32 s10, s10, 1
    s_max_i32 s7, s10, 0
    s_mul_i32 s13, s4, 4224
    s_add_u32 s13, s13, 82944
    s_lshl_b32 s14, s4, 10
    s_add_u32 s14, s14, 5120
    s_mul_i32 s12, s4, 2304
    s_add_u32 s12, s12, 46080
    s_movk_i32 s15, 128
    v_bfe_u32 v194, v255, 4, 4
    v_and_b32 v195, 7, v255
    v_cmp_eq_u32 vcc, v194, v195
    v_and_b32 v194, 8, v255
    v_lshlrev_b32 v194, 1, v194
    v_mov_b32 v196, 0x3f80
    v_lshlrev_b32 v196, v194, v196
    v_cndmask_b32 v196, 0, v196, vcc
    ds_write_b32 v192, v196 offset:0
    v_mov_b64 v[196:197], 0
    ds_write_b64 v190, v[196:197] offset:1024
    v_add_u32 v194, 155776, v191
    ds_write_b32 v194, v196
    v_lshrrev_b32 v223, 3, v255
    v_mul_u32_u24 v224, 160, v223
    v_mad_u32_u24 v220, v223, s68, v243
    v_add_u32 v221, v224, v243
    v_add_u32 v221, 46080, v221
    v_bfe_u32 v194, v255, 5, 1
    v_bfe_u32 v196, v255, 6, 1
    v_sub_u32 v194, v194, v196
    v_mul_i32_i24 v194, 640, v194
    v_add_u32 v224, v224, v194
    v_lshl_add_u32 v224, v195, 2, v224
    v_add_u32 v224, 13312, v224
    v_lshlrev_b32 v185, 4, v247
    v_and_b32 v194, 3, v247
    v_lshlrev_b32 v246, 3, v194
    v_bfe_u32 v197, v247, 2, 3
    v_lshrrev_b32 v196, 5, v247
    v_lshl_add_u32 v197, v196, 4, v197
    v_mul_u32_u24 v225, 160, v197
    v_add_u32 v225, v225, v246
    s_movk_i32 s69, 11520
    v_mov_b64 v[116:117], 0
    v_mov_b64 v[118:119], 0
    s_waitcnt lgkmcnt(0)
    s_barrier
    s_cmp_eq_u64 s[70:71], 0
    s_cbranch_scc1 L_R4
    s_waitcnt vmcnt(3)
    v_mul_u32_u24 v104, s64, v128
    v_mul_u32_u24 v105, s64, v129
    v_mul_u32_u24 v106, s64, v130
    v_mul_u32_u24 v107, s64, v131
    v_lshrrev_b32 v136, 29, v104
    v_lshrrev_b32 v137, 29, v105
    v_lshrrev_b32 v138, 29, v106
    v_lshrrev_b32 v139, 29, v107
    v_cmp_eq_u32 s[72:73], v136, v137
    v_cmp_eq_u32 s[76:77], v138, v139
    v_cmp_eq_u32 vcc, v136, v138
    v_cmp_eq_u32 s[88:89], v137, v139
    v_cmp_eq_u32 s[90:91], v136, v139
    v_cmp_eq_u32 s[10:11], v137, v138
    v_lshrrev_b32 v104, 24, v104
    v_lshrrev_b32 v105, 24, v105
    v_lshrrev_b32 v106, 24, v106
    v_lshrrev_b32 v107, 24, v107
    s_or_b64 s[74:75], s[72:73], s[88:89]
    s_or_b64 s[78:79], s[76:77], s[88:89]
    s_or_b64 s[72:73], s[72:73], vcc
    s_or_b64 s[76:77], s[76:77], vcc
    s_or_b64 s[72:73], s[72:73], s[90:91]
    s_or_b64 s[74:75], s[74:75], s[10:11]
    s_or_b64 s[76:77], s[76:77], s[10:11]
    s_or_b64 s[78:79], s[78:79], s[90:91]
    v_cndmask_b32 v136, 0, v146, s[72:73]
    v_lshl_add_u32 v136, v104, 2, v136
    ds_add_rtn_u32 v112, v136, v184 offset:5120
    v_cndmask_b32 v137, 0, v146, s[74:75]
    v_lshl_add_u32 v137, v105, 2, v137
    ds_add_rtn_u32 v113, v137, v184 offset:5120
    v_cndmask_b32 v138, 0, v146, s[76:77]
    v_lshl_add_u32 v138, v106, 2, v138
    ds_add_rtn_u32 v114, v138, v184 offset:5120
    v_cndmask_b32 v139, 0, v146, s[78:79]
    v_lshl_add_u32 v139, v107, 2, v139
    ds_add_rtn_u32 v115, v139, v184 offset:5120
    s_waitcnt vmcnt(1)
    s_mov_b64 exec, s[70:71]
    v_mul_u32_u24 v108, s64, v132
    v_mul_u32_u24 v109, s64, v133
    v_mul_u32_u24 v110, s64, v134
    v_mul_u32_u24 v111, s64, v135
    v_lshrrev_b32 v108, 24, v108
    v_lshrrev_b32 v109, 24, v109
    v_lshrrev_b32 v110, 24, v110
    v_lshrrev_b32 v111, 24, v111
    v_lshlrev_b32 v140, 2, v108
    ds_add_rtn_u32 v116, v140, v184 offset:5120
    v_lshlrev_b32 v141, 2, v109
    ds_add_rtn_u32 v117, v141, v184 offset:5120
    v_lshlrev_b32 v142, 2, v110
    ds_add_rtn_u32 v118, v142, v184 offset:5120
    v_lshlrev_b32 v143, 2, v111
    ds_add_rtn_u32 v119, v143, v184 offset:5120
    s_waitcnt lgkmcnt(7)
    s_mov_b64 exec, s[72:73]
    v_cmpx_le_u32 vcc, 132, v112
    ds_add_rtn_u32 v112, v136, v184 offset:4096
    s_waitcnt lgkmcnt(7)
    s_mov_b64 exec, s[74:75]
    v_cmpx_le_u32 vcc, 132, v113
    ds_add_rtn_u32 v113, v137, v184 offset:4096
    s_waitcnt lgkmcnt(7)
    s_mov_b64 exec, s[76:77]
    v_cmpx_le_u32 vcc, 132, v114
    ds_add_rtn_u32 v114, v138, v184 offset:4096
    s_waitcnt lgkmcnt(7)
    s_mov_b64 exec, s[78:79]
    v_cmpx_le_u32 vcc, 132, v115
    ds_add_rtn_u32 v115, v139, v184 offset:4096
    s_mov_b64 exec, s[70:71]
    s_waitcnt vmcnt(0)
    v_mad_i32_i24 v132, v108, s65, v132
    v_mul_u32_u24 v194, s66, v100
    v_lshl_or_b32 v100, v132, 18, v100
    v_and_b32 v132, 0xe0, v108
    v_mad_i32_i24 v194, v132, s100, v194
    v_and_or_b32 v194, v194, s67, v145
    v_mad_u32_u24 v132, v108, 40, s69
    v_or_b32 v100, v100, v194
    v_mad_i32_i24 v133, v109, s65, v133
    v_mul_u32_u24 v194, s66, v101
    v_lshl_or_b32 v101, v133, 18, v101
    v_and_b32 v133, 0xe0, v109
    v_mad_i32_i24 v194, v133, s100, v194
    v_and_or_b32 v194, v194, s67, v145
    v_mad_u32_u24 v133, v109, 40, s69
    v_or_b32 v101, v101, v194
    v_mad_i32_i24 v134, v110, s65, v134
    v_mul_u32_u24 v194, s66, v102
    v_lshl_or_b32 v102, v134, 18, v102
    v_and_b32 v134, 0xe0, v110
    v_mad_i32_i24 v194, v134, s100, v194
    v_and_or_b32 v194, v194, s67, v145
    v_mad_u32_u24 v134, v110, 40, s69
    v_or_b32 v102, v102, v194
    v_mad_i32_i24 v135, v111, s65, v135
    v_mul_u32_u24 v194, s66, v103
    v_lshl_or_b32 v103, v135, 18, v103
    v_and_b32 v135, 0xe0, v111
    v_mad_i32_i24 v194, v135, s100, v194
    v_and_or_b32 v194, v194, s67, v145
    v_mad_u32_u24 v135, v111, 40, s69
    v_or_b32 v103, v103, v194
    s_waitcnt lgkmcnt(7)
    v_bfe_u32 v194, v116, 3, 5
    v_add_lshl_u32 v132, v194, v132, 2
    v_and_b32 v194, 3, v194
    v_mad_i32_i24 v194, v194, -3, v132
    v_cmpx_gt_u32 vcc, 792, v116
    ds_write_b32 v132, v100
    ds_write_b8 v194, v120 offset:12
    s_mov_b64 exec, s[70:71]
    s_waitcnt lgkmcnt(8)
    v_bfe_u32 v194, v117, 3, 5
    v_add_lshl_u32 v133, v194, v133, 2
    v_and_b32 v194, 3, v194
    v_mad_i32_i24 v194, v194, -3, v133
    v_cmpx_gt_u32 vcc, 792, v117
    ds_write_b32 v133, v101
    ds_write_b8 v194, v121 offset:12
    s_mov_b64 exec, s[70:71]
    s_waitcnt lgkmcnt(9)
    v_bfe_u32 v194, v118, 3, 5
    v_add_lshl_u32 v134, v194, v134, 2
    v_and_b32 v194, 3, v194
    v_mad_i32_i24 v194, v194, -3, v134
    v_cmpx_gt_u32 vcc, 792, v118
    ds_write_b32 v134, v102
    ds_write_b8 v194, v122 offset:12
    s_mov_b64 exec, s[70:71]
    s_waitcnt lgkmcnt(10)
    v_bfe_u32 v194, v119, 3, 5
    v_add_lshl_u32 v135, v194, v135, 2
    v_and_b32 v194, 3, v194
    v_mad_i32_i24 v194, v194, -3, v135
    v_cmpx_gt_u32 vcc, 792, v119
    ds_write_b32 v135, v103
    ds_write_b8 v194, v123 offset:12
    s_mov_b64 exec, -1
    v_mad_i32_i24 v128, v104, s65, v128
    v_mul_u32_u24 v194, s66, v96
    v_lshl_or_b32 v96, v128, 18, v96
    v_and_b32 v128, 0xe0, v104
    v_mad_i32_i24 v194, v128, s100, v194
    v_and_or_b32 v194, v194, s67, v144
    v_mad_u32_u24 v128, v104, 40, s69
    v_or_b32 v96, v96, v194
    v_mad_i32_i24 v129, v105, s65, v129
    v_mul_u32_u24 v194, s66, v97
    v_lshl_or_b32 v97, v129, 18, v97
    v_and_b32 v129, 0xe0, v105
    v_mad_i32_i24 v194, v129, s100, v194
    v_and_or_b32 v194, v194, s67, v144
    v_mad_u32_u24 v129, v105, 40, s69
    v_or_b32 v97, v97, v194
    v_mad_i32_i24 v130, v106, s65, v130
    v_mul_u32_u24 v194, s66, v98
    v_lshl_or_b32 v98, v130, 18, v98
    v_and_b32 v130, 0xe0, v106
    v_mad_i32_i24 v194, v130, s100, v194
    v_and_or_b32 v194, v194, s67, v144
    v_mad_u32_u24 v130, v106, 40, s69
    v_or_b32 v98, v98, v194
    v_mad_i32_i24 v131, v107, s65, v131
    v_mul_u32_u24 v194, s66, v99
    v_lshl_or_b32 v99, v131, 18, v99
    v_and_b32 v131, 0xe0, v107
    v_mad_i32_i24 v194, v131, s100, v194
    v_and_or_b32 v194, v194, s67, v144
    v_mad_u32_u24 v131, v107, 40, s69
    v_or_b32 v99, v99, v194
    s_waitcnt lgkmcnt(11)
    v_bfe_u32 v194, v112, 3, 5
    v_add_lshl_u32 v128, v194, v128, 2
    v_and_b32 v194, 3, v194
    v_mad_i32_i24 v194, v194, -3, v128
    v_cmpx_gt_u32 vcc, 792, v112
    ds_write_b32 v128, v96
    ds_write_b8 v194, v120 offset:12
    s_mov_b64 exec, -1
    s_waitcnt lgkmcnt(12)
    v_bfe_u32 v194, v113, 3, 5
    v_add_lshl_u32 v129, v194, v129, 2
    v_and_b32 v194, 3, v194
    v_mad_i32_i24 v194, v194, -3, v129
    v_cmpx_gt_u32 vcc, 792, v113
    ds_write_b32 v129, v97
    ds_write_b8 v194, v121 offset:12
    s_mov_b64 exec, -1
    s_waitcnt lgkmcnt(13)
    v_bfe_u32 v194, v114, 3, 5
    v_add_lshl_u32 v130, v194, v130, 2
    v_and_b32 v194, 3, v194
    v_mad_i32_i24 v194, v194, -3, v130
    v_cmpx_gt_u32 vcc, 792, v114
    ds_write_b32 v130, v98
    ds_write_b8 v194, v122 offset:12
    s_mov_b64 exec, -1
    s_waitcnt lgkmcnt(14)
    v_bfe_u32 v194, v115, 3, 5
    v_add_lshl_u32 v131, v194, v131, 2
    v_and_b32 v194, 3, v194
    v_mad_i32_i24 v194, v194, -3, v131
    v_cmpx_gt_u32 vcc, 792, v115
    ds_write_b32 v131, v99
    ds_write_b8 v194, v123 offset:12
    s_mov_b64 exec, -1
    s_branch L_B1
L_R4:
    s_waitcnt vmcnt(1)
    v_mul_u32_u24 v104, s64, v128
    v_mul_u32_u24 v105, s64, v129
    v_mul_u32_u24 v106, s64, v130
    v_mul_u32_u24 v107, s64, v131
    v_lshrrev_b32 v136, 29, v104
    v_lshrrev_b32 v137, 29, v105
    v_lshrrev_b32 v138, 29, v106
    v_lshrrev_b32 v139, 29, v107
    v_cmp_eq_u32 s[72:73], v136, v137
    v_cmp_eq_u32 s[76:77], v138, v139
    v_cmp_eq_u32 vcc, v136, v138
    v_cmp_eq_u32 s[88:89], v137, v139
    v_cmp_eq_u32 s[90:91], v136, v139
    v_cmp_eq_u32 s[10:11], v137, v138
    v_lshrrev_b32 v104, 24, v104
    v_lshrrev_b32 v105, 24, v105
    v_lshrrev_b32 v106, 24, v106
    v_lshrrev_b32 v107, 24, v107
    s_or_b64 s[74:75], s[72:73], s[88:89]
    s_or_b64 s[78:79], s[76:77], s[88:89]
    s_or_b64 s[72:73], s[72:73], vcc
    s_or_b64 s[76:77], s[76:77], vcc
    s_or_b64 s[72:73], s[72:73], s[90:91]
    s_or_b64 s[74:75], s[74:75], s[10:11]
    s_or_b64 s[76:77], s[76:77], s[10:11]
    s_or_b64 s[78:79], s[78:79], s[90:91]
    v_cndmask_b32 v136, 0, v146, s[72:73]
    v_lshl_add_u32 v136, v104, 2, v136
    ds_add_rtn_u32 v112, v136, v184 offset:5120
    v_cndmask_b32 v137, 0, v146, s[74:75]
    v_lshl_add_u32 v137, v105, 2, v137
    ds_add_rtn_u32 v113, v137, v184 offset:5120
    v_cndmask_b32 v138, 0, v146, s[76:77]
    v_lshl_add_u32 v138, v106, 2, v138
    ds_add_rtn_u32 v114, v138, v184 offset:5120
    v_cndmask_b32 v139, 0, v146, s[78:79]
    v_lshl_add_u32 v139, v107, 2, v139
    ds_add_rtn_u32 v115, v139, v184 offset:5120
    s_waitcnt vmcnt(0)
    v_mad_i32_i24 v128, v104, s65, v128
    v_mul_u32_u24 v194, s66, v96
    v_lshl_or_b32 v96, v128, 18, v96
    v_and_b32 v128, 0xe0, v104
    v_mad_i32_i24 v194, v128, s100, v194
    v_and_or_b32 v194, v194, s67, v144
    v_mad_u32_u24 v128, v104, 40, s69
    v_or_b32 v96, v96, v194
    v_mad_i32_i24 v129, v105, s65, v129
    v_mul_u32_u24 v194, s66, v97
    v_lshl_or_b32 v97, v129, 18, v97
    v_and_b32 v129, 0xe0, v105
    v_mad_i32_i24 v194, v129, s100, v194
    v_and_or_b32 v194, v194, s67, v144
    v_mad_u32_u24 v129, v105, 40, s69
    v_or_b32 v97, v97, v194
    s_waitcnt lgkmcnt(3)
    s_mov_b64 exec, s[72:73]
    v_cmpx_le_u32 vcc, 132, v112
    ds_add_rtn_u32 v112, v136, v184 offset:4096
    s_waitcnt lgkmcnt(3)
    s_mov_b64 exec, s[74:75]
    v_cmpx_le_u32 vcc, 132, v113
    ds_add_rtn_u32 v113, v137, v184 offset:4096
    s_waitcnt lgkmcnt(3)
    s_mov_b64 exec, s[76:77]
    v_cmpx_le_u32 vcc, 132, v114
    ds_add_rtn_u32 v114, v138, v184 offset:4096
    s_waitcnt lgkmcnt(3)
    s_mov_b64 exec, s[78:79]
    v_cmpx_le_u32 vcc, 132, v115
    ds_add_rtn_u32 v115, v139, v184 offset:4096
    s_mov_b64 exec, -1
    v_mad_i32_i24 v130, v106, s65, v130
    v_mul_u32_u24 v194, s66, v98
    v_lshl_or_b32 v98, v130, 18, v98
    v_and_b32 v130, 0xe0, v106
    v_mad_i32_i24 v194, v130, s100, v194
    v_and_or_b32 v194, v194, s67, v144
    v_mad_u32_u24 v130, v106, 40, s69
    v_or_b32 v98, v98, v194
    v_mad_i32_i24 v131, v107, s65, v131
    v_mul_u32_u24 v194, s66, v99
    v_lshl_or_b32 v99, v131, 18, v99
    v_and_b32 v131, 0xe0, v107
    v_mad_i32_i24 v194, v131, s100, v194
    v_and_or_b32 v194, v194, s67, v144
    v_mad_u32_u24 v131, v107, 40, s69
    v_or_b32 v99, v99, v194
    s_waitcnt lgkmcnt(3)
    v_bfe_u32 v194, v112, 3, 5
    v_add_lshl_u32 v128, v194, v128, 2
    v_and_b32 v194, 3, v194
    v_mad_i32_i24 v194, v194, -3, v128
    v_cmpx_gt_u32 vcc, 792, v112
    ds_write_b32 v128, v96
    ds_write_b8 v194, v120 offset:12
    s_mov_b64 exec, -1
    s_waitcnt lgkmcnt(4)
    v_bfe_u32 v194, v113, 3, 5
    v_add_lshl_u32 v129, v194, v129, 2
    v_and_b32 v194, 3, v194
    v_mad_i32_i24 v194, v194, -3, v129
    v_cmpx_gt_u32 vcc, 792, v113
    ds_write_b32 v129, v97
    ds_write_b8 v194, v121 offset:12
    s_mov_b64 exec, -1
    s_waitcnt lgkmcnt(5)
    v_bfe_u32 v194, v114, 3, 5
    v_add_lshl_u32 v130, v194, v130, 2
    v_and_b32 v194, 3, v194
    v_mad_i32_i24 v194, v194, -3, v130
    v_cmpx_gt_u32 vcc, 792, v114
    ds_write_b32 v130, v98
    ds_write_b8 v194, v122 offset:12
    s_mov_b64 exec, -1
    s_waitcnt lgkmcnt(6)
    v_bfe_u32 v194, v115, 3, 5
    v_add_lshl_u32 v131, v194, v131, 2
    v_and_b32 v194, 3, v194
    v_mad_i32_i24 v194, v194, -3, v131
    v_cmpx_gt_u32 vcc, 792, v115
    ds_write_b32 v131, v99
    ds_write_b8 v194, v123 offset:12
    s_mov_b64 exec, -1
L_B1:
    s_cmp_ge_u32 s3, 2
    s_cbranch_scc1 L_NOC
    global_load_dwordx4 v[176:179], v232, s[28:29]
L_NOC:
    global_load_dwordx4 v[160:163], v232, s[26:27]
    global_load_dwordx4 v[164:167], v232, s[32:33]
    global_load_dwordx4 v[168:171], v232, s[24:25]
    global_load_dwordx4 v[172:175], v232, s[30:31]
    s_add_u32 s6, s6, 0x2020202
    v_lshlrev_b32 v186, v246, s6
    v_and_b32 v189, 4, v247
    v_mul_u32_u24 v189, 1212416, v189
    v_lshl_add_u32 v186, v189, 8, v186
    v_and_b32 v186, 0xfe000000, v186
    v_and_b32 v187, 7, v247
    v_mul_u32_u24 v187, 33, v187
    v_add_u32 v187, 792, v187
    v_lshlrev_b32 v222, 2, v223
    s_mov_b32 s64, 0x1000000
    s_waitcnt lgkmcnt(0)
    s_barrier
    ds_read_b128 v[192:195], v185 offset:5120
    ds_read_b32 v228, v222 offset:5120
    ds_read_b128 v[204:207], v221 offset:0
    ds_read_b32 v229, v222 offset:5376
    ds_read_b128 v[208:211], v221 offset:10240
    ds_read_b32 v230, v222 offset:5632
    ds_read_b128 v[212:215], v221 offset:20480
    ds_read_b32 v231, v222 offset:5888
    ds_read_b128 v[216:219], v221 offset:30720
    s_mov_b32 s80, 2105344
    s_mov_b32 s81, 4210688
    s_mov_b32 s82, 6316032
    s_waitcnt lgkmcnt(8)
    v_max3_u32 v188, v192, v193, v194
    v_max_u32 v188, v188, v195
    v_cmp_lt_u32 vcc, 1056, v188
    s_cbranch_vccnz L_POVF
L_POUT:
    s_waitcnt lgkmcnt(7)
    v_sub_u32 v228, v187, v228
    v_and_or_b32 v228, v228, s64, v186
    s_waitcnt lgkmcnt(6)
    v_or_b32 v207, v207, v228
    buffer_store_dwordx4 v[204:207], v220, s[56:59], 0 offen sc1
    s_waitcnt lgkmcnt(5)
    v_sub_u32 v229, v187, v229
    v_and_or_b32 v229, v229, s64, v186
    s_waitcnt lgkmcnt(4)
    v_or_b32 v211, v211, v229
    buffer_store_dwordx4 v[208:211], v220, s[56:59], s80 offen sc1
    s_waitcnt lgkmcnt(3)
    v_sub_u32 v230, v187, v230
    v_and_or_b32 v230, v230, s64, v186
    s_waitcnt lgkmcnt(2)
    v_or_b32 v215, v215, v230
    buffer_store_dwordx4 v[212:215], v220, s[56:59], s81 offen sc1
    s_waitcnt lgkmcnt(1)
    v_sub_u32 v231, v187, v231
    v_and_or_b32 v231, v231, s64, v186
    s_waitcnt lgkmcnt(0)
    v_or_b32 v219, v219, v231
    buffer_store_dwordx4 v[216:219], v220, s[56:59], s82 offen sc1
    s_mov_b32 s10, 0xbfb8aa3b
    s_mov_b32 s11, s10
    s_mov_b32 s64, 0x05040100
    s_mov_b32 s66, 0x07060302
    s_waitcnt vmcnt(4)
    v_perm_b32 v144, v170, v168, s64
    v_perm_b32 v145, v170, v168, s66
    v_perm_b32 v146, v171, v169, s64
    v_perm_b32 v147, v171, v169, s66
    v_add_u32 v148, 77824, v224
    ds_write2_b32 v148, v144, v145 offset0:0 offset1:8
    ds_write2_b32 v148, v146, v147 offset0:16 offset1:24
    v_lshlrev_b32 v128, 16, v160
    v_and_b32 v129, 0xffff0000, v160
    v_lshlrev_b32 v130, 16, v161
    v_and_b32 v131, 0xffff0000, v161
    v_lshlrev_b32 v132, 16, v162
    v_and_b32 v133, 0xffff0000, v162
    v_lshlrev_b32 v134, 16, v163
    v_and_b32 v135, 0xffff0000, v163
    v_pk_mul_f32 v[128:129], v[128:129], s[10:11]
    v_pk_mul_f32 v[130:131], v[130:131], s[10:11]
    v_pk_mul_f32 v[132:133], v[132:133], s[10:11]
    v_pk_mul_f32 v[134:135], v[134:135], s[10:11]
    v_cvt_pk_bf16_f32 v136, v128, v132
    v_cvt_pk_bf16_f32 v137, v129, v133
    v_cvt_pk_bf16_f32 v138, v130, v134
    v_cvt_pk_bf16_f32 v139, v131, v135
    ds_write2_b32 v224, v136, v137 offset0:0 offset1:8
    ds_write2_b32 v224, v138, v139 offset0:16 offset1:24
    v_perm_b32 v152, v166, v164, s64
    v_perm_b32 v153, v166, v164, s66
    v_perm_b32 v154, v167, v165, s64
    v_perm_b32 v155, v167, v165, s66
    v_add_u32 v156, 10240, v224
    ds_write2_b32 v156, v152, v153 offset0:0 offset1:8
    ds_write2_b32 v156, v154, v155 offset0:16 offset1:24
    v_perm_b32 v144, v174, v172, s64
    v_perm_b32 v145, v174, v172, s66
    v_perm_b32 v146, v175, v173, s64
    v_perm_b32 v147, v175, v173, s66
    v_add_u32 v148, 130176, v224
    ds_write2_b32 v148, v144, v145 offset0:0 offset1:8
    ds_write2_b32 v148, v146, v147 offset0:16 offset1:24
    s_cmp_ge_u32 s3, 2
    s_cbranch_scc1 L_NOWC
    v_lshlrev_b32 v128, 16, v176
    v_and_b32 v129, 0xffff0000, v176
    v_lshlrev_b32 v130, 16, v177
    v_and_b32 v131, 0xffff0000, v177
    v_lshlrev_b32 v132, 16, v178
    v_and_b32 v133, 0xffff0000, v178
    v_lshlrev_b32 v134, 16, v179
    v_and_b32 v135, 0xffff0000, v179
    v_pk_mul_f32 v[128:129], v[128:129], s[10:11]
    v_pk_mul_f32 v[130:131], v[130:131], s[10:11]
    v_pk_mul_f32 v[132:133], v[132:133], s[10:11]
    v_pk_mul_f32 v[134:135], v[134:135], s[10:11]
    v_cvt_pk_bf16_f32 v136, v128, v132
    v_cvt_pk_bf16_f32 v137, v129, v133
    v_cvt_pk_bf16_f32 v138, v130, v134
    v_cvt_pk_bf16_f32 v139, v131, v135
    v_add_u32 v140, 20480, v224
    ds_write2_b32 v140, v136, v137 offset0:0 offset1:8
    ds_write2_b32 v140, v138, v139 offset0:16 offset1:24
L_NOWC:
    s_mul_i32 s34, s5, 32896
    s_add_u32 s34, s34, 65536
    s_add_u32 s56, s38, s34
    s_addc_u32 s57, s39, 0
    s_mov_b32 s58, 32768
    s_mov_b32 s59, 0x20000
    s_add_u32 s34, s34, 8421376
    s_add_u32 s60, s38, s34
    s_addc_u32 s61, s39, 0
    s_mov_b32 s62, 32768
    s_mov_b32 s63, 0x20000
    s_movk_i32 s26, 0
    s_movk_i32 s27, 8192
    s_movk_i32 s28, 16384
    s_movk_i32 s29, 24576
    s_waitcnt lgkmcnt(0)
    s_barrier
    v_add_u32 v225, 13312, v225
    ds_read_b64_tr_b16 v[0:1], v225 offset:0
    ds_read_b64_tr_b16 v[2:3], v225 offset:1280
    ds_read_b64_tr_b16 v[4:5], v225 offset:5120
    ds_read_b64_tr_b16 v[6:7], v225 offset:6400
    ds_read_b64_tr_b16 v[8:9], v225 offset:32
    ds_read_b64_tr_b16 v[10:11], v225 offset:1312
    ds_read_b64_tr_b16 v[12:13], v225 offset:5152
    ds_read_b64_tr_b16 v[14:15], v225 offset:6432
    ds_read_b64_tr_b16 v[16:17], v225 offset:64
    ds_read_b64_tr_b16 v[18:19], v225 offset:1344
    ds_read_b64_tr_b16 v[20:21], v225 offset:5184
    ds_read_b64_tr_b16 v[22:23], v225 offset:6464
    ds_read_b64_tr_b16 v[24:25], v225 offset:96
    ds_read_b64_tr_b16 v[26:27], v225 offset:1376
    v_mov_b32 v64, 0x2000000
    v_mov_b32 v65, 0x2000000
    v_mov_b32 v66, 0x2000000
    v_mov_b32 v67, 0x2000000
    v_mov_b32 v68, 0xfffff
    v_mov_b32 v69, 0xfffff
    v_mov_b32 v70, 0xfffff
    v_mov_b32 v71, 0xfffff
    v_lshl_add_u32 v72, v247, 4, s12
    ds_write_b128 v72, v[64:67] offset:0
    ds_write_b128 v72, v[68:71] offset:18432
    ds_write_b128 v72, v[64:67] offset:1024
    ds_write_b128 v72, v[68:71] offset:19456
    ds_write_b128 v72, v[64:67] offset:1280
    ds_write_b128 v72, v[68:71] offset:19712
    ds_read_b64_tr_b16 v[28:29], v225 offset:5216
    ds_read_b64_tr_b16 v[30:31], v225 offset:6496
    ds_read_b64_tr_b16 v[32:33], v225 offset:10240
    ds_read_b64_tr_b16 v[34:35], v225 offset:11520
    ds_read_b64_tr_b16 v[36:37], v225 offset:15360
    ds_read_b64_tr_b16 v[38:39], v225 offset:16640
    ds_read_b64_tr_b16 v[40:41], v225 offset:10272
    ds_read_b64_tr_b16 v[42:43], v225 offset:11552
    ds_read_b64_tr_b16 v[44:45], v225 offset:15392
    ds_read_b64_tr_b16 v[46:47], v225 offset:16672
    v_mov_b32 v192, v225
    s_mov_b32 exec_lo, 0
    v_subrev_u32 v192, 2560, v225
    s_mov_b32 exec_lo, -1
    s_waitcnt lgkmcnt(4)
    ds_read_b64_tr_b16 v[48:49], v225 offset:10304
    ds_read_b64_tr_b16 v[50:51], v225 offset:11584
    ds_read_b64_tr_b16 v[52:53], v225 offset:15424
    ds_read_b64_tr_b16 v[54:55], v225 offset:16704
    ds_read_b64_tr_b16 v[56:57], v225 offset:10336
    ds_read_b64_tr_b16 v[58:59], v225 offset:11616
    ds_read_b64_tr_b16 v[60:61], v225 offset:15456
    ds_read_b64_tr_b16 v[62:63], v225 offset:16736
    ds_read_b64_tr_b16 v[80:81], v192 offset:20480
    ds_read_b64_tr_b16 v[82:83], v192 offset:21760
    ds_read_b64_tr_b16 v[84:85], v192 offset:20512
    ds_read_b64_tr_b16 v[86:87], v192 offset:21792
    ds_read_b64_tr_b16 v[88:89], v192 offset:20544
    ds_read_b64_tr_b16 v[90:91], v192 offset:21824
    ds_read_b64_tr_b16 v[92:93], v192 offset:20576
    ds_read_b64_tr_b16 v[94:95], v192 offset:21856
    v_add_u32 v225, 77824, v225
    v_and_b32 v241, 1, v247
    v_lshlrev_b32 v241, 4, v241
    v_mov_b32 v242, 0x3f80
    v_and_b32 v245, 16, v247
    v_and_b32 v194, 15, v247
    v_lshl_add_u32 v194, v194, 5, s14
    s_mov_b32 exec_hi, 0
    v_add_u32 v245, v245, v194
    s_mov_b32 exec_hi, -1
    v_and_b32 v194, 3, v247
    v_bfe_u32 v196, v247, 2, 2
    v_and_b32 v197, 48, v247
    v_lshl_add_u32 v198, v196, 7, v197
    v_mul_u32_u24 v244, 1056, v194
    v_add3_u32 v244, v244, v198, s13
    v_lshrrev_b32 v194, 3, v247
    v_lshl_add_u32 v248, v194, 4, s12
    s_add_u32 s10, s12, 18432
    v_lshrrev_b32 v194, 1, v247
    v_lshl_add_u32 v249, v194, 2, s10
    s_add_u32 s10, s10, 2
    v_lshrrev_b32 v194, 5, v247
    v_mul_i32_i24 v250, 0xffffb800, v194
    v_and_b32 v194, 15, v247
    v_lshl_add_u32 v250, v194, 2, v250
    v_add_u32 v250, s10, v250
    s_add_u32 s10, s12, 2
    v_and_b32 v194, 48, v247
    v_lshl_add_u32 v251, v194, 1, s10
    v_and_b32 v194, 12, v247
    v_add_u32 v251, v251, v194
    v_mul_u32_u24 v159, 3128, v223
    v_add_u32 v156, 0, v159
    v_add_u32 v157, 200192, v159
    v_add_u32 v158, 400384, v159
    v_add_u32 v159, 600576, v159
    s_mov_b32 s98, 0xf0f0f0f
    s_mov_b32 s99, 0xf0f0f0f
    v_mov_b32 v180, 0xfffff
    v_mov_b32 v176, 0
    v_add_lshl_u32 v191, v232, v243, 16
    v_add_u32 v152, 0x34000000, v191
    v_cndmask_b32 v152, 0, v152, s[98:99]
    v_add_u32 v153, 0x54000000, v191
    v_cndmask_b32 v153, 0, v153, s[98:99]
    v_add_u32 v154, 0x74000000, v191
    v_cndmask_b32 v154, 0, v154, s[98:99]
    v_add_u32 v155, 0x94000000, v191
    v_cndmask_b32 v155, 0, v155, s[98:99]
    v_mov_b32 v184, 4
    v_and_b32 v177, 31, v247
    v_add_lshl_u32 v179, v177, s7, 2
    v_lshrrev_b32 v191, 5, v247
    v_lshl_add_u32 v178, v191, 11, v179
    v_add_u32 v179, 153728, v179
    v_lshlrev_b32 v191, 2, v247
    v_subrev_u32 v191, s7, v191
    s_mov_b32 s10, 0x10000
    v_add_u32 v228, 0, v191
    v_and_or_b32 v228, v228, s10, 1
    v_add_u32 v229, 1, v191
    v_and_or_b32 v229, v229, s10, 1
    v_add_u32 v230, 2, v191
    v_and_or_b32 v230, v230, s10, 1
    v_add_u32 v231, 3, v191
    v_and_or_b32 v231, v231, s10, 1
    s_movk_i32 s18, 0xffc
    s_movk_i32 s20, 32
    s_mov_b32 s21, 0
    s_mov_b32 s100, 0
    s_mov_b32 s16, 0x1ffffff
    s_mov_b32 s17, 0xffff
    s_mul_i32 s10, s4, 49
    s_sub_i32 s22, s10, 6
    s_ashr_i32 s22, s22, 1
    s_add_i32 s23, s10, 7
    s_ashr_i32 s23, s23, 1
    s_add_i32 s24, s10, 43
    s_ashr_i32 s24, s24, 1
    s_add_i32 s25, s22, 31
    s_cmp_eq_u32 s4, 7
    s_cselect_b32 s24, 196, s24
    s_cselect_b32 s25, 196, s25
    s_sub_i32 s23, s23, s7
    s_sub_i32 s24, s24, s7
    s_sub_i32 s25, s25, s7
    s_waitcnt vmcnt(0)
    buffer_load_dwordx4 v[128:131], v232, s[56:59], s26 offen sc1
    buffer_load_dwordx4 v[132:135], v232, s[56:59], s27 offen sc1
    buffer_load_dwordx4 v[136:139], v232, s[56:59], s28 offen sc1
    buffer_load_dwordx4 v[140:143], v232, s[56:59], s29 offen sc1
    v_max3_u32 v188, v112, v113, v114
    v_max3_u32 v189, v115, v116, v117
    v_max3_u32 v188, v188, v118, v119
    v_max_u32 v188, v188, v189
    v_cmp_le_u32 vcc, 792, v188
    s_cbranch_vccz L_PEXTR
    v_mov_b32 v65, s6
    s_lshl_b32 s34, s2, 7
    s_add_u32 s34, s34, 8486912
    v_subrev_u32 v68, 792, v112
    v_cmpx_gt_u32 vcc, 264, v68
    s_cbranch_execz L_PE0
    v_mov_b32 v64, v96
    v_mov_b32 v66, v120
    v_bfe_u32 v68, v112, 5, 3
    v_lshlrev_b32 v68, 4, v68
    v_mad_u32_u24 v68, v104, s68, v68
    buffer_store_dwordx4 v[64:67], v68, s[52:55], s34 offen sc1
L_PE0:
    s_mov_b64 exec, -1
    v_subrev_u32 v68, 792, v113
    v_cmpx_gt_u32 vcc, 264, v68
    s_cbranch_execz L_PE1
    v_mov_b32 v64, v97
    v_mov_b32 v66, v121
    v_bfe_u32 v68, v113, 5, 3
    v_lshlrev_b32 v68, 4, v68
    v_mad_u32_u24 v68, v105, s68, v68
    buffer_store_dwordx4 v[64:67], v68, s[52:55], s34 offen sc1
L_PE1:
    s_mov_b64 exec, -1
    v_subrev_u32 v68, 792, v114
    v_cmpx_gt_u32 vcc, 264, v68
    s_cbranch_execz L_PE2
    v_mov_b32 v64, v98
    v_mov_b32 v66, v122
    v_bfe_u32 v68, v114, 5, 3
    v_lshlrev_b32 v68, 4, v68
    v_mad_u32_u24 v68, v106, s68, v68
    buffer_store_dwordx4 v[64:67], v68, s[52:55], s34 offen sc1
L_PE2:
    s_mov_b64 exec, -1
    v_subrev_u32 v68, 792, v115
    v_cmpx_gt_u32 vcc, 264, v68
    s_cbranch_execz L_PE3
    v_mov_b32 v64, v99
    v_mov_b32 v66, v123
    v_bfe_u32 v68, v115, 5, 3
    v_lshlrev_b32 v68, 4, v68
    v_mad_u32_u24 v68, v107, s68, v68
    buffer_store_dwordx4 v[64:67], v68, s[52:55], s34 offen sc1
L_PE3:
    s_mov_b64 exec, -1
    v_subrev_u32 v68, 792, v116
    v_cmpx_gt_u32 vcc, 264, v68
    s_cbranch_execz L_PE4
    v_mov_b32 v64, v100
    v_mov_b32 v66, v120
    v_bfe_u32 v68, v116, 5, 3
    v_lshlrev_b32 v68, 4, v68
    v_mad_u32_u24 v68, v108, s68, v68
    buffer_store_dwordx4 v[64:67], v68, s[52:55], s34 offen sc1
L_PE4:
    s_mov_b64 exec, -1
    v_subrev_u32 v68, 792, v117
    v_cmpx_gt_u32 vcc, 264, v68
    s_cbranch_execz L_PE5
    v_mov_b32 v64, v101
    v_mov_b32 v66, v121
    v_bfe_u32 v68, v117, 5, 3
    v_lshlrev_b32 v68, 4, v68
    v_mad_u32_u24 v68, v109, s68, v68
    buffer_store_dwordx4 v[64:67], v68, s[52:55], s34 offen sc1
L_PE5:
    s_mov_b64 exec, -1
    v_subrev_u32 v68, 792, v118
    v_cmpx_gt_u32 vcc, 264, v68
    s_cbranch_execz L_PE6
    v_mov_b32 v64, v102
    v_mov_b32 v66, v122
    v_bfe_u32 v68, v118, 5, 3
    v_lshlrev_b32 v68, 4, v68
    v_mad_u32_u24 v68, v110, s68, v68
    buffer_store_dwordx4 v[64:67], v68, s[52:55], s34 offen sc1
L_PE6:
    s_mov_b64 exec, -1
    v_subrev_u32 v68, 792, v119
    v_cmpx_gt_u32 vcc, 264, v68
    s_cbranch_execz L_PE7
    v_mov_b32 v64, v103
    v_mov_b32 v66, v123
    v_bfe_u32 v68, v119, 5, 3
    v_lshlrev_b32 v68, 4, v68
    v_mad_u32_u24 v68, v111, s68, v68
    buffer_store_dwordx4 v[64:67], v68, s[52:55], s34 offen sc1
L_PE7:
    s_mov_b64 exec, -1
L_PEXTR:
L_PW0:
    s_waitcnt vmcnt(3)
    v_xor_b32 v188, v131, v186
    v_and_b32_sdwa v96, v128, s18 dst_sel:DWORD dst_unused:UNUSED_PAD src0_sel:WORD_1 src1_sel:DWORD
    v_and_b32_sdwa v97, v129, s18 dst_sel:DWORD dst_unused:UNUSED_PAD src0_sel:WORD_1 src1_sel:DWORD
    v_and_b32_sdwa v98, v130, s18 dst_sel:DWORD dst_unused:UNUSED_PAD src0_sel:WORD_1 src1_sel:DWORD
    v_cmp_lt_u32 vcc, s16, v188
    v_cmp_ne_u32 s[64:65], 0, v128
    v_cmp_ne_u32 s[66:67], 0, v129
    v_cmp_ne_u32 s[68:69], 0, v130
    s_cbranch_vccnz L_RT0
    s_mov_b64 exec, s[64:65]
    ds_add_rtn_u32 v112, v96, v184 offset:1024
    s_mov_b64 exec, s[66:67]
    ds_add_rtn_u32 v113, v97, v184 offset:1024
    s_mov_b64 exec, s[68:69]
    ds_add_rtn_u32 v114, v98, v184 offset:1024
    s_mov_b64 exec, -1
    v_or_b32 v176, v176, v129
    v_add_u32_sdwa v204, v131, v156 dst_sel:DWORD dst_unused:UNUSED_PAD src0_sel:BYTE_0 src1_sel:DWORD
    v_lshrrev_b32 v189, 28, v128
    v_lshl_add_u32 v204, v189, 8, v204
    v_and_b32 v189, 60, v96
    v_and_b32 v128, 0xffff, v128
    v_lshl_or_b32 v128, v189, 19, v128
    v_cndmask_b32 v188, v180, v204, s[64:65]
    v_max_u32 v204, v204, v152
    v_add_u32_sdwa v205, v131, v156 dst_sel:DWORD dst_unused:UNUSED_PAD src0_sel:BYTE_1 src1_sel:DWORD
    v_lshrrev_b32 v189, 28, v129
    v_lshl_add_u32 v205, v189, 8, v205
    v_and_b32 v189, 60, v97
    v_and_b32 v129, 0xffff, v129
    v_lshl_or_b32 v129, v189, 19, v129
    v_mov_b32_dpp v190, v188 quad_perm:[2,2,3,3] row_mask:0xf bank_mask:0xf
    v_mov_b32_dpp v207, v188 quad_perm:[0,0,1,1] row_mask:0xf bank_mask:0xf
    v_add_u32_sdwa v206, v131, v156 dst_sel:DWORD dst_unused:UNUSED_PAD src0_sel:BYTE_2 src1_sel:DWORD
    v_lshrrev_b32 v189, 28, v130
    v_lshl_add_u32 v206, v189, 8, v206
    v_and_b32 v189, 60, v98
    v_and_b32 v130, 0xffff, v130
    v_lshl_or_b32 v130, v189, 19, v130
    v_mov_b32_dpp v207, v190 row_shr:4 row_mask:0xf bank_mask:0xa
L_PW1:
    s_waitcnt vmcnt(2)
    v_xor_b32 v188, v135, v186
    v_and_b32_sdwa v100, v132, s18 dst_sel:DWORD dst_unused:UNUSED_PAD src0_sel:WORD_1 src1_sel:DWORD
    v_and_b32_sdwa v101, v133, s18 dst_sel:DWORD dst_unused:UNUSED_PAD src0_sel:WORD_1 src1_sel:DWORD
    v_and_b32_sdwa v102, v134, s18 dst_sel:DWORD dst_unused:UNUSED_PAD src0_sel:WORD_1 src1_sel:DWORD
    v_cmp_lt_u32 vcc, s16, v188
    v_cmp_ne_u32 s[72:73], 0, v132
    v_cmp_ne_u32 s[74:75], 0, v133
    v_cmp_ne_u32 s[76:77], 0, v134
    s_cbranch_vccnz L_RT1
    s_mov_b64 exec, s[72:73]
    ds_add_rtn_u32 v116, v100, v184 offset:1024
    s_mov_b64 exec, s[74:75]
    ds_add_rtn_u32 v117, v101, v184 offset:1024
    s_mov_b64 exec, s[76:77]
    ds_add_rtn_u32 v118, v102, v184 offset:1024
    s_mov_b64 exec, -1
    v_or_b32 v176, v176, v133
    v_add_u32_sdwa v208, v135, v157 dst_sel:DWORD dst_unused:UNUSED_PAD src0_sel:BYTE_0 src1_sel:DWORD
    v_lshrrev_b32 v189, 28, v132
    v_lshl_add_u32 v208, v189, 8, v208
    v_and_b32 v189, 60, v100
    v_and_b32 v132, 0xffff, v132
    v_lshl_or_b32 v132, v189, 19, v132
    v_cndmask_b32 v188, v180, v208, s[72:73]
    v_max_u32 v208, v208, v153
    v_add_u32_sdwa v209, v135, v157 dst_sel:DWORD dst_unused:UNUSED_PAD src0_sel:BYTE_1 src1_sel:DWORD
    v_lshrrev_b32 v189, 28, v133
    v_lshl_add_u32 v209, v189, 8, v209
    v_and_b32 v189, 60, v101
    v_and_b32 v133, 0xffff, v133
    v_lshl_or_b32 v133, v189, 19, v133
    v_mov_b32_dpp v190, v188 quad_perm:[2,2,3,3] row_mask:0xf bank_mask:0xf
    v_mov_b32_dpp v211, v188 quad_perm:[0,0,1,1] row_mask:0xf bank_mask:0xf
    v_add_u32_sdwa v210, v135, v157 dst_sel:DWORD dst_unused:UNUSED_PAD src0_sel:BYTE_2 src1_sel:DWORD
    v_lshrrev_b32 v189, 28, v134
    v_lshl_add_u32 v210, v189, 8, v210
    v_and_b32 v189, 60, v102
    v_and_b32 v134, 0xffff, v134
    v_lshl_or_b32 v134, v189, 19, v134
    v_mov_b32_dpp v211, v190 row_shr:4 row_mask:0xf bank_mask:0xa
L_PW2:
    s_waitcnt vmcnt(1)
    v_xor_b32 v188, v139, v186
    v_and_b32_sdwa v104, v136, s18 dst_sel:DWORD dst_unused:UNUSED_PAD src0_sel:WORD_1 src1_sel:DWORD
    v_and_b32_sdwa v105, v137, s18 dst_sel:DWORD dst_unused:UNUSED_PAD src0_sel:WORD_1 src1_sel:DWORD
    v_and_b32_sdwa v106, v138, s18 dst_sel:DWORD dst_unused:UNUSED_PAD src0_sel:WORD_1 src1_sel:DWORD
    v_cmp_lt_u32 vcc, s16, v188
    v_cmp_ne_u32 s[80:81], 0, v136
    v_cmp_ne_u32 s[82:83], 0, v137
    v_cmp_ne_u32 s[84:85], 0, v138
    s_cbranch_vccnz L_RT2
    s_mov_b64 exec, s[80:81]
    ds_add_rtn_u32 v120, v104, v184 offset:1024
    s_mov_b64 exec, s[82:83]
    ds_add_rtn_u32 v121, v105, v184 offset:1024
    s_mov_b64 exec, s[84:85]
    ds_add_rtn_u32 v122, v106, v184 offset:1024
    s_mov_b64 exec, -1
    v_or_b32 v176, v176, v137
    v_add_u32_sdwa v212, v139, v158 dst_sel:DWORD dst_unused:UNUSED_PAD src0_sel:BYTE_0 src1_sel:DWORD
    v_lshrrev_b32 v189, 28, v136
    v_lshl_add_u32 v212, v189, 8, v212
    v_and_b32 v189, 60, v104
    v_and_b32 v136, 0xffff, v136
    v_lshl_or_b32 v136, v189, 19, v136
    v_cndmask_b32 v188, v180, v212, s[80:81]
    v_max_u32 v212, v212, v154
    v_add_u32_sdwa v213, v139, v158 dst_sel:DWORD dst_unused:UNUSED_PAD src0_sel:BYTE_1 src1_sel:DWORD
    v_lshrrev_b32 v189, 28, v137
    v_lshl_add_u32 v213, v189, 8, v213
    v_and_b32 v189, 60, v105
    v_and_b32 v137, 0xffff, v137
    v_lshl_or_b32 v137, v189, 19, v137
    v_mov_b32_dpp v190, v188 quad_perm:[2,2,3,3] row_mask:0xf bank_mask:0xf
    v_mov_b32_dpp v215, v188 quad_perm:[0,0,1,1] row_mask:0xf bank_mask:0xf
    v_add_u32_sdwa v214, v139, v158 dst_sel:DWORD dst_unused:UNUSED_PAD src0_sel:BYTE_2 src1_sel:DWORD
    v_lshrrev_b32 v189, 28, v138
    v_lshl_add_u32 v214, v189, 8, v214
    v_and_b32 v189, 60, v106
    v_and_b32 v138, 0xffff, v138
    v_lshl_or_b32 v138, v189, 19, v138
    v_mov_b32_dpp v215, v190 row_shr:4 row_mask:0xf bank_mask:0xa
L_PW3:
    s_waitcnt vmcnt(0)
    v_xor_b32 v188, v143, v186
    v_and_b32_sdwa v108, v140, s18 dst_sel:DWORD dst_unused:UNUSED_PAD src0_sel:WORD_1 src1_sel:DWORD
    v_and_b32_sdwa v109, v141, s18 dst_sel:DWORD dst_unused:UNUSED_PAD src0_sel:WORD_1 src1_sel:DWORD
    v_and_b32_sdwa v110, v142, s18 dst_sel:DWORD dst_unused:UNUSED_PAD src0_sel:WORD_1 src1_sel:DWORD
    v_cmp_lt_u32 vcc, s16, v188
    v_cmp_ne_u32 s[88:89], 0, v140
    v_cmp_ne_u32 s[90:91], 0, v141
    v_cmp_ne_u32 s[92:93], 0, v142
    s_cbranch_vccnz L_RT3
    s_mov_b64 exec, s[88:89]
    ds_add_rtn_u32 v124, v108, v184 offset:1024
    s_mov_b64 exec, s[90:91]
    ds_add_rtn_u32 v125, v109, v184 offset:1024
    s_mov_b64 exec, s[92:93]
    ds_add_rtn_u32 v126, v110, v184 offset:1024
    s_mov_b64 exec, -1
    v_or_b32 v176, v176, v141
    v_or3_b32 v190, v131, v135, v139
    v_or_b32 v190, v190, v143
    v_and_b32 v190, 0x1000000, v190
    v_cmp_ne_u32 vcc, 0, v190
    s_cbranch_vccz L_XT1R
    v_and_b32 v190, 0x1000000, v131
    v_cmp_ne_u32 s[70:71], 0, v190
    s_bcnt1_i32_b64 s10, s[70:71]
    s_lshl2_add_u32 s21, s10, s21
    v_and_b32 v190, 0x1000000, v135
    v_cmp_ne_u32 s[78:79], 0, v190
    s_bcnt1_i32_b64 s10, s[78:79]
    s_lshl2_add_u32 s21, s10, s21
    v_and_b32 v190, 0x1000000, v139
    v_cmp_ne_u32 s[86:87], 0, v190
    s_bcnt1_i32_b64 s10, s[86:87]
    s_lshl2_add_u32 s21, s10, s21
    v_and_b32 v190, 0x1000000, v143
    v_cmp_ne_u32 s[94:95], 0, v190
    s_bcnt1_i32_b64 s10, s[94:95]
    s_lshl2_add_u32 s21, s10, s21
    s_mov_b64 exec, s[70:71]
    s_cbranch_execz L_XLa0
    s_movk_i32 s10, 0
    buffer_load_dwordx4 v[64:67], v232, s[60:63], s10 offen sc1
L_XLa0:
    s_mov_b64 exec, s[78:79]
    s_cbranch_execz L_XLa1
    s_movk_i32 s10, 8192
    buffer_load_dwordx4 v[68:71], v232, s[60:63], s10 offen sc1
L_XLa1:
    s_mov_b64 exec, s[86:87]
    s_cbranch_execz L_XLa2
    s_movk_i32 s10, 16384
    buffer_load_dwordx4 v[72:75], v232, s[60:63], s10 offen sc1
L_XLa2:
    s_mov_b64 exec, s[94:95]
    s_cbranch_execz L_XLa3
    s_movk_i32 s10, 24576
    buffer_load_dwordx4 v[76:79], v232, s[60:63], s10 offen sc1
L_XLa3:
    s_mov_b64 exec, -1
    v_and_b32 v190, 0x10000, v176
    v_mov_b32 v191, 640
    v_cmpx_ne_u32 vcc, 0, v190
    ds_write_b32 v191, v184 offset:4
    s_mov_b64 exec, 1
    v_mov_b32 v190, s21
    ds_add_u32 v191, v190 offset:8
    s_mov_b64 exec, -1
L_XT1R:
    v_add_u32_sdwa v216, v143, v159 dst_sel:DWORD dst_unused:UNUSED_PAD src0_sel:BYTE_0 src1_sel:DWORD
    v_lshrrev_b32 v189, 28, v140
    v_lshl_add_u32 v216, v189, 8, v216
    v_and_b32 v189, 60, v108
    v_and_b32 v140, 0xffff, v140
    v_lshl_or_b32 v140, v189, 19, v140
    v_cndmask_b32 v188, v180, v216, s[88:89]
    v_max_u32 v216, v216, v155
    v_add_u32_sdwa v217, v143, v159 dst_sel:DWORD dst_unused:UNUSED_PAD src0_sel:BYTE_1 src1_sel:DWORD
    v_lshrrev_b32 v189, 28, v141
    v_lshl_add_u32 v217, v189, 8, v217
    v_and_b32 v189, 60, v109
    v_and_b32 v141, 0xffff, v141
    v_lshl_or_b32 v141, v189, 19, v141
    v_mov_b32_dpp v190, v188 quad_perm:[2,2,3,3] row_mask:0xf bank_mask:0xf
    v_mov_b32_dpp v219, v188 quad_perm:[0,0,1,1] row_mask:0xf bank_mask:0xf
    v_add_u32_sdwa v218, v143, v159 dst_sel:DWORD dst_unused:UNUSED_PAD src0_sel:BYTE_2 src1_sel:DWORD
    v_lshrrev_b32 v189, 28, v142
    v_lshl_add_u32 v218, v189, 8, v218
    v_mov_b32_dpp v219, v190 row_shr:4 row_mask:0xf bank_mask:0xa
    v_mov_b32 v197, 640
    s_cmp_eq_u32 s3, 6
    s_cselect_b32 exec_hi, 0, -1
    s_cmp_eq_u32 s3, 7
    s_cselect_b64 exec, 1, exec
    s_add_u32 m0, s101, 0
    s_nop 0
    buffer_load_dwordx4 v234, s[40:43], 0 offen offset:0 lds
    s_add_u32 m0, s101, 6560
    s_nop 0
    buffer_load_dwordx4 v234, s[40:43], 0 offen offset:128 lds
    s_add_u32 m0, s101, 13120
    s_nop 0
    buffer_load_dwordx4 v234, s[40:43], 0 offen offset:256 lds
    s_add_u32 m0, s101, 19680
    s_nop 0
    buffer_load_dwordx4 v234, s[40:43], 0 offen offset:384 lds
    s_mov_b64 exec, -1
    s_waitcnt lgkmcnt(0)
    s_barrier
    ds_read_u16 v198, v178 offset:1024
    ds_read_u16 v199, v178 offset:2048
    ds_read_b128 v[160:163], v185 offset:1024
    ds_read_b128 v[164:167], v185 offset:2048
    ds_read_b128 v[168:171], v185 offset:3072
    ds_read_b128 v[172:175], v185 offset:4096
    ds_read_b32 v236, v197 offset:8
    s_lshl_b32 m0, s3, 10
    v_mov_b32 v240, v207
    s_add_u32 m0, m0, 13312
    s_nop 0
    buffer_load_dwordx4 v[240:241], s[44:47], 0 idxen offen lds
    s_cmp_lg_u32 s2, 0
    s_cbranch_scc1 L_NOK
    v_mov_b32 v237, s6
    v_mov_b32 v238, 0
    buffer_store_dword v237, v238, s[52:55], 0 offen sc1
L_NOK:
    s_waitcnt lgkmcnt(5)
    v_lshl_or_b32 v198, v199, 16, v198
    v_mov_b32 v199, v198
    s_waitcnt lgkmcnt(0)
    v_add_u32_sdwa v188, v160, v164 dst_sel:DWORD dst_unused:UNUSED_PAD src0_sel:WORD_0 src1_sel:WORD_0
    v_add_u32_sdwa v192, v168, v172 dst_sel:DWORD dst_unused:UNUSED_PAD src0_sel:WORD_0 src1_sel:WORD_0
    v_add_u32_dpp v199, v199, v199 row_shr:1 row_mask:0xf bank_mask:0xf bound_ctrl:0
    v_add_u32_sdwa v189, v161, v165 dst_sel:DWORD dst_unused:UNUSED_PAD src0_sel:WORD_0 src1_sel:WORD_0
    v_add_u32_sdwa v193, v169, v173 dst_sel:DWORD dst_unused:UNUSED_PAD src0_sel:WORD_0 src1_sel:WORD_0
    v_add_u32_dpp v199, v199, v199 row_shr:2 row_mask:0xf bank_mask:0xf bound_ctrl:0
    v_add_u32_sdwa v190, v162, v166 dst_sel:DWORD dst_unused:UNUSED_PAD src0_sel:WORD_0 src1_sel:WORD_0
    v_add_u32_sdwa v194, v170, v174 dst_sel:DWORD dst_unused:UNUSED_PAD src0_sel:WORD_0 src1_sel:WORD_0
    v_add_u32_dpp v199, v199, v199 row_shr:4 row_mask:0xf bank_mask:0xf bound_ctrl:0
    v_add_u32_sdwa v191, v163, v167 dst_sel:DWORD dst_unused:UNUSED_PAD src0_sel:WORD_0 src1_sel:WORD_0
    v_add_u32_sdwa v195, v171, v175 dst_sel:DWORD dst_unused:UNUSED_PAD src0_sel:WORD_0 src1_sel:WORD_0
    v_add_u32_dpp v199, v199, v199 row_shr:8 row_mask:0xf bank_mask:0xf bound_ctrl:0
    v_add_u32 v188, v188, v192
    v_add_u32 v189, v189, v193
    v_add_u32_dpp v199, v199, v199 row_bcast:15 row_mask:0xa bank_mask:0xf
    v_add_u32 v190, v190, v194
    v_add_u32 v191, v191, v195
    v_mul_u32_u24 v196, v188, v228
    v_mad_u32_u24 v196, v189, v229, v196
    v_mad_u32_u24 v196, v190, v230, v196
    v_mad_u32_u24 v196, v191, v231, v196
    s_mov_b32 s96, -1
    s_mov_b32 s97, 0
    v_sub_u32 v200, v199, v198
    v_add_u32_sdwa v202, v199, v199 dst_sel:DWORD dst_unused:UNUSED_PAD src0_sel:WORD_0 src1_sel:WORD_1
    v_add_u32_dpp v196, v196, v196 row_shr:1 row_mask:0xf bank_mask:0xf bound_ctrl:0
    v_add_u32_sdwa v201, v200, v200 dst_sel:DWORD dst_unused:UNUSED_PAD src0_sel:WORD_0 src1_sel:WORD_1
    v_add_u32_sdwa v203, v198, v198 dst_sel:DWORD dst_unused:UNUSED_PAD src0_sel:WORD_0 src1_sel:WORD_1
    v_add_u32_dpp v196, v196, v196 row_shr:2 row_mask:0xf bank_mask:0xf bound_ctrl:0
    v_and_b32 v239, 60, v110
    v_readfirstlane_b32 s19, v236
    v_add_u32_dpp v196, v196, v196 row_shr:4 row_mask:0xf bank_mask:0xf bound_ctrl:0
    v_permlane32_swap_b32 v201, v202
    v_cndmask_b32 v203, 0, v203, s[96:97]
    v_add_u32_dpp v196, v196, v196 row_shr:8 row_mask:0xf bank_mask:0xf bound_ctrl:0
    v_add_u32 v201, v201, v202
    v_and_b32 v142, 0xffff, v142
    v_add_u32_dpp v196, v196, v196 row_bcast:15 row_mask:0xa bank_mask:0xf
    v_add_u32 v202, v201, v203
    v_lshl_or_b32 v142, v239, 19, v142
    v_add_u32_dpp v196, v196, v196 row_bcast:31 row_mask:0xc bank_mask:0xf
    v_sub_u32_sdwa v203, v202, v198 dst_sel:DWORD dst_unused:UNUSED_PAD src0_sel:DWORD src1_sel:WORD_1
    v_readlane_b32 s16, v196, 63
    s_lshl_b32 m0, s3, 10
    v_mov_b32 v240, v211
    s_add_u32 m0, m0, 21504
    s_nop 0
    buffer_load_dwordx4 v[240:241], s[44:47], 0 idxen offen lds
    s_bfe_u32 s10, s16, 0xe0002
    s_lshr_b32 s16, s16, 16
    s_lshr_b32 s11, s10, 1
    s_add_u32 s11, s11, 48
    s_and_b32 s11, s11, -128
    s_lshr_b32 s8, s4, 1
    s_mul_i32 s8, s8, s10
    s_sub_i32 s11, s11, 48
    s_sub_i32 s8, s8, s16
    s_add_i32 s11, s11, s8
    s_add_i32 s10, s10, s8
    s_bitcmp1_b32 s4, 0
    s_cselect_b32 s31, s11, s8
    s_cselect_b32 s10, s10, s11
    v_cmp_gt_i32 vcc, s31, v202
    v_cmp_gt_i32 s[34:35], s10, v202
    s_bcnt1_i32_b32 s22, vcc_lo
    s_bcnt1_i32_b32 s10, s34
    s_min_i32 s22, s22, s23
    s_max_i32 s10, s10, s24
    s_min_i32 s23, s10, s25
    v_readlane_b32 s16, v201, s22
    v_readlane_b32 s30, v201, s23
    s_add_u32 s8, s22, s7
    s_add_u32 s9, s23, s7
    s_add_u32 s10, s22, 32
    s_add_u32 s11, s23, 32
    v_readlane_b32 s26, v200, s22
    v_readlane_b32 s28, v200, s23
    v_readlane_b32 s27, v200, s10
    v_readlane_b32 s29, v200, s11
    s_sub_u32 s31, s30, s16
    s_add_u32 s10, s31, 255
    s_sub_i32 s11, s23, 16
    s_max_i32 s11, s11, s22
    v_readlane_b32 s11, v201, s11
    s_add_u32 vcc_lo, s31, 127
    s_and_b32 vcc_hi, vcc_lo, 127
    s_add_u32 vcc_hi, vcc_hi, s19
    s_cmp_lt_u32 vcc_hi, 55
    s_cselect_b32 vcc_lo, vcc_lo, s10
    s_sub_u32 s11, s11, s16
    s_add_u32 s11, s11, s19
    s_lshl_b32 s11, s11, 1
    s_and_b32 vcc_lo, vcc_lo, -256
    s_cmp_le_u32 s11, vcc_lo
    s_cselect_b32 s10, vcc_lo, s10
    s_lshr_b32 s10, s10, 8
    s_lshl_b32 s10, s10, 7
    s_sub_u32 s10, s10, s19
    s_max_i32 s10, s10, 0
    s_add_u32 s16, s16, s10
    s_add_u32 s10, s22, 16
    s_min_u32 s10, s10, s23
    s_sub_i32 s11, s23, 16
    v_cmp_ge_u32 s[34:35], s16, v203
    v_cmp_ge_u32 s[36:37], s16, v202
    v_cmp_gt_i32 vcc, s10, v177
    v_cmp_gt_i32 s[10:11], s11, v177
    v_cmp_le_u32 s[32:33], s22, v177
    v_cmp_gt_u32 s[96:97], s23, v177
    s_and_b64 s[34:35], s[34:35], vcc
    s_and_b64 s[36:37], s[36:37], vcc
    s_or_b64 s[34:35], s[34:35], s[10:11]
    s_or_b64 s[36:37], s[36:37], s[10:11]
    s_bcnt1_i32_b32 s24, s34
    s_bcnt1_i32_b32 s10, s36
    s_bcnt1_i32_b32 s11, s35
    s_bcnt1_i32_b32 s25, s37
    v_readlane_b32 s22, v200, s24
    v_readlane_b32 s10, v200, s10
    s_add_u32 s11, s11, 32
    s_add_u32 s16, s25, 32
    v_readlane_b32 s23, v200, s11
    v_readlane_b32 s11, v200, s16
    v_mov_b32 v188, s17
    v_cndmask_b32 v189, 0, v188, s[34:35]
    v_cndmask_b32 v188, 0, v188, s[36:37]
    s_and_b64 s[32:33], s[32:33], s[96:97]
    s_pack_lh_b32_b16 s22, s22, s10
    s_pack_lh_b32_b16 s23, s23, s11
    v_lshl_or_b32 v188, v188, 16, v189
    s_sub_u32 s16, s12, 37888
    s_pack_ll_b32_b16 s16, s16, s16
    s_sub_u32 s10, s22, s26
    s_sub_u32 s11, s23, s27
    s_mul_i32 s10, s10, 0x10001
    s_lshl_b32 vcc_lo, s10, 16
    s_pack_hh_b32_b16 s10, s10, s10
    s_lshl_b32 vcc_hi, s11, 16
    s_add_u32 vcc_hi, vcc_hi, s10
    s_add_u32 s96, vcc_hi, s11
    s_lshr_b32 s96, s96, 16
    s_sub_u32 s31, s31, s96
    s_cmp_gt_u32 s31, s96
    s_cselect_b32 s97, 0x4800480, 0
    s_add_u32 s16, s16, s97
    s_sub_u32 s10, s16, s26
    s_sub_u32 s11, s16, s27
    s_add_u32 s10, s10, vcc_lo
    s_add_u32 s11, s11, vcc_hi
    v_mov_b32 v192, s10
    v_mov_b32 v193, s11
    s_add_u32 s16, s16, 0x4800480
    s_sub_u32 s16, s16, s97
    s_sub_u32 s16, s16, s97
    s_sub_u32 s10, s28, s22
    s_sub_u32 s11, s29, s23
    s_mul_i32 s10, s10, 0x10001
    s_lshl_b32 vcc_lo, s10, 16
    s_pack_hh_b32_b16 s10, s10, s10
    s_lshl_b32 vcc_hi, s11, 16
    s_add_u32 vcc_hi, vcc_hi, s10
    s_sub_u32 s10, s16, s22
    s_sub_u32 s11, s16, s23
    s_add_u32 s10, s10, vcc_lo
    s_add_u32 s11, s11, vcc_hi
    v_mov_b32 v194, s10
    v_mov_b32 v195, s11
    v_bfi_b32 v192, v188, v192, v194
    v_bfi_b32 v193, v188, v193, v195
    s_mov_b32 exec_hi, 0
    v_mov_b32 v193, v192
    s_mov_b64 exec, s[32:33]
    v_add_u32 v200, v200, v193
    s_bfe_u32 s10, s97, 0x10007
    s_lshl1_add_u32 s10, s4, s10
    s_lshl_b32 s10, s10, 2
    v_cndmask_b32 v188, 4, 0, s[34:35]
    ds_write_b16 v178, v200 offset:1026
    ds_write_b16_d16_hi v178, v200 offset:2050
    s_mov_b32 exec_hi, 0
    v_xor_b32 v188, s10, v188
    ds_write_b32 v179, v188
    s_mov_b64 exec, -1
    s_min_u32 s10, s31, s96
    s_max_u32 s96, s31, s96
    s_mov_b32 s31, s10
    s_add_u32 s10, s96, s19
    s_mul_i32 s11, s30, 9216
    s_lshr_b32 s11, s11, 16
    s_max_u32 s10, s10, s11
    s_cmp_lt_u32 s10, 1152
    s_cbranch_scc1 L_LFIT
    ds_write_b32 v197, v184
L_LFIT:
    s_cmp_eq_u32 s19, 0
    s_cbranch_scc1 L_XCNR
    s_sub_u32 s10, s12, 37888
    s_add_u32 s11, s10, s96
    v_mov_b32 v188, s11
    s_add_u32 s11, s10, s31
    s_add_u32 s11, s11, 1152
    v_mov_b32 v189, s11
    s_lshl_b32 s10, s4, 3
    v_mov_b32 v190, s10
    ds_write_b64 v190, v[188:189] offset:576
L_XCNR:
    s_lshl_b32 m0, s3, 10
    v_mov_b32 v240, v215
    s_add_u32 m0, m0, 29696
    s_nop 0
    buffer_load_dwordx4 v[240:241], s[44:47], 0 idxen offen lds
    s_waitcnt vmcnt(3)
    s_waitcnt lgkmcnt(0)
    s_barrier
    ds_read_b64 v[202:203], v197
    ds_read_u16 v96, v96 offset:1026
    ds_read_u16 v97, v97 offset:1026
    ds_read_u16 v98, v98 offset:1026
    ds_read_u16 v100, v100 offset:1026
    ds_read_u16 v101, v101 offset:1026
    ds_read_u16 v102, v102 offset:1026
    ds_read_u16 v104, v104 offset:1026
    ds_read_u16 v105, v105 offset:1026
    ds_read_u16 v106, v106 offset:1026
    ds_read_u16 v108, v108 offset:1026
    ds_read_u16 v109, v109 offset:1026
    ds_read_u16 v110, v110 offset:1026
    s_lshl_b32 m0, s3, 10
    v_mov_b32 v240, v219
    s_add_u32 m0, m0, 37888
    s_nop 0
    buffer_load_dwordx4 v[240:241], s[44:47], 0 idxen offen lds
    s_add_u32 s24, s24, s7
    s_add_u32 s11, s25, s7
    s_and_b32 s10, s11, 15
    s_cmp_lt_u32 s11, s24
    s_cselect_b32 s25, s10, 16
    s_cmp_lg_u32 s97, 0
    s_cselect_b32 s23, s8, s11
    s_cselect_b32 s7, s8, s24
    s_cselect_b32 s8, s11, s8
    s_cselect_b32 s24, s9, s24
    s_cselect_b32 s9, s11, s9
    s_min_u32 s22, s8, 192
    s_min_u32 s23, s23, 192
    s_mov_b32 s30, s19
    s_waitcnt lgkmcnt(12)
    v_cmp_ne_u32 vcc, 0, v202
    v_readfirstlane_b32 s19, v203
    s_cbranch_vccnz L_OVF
    s_waitcnt lgkmcnt(9)
    s_mov_b64 exec, s[64:65]
    v_add_u32 v96, v96, v112
    ds_write2st64_b32 v96, v128, v204 offset0:148 offset1:220
    s_mov_b64 exec, s[66:67]
    v_add_u32 v97, v97, v113
    ds_write2st64_b32 v97, v129, v205 offset0:148 offset1:220
    s_mov_b64 exec, s[68:69]
    v_add_u32 v98, v98, v114
    ds_write2st64_b32 v98, v130, v206 offset0:148 offset1:220
    s_waitcnt lgkmcnt(9)
    s_mov_b64 exec, s[72:73]
    v_add_u32 v100, v100, v116
    ds_write2st64_b32 v100, v132, v208 offset0:148 offset1:220
    s_mov_b64 exec, s[74:75]
    v_add_u32 v101, v101, v117
    ds_write2st64_b32 v101, v133, v209 offset0:148 offset1:220
    s_mov_b64 exec, s[76:77]
    v_add_u32 v102, v102, v118
    ds_write2st64_b32 v102, v134, v210 offset0:148 offset1:220
    s_waitcnt lgkmcnt(9)
    s_mov_b64 exec, s[80:81]
    v_add_u32 v104, v104, v120
    ds_write2st64_b32 v104, v136, v212 offset0:148 offset1:220
    s_mov_b64 exec, s[82:83]
    v_add_u32 v105, v105, v121
    ds_write2st64_b32 v105, v137, v213 offset0:148 offset1:220
    s_mov_b64 exec, s[84:85]
    v_add_u32 v106, v106, v122
    ds_write2st64_b32 v106, v138, v214 offset0:148 offset1:220
    s_waitcnt lgkmcnt(9)
    s_mov_b64 exec, s[88:89]
    v_add_u32 v108, v108, v124
    ds_write2st64_b32 v108, v140, v216 offset0:148 offset1:220
    s_mov_b64 exec, s[90:91]
    v_add_u32 v109, v109, v125
    ds_write2st64_b32 v109, v141, v217 offset0:148 offset1:220
    s_mov_b64 exec, s[92:93]
    v_add_u32 v110, v110, v126
    ds_write2st64_b32 v110, v142, v218 offset0:148 offset1:220
    s_mov_b64 exec, -1
    s_add_u32 s10, s96, 127
    s_lshr_b32 s10, s10, 7
    s_lshl1_add_u32 s10, s10, -1
    s_add_u32 s11, s31, 127
    s_lshr_b32 s11, s11, 6
    s_and_b32 s11, s11, -2
    s_max_i32 s17, s10, s11
    s_cselect_b32 s10, s96, s31
    s_sub_u32 s10, s10, 1
    s_andn2_b32 s99, 64, s10
L_CA:
    ds_read_b64_tr_b16 v[96:97], v225 offset:0
    ds_read_b64_tr_b16 v[98:99], v225 offset:1280
    ds_read_b64_tr_b16 v[100:101], v225 offset:5120
    ds_read_b64_tr_b16 v[102:103], v225 offset:6400
    ds_read_b64_tr_b16 v[104:105], v225 offset:32
    ds_read_b64_tr_b16 v[106:107], v225 offset:1312
    ds_read_b64_tr_b16 v[108:109], v225 offset:5152
    ds_read_b64_tr_b16 v[110:111], v225 offset:6432
    ds_read_b64_tr_b16 v[112:113], v225 offset:64
    ds_read_b64_tr_b16 v[114:115], v225 offset:1344
    ds_read_b64_tr_b16 v[116:117], v225 offset:5184
    ds_read_b64_tr_b16 v[118:119], v225 offset:6464
    ds_read_b64_tr_b16 v[120:121], v225 offset:96
    ds_read_b64_tr_b16 v[122:123], v225 offset:1376
    ds_read_b64_tr_b16 v[124:125], v225 offset:5216
    ds_read_b64_tr_b16 v[126:127], v225 offset:6496
    s_cmp_eq_u32 s21, 0
    s_cbranch_scc1 L_XT2R
    s_waitcnt vmcnt(8)
L_XT2:
    s_mov_b64 s[34:35], 0
    v_cmp_ne_u32 vcc, s6, v65
    s_and_b64 vcc, vcc, s[70:71]
    s_or_b64 s[34:35], s[34:35], vcc
    v_cmp_ne_u32 vcc, s6, v69
    s_and_b64 vcc, vcc, s[78:79]
    s_or_b64 s[34:35], s[34:35], vcc
    v_cmp_ne_u32 vcc, s6, v73
    s_and_b64 vcc, vcc, s[86:87]
    s_or_b64 s[34:35], s[34:35], vcc
    v_cmp_ne_u32 vcc, s6, v77
    s_and_b64 vcc, vcc, s[94:95]
    s_or_b64 s[34:35], s[34:35], vcc
    s_cbranch_scc1 L_XT2B
    s_cmp_eq_u32 s20, 0
    s_cbranch_scc1 L_XT2R
    s_mov_b64 exec, s[70:71]
    s_cbranch_execz L_XS0
    v_bfe_u32 v65, v64, 18, 8
    v_lshlrev_b32 v65, 2, v65
    v_add_u32 v67, 153728, v65
    ds_read_b32 v67, v67
    v_add_u32_sdwa v66, v66, v156 dst_sel:DWORD dst_unused:UNUSED_PAD src0_sel:BYTE_0 src1_sel:DWORD
    v_lshrrev_b32 v189, 28, v64
    v_lshl_add_u32 v66, v189, 8, v66
    v_and_b32 v189, 60, v65
    v_and_b32 v64, 0xffff, v64
    v_lshl_or_b32 v64, v189, 19, v64
    s_waitcnt lgkmcnt(0)
    ds_add_rtn_u32 v67, v67, v184 offset:576
    s_waitcnt lgkmcnt(0)
    ds_write2st64_b32 v67, v64, v66 offset0:148 offset1:220
L_XS0:
    s_mov_b64 exec, s[78:79]
    s_cbranch_execz L_XS1
    v_bfe_u32 v69, v68, 18, 8
    v_lshlrev_b32 v69, 2, v69
    v_add_u32 v71, 153728, v69
    ds_read_b32 v71, v71
    v_add_u32_sdwa v70, v70, v157 dst_sel:DWORD dst_unused:UNUSED_PAD src0_sel:BYTE_0 src1_sel:DWORD
    v_lshrrev_b32 v189, 28, v68
    v_lshl_add_u32 v70, v189, 8, v70
    v_and_b32 v189, 60, v69
    v_and_b32 v68, 0xffff, v68
    v_lshl_or_b32 v68, v189, 19, v68
    s_waitcnt lgkmcnt(0)
    ds_add_rtn_u32 v71, v71, v184 offset:576
    s_waitcnt lgkmcnt(0)
    ds_write2st64_b32 v71, v68, v70 offset0:148 offset1:220
L_XS1:
    s_mov_b64 exec, s[86:87]
    s_cbranch_execz L_XS2
    v_bfe_u32 v73, v72, 18, 8
    v_lshlrev_b32 v73, 2, v73
    v_add_u32 v75, 153728, v73
    ds_read_b32 v75, v75
    v_add_u32_sdwa v74, v74, v158 dst_sel:DWORD dst_unused:UNUSED_PAD src0_sel:BYTE_0 src1_sel:DWORD
    v_lshrrev_b32 v189, 28, v72
    v_lshl_add_u32 v74, v189, 8, v74
    v_and_b32 v189, 60, v73
    v_and_b32 v72, 0xffff, v72
    v_lshl_or_b32 v72, v189, 19, v72
    s_waitcnt lgkmcnt(0)
    ds_add_rtn_u32 v75, v75, v184 offset:576
    s_waitcnt lgkmcnt(0)
    ds_write2st64_b32 v75, v72, v74 offset0:148 offset1:220
L_XS2:
    s_mov_b64 exec, s[94:95]
    s_cbranch_execz L_XS3
    v_bfe_u32 v77, v76, 18, 8
    v_lshlrev_b32 v77, 2, v77
    v_add_u32 v79, 153728, v77
    ds_read_b32 v79, v79
    v_add_u32_sdwa v78, v78, v159 dst_sel:DWORD dst_unused:UNUSED_PAD src0_sel:BYTE_0 src1_sel:DWORD
    v_lshrrev_b32 v189, 28, v76
    v_lshl_add_u32 v78, v189, 8, v78
    v_and_b32 v189, 60, v77
    v_and_b32 v76, 0xffff, v76
    v_lshl_or_b32 v76, v189, 19, v76
    s_waitcnt lgkmcnt(0)
    ds_add_rtn_u32 v79, v79, v184 offset:576
    s_waitcnt lgkmcnt(0)
    ds_write2st64_b32 v79, v76, v78 offset0:148 offset1:220
L_XS3:
    s_mov_b64 exec, -1
L_XT2R:
    s_cmp_ge_u32 s3, 4
    s_cbranch_scc1 L_EP0
    s_lshl_b32 s34, s22, 5
    s_lshl_b32 s35, s23, 5
    s_mov_b32 vcc_lo, 0xff00ff00
    s_mov_b32 vcc_hi, 0xff00ff00
    v_mov_b32 v176, s35
    v_mov_b32 v177, s34
    v_cndmask_b32 v176, v176, v177, vcc
    v_and_b32 v177, 4, v247
    v_lshlrev_b32 v177, 6, v177
    v_lshl_add_u32 v177, v246, 2, v177
    v_sub_u32 v177, v177, v176
    v_and_b32 v178, 48, v247
    s_movk_i32 s34, 832
    v_mad_u32_u24 v178, v246, s34, v178
    s_mov_b32 s34, 116736
    v_add3_u32 v178, v178, v176, s34
    v_and_b32 v176, 0x1ff, v177
    v_add_u32 v176, v176, v178
    v_add_u32 v177, 0x80, v177
    v_and_b32 v177, 0x1ff, v177
    v_add_u32 v177, v177, v178
    v_mov_b64 v[184:185], 0
    v_mov_b64 v[186:187], 0
    v_lshrrev_b32 v188, 2, v247
    v_and_b32 v188, 12, v188
    v_subrev_u32 v188, s25, v188
    v_mov_b32 v189, 0x358637bd
    v_mfma_f32_32x32x16_bf16 v[144:159], v[184:187], v[184:187], 0
    v_cmp_ne_u32 s[80:81], 0, v188
    v_cmp_ne_u32 s[82:83], -1, v188
    v_cmp_ne_u32 s[84:85], -2, v188
    v_cmp_ne_u32 s[86:87], -3, v188
    v_cndmask_b32 v128, 0, v189, s[80:81]
    v_cndmask_b32 v129, 0, v189, s[82:83]
    v_cndmask_b32 v130, 0, v189, s[84:85]
    v_cndmask_b32 v131, 0, v189, s[86:87]
    v_mov_b64 v[132:133], v[128:129]
    v_mov_b64 v[134:135], v[130:131]
    v_mov_b64 v[136:137], v[128:129]
    v_mov_b64 v[138:139], v[130:131]
    v_mov_b64 v[140:141], v[128:129]
    v_mov_b64 v[142:143], v[130:131]
    ds_read_b128 v[160:163], v176 offset:0
    ds_read_b128 v[164:167], v176 offset:64
    ds_read_b128 v[168:171], v177 offset:0
    ds_read_b128 v[172:175], v177 offset:64
    s_mov_b32 s34, 0xbfb8aa3b
    s_mov_b32 s35, s34
    s_waitcnt lgkmcnt(3)
    v_mfma_f32_16x16x32_bf16 v[204:207], v[160:163], v[96:99], 0
    v_mfma_f32_16x16x32_bf16 v[212:215], v[160:163], v[104:107], 0
    v_mfma_f32_16x16x32_bf16 v[220:223], v[160:163], v[112:115], 0
    v_mfma_f32_16x16x32_bf16 v[228:231], v[160:163], v[120:123], 0
    s_waitcnt lgkmcnt(2)
    v_mfma_f32_16x16x32_bf16 v[204:207], v[164:167], v[100:103], v[204:207]
    v_mfma_f32_16x16x32_bf16 v[212:215], v[164:167], v[108:111], v[212:215]
    v_mfma_f32_16x16x32_bf16 v[220:223], v[164:167], v[116:119], v[220:223]
    v_mfma_f32_16x16x32_bf16 v[228:231], v[164:167], v[124:127], v[228:231]
    s_waitcnt lgkmcnt(1)
    v_mfma_f32_16x16x32_bf16 v[208:211], v[168:171], v[96:99], 0
    v_mfma_f32_16x16x32_bf16 v[216:219], v[168:171], v[104:107], 0
    v_mfma_f32_16x16x32_bf16 v[224:227], v[168:171], v[112:115], 0
    v_mfma_f32_16x16x32_bf16 v[232:235], v[168:171], v[120:123], 0
    s_waitcnt lgkmcnt(0)
    v_mfma_f32_16x16x32_bf16 v[208:211], v[172:175], v[100:103], v[208:211]
    v_mfma_f32_16x16x32_bf16 v[216:219], v[172:175], v[108:111], v[216:219]
    v_mfma_f32_16x16x32_bf16 v[224:227], v[172:175], v[116:119], v[224:227]
    v_mfma_f32_16x16x32_bf16 v[232:235], v[172:175], v[124:127], v[232:235]
    s_mov_b32 s10, 0x358637bd
    s_mov_b32 s11, s10
    v_mov_b64 v[96:97], s[10:11]
    v_mov_b64 v[98:99], s[10:11]
    v_mov_b64 v[100:101], s[10:11]
    v_mov_b64 v[102:103], s[10:11]
    v_mov_b64 v[104:105], s[10:11]
    v_mov_b64 v[106:107], s[10:11]
    v_mov_b64 v[108:109], s[10:11]
    v_mov_b64 v[110:111], s[10:11]
L_EP0:
    s_waitcnt vmcnt(0) lgkmcnt(0)
    s_barrier
    ds_read_b128 v[236:239], v248
    ds_read_b32 v240, v249
    s_cmp_ge_u32 s3, 4
    s_cbranch_scc1 L_LATE0
    s_waitcnt lgkmcnt(0)
    s_add_u32 m0, s13, 0
    v_mad_u32_u16 v236, v236, s15, v243
    buffer_load_dwordx4 v236, s[40:43], 0 offen lds
    s_add_u32 m0, s13, 1056
    v_mad_u32_u16 v237, v237, s15, v243
    buffer_load_dwordx4 v237, s[40:43], 0 offen lds
    s_add_u32 m0, s13, 2112
    v_mad_u32_u16 v238, v238, s15, v243
    buffer_load_dwordx4 v238, s[40:43], 0 offen lds
    s_add_u32 m0, s13, 3168
    v_mad_u32_u16 v239, v239, s15, v243
    buffer_load_dwordx4 v239, s[40:43], 0 offen lds
    s_mov_b32 m0, s14
    s_nop 0
    buffer_load_dwordx4 v[240:241], s[44:47], 0 idxen offen lds
    s_mov_b32 s34, 0xbfb8aa3b
    s_mov_b32 s35, s34
    v_pk_mul_f32 v[204:205], v[204:205], s[34:35]
    v_pk_mul_f32 v[206:207], v[206:207], s[34:35]
    v_pk_mul_f32 v[208:209], v[208:209], s[34:35]
    v_pk_mul_f32 v[210:211], v[210:211], s[34:35]
    v_pk_mul_f32 v[212:213], v[212:213], s[34:35]
    v_pk_mul_f32 v[214:215], v[214:215], s[34:35]
    v_pk_mul_f32 v[216:217], v[216:217], s[34:35]
    v_pk_mul_f32 v[218:219], v[218:219], s[34:35]
    v_pk_mul_f32 v[220:221], v[220:221], s[34:35]
    v_pk_mul_f32 v[222:223], v[222:223], s[34:35]
    v_pk_mul_f32 v[224:225], v[224:225], s[34:35]
    v_pk_mul_f32 v[226:227], v[226:227], s[34:35]
    v_pk_mul_f32 v[228:229], v[228:229], s[34:35]
    v_pk_mul_f32 v[230:231], v[230:231], s[34:35]
    v_pk_mul_f32 v[232:233], v[232:233], s[34:35]
    v_pk_mul_f32 v[234:235], v[234:235], s[34:35]
    v_mfma_f32_32x32x16_bf16 v[112:127], v[184:187], v[184:187], 0
    v_cvt_pk_bf16_f32 v64, v204, v205
    v_cvt_pk_bf16_f32 v65, v206, v207
    v_cvt_pk_bf16_f32 v66, v208, v209
    v_cvt_pk_bf16_f32 v67, v210, v211
    v_cvt_pk_bf16_f32 v68, v212, v213
    v_cvt_pk_bf16_f32 v69, v214, v215
    v_cvt_pk_bf16_f32 v70, v216, v217
    v_cvt_pk_bf16_f32 v71, v218, v219
    v_cvt_pk_bf16_f32 v72, v220, v221
    v_cvt_pk_bf16_f32 v73, v222, v223
    v_cvt_pk_bf16_f32 v74, v224, v225
    v_cvt_pk_bf16_f32 v75, v226, v227
    v_cvt_pk_bf16_f32 v76, v228, v229
    v_cvt_pk_bf16_f32 v77, v230, v231
    v_cvt_pk_bf16_f32 v78, v232, v233
    v_cvt_pk_bf16_f32 v79, v234, v235
    v_permlane32_swap_b32 v80, v64
    v_permlane32_swap_b32 v81, v65
    v_permlane32_swap_b32 v82, v66
    v_permlane32_swap_b32 v83, v67
    v_permlane32_swap_b32 v84, v68
    v_permlane32_swap_b32 v85, v69
    v_permlane32_swap_b32 v86, v70
    v_permlane32_swap_b32 v87, v71
    v_permlane32_swap_b32 v88, v72
    v_permlane32_swap_b32 v89, v73
    v_permlane32_swap_b32 v90, v74
    v_permlane32_swap_b32 v91, v75
    v_permlane32_swap_b32 v92, v76
    v_permlane32_swap_b32 v93, v77
    v_permlane32_swap_b32 v94, v78
    v_permlane32_swap_b32 v95, v79
    s_lshl_b32 s72, s4, 7
    s_add_u32 s72, s72, 157824
    v_mov_b32 v190, s22
    s_mov_b32 exec_lo, 0xffff0000
    v_mov_b32 v190, s23
    s_mov_b32 exec_lo, -1
    s_mov_b32 exec_hi, 0
    v_sub_u32 v191, v247, v190
    v_and_b32 v191, 15, v191
    v_add_lshl_u32 v191, v191, v190, 5
    v_lshl_add_u32 v190, v247, 2, s72
    ds_write_b32 v190, v191
    s_mov_b32 exec_hi, -1
    s_mul_i32 s10, s5, 196
    s_add_u32 s11, s10, s7
    s_add_u32 s62, s10, s9
    s_min_u32 s11, s11, 50000
    s_min_u32 s62, s62, 50000
    s_sub_u32 s62, s62, s11
    s_lshl_b32 s11, s11, 7
    s_lshl_b32 s62, s62, 7
    s_add_u32 s60, s48, s11
    s_addc_u32 s61, s49, 0
    s_mul_i32 s74, s7, -128
    s_add_u32 s11, s10, s8
    s_add_u32 s50, s10, s24
    s_min_u32 s11, s11, 50000
    s_min_u32 s50, s50, 50000
    s_sub_u32 s50, s50, s11
    s_lshl_b32 s11, s11, 7
    s_lshl_b32 s50, s50, 7
    s_add_u32 s48, s48, s11
    s_addc_u32 s49, s49, 0
    s_mul_i32 s73, s8, -128
    s_and_b32 s10, s25, 12
    s_lshl_b32 s10, s10, 2
    s_bfm_b64 s[76:77], 16, s10
    s_branch L_SET
L_LATE0:
    s_lshl_b32 s34, s22, 5
    s_lshl_b32 s35, s23, 5
    s_mov_b32 vcc_lo, 0xff00ff00
    s_mov_b32 vcc_hi, 0xff00ff00
    v_mov_b32 v176, s35
    v_mov_b32 v177, s34
    v_cndmask_b32 v176, v176, v177, vcc
    v_and_b32 v177, 4, v247
    v_lshlrev_b32 v177, 6, v177
    v_lshl_add_u32 v177, v246, 2, v177
    v_sub_u32 v177, v177, v176
    v_and_b32 v178, 48, v247
    s_movk_i32 s34, 832
    v_mad_u32_u24 v178, v246, s34, v178
    s_mov_b32 s34, 116736
    v_add3_u32 v178, v178, v176, s34
    v_and_b32 v176, 0x1ff, v177
    v_add_u32 v176, v176, v178
    v_add_u32 v177, 0x80, v177
    v_and_b32 v177, 0x1ff, v177
    v_add_u32 v177, v177, v178
    v_mov_b64 v[184:185], 0
    v_mov_b64 v[186:187], 0
    v_lshrrev_b32 v188, 2, v247
    v_and_b32 v188, 12, v188
    v_subrev_u32 v188, s25, v188
    v_mov_b32 v189, 0x358637bd
    v_mfma_f32_32x32x16_bf16 v[144:159], v[184:187], v[184:187], 0
    v_cmp_ne_u32 s[80:81], 0, v188
    v_cmp_ne_u32 s[82:83], -1, v188
    v_cmp_ne_u32 s[84:85], -2, v188
    v_cmp_ne_u32 s[86:87], -3, v188
    v_cndmask_b32 v128, 0, v189, s[80:81]
    v_cndmask_b32 v129, 0, v189, s[82:83]
    v_cndmask_b32 v130, 0, v189, s[84:85]
    v_cndmask_b32 v131, 0, v189, s[86:87]
    v_mov_b64 v[132:133], v[128:129]
    v_mov_b64 v[134:135], v[130:131]
    v_mov_b64 v[136:137], v[128:129]
    v_mov_b64 v[138:139], v[130:131]
    v_mov_b64 v[140:141], v[128:129]
    v_mov_b64 v[142:143], v[130:131]
    ds_read_b128 v[160:163], v176 offset:0
    ds_read_b128 v[164:167], v176 offset:64
    ds_read_b128 v[168:171], v177 offset:0
    ds_read_b128 v[172:175], v177 offset:64
    s_mov_b32 s34, 0xbfb8aa3b
    s_mov_b32 s35, s34
    s_waitcnt lgkmcnt(3)
    v_mfma_f32_16x16x32_bf16 v[204:207], v[160:163], v[96:99], 0
    v_mfma_f32_16x16x32_bf16 v[212:215], v[160:163], v[104:107], 0
    v_mfma_f32_16x16x32_bf16 v[220:223], v[160:163], v[112:115], 0
    v_mfma_f32_16x16x32_bf16 v[228:231], v[160:163], v[120:123], 0
    s_waitcnt lgkmcnt(2)
    v_mfma_f32_16x16x32_bf16 v[204:207], v[164:167], v[100:103], v[204:207]
    v_mfma_f32_16x16x32_bf16 v[212:215], v[164:167], v[108:111], v[212:215]
    v_mfma_f32_16x16x32_bf16 v[220:223], v[164:167], v[116:119], v[220:223]
    v_mfma_f32_16x16x32_bf16 v[228:231], v[164:167], v[124:127], v[228:231]
    s_waitcnt lgkmcnt(1)
    v_mfma_f32_16x16x32_bf16 v[208:211], v[168:171], v[96:99], 0
    v_mfma_f32_16x16x32_bf16 v[216:219], v[168:171], v[104:107], 0
    v_mfma_f32_16x16x32_bf16 v[224:227], v[168:171], v[112:115], 0
    v_mfma_f32_16x16x32_bf16 v[232:235], v[168:171], v[120:123], 0
    s_waitcnt lgkmcnt(0)
    v_mfma_f32_16x16x32_bf16 v[208:211], v[172:175], v[100:103], v[208:211]
    v_mfma_f32_16x16x32_bf16 v[216:219], v[172:175], v[108:111], v[216:219]
    v_mfma_f32_16x16x32_bf16 v[224:227], v[172:175], v[116:119], v[224:227]
    v_mfma_f32_16x16x32_bf16 v[232:235], v[172:175], v[124:127], v[232:235]
    s_mov_b32 s10, 0x358637bd
    s_mov_b32 s11, s10
    v_mov_b64 v[96:97], s[10:11]
    v_mov_b64 v[98:99], s[10:11]
    v_mov_b64 v[100:101], s[10:11]
    v_mov_b64 v[102:103], s[10:11]
    v_mov_b64 v[104:105], s[10:11]
    v_mov_b64 v[106:107], s[10:11]
    v_mov_b64 v[108:109], s[10:11]
    v_mov_b64 v[110:111], s[10:11]
    v_pk_mul_f32 v[204:205], v[204:205], s[34:35]
    v_pk_mul_f32 v[206:207], v[206:207], s[34:35]
    v_pk_mul_f32 v[208:209], v[208:209], s[34:35]
    v_pk_mul_f32 v[210:211], v[210:211], s[34:35]
    v_pk_mul_f32 v[212:213], v[212:213], s[34:35]
    v_pk_mul_f32 v[214:215], v[214:215], s[34:35]
    v_pk_mul_f32 v[216:217], v[216:217], s[34:35]
    v_pk_mul_f32 v[218:219], v[218:219], s[34:35]
    v_pk_mul_f32 v[220:221], v[220:221], s[34:35]
    v_pk_mul_f32 v[222:223], v[222:223], s[34:35]
    v_pk_mul_f32 v[224:225], v[224:225], s[34:35]
    v_pk_mul_f32 v[226:227], v[226:227], s[34:35]
    v_pk_mul_f32 v[228:229], v[228:229], s[34:35]
    v_pk_mul_f32 v[230:231], v[230:231], s[34:35]
    v_pk_mul_f32 v[232:233], v[232:233], s[34:35]
    v_pk_mul_f32 v[234:235], v[234:235], s[34:35]
    v_mfma_f32_32x32x16_bf16 v[112:127], v[184:187], v[184:187], 0
    v_cvt_pk_bf16_f32 v64, v204, v205
    v_cvt_pk_bf16_f32 v65, v206, v207
    v_cvt_pk_bf16_f32 v66, v208, v209
    v_cvt_pk_bf16_f32 v67, v210, v211
    v_cvt_pk_bf16_f32 v68, v212, v213
    v_cvt_pk_bf16_f32 v69, v214, v215
    v_cvt_pk_bf16_f32 v70, v216, v217
    v_cvt_pk_bf16_f32 v71, v218, v219
    v_cvt_pk_bf16_f32 v72, v220, v221
    v_cvt_pk_bf16_f32 v73, v222, v223
    v_cvt_pk_bf16_f32 v74, v224, v225
    v_cvt_pk_bf16_f32 v75, v226, v227
    v_cvt_pk_bf16_f32 v76, v228, v229
    v_cvt_pk_bf16_f32 v77, v230, v231
    v_cvt_pk_bf16_f32 v78, v232, v233
    v_cvt_pk_bf16_f32 v79, v234, v235
    v_permlane32_swap_b32 v80, v64
    v_permlane32_swap_b32 v81, v65
    v_permlane32_swap_b32 v82, v66
    v_permlane32_swap_b32 v83, v67
    v_permlane32_swap_b32 v84, v68
    v_permlane32_swap_b32 v85, v69
    v_permlane32_swap_b32 v86, v70
    v_permlane32_swap_b32 v87, v71
    v_permlane32_swap_b32 v88, v72
    v_permlane32_swap_b32 v89, v73
    v_permlane32_swap_b32 v90, v74
    v_permlane32_swap_b32 v91, v75
    v_permlane32_swap_b32 v92, v76
    v_permlane32_swap_b32 v93, v77
    v_permlane32_swap_b32 v94, v78
    v_permlane32_swap_b32 v95, v79
L_SET:
    s_mov_b32 s26, -1
    s_mov_b64 s[32:33], 0
    s_mov_b32 s28, 0
    s_mov_b32 s29, 0
    s_cmp_lt_u32 s3, 4
    s_cbranch_scc1 L_HAD0
    s_lshl_b32 s72, s4, 7
    s_add_u32 s72, s72, 157824
    v_mov_b32 v190, s22
    s_mov_b32 exec_lo, 0xffff0000
    v_mov_b32 v190, s23
    s_mov_b32 exec_lo, -1
    s_mov_b32 exec_hi, 0
    v_sub_u32 v191, v247, v190
    v_and_b32 v191, 15, v191
    v_add_lshl_u32 v191, v191, v190, 5
    v_lshl_add_u32 v190, v247, 2, s72
    ds_write_b32 v190, v191
    s_mov_b32 exec_hi, -1
    s_mul_i32 s10, s5, 196
    s_add_u32 s11, s10, s7
    s_add_u32 s62, s10, s9
    s_min_u32 s11, s11, 50000
    s_min_u32 s62, s62, 50000
    s_sub_u32 s62, s62, s11
    s_lshl_b32 s11, s11, 7
    s_lshl_b32 s62, s62, 7
    s_add_u32 s60, s48, s11
    s_addc_u32 s61, s49, 0
    s_mul_i32 s74, s7, -128
    s_add_u32 s11, s10, s8
    s_add_u32 s50, s10, s24
    s_min_u32 s11, s11, 50000
    s_min_u32 s50, s50, 50000
    s_sub_u32 s50, s50, s11
    s_lshl_b32 s11, s11, 7
    s_lshl_b32 s50, s50, 7
    s_add_u32 s48, s48, s11
    s_addc_u32 s49, s49, 0
    s_mul_i32 s73, s8, -128
    s_and_b32 s10, s25, 12
    s_lshl_b32 s10, s10, 2
    s_bfm_b64 s[76:77], 16, s10
    s_add_u32 m0, s13, 0
    v_mad_u32_u16 v236, v236, s15, v243
    buffer_load_dwordx4 v236, s[40:43], 0 offen lds
    s_add_u32 m0, s13, 1056
    v_mad_u32_u16 v237, v237, s15, v243
    buffer_load_dwordx4 v237, s[40:43], 0 offen lds
    s_add_u32 m0, s13, 2112
    v_mad_u32_u16 v238, v238, s15, v243
    buffer_load_dwordx4 v238, s[40:43], 0 offen lds
    s_add_u32 m0, s13, 3168
    v_mad_u32_u16 v239, v239, s15, v243
    buffer_load_dwordx4 v239, s[40:43], 0 offen lds
    s_mov_b32 m0, s14
    s_nop 0
    buffer_load_dwordx4 v[240:241], s[44:47], 0 idxen offen lds
L_HAD0:
    s_cmp_eq_u32 s30, 0
    s_cbranch_scc1 L_GO
    s_lshl_b32 s10, s4, 3
    v_mov_b32 v188, s10
    ds_read_b64 v[188:189], v188 offset:576
    s_waitcnt lgkmcnt(0)
    v_readfirstlane_b32 s34, v188
    v_readfirstlane_b32 s35, v189
    s_sub_u32 s10, s12, 37888
    s_sub_u32 s34, s34, s10
    s_sub_u32 s35, s35, s10
    s_sub_u32 s35, s35, 1152
    s_add_u32 s10, s34, 127
    s_lshr_b32 s10, s10, 7
    s_lshl1_add_u32 s10, s10, -1
    s_add_u32 s11, s35, 127
    s_lshr_b32 s11, s11, 6
    s_and_b32 s11, s11, -2
    s_max_i32 s17, s10, s11
    s_cselect_b32 s10, s34, s35
    s_sub_u32 s10, s10, 1
    s_andn2_b32 s99, 64, s10
L_GO:
    ds_read_u16 v252, v250 offset:0
    ds_read_u16 v253, v250 offset:64
    ds_read_b128 v[236:239], v248 offset:1152
    ds_read_b32 v240, v249 offset:1152
    s_lshr_b32 s10, s4, 1
    s_lshl_b32 s10, s10, 9
    s_add_u32 s10, s10, 155776
    v_lshl_add_u32 v246, v247, 3, s10
    s_bitcmp1_b32 s4, 0
    s_cselect_b32 s101, -1, 1
    s_mul_i32 s10, s101, 0xff000000
    s_or_b32 s10, s10, 0xdddd
    v_mov_b32 v255, s10
    s_max_i32 s10, s17, 1
    s_sub_u32 s10, s10, 1
    s_mul_i32 s10, s101, s10
    s_lshl_b32 s10, s10, 24
    v_mov_b32 v188, s10
    ds_add_u32 v246, v188
    s_movk_i32 s94, 128
    s_movk_i32 s95, 128
    v_mov_b32 v247, 0
    s_mov_b32 exec_hi, 0
    v_add_u32 v247, 0x200, v245
    s_mov_b32 exec_hi, -1
    s_waitcnt lgkmcnt(0)
    v_bfi_b32 v252, 31, v245, v252
    v_bfi_b32 v253, 31, v245, v253
    v_max_u32 v252, v252, v245
    v_max_u32 v253, v253, v247
    s_waitcnt vmcnt(0)
    ds_read_b128 v[176:179], v252
    ds_read_b128 v[180:183], v253
    ds_read_b128 v[160:163], v244 offset:0
    ds_read_b128 v[168:171], v244 offset:512
    ds_read_b128 v[164:167], v244 offset:64
    ds_read_b128 v[172:175], v244 offset:576
    s_cmp_lt_i32 s17, 1
    s_cbranch_scc1 L_DONE
    s_waitcnt lgkmcnt(4)
    v_mfma_f32_16x16x32_bf16 v[188:191], v[176:179], v[64:67], 0
    v_mfma_f32_16x16x32_bf16 v[196:199], v[176:179], v[68:71], 0
    v_mfma_f32_16x16x32_bf16 v[192:195], v[180:183], v[64:67], 0
    v_mfma_f32_16x16x32_bf16 v[200:203], v[180:183], v[68:71], 0
    s_waitcnt lgkmcnt(0)
    v_mfma_f32_16x16x32_bf16 v[188:191], v[160:163], v[0:3], v[188:191]
    v_mfma_f32_16x16x32_bf16 v[196:199], v[160:163], v[8:11], v[196:199]
    v_mfma_f32_16x16x32_bf16 v[192:195], v[168:171], v[0:3], v[192:195]
    v_mfma_f32_16x16x32_bf16 v[200:203], v[168:171], v[8:11], v[200:203]
    v_mfma_f32_16x16x32_bf16 v[188:191], v[164:167], v[4:7], v[188:191]
    v_mfma_f32_16x16x32_bf16 v[196:199], v[164:167], v[12:15], v[196:199]
    v_mfma_f32_16x16x32_bf16 v[192:195], v[172:175], v[4:7], v[192:195]
    v_mfma_f32_16x16x32_bf16 v[200:203], v[172:175], v[12:15], v[200:203]
    s_mov_b32 s16, 1
    s_cmp_eq_u32 s17, 1
    s_cbranch_scc1 L_LT0
    s_add_u32 m0, s13, 0
    v_mad_u32_u16 v236, v236, s15, v243
    buffer_load_dwordx4 v236, s[40:43], 0 offen lds
    s_add_u32 m0, s13, 1056
    v_mad_u32_u16 v237, v237, s15, v243
    buffer_load_dwordx4 v237, s[40:43], 0 offen lds
    s_add_u32 m0, s13, 2112
    v_mad_u32_u16 v238, v238, s15, v243
    buffer_load_dwordx4 v238, s[40:43], 0 offen lds
    s_add_u32 m0, s13, 3168
    v_mad_u32_u16 v239, v239, s15, v243
    buffer_load_dwordx4 v239, s[40:43], 0 offen lds
    s_mov_b32 m0, s14
    s_nop 0
    buffer_load_dwordx4 v[240:241], s[44:47], 0 idxen offen lds
.p2align 6
L_LOOP1:
    s_setprio 1
    v_smfmac_f32_16x16x64_bf16 v[152:155], v[184:187], v[204:211], v255
    ds_read_u16 v236, v251 offset:0
    ds_read_u16 v237, v251 offset:16
    ds_add_rtn_u32 v238, v246, v255
    v_exp_f32 v188, v188
    v_smfmac_f32_16x16x64_bf16 v[156:159], v[184:187], v[212:219], v255
    v_exp_f32 v189, v189
    v_mfma_f32_16x16x32_bf16 v[204:207], v[160:163], v[32:35], 0
    v_exp_f32 v190, v190
    v_mfma_f32_16x16x32_bf16 v[212:215], v[160:163], v[40:43], 0
    v_exp_f32 v191, v191
    v_mfma_f32_16x16x32_bf16 v[208:211], v[168:171], v[32:35], 0
    v_exp_f32 v192, v192
    v_mfma_f32_16x16x32_bf16 v[216:219], v[168:171], v[40:43], 0
    v_exp_f32 v193, v193
    v_mfma_f32_16x16x32_bf16 v[204:207], v[164:167], v[36:39], v[204:207]
    v_exp_f32 v194, v194
    v_mfma_f32_16x16x32_bf16 v[212:215], v[164:167], v[44:47], v[212:215]
    v_exp_f32 v195, v195
    v_mfma_f32_16x16x32_bf16 v[208:211], v[172:175], v[36:39], v[208:211]
    s_waitcnt lgkmcnt(0)
    v_bfi_b32 v236, 31, v246, v236
    v_bfi_b32 v237, 31, v246, v237
    v_readfirstlane_b32 s96, v238
    v_exp_f32 v196, v196
    v_mfma_f32_16x16x32_bf16 v[216:219], v[172:175], v[44:47], v[216:219]
    v_exp_f32 v197, v197
    v_smfmac_f32_16x16x64_bf16 v[136:139], v[184:187], v[220:227], v255
    v_exp_f32 v198, v198
    v_smfmac_f32_16x16x64_bf16 v[140:143], v[184:187], v[228:235], v255
    v_exp_f32 v199, v199
    v_mfma_f32_4x4x4_16b_bf16 v[188:191], v[242:243], v[242:243], v[188:191]
    v_exp_f32 v200, v200
    v_mfma_f32_4x4x4_16b_bf16 v[192:195], v[242:243], v[242:243], v[192:195]
    v_exp_f32 v201, v201
    v_mfma_f32_4x4x4_16b_bf16 v[196:199], v[242:243], v[242:243], v[196:199]
    v_exp_f32 v202, v202
    v_mfma_f32_16x16x32_bf16 v[220:223], v[176:179], v[72:75], 0
    ds_read_b64_tr_b16 v[184:185], v236
    ds_read_b64_tr_b16 v[186:187], v237
    ds_read_u16 v252, v250 offset:1152
    ds_read_u16 v253, v250 offset:1216
    v_exp_f32 v203, v203
    v_mfma_f32_16x16x32_bf16 v[228:231], v[176:179], v[76:79], 0
    s_ashr_i32 s96, s96, 24
    s_mul_i32 s96, s96, s101
    v_rcp_f32 v188, v188
    v_mfma_f32_16x16x32_bf16 v[224:227], v[180:183], v[72:75], 0
    v_rcp_f32 v189, v189
    v_mfma_f32_4x4x4_16b_bf16 v[200:203], v[242:243], v[242:243], v[200:203]
    v_rcp_f32 v190, v190
    v_mfma_f32_16x16x32_bf16 v[232:235], v[180:183], v[76:79], 0
    v_rcp_f32 v191, v191
    v_mfma_f32_16x16x32_bf16 v[220:223], v[160:163], v[16:19], v[220:223]
    v_rcp_f32 v192, v192
    v_mfma_f32_16x16x32_bf16 v[228:231], v[160:163], v[24:27], v[228:231]
    v_rcp_f32 v193, v193
    v_mfma_f32_16x16x32_bf16 v[224:227], v[168:171], v[16:19], v[224:227]
    s_waitcnt lgkmcnt(0)
    v_bfi_b32 v252, 31, v245, v252
    v_bfi_b32 v253, 31, v245, v253
    v_max_u32 v252, v252, v245
    v_max_u32 v253, v253, v247
    ds_read_b128 v[236:239], v248 offset:128
    ds_read_b32 v240, v249 offset:128
    s_add_u32 s16, s16, 1
    v_rcp_f32 v194, v194
    v_mfma_f32_16x16x32_bf16 v[232:235], v[168:171], v[24:27], v[232:235]
    v_rcp_f32 v195, v195
    v_mfma_f32_16x16x32_bf16 v[220:223], v[164:167], v[20:23], v[220:223]
    v_rcp_f32 v196, v196
    v_mfma_f32_16x16x32_bf16 v[228:231], v[164:167], v[28:31], v[228:231]
    v_rcp_f32 v197, v197
    s_setprio 3
    v_mfma_f32_16x16x32_bf16 v[224:227], v[172:175], v[20:23], v[224:227]
    v_rcp_f32 v198, v198
    v_mfma_f32_16x16x32_bf16 v[232:235], v[172:175], v[28:31], v[232:235]
    v_rcp_f32 v199, v199
    v_rcp_f32 v200, v200
    v_rcp_f32 v201, v201
    v_rcp_f32 v202, v202
    v_rcp_f32 v203, v203
    v_pk_mul_f32 v[204:205], v[188:189], v[204:205]
    v_pk_mul_f32 v[206:207], v[190:191], v[206:207]
    v_pk_mul_f32 v[208:209], v[192:193], v[208:209]
    v_pk_mul_f32 v[210:211], v[194:195], v[210:211]
    v_pk_mul_f32 v[212:213], v[196:197], v[212:213]
    v_pk_mul_f32 v[214:215], v[198:199], v[214:215]
    v_pk_mul_f32 v[216:217], v[200:201], v[216:217]
    v_pk_mul_f32 v[218:219], v[202:203], v[218:219]
    s_cmp_ge_i32 s96, 1
    s_cbranch_scc0 L_PB00
L_PB01:
    s_setprio 1
    v_smfmac_f32_16x16x64_bf16 v[112:115], v[184:187], v[204:211], v255
    v_exp_f32 v220, v220
    v_smfmac_f32_16x16x64_bf16 v[116:119], v[184:187], v[212:219], v255
    v_exp_f32 v221, v221
    s_waitcnt vmcnt(0)
    ds_read_b128 v[176:179], v252
    ds_read_b128 v[180:183], v253
    v_mfma_f32_16x16x32_bf16 v[204:207], v[160:163], v[48:51], 0
    v_exp_f32 v222, v222
    v_mfma_f32_16x16x32_bf16 v[212:215], v[160:163], v[56:59], 0
    ds_read_b128 v[160:163], v244 offset:0
    v_exp_f32 v223, v223
    v_mfma_f32_16x16x32_bf16 v[208:211], v[168:171], v[48:51], 0
    v_exp_f32 v224, v224
    v_mfma_f32_16x16x32_bf16 v[216:219], v[168:171], v[56:59], 0
    ds_read_b128 v[168:171], v244 offset:512
    v_exp_f32 v225, v225
    v_mfma_f32_16x16x32_bf16 v[204:207], v[164:167], v[52:55], v[204:207]
    v_exp_f32 v226, v226
    v_mfma_f32_16x16x32_bf16 v[212:215], v[164:167], v[60:63], v[212:215]
    ds_read_b128 v[164:167], v244 offset:64
    v_exp_f32 v227, v227
    v_mfma_f32_16x16x32_bf16 v[208:211], v[172:175], v[52:55], v[208:211]
    v_exp_f32 v228, v228
    v_mfma_f32_16x16x32_bf16 v[216:219], v[172:175], v[60:63], v[216:219]
    ds_read_b128 v[172:175], v244 offset:576
    v_exp_f32 v229, v229
    v_smfmac_f32_16x16x64_bf16 v[96:99], v[184:187], v[188:195], v255
    v_exp_f32 v230, v230
    v_smfmac_f32_16x16x64_bf16 v[100:103], v[184:187], v[196:203], v255
    v_exp_f32 v231, v231
    v_mfma_f32_4x4x4_16b_bf16 v[220:223], v[242:243], v[242:243], v[220:223]
    v_exp_f32 v232, v232
    v_mfma_f32_4x4x4_16b_bf16 v[224:227], v[242:243], v[242:243], v[224:227]
    v_exp_f32 v233, v233
    v_mfma_f32_4x4x4_16b_bf16 v[228:231], v[242:243], v[242:243], v[228:231]
    v_exp_f32 v234, v234
    s_waitcnt lgkmcnt(4)
    v_mfma_f32_16x16x32_bf16 v[188:191], v[176:179], v[80:83], 0
    v_exp_f32 v235, v235
    v_mfma_f32_16x16x32_bf16 v[196:199], v[176:179], v[84:87], 0
    v_rcp_f32 v220, v220
    v_mfma_f32_16x16x32_bf16 v[192:195], v[180:183], v[80:83], 0
    v_rcp_f32 v221, v221
    v_mfma_f32_4x4x4_16b_bf16 v[232:235], v[242:243], v[242:243], v[232:235]
    v_rcp_f32 v222, v222
    v_mfma_f32_16x16x32_bf16 v[200:203], v[180:183], v[84:87], 0
    v_rcp_f32 v223, v223
    s_waitcnt lgkmcnt(3)
    v_mfma_f32_16x16x32_bf16 v[188:191], v[160:163], v[0:3], v[188:191]
    v_rcp_f32 v224, v224
    v_mfma_f32_16x16x32_bf16 v[196:199], v[160:163], v[8:11], v[196:199]
    v_rcp_f32 v225, v225
    s_waitcnt lgkmcnt(2)
    v_mfma_f32_16x16x32_bf16 v[192:195], v[168:171], v[0:3], v[192:195]
    v_rcp_f32 v226, v226
    v_mfma_f32_16x16x32_bf16 v[200:203], v[168:171], v[8:11], v[200:203]
    v_rcp_f32 v227, v227
    s_waitcnt lgkmcnt(1)
    v_mfma_f32_16x16x32_bf16 v[188:191], v[164:167], v[4:7], v[188:191]
    v_rcp_f32 v228, v228
    v_mfma_f32_16x16x32_bf16 v[196:199], v[164:167], v[12:15], v[196:199]
    v_rcp_f32 v229, v229
    s_setprio 3
    s_waitcnt lgkmcnt(0)
    v_mfma_f32_16x16x32_bf16 v[192:195], v[172:175], v[4:7], v[192:195]
    s_cmp_lt_u32 s16, s17
    s_cbranch_scc0 L_ND01
    s_add_u32 m0, s13, 0
    v_mad_u32_u16 v236, v236, s15, v243
    buffer_load_dwordx4 v236, s[40:43], 0 offen lds
    s_add_u32 m0, s13, 1056
    v_mad_u32_u16 v237, v237, s15, v243
    buffer_load_dwordx4 v237, s[40:43], 0 offen lds
    s_add_u32 m0, s13, 2112
    v_mad_u32_u16 v238, v238, s15, v243
    buffer_load_dwordx4 v238, s[40:43], 0 offen lds
    s_add_u32 m0, s13, 3168
    v_mad_u32_u16 v239, v239, s15, v243
    buffer_load_dwordx4 v239, s[40:43], 0 offen lds
    s_mov_b32 m0, s14
    s_nop 0
    buffer_load_dwordx4 v[240:241], s[44:47], 0 idxen offen lds
L_ND01:
    v_rcp_f32 v230, v230
    v_mfma_f32_16x16x32_bf16 v[200:203], v[172:175], v[12:15], v[200:203]
    v_rcp_f32 v231, v231
    v_rcp_f32 v232, v232
    v_rcp_f32 v233, v233
    v_rcp_f32 v234, v234
    v_rcp_f32 v235, v235
    v_pk_mul_f32 v[204:205], v[220:221], v[204:205]
    v_pk_mul_f32 v[206:207], v[222:223], v[206:207]
    v_pk_mul_f32 v[208:209], v[224:225], v[208:209]
    v_pk_mul_f32 v[210:211], v[226:227], v[210:211]
    v_pk_mul_f32 v[212:213], v[228:229], v[212:213]
    v_pk_mul_f32 v[214:215], v[230:231], v[214:215]
    v_pk_mul_f32 v[216:217], v[232:233], v[216:217]
    v_pk_mul_f32 v[218:219], v[234:235], v[218:219]
    s_cmp_ge_u32 s16, s17
    s_cbranch_scc1 L_LT1
    s_setprio 1
    v_smfmac_f32_16x16x64_bf16 v[120:123], v[184:187], v[204:211], v255
    ds_read_u16 v236, v251 offset:1152
    ds_read_u16 v237, v251 offset:1168
    ds_add_rtn_u32 v238, v246, v255
    v_exp_f32 v188, v188
    v_smfmac_f32_16x16x64_bf16 v[124:127], v[184:187], v[212:219], v255
    v_exp_f32 v189, v189
    v_mfma_f32_16x16x32_bf16 v[204:207], v[160:163], v[32:35], 0
    v_exp_f32 v190, v190
    v_mfma_f32_16x16x32_bf16 v[212:215], v[160:163], v[40:43], 0
    v_exp_f32 v191, v191
    v_mfma_f32_16x16x32_bf16 v[208:211], v[168:171], v[32:35], 0
    v_exp_f32 v192, v192
    v_mfma_f32_16x16x32_bf16 v[216:219], v[168:171], v[40:43], 0
    v_exp_f32 v193, v193
    v_mfma_f32_16x16x32_bf16 v[204:207], v[164:167], v[36:39], v[204:207]
    v_exp_f32 v194, v194
    v_mfma_f32_16x16x32_bf16 v[212:215], v[164:167], v[44:47], v[212:215]
    v_exp_f32 v195, v195
    v_mfma_f32_16x16x32_bf16 v[208:211], v[172:175], v[36:39], v[208:211]
    s_waitcnt lgkmcnt(0)
    v_bfi_b32 v236, 31, v246, v236
    v_bfi_b32 v237, 31, v246, v237
    v_readfirstlane_b32 s96, v238
    v_exp_f32 v196, v196
    v_mfma_f32_16x16x32_bf16 v[216:219], v[172:175], v[44:47], v[216:219]
    v_exp_f32 v197, v197
    v_smfmac_f32_16x16x64_bf16 v[104:107], v[184:187], v[220:227], v255
    v_exp_f32 v198, v198
    v_smfmac_f32_16x16x64_bf16 v[108:111], v[184:187], v[228:235], v255
    v_exp_f32 v199, v199
    v_mfma_f32_4x4x4_16b_bf16 v[188:191], v[242:243], v[242:243], v[188:191]
    v_exp_f32 v200, v200
    v_mfma_f32_4x4x4_16b_bf16 v[192:195], v[242:243], v[242:243], v[192:195]
    v_exp_f32 v201, v201
    v_mfma_f32_4x4x4_16b_bf16 v[196:199], v[242:243], v[242:243], v[196:199]
    v_exp_f32 v202, v202
    v_mfma_f32_16x16x32_bf16 v[220:223], v[176:179], v[88:91], 0
    ds_read_b64_tr_b16 v[184:185], v236
    ds_read_b64_tr_b16 v[186:187], v237
    ds_read_u16 v252, v250 offset:128
    ds_read_u16 v253, v250 offset:192
    v_exp_f32 v203, v203
    v_mfma_f32_16x16x32_bf16 v[228:231], v[176:179], v[92:95], 0
    s_ashr_i32 s96, s96, 24
    s_mul_i32 s96, s96, s101
    v_rcp_f32 v188, v188
    v_mfma_f32_16x16x32_bf16 v[224:227], v[180:183], v[88:91], 0
    v_rcp_f32 v189, v189
    v_mfma_f32_4x4x4_16b_bf16 v[200:203], v[242:243], v[242:243], v[200:203]
    v_rcp_f32 v190, v190
    v_mfma_f32_16x16x32_bf16 v[232:235], v[180:183], v[92:95], 0
    v_rcp_f32 v191, v191
    v_mfma_f32_16x16x32_bf16 v[220:223], v[160:163], v[16:19], v[220:223]
    v_rcp_f32 v192, v192
    v_mfma_f32_16x16x32_bf16 v[228:231], v[160:163], v[24:27], v[228:231]
    v_rcp_f32 v193, v193
    v_mfma_f32_16x16x32_bf16 v[224:227], v[168:171], v[16:19], v[224:227]
    s_waitcnt lgkmcnt(0)
    v_bfi_b32 v252, 31, v245, v252
    v_bfi_b32 v253, 31, v245, v253
    v_max_u32 v252, v252, v245
    v_max_u32 v253, v253, v247
    ds_read_b128 v[236:239], v248 offset:1280
    ds_read_b32 v240, v249 offset:1280
    s_add_u32 s16, s16, 1
    v_rcp_f32 v194, v194
    v_mfma_f32_16x16x32_bf16 v[232:235], v[168:171], v[24:27], v[232:235]
    v_lshl_add_u64 v[248:249], v[248:249], 0, s[94:95]
    v_lshl_add_u64 v[250:251], v[250:251], 0, s[94:95]
    v_rcp_f32 v195, v195
    v_mfma_f32_16x16x32_bf16 v[220:223], v[164:167], v[20:23], v[220:223]
    v_rcp_f32 v196, v196
    v_mfma_f32_16x16x32_bf16 v[228:231], v[164:167], v[28:31], v[228:231]
    v_rcp_f32 v197, v197
    s_setprio 3
    v_mfma_f32_16x16x32_bf16 v[224:227], v[172:175], v[20:23], v[224:227]
    v_rcp_f32 v198, v198
    v_mfma_f32_16x16x32_bf16 v[232:235], v[172:175], v[28:31], v[232:235]
    v_rcp_f32 v199, v199
    v_rcp_f32 v200, v200
    v_rcp_f32 v201, v201
    v_rcp_f32 v202, v202
    v_rcp_f32 v203, v203
    v_pk_mul_f32 v[204:205], v[188:189], v[204:205]
    v_pk_mul_f32 v[206:207], v[190:191], v[206:207]
    v_pk_mul_f32 v[208:209], v[192:193], v[208:209]
    v_pk_mul_f32 v[210:211], v[194:195], v[210:211]
    v_pk_mul_f32 v[212:213], v[196:197], v[212:213]
    v_pk_mul_f32 v[214:215], v[198:199], v[214:215]
    v_pk_mul_f32 v[216:217], v[200:201], v[216:217]
    v_pk_mul_f32 v[218:219], v[202:203], v[218:219]
    s_cmp_ge_i32 s96, 1
    s_cbranch_scc0 L_PB10
L_PB11:
    s_setprio 1
    v_smfmac_f32_16x16x64_bf16 v[144:147], v[184:187], v[204:211], v255
    v_exp_f32 v220, v220
    v_smfmac_f32_16x16x64_bf16 v[148:151], v[184:187], v[212:219], v255
    v_exp_f32 v221, v221
    s_waitcnt vmcnt(0)
    ds_read_b128 v[176:179], v252
    ds_read_b128 v[180:183], v253
    v_mfma_f32_16x16x32_bf16 v[204:207], v[160:163], v[48:51], 0
    v_exp_f32 v222, v222
    v_mfma_f32_16x16x32_bf16 v[212:215], v[160:163], v[56:59], 0
    ds_read_b128 v[160:163], v244 offset:0
    v_exp_f32 v223, v223
    v_mfma_f32_16x16x32_bf16 v[208:211], v[168:171], v[48:51], 0
    v_exp_f32 v224, v224
    v_mfma_f32_16x16x32_bf16 v[216:219], v[168:171], v[56:59], 0
    ds_read_b128 v[168:171], v244 offset:512
    v_exp_f32 v225, v225
    v_mfma_f32_16x16x32_bf16 v[204:207], v[164:167], v[52:55], v[204:207]
    v_exp_f32 v226, v226
    v_mfma_f32_16x16x32_bf16 v[212:215], v[164:167], v[60:63], v[212:215]
    ds_read_b128 v[164:167], v244 offset:64
    v_exp_f32 v227, v227
    v_mfma_f32_16x16x32_bf16 v[208:211], v[172:175], v[52:55], v[208:211]
    v_exp_f32 v228, v228
    v_mfma_f32_16x16x32_bf16 v[216:219], v[172:175], v[60:63], v[216:219]
    ds_read_b128 v[172:175], v244 offset:576
    v_exp_f32 v229, v229
    v_smfmac_f32_16x16x64_bf16 v[128:131], v[184:187], v[188:195], v255
    v_exp_f32 v230, v230
    v_smfmac_f32_16x16x64_bf16 v[132:135], v[184:187], v[196:203], v255
    v_exp_f32 v231, v231
    v_mfma_f32_4x4x4_16b_bf16 v[220:223], v[242:243], v[242:243], v[220:223]
    v_exp_f32 v232, v232
    v_mfma_f32_4x4x4_16b_bf16 v[224:227], v[242:243], v[242:243], v[224:227]
    v_exp_f32 v233, v233
    v_mfma_f32_4x4x4_16b_bf16 v[228:231], v[242:243], v[242:243], v[228:231]
    v_exp_f32 v234, v234
    s_waitcnt lgkmcnt(4)
    v_mfma_f32_16x16x32_bf16 v[188:191], v[176:179], v[64:67], 0
    v_exp_f32 v235, v235
    v_mfma_f32_16x16x32_bf16 v[196:199], v[176:179], v[68:71], 0
    v_rcp_f32 v220, v220
    v_mfma_f32_16x16x32_bf16 v[192:195], v[180:183], v[64:67], 0
    v_rcp_f32 v221, v221
    v_mfma_f32_4x4x4_16b_bf16 v[232:235], v[242:243], v[242:243], v[232:235]
    v_rcp_f32 v222, v222
    v_mfma_f32_16x16x32_bf16 v[200:203], v[180:183], v[68:71], 0
    v_rcp_f32 v223, v223
    s_waitcnt lgkmcnt(3)
    v_mfma_f32_16x16x32_bf16 v[188:191], v[160:163], v[0:3], v[188:191]
    v_rcp_f32 v224, v224
    v_mfma_f32_16x16x32_bf16 v[196:199], v[160:163], v[8:11], v[196:199]
    v_rcp_f32 v225, v225
    s_waitcnt lgkmcnt(2)
    v_mfma_f32_16x16x32_bf16 v[192:195], v[168:171], v[0:3], v[192:195]
    v_rcp_f32 v226, v226
    v_mfma_f32_16x16x32_bf16 v[200:203], v[168:171], v[8:11], v[200:203]
    v_rcp_f32 v227, v227
    s_waitcnt lgkmcnt(1)
    v_mfma_f32_16x16x32_bf16 v[188:191], v[164:167], v[4:7], v[188:191]
    v_rcp_f32 v228, v228
    v_mfma_f32_16x16x32_bf16 v[196:199], v[164:167], v[12:15], v[196:199]
    v_rcp_f32 v229, v229
    s_setprio 3
    s_waitcnt lgkmcnt(0)
    v_mfma_f32_16x16x32_bf16 v[192:195], v[172:175], v[4:7], v[192:195]
    s_cmp_lt_u32 s16, s17
    s_cbranch_scc0 L_ND11
    s_add_u32 m0, s13, 0
    v_mad_u32_u16 v236, v236, s15, v243
    buffer_load_dwordx4 v236, s[40:43], 0 offen lds
    s_add_u32 m0, s13, 1056
    v_mad_u32_u16 v237, v237, s15, v243
    buffer_load_dwordx4 v237, s[40:43], 0 offen lds
    s_add_u32 m0, s13, 2112
    v_mad_u32_u16 v238, v238, s15, v243
    buffer_load_dwordx4 v238, s[40:43], 0 offen lds
    s_add_u32 m0, s13, 3168
    v_mad_u32_u16 v239, v239, s15, v243
    buffer_load_dwordx4 v239, s[40:43], 0 offen lds
    s_mov_b32 m0, s14
    s_nop 0
    buffer_load_dwordx4 v[240:241], s[44:47], 0 idxen offen lds
L_ND11:
    v_rcp_f32 v230, v230
    v_mfma_f32_16x16x32_bf16 v[200:203], v[172:175], v[12:15], v[200:203]
    v_rcp_f32 v231, v231
    v_rcp_f32 v232, v232
    v_rcp_f32 v233, v233
    v_rcp_f32 v234, v234
    v_rcp_f32 v235, v235
    v_pk_mul_f32 v[204:205], v[220:221], v[204:205]
    v_pk_mul_f32 v[206:207], v[222:223], v[206:207]
    v_pk_mul_f32 v[208:209], v[224:225], v[208:209]
    v_pk_mul_f32 v[210:211], v[226:227], v[210:211]
    v_pk_mul_f32 v[212:213], v[228:229], v[212:213]
    v_pk_mul_f32 v[214:215], v[230:231], v[214:215]
    v_pk_mul_f32 v[216:217], v[232:233], v[216:217]
    v_pk_mul_f32 v[218:219], v[234:235], v[218:219]
    s_cmp_lt_u32 s16, s17
    s_cbranch_scc1 L_LOOP1
    s_branch L_LT0
.p2align 6
L_LOOP0:
    s_setprio 0
    v_smfmac_f32_16x16x64_bf16 v[152:155], v[184:187], v[204:211], v255
    ds_read_u16 v236, v251 offset:0
    ds_read_u16 v237, v251 offset:16
    ds_add_rtn_u32 v238, v246, v255
    v_exp_f32 v188, v188
    v_smfmac_f32_16x16x64_bf16 v[156:159], v[184:187], v[212:219], v255
    v_exp_f32 v189, v189
    v_mfma_f32_16x16x32_bf16 v[204:207], v[160:163], v[32:35], 0
    v_exp_f32 v190, v190
    v_mfma_f32_16x16x32_bf16 v[212:215], v[160:163], v[40:43], 0
    v_exp_f32 v191, v191
    v_mfma_f32_16x16x32_bf16 v[208:211], v[168:171], v[32:35], 0
    v_exp_f32 v192, v192
    v_mfma_f32_16x16x32_bf16 v[216:219], v[168:171], v[40:43], 0
    v_exp_f32 v193, v193
    v_mfma_f32_16x16x32_bf16 v[204:207], v[164:167], v[36:39], v[204:207]
    v_exp_f32 v194, v194
    v_mfma_f32_16x16x32_bf16 v[212:215], v[164:167], v[44:47], v[212:215]
    v_exp_f32 v195, v195
    v_mfma_f32_16x16x32_bf16 v[208:211], v[172:175], v[36:39], v[208:211]
    s_waitcnt lgkmcnt(0)
    v_bfi_b32 v236, 31, v246, v236
    v_bfi_b32 v237, 31, v246, v237
    v_readfirstlane_b32 s96, v238
    v_exp_f32 v196, v196
    v_mfma_f32_16x16x32_bf16 v[216:219], v[172:175], v[44:47], v[216:219]
    v_exp_f32 v197, v197
    v_smfmac_f32_16x16x64_bf16 v[136:139], v[184:187], v[220:227], v255
    v_exp_f32 v198, v198
    v_smfmac_f32_16x16x64_bf16 v[140:143], v[184:187], v[228:235], v255
    v_exp_f32 v199, v199
    v_mfma_f32_4x4x4_16b_bf16 v[188:191], v[242:243], v[242:243], v[188:191]
    v_exp_f32 v200, v200
    v_mfma_f32_4x4x4_16b_bf16 v[192:195], v[242:243], v[242:243], v[192:195]
    v_exp_f32 v201, v201
    v_mfma_f32_4x4x4_16b_bf16 v[196:199], v[242:243], v[242:243], v[196:199]
    v_exp_f32 v202, v202
    v_mfma_f32_16x16x32_bf16 v[220:223], v[176:179], v[72:75], 0
    ds_read_b64_tr_b16 v[184:185], v236
    ds_read_b64_tr_b16 v[186:187], v237
    ds_read_u16 v252, v250 offset:1152
    ds_read_u16 v253, v250 offset:1216
    v_exp_f32 v203, v203
    v_mfma_f32_16x16x32_bf16 v[228:231], v[176:179], v[76:79], 0
    s_ashr_i32 s96, s96, 24
    s_mul_i32 s96, s96, s101
    v_rcp_f32 v188, v188
    v_mfma_f32_16x16x32_bf16 v[224:227], v[180:183], v[72:75], 0
    v_rcp_f32 v189, v189
    v_mfma_f32_4x4x4_16b_bf16 v[200:203], v[242:243], v[242:243], v[200:203]
    v_rcp_f32 v190, v190
    v_mfma_f32_16x16x32_bf16 v[232:235], v[180:183], v[76:79], 0
    v_rcp_f32 v191, v191
    v_mfma_f32_16x16x32_bf16 v[220:223], v[160:163], v[16:19], v[220:223]
    v_rcp_f32 v192, v192
    v_mfma_f32_16x16x32_bf16 v[228:231], v[160:163], v[24:27], v[228:231]
    v_rcp_f32 v193, v193
    v_mfma_f32_16x16x32_bf16 v[224:227], v[168:171], v[16:19], v[224:227]
    s_waitcnt lgkmcnt(0)
    v_bfi_b32 v252, 31, v245, v252
    v_bfi_b32 v253, 31, v245, v253
    v_max_u32 v252, v252, v245
    v_max_u32 v253, v253, v247
    ds_read_b128 v[236:239], v248 offset:128
    ds_read_b32 v240, v249 offset:128
    s_add_u32 s16, s16, 1
    v_rcp_f32 v194, v194
    v_mfma_f32_16x16x32_bf16 v[232:235], v[168:171], v[24:27], v[232:235]
    v_rcp_f32 v195, v195
    v_mfma_f32_16x16x32_bf16 v[220:223], v[164:167], v[20:23], v[220:223]
    v_rcp_f32 v196, v196
    v_mfma_f32_16x16x32_bf16 v[228:231], v[164:167], v[28:31], v[228:231]
    v_rcp_f32 v197, v197
    s_setprio 3
    v_mfma_f32_16x16x32_bf16 v[224:227], v[172:175], v[20:23], v[224:227]
    v_rcp_f32 v198, v198
    v_mfma_f32_16x16x32_bf16 v[232:235], v[172:175], v[28:31], v[232:235]
    v_rcp_f32 v199, v199
    v_rcp_f32 v200, v200
    v_rcp_f32 v201, v201
    v_rcp_f32 v202, v202
    v_rcp_f32 v203, v203
    v_pk_mul_f32 v[204:205], v[188:189], v[204:205]
    v_pk_mul_f32 v[206:207], v[190:191], v[206:207]
    v_pk_mul_f32 v[208:209], v[192:193], v[208:209]
    v_pk_mul_f32 v[210:211], v[194:195], v[210:211]
    v_pk_mul_f32 v[212:213], v[196:197], v[212:213]
    v_pk_mul_f32 v[214:215], v[198:199], v[214:215]
    v_pk_mul_f32 v[216:217], v[200:201], v[216:217]
    v_pk_mul_f32 v[218:219], v[202:203], v[218:219]
    s_cmp_ge_i32 s96, 1
    s_cbranch_scc1 L_PB01
L_PB00:
    s_setprio 0
    v_smfmac_f32_16x16x64_bf16 v[112:115], v[184:187], v[204:211], v255
    v_exp_f32 v220, v220
    v_smfmac_f32_16x16x64_bf16 v[116:119], v[184:187], v[212:219], v255
    v_exp_f32 v221, v221
    s_waitcnt vmcnt(0)
    ds_read_b128 v[176:179], v252
    ds_read_b128 v[180:183], v253
    v_mfma_f32_16x16x32_bf16 v[204:207], v[160:163], v[48:51], 0
    v_exp_f32 v222, v222
    v_mfma_f32_16x16x32_bf16 v[212:215], v[160:163], v[56:59], 0
    ds_read_b128 v[160:163], v244 offset:0
    v_exp_f32 v223, v223
    v_mfma_f32_16x16x32_bf16 v[208:211], v[168:171], v[48:51], 0
    v_exp_f32 v224, v224
    v_mfma_f32_16x16x32_bf16 v[216:219], v[168:171], v[56:59], 0
    ds_read_b128 v[168:171], v244 offset:512
    v_exp_f32 v225, v225
    v_mfma_f32_16x16x32_bf16 v[204:207], v[164:167], v[52:55], v[204:207]
    v_exp_f32 v226, v226
    v_mfma_f32_16x16x32_bf16 v[212:215], v[164:167], v[60:63], v[212:215]
    ds_read_b128 v[164:167], v244 offset:64
    v_exp_f32 v227, v227
    v_mfma_f32_16x16x32_bf16 v[208:211], v[172:175], v[52:55], v[208:211]
    v_exp_f32 v228, v228
    v_mfma_f32_16x16x32_bf16 v[216:219], v[172:175], v[60:63], v[216:219]
    ds_read_b128 v[172:175], v244 offset:576
    v_exp_f32 v229, v229
    v_smfmac_f32_16x16x64_bf16 v[96:99], v[184:187], v[188:195], v255
    v_exp_f32 v230, v230
    v_smfmac_f32_16x16x64_bf16 v[100:103], v[184:187], v[196:203], v255
    v_exp_f32 v231, v231
    v_mfma_f32_4x4x4_16b_bf16 v[220:223], v[242:243], v[242:243], v[220:223]
    v_exp_f32 v232, v232
    v_mfma_f32_4x4x4_16b_bf16 v[224:227], v[242:243], v[242:243], v[224:227]
    v_exp_f32 v233, v233
    v_mfma_f32_4x4x4_16b_bf16 v[228:231], v[242:243], v[242:243], v[228:231]
    v_exp_f32 v234, v234
    s_waitcnt lgkmcnt(4)
    v_mfma_f32_16x16x32_bf16 v[188:191], v[176:179], v[80:83], 0
    v_exp_f32 v235, v235
    v_mfma_f32_16x16x32_bf16 v[196:199], v[176:179], v[84:87], 0
    v_rcp_f32 v220, v220
    v_mfma_f32_16x16x32_bf16 v[192:195], v[180:183], v[80:83], 0
    v_rcp_f32 v221, v221
    v_mfma_f32_4x4x4_16b_bf16 v[232:235], v[242:243], v[242:243], v[232:235]
    v_rcp_f32 v222, v222
    v_mfma_f32_16x16x32_bf16 v[200:203], v[180:183], v[84:87], 0
    v_rcp_f32 v223, v223
    s_waitcnt lgkmcnt(3)
    v_mfma_f32_16x16x32_bf16 v[188:191], v[160:163], v[0:3], v[188:191]
    v_rcp_f32 v224, v224
    v_mfma_f32_16x16x32_bf16 v[196:199], v[160:163], v[8:11], v[196:199]
    v_rcp_f32 v225, v225
    s_waitcnt lgkmcnt(2)
    v_mfma_f32_16x16x32_bf16 v[192:195], v[168:171], v[0:3], v[192:195]
    v_rcp_f32 v226, v226
    v_mfma_f32_16x16x32_bf16 v[200:203], v[168:171], v[8:11], v[200:203]
    v_rcp_f32 v227, v227
    s_waitcnt lgkmcnt(1)
    v_mfma_f32_16x16x32_bf16 v[188:191], v[164:167], v[4:7], v[188:191]
    v_rcp_f32 v228, v228
    v_mfma_f32_16x16x32_bf16 v[196:199], v[164:167], v[12:15], v[196:199]
    v_rcp_f32 v229, v229
    s_setprio 3
    s_waitcnt lgkmcnt(0)
    v_mfma_f32_16x16x32_bf16 v[192:195], v[172:175], v[4:7], v[192:195]
    s_cmp_lt_u32 s16, s17
    s_cbranch_scc0 L_ND00
    s_add_u32 m0, s13, 0
    v_mad_u32_u16 v236, v236, s15, v243
    buffer_load_dwordx4 v236, s[40:43], 0 offen lds
    s_add_u32 m0, s13, 1056
    v_mad_u32_u16 v237, v237, s15, v243
    buffer_load_dwordx4 v237, s[40:43], 0 offen lds
    s_add_u32 m0, s13, 2112
    v_mad_u32_u16 v238, v238, s15, v243
    buffer_load_dwordx4 v238, s[40:43], 0 offen lds
    s_add_u32 m0, s13, 3168
    v_mad_u32_u16 v239, v239, s15, v243
    buffer_load_dwordx4 v239, s[40:43], 0 offen lds
    s_mov_b32 m0, s14
    s_nop 0
    buffer_load_dwordx4 v[240:241], s[44:47], 0 idxen offen lds
L_ND00:
    v_rcp_f32 v230, v230
    v_mfma_f32_16x16x32_bf16 v[200:203], v[172:175], v[12:15], v[200:203]
    v_rcp_f32 v231, v231
    v_rcp_f32 v232, v232
    v_rcp_f32 v233, v233
    v_rcp_f32 v234, v234
    v_rcp_f32 v235, v235
    v_pk_mul_f32 v[204:205], v[220:221], v[204:205]
    v_pk_mul_f32 v[206:207], v[222:223], v[206:207]
    v_pk_mul_f32 v[208:209], v[224:225], v[208:209]
    v_pk_mul_f32 v[210:211], v[226:227], v[210:211]
    v_pk_mul_f32 v[212:213], v[228:229], v[212:213]
    v_pk_mul_f32 v[214:215], v[230:231], v[214:215]
    v_pk_mul_f32 v[216:217], v[232:233], v[216:217]
    v_pk_mul_f32 v[218:219], v[234:235], v[218:219]
    s_cmp_ge_u32 s16, s17
    s_cbranch_scc1 L_LT1
    s_setprio 0
    v_smfmac_f32_16x16x64_bf16 v[120:123], v[184:187], v[204:211], v255
    ds_read_u16 v236, v251 offset:1152
    ds_read_u16 v237, v251 offset:1168
    ds_add_rtn_u32 v238, v246, v255
    v_exp_f32 v188, v188
    v_smfmac_f32_16x16x64_bf16 v[124:127], v[184:187], v[212:219], v255
    v_exp_f32 v189, v189
    v_mfma_f32_16x16x32_bf16 v[204:207], v[160:163], v[32:35], 0
    v_exp_f32 v190, v190
    v_mfma_f32_16x16x32_bf16 v[212:215], v[160:163], v[40:43], 0
    v_exp_f32 v191, v191
    v_mfma_f32_16x16x32_bf16 v[208:211], v[168:171], v[32:35], 0
    v_exp_f32 v192, v192
    v_mfma_f32_16x16x32_bf16 v[216:219], v[168:171], v[40:43], 0
    v_exp_f32 v193, v193
    v_mfma_f32_16x16x32_bf16 v[204:207], v[164:167], v[36:39], v[204:207]
    v_exp_f32 v194, v194
    v_mfma_f32_16x16x32_bf16 v[212:215], v[164:167], v[44:47], v[212:215]
    v_exp_f32 v195, v195
    v_mfma_f32_16x16x32_bf16 v[208:211], v[172:175], v[36:39], v[208:211]
    s_waitcnt lgkmcnt(0)
    v_bfi_b32 v236, 31, v246, v236
    v_bfi_b32 v237, 31, v246, v237
    v_readfirstlane_b32 s96, v238
    v_exp_f32 v196, v196
    v_mfma_f32_16x16x32_bf16 v[216:219], v[172:175], v[44:47], v[216:219]
    v_exp_f32 v197, v197
    v_smfmac_f32_16x16x64_bf16 v[104:107], v[184:187], v[220:227], v255
    v_exp_f32 v198, v198
    v_smfmac_f32_16x16x64_bf16 v[108:111], v[184:187], v[228:235], v255
    v_exp_f32 v199, v199
    v_mfma_f32_4x4x4_16b_bf16 v[188:191], v[242:243], v[242:243], v[188:191]
    v_exp_f32 v200, v200
    v_mfma_f32_4x4x4_16b_bf16 v[192:195], v[242:243], v[242:243], v[192:195]
    v_exp_f32 v201, v201
    v_mfma_f32_4x4x4_16b_bf16 v[196:199], v[242:243], v[242:243], v[196:199]
    v_exp_f32 v202, v202
    v_mfma_f32_16x16x32_bf16 v[220:223], v[176:179], v[88:91], 0
    ds_read_b64_tr_b16 v[184:185], v236
    ds_read_b64_tr_b16 v[186:187], v237
    ds_read_u16 v252, v250 offset:128
    ds_read_u16 v253, v250 offset:192
    v_exp_f32 v203, v203
    v_mfma_f32_16x16x32_bf16 v[228:231], v[176:179], v[92:95], 0
    s_ashr_i32 s96, s96, 24
    s_mul_i32 s96, s96, s101
    v_rcp_f32 v188, v188
    v_mfma_f32_16x16x32_bf16 v[224:227], v[180:183], v[88:91], 0
    v_rcp_f32 v189, v189
    v_mfma_f32_4x4x4_16b_bf16 v[200:203], v[242:243], v[242:243], v[200:203]
    v_rcp_f32 v190, v190
    v_mfma_f32_16x16x32_bf16 v[232:235], v[180:183], v[92:95], 0
    v_rcp_f32 v191, v191
    v_mfma_f32_16x16x32_bf16 v[220:223], v[160:163], v[16:19], v[220:223]
    v_rcp_f32 v192, v192
    v_mfma_f32_16x16x32_bf16 v[228:231], v[160:163], v[24:27], v[228:231]
    v_rcp_f32 v193, v193
    v_mfma_f32_16x16x32_bf16 v[224:227], v[168:171], v[16:19], v[224:227]
    s_waitcnt lgkmcnt(0)
    v_bfi_b32 v252, 31, v245, v252
    v_bfi_b32 v253, 31, v245, v253
    v_max_u32 v252, v252, v245
    v_max_u32 v253, v253, v247
    ds_read_b128 v[236:239], v248 offset:1280
    ds_read_b32 v240, v249 offset:1280
    s_add_u32 s16, s16, 1
    v_rcp_f32 v194, v194
    v_mfma_f32_16x16x32_bf16 v[232:235], v[168:171], v[24:27], v[232:235]
    v_lshl_add_u64 v[248:249], v[248:249], 0, s[94:95]
    v_lshl_add_u64 v[250:251], v[250:251], 0, s[94:95]
    v_rcp_f32 v195, v195
    v_mfma_f32_16x16x32_bf16 v[220:223], v[164:167], v[20:23], v[220:223]
    v_rcp_f32 v196, v196
    v_mfma_f32_16x16x32_bf16 v[228:231], v[164:167], v[28:31], v[228:231]
    v_rcp_f32 v197, v197
    s_setprio 3
    v_mfma_f32_16x16x32_bf16 v[224:227], v[172:175], v[20:23], v[224:227]
    v_rcp_f32 v198, v198
    v_mfma_f32_16x16x32_bf16 v[232:235], v[172:175], v[28:31], v[232:235]
    v_rcp_f32 v199, v199
    v_rcp_f32 v200, v200
    v_rcp_f32 v201, v201
    v_rcp_f32 v202, v202
    v_rcp_f32 v203, v203
    v_pk_mul_f32 v[204:205], v[188:189], v[204:205]
    v_pk_mul_f32 v[206:207], v[190:191], v[206:207]
    v_pk_mul_f32 v[208:209], v[192:193], v[208:209]
    v_pk_mul_f32 v[210:211], v[194:195], v[210:211]
    v_pk_mul_f32 v[212:213], v[196:197], v[212:213]
    v_pk_mul_f32 v[214:215], v[198:199], v[214:215]
    v_pk_mul_f32 v[216:217], v[200:201], v[216:217]
    v_pk_mul_f32 v[218:219], v[202:203], v[218:219]
    s_cmp_ge_i32 s96, 1
    s_cbranch_scc1 L_PB11
L_PB10:
    s_setprio 0
    v_smfmac_f32_16x16x64_bf16 v[144:147], v[184:187], v[204:211], v255
    v_exp_f32 v220, v220
    v_smfmac_f32_16x16x64_bf16 v[148:151], v[184:187], v[212:219], v255
    v_exp_f32 v221, v221
    s_waitcnt vmcnt(0)
    ds_read_b128 v[176:179], v252
    ds_read_b128 v[180:183], v253
    v_mfma_f32_16x16x32_bf16 v[204:207], v[160:163], v[48:51], 0
    v_exp_f32 v222, v222
    v_mfma_f32_16x16x32_bf16 v[212:215], v[160:163], v[56:59], 0
    ds_read_b128 v[160:163], v244 offset:0
    v_exp_f32 v223, v223
    v_mfma_f32_16x16x32_bf16 v[208:211], v[168:171], v[48:51], 0
    v_exp_f32 v224, v224
    v_mfma_f32_16x16x32_bf16 v[216:219], v[168:171], v[56:59], 0
    ds_read_b128 v[168:171], v244 offset:512
    v_exp_f32 v225, v225
    v_mfma_f32_16x16x32_bf16 v[204:207], v[164:167], v[52:55], v[204:207]
    v_exp_f32 v226, v226
    v_mfma_f32_16x16x32_bf16 v[212:215], v[164:167], v[60:63], v[212:215]
    ds_read_b128 v[164:167], v244 offset:64
    v_exp_f32 v227, v227
    v_mfma_f32_16x16x32_bf16 v[208:211], v[172:175], v[52:55], v[208:211]
    v_exp_f32 v228, v228
    v_mfma_f32_16x16x32_bf16 v[216:219], v[172:175], v[60:63], v[216:219]
    ds_read_b128 v[172:175], v244 offset:576
    v_exp_f32 v229, v229
    v_smfmac_f32_16x16x64_bf16 v[128:131], v[184:187], v[188:195], v255
    v_exp_f32 v230, v230
    v_smfmac_f32_16x16x64_bf16 v[132:135], v[184:187], v[196:203], v255
    v_exp_f32 v231, v231
    v_mfma_f32_4x4x4_16b_bf16 v[220:223], v[242:243], v[242:243], v[220:223]
    v_exp_f32 v232, v232
    v_mfma_f32_4x4x4_16b_bf16 v[224:227], v[242:243], v[242:243], v[224:227]
    v_exp_f32 v233, v233
    v_mfma_f32_4x4x4_16b_bf16 v[228:231], v[242:243], v[242:243], v[228:231]
    v_exp_f32 v234, v234
    s_waitcnt lgkmcnt(4)
    v_mfma_f32_16x16x32_bf16 v[188:191], v[176:179], v[64:67], 0
    v_exp_f32 v235, v235
    v_mfma_f32_16x16x32_bf16 v[196:199], v[176:179], v[68:71], 0
    v_rcp_f32 v220, v220
    v_mfma_f32_16x16x32_bf16 v[192:195], v[180:183], v[64:67], 0
    v_rcp_f32 v221, v221
    v_mfma_f32_4x4x4_16b_bf16 v[232:235], v[242:243], v[242:243], v[232:235]
    v_rcp_f32 v222, v222
    v_mfma_f32_16x16x32_bf16 v[200:203], v[180:183], v[68:71], 0
    v_rcp_f32 v223, v223
    s_waitcnt lgkmcnt(3)
    v_mfma_f32_16x16x32_bf16 v[188:191], v[160:163], v[0:3], v[188:191]
    v_rcp_f32 v224, v224
    v_mfma_f32_16x16x32_bf16 v[196:199], v[160:163], v[8:11], v[196:199]
    v_rcp_f32 v225, v225
    s_waitcnt lgkmcnt(2)
    v_mfma_f32_16x16x32_bf16 v[192:195], v[168:171], v[0:3], v[192:195]
    v_rcp_f32 v226, v226
    v_mfma_f32_16x16x32_bf16 v[200:203], v[168:171], v[8:11], v[200:203]
    v_rcp_f32 v227, v227
    s_waitcnt lgkmcnt(1)
    v_mfma_f32_16x16x32_bf16 v[188:191], v[164:167], v[4:7], v[188:191]
    v_rcp_f32 v228, v228
    v_mfma_f32_16x16x32_bf16 v[196:199], v[164:167], v[12:15], v[196:199]
    v_rcp_f32 v229, v229
    s_setprio 3
    s_waitcnt lgkmcnt(0)
    v_mfma_f32_16x16x32_bf16 v[192:195], v[172:175], v[4:7], v[192:195]
    s_cmp_lt_u32 s16, s17
    s_cbranch_scc0 L_ND10
    s_add_u32 m0, s13, 0
    v_mad_u32_u16 v236, v236, s15, v243
    buffer_load_dwordx4 v236, s[40:43], 0 offen lds
    s_add_u32 m0, s13, 1056
    v_mad_u32_u16 v237, v237, s15, v243
    buffer_load_dwordx4 v237, s[40:43], 0 offen lds
    s_add_u32 m0, s13, 2112
    v_mad_u32_u16 v238, v238, s15, v243
    buffer_load_dwordx4 v238, s[40:43], 0 offen lds
    s_add_u32 m0, s13, 3168
    v_mad_u32_u16 v239, v239, s15, v243
    buffer_load_dwordx4 v239, s[40:43], 0 offen lds
    s_mov_b32 m0, s14
    s_nop 0
    buffer_load_dwordx4 v[240:241], s[44:47], 0 idxen offen lds
L_ND10:
    v_rcp_f32 v230, v230
    v_mfma_f32_16x16x32_bf16 v[200:203], v[172:175], v[12:15], v[200:203]
    v_rcp_f32 v231, v231
    v_rcp_f32 v232, v232
    v_rcp_f32 v233, v233
    v_rcp_f32 v234, v234
    v_rcp_f32 v235, v235
    v_pk_mul_f32 v[204:205], v[220:221], v[204:205]
    v_pk_mul_f32 v[206:207], v[222:223], v[206:207]
    v_pk_mul_f32 v[208:209], v[224:225], v[208:209]
    v_pk_mul_f32 v[210:211], v[226:227], v[210:211]
    v_pk_mul_f32 v[212:213], v[228:229], v[212:213]
    v_pk_mul_f32 v[214:215], v[230:231], v[214:215]
    v_pk_mul_f32 v[216:217], v[232:233], v[216:217]
    v_pk_mul_f32 v[218:219], v[234:235], v[218:219]
    s_cmp_lt_u32 s16, s17
    s_cbranch_scc1 L_LOOP0
    s_branch L_LT0
L_LT0:
    s_cmp_lg_u32 s99, 0
    s_cbranch_scc1 L_LH0
    s_setprio 0
    v_smfmac_f32_16x16x64_bf16 v[152:155], v[184:187], v[204:211], v255
    ds_read_u16 v236, v251 offset:0
    ds_read_u16 v237, v251 offset:16
    v_exp_f32 v188, v188
    v_smfmac_f32_16x16x64_bf16 v[156:159], v[184:187], v[212:219], v255
    v_exp_f32 v189, v189
    v_mfma_f32_16x16x32_bf16 v[204:207], v[160:163], v[32:35], 0
    v_exp_f32 v190, v190
    v_mfma_f32_16x16x32_bf16 v[212:215], v[160:163], v[40:43], 0
    v_exp_f32 v191, v191
    v_mfma_f32_16x16x32_bf16 v[208:211], v[168:171], v[32:35], 0
    v_exp_f32 v192, v192
    v_mfma_f32_16x16x32_bf16 v[216:219], v[168:171], v[40:43], 0
    v_exp_f32 v193, v193
    v_mfma_f32_16x16x32_bf16 v[204:207], v[164:167], v[36:39], v[204:207]
    v_exp_f32 v194, v194
    v_mfma_f32_16x16x32_bf16 v[212:215], v[164:167], v[44:47], v[212:215]
    v_exp_f32 v195, v195
    v_mfma_f32_16x16x32_bf16 v[208:211], v[172:175], v[36:39], v[208:211]
    v_exp_f32 v196, v196
    v_mfma_f32_16x16x32_bf16 v[216:219], v[172:175], v[44:47], v[216:219]
    v_exp_f32 v197, v197
    v_smfmac_f32_16x16x64_bf16 v[136:139], v[184:187], v[220:227], v255
    s_waitcnt lgkmcnt(0)
    v_bfi_b32 v236, 31, v246, v236
    v_bfi_b32 v237, 31, v246, v237
    v_exp_f32 v198, v198
    s_setprio 3
    v_smfmac_f32_16x16x64_bf16 v[140:143], v[184:187], v[228:235], v255
    v_exp_f32 v199, v199
    v_exp_f32 v200, v200
    v_exp_f32 v201, v201
    v_exp_f32 v202, v202
    v_exp_f32 v203, v203
    v_pk_add_f32 v[188:189], v[188:189], 1.0 op_sel_hi:[1,0]
    v_pk_add_f32 v[190:191], v[190:191], 1.0 op_sel_hi:[1,0]
    v_pk_add_f32 v[192:193], v[192:193], 1.0 op_sel_hi:[1,0]
    v_pk_add_f32 v[194:195], v[194:195], 1.0 op_sel_hi:[1,0]
    v_pk_add_f32 v[196:197], v[196:197], 1.0 op_sel_hi:[1,0]
    v_pk_add_f32 v[198:199], v[198:199], 1.0 op_sel_hi:[1,0]
    v_pk_add_f32 v[200:201], v[200:201], 1.0 op_sel_hi:[1,0]
    v_pk_add_f32 v[202:203], v[202:203], 1.0 op_sel_hi:[1,0]
    s_setprio 0
    v_mfma_f32_16x16x32_bf16 v[220:223], v[176:179], v[72:75], 0
    ds_read_b64_tr_b16 v[184:185], v236
    ds_read_b64_tr_b16 v[186:187], v237
    v_rcp_f32 v188, v188
    v_mfma_f32_16x16x32_bf16 v[228:231], v[176:179], v[76:79], 0
    v_rcp_f32 v189, v189
    v_mfma_f32_16x16x32_bf16 v[224:227], v[180:183], v[72:75], 0
    v_rcp_f32 v190, v190
    v_mfma_f32_16x16x32_bf16 v[232:235], v[180:183], v[76:79], 0
    v_rcp_f32 v191, v191
    v_mfma_f32_16x16x32_bf16 v[220:223], v[160:163], v[16:19], v[220:223]
    v_rcp_f32 v192, v192
    v_mfma_f32_16x16x32_bf16 v[228:231], v[160:163], v[24:27], v[228:231]
    v_rcp_f32 v193, v193
    v_mfma_f32_16x16x32_bf16 v[224:227], v[168:171], v[16:19], v[224:227]
    v_rcp_f32 v194, v194
    v_mfma_f32_16x16x32_bf16 v[232:235], v[168:171], v[24:27], v[232:235]
    v_rcp_f32 v195, v195
    v_mfma_f32_16x16x32_bf16 v[220:223], v[164:167], v[20:23], v[220:223]
    v_rcp_f32 v196, v196
    v_mfma_f32_16x16x32_bf16 v[228:231], v[164:167], v[28:31], v[228:231]
    v_rcp_f32 v197, v197
    v_mfma_f32_16x16x32_bf16 v[224:227], v[172:175], v[20:23], v[224:227]
    v_rcp_f32 v198, v198
    s_setprio 3
    v_mfma_f32_16x16x32_bf16 v[232:235], v[172:175], v[28:31], v[232:235]
    v_rcp_f32 v199, v199
    v_rcp_f32 v200, v200
    v_rcp_f32 v201, v201
    v_rcp_f32 v202, v202
    v_rcp_f32 v203, v203
    v_pk_mul_f32 v[204:205], v[188:189], v[204:205]
    v_pk_mul_f32 v[206:207], v[190:191], v[206:207]
    v_pk_mul_f32 v[208:209], v[192:193], v[208:209]
    v_pk_mul_f32 v[210:211], v[194:195], v[210:211]
    v_pk_mul_f32 v[212:213], v[196:197], v[212:213]
    v_pk_mul_f32 v[214:215], v[198:199], v[214:215]
    v_pk_mul_f32 v[216:217], v[200:201], v[216:217]
    v_pk_mul_f32 v[218:219], v[202:203], v[218:219]
    s_setprio 0
    s_waitcnt lgkmcnt(0)
    v_smfmac_f32_16x16x64_bf16 v[112:115], v[184:187], v[204:211], v255
    v_exp_f32 v220, v220
    v_smfmac_f32_16x16x64_bf16 v[116:119], v[184:187], v[212:219], v255
    v_exp_f32 v221, v221
    v_mfma_f32_16x16x32_bf16 v[204:207], v[160:163], v[48:51], 0
    v_exp_f32 v222, v222
    v_mfma_f32_16x16x32_bf16 v[212:215], v[160:163], v[56:59], 0
    v_exp_f32 v223, v223
    v_mfma_f32_16x16x32_bf16 v[208:211], v[168:171], v[48:51], 0
    v_exp_f32 v224, v224
    v_mfma_f32_16x16x32_bf16 v[216:219], v[168:171], v[56:59], 0
    v_exp_f32 v225, v225
    v_mfma_f32_16x16x32_bf16 v[204:207], v[164:167], v[52:55], v[204:207]
    v_exp_f32 v226, v226
    v_mfma_f32_16x16x32_bf16 v[212:215], v[164:167], v[60:63], v[212:215]
    v_exp_f32 v227, v227
    v_mfma_f32_16x16x32_bf16 v[208:211], v[172:175], v[52:55], v[208:211]
    v_exp_f32 v228, v228
    v_mfma_f32_16x16x32_bf16 v[216:219], v[172:175], v[60:63], v[216:219]
    v_exp_f32 v229, v229
    v_smfmac_f32_16x16x64_bf16 v[96:99], v[184:187], v[188:195], v255
    v_exp_f32 v230, v230
    s_setprio 3
    v_smfmac_f32_16x16x64_bf16 v[100:103], v[184:187], v[196:203], v255
    v_exp_f32 v231, v231
    v_exp_f32 v232, v232
    v_exp_f32 v233, v233
    v_exp_f32 v234, v234
    v_exp_f32 v235, v235
    v_pk_add_f32 v[220:221], v[220:221], 1.0 op_sel_hi:[1,0]
    v_pk_add_f32 v[222:223], v[222:223], 1.0 op_sel_hi:[1,0]
    v_pk_add_f32 v[224:225], v[224:225], 1.0 op_sel_hi:[1,0]
    v_pk_add_f32 v[226:227], v[226:227], 1.0 op_sel_hi:[1,0]
    v_pk_add_f32 v[228:229], v[228:229], 1.0 op_sel_hi:[1,0]
    v_pk_add_f32 v[230:231], v[230:231], 1.0 op_sel_hi:[1,0]
    v_pk_add_f32 v[232:233], v[232:233], 1.0 op_sel_hi:[1,0]
    v_pk_add_f32 v[234:235], v[234:235], 1.0 op_sel_hi:[1,0]
    s_setprio 0
    v_rcp_f32 v220, v220
    v_rcp_f32 v221, v221
    v_rcp_f32 v222, v222
    v_rcp_f32 v223, v223
    v_rcp_f32 v224, v224
    v_rcp_f32 v225, v225
    v_rcp_f32 v226, v226
    v_rcp_f32 v227, v227
    v_rcp_f32 v228, v228
    v_rcp_f32 v229, v229
    v_rcp_f32 v230, v230
    v_rcp_f32 v231, v231
    v_rcp_f32 v232, v232
    v_rcp_f32 v233, v233
    v_rcp_f32 v234, v234
    v_rcp_f32 v235, v235
    v_pk_mul_f32 v[204:205], v[220:221], v[204:205]
    v_pk_mul_f32 v[206:207], v[222:223], v[206:207]
    v_pk_mul_f32 v[208:209], v[224:225], v[208:209]
    v_pk_mul_f32 v[210:211], v[226:227], v[210:211]
    v_pk_mul_f32 v[212:213], v[228:229], v[212:213]
    v_pk_mul_f32 v[214:215], v[230:231], v[214:215]
    v_pk_mul_f32 v[216:217], v[232:233], v[216:217]
    v_pk_mul_f32 v[218:219], v[234:235], v[218:219]
    v_smfmac_f32_16x16x64_bf16 v[104:107], v[184:187], v[220:227], v255
    v_smfmac_f32_16x16x64_bf16 v[108:111], v[184:187], v[228:235], v255
    v_smfmac_f32_16x16x64_bf16 v[120:123], v[184:187], v[204:211], v255
    v_smfmac_f32_16x16x64_bf16 v[124:127], v[184:187], v[212:219], v255
    s_branch L_DONE
L_LH0:
    s_setprio 0
    v_smfmac_f32_16x16x64_bf16 v[152:155], v[184:187], v[204:211], v255
    ds_read_u16 v236, v251 offset:0
    ds_read_u16 v237, v251 offset:16
    v_smfmac_f32_16x16x64_bf16 v[156:159], v[184:187], v[212:219], v255
    v_exp_f32 v188, v188
    v_mfma_f32_16x16x32_bf16 v[204:207], v[160:163], v[32:35], 0
    v_mfma_f32_16x16x32_bf16 v[212:215], v[160:163], v[40:43], 0
    v_exp_f32 v189, v189
    v_mfma_f32_16x16x32_bf16 v[204:207], v[164:167], v[36:39], v[204:207]
    v_mfma_f32_16x16x32_bf16 v[212:215], v[164:167], v[44:47], v[212:215]
    v_exp_f32 v190, v190
    v_smfmac_f32_16x16x64_bf16 v[136:139], v[184:187], v[220:227], v255
    s_waitcnt lgkmcnt(0)
    v_bfi_b32 v236, 31, v246, v236
    v_bfi_b32 v237, 31, v246, v237
    v_exp_f32 v191, v191
    s_setprio 3
    v_smfmac_f32_16x16x64_bf16 v[140:143], v[184:187], v[228:235], v255
    v_exp_f32 v196, v196
    v_exp_f32 v197, v197
    v_exp_f32 v198, v198
    v_exp_f32 v199, v199
    v_pk_add_f32 v[188:189], v[188:189], 1.0 op_sel_hi:[1,0]
    v_pk_add_f32 v[190:191], v[190:191], 1.0 op_sel_hi:[1,0]
    v_pk_add_f32 v[196:197], v[196:197], 1.0 op_sel_hi:[1,0]
    v_pk_add_f32 v[198:199], v[198:199], 1.0 op_sel_hi:[1,0]
    s_setprio 0
    v_mfma_f32_16x16x32_bf16 v[220:223], v[176:179], v[72:75], 0
    ds_read_b64_tr_b16 v[184:185], v236
    ds_read_b64_tr_b16 v[186:187], v237
    v_mfma_f32_16x16x32_bf16 v[228:231], v[176:179], v[76:79], 0
    v_rcp_f32 v188, v188
    v_mfma_f32_16x16x32_bf16 v[220:223], v[160:163], v[16:19], v[220:223]
    v_rcp_f32 v189, v189
    v_mfma_f32_16x16x32_bf16 v[228:231], v[160:163], v[24:27], v[228:231]
    v_rcp_f32 v190, v190
    v_mfma_f32_16x16x32_bf16 v[220:223], v[164:167], v[20:23], v[220:223]
    v_rcp_f32 v191, v191
    s_setprio 3
    v_mfma_f32_16x16x32_bf16 v[228:231], v[164:167], v[28:31], v[228:231]
    v_rcp_f32 v196, v196
    v_rcp_f32 v197, v197
    v_rcp_f32 v198, v198
    v_rcp_f32 v199, v199
    v_pk_mul_f32 v[204:205], v[188:189], v[204:205]
    v_pk_mul_f32 v[206:207], v[190:191], v[206:207]
    v_pk_mul_f32 v[212:213], v[196:197], v[212:213]
    v_pk_mul_f32 v[214:215], v[198:199], v[214:215]
    s_setprio 0
    s_waitcnt lgkmcnt(0)
    v_smfmac_f32_16x16x64_bf16 v[112:115], v[184:187], v[204:211], v255
    v_smfmac_f32_16x16x64_bf16 v[116:119], v[184:187], v[212:219], v255
    v_exp_f32 v220, v220
    v_mfma_f32_16x16x32_bf16 v[204:207], v[160:163], v[48:51], 0
    v_mfma_f32_16x16x32_bf16 v[212:215], v[160:163], v[56:59], 0
    v_exp_f32 v221, v221
    v_mfma_f32_16x16x32_bf16 v[204:207], v[164:167], v[52:55], v[204:207]
    v_mfma_f32_16x16x32_bf16 v[212:215], v[164:167], v[60:63], v[212:215]
    v_exp_f32 v222, v222
    v_smfmac_f32_16x16x64_bf16 v[96:99], v[184:187], v[188:195], v255
    v_exp_f32 v223, v223
    s_setprio 3
    v_smfmac_f32_16x16x64_bf16 v[100:103], v[184:187], v[196:203], v255
    v_exp_f32 v228, v228
    v_exp_f32 v229, v229
    v_exp_f32 v230, v230
    v_exp_f32 v231, v231
    v_pk_add_f32 v[220:221], v[220:221], 1.0 op_sel_hi:[1,0]
    v_pk_add_f32 v[222:223], v[222:223], 1.0 op_sel_hi:[1,0]
    v_pk_add_f32 v[228:229], v[228:229], 1.0 op_sel_hi:[1,0]
    v_pk_add_f32 v[230:231], v[230:231], 1.0 op_sel_hi:[1,0]
    s_setprio 0
    v_rcp_f32 v220, v220
    v_rcp_f32 v221, v221
    v_rcp_f32 v222, v222
    v_rcp_f32 v223, v223
    v_rcp_f32 v228, v228
    v_rcp_f32 v229, v229
    v_rcp_f32 v230, v230
    v_rcp_f32 v231, v231
    v_pk_mul_f32 v[204:205], v[220:221], v[204:205]
    v_pk_mul_f32 v[206:207], v[222:223], v[206:207]
    v_pk_mul_f32 v[212:213], v[228:229], v[212:213]
    v_pk_mul_f32 v[214:215], v[230:231], v[214:215]
    v_smfmac_f32_16x16x64_bf16 v[104:107], v[184:187], v[220:227], v255
    v_smfmac_f32_16x16x64_bf16 v[108:111], v[184:187], v[228:235], v255
    v_smfmac_f32_16x16x64_bf16 v[120:123], v[184:187], v[204:211], v255
    v_smfmac_f32_16x16x64_bf16 v[124:127], v[184:187], v[212:219], v255
    s_branch L_DONE
L_LT1:
    s_cmp_lg_u32 s99, 0
    s_cbranch_scc1 L_LH1
    s_setprio 0
    v_smfmac_f32_16x16x64_bf16 v[120:123], v[184:187], v[204:211], v255
    ds_read_u16 v236, v251 offset:1152
    ds_read_u16 v237, v251 offset:1168
    v_exp_f32 v188, v188
    v_smfmac_f32_16x16x64_bf16 v[124:127], v[184:187], v[212:219], v255
    v_exp_f32 v189, v189
    v_mfma_f32_16x16x32_bf16 v[204:207], v[160:163], v[32:35], 0
    v_exp_f32 v190, v190
    v_mfma_f32_16x16x32_bf16 v[212:215], v[160:163], v[40:43], 0
    v_exp_f32 v191, v191
    v_mfma_f32_16x16x32_bf16 v[208:211], v[168:171], v[32:35], 0
    v_exp_f32 v192, v192
    v_mfma_f32_16x16x32_bf16 v[216:219], v[168:171], v[40:43], 0
    v_exp_f32 v193, v193
    v_mfma_f32_16x16x32_bf16 v[204:207], v[164:167], v[36:39], v[204:207]
    v_exp_f32 v194, v194
    v_mfma_f32_16x16x32_bf16 v[212:215], v[164:167], v[44:47], v[212:215]
    v_exp_f32 v195, v195
    v_mfma_f32_16x16x32_bf16 v[208:211], v[172:175], v[36:39], v[208:211]
    v_exp_f32 v196, v196
    v_mfma_f32_16x16x32_bf16 v[216:219], v[172:175], v[44:47], v[216:219]
    v_exp_f32 v197, v197
    v_smfmac_f32_16x16x64_bf16 v[104:107], v[184:187], v[220:227], v255
    s_waitcnt lgkmcnt(0)
    v_bfi_b32 v236, 31, v246, v236
    v_bfi_b32 v237, 31, v246, v237
    v_exp_f32 v198, v198
    s_setprio 3
    v_smfmac_f32_16x16x64_bf16 v[108:111], v[184:187], v[228:235], v255
    v_exp_f32 v199, v199
    v_exp_f32 v200, v200
    v_exp_f32 v201, v201
    v_exp_f32 v202, v202
    v_exp_f32 v203, v203
    v_pk_add_f32 v[188:189], v[188:189], 1.0 op_sel_hi:[1,0]
    v_pk_add_f32 v[190:191], v[190:191], 1.0 op_sel_hi:[1,0]
    v_pk_add_f32 v[192:193], v[192:193], 1.0 op_sel_hi:[1,0]
    v_pk_add_f32 v[194:195], v[194:195], 1.0 op_sel_hi:[1,0]
    v_pk_add_f32 v[196:197], v[196:197], 1.0 op_sel_hi:[1,0]
    v_pk_add_f32 v[198:199], v[198:199], 1.0 op_sel_hi:[1,0]
    v_pk_add_f32 v[200:201], v[200:201], 1.0 op_sel_hi:[1,0]
    v_pk_add_f32 v[202:203], v[202:203], 1.0 op_sel_hi:[1,0]
    s_setprio 0
    v_mfma_f32_16x16x32_bf16 v[220:223], v[176:179], v[88:91], 0
    ds_read_b64_tr_b16 v[184:185], v236
    ds_read_b64_tr_b16 v[186:187], v237
    v_rcp_f32 v188, v188
    v_mfma_f32_16x16x32_bf16 v[228:231], v[176:179], v[92:95], 0
    v_rcp_f32 v189, v189
    v_mfma_f32_16x16x32_bf16 v[224:227], v[180:183], v[88:91], 0
    v_rcp_f32 v190, v190
    v_mfma_f32_16x16x32_bf16 v[232:235], v[180:183], v[92:95], 0
    v_rcp_f32 v191, v191
    v_mfma_f32_16x16x32_bf16 v[220:223], v[160:163], v[16:19], v[220:223]
    v_rcp_f32 v192, v192
    v_mfma_f32_16x16x32_bf16 v[228:231], v[160:163], v[24:27], v[228:231]
    v_rcp_f32 v193, v193
    v_mfma_f32_16x16x32_bf16 v[224:227], v[168:171], v[16:19], v[224:227]
    v_rcp_f32 v194, v194
    v_mfma_f32_16x16x32_bf16 v[232:235], v[168:171], v[24:27], v[232:235]
    v_rcp_f32 v195, v195
    v_mfma_f32_16x16x32_bf16 v[220:223], v[164:167], v[20:23], v[220:223]
    v_rcp_f32 v196, v196
    v_mfma_f32_16x16x32_bf16 v[228:231], v[164:167], v[28:31], v[228:231]
    v_rcp_f32 v197, v197
    v_mfma_f32_16x16x32_bf16 v[224:227], v[172:175], v[20:23], v[224:227]
    v_rcp_f32 v198, v198
    s_setprio 3
    v_mfma_f32_16x16x32_bf16 v[232:235], v[172:175], v[28:31], v[232:235]
    v_rcp_f32 v199, v199
    v_rcp_f32 v200, v200
    v_rcp_f32 v201, v201
    v_rcp_f32 v202, v202
    v_rcp_f32 v203, v203
    v_pk_mul_f32 v[204:205], v[188:189], v[204:205]
    v_pk_mul_f32 v[206:207], v[190:191], v[206:207]
    v_pk_mul_f32 v[208:209], v[192:193], v[208:209]
    v_pk_mul_f32 v[210:211], v[194:195], v[210:211]
    v_pk_mul_f32 v[212:213], v[196:197], v[212:213]
    v_pk_mul_f32 v[214:215], v[198:199], v[214:215]
    v_pk_mul_f32 v[216:217], v[200:201], v[216:217]
    v_pk_mul_f32 v[218:219], v[202:203], v[218:219]
    s_setprio 0
    s_waitcnt lgkmcnt(0)
    v_smfmac_f32_16x16x64_bf16 v[144:147], v[184:187], v[204:211], v255
    v_exp_f32 v220, v220
    v_smfmac_f32_16x16x64_bf16 v[148:151], v[184:187], v[212:219], v255
    v_exp_f32 v221, v221
    v_mfma_f32_16x16x32_bf16 v[204:207], v[160:163], v[48:51], 0
    v_exp_f32 v222, v222
    v_mfma_f32_16x16x32_bf16 v[212:215], v[160:163], v[56:59], 0
    v_exp_f32 v223, v223
    v_mfma_f32_16x16x32_bf16 v[208:211], v[168:171], v[48:51], 0
    v_exp_f32 v224, v224
    v_mfma_f32_16x16x32_bf16 v[216:219], v[168:171], v[56:59], 0
    v_exp_f32 v225, v225
    v_mfma_f32_16x16x32_bf16 v[204:207], v[164:167], v[52:55], v[204:207]
    v_exp_f32 v226, v226
    v_mfma_f32_16x16x32_bf16 v[212:215], v[164:167], v[60:63], v[212:215]
    v_exp_f32 v227, v227
    v_mfma_f32_16x16x32_bf16 v[208:211], v[172:175], v[52:55], v[208:211]
    v_exp_f32 v228, v228
    v_mfma_f32_16x16x32_bf16 v[216:219], v[172:175], v[60:63], v[216:219]
    v_exp_f32 v229, v229
    v_smfmac_f32_16x16x64_bf16 v[128:131], v[184:187], v[188:195], v255
    v_exp_f32 v230, v230
    s_setprio 3
    v_smfmac_f32_16x16x64_bf16 v[132:135], v[184:187], v[196:203], v255
    v_exp_f32 v231, v231
    v_exp_f32 v232, v232
    v_exp_f32 v233, v233
    v_exp_f32 v234, v234
    v_exp_f32 v235, v235
    v_pk_add_f32 v[220:221], v[220:221], 1.0 op_sel_hi:[1,0]
    v_pk_add_f32 v[222:223], v[222:223], 1.0 op_sel_hi:[1,0]
    v_pk_add_f32 v[224:225], v[224:225], 1.0 op_sel_hi:[1,0]
    v_pk_add_f32 v[226:227], v[226:227], 1.0 op_sel_hi:[1,0]
    v_pk_add_f32 v[228:229], v[228:229], 1.0 op_sel_hi:[1,0]
    v_pk_add_f32 v[230:231], v[230:231], 1.0 op_sel_hi:[1,0]
    v_pk_add_f32 v[232:233], v[232:233], 1.0 op_sel_hi:[1,0]
    v_pk_add_f32 v[234:235], v[234:235], 1.0 op_sel_hi:[1,0]
    s_setprio 0
    v_rcp_f32 v220, v220
    v_rcp_f32 v221, v221
    v_rcp_f32 v222, v222
    v_rcp_f32 v223, v223
    v_rcp_f32 v224, v224
    v_rcp_f32 v225, v225
    v_rcp_f32 v226, v226
    v_rcp_f32 v227, v227
    v_rcp_f32 v228, v228
    v_rcp_f32 v229, v229
    v_rcp_f32 v230, v230
    v_rcp_f32 v231, v231
    v_rcp_f32 v232, v232
    v_rcp_f32 v233, v233
    v_rcp_f32 v234, v234
    v_rcp_f32 v235, v235
    v_pk_mul_f32 v[204:205], v[220:221], v[204:205]
    v_pk_mul_f32 v[206:207], v[222:223], v[206:207]
    v_pk_mul_f32 v[208:209], v[224:225], v[208:209]
    v_pk_mul_f32 v[210:211], v[226:227], v[210:211]
    v_pk_mul_f32 v[212:213], v[228:229], v[212:213]
    v_pk_mul_f32 v[214:215], v[230:231], v[214:215]
    v_pk_mul_f32 v[216:217], v[232:233], v[216:217]
    v_pk_mul_f32 v[218:219], v[234:235], v[218:219]
    v_smfmac_f32_16x16x64_bf16 v[136:139], v[184:187], v[220:227], v255
    v_smfmac_f32_16x16x64_bf16 v[140:143], v[184:187], v[228:235], v255
    v_smfmac_f32_16x16x64_bf16 v[152:155], v[184:187], v[204:211], v255
    v_smfmac_f32_16x16x64_bf16 v[156:159], v[184:187], v[212:219], v255
    s_branch L_DONE
L_LH1:
    s_setprio 0
    v_smfmac_f32_16x16x64_bf16 v[120:123], v[184:187], v[204:211], v255
    ds_read_u16 v236, v251 offset:1152
    ds_read_u16 v237, v251 offset:1168
    v_smfmac_f32_16x16x64_bf16 v[124:127], v[184:187], v[212:219], v255
    v_exp_f32 v188, v188
    v_mfma_f32_16x16x32_bf16 v[204:207], v[160:163], v[32:35], 0
    v_mfma_f32_16x16x32_bf16 v[212:215], v[160:163], v[40:43], 0
    v_exp_f32 v189, v189
    v_mfma_f32_16x16x32_bf16 v[204:207], v[164:167], v[36:39], v[204:207]
    v_mfma_f32_16x16x32_bf16 v[212:215], v[164:167], v[44:47], v[212:215]
    v_exp_f32 v190, v190
    v_smfmac_f32_16x16x64_bf16 v[104:107], v[184:187], v[220:227], v255
    s_waitcnt lgkmcnt(0)
    v_bfi_b32 v236, 31, v246, v236
    v_bfi_b32 v237, 31, v246, v237
    v_exp_f32 v191, v191
    s_setprio 3
    v_smfmac_f32_16x16x64_bf16 v[108:111], v[184:187], v[228:235], v255
    v_exp_f32 v196, v196
    v_exp_f32 v197, v197
    v_exp_f32 v198, v198
    v_exp_f32 v199, v199
    v_pk_add_f32 v[188:189], v[188:189], 1.0 op_sel_hi:[1,0]
    v_pk_add_f32 v[190:191], v[190:191], 1.0 op_sel_hi:[1,0]
    v_pk_add_f32 v[196:197], v[196:197], 1.0 op_sel_hi:[1,0]
    v_pk_add_f32 v[198:199], v[198:199], 1.0 op_sel_hi:[1,0]
    s_setprio 0
    v_mfma_f32_16x16x32_bf16 v[220:223], v[176:179], v[88:91], 0
    ds_read_b64_tr_b16 v[184:185], v236
    ds_read_b64_tr_b16 v[186:187], v237
    v_mfma_f32_16x16x32_bf16 v[228:231], v[176:179], v[92:95], 0
    v_rcp_f32 v188, v188
    v_mfma_f32_16x16x32_bf16 v[220:223], v[160:163], v[16:19], v[220:223]
    v_rcp_f32 v189, v189
    v_mfma_f32_16x16x32_bf16 v[228:231], v[160:163], v[24:27], v[228:231]
    v_rcp_f32 v190, v190
    v_mfma_f32_16x16x32_bf16 v[220:223], v[164:167], v[20:23], v[220:223]
    v_rcp_f32 v191, v191
    s_setprio 3
    v_mfma_f32_16x16x32_bf16 v[228:231], v[164:167], v[28:31], v[228:231]
    v_rcp_f32 v196, v196
    v_rcp_f32 v197, v197
    v_rcp_f32 v198, v198
    v_rcp_f32 v199, v199
    v_pk_mul_f32 v[204:205], v[188:189], v[204:205]
    v_pk_mul_f32 v[206:207], v[190:191], v[206:207]
    v_pk_mul_f32 v[212:213], v[196:197], v[212:213]
    v_pk_mul_f32 v[214:215], v[198:199], v[214:215]
    s_setprio 0
    s_waitcnt lgkmcnt(0)
    v_smfmac_f32_16x16x64_bf16 v[144:147], v[184:187], v[204:211], v255
    v_smfmac_f32_16x16x64_bf16 v[148:151], v[184:187], v[212:219], v255
    v_exp_f32 v220, v220
    v_mfma_f32_16x16x32_bf16 v[204:207], v[160:163], v[48:51], 0
    v_mfma_f32_16x16x32_bf16 v[212:215], v[160:163], v[56:59], 0
    v_exp_f32 v221, v221
    v_mfma_f32_16x16x32_bf16 v[204:207], v[164:167], v[52:55], v[204:207]
    v_mfma_f32_16x16x32_bf16 v[212:215], v[164:167], v[60:63], v[212:215]
    v_exp_f32 v222, v222
    v_smfmac_f32_16x16x64_bf16 v[128:131], v[184:187], v[188:195], v255
    v_exp_f32 v223, v223
    s_setprio 3
    v_smfmac_f32_16x16x64_bf16 v[132:135], v[184:187], v[196:203], v255
    v_exp_f32 v228, v228
    v_exp_f32 v229, v229
    v_exp_f32 v230, v230
    v_exp_f32 v231, v231
    v_pk_add_f32 v[220:221], v[220:221], 1.0 op_sel_hi:[1,0]
    v_pk_add_f32 v[222:223], v[222:223], 1.0 op_sel_hi:[1,0]
    v_pk_add_f32 v[228:229], v[228:229], 1.0 op_sel_hi:[1,0]
    v_pk_add_f32 v[230:231], v[230:231], 1.0 op_sel_hi:[1,0]
    s_setprio 0
    v_rcp_f32 v220, v220
    v_rcp_f32 v221, v221
    v_rcp_f32 v222, v222
    v_rcp_f32 v223, v223
    v_rcp_f32 v228, v228
    v_rcp_f32 v229, v229
    v_rcp_f32 v230, v230
    v_rcp_f32 v231, v231
    v_pk_mul_f32 v[204:205], v[220:221], v[204:205]
    v_pk_mul_f32 v[206:207], v[222:223], v[206:207]
    v_pk_mul_f32 v[212:213], v[228:229], v[212:213]
    v_pk_mul_f32 v[214:215], v[230:231], v[214:215]
    v_smfmac_f32_16x16x64_bf16 v[136:139], v[184:187], v[220:227], v255
    v_smfmac_f32_16x16x64_bf16 v[140:143], v[184:187], v[228:235], v255
    v_smfmac_f32_16x16x64_bf16 v[152:155], v[184:187], v[204:211], v255
    v_smfmac_f32_16x16x64_bf16 v[156:159], v[184:187], v[212:219], v255
    s_branch L_DONE
L_DONE:
    v_mbcnt_lo_u32_b32 v247, -1, 0
    v_mbcnt_hi_u32_b32 v247, -1, v247
    v_and_b32 v246, 24, v246
    s_cmp_lg_u32 s19, 0
    s_cbranch_scc1 L_SLOW
L_EPI:
    s_waitcnt lgkmcnt(0)
    v_and_b32 v64, 48, v247
    v_and_b32 v67, 15, v247
    v_add_u32 v69, s72, v64
    v_lshl_add_u32 v70, v67, 2, s72
    ds_read_b128 v[80:83], v69 offset:0
    ds_read_b128 v[84:87], v69 offset:64
    ds_read2_b32 v[72:73], v70 offset0:0 offset1:16
    v_bfe_u32 v65, v247, 2, 3
    v_lshrrev_b32 v66, 5, v247
    v_lshl_add_u32 v65, v66, 4, v65
    v_mul_u32_u24 v65, 160, v65
    s_mov_b32 s10, 143488
    v_add3_u32 v65, v65, v246, s10
    ds_read_b64_tr_b16 v[0:1], v65 offset:0
    ds_read_b64_tr_b16 v[2:3], v65 offset:1280
    ds_read_b64_tr_b16 v[8:9], v65 offset:32
    ds_read_b64_tr_b16 v[10:11], v65 offset:1312
    ds_read_b64_tr_b16 v[16:17], v65 offset:64
    ds_read_b64_tr_b16 v[18:19], v65 offset:1344
    ds_read_b64_tr_b16 v[24:25], v65 offset:96
    ds_read_b64_tr_b16 v[26:27], v65 offset:1376
    ds_read_b64_tr_b16 v[4:5], v65 offset:5120
    ds_read_b64_tr_b16 v[6:7], v65 offset:6400
    ds_read_b64_tr_b16 v[12:13], v65 offset:5152
    ds_read_b64_tr_b16 v[14:15], v65 offset:6432
    s_movk_i32 s10, 832
    v_mad_u32_u24 v64, v246, s10, v64
    s_mov_b32 s10, 116736
    v_lshl_add_u32 v69, v67, 3, s10
    v_lshl_add_u32 v74, v67, 3, s73
    v_lshl_add_u32 v75, v67, 3, s74
    s_waitcnt lgkmcnt(8)
    ds_read_b64_tr_b16 v[20:21], v65 offset:5184
    ds_read_b64_tr_b16 v[22:23], v65 offset:6464
    ds_read_b64_tr_b16 v[28:29], v65 offset:5216
    ds_read_b64_tr_b16 v[30:31], v65 offset:6496
    v_add_u32 v76, v80, v69
    ds_read_b64 v[32:33], v76 offset:0
    v_add_u32 v76, v81, v69
    ds_read_b64 v[34:35], v76 offset:6656
    v_add_u32 v76, v82, v69
    ds_read_b64 v[36:37], v76 offset:13312
    v_add_u32 v76, v83, v69
    ds_read_b64 v[38:39], v76 offset:19968
    v_add_u32 v76, v84, v69
    ds_read_b64 v[40:41], v76 offset:0
    v_add_u32 v76, v85, v69
    ds_read_b64 v[42:43], v76 offset:6656
    v_add_u32 v76, v86, v69
    ds_read_b64 v[44:45], v76 offset:13312
    v_add_u32 v76, v87, v69
    ds_read_b64 v[46:47], v76 offset:19968
    v_add3_u32 v72, v72, v64, s10
    ds_read_b128 v[160:163], v72 offset:0
    ds_read_b128 v[164:167], v72 offset:64
    v_add3_u32 v73, v73, v64, s10
    ds_read_b128 v[168:171], v73 offset:0
    ds_read_b128 v[172:175], v73 offset:64
    s_waitcnt lgkmcnt(0)
    v_lshlrev_b32 v188, 16, v32
    v_lshlrev_b32 v189, 16, v34
    v_lshlrev_b32 v190, 16, v36
    v_lshlrev_b32 v191, 16, v38
    v_and_b32 v192, 0xffff0000, v32
    v_and_b32 v193, 0xffff0000, v34
    v_and_b32 v194, 0xffff0000, v36
    v_and_b32 v195, 0xffff0000, v38
    v_mfma_f32_16x16x32_bf16 v[188:191], v[160:163], v[0:3], v[188:191]
    v_lshlrev_b32 v196, 16, v33
    v_lshlrev_b32 v197, 16, v35
    v_lshlrev_b32 v198, 16, v37
    v_lshlrev_b32 v199, 16, v39
    v_lshl_add_u32 v80, v80, 2, v74
    v_mfma_f32_16x16x32_bf16 v[188:191], v[164:167], v[4:7], v[188:191]
    v_mfma_f32_16x16x32_bf16 v[192:195], v[160:163], v[8:11], v[192:195]
    v_and_b32 v200, 0xffff0000, v33
    v_and_b32 v201, 0xffff0000, v35
    v_and_b32 v202, 0xffff0000, v37
    v_and_b32 v203, 0xffff0000, v39
    v_lshl_add_u32 v81, v81, 2, v74
    v_mfma_f32_16x16x32_bf16 v[192:195], v[164:167], v[12:15], v[192:195]
    v_mfma_f32_16x16x32_bf16 v[196:199], v[160:163], v[16:19], v[196:199]
    v_lshlrev_b32 v48, 16, v40
    v_lshlrev_b32 v49, 16, v42
    v_lshlrev_b32 v50, 16, v44
    v_lshlrev_b32 v51, 16, v46
    v_lshl_add_u32 v82, v82, 2, v74
    v_mfma_f32_16x16x32_bf16 v[196:199], v[164:167], v[20:23], v[196:199]
    v_mfma_f32_16x16x32_bf16 v[200:203], v[160:163], v[24:27], v[200:203]
    v_and_b32 v52, 0xffff0000, v40
    v_and_b32 v53, 0xffff0000, v42
    v_and_b32 v54, 0xffff0000, v44
    v_and_b32 v55, 0xffff0000, v46
    v_lshl_add_u32 v83, v83, 2, v74
    v_mfma_f32_16x16x32_bf16 v[200:203], v[164:167], v[28:31], v[200:203]
    v_mfma_f32_16x16x32_bf16 v[48:51], v[168:171], v[0:3], v[48:51]
    v_lshlrev_b32 v56, 16, v41
    v_lshlrev_b32 v57, 16, v43
    v_lshlrev_b32 v58, 16, v45
    v_lshlrev_b32 v59, 16, v47
    v_lshl_add_u32 v84, v84, 2, v75
    v_mfma_f32_16x16x32_bf16 v[48:51], v[172:175], v[4:7], v[48:51]
    v_mfma_f32_16x16x32_bf16 v[52:55], v[168:171], v[8:11], v[52:55]
    v_and_b32 v60, 0xffff0000, v41
    v_and_b32 v61, 0xffff0000, v43
    v_and_b32 v62, 0xffff0000, v45
    v_and_b32 v63, 0xffff0000, v47
    v_lshl_add_u32 v85, v85, 2, v75
    v_mfma_f32_16x16x32_bf16 v[52:55], v[172:175], v[12:15], v[52:55]
    v_mfma_f32_16x16x32_bf16 v[56:59], v[168:171], v[16:19], v[56:59]
    v_lshl_add_u32 v86, v86, 2, v75
    v_mfma_f32_16x16x32_bf16 v[56:59], v[172:175], v[20:23], v[56:59]
    v_mfma_f32_16x16x32_bf16 v[60:63], v[168:171], v[24:27], v[60:63]
    v_lshl_add_u32 v87, v87, 2, v75
    v_mfma_f32_16x16x32_bf16 v[60:63], v[172:175], v[28:31], v[60:63]
L_EPB:
    s_setprio 0
    s_mov_b64 exec, s[76:77]
    s_and_b32 s11, s25, 19
    s_nop 2
    s_cmp_eq_u32 s11, 0
    s_cbranch_scc1 L_NS0
    s_cmp_eq_u32 s11, 1
    s_cbranch_scc1 L_NS1
    s_cmp_eq_u32 s11, 2
    s_cbranch_scc1 L_NS2
    s_cmp_eq_u32 s11, 3
    s_cbranch_scc1 L_NS3
L_NSR:
    s_mov_b64 exec, -1
    v_rcp_f32 v96, v96
    v_rcp_f32 v97, v97
    v_rcp_f32 v98, v98
    v_rcp_f32 v99, v99
    v_rcp_f32 v100, v100
    v_rcp_f32 v101, v101
    v_rcp_f32 v102, v102
    v_rcp_f32 v103, v103
    v_rcp_f32 v104, v104
    v_rcp_f32 v105, v105
    v_rcp_f32 v106, v106
    v_rcp_f32 v107, v107
    v_rcp_f32 v108, v108
    v_rcp_f32 v109, v109
    v_rcp_f32 v110, v110
    v_rcp_f32 v111, v111
    v_pk_fma_f32 v[112:113], v[112:113], v[96:97], v[188:189]
    v_pk_fma_f32 v[114:115], v[114:115], v[98:99], v[190:191]
    v_pk_fma_f32 v[116:117], v[116:117], v[100:101], v[192:193]
    v_pk_fma_f32 v[118:119], v[118:119], v[102:103], v[194:195]
    v_pk_fma_f32 v[120:121], v[120:121], v[104:105], v[196:197]
    v_pk_fma_f32 v[122:123], v[122:123], v[106:107], v[198:199]
    v_pk_fma_f32 v[124:125], v[124:125], v[108:109], v[200:201]
    v_pk_fma_f32 v[126:127], v[126:127], v[110:111], v[202:203]
    v_cvt_pk_bf16_f32 v96, v112, v116
    v_cvt_pk_bf16_f32 v97, v120, v124
    v_pk_max_f16 v96, v96, v32
    v_pk_max_f16 v97, v97, v33
    buffer_store_dwordx2 v[96:97], v80, s[48:51], 0 offen sc1
    v_cvt_pk_bf16_f32 v98, v113, v117
    v_cvt_pk_bf16_f32 v99, v121, v125
    v_pk_max_f16 v98, v98, v34
    v_pk_max_f16 v99, v99, v35
    buffer_store_dwordx2 v[98:99], v81, s[48:51], 0 offen sc1
    v_cvt_pk_bf16_f32 v100, v114, v118
    v_cvt_pk_bf16_f32 v101, v122, v126
    v_pk_max_f16 v100, v100, v36
    v_pk_max_f16 v101, v101, v37
    buffer_store_dwordx2 v[100:101], v82, s[48:51], 0 offen sc1
    v_cvt_pk_bf16_f32 v102, v115, v119
    v_cvt_pk_bf16_f32 v103, v123, v127
    v_pk_max_f16 v102, v102, v38
    v_pk_max_f16 v103, v103, v39
    buffer_store_dwordx2 v[102:103], v83, s[48:51], 0 offen sc1
    v_rcp_f32 v128, v128
    v_rcp_f32 v129, v129
    v_rcp_f32 v130, v130
    v_rcp_f32 v131, v131
    v_rcp_f32 v132, v132
    v_rcp_f32 v133, v133
    v_rcp_f32 v134, v134
    v_rcp_f32 v135, v135
    v_rcp_f32 v136, v136
    v_rcp_f32 v137, v137
    v_rcp_f32 v138, v138
    v_rcp_f32 v139, v139
    v_rcp_f32 v140, v140
    v_rcp_f32 v141, v141
    v_rcp_f32 v142, v142
    v_rcp_f32 v143, v143
    v_pk_fma_f32 v[144:145], v[144:145], v[128:129], v[48:49]
    v_pk_fma_f32 v[146:147], v[146:147], v[130:131], v[50:51]
    v_pk_fma_f32 v[148:149], v[148:149], v[132:133], v[52:53]
    v_pk_fma_f32 v[150:151], v[150:151], v[134:135], v[54:55]
    v_pk_fma_f32 v[152:153], v[152:153], v[136:137], v[56:57]
    v_pk_fma_f32 v[154:155], v[154:155], v[138:139], v[58:59]
    v_pk_fma_f32 v[156:157], v[156:157], v[140:141], v[60:61]
    v_pk_fma_f32 v[158:159], v[158:159], v[142:143], v[62:63]
    v_cvt_pk_bf16_f32 v128, v144, v148
    v_cvt_pk_bf16_f32 v129, v152, v156
    v_pk_max_f16 v128, v128, v40
    v_pk_max_f16 v129, v129, v41
    buffer_store_dwordx2 v[128:129], v84, s[60:63], 0 offen sc1
    v_cvt_pk_bf16_f32 v130, v145, v149
    v_cvt_pk_bf16_f32 v131, v153, v157
    v_pk_max_f16 v130, v130, v42
    v_pk_max_f16 v131, v131, v43
    buffer_store_dwordx2 v[130:131], v85, s[60:63], 0 offen sc1
    v_cvt_pk_bf16_f32 v132, v146, v150
    v_cvt_pk_bf16_f32 v133, v154, v158
    v_pk_max_f16 v132, v132, v44
    v_pk_max_f16 v133, v133, v45
    buffer_store_dwordx2 v[132:133], v86, s[60:63], 0 offen sc1
    v_cvt_pk_bf16_f32 v134, v147, v151
    v_cvt_pk_bf16_f32 v135, v155, v159
    v_pk_max_f16 v134, v134, v46
    v_pk_max_f16 v135, v135, v47
    buffer_store_dwordx2 v[134:135], v87, s[60:63], 0 offen sc1
L_END:
    s_endpgm
L_NS0:
    v_add_f32 v96, v96, v128
    v_add_f32 v100, v100, v132
    v_add_f32 v104, v104, v136
    v_add_f32 v108, v108, v140
    v_add_f32 v112, v112, v144
    v_add_f32 v116, v116, v148
    v_add_f32 v120, v120, v152
    v_add_f32 v124, v124, v156
    s_branch L_NSR
L_NS1:
    v_add_f32 v97, v97, v129
    v_add_f32 v101, v101, v133
    v_add_f32 v105, v105, v137
    v_add_f32 v109, v109, v141
    v_add_f32 v113, v113, v145
    v_add_f32 v117, v117, v149
    v_add_f32 v121, v121, v153
    v_add_f32 v125, v125, v157
    s_branch L_NSR
L_NS2:
    v_add_f32 v98, v98, v130
    v_add_f32 v102, v102, v134
    v_add_f32 v106, v106, v138
    v_add_f32 v110, v110, v142
    v_add_f32 v114, v114, v146
    v_add_f32 v118, v118, v150
    v_add_f32 v122, v122, v154
    v_add_f32 v126, v126, v158
    s_branch L_NSR
L_NS3:
    v_add_f32 v99, v99, v131
    v_add_f32 v103, v103, v135
    v_add_f32 v107, v107, v139
    v_add_f32 v111, v111, v143
    v_add_f32 v115, v115, v147
    v_add_f32 v119, v119, v151
    v_add_f32 v123, v123, v155
    v_add_f32 v127, v127, v159
    s_branch L_NSR
L_RT0:
    s_waitcnt vmcnt(0)
    s_add_u32 s100, s100, 1
    s_cmp_gt_u32 s100, 200000
    s_cbranch_scc1 L_END
    s_sleep 1
    buffer_load_dwordx4 v[128:131], v232, s[56:59], s26 offen sc1
    buffer_load_dwordx4 v[132:135], v232, s[56:59], s27 offen sc1
    buffer_load_dwordx4 v[136:139], v232, s[56:59], s28 offen sc1
    buffer_load_dwordx4 v[140:143], v232, s[56:59], s29 offen sc1
    s_waitcnt vmcnt(0)
    s_branch L_PW0
L_RT1:
    s_waitcnt vmcnt(0)
    s_add_u32 s100, s100, 1
    s_cmp_gt_u32 s100, 200000
    s_cbranch_scc1 L_END
    s_sleep 1
    buffer_load_dwordx4 v[132:135], v232, s[56:59], s27 offen sc1
    buffer_load_dwordx4 v[136:139], v232, s[56:59], s28 offen sc1
    buffer_load_dwordx4 v[140:143], v232, s[56:59], s29 offen sc1
    s_waitcnt vmcnt(0)
    s_branch L_PW1
L_RT2:
    s_waitcnt vmcnt(0)
    s_add_u32 s100, s100, 1
    s_cmp_gt_u32 s100, 200000
    s_cbranch_scc1 L_END
    s_sleep 1
    buffer_load_dwordx4 v[136:139], v232, s[56:59], s28 offen sc1
    buffer_load_dwordx4 v[140:143], v232, s[56:59], s29 offen sc1
    s_waitcnt vmcnt(0)
    s_branch L_PW2
L_RT3:
    s_waitcnt vmcnt(0)
    s_add_u32 s100, s100, 1
    s_cmp_gt_u32 s100, 200000
    s_cbranch_scc1 L_END
    s_sleep 1
    buffer_load_dwordx4 v[140:143], v232, s[56:59], s29 offen sc1
    s_waitcnt vmcnt(0)
    s_branch L_PW3
L_XT2B:
    s_add_u32 s100, s100, 1
    s_cmp_gt_u32 s100, 200000
    s_cbranch_scc1 L_END
    s_sleep 1
    s_mov_b64 exec, s[70:71]
    s_cbranch_execz L_XLb0
    s_movk_i32 s10, 0
    buffer_load_dwordx4 v[64:67], v232, s[60:63], s10 offen sc1
L_XLb0:
    s_mov_b64 exec, s[78:79]
    s_cbranch_execz L_XLb1
    s_movk_i32 s10, 8192
    buffer_load_dwordx4 v[68:71], v232, s[60:63], s10 offen sc1
L_XLb1:
    s_mov_b64 exec, s[86:87]
    s_cbranch_execz L_XLb2
    s_movk_i32 s10, 16384
    buffer_load_dwordx4 v[72:75], v232, s[60:63], s10 offen sc1
L_XLb2:
    s_mov_b64 exec, s[94:95]
    s_cbranch_execz L_XLb3
    s_movk_i32 s10, 24576
    buffer_load_dwordx4 v[76:79], v232, s[60:63], s10 offen sc1
L_XLb3:
    s_mov_b64 exec, -1
    s_waitcnt vmcnt(0)
    s_branch L_XT2
L_OVF:
    s_mov_b32 s20, 0
    s_mov_b32 s17, 0
    s_mov_b32 s30, 0
    s_mov_b32 s19, 4
    s_waitcnt lgkmcnt(0)
    s_branch L_CA
L_POVF:
    s_movk_i32 s11, 1986
    v_mul_u32_u24 v64, s11, v192
    v_lshrrev_b32 v64, 16, v64
    v_mul_u32_u24 v65, s11, v193
    v_lshrrev_b32 v65, 16, v65
    v_mul_u32_u24 v66, s11, v194
    v_lshrrev_b32 v66, 16, v66
    v_mul_u32_u24 v67, s11, v195
    v_lshrrev_b32 v67, 16, v67
    v_add_u32 v69, v64, v65
    v_add_u32 v70, v69, v66
    v_add_u32 v71, v70, v67
    v_mov_b32 v72, v71
    s_nop 1
    v_add_u32_dpp v72, v72, v72 row_shr:1 row_mask:0xf bank_mask:0xf bound_ctrl:0
    s_nop 1
    v_add_u32_dpp v72, v72, v72 row_shr:2 row_mask:0xf bank_mask:0xf bound_ctrl:0
    s_nop 1
    v_add_u32_dpp v72, v72, v72 row_shr:4 row_mask:0xf bank_mask:0xf bound_ctrl:0
    s_nop 1
    v_add_u32_dpp v72, v72, v72 row_shr:8 row_mask:0xf bank_mask:0xf bound_ctrl:0
    s_nop 1
    v_add_u32_dpp v72, v72, v72 row_bcast:15 row_mask:0xa bank_mask:0xf
    s_nop 1
    v_add_u32_dpp v72, v72, v72 row_bcast:31 row_mask:0xc bank_mask:0xf
    s_nop 0
    v_sub_u32 v68, v72, v71
    v_add_u32 v71, v68, v70
    v_add_u32 v70, v68, v69
    v_add_u32 v69, v68, v64
    v_lshl_or_b32 v68, v64, 16, v68
    v_lshl_or_b32 v69, v65, 16, v69
    v_lshl_or_b32 v70, v66, 16, v70
    v_lshl_or_b32 v71, v67, 16, v71
    v_add_u32 v72, 154752, v185
    ds_write_b128 v72, v[68:71]
    s_lshl_b32 s10, s2, 10
    s_add_u32 s10, s10, 24772608
    buffer_store_dwordx4 v[68:71], v185, s[52:55], s10 offen sc1
    v_and_b32 v74, 0x3fc, v136
    v_add_u32 v74, 154752, v74
    ds_read_u16 v74, v74
    v_and_b32 v75, 0x3fc, v137
    v_add_u32 v75, 154752, v75
    ds_read_u16 v75, v75
    v_and_b32 v76, 0x3fc, v138
    v_add_u32 v76, 154752, v76
    ds_read_u16 v76, v76
    v_and_b32 v77, 0x3fc, v139
    v_add_u32 v77, 154752, v77
    ds_read_u16 v77, v77
    v_and_b32 v78, 0x3fc, v140
    v_add_u32 v78, 154752, v78
    ds_read_u16 v78, v78
    v_and_b32 v79, 0x3fc, v141
    v_add_u32 v79, 154752, v79
    ds_read_u16 v79, v79
    v_and_b32 v80, 0x3fc, v142
    v_add_u32 v80, 154752, v80
    ds_read_u16 v80, v80
    v_and_b32 v81, 0x3fc, v143
    v_add_u32 v81, 154752, v81
    ds_read_u16 v81, v81
    s_waitcnt lgkmcnt(0)
    v_cmpx_lt_u32 vcc, 1056, v228
    v_or_b32 v205, 0x10000, v205
    s_mov_b64 exec, -1
    v_cmpx_lt_u32 vcc, 1056, v229
    v_or_b32 v209, 0x10000, v209
    s_mov_b64 exec, -1
    v_cmpx_lt_u32 vcc, 1056, v230
    v_or_b32 v213, 0x10000, v213
    s_mov_b64 exec, -1
    v_cmpx_lt_u32 vcc, 1056, v231
    v_or_b32 v217, 0x10000, v217
    s_mov_b64 exec, -1
    s_mul_i32 s10, s2, 4152
    s_mov_b32 s34, 18874368
    s_mov_b32 s35, 23592960
    v_mul_u32_u24 v64, s11, v112
    v_lshrrev_b32 v64, 16, v64
    v_add3_u32 v64, v64, v74, s10
    v_lshlrev_b32 v65, 2, v64
    v_cmpx_le_u32 vcc, 1056, v112
    s_cbranch_execz L_PO0
    buffer_store_byte v120, v64, s[52:55], s35 offen sc1
    buffer_store_dword v96, v65, s[52:55], s34 offen sc1
L_PO0:
    s_mov_b64 exec, -1
    v_mul_u32_u24 v64, s11, v113
    v_lshrrev_b32 v64, 16, v64
    v_add3_u32 v64, v64, v75, s10
    v_lshlrev_b32 v65, 2, v64
    v_cmpx_le_u32 vcc, 1056, v113
    s_cbranch_execz L_PO1
    buffer_store_byte v121, v64, s[52:55], s35 offen sc1
    buffer_store_dword v97, v65, s[52:55], s34 offen sc1
L_PO1:
    s_mov_b64 exec, -1
    v_mul_u32_u24 v64, s11, v114
    v_lshrrev_b32 v64, 16, v64
    v_add3_u32 v64, v64, v76, s10
    v_lshlrev_b32 v65, 2, v64
    v_cmpx_le_u32 vcc, 1056, v114
    s_cbranch_execz L_PO2
    buffer_store_byte v122, v64, s[52:55], s35 offen sc1
    buffer_store_dword v98, v65, s[52:55], s34 offen sc1
L_PO2:
    s_mov_b64 exec, -1
    v_mul_u32_u24 v64, s11, v115
    v_lshrrev_b32 v64, 16, v64
    v_add3_u32 v64, v64, v77, s10
    v_lshlrev_b32 v65, 2, v64
    v_cmpx_le_u32 vcc, 1056, v115
    s_cbranch_execz L_PO3
    buffer_store_byte v123, v64, s[52:55], s35 offen sc1
    buffer_store_dword v99, v65, s[52:55], s34 offen sc1
L_PO3:
    s_mov_b64 exec, -1
    v_mul_u32_u24 v64, s11, v116
    v_lshrrev_b32 v64, 16, v64
    v_add3_u32 v64, v64, v78, s10
    v_lshlrev_b32 v65, 2, v64
    v_cmpx_le_u32 vcc, 1056, v116
    s_cbranch_execz L_PO4
    buffer_store_byte v120, v64, s[52:55], s35 offen sc1
    buffer_store_dword v100, v65, s[52:55], s34 offen sc1
L_PO4:
    s_mov_b64 exec, -1
    v_mul_u32_u24 v64, s11, v117
    v_lshrrev_b32 v64, 16, v64
    v_add3_u32 v64, v64, v79, s10
    v_lshlrev_b32 v65, 2, v64
    v_cmpx_le_u32 vcc, 1056, v117
    s_cbranch_execz L_PO5
    buffer_store_byte v121, v64, s[52:55], s35 offen sc1
    buffer_store_dword v101, v65, s[52:55], s34 offen sc1
L_PO5:
    s_mov_b64 exec, -1
    v_mul_u32_u24 v64, s11, v118
    v_lshrrev_b32 v64, 16, v64
    v_add3_u32 v64, v64, v80, s10
    v_lshlrev_b32 v65, 2, v64
    v_cmpx_le_u32 vcc, 1056, v118
    s_cbranch_execz L_PO6
    buffer_store_byte v122, v64, s[52:55], s35 offen sc1
    buffer_store_dword v102, v65, s[52:55], s34 offen sc1
L_PO6:
    s_mov_b64 exec, -1
    v_mul_u32_u24 v64, s11, v119
    v_lshrrev_b32 v64, 16, v64
    v_add3_u32 v64, v64, v81, s10
    v_lshlrev_b32 v65, 2, v64
    v_cmpx_le_u32 vcc, 1056, v119
    s_cbranch_execz L_PO7
    buffer_store_byte v123, v64, s[52:55], s35 offen sc1
    buffer_store_dword v103, v65, s[52:55], s34 offen sc1
L_PO7:
    s_mov_b64 exec, -1
    s_waitcnt vmcnt(0) lgkmcnt(0)
    s_barrier
    s_branch L_POUT
L_SLOW:
    s_setprio 0
    s_lshl_b32 s10, s3, 6
    v_add_u32 v255, s10, v247
    s_cmp_lg_u32 s19, 4
    s_cbranch_scc1 L_SL1
    s_mov_b32 s19, 1
    v_and_b32 v188, 0xff, v255
    v_lshlrev_b32 v189, 7, v188
    buffer_load_dword v190, v189, s[56:59], 0 offen offset:4 sc1
    v_lshlrev_b32 v189, 10, v188
    s_lshl_b32 s10, s5, 2
    s_add_u32 s10, s10, 24772608
    buffer_load_dword v191, v189, s[52:55], s10 offen sc1
    v_lshlrev_b32 v188, 2, v188
    v_add_u32 v188, 154752, v188
    s_waitcnt vmcnt(0)
    v_and_b32 v190, 0x10000, v190
    v_cmp_ne_u32 vcc, 0, v190
    v_mov_b32 v190, 2097152
    s_nop 0
    v_cndmask_b32 v190, v190, v191, vcc
    ds_write_b32 v188, v190
    s_waitcnt lgkmcnt(0)
    s_barrier
L_SL1:
    s_add_u32 s28, s28, 288
    s_cmp_lt_u32 s28, s29
    s_cbranch_scc1 L_BATCH
L_FIND:
    s_cmp_lg_u64 s[32:33], 0
    s_cbranch_scc1 L_GOT
    s_add_u32 s26, s26, 1
    s_cmp_ge_u32 s26, 4
    s_cbranch_scc1 L_EPI
    s_lshl_b32 s10, s26, 8
    s_add_u32 s10, s10, 154752
    v_lshl_add_u32 v188, v247, 2, s10
    ds_read_u16 v188, v188 offset:2
    s_waitcnt lgkmcnt(0)
    v_cmp_lt_u32 s[32:33], s20, v188
    s_nop 3
    s_branch L_FIND
L_GOT:
    s_ff1_i32_b64 s10, s[32:33]
    s_bitset0_b64 s[32:33], s10
    s_lshl_b32 s11, s26, 6
    s_add_u32 s27, s10, s11
    s_lshl_b32 s10, s27, 2
    s_add_u32 s10, s10, 154752
    v_mov_b32 v188, s10
    ds_read_b32 v188, v188
    s_waitcnt lgkmcnt(0)
    v_readfirstlane_b32 s10, v188
    s_nop 3
    s_lshr_b32 s29, s10, 16
    s_and_b32 s30, s10, 0xffff
    s_mov_b32 s28, s20
L_BATCH:
    s_waitcnt vmcnt(0)
    s_barrier
    v_mov_b32 v192, 0x2000000
    v_mov_b32 v193, 0x2000000
    v_mov_b32 v194, 0x2000000
    v_mov_b32 v195, 0x2000000
    v_mov_b32 v196, 0xfffff
    v_mov_b32 v197, 0xfffff
    v_mov_b32 v198, 0xfffff
    v_mov_b32 v199, 0xfffff
    v_lshl_add_u32 v200, v247, 4, s12
    ds_write_b128 v200, v[192:195] offset:0
    ds_write_b128 v200, v[196:199] offset:18432
    ds_write_b128 v200, v[192:195] offset:1024
    ds_write_b128 v200, v[196:199] offset:19456
    ds_write_b128 v200, v[192:195] offset:1280
    ds_write_b128 v200, v[196:199] offset:19712
    v_and_b32 v188, 15, v247
    v_mul_u32_u24 v189, 1152, v188
    v_add_u32 v189, 8192, v189
    v_lshlrev_b32 v188, 2, v188
    ds_write_b32 v188, v189 offset:576
    v_add_u32 v188, s28, v255
    s_mul_i32 s36, s27, 3128
    s_mul_i32 s11, s27, 4152
    s_add_u32 s11, s11, s30
    s_lshl_b32 s34, s11, 2
    s_add_u32 s34, s34, 18874368
    v_lshl_add_u32 v190, v188, 2, s34
    s_add_u32 s34, s11, 23592960
    v_add_u32 v191, s34, v188
    s_mul_i32 s10, s5, 32896
    s_lshl_b32 s34, s27, 7
    s_add_u32 s10, s10, s34
    s_add_u32 s10, s10, 65536
    v_and_b32 v206, 7, v188
    v_lshl_add_u32 v206, v206, 4, s10
    v_lshrrev_b32 v207, 3, v188
    v_cmpx_gt_u32 vcc, 32, v188
    v_add_u32 v190, 8421376, v206
    v_add_u32 v191, 8, v190
    v_cmpx_gt_u32 vcc, 24, v188
    v_lshl_add_u32 v190, v207, 2, v206
    v_add3_u32 v191, v206, v207, 12
    s_mov_b64 exec, -1
    s_add_u32 s10, s28, 288
    s_min_u32 s10, s10, s29
    v_cmp_gt_u32 vcc, s10, v188
    v_mov_b32 v206, 0x7ffffff0
    s_nop 0
    v_cndmask_b32 v190, v206, v190, vcc
    v_cndmask_b32 v191, v206, v191, vcc
    buffer_load_dwordx2 v[204:205], v190, s[52:55], 0 offen sc1
    buffer_load_ubyte v191, v191, s[52:55], 0 offen sc1
    s_waitcnt lgkmcnt(0)
    s_barrier
    s_waitcnt vmcnt(0)
    v_cmp_ne_u32 vcc, 3, v207
    v_cmp_eq_u32 s[10:11], s6, v205
    v_mov_b32 v206, s36
    s_or_b64 exec, vcc, s[10:11]
    v_cmpx_ne_u32 vcc, 0, v204
    v_bfe_u32 v190, v204, 18, 8
    v_lshlrev_b32 v190, 2, v190
    v_add_u32 v188, 153728, v190
    ds_read_b32 v188, v188
    v_add_u32_sdwa v191, v191, v206 dst_sel:DWORD dst_unused:UNUSED_PAD src0_sel:BYTE_0 src1_sel:DWORD
    v_lshrrev_b32 v189, 28, v204
    v_lshl_add_u32 v191, v189, 8, v191
    v_and_b32 v189, 60, v190
    v_and_b32 v204, 0xffff, v204
    v_lshl_or_b32 v204, v189, 19, v204
    v_mov_b32 v190, 4
    s_waitcnt lgkmcnt(0)
    ds_add_rtn_u32 v188, v188, v190 offset:576
    s_waitcnt lgkmcnt(0)
    ds_write2st64_b32 v188, v204, v191 offset0:148 offset1:220
    s_mov_b64 exec, -1
    s_waitcnt lgkmcnt(0)
    s_barrier
    v_lshrrev_b32 v190, 3, v247
    v_lshl_add_u32 v248, v190, 4, s12
    s_add_u32 s10, s12, 18432
    v_lshrrev_b32 v190, 1, v247
    v_lshl_add_u32 v249, v190, 2, s10
    s_add_u32 s10, s10, 2
    v_lshrrev_b32 v190, 5, v247
    v_mul_i32_i24 v250, 0xffffb800, v190
    v_and_b32 v190, 15, v247
    v_lshl_add_u32 v250, v190, 2, v250
    v_add_u32 v250, s10, v250
    s_add_u32 s10, s12, 2
    v_and_b32 v190, 48, v247
    v_lshl_add_u32 v251, v190, 1, s10
    v_and_b32 v190, 12, v247
    v_add_u32 v251, v251, v190
    ds_read_b128 v[236:239], v248
    ds_read_b32 v240, v249
    s_lshl_b32 s10, s4, 3
    v_mov_b32 v190, s10
    ds_read_b64 v[190:191], v190 offset:576
    s_waitcnt lgkmcnt(0)
    v_readfirstlane_b32 s34, v190
    v_readfirstlane_b32 s35, v191
    s_sub_u32 s10, s12, 37888
    s_sub_u32 s34, s34, s10
    s_sub_u32 s35, s35, s10
    s_sub_u32 s35, s35, 1152
    s_add_u32 s10, s34, 127
    s_lshr_b32 s10, s10, 7
    s_lshl1_add_u32 s10, s10, -1
    s_add_u32 s11, s35, 127
    s_lshr_b32 s11, s11, 6
    s_and_b32 s11, s11, -2
    s_max_i32 s17, s10, s11
    s_cselect_b32 s10, s34, s35
    s_sub_u32 s10, s10, 1
    s_andn2_b32 s99, 64, s10
    v_mov_b64 v[204:205], 0
    v_mov_b64 v[206:207], 0
    v_mov_b64 v[184:185], 0
    v_mov_b64 v[186:187], 0
    s_add_u32 m0, s13, 0
    v_mad_u32_u16 v236, v236, s15, v243
    buffer_load_dwordx4 v236, s[40:43], 0 offen lds
    s_add_u32 m0, s13, 1056
    v_mad_u32_u16 v237, v237, s15, v243
    buffer_load_dwordx4 v237, s[40:43], 0 offen lds
    s_add_u32 m0, s13, 2112
    v_mad_u32_u16 v238, v238, s15, v243
    buffer_load_dwordx4 v238, s[40:43], 0 offen lds
    s_add_u32 m0, s13, 3168
    v_mad_u32_u16 v239, v239, s15, v243
    buffer_load_dwordx4 v239, s[40:43], 0 offen lds
    s_mov_b32 m0, s14
    s_nop 0
    buffer_load_dwordx4 v[240:241], s[44:47], 0 idxen offen lds
L_LAST:
    s_branch L_GO
.section .rodata,"a"
.p2align 6
.amdhsa_kernel standalone__edge_featured_mpnn_gatedgcn__graph_kernel
  .amdhsa_next_free_vgpr 256
  .amdhsa_next_free_sgpr 102
  .amdhsa_accum_offset 256
  .amdhsa_group_segment_fixed_size 0
  .amdhsa_kernarg_size 96
  .amdhsa_user_sgpr_count 2
  .amdhsa_user_sgpr_kernarg_segment_ptr 1
  .amdhsa_system_sgpr_workgroup_id_x 1
.end_amdhsa_kernel
```

```asm
; @launch grid=(256,1,1) block=(512,1,1) lds=158848
.amdgcn_target "amdgcn-amd-amdhsa--gfx950"
.text
.globl standalone__edge_featured_mpnn_gatedgcn__graph_kernel
.p2align 8
.type standalone__edge_featured_mpnn_gatedgcn__graph_kernel,@function
standalone__edge_featured_mpnn_gatedgcn__graph_kernel:
    s_load_dwordx16 s[16:31], s[0:1], 0
    s_load_dwordx8 s[32:39], s[0:1], 64
    s_getpc_b64 s[64:65]
L_PC:
    s_and_b32 s3, s2, -8
    v_add_lshl_u32 v1, v0, s3, 7
    v_min_u32 v1, L_LAST-L_PC, v1
    v_cmpx_gt_u32 vcc, 8, v0
    s_cbranch_execz L_NOCPF
    global_load_dword v252, v1, s[64:65]
L_NOCPF:
    s_mov_b64 exec, -1
    s_cmp_ge_u32 s2, 256
    s_cbranch_scc1 L_END
    s_mul_i32 s10, s2, 12512
    v_lshl_add_u32 v1, v0, 4, s10
    s_add_u32 s11, s10, 12512
    s_min_u32 s11, s11, 3200000
    v_add_u32 v2, 0x2000, v1
    s_waitcnt lgkmcnt(0)
    global_load_dwordx4 v[128:131], v1, s[22:23] nt
    global_load_dwordx4 v[96:99], v1, s[20:21] nt
    v_cmpx_gt_u32 s[70:71], s11, v2
    s_cbranch_execz L_NO8
    global_load_dwordx4 v[132:135], v2, s[22:23] nt
    global_load_dwordx4 v[100:103], v2, s[20:21] nt
L_NO8:
    s_mov_b64 exec, -1
L_NO7:
    s_mov_b64 exec, -1
    s_load_dword s6, s[38:39], 0
    v_mov_b32 v255, v0
    v_lshrrev_b32 v188, 6, v0
    v_and_b32 v247, 63, v0
    v_readfirstlane_b32 s3, v188
    v_lshlrev_b32 v232, 4, v0
    v_lshlrev_b32 v190, 3, v0
    v_lshlrev_b32 v191, 2, v0
    v_and_b32 v192, 0x3fc, v191
    s_and_b32 s5, s2, 7
    s_lshr_b32 s4, s2, 3
    s_lshl_b32 s5, s5, 5
    s_add_u32 s5, s5, s4
    s_mul_i32 s9, s5, 196
    s_cmp_eq_u32 s3, 7
    s_cselect_b32 s101, 0, s3
    s_lshl_b32 s12, s101, 5
    s_add_u32 s9, s9, s12
    v_lshrrev_b32 v193, 3, v247
    v_lshl_add_u32 v193, v193, 2, s9
    v_and_b32 v243, 7, v247
    v_lshlrev_b32 v243, 4, v243
    v_lshl_add_u32 v234, v193, 7, v243
    s_lshl_b32 s101, s101, 10
    s_add_u32 s101, s101, 116736
    v_mov_b64 v[196:197], 0
    v_mov_b64 v[198:199], 0
    v_mov_b32 v194, 132
    ds_write2st64_b32 v192, v194, v196 offset0:20 offset1:24
    v_add_u32 v193, 46080, v232
    ds_write_b128 v193, v[196:199] offset:0
    ds_write_b128 v193, v[196:199] offset:8192
    ds_write_b128 v193, v[196:199] offset:16384
    ds_write_b128 v193, v[196:199] offset:24576
    ds_write_b128 v193, v[196:199] offset:32768
    s_mov_b32 s44, s18
    s_or_b32 s45, s19, 0x200000
    s_mov_b32 s46, 800000
    s_mov_b32 s47, 0x20000
    s_mov_b32 s48, s34
    s_mov_b32 s49, s35
    s_mov_b32 s50, 6400000
    s_mov_b32 s51, 0x20000
    s_mov_b32 s40, s16
    s_mov_b32 s41, s17
    s_mov_b32 s42, 6400000
    s_mov_b32 s43, 0x20000
    s_mov_b32 s52, s38
    s_mov_b32 s53, s39
    s_mov_b32 s54, 25165824
    s_mov_b32 s55, 0x20000
    s_lshl_b32 s12, s2, 7
    s_add_u32 s12, s12, 65536
    s_add_u32 s56, s38, s12
    s_addc_u32 s57, s39, 0
    s_mov_b32 s58, 16809984
    s_mov_b32 s59, 0x20000
    s_mov_b32 s64, 85599
    s_mov_b32 s65, 4294967100
    s_movk_i32 s66, 5368
    s_mov_b32 s67, 0xc000000
    s_mov_b32 s68, 32896
    s_mov_b32 s100, 0xffeff220
    v_add_u32 v120, 0, v191
    v_add_u32 v121, 1, v191
    v_add_u32 v122, 2, v191
    v_add_u32 v123, 3, v191
    s_lshl_b32 s10, s3, 28
    s_or_b32 s10, s10, 0x20000
    v_mov_b32 v144, s10
    v_or_b32 v145, 0x80000000, v144
    v_mov_b32 v184, 33
    v_mov_b32 v146, 0x400
    s_and_b32 s10, s3, 3
    s_lshr_b32 s4, s3, 2
    s_lshl1_add_u32 s4, s10, s4
    s_xor_b32 s4, s4, 1
    s_mul_i32 s10, s4, 49
    s_sub_i32 s10, s10, 6
    s_ashr_i32 s10, s10, 1
    s_max_i32 s7, s10, 0
    s_mul_i32 s13, s4, 4224
    s_add_u32 s13, s13, 82944
    s_lshl_b32 s14, s4, 10
    s_add_u32 s14, s14, 5120
    s_mul_i32 s12, s4, 2304
    s_add_u32 s12, s12, 46080
    s_movk_i32 s15, 128
    v_bfe_u32 v194, v255, 4, 4
    v_and_b32 v195, 7, v255
    v_cmp_eq_u32 vcc, v194, v195
    v_and_b32 v194, 8, v255
    v_lshlrev_b32 v194, 1, v194
    v_mov_b32 v196, 0x3f80
    v_lshlrev_b32 v196, v194, v196
    v_cndmask_b32 v196, 0, v196, vcc
    ds_write_b32 v192, v196 offset:0
    v_mov_b64 v[196:197], 0
    ds_write_b64 v190, v[196:197] offset:1024
    v_add_u32 v194, 155776, v191
    ds_write_b32 v194, v196
    v_lshrrev_b32 v223, 3, v255
    v_mul_u32_u24 v224, 160, v223
    v_mad_u32_u24 v220, v223, s68, v243
    v_add_u32 v221, v224, v243
    v_add_u32 v221, 46080, v221
    v_bfe_u32 v194, v255, 5, 1
    v_bfe_u32 v196, v255, 6, 1
    v_sub_u32 v194, v194, v196
    v_mul_i32_i24 v194, 640, v194
    v_add_u32 v224, v224, v194
    v_lshl_add_u32 v224, v195, 2, v224
    v_add_u32 v224, 13312, v224
    v_lshlrev_b32 v185, 4, v247
    v_and_b32 v194, 3, v247
    v_lshlrev_b32 v246, 3, v194
    v_bfe_u32 v197, v247, 2, 3
    v_lshrrev_b32 v196, 5, v247
    v_lshl_add_u32 v197, v196, 4, v197
    v_mul_u32_u24 v225, 160, v197
    v_add_u32 v225, v225, v246
    s_movk_i32 s69, 11520
    v_mov_b64 v[116:117], 0
    v_mov_b64 v[118:119], 0
    s_waitcnt lgkmcnt(0)
    s_barrier
    s_cmp_eq_u64 s[70:71], 0
    s_cbranch_scc1 L_R4
    s_waitcnt vmcnt(3)
    v_mul_u32_u24 v104, s64, v128
    v_mul_u32_u24 v105, s64, v129
    v_mul_u32_u24 v106, s64, v130
    v_mul_u32_u24 v107, s64, v131
    v_lshrrev_b32 v136, 29, v104
    v_lshrrev_b32 v137, 29, v105
    v_lshrrev_b32 v138, 29, v106
    v_lshrrev_b32 v139, 29, v107
    v_cmp_eq_u32 s[72:73], v136, v137
    v_cmp_eq_u32 s[76:77], v138, v139
    v_cmp_eq_u32 vcc, v136, v138
    v_cmp_eq_u32 s[88:89], v137, v139
    v_cmp_eq_u32 s[90:91], v136, v139
    v_cmp_eq_u32 s[10:11], v137, v138
    v_lshrrev_b32 v104, 24, v104
    v_lshrrev_b32 v105, 24, v105
    v_lshrrev_b32 v106, 24, v106
    v_lshrrev_b32 v107, 24, v107
    s_or_b64 s[74:75], s[72:73], s[88:89]
    s_or_b64 s[78:79], s[76:77], s[88:89]
    s_or_b64 s[72:73], s[72:73], vcc
    s_or_b64 s[76:77], s[76:77], vcc
    s_or_b64 s[72:73], s[72:73], s[90:91]
    s_or_b64 s[74:75], s[74:75], s[10:11]
    s_or_b64 s[76:77], s[76:77], s[10:11]
    s_or_b64 s[78:79], s[78:79], s[90:91]
    v_cndmask_b32 v136, 0, v146, s[72:73]
    v_lshl_add_u32 v136, v104, 2, v136
    ds_add_rtn_u32 v112, v136, v184 offset:5120
    v_cndmask_b32 v137, 0, v146, s[74:75]
    v_lshl_add_u32 v137, v105, 2, v137
    ds_add_rtn_u32 v113, v137, v184 offset:5120
    v_cndmask_b32 v138, 0, v146, s[76:77]
    v_lshl_add_u32 v138, v106, 2, v138
    ds_add_rtn_u32 v114, v138, v184 offset:5120
    v_cndmask_b32 v139, 0, v146, s[78:79]
    v_lshl_add_u32 v139, v107, 2, v139
    ds_add_rtn_u32 v115, v139, v184 offset:5120
    s_waitcnt vmcnt(1)
    s_mov_b64 exec, s[70:71]
    v_mul_u32_u24 v108, s64, v132
    v_mul_u32_u24 v109, s64, v133
    v_mul_u32_u24 v110, s64, v134
    v_mul_u32_u24 v111, s64, v135
    v_lshrrev_b32 v108, 24, v108
    v_lshrrev_b32 v109, 24, v109
    v_lshrrev_b32 v110, 24, v110
    v_lshrrev_b32 v111, 24, v111
    v_lshlrev_b32 v140, 2, v108
    ds_add_rtn_u32 v116, v140, v184 offset:5120
    v_lshlrev_b32 v141, 2, v109
    ds_add_rtn_u32 v117, v141, v184 offset:5120
    v_lshlrev_b32 v142, 2, v110
    ds_add_rtn_u32 v118, v142, v184 offset:5120
    v_lshlrev_b32 v143, 2, v111
    ds_add_rtn_u32 v119, v143, v184 offset:5120
    s_waitcnt lgkmcnt(7)
    s_mov_b64 exec, s[72:73]
    v_cmpx_le_u32 vcc, 132, v112
    ds_add_rtn_u32 v112, v136, v184 offset:4096
    s_waitcnt lgkmcnt(7)
    s_mov_b64 exec, s[74:75]
    v_cmpx_le_u32 vcc, 132, v113
    ds_add_rtn_u32 v113, v137, v184 offset:4096
    s_waitcnt lgkmcnt(7)
    s_mov_b64 exec, s[76:77]
    v_cmpx_le_u32 vcc, 132, v114
    ds_add_rtn_u32 v114, v138, v184 offset:4096
    s_waitcnt lgkmcnt(7)
    s_mov_b64 exec, s[78:79]
    v_cmpx_le_u32 vcc, 132, v115
    ds_add_rtn_u32 v115, v139, v184 offset:4096
    s_mov_b64 exec, s[70:71]
    s_waitcnt vmcnt(0)
    v_mad_i32_i24 v132, v108, s65, v132
    v_mul_u32_u24 v194, s66, v100
    v_lshl_or_b32 v100, v132, 18, v100
    v_and_b32 v132, 0xe0, v108
    v_mad_i32_i24 v194, v132, s100, v194
    v_and_or_b32 v194, v194, s67, v145
    v_mad_u32_u24 v132, v108, 40, s69
    v_or_b32 v100, v100, v194
    v_mad_i32_i24 v133, v109, s65, v133
    v_mul_u32_u24 v194, s66, v101
    v_lshl_or_b32 v101, v133, 18, v101
    v_and_b32 v133, 0xe0, v109
    v_mad_i32_i24 v194, v133, s100, v194
    v_and_or_b32 v194, v194, s67, v145
    v_mad_u32_u24 v133, v109, 40, s69
    v_or_b32 v101, v101, v194
    v_mad_i32_i24 v134, v110, s65, v134
    v_mul_u32_u24 v194, s66, v102
    v_lshl_or_b32 v102, v134, 18, v102
    v_and_b32 v134, 0xe0, v110
    v_mad_i32_i24 v194, v134, s100, v194
    v_and_or_b32 v194, v194, s67, v145
    v_mad_u32_u24 v134, v110, 40, s69
    v_or_b32 v102, v102, v194
    v_mad_i32_i24 v135, v111, s65, v135
    v_mul_u32_u24 v194, s66, v103
    v_lshl_or_b32 v103, v135, 18, v103
    v_and_b32 v135, 0xe0, v111
    v_mad_i32_i24 v194, v135, s100, v194
    v_and_or_b32 v194, v194, s67, v145
    v_mad_u32_u24 v135, v111, 40, s69
    v_or_b32 v103, v103, v194
    s_waitcnt lgkmcnt(7)
    v_bfe_u32 v194, v116, 3, 5
    v_add_lshl_u32 v132, v194, v132, 2
    v_and_b32 v194, 3, v194
    v_mad_i32_i24 v194, v194, -3, v132
    v_cmpx_gt_u32 vcc, 792, v116
    ds_write_b32 v132, v100
    ds_write_b8 v194, v120 offset:12
    s_mov_b64 exec, s[70:71]
    s_waitcnt lgkmcnt(8)
    v_bfe_u32 v194, v117, 3, 5
    v_add_lshl_u32 v133, v194, v133, 2
    v_and_b32 v194, 3, v194
    v_mad_i32_i24 v194, v194, -3, v133
    v_cmpx_gt_u32 vcc, 792, v117
    ds_write_b32 v133, v101
    ds_write_b8 v194, v121 offset:12
    s_mov_b64 exec, s[70:71]
    s_waitcnt lgkmcnt(9)
    v_bfe_u32 v194, v118, 3, 5
    v_add_lshl_u32 v134, v194, v134, 2
    v_and_b32 v194, 3, v194
    v_mad_i32_i24 v194, v194, -3, v134
    v_cmpx_gt_u32 vcc, 792, v118
    ds_write_b32 v134, v102
    ds_write_b8 v194, v122 offset:12
    s_mov_b64 exec, s[70:71]
    s_waitcnt lgkmcnt(10)
    v_bfe_u32 v194, v119, 3, 5
    v_add_lshl_u32 v135, v194, v135, 2
    v_and_b32 v194, 3, v194
    v_mad_i32_i24 v194, v194, -3, v135
    v_cmpx_gt_u32 vcc, 792, v119
    ds_write_b32 v135, v103
    ds_write_b8 v194, v123 offset:12
    s_mov_b64 exec, -1
    v_mad_i32_i24 v128, v104, s65, v128
    v_mul_u32_u24 v194, s66, v96
    v_lshl_or_b32 v96, v128, 18, v96
    v_and_b32 v128, 0xe0, v104
    v_mad_i32_i24 v194, v128, s100, v194
    v_and_or_b32 v194, v194, s67, v144
    v_mad_u32_u24 v128, v104, 40, s69
    v_or_b32 v96, v96, v194
    v_mad_i32_i24 v129, v105, s65, v129
    v_mul_u32_u24 v194, s66, v97
    v_lshl_or_b32 v97, v129, 18, v97
    v_and_b32 v129, 0xe0, v105
    v_mad_i32_i24 v194, v129, s100, v194
    v_and_or_b32 v194, v194, s67, v144
    v_mad_u32_u24 v129, v105, 40, s69
    v_or_b32 v97, v97, v194
    v_mad_i32_i24 v130, v106, s65, v130
    v_mul_u32_u24 v194, s66, v98
    v_lshl_or_b32 v98, v130, 18, v98
    v_and_b32 v130, 0xe0, v106
    v_mad_i32_i24 v194, v130, s100, v194
    v_and_or_b32 v194, v194, s67, v144
    v_mad_u32_u24 v130, v106, 40, s69
    v_or_b32 v98, v98, v194
    v_mad_i32_i24 v131, v107, s65, v131
    v_mul_u32_u24 v194, s66, v99
    v_lshl_or_b32 v99, v131, 18, v99
    v_and_b32 v131, 0xe0, v107
    v_mad_i32_i24 v194, v131, s100, v194
    v_and_or_b32 v194, v194, s67, v144
    v_mad_u32_u24 v131, v107, 40, s69
    v_or_b32 v99, v99, v194
    s_waitcnt lgkmcnt(11)
    v_bfe_u32 v194, v112, 3, 5
    v_add_lshl_u32 v128, v194, v128, 2
    v_and_b32 v194, 3, v194
    v_mad_i32_i24 v194, v194, -3, v128
    v_cmpx_gt_u32 vcc, 792, v112
    ds_write_b32 v128, v96
    ds_write_b8 v194, v120 offset:12
    s_mov_b64 exec, -1
    s_waitcnt lgkmcnt(12)
    v_bfe_u32 v194, v113, 3, 5
    v_add_lshl_u32 v129, v194, v129, 2
    v_and_b32 v194, 3, v194
    v_mad_i32_i24 v194, v194, -3, v129
    v_cmpx_gt_u32 vcc, 792, v113
    ds_write_b32 v129, v97
    ds_write_b8 v194, v121 offset:12
    s_mov_b64 exec, -1
    s_waitcnt lgkmcnt(13)
    v_bfe_u32 v194, v114, 3, 5
    v_add_lshl_u32 v130, v194, v130, 2
    v_and_b32 v194, 3, v194
    v_mad_i32_i24 v194, v194, -3, v130
    v_cmpx_gt_u32 vcc, 792, v114
    ds_write_b32 v130, v98
    ds_write_b8 v194, v122 offset:12
    s_mov_b64 exec, -1
    s_waitcnt lgkmcnt(14)
    v_bfe_u32 v194, v115, 3, 5
    v_add_lshl_u32 v131, v194, v131, 2
    v_and_b32 v194, 3, v194
    v_mad_i32_i24 v194, v194, -3, v131
    v_cmpx_gt_u32 vcc, 792, v115
    ds_write_b32 v131, v99
    ds_write_b8 v194, v123 offset:12
    s_mov_b64 exec, -1
    s_branch L_B1
L_R4:
    s_waitcnt vmcnt(1)
    v_mul_u32_u24 v104, s64, v128
    v_mul_u32_u24 v105, s64, v129
    v_mul_u32_u24 v106, s64, v130
    v_mul_u32_u24 v107, s64, v131
    v_lshrrev_b32 v136, 29, v104
    v_lshrrev_b32 v137, 29, v105
    v_lshrrev_b32 v138, 29, v106
    v_lshrrev_b32 v139, 29, v107
    v_cmp_eq_u32 s[72:73], v136, v137
    v_cmp_eq_u32 s[76:77], v138, v139
    v_cmp_eq_u32 vcc, v136, v138
    v_cmp_eq_u32 s[88:89], v137, v139
    v_cmp_eq_u32 s[90:91], v136, v139
    v_cmp_eq_u32 s[10:11], v137, v138
    v_lshrrev_b32 v104, 24, v104
    v_lshrrev_b32 v105, 24, v105
    v_lshrrev_b32 v106, 24, v106
    v_lshrrev_b32 v107, 24, v107
    s_or_b64 s[74:75], s[72:73], s[88:89]
    s_or_b64 s[78:79], s[76:77], s[88:89]
    s_or_b64 s[72:73], s[72:73], vcc
    s_or_b64 s[76:77], s[76:77], vcc
    s_or_b64 s[72:73], s[72:73], s[90:91]
    s_or_b64 s[74:75], s[74:75], s[10:11]
    s_or_b64 s[76:77], s[76:77], s[10:11]
    s_or_b64 s[78:79], s[78:79], s[90:91]
    v_cndmask_b32 v136, 0, v146, s[72:73]
    v_lshl_add_u32 v136, v104, 2, v136
    ds_add_rtn_u32 v112, v136, v184 offset:5120
    v_cndmask_b32 v137, 0, v146, s[74:75]
    v_lshl_add_u32 v137, v105, 2, v137
    ds_add_rtn_u32 v113, v137, v184 offset:5120
    v_cndmask_b32 v138, 0, v146, s[76:77]
    v_lshl_add_u32 v138, v106, 2, v138
    ds_add_rtn_u32 v114, v138, v184 offset:5120
    v_cndmask_b32 v139, 0, v146, s[78:79]
    v_lshl_add_u32 v139, v107, 2, v139
    ds_add_rtn_u32 v115, v139, v184 offset:5120
    s_waitcnt vmcnt(0)
    v_mad_i32_i24 v128, v104, s65, v128
    v_mul_u32_u24 v194, s66, v96
    v_lshl_or_b32 v96, v128, 18, v96
    v_and_b32 v128, 0xe0, v104
    v_mad_i32_i24 v194, v128, s100, v194
    v_and_or_b32 v194, v194, s67, v144
    v_mad_u32_u24 v128, v104, 40, s69
    v_or_b32 v96, v96, v194
    v_mad_i32_i24 v129, v105, s65, v129
    v_mul_u32_u24 v194, s66, v97
    v_lshl_or_b32 v97, v129, 18, v97
    v_and_b32 v129, 0xe0, v105
    v_mad_i32_i24 v194, v129, s100, v194
    v_and_or_b32 v194, v194, s67, v144
    v_mad_u32_u24 v129, v105, 40, s69
    v_or_b32 v97, v97, v194
    s_waitcnt lgkmcnt(3)
    s_mov_b64 exec, s[72:73]
    v_cmpx_le_u32 vcc, 132, v112
    ds_add_rtn_u32 v112, v136, v184 offset:4096
    s_waitcnt lgkmcnt(3)
    s_mov_b64 exec, s[74:75]
    v_cmpx_le_u32 vcc, 132, v113
    ds_add_rtn_u32 v113, v137, v184 offset:4096
    s_waitcnt lgkmcnt(3)
    s_mov_b64 exec, s[76:77]
    v_cmpx_le_u32 vcc, 132, v114
    ds_add_rtn_u32 v114, v138, v184 offset:4096
    s_waitcnt lgkmcnt(3)
    s_mov_b64 exec, s[78:79]
    v_cmpx_le_u32 vcc, 132, v115
    ds_add_rtn_u32 v115, v139, v184 offset:4096
    s_mov_b64 exec, -1
    v_mad_i32_i24 v130, v106, s65, v130
    v_mul_u32_u24 v194, s66, v98
    v_lshl_or_b32 v98, v130, 18, v98
    v_and_b32 v130, 0xe0, v106
    v_mad_i32_i24 v194, v130, s100, v194
    v_and_or_b32 v194, v194, s67, v144
    v_mad_u32_u24 v130, v106, 40, s69
    v_or_b32 v98, v98, v194
    v_mad_i32_i24 v131, v107, s65, v131
    v_mul_u32_u24 v194, s66, v99
    v_lshl_or_b32 v99, v131, 18, v99
    v_and_b32 v131, 0xe0, v107
    v_mad_i32_i24 v194, v131, s100, v194
    v_and_or_b32 v194, v194, s67, v144
    v_mad_u32_u24 v131, v107, 40, s69
    v_or_b32 v99, v99, v194
    s_waitcnt lgkmcnt(3)
    v_bfe_u32 v194, v112, 3, 5
    v_add_lshl_u32 v128, v194, v128, 2
    v_and_b32 v194, 3, v194
    v_mad_i32_i24 v194, v194, -3, v128
    v_cmpx_gt_u32 vcc, 792, v112
    ds_write_b32 v128, v96
    ds_write_b8 v194, v120 offset:12
    s_mov_b64 exec, -1
    s_waitcnt lgkmcnt(4)
    v_bfe_u32 v194, v113, 3, 5
    v_add_lshl_u32 v129, v194, v129, 2
    v_and_b32 v194, 3, v194
    v_mad_i32_i24 v194, v194, -3, v129
    v_cmpx_gt_u32 vcc, 792, v113
    ds_write_b32 v129, v97
    ds_write_b8 v194, v121 offset:12
    s_mov_b64 exec, -1
    s_waitcnt lgkmcnt(5)
    v_bfe_u32 v194, v114, 3, 5
    v_add_lshl_u32 v130, v194, v130, 2
    v_and_b32 v194, 3, v194
    v_mad_i32_i24 v194, v194, -3, v130
    v_cmpx_gt_u32 vcc, 792, v114
    ds_write_b32 v130, v98
    ds_write_b8 v194, v122 offset:12
    s_mov_b64 exec, -1
    s_waitcnt lgkmcnt(6)
    v_bfe_u32 v194, v115, 3, 5
    v_add_lshl_u32 v131, v194, v131, 2
    v_and_b32 v194, 3, v194
    v_mad_i32_i24 v194, v194, -3, v131
    v_cmpx_gt_u32 vcc, 792, v115
    ds_write_b32 v131, v99
    ds_write_b8 v194, v123 offset:12
    s_mov_b64 exec, -1
L_B1:
    s_cmp_ge_u32 s3, 2
    s_cbranch_scc1 L_NOC
    global_load_dwordx4 v[176:179], v232, s[28:29]
L_NOC:
    global_load_dwordx4 v[160:163], v232, s[26:27]
    global_load_dwordx4 v[164:167], v232, s[32:33]
    global_load_dwordx4 v[168:171], v232, s[24:25]
    global_load_dwordx4 v[172:175], v232, s[30:31]
    s_add_u32 s6, s6, 0x2020202
    v_lshlrev_b32 v186, v246, s6
    v_and_b32 v189, 4, v247
    v_mul_u32_u24 v189, 1212416, v189
    v_lshl_add_u32 v186, v189, 8, v186
    v_and_b32 v186, 0xfe000000, v186
    v_and_b32 v187, 7, v247
    v_mul_u32_u24 v187, 33, v187
    v_add_u32 v187, 792, v187
    v_lshlrev_b32 v222, 2, v223
    s_mov_b32 s64, 0x1000000
    s_waitcnt lgkmcnt(0)
    s_barrier
    ds_read_b128 v[192:195], v185 offset:5120
    ds_read_b32 v228, v222 offset:5120
    ds_read_b128 v[204:207], v221 offset:0
    ds_read_b32 v229, v222 offset:5376
    ds_read_b128 v[208:211], v221 offset:10240
    ds_read_b32 v230, v222 offset:5632
    ds_read_b128 v[212:215], v221 offset:20480
    ds_read_b32 v231, v222 offset:5888
    ds_read_b128 v[216:219], v221 offset:30720
    s_mov_b32 s80, 2105344
    s_mov_b32 s81, 4210688
    s_mov_b32 s82, 6316032
    s_waitcnt lgkmcnt(8)
    v_max3_u32 v188, v192, v193, v194
    v_max_u32 v188, v188, v195
    v_cmp_lt_u32 vcc, 1056, v188
    s_cbranch_vccnz L_POVF
L_POUT:
    s_waitcnt lgkmcnt(7)
    v_sub_u32 v228, v187, v228
    v_and_or_b32 v228, v228, s64, v186
    s_waitcnt lgkmcnt(6)
    v_or_b32 v207, v207, v228
    buffer_store_dwordx4 v[204:207], v220, s[56:59], 0 offen sc1
    s_waitcnt lgkmcnt(5)
    v_sub_u32 v229, v187, v229
    v_and_or_b32 v229, v229, s64, v186
    s_waitcnt lgkmcnt(4)
    v_or_b32 v211, v211, v229
    buffer_store_dwordx4 v[208:211], v220, s[56:59], s80 offen sc1
    s_waitcnt lgkmcnt(3)
    v_sub_u32 v230, v187, v230
    v_and_or_b32 v230, v230, s64, v186
    s_waitcnt lgkmcnt(2)
    v_or_b32 v215, v215, v230
    buffer_store_dwordx4 v[212:215], v220, s[56:59], s81 offen sc1
    s_waitcnt lgkmcnt(1)
    v_sub_u32 v231, v187, v231
    v_and_or_b32 v231, v231, s64, v186
    s_waitcnt lgkmcnt(0)
    v_or_b32 v219, v219, v231
    buffer_store_dwordx4 v[216:219], v220, s[56:59], s82 offen sc1
    s_mov_b32 s10, 0xbfb8aa3b
    s_mov_b32 s11, s10
    s_mov_b32 s64, 0x05040100
    s_mov_b32 s66, 0x07060302
    s_waitcnt vmcnt(4)
    v_perm_b32 v144, v170, v168, s64
    v_perm_b32 v145, v170, v168, s66
    v_perm_b32 v146, v171, v169, s64
    v_perm_b32 v147, v171, v169, s66
    v_add_u32 v148, 77824, v224
    ds_write2_b32 v148, v144, v145 offset0:0 offset1:8
    ds_write2_b32 v148, v146, v147 offset0:16 offset1:24
    v_lshlrev_b32 v128, 16, v160
    v_and_b32 v129, 0xffff0000, v160
    v_lshlrev_b32 v130, 16, v161
    v_and_b32 v131, 0xffff0000, v161
    v_lshlrev_b32 v132, 16, v162
    v_and_b32 v133, 0xffff0000, v162
    v_lshlrev_b32 v134, 16, v163
    v_and_b32 v135, 0xffff0000, v163
    v_pk_mul_f32 v[128:129], v[128:129], s[10:11]
    v_pk_mul_f32 v[130:131], v[130:131], s[10:11]
    v_pk_mul_f32 v[132:133], v[132:133], s[10:11]
    v_pk_mul_f32 v[134:135], v[134:135], s[10:11]
    v_cvt_pk_bf16_f32 v136, v128, v132
    v_cvt_pk_bf16_f32 v137, v129, v133
    v_cvt_pk_bf16_f32 v138, v130, v134
    v_cvt_pk_bf16_f32 v139, v131, v135
    ds_write2_b32 v224, v136, v137 offset0:0 offset1:8
    ds_write2_b32 v224, v138, v139 offset0:16 offset1:24
    v_perm_b32 v152, v166, v164, s64
    v_perm_b32 v153, v166, v164, s66
    v_perm_b32 v154, v167, v165, s64
    v_perm_b32 v155, v167, v165, s66
    v_add_u32 v156, 10240, v224
    ds_write2_b32 v156, v152, v153 offset0:0 offset1:8
    ds_write2_b32 v156, v154, v155 offset0:16 offset1:24
    v_perm_b32 v144, v174, v172, s64
    v_perm_b32 v145, v174, v172, s66
    v_perm_b32 v146, v175, v173, s64
    v_perm_b32 v147, v175, v173, s66
    v_add_u32 v148, 130176, v224
    ds_write2_b32 v148, v144, v145 offset0:0 offset1:8
    ds_write2_b32 v148, v146, v147 offset0:16 offset1:24
    s_cmp_ge_u32 s3, 2
    s_cbranch_scc1 L_NOWC
    v_lshlrev_b32 v128, 16, v176
    v_and_b32 v129, 0xffff0000, v176
    v_lshlrev_b32 v130, 16, v177
    v_and_b32 v131, 0xffff0000, v177
    v_lshlrev_b32 v132, 16, v178
    v_and_b32 v133, 0xffff0000, v178
    v_lshlrev_b32 v134, 16, v179
    v_and_b32 v135, 0xffff0000, v179
    v_pk_mul_f32 v[128:129], v[128:129], s[10:11]
    v_pk_mul_f32 v[130:131], v[130:131], s[10:11]
    v_pk_mul_f32 v[132:133], v[132:133], s[10:11]
    v_pk_mul_f32 v[134:135], v[134:135], s[10:11]
    v_cvt_pk_bf16_f32 v136, v128, v132
    v_cvt_pk_bf16_f32 v137, v129, v133
    v_cvt_pk_bf16_f32 v138, v130, v134
    v_cvt_pk_bf16_f32 v139, v131, v135
    v_add_u32 v140, 20480, v224
    ds_write2_b32 v140, v136, v137 offset0:0 offset1:8
    ds_write2_b32 v140, v138, v139 offset0:16 offset1:24
L_NOWC:
    s_mul_i32 s34, s5, 32896
    s_add_u32 s34, s34, 65536
    s_add_u32 s56, s38, s34
    s_addc_u32 s57, s39, 0
    s_mov_b32 s58, 32768
    s_mov_b32 s59, 0x20000
    s_add_u32 s34, s34, 8421376
    s_add_u32 s60, s38, s34
    s_addc_u32 s61, s39, 0
    s_mov_b32 s62, 32768
    s_mov_b32 s63, 0x20000
    s_movk_i32 s26, 0
    s_movk_i32 s27, 8192
    s_movk_i32 s28, 16384
    s_movk_i32 s29, 24576
    s_waitcnt lgkmcnt(0)
    s_barrier
    v_add_u32 v225, 13312, v225
    ds_read_b64_tr_b16 v[0:1], v225 offset:0
    ds_read_b64_tr_b16 v[2:3], v225 offset:1280
    ds_read_b64_tr_b16 v[4:5], v225 offset:5120
    ds_read_b64_tr_b16 v[6:7], v225 offset:6400
    ds_read_b64_tr_b16 v[8:9], v225 offset:32
    ds_read_b64_tr_b16 v[10:11], v225 offset:1312
    ds_read_b64_tr_b16 v[12:13], v225 offset:5152
    ds_read_b64_tr_b16 v[14:15], v225 offset:6432
    ds_read_b64_tr_b16 v[16:17], v225 offset:64
    ds_read_b64_tr_b16 v[18:19], v225 offset:1344
    ds_read_b64_tr_b16 v[20:21], v225 offset:5184
    ds_read_b64_tr_b16 v[22:23], v225 offset:6464
    ds_read_b64_tr_b16 v[24:25], v225 offset:96
    ds_read_b64_tr_b16 v[26:27], v225 offset:1376
    v_mov_b32 v64, 0x2000000
    v_mov_b32 v65, 0x2000000
    v_mov_b32 v66, 0x2000000
    v_mov_b32 v67, 0x2000000
    v_mov_b32 v68, 0xfffff
    v_mov_b32 v69, 0xfffff
    v_mov_b32 v70, 0xfffff
    v_mov_b32 v71, 0xfffff
    v_lshl_add_u32 v72, v247, 4, s12
    ds_write_b128 v72, v[64:67] offset:0
    ds_write_b128 v72, v[68:71] offset:18432
    ds_write_b128 v72, v[64:67] offset:1024
    ds_write_b128 v72, v[68:71] offset:19456
    ds_write_b128 v72, v[64:67] offset:1280
    ds_write_b128 v72, v[68:71] offset:19712
    ds_read_b64_tr_b16 v[28:29], v225 offset:5216
    ds_read_b64_tr_b16 v[30:31], v225 offset:6496
    ds_read_b64_tr_b16 v[32:33], v225 offset:10240
    ds_read_b64_tr_b16 v[34:35], v225 offset:11520
    ds_read_b64_tr_b16 v[36:37], v225 offset:15360
    ds_read_b64_tr_b16 v[38:39], v225 offset:16640
    ds_read_b64_tr_b16 v[40:41], v225 offset:10272
    ds_read_b64_tr_b16 v[42:43], v225 offset:11552
    ds_read_b64_tr_b16 v[44:45], v225 offset:15392
    ds_read_b64_tr_b16 v[46:47], v225 offset:16672
    v_mov_b32 v192, v225
    s_mov_b32 exec_lo, 0
    v_subrev_u32 v192, 2560, v225
    s_mov_b32 exec_lo, -1
    s_waitcnt lgkmcnt(4)
    ds_read_b64_tr_b16 v[48:49], v225 offset:10304
    ds_read_b64_tr_b16 v[50:51], v225 offset:11584
    ds_read_b64_tr_b16 v[52:53], v225 offset:15424
    ds_read_b64_tr_b16 v[54:55], v225 offset:16704
    ds_read_b64_tr_b16 v[56:57], v225 offset:10336
    ds_read_b64_tr_b16 v[58:59], v225 offset:11616
    ds_read_b64_tr_b16 v[60:61], v225 offset:15456
    ds_read_b64_tr_b16 v[62:63], v225 offset:16736
    ds_read_b64_tr_b16 v[80:81], v192 offset:20480
    ds_read_b64_tr_b16 v[82:83], v192 offset:21760
    ds_read_b64_tr_b16 v[84:85], v192 offset:20512
    ds_read_b64_tr_b16 v[86:87], v192 offset:21792
    ds_read_b64_tr_b16 v[88:89], v192 offset:20544
    ds_read_b64_tr_b16 v[90:91], v192 offset:21824
    ds_read_b64_tr_b16 v[92:93], v192 offset:20576
    ds_read_b64_tr_b16 v[94:95], v192 offset:21856
    v_add_u32 v225, 77824, v225
    v_and_b32 v241, 1, v247
    v_lshlrev_b32 v241, 4, v241
    v_mov_b32 v242, 0x3f80
    v_and_b32 v245, 16, v247
    v_and_b32 v194, 15, v247
    v_lshl_add_u32 v194, v194, 5, s14
    s_mov_b32 exec_hi, 0
    v_add_u32 v245, v245, v194
    s_mov_b32 exec_hi, -1
    v_and_b32 v194, 3, v247
    v_bfe_u32 v196, v247, 2, 2
    v_and_b32 v197, 48, v247
    v_lshl_add_u32 v198, v196, 7, v197
    v_mul_u32_u24 v244, 1056, v194
    v_add3_u32 v244, v244, v198, s13
    v_lshrrev_b32 v194, 3, v247
    v_lshl_add_u32 v248, v194, 4, s12
    s_add_u32 s10, s12, 18432
    v_lshrrev_b32 v194, 1, v247
    v_lshl_add_u32 v249, v194, 2, s10
    s_add_u32 s10, s10, 2
    v_lshrrev_b32 v194, 5, v247
    v_mul_i32_i24 v250, 0xffffb800, v194
    v_and_b32 v194, 15, v247
    v_lshl_add_u32 v250, v194, 2, v250
    v_add_u32 v250, s10, v250
    s_add_u32 s10, s12, 2
    v_and_b32 v194, 48, v247
    v_lshl_add_u32 v251, v194, 1, s10
    v_and_b32 v194, 12, v247
    v_add_u32 v251, v251, v194
    v_mul_u32_u24 v159, 3128, v223
    v_add_u32 v156, 0, v159
    v_add_u32 v157, 200192, v159
    v_add_u32 v158, 400384, v159
    v_add_u32 v159, 600576, v159
    s_mov_b32 s98, 0xf0f0f0f
    s_mov_b32 s99, 0xf0f0f0f
    v_mov_b32 v180, 0xfffff
    v_mov_b32 v176, 0
    v_add_lshl_u32 v191, v232, v243, 16
    v_add_u32 v152, 0x34000000, v191
    v_cndmask_b32 v152, 0, v152, s[98:99]
    v_add_u32 v153, 0x54000000, v191
    v_cndmask_b32 v153, 0, v153, s[98:99]
    v_add_u32 v154, 0x74000000, v191
    v_cndmask_b32 v154, 0, v154, s[98:99]
    v_add_u32 v155, 0x94000000, v191
    v_cndmask_b32 v155, 0, v155, s[98:99]
    v_mov_b32 v184, 4
    v_and_b32 v177, 31, v247
    v_add_lshl_u32 v179, v177, s7, 2
    v_lshrrev_b32 v191, 5, v247
    v_lshl_add_u32 v178, v191, 11, v179
    v_add_u32 v179, 153728, v179
    v_lshlrev_b32 v191, 2, v247
    v_subrev_u32 v191, s7, v191
    s_mov_b32 s10, 0x10000
    v_add_u32 v228, 0, v191
    v_and_or_b32 v228, v228, s10, 1
    v_add_u32 v229, 1, v191
    v_and_or_b32 v229, v229, s10, 1
    v_add_u32 v230, 2, v191
    v_and_or_b32 v230, v230, s10, 1
    v_add_u32 v231, 3, v191
    v_and_or_b32 v231, v231, s10, 1
    s_movk_i32 s18, 0xffc
    s_movk_i32 s20, 32
    s_mov_b32 s21, 0
    s_mov_b32 s100, 0
    s_mov_b32 s16, 0x1ffffff
    s_mov_b32 s17, 0xffff
    s_mul_i32 s10, s4, 49
    s_sub_i32 s22, s10, 6
    s_ashr_i32 s22, s22, 1
    s_add_i32 s23, s10, 7
    s_ashr_i32 s23, s23, 1
    s_add_i32 s24, s10, 43
    s_ashr_i32 s24, s24, 1
    s_add_i32 s25, s22, 31
    s_cmp_eq_u32 s4, 7
    s_cselect_b32 s24, 196, s24
    s_cselect_b32 s25, 196, s25
    s_sub_i32 s23, s23, s7
    s_sub_i32 s24, s24, s7
    s_sub_i32 s25, s25, s7
    s_waitcnt vmcnt(0)
    buffer_load_dwordx4 v[128:131], v232, s[56:59], s26 offen sc1
    buffer_load_dwordx4 v[132:135], v232, s[56:59], s27 offen sc1
    buffer_load_dwordx4 v[136:139], v232, s[56:59], s28 offen sc1
    buffer_load_dwordx4 v[140:143], v232, s[56:59], s29 offen sc1
    v_max3_u32 v188, v112, v113, v114
    v_max3_u32 v189, v115, v116, v117
    v_max3_u32 v188, v188, v118, v119
    v_max_u32 v188, v188, v189
    v_cmp_le_u32 vcc, 792, v188
    s_cbranch_vccz L_PEXTR
    v_mov_b32 v65, s6
    s_lshl_b32 s34, s2, 7
    s_add_u32 s34, s34, 8486912
    v_subrev_u32 v68, 792, v112
    v_cmpx_gt_u32 vcc, 264, v68
    s_cbranch_execz L_PE0
    v_mov_b32 v64, v96
    v_mov_b32 v66, v120
    v_bfe_u32 v68, v112, 5, 3
    v_lshlrev_b32 v68, 4, v68
    v_mad_u32_u24 v68, v104, s68, v68
    buffer_store_dwordx4 v[64:67], v68, s[52:55], s34 offen sc1
L_PE0:
    s_mov_b64 exec, -1
    v_subrev_u32 v68, 792, v113
    v_cmpx_gt_u32 vcc, 264, v68
    s_cbranch_execz L_PE1
    v_mov_b32 v64, v97
    v_mov_b32 v66, v121
    v_bfe_u32 v68, v113, 5, 3
    v_lshlrev_b32 v68, 4, v68
    v_mad_u32_u24 v68, v105, s68, v68
    buffer_store_dwordx4 v[64:67], v68, s[52:55], s34 offen sc1
L_PE1:
    s_mov_b64 exec, -1
    v_subrev_u32 v68, 792, v114
    v_cmpx_gt_u32 vcc, 264, v68
    s_cbranch_execz L_PE2
    v_mov_b32 v64, v98
    v_mov_b32 v66, v122
    v_bfe_u32 v68, v114, 5, 3
    v_lshlrev_b32 v68, 4, v68
    v_mad_u32_u24 v68, v106, s68, v68
    buffer_store_dwordx4 v[64:67], v68, s[52:55], s34 offen sc1
L_PE2:
    s_mov_b64 exec, -1
    v_subrev_u32 v68, 792, v115
    v_cmpx_gt_u32 vcc, 264, v68
    s_cbranch_execz L_PE3
    v_mov_b32 v64, v99
    v_mov_b32 v66, v123
    v_bfe_u32 v68, v115, 5, 3
    v_lshlrev_b32 v68, 4, v68
    v_mad_u32_u24 v68, v107, s68, v68
    buffer_store_dwordx4 v[64:67], v68, s[52:55], s34 offen sc1
L_PE3:
    s_mov_b64 exec, -1
    v_subrev_u32 v68, 792, v116
    v_cmpx_gt_u32 vcc, 264, v68
    s_cbranch_execz L_PE4
    v_mov_b32 v64, v100
    v_mov_b32 v66, v120
    v_bfe_u32 v68, v116, 5, 3
    v_lshlrev_b32 v68, 4, v68
    v_mad_u32_u24 v68, v108, s68, v68
    buffer_store_dwordx4 v[64:67], v68, s[52:55], s34 offen sc1
L_PE4:
    s_mov_b64 exec, -1
    v_subrev_u32 v68, 792, v117
    v_cmpx_gt_u32 vcc, 264, v68
    s_cbranch_execz L_PE5
    v_mov_b32 v64, v101
    v_mov_b32 v66, v121
    v_bfe_u32 v68, v117, 5, 3
    v_lshlrev_b32 v68, 4, v68
    v_mad_u32_u24 v68, v109, s68, v68
    buffer_store_dwordx4 v[64:67], v68, s[52:55], s34 offen sc1
L_PE5:
    s_mov_b64 exec, -1
    v_subrev_u32 v68, 792, v118
    v_cmpx_gt_u32 vcc, 264, v68
    s_cbranch_execz L_PE6
    v_mov_b32 v64, v102
    v_mov_b32 v66, v122
    v_bfe_u32 v68, v118, 5, 3
    v_lshlrev_b32 v68, 4, v68
    v_mad_u32_u24 v68, v110, s68, v68
    buffer_store_dwordx4 v[64:67], v68, s[52:55], s34 offen sc1
L_PE6:
    s_mov_b64 exec, -1
    v_subrev_u32 v68, 792, v119
    v_cmpx_gt_u32 vcc, 264, v68
    s_cbranch_execz L_PE7
    v_mov_b32 v64, v103
    v_mov_b32 v66, v123
    v_bfe_u32 v68, v119, 5, 3
    v_lshlrev_b32 v68, 4, v68
    v_mad_u32_u24 v68, v111, s68, v68
    buffer_store_dwordx4 v[64:67], v68, s[52:55], s34 offen sc1
L_PE7:
    s_mov_b64 exec, -1
L_PEXTR:
L_PW0:
    s_waitcnt vmcnt(3)
    v_xor_b32 v188, v131, v186
    v_and_b32_sdwa v96, v128, s18 dst_sel:DWORD dst_unused:UNUSED_PAD src0_sel:WORD_1 src1_sel:DWORD
    v_and_b32_sdwa v97, v129, s18 dst_sel:DWORD dst_unused:UNUSED_PAD src0_sel:WORD_1 src1_sel:DWORD
    v_and_b32_sdwa v98, v130, s18 dst_sel:DWORD dst_unused:UNUSED_PAD src0_sel:WORD_1 src1_sel:DWORD
    v_cmp_lt_u32 vcc, s16, v188
    v_cmp_ne_u32 s[64:65], 0, v128
    v_cmp_ne_u32 s[66:67], 0, v129
    v_cmp_ne_u32 s[68:69], 0, v130
    s_cbranch_vccnz L_RT0
    s_mov_b64 exec, s[64:65]
    ds_add_rtn_u32 v112, v96, v184 offset:1024
    s_mov_b64 exec, s[66:67]
    ds_add_rtn_u32 v113, v97, v184 offset:1024
    s_mov_b64 exec, s[68:69]
    ds_add_rtn_u32 v114, v98, v184 offset:1024
    s_mov_b64 exec, -1
    v_or_b32 v176, v176, v129
    v_add_u32_sdwa v204, v131, v156 dst_sel:DWORD dst_unused:UNUSED_PAD src0_sel:BYTE_0 src1_sel:DWORD
    v_lshrrev_b32 v189, 28, v128
    v_lshl_add_u32 v204, v189, 8, v204
    v_and_b32 v189, 60, v96
    v_and_b32 v128, 0xffff, v128
    v_lshl_or_b32 v128, v189, 19, v128
    v_cndmask_b32 v188, v180, v204, s[64:65]
    v_max_u32 v204, v204, v152
    v_add_u32_sdwa v205, v131, v156 dst_sel:DWORD dst_unused:UNUSED_PAD src0_sel:BYTE_1 src1_sel:DWORD
    v_lshrrev_b32 v189, 28, v129
    v_lshl_add_u32 v205, v189, 8, v205
    v_and_b32 v189, 60, v97
    v_and_b32 v129, 0xffff, v129
    v_lshl_or_b32 v129, v189, 19, v129
    v_mov_b32_dpp v190, v188 quad_perm:[2,2,3,3] row_mask:0xf bank_mask:0xf
    v_mov_b32_dpp v207, v188 quad_perm:[0,0,1,1] row_mask:0xf bank_mask:0xf
    v_add_u32_sdwa v206, v131, v156 dst_sel:DWORD dst_unused:UNUSED_PAD src0_sel:BYTE_2 src1_sel:DWORD
    v_lshrrev_b32 v189, 28, v130
    v_lshl_add_u32 v206, v189, 8, v206
    v_and_b32 v189, 60, v98
    v_and_b32 v130, 0xffff, v130
    v_lshl_or_b32 v130, v189, 19, v130
    v_mov_b32_dpp v207, v190 row_shr:4 row_mask:0xf bank_mask:0xa
L_PW1:
    s_waitcnt vmcnt(2)
    v_xor_b32 v188, v135, v186
    v_and_b32_sdwa v100, v132, s18 dst_sel:DWORD dst_unused:UNUSED_PAD src0_sel:WORD_1 src1_sel:DWORD
    v_and_b32_sdwa v101, v133, s18 dst_sel:DWORD dst_unused:UNUSED_PAD src0_sel:WORD_1 src1_sel:DWORD
    v_and_b32_sdwa v102, v134, s18 dst_sel:DWORD dst_unused:UNUSED_PAD src0_sel:WORD_1 src1_sel:DWORD
    v_cmp_lt_u32 vcc, s16, v188
    v_cmp_ne_u32 s[72:73], 0, v132
    v_cmp_ne_u32 s[74:75], 0, v133
    v_cmp_ne_u32 s[76:77], 0, v134
    s_cbranch_vccnz L_RT1
    s_mov_b64 exec, s[72:73]
    ds_add_rtn_u32 v116, v100, v184 offset:1024
    s_mov_b64 exec, s[74:75]
    ds_add_rtn_u32 v117, v101, v184 offset:1024
    s_mov_b64 exec, s[76:77]
    ds_add_rtn_u32 v118, v102, v184 offset:1024
    s_mov_b64 exec, -1
    v_or_b32 v176, v176, v133
    v_add_u32_sdwa v208, v135, v157 dst_sel:DWORD dst_unused:UNUSED_PAD src0_sel:BYTE_0 src1_sel:DWORD
    v_lshrrev_b32 v189, 28, v132
    v_lshl_add_u32 v208, v189, 8, v208
    v_and_b32 v189, 60, v100
    v_and_b32 v132, 0xffff, v132
    v_lshl_or_b32 v132, v189, 19, v132
    v_cndmask_b32 v188, v180, v208, s[72:73]
    v_max_u32 v208, v208, v153
    v_add_u32_sdwa v209, v135, v157 dst_sel:DWORD dst_unused:UNUSED_PAD src0_sel:BYTE_1 src1_sel:DWORD
    v_lshrrev_b32 v189, 28, v133
    v_lshl_add_u32 v209, v189, 8, v209
    v_and_b32 v189, 60, v101
    v_and_b32 v133, 0xffff, v133
    v_lshl_or_b32 v133, v189, 19, v133
    v_mov_b32_dpp v190, v188 quad_perm:[2,2,3,3] row_mask:0xf bank_mask:0xf
    v_mov_b32_dpp v211, v188 quad_perm:[0,0,1,1] row_mask:0xf bank_mask:0xf
    v_add_u32_sdwa v210, v135, v157 dst_sel:DWORD dst_unused:UNUSED_PAD src0_sel:BYTE_2 src1_sel:DWORD
    v_lshrrev_b32 v189, 28, v134
    v_lshl_add_u32 v210, v189, 8, v210
    v_and_b32 v189, 60, v102
    v_and_b32 v134, 0xffff, v134
    v_lshl_or_b32 v134, v189, 19, v134
    v_mov_b32_dpp v211, v190 row_shr:4 row_mask:0xf bank_mask:0xa
L_PW2:
    s_waitcnt vmcnt(1)
    v_xor_b32 v188, v139, v186
    v_and_b32_sdwa v104, v136, s18 dst_sel:DWORD dst_unused:UNUSED_PAD src0_sel:WORD_1 src1_sel:DWORD
    v_and_b32_sdwa v105, v137, s18 dst_sel:DWORD dst_unused:UNUSED_PAD src0_sel:WORD_1 src1_sel:DWORD
    v_and_b32_sdwa v106, v138, s18 dst_sel:DWORD dst_unused:UNUSED_PAD src0_sel:WORD_1 src1_sel:DWORD
    v_cmp_lt_u32 vcc, s16, v188
    v_cmp_ne_u32 s[80:81], 0, v136
    v_cmp_ne_u32 s[82:83], 0, v137
    v_cmp_ne_u32 s[84:85], 0, v138
    s_cbranch_vccnz L_RT2
    s_mov_b64 exec, s[80:81]
    ds_add_rtn_u32 v120, v104, v184 offset:1024
    s_mov_b64 exec, s[82:83]
    ds_add_rtn_u32 v121, v105, v184 offset:1024
    s_mov_b64 exec, s[84:85]
    ds_add_rtn_u32 v122, v106, v184 offset:1024
    s_mov_b64 exec, -1
    v_or_b32 v176, v176, v137
    v_add_u32_sdwa v212, v139, v158 dst_sel:DWORD dst_unused:UNUSED_PAD src0_sel:BYTE_0 src1_sel:DWORD
    v_lshrrev_b32 v189, 28, v136
    v_lshl_add_u32 v212, v189, 8, v212
    v_and_b32 v189, 60, v104
    v_and_b32 v136, 0xffff, v136
    v_lshl_or_b32 v136, v189, 19, v136
    v_cndmask_b32 v188, v180, v212, s[80:81]
    v_max_u32 v212, v212, v154
    v_add_u32_sdwa v213, v139, v158 dst_sel:DWORD dst_unused:UNUSED_PAD src0_sel:BYTE_1 src1_sel:DWORD
    v_lshrrev_b32 v189, 28, v137
    v_lshl_add_u32 v213, v189, 8, v213
    v_and_b32 v189, 60, v105
    v_and_b32 v137, 0xffff, v137
    v_lshl_or_b32 v137, v189, 19, v137
    v_mov_b32_dpp v190, v188 quad_perm:[2,2,3,3] row_mask:0xf bank_mask:0xf
    v_mov_b32_dpp v215, v188 quad_perm:[0,0,1,1] row_mask:0xf bank_mask:0xf
    v_add_u32_sdwa v214, v139, v158 dst_sel:DWORD dst_unused:UNUSED_PAD src0_sel:BYTE_2 src1_sel:DWORD
    v_lshrrev_b32 v189, 28, v138
    v_lshl_add_u32 v214, v189, 8, v214
    v_and_b32 v189, 60, v106
    v_and_b32 v138, 0xffff, v138
    v_lshl_or_b32 v138, v189, 19, v138
    v_mov_b32_dpp v215, v190 row_shr:4 row_mask:0xf bank_mask:0xa
L_PW3:
    s_waitcnt vmcnt(0)
    v_xor_b32 v188, v143, v186
    v_and_b32_sdwa v108, v140, s18 dst_sel:DWORD dst_unused:UNUSED_PAD src0_sel:WORD_1 src1_sel:DWORD
    v_and_b32_sdwa v109, v141, s18 dst_sel:DWORD dst_unused:UNUSED_PAD src0_sel:WORD_1 src1_sel:DWORD
    v_and_b32_sdwa v110, v142, s18 dst_sel:DWORD dst_unused:UNUSED_PAD src0_sel:WORD_1 src1_sel:DWORD
    v_cmp_lt_u32 vcc, s16, v188
    v_cmp_ne_u32 s[88:89], 0, v140
    v_cmp_ne_u32 s[90:91], 0, v141
    v_cmp_ne_u32 s[92:93], 0, v142
    s_cbranch_vccnz L_RT3
    s_mov_b64 exec, s[88:89]
    ds_add_rtn_u32 v124, v108, v184 offset:1024
    s_mov_b64 exec, s[90:91]
    ds_add_rtn_u32 v125, v109, v184 offset:1024
    s_mov_b64 exec, s[92:93]
    ds_add_rtn_u32 v126, v110, v184 offset:1024
    s_mov_b64 exec, -1
    v_or_b32 v176, v176, v141
    v_or3_b32 v190, v131, v135, v139
    v_or_b32 v190, v190, v143
    v_and_b32 v190, 0x1000000, v190
    v_cmp_ne_u32 vcc, 0, v190
    s_cbranch_vccz L_XT1R
    v_and_b32 v190, 0x1000000, v131
    v_cmp_ne_u32 s[70:71], 0, v190
    s_bcnt1_i32_b64 s10, s[70:71]
    s_lshl2_add_u32 s21, s10, s21
    v_and_b32 v190, 0x1000000, v135
    v_cmp_ne_u32 s[78:79], 0, v190
    s_bcnt1_i32_b64 s10, s[78:79]
    s_lshl2_add_u32 s21, s10, s21
    v_and_b32 v190, 0x1000000, v139
    v_cmp_ne_u32 s[86:87], 0, v190
    s_bcnt1_i32_b64 s10, s[86:87]
    s_lshl2_add_u32 s21, s10, s21
    v_and_b32 v190, 0x1000000, v143
    v_cmp_ne_u32 s[94:95], 0, v190
    s_bcnt1_i32_b64 s10, s[94:95]
    s_lshl2_add_u32 s21, s10, s21
    s_mov_b64 exec, s[70:71]
    s_cbranch_execz L_XLa0
    s_movk_i32 s10, 0
    buffer_load_dwordx4 v[64:67], v232, s[60:63], s10 offen sc1
L_XLa0:
    s_mov_b64 exec, s[78:79]
    s_cbranch_execz L_XLa1
    s_movk_i32 s10, 8192
    buffer_load_dwordx4 v[68:71], v232, s[60:63], s10 offen sc1
L_XLa1:
    s_mov_b64 exec, s[86:87]
    s_cbranch_execz L_XLa2
    s_movk_i32 s10, 16384
    buffer_load_dwordx4 v[72:75], v232, s[60:63], s10 offen sc1
L_XLa2:
    s_mov_b64 exec, s[94:95]
    s_cbranch_execz L_XLa3
    s_movk_i32 s10, 24576
    buffer_load_dwordx4 v[76:79], v232, s[60:63], s10 offen sc1
L_XLa3:
    s_mov_b64 exec, -1
    v_and_b32 v190, 0x10000, v176
    v_mov_b32 v191, 640
    v_cmpx_ne_u32 vcc, 0, v190
    ds_write_b32 v191, v184 offset:4
    s_mov_b64 exec, 1
    v_mov_b32 v190, s21
    ds_add_u32 v191, v190 offset:8
    s_mov_b64 exec, -1
L_XT1R:
    v_add_u32_sdwa v216, v143, v159 dst_sel:DWORD dst_unused:UNUSED_PAD src0_sel:BYTE_0 src1_sel:DWORD
    v_lshrrev_b32 v189, 28, v140
    v_lshl_add_u32 v216, v189, 8, v216
    v_and_b32 v189, 60, v108
    v_and_b32 v140, 0xffff, v140
    v_lshl_or_b32 v140, v189, 19, v140
    v_cndmask_b32 v188, v180, v216, s[88:89]
    v_max_u32 v216, v216, v155
    v_add_u32_sdwa v217, v143, v159 dst_sel:DWORD dst_unused:UNUSED_PAD src0_sel:BYTE_1 src1_sel:DWORD
    v_lshrrev_b32 v189, 28, v141
    v_lshl_add_u32 v217, v189, 8, v217
    v_and_b32 v189, 60, v109
    v_and_b32 v141, 0xffff, v141
    v_lshl_or_b32 v141, v189, 19, v141
    v_mov_b32_dpp v190, v188 quad_perm:[2,2,3,3] row_mask:0xf bank_mask:0xf
    v_mov_b32_dpp v219, v188 quad_perm:[0,0,1,1] row_mask:0xf bank_mask:0xf
    v_add_u32_sdwa v218, v143, v159 dst_sel:DWORD dst_unused:UNUSED_PAD src0_sel:BYTE_2 src1_sel:DWORD
    v_lshrrev_b32 v189, 28, v142
    v_lshl_add_u32 v218, v189, 8, v218
    v_mov_b32_dpp v219, v190 row_shr:4 row_mask:0xf bank_mask:0xa
    v_mov_b32 v197, 640
    s_cmp_eq_u32 s3, 6
    s_cselect_b32 exec_hi, 0, -1
    s_cmp_eq_u32 s3, 7
    s_cselect_b64 exec, 1, exec
    s_add_u32 m0, s101, 0
    s_nop 0
    buffer_load_dwordx4 v234, s[40:43], 0 offen offset:0 lds
    s_add_u32 m0, s101, 6560
    s_nop 0
    buffer_load_dwordx4 v234, s[40:43], 0 offen offset:128 lds
    s_add_u32 m0, s101, 13120
    s_nop 0
    buffer_load_dwordx4 v234, s[40:43], 0 offen offset:256 lds
    s_add_u32 m0, s101, 19680
    s_nop 0
    buffer_load_dwordx4 v234, s[40:43], 0 offen offset:384 lds
    s_mov_b64 exec, -1
    s_waitcnt lgkmcnt(0)
    s_barrier
    ds_read_u16 v198, v178 offset:1024
    ds_read_u16 v199, v178 offset:2048
    ds_read_b128 v[160:163], v185 offset:1024
    ds_read_b128 v[164:167], v185 offset:2048
    ds_read_b128 v[168:171], v185 offset:3072
    ds_read_b128 v[172:175], v185 offset:4096
    ds_read_b32 v236, v197 offset:8
    s_lshl_b32 m0, s3, 10
    v_mov_b32 v240, v207
    s_add_u32 m0, m0, 13312
    s_nop 0
    buffer_load_dwordx4 v[240:241], s[44:47], 0 idxen offen lds
    s_cmp_lg_u32 s2, 0
    s_cbranch_scc1 L_NOK
    v_mov_b32 v237, s6
    v_mov_b32 v238, 0
    buffer_store_dword v237, v238, s[52:55], 0 offen sc1
L_NOK:
    s_waitcnt lgkmcnt(5)
    v_lshl_or_b32 v198, v199, 16, v198
    v_mov_b32 v199, v198
    s_waitcnt lgkmcnt(0)
    v_add_u32_sdwa v188, v160, v164 dst_sel:DWORD dst_unused:UNUSED_PAD src0_sel:WORD_0 src1_sel:WORD_0
    v_add_u32_sdwa v192, v168, v172 dst_sel:DWORD dst_unused:UNUSED_PAD src0_sel:WORD_0 src1_sel:WORD_0
    v_add_u32_dpp v199, v199, v199 row_shr:1 row_mask:0xf bank_mask:0xf bound_ctrl:0
    v_add_u32_sdwa v189, v161, v165 dst_sel:DWORD dst_unused:UNUSED_PAD src0_sel:WORD_0 src1_sel:WORD_0
    v_add_u32_sdwa v193, v169, v173 dst_sel:DWORD dst_unused:UNUSED_PAD src0_sel:WORD_0 src1_sel:WORD_0
    v_add_u32_dpp v199, v199, v199 row_shr:2 row_mask:0xf bank_mask:0xf bound_ctrl:0
    v_add_u32_sdwa v190, v162, v166 dst_sel:DWORD dst_unused:UNUSED_PAD src0_sel:WORD_0 src1_sel:WORD_0
    v_add_u32_sdwa v194, v170, v174 dst_sel:DWORD dst_unused:UNUSED_PAD src0_sel:WORD_0 src1_sel:WORD_0
    v_add_u32_dpp v199, v199, v199 row_shr:4 row_mask:0xf bank_mask:0xf bound_ctrl:0
    v_add_u32_sdwa v191, v163, v167 dst_sel:DWORD dst_unused:UNUSED_PAD src0_sel:WORD_0 src1_sel:WORD_0
    v_add_u32_sdwa v195, v171, v175 dst_sel:DWORD dst_unused:UNUSED_PAD src0_sel:WORD_0 src1_sel:WORD_0
    v_add_u32_dpp v199, v199, v199 row_shr:8 row_mask:0xf bank_mask:0xf bound_ctrl:0
    v_add_u32 v188, v188, v192
    v_add_u32 v189, v189, v193
    v_add_u32_dpp v199, v199, v199 row_bcast:15 row_mask:0xa bank_mask:0xf
    v_add_u32 v190, v190, v194
    v_add_u32 v191, v191, v195
    v_mul_u32_u24 v196, v188, v228
    v_mad_u32_u24 v196, v189, v229, v196
    v_mad_u32_u24 v196, v190, v230, v196
    v_mad_u32_u24 v196, v191, v231, v196
    s_mov_b32 s96, -1
    s_mov_b32 s97, 0
    v_sub_u32 v200, v199, v198
    v_add_u32_sdwa v202, v199, v199 dst_sel:DWORD dst_unused:UNUSED_PAD src0_sel:WORD_0 src1_sel:WORD_1
    v_add_u32_dpp v196, v196, v196 row_shr:1 row_mask:0xf bank_mask:0xf bound_ctrl:0
    v_add_u32_sdwa v201, v200, v200 dst_sel:DWORD dst_unused:UNUSED_PAD src0_sel:WORD_0 src1_sel:WORD_1
    v_add_u32_sdwa v203, v198, v198 dst_sel:DWORD dst_unused:UNUSED_PAD src0_sel:WORD_0 src1_sel:WORD_1
    v_add_u32_dpp v196, v196, v196 row_shr:2 row_mask:0xf bank_mask:0xf bound_ctrl:0
    v_and_b32 v239, 60, v110
    v_readfirstlane_b32 s19, v236
    v_add_u32_dpp v196, v196, v196 row_shr:4 row_mask:0xf bank_mask:0xf bound_ctrl:0
    v_permlane32_swap_b32 v201, v202
    v_cndmask_b32 v203, 0, v203, s[96:97]
    v_add_u32_dpp v196, v196, v196 row_shr:8 row_mask:0xf bank_mask:0xf bound_ctrl:0
    v_add_u32 v201, v201, v202
    v_and_b32 v142, 0xffff, v142
    v_add_u32_dpp v196, v196, v196 row_bcast:15 row_mask:0xa bank_mask:0xf
    v_add_u32 v202, v201, v203
    v_lshl_or_b32 v142, v239, 19, v142
    v_add_u32_dpp v196, v196, v196 row_bcast:31 row_mask:0xc bank_mask:0xf
    v_sub_u32_sdwa v203, v202, v198 dst_sel:DWORD dst_unused:UNUSED_PAD src0_sel:DWORD src1_sel:WORD_1
    v_readlane_b32 s16, v196, 63
    s_lshl_b32 m0, s3, 10
    v_mov_b32 v240, v211
    s_add_u32 m0, m0, 21504
    s_nop 0
    buffer_load_dwordx4 v[240:241], s[44:47], 0 idxen offen lds
    s_bfe_u32 s10, s16, 0xe0002
    s_lshr_b32 s16, s16, 16
    s_lshr_b32 s11, s10, 1
    s_add_u32 s11, s11, 48
    s_and_b32 s11, s11, -128
    s_lshr_b32 s8, s4, 1
    s_mul_i32 s8, s8, s10
    s_sub_i32 s11, s11, 48
    s_sub_i32 s8, s8, s16
    s_add_i32 s11, s11, s8
    s_add_i32 s10, s10, s8
    s_bitcmp1_b32 s4, 0
    s_cselect_b32 s31, s11, s8
    s_cselect_b32 s10, s10, s11
    v_cmp_gt_i32 vcc, s31, v202
    v_cmp_gt_i32 s[34:35], s10, v202
    s_bcnt1_i32_b32 s22, vcc_lo
    s_bcnt1_i32_b32 s10, s34
    s_min_i32 s22, s22, s23
    s_max_i32 s10, s10, s24
    s_min_i32 s23, s10, s25
    v_readlane_b32 s16, v201, s22
    v_readlane_b32 s30, v201, s23
    s_add_u32 s8, s22, s7
    s_add_u32 s9, s23, s7
    s_add_u32 s10, s22, 32
    s_add_u32 s11, s23, 32
    v_readlane_b32 s26, v200, s22
    v_readlane_b32 s28, v200, s23
    v_readlane_b32 s27, v200, s10
    v_readlane_b32 s29, v200, s11
    s_sub_u32 s31, s30, s16
    s_add_u32 s10, s31, 255
    s_sub_i32 s11, s23, 16
    s_max_i32 s11, s11, s22
    v_readlane_b32 s11, v201, s11
    s_add_u32 vcc_lo, s31, 127
    s_and_b32 vcc_hi, vcc_lo, 127
    s_add_u32 vcc_hi, vcc_hi, s19
    s_cmp_lt_u32 vcc_hi, 55
    s_cselect_b32 vcc_lo, vcc_lo, s10
    s_sub_u32 s11, s11, s16
    s_add_u32 s11, s11, s19
    s_lshl_b32 s11, s11, 1
    s_and_b32 vcc_lo, vcc_lo, -256
    s_cmp_le_u32 s11, vcc_lo
    s_cselect_b32 s10, vcc_lo, s10
    s_lshr_b32 s10, s10, 8
    s_lshl_b32 s10, s10, 7
    s_sub_u32 s10, s10, s19
    s_max_i32 s10, s10, 0
    s_add_u32 s16, s16, s10
    s_add_u32 s10, s22, 16
    s_min_u32 s10, s10, s23
    s_sub_i32 s11, s23, 16
    v_cmp_ge_u32 s[34:35], s16, v203
    v_cmp_ge_u32 s[36:37], s16, v202
    v_cmp_gt_i32 vcc, s10, v177
    v_cmp_gt_i32 s[10:11], s11, v177
    v_cmp_le_u32 s[32:33], s22, v177
    v_cmp_gt_u32 s[96:97], s23, v177
    s_and_b64 s[34:35], s[34:35], vcc
    s_and_b64 s[36:37], s[36:37], vcc
    s_or_b64 s[34:35], s[34:35], s[10:11]
    s_or_b64 s[36:37], s[36:37], s[10:11]
    s_bcnt1_i32_b32 s24, s34
    s_bcnt1_i32_b32 s10, s36
    s_bcnt1_i32_b32 s11, s35
    s_bcnt1_i32_b32 s25, s37
    v_readlane_b32 s22, v200, s24
    v_readlane_b32 s10, v200, s10
    s_add_u32 s11, s11, 32
    s_add_u32 s16, s25, 32
    v_readlane_b32 s23, v200, s11
    v_readlane_b32 s11, v200, s16
    v_mov_b32 v188, s17
    v_cndmask_b32 v189, 0, v188, s[34:35]
    v_cndmask_b32 v188, 0, v188, s[36:37]
    s_and_b64 s[32:33], s[32:33], s[96:97]
    s_pack_lh_b32_b16 s22, s22, s10
    s_pack_lh_b32_b16 s23, s23, s11
    v_lshl_or_b32 v188, v188, 16, v189
    s_sub_u32 s16, s12, 37888
    s_pack_ll_b32_b16 s16, s16, s16
    s_sub_u32 s10, s22, s26
    s_sub_u32 s11, s23, s27
    s_mul_i32 s10, s10, 0x10001
    s_lshl_b32 vcc_lo, s10, 16
    s_pack_hh_b32_b16 s10, s10, s10
    s_lshl_b32 vcc_hi, s11, 16
    s_add_u32 vcc_hi, vcc_hi, s10
    s_add_u32 s96, vcc_hi, s11
    s_lshr_b32 s96, s96, 16
    s_sub_u32 s31, s31, s96
    s_cmp_gt_u32 s31, s96
    s_cselect_b32 s97, 0x4800480, 0
    s_add_u32 s16, s16, s97
    s_sub_u32 s10, s16, s26
    s_sub_u32 s11, s16, s27
    s_add_u32 s10, s10, vcc_lo
    s_add_u32 s11, s11, vcc_hi
    v_mov_b32 v192, s10
    v_mov_b32 v193, s11
    s_add_u32 s16, s16, 0x4800480
    s_sub_u32 s16, s16, s97
    s_sub_u32 s16, s16, s97
    s_sub_u32 s10, s28, s22
    s_sub_u32 s11, s29, s23
    s_mul_i32 s10, s10, 0x10001
    s_lshl_b32 vcc_lo, s10, 16
    s_pack_hh_b32_b16 s10, s10, s10
    s_lshl_b32 vcc_hi, s11, 16
    s_add_u32 vcc_hi, vcc_hi, s10
    s_sub_u32 s10, s16, s22
    s_sub_u32 s11, s16, s23
    s_add_u32 s10, s10, vcc_lo
    s_add_u32 s11, s11, vcc_hi
    v_mov_b32 v194, s10
    v_mov_b32 v195, s11
    v_bfi_b32 v192, v188, v192, v194
    v_bfi_b32 v193, v188, v193, v195
    s_mov_b32 exec_hi, 0
    v_mov_b32 v193, v192
    s_mov_b64 exec, s[32:33]
    v_add_u32 v200, v200, v193
    s_bfe_u32 s10, s97, 0x10007
    s_lshl1_add_u32 s10, s4, s10
    s_lshl_b32 s10, s10, 2
    v_cndmask_b32 v188, 4, 0, s[34:35]
    ds_write_b16 v178, v200 offset:1026
    ds_write_b16_d16_hi v178, v200 offset:2050
    s_mov_b32 exec_hi, 0
    v_xor_b32 v188, s10, v188
    ds_write_b32 v179, v188
    s_mov_b64 exec, -1
    s_min_u32 s10, s31, s96
    s_max_u32 s96, s31, s96
    s_mov_b32 s31, s10
    s_add_u32 s10, s96, s19
    s_mul_i32 s11, s30, 9216
    s_lshr_b32 s11, s11, 16
    s_max_u32 s10, s10, s11
    s_cmp_lt_u32 s10, 1152
    s_cbranch_scc1 L_LFIT
    ds_write_b32 v197, v184
L_LFIT:
    s_cmp_eq_u32 s19, 0
    s_cbranch_scc1 L_XCNR
    s_sub_u32 s10, s12, 37888
    s_add_u32 s11, s10, s96
    v_mov_b32 v188, s11
    s_add_u32 s11, s10, s31
    s_add_u32 s11, s11, 1152
    v_mov_b32 v189, s11
    s_lshl_b32 s10, s4, 3
    v_mov_b32 v190, s10
    ds_write_b64 v190, v[188:189] offset:576
L_XCNR:
    s_lshl_b32 m0, s3, 10
    v_mov_b32 v240, v215
    s_add_u32 m0, m0, 29696
    s_nop 0
    buffer_load_dwordx4 v[240:241], s[44:47], 0 idxen offen lds
    s_waitcnt vmcnt(3)
    s_waitcnt lgkmcnt(0)
    s_barrier
    ds_read_b64 v[202:203], v197
    ds_read_u16 v96, v96 offset:1026
    ds_read_u16 v97, v97 offset:1026
    ds_read_u16 v98, v98 offset:1026
    ds_read_u16 v100, v100 offset:1026
    ds_read_u16 v101, v101 offset:1026
    ds_read_u16 v102, v102 offset:1026
    ds_read_u16 v104, v104 offset:1026
    ds_read_u16 v105, v105 offset:1026
    ds_read_u16 v106, v106 offset:1026
    ds_read_u16 v108, v108 offset:1026
    ds_read_u16 v109, v109 offset:1026
    ds_read_u16 v110, v110 offset:1026
    s_lshl_b32 m0, s3, 10
    v_mov_b32 v240, v219
    s_add_u32 m0, m0, 37888
    s_nop 0
    buffer_load_dwordx4 v[240:241], s[44:47], 0 idxen offen lds
    s_add_u32 s24, s24, s7
    s_add_u32 s11, s25, s7
    s_and_b32 s10, s11, 15
    s_cmp_lt_u32 s11, s24
    s_cselect_b32 s25, s10, 16
    s_cmp_lg_u32 s97, 0
    s_cselect_b32 s23, s8, s11
    s_cselect_b32 s7, s8, s24
    s_cselect_b32 s8, s11, s8
    s_cselect_b32 s24, s9, s24
    s_cselect_b32 s9, s11, s9
    s_min_u32 s22, s8, 192
    s_min_u32 s23, s23, 192
    s_mov_b32 s30, s19
    s_waitcnt lgkmcnt(12)
    v_cmp_ne_u32 vcc, 0, v202
    v_readfirstlane_b32 s19, v203
    s_cbranch_vccnz L_OVF
    s_waitcnt lgkmcnt(9)
    s_mov_b64 exec, s[64:65]
    v_add_u32 v96, v96, v112
    ds_write2st64_b32 v96, v128, v204 offset0:148 offset1:220
    s_mov_b64 exec, s[66:67]
    v_add_u32 v97, v97, v113
    ds_write2st64_b32 v97, v129, v205 offset0:148 offset1:220
    s_mov_b64 exec, s[68:69]
    v_add_u32 v98, v98, v114
    ds_write2st64_b32 v98, v130, v206 offset0:148 offset1:220
    s_waitcnt lgkmcnt(9)
    s_mov_b64 exec, s[72:73]
    v_add_u32 v100, v100, v116
    ds_write2st64_b32 v100, v132, v208 offset0:148 offset1:220
    s_mov_b64 exec, s[74:75]
    v_add_u32 v101, v101, v117
    ds_write2st64_b32 v101, v133, v209 offset0:148 offset1:220
    s_mov_b64 exec, s[76:77]
    v_add_u32 v102, v102, v118
    ds_write2st64_b32 v102, v134, v210 offset0:148 offset1:220
    s_waitcnt lgkmcnt(9)
    s_mov_b64 exec, s[80:81]
    v_add_u32 v104, v104, v120
    ds_write2st64_b32 v104, v136, v212 offset0:148 offset1:220
    s_mov_b64 exec, s[82:83]
    v_add_u32 v105, v105, v121
    ds_write2st64_b32 v105, v137, v213 offset0:148 offset1:220
    s_mov_b64 exec, s[84:85]
    v_add_u32 v106, v106, v122
    ds_write2st64_b32 v106, v138, v214 offset0:148 offset1:220
    s_waitcnt lgkmcnt(9)
    s_mov_b64 exec, s[88:89]
    v_add_u32 v108, v108, v124
    ds_write2st64_b32 v108, v140, v216 offset0:148 offset1:220
    s_mov_b64 exec, s[90:91]
    v_add_u32 v109, v109, v125
    ds_write2st64_b32 v109, v141, v217 offset0:148 offset1:220
    s_mov_b64 exec, s[92:93]
    v_add_u32 v110, v110, v126
    ds_write2st64_b32 v110, v142, v218 offset0:148 offset1:220
    s_mov_b64 exec, -1
    s_add_u32 s10, s96, 127
    s_lshr_b32 s10, s10, 7
    s_lshl1_add_u32 s10, s10, -1
    s_add_u32 s11, s31, 127
    s_lshr_b32 s11, s11, 6
    s_and_b32 s11, s11, -2
    s_max_i32 s17, s10, s11
    s_cselect_b32 s10, s96, s31
    s_sub_u32 s10, s10, 1
    s_andn2_b32 s99, 64, s10
L_CA:
    ds_read_b64_tr_b16 v[96:97], v225 offset:0
    ds_read_b64_tr_b16 v[98:99], v225 offset:1280
    ds_read_b64_tr_b16 v[100:101], v225 offset:5120
    ds_read_b64_tr_b16 v[102:103], v225 offset:6400
    ds_read_b64_tr_b16 v[104:105], v225 offset:32
    ds_read_b64_tr_b16 v[106:107], v225 offset:1312
    ds_read_b64_tr_b16 v[108:109], v225 offset:5152
    ds_read_b64_tr_b16 v[110:111], v225 offset:6432
    ds_read_b64_tr_b16 v[112:113], v225 offset:64
    ds_read_b64_tr_b16 v[114:115], v225 offset:1344
    ds_read_b64_tr_b16 v[116:117], v225 offset:5184
    ds_read_b64_tr_b16 v[118:119], v225 offset:6464
    ds_read_b64_tr_b16 v[120:121], v225 offset:96
    ds_read_b64_tr_b16 v[122:123], v225 offset:1376
    ds_read_b64_tr_b16 v[124:125], v225 offset:5216
    ds_read_b64_tr_b16 v[126:127], v225 offset:6496
    s_cmp_eq_u32 s21, 0
    s_cbranch_scc1 L_XT2R
    s_waitcnt vmcnt(8)
L_XT2:
    s_mov_b64 s[34:35], 0
    v_cmp_ne_u32 vcc, s6, v65
    s_and_b64 vcc, vcc, s[70:71]
    s_or_b64 s[34:35], s[34:35], vcc
    v_cmp_ne_u32 vcc, s6, v69
    s_and_b64 vcc, vcc, s[78:79]
    s_or_b64 s[34:35], s[34:35], vcc
    v_cmp_ne_u32 vcc, s6, v73
    s_and_b64 vcc, vcc, s[86:87]
    s_or_b64 s[34:35], s[34:35], vcc
    v_cmp_ne_u32 vcc, s6, v77
    s_and_b64 vcc, vcc, s[94:95]
    s_or_b64 s[34:35], s[34:35], vcc
    s_cbranch_scc1 L_XT2B
    s_cmp_eq_u32 s20, 0
    s_cbranch_scc1 L_XT2R
    s_mov_b64 exec, s[70:71]
    s_cbranch_execz L_XS0
    v_bfe_u32 v65, v64, 18, 8
    v_lshlrev_b32 v65, 2, v65
    v_add_u32 v67, 153728, v65
    ds_read_b32 v67, v67
    v_add_u32_sdwa v66, v66, v156 dst_sel:DWORD dst_unused:UNUSED_PAD src0_sel:BYTE_0 src1_sel:DWORD
    v_lshrrev_b32 v189, 28, v64
    v_lshl_add_u32 v66, v189, 8, v66
    v_and_b32 v189, 60, v65
    v_and_b32 v64, 0xffff, v64
    v_lshl_or_b32 v64, v189, 19, v64
    s_waitcnt lgkmcnt(0)
    ds_add_rtn_u32 v67, v67, v184 offset:576
    s_waitcnt lgkmcnt(0)
    ds_write2st64_b32 v67, v64, v66 offset0:148 offset1:220
L_XS0:
    s_mov_b64 exec, s[78:79]
    s_cbranch_execz L_XS1
    v_bfe_u32 v69, v68, 18, 8
    v_lshlrev_b32 v69, 2, v69
    v_add_u32 v71, 153728, v69
    ds_read_b32 v71, v71
    v_add_u32_sdwa v70, v70, v157 dst_sel:DWORD dst_unused:UNUSED_PAD src0_sel:BYTE_0 src1_sel:DWORD
    v_lshrrev_b32 v189, 28, v68
    v_lshl_add_u32 v70, v189, 8, v70
    v_and_b32 v189, 60, v69
    v_and_b32 v68, 0xffff, v68
    v_lshl_or_b32 v68, v189, 19, v68
    s_waitcnt lgkmcnt(0)
    ds_add_rtn_u32 v71, v71, v184 offset:576
    s_waitcnt lgkmcnt(0)
    ds_write2st64_b32 v71, v68, v70 offset0:148 offset1:220
L_XS1:
    s_mov_b64 exec, s[86:87]
    s_cbranch_execz L_XS2
    v_bfe_u32 v73, v72, 18, 8
    v_lshlrev_b32 v73, 2, v73
    v_add_u32 v75, 153728, v73
    ds_read_b32 v75, v75
    v_add_u32_sdwa v74, v74, v158 dst_sel:DWORD dst_unused:UNUSED_PAD src0_sel:BYTE_0 src1_sel:DWORD
    v_lshrrev_b32 v189, 28, v72
    v_lshl_add_u32 v74, v189, 8, v74
    v_and_b32 v189, 60, v73
    v_and_b32 v72, 0xffff, v72
    v_lshl_or_b32 v72, v189, 19, v72
    s_waitcnt lgkmcnt(0)
    ds_add_rtn_u32 v75, v75, v184 offset:576
    s_waitcnt lgkmcnt(0)
    ds_write2st64_b32 v75, v72, v74 offset0:148 offset1:220
L_XS2:
    s_mov_b64 exec, s[94:95]
    s_cbranch_execz L_XS3
    v_bfe_u32 v77, v76, 18, 8
    v_lshlrev_b32 v77, 2, v77
    v_add_u32 v79, 153728, v77
    ds_read_b32 v79, v79
    v_add_u32_sdwa v78, v78, v159 dst_sel:DWORD dst_unused:UNUSED_PAD src0_sel:BYTE_0 src1_sel:DWORD
    v_lshrrev_b32 v189, 28, v76
    v_lshl_add_u32 v78, v189, 8, v78
    v_and_b32 v189, 60, v77
    v_and_b32 v76, 0xffff, v76
    v_lshl_or_b32 v76, v189, 19, v76
    s_waitcnt lgkmcnt(0)
    ds_add_rtn_u32 v79, v79, v184 offset:576
    s_waitcnt lgkmcnt(0)
    ds_write2st64_b32 v79, v76, v78 offset0:148 offset1:220
L_XS3:
    s_mov_b64 exec, -1
L_XT2R:
    s_cmp_ge_u32 s3, 4
    s_cbranch_scc1 L_EP0
    s_lshl_b32 s34, s22, 5
    s_lshl_b32 s35, s23, 5
    s_mov_b32 vcc_lo, 0xff00ff00
    s_mov_b32 vcc_hi, 0xff00ff00
    v_mov_b32 v176, s35
    v_mov_b32 v177, s34
    v_cndmask_b32 v176, v176, v177, vcc
    v_and_b32 v177, 4, v247
    v_lshlrev_b32 v177, 6, v177
    v_lshl_add_u32 v177, v246, 2, v177
    v_sub_u32 v177, v177, v176
    v_and_b32 v178, 48, v247
    s_movk_i32 s34, 832
    v_mad_u32_u24 v178, v246, s34, v178
    s_mov_b32 s34, 116736
    v_add3_u32 v178, v178, v176, s34
    v_and_b32 v176, 0x1ff, v177
    v_add_u32 v176, v176, v178
    v_add_u32 v177, 0x80, v177
    v_and_b32 v177, 0x1ff, v177
    v_add_u32 v177, v177, v178
    v_mov_b64 v[184:185], 0
    v_mov_b64 v[186:187], 0
    v_lshrrev_b32 v188, 2, v247
    v_and_b32 v188, 12, v188
    v_subrev_u32 v188, s25, v188
    v_mov_b32 v189, 0x358637bd
    v_mfma_f32_32x32x16_bf16 v[144:159], v[184:187], v[184:187], 0
    v_cmp_ne_u32 s[80:81], 0, v188
    v_cmp_ne_u32 s[82:83], -1, v188
    v_cmp_ne_u32 s[84:85], -2, v188
    v_cmp_ne_u32 s[86:87], -3, v188
    v_cndmask_b32 v128, 0, v189, s[80:81]
    v_cndmask_b32 v129, 0, v189, s[82:83]
    v_cndmask_b32 v130, 0, v189, s[84:85]
    v_cndmask_b32 v131, 0, v189, s[86:87]
    v_mov_b64 v[132:133], v[128:129]
    v_mov_b64 v[134:135], v[130:131]
    v_mov_b64 v[136:137], v[128:129]
    v_mov_b64 v[138:139], v[130:131]
    v_mov_b64 v[140:141], v[128:129]
    v_mov_b64 v[142:143], v[130:131]
    ds_read_b128 v[160:163], v176 offset:0
    ds_read_b128 v[164:167], v176 offset:64
    ds_read_b128 v[168:171], v177 offset:0
    ds_read_b128 v[172:175], v177 offset:64
    s_mov_b32 s34, 0xbfb8aa3b
    s_mov_b32 s35, s34
    s_waitcnt lgkmcnt(3)
    v_mfma_f32_16x16x32_bf16 v[204:207], v[160:163], v[96:99], 0
    v_mfma_f32_16x16x32_bf16 v[212:215], v[160:163], v[104:107], 0
    v_mfma_f32_16x16x32_bf16 v[220:223], v[160:163], v[112:115], 0
    v_mfma_f32_16x16x32_bf16 v[228:231], v[160:163], v[120:123], 0
    s_waitcnt lgkmcnt(2)
    v_mfma_f32_16x16x32_bf16 v[204:207], v[164:167], v[100:103], v[204:207]
    v_mfma_f32_16x16x32_bf16 v[212:215], v[164:167], v[108:111], v[212:215]
    v_mfma_f32_16x16x32_bf16 v[220:223], v[164:167], v[116:119], v[220:223]
    v_mfma_f32_16x16x32_bf16 v[228:231], v[164:167], v[124:127], v[228:231]
    s_waitcnt lgkmcnt(1)
    v_mfma_f32_16x16x32_bf16 v[208:211], v[168:171], v[96:99], 0
    v_mfma_f32_16x16x32_bf16 v[216:219], v[168:171], v[104:107], 0
    v_mfma_f32_16x16x32_bf16 v[224:227], v[168:171], v[112:115], 0
    v_mfma_f32_16x16x32_bf16 v[232:235], v[168:171], v[120:123], 0
    s_waitcnt lgkmcnt(0)
    v_mfma_f32_16x16x32_bf16 v[208:211], v[172:175], v[100:103], v[208:211]
    v_mfma_f32_16x16x32_bf16 v[216:219], v[172:175], v[108:111], v[216:219]
    v_mfma_f32_16x16x32_bf16 v[224:227], v[172:175], v[116:119], v[224:227]
    v_mfma_f32_16x16x32_bf16 v[232:235], v[172:175], v[124:127], v[232:235]
    s_mov_b32 s10, 0x358637bd
    s_mov_b32 s11, s10
    v_mov_b64 v[96:97], s[10:11]
    v_mov_b64 v[98:99], s[10:11]
    v_mov_b64 v[100:101], s[10:11]
    v_mov_b64 v[102:103], s[10:11]
    v_mov_b64 v[104:105], s[10:11]
    v_mov_b64 v[106:107], s[10:11]
    v_mov_b64 v[108:109], s[10:11]
    v_mov_b64 v[110:111], s[10:11]
L_EP0:
    s_waitcnt vmcnt(0) lgkmcnt(0)
    s_barrier
    ds_read_b128 v[236:239], v248
    ds_read_b32 v240, v249
    s_cmp_ge_u32 s3, 4
    s_cbranch_scc1 L_LATE0
    s_waitcnt lgkmcnt(0)
    s_add_u32 m0, s13, 0
    v_mad_u32_u16 v236, v236, s15, v243
    buffer_load_dwordx4 v236, s[40:43], 0 offen lds
    s_add_u32 m0, s13, 1056
    v_mad_u32_u16 v237, v237, s15, v243
    buffer_load_dwordx4 v237, s[40:43], 0 offen lds
    s_add_u32 m0, s13, 2112
    v_mad_u32_u16 v238, v238, s15, v243
    buffer_load_dwordx4 v238, s[40:43], 0 offen lds
    s_add_u32 m0, s13, 3168
    v_mad_u32_u16 v239, v239, s15, v243
    buffer_load_dwordx4 v239, s[40:43], 0 offen lds
    s_mov_b32 m0, s14
    s_nop 0
    buffer_load_dwordx4 v[240:241], s[44:47], 0 idxen offen lds
    s_mov_b32 s34, 0xbfb8aa3b
    s_mov_b32 s35, s34
    v_pk_mul_f32 v[204:205], v[204:205], s[34:35]
    v_pk_mul_f32 v[206:207], v[206:207], s[34:35]
    v_pk_mul_f32 v[208:209], v[208:209], s[34:35]
    v_pk_mul_f32 v[210:211], v[210:211], s[34:35]
    v_pk_mul_f32 v[212:213], v[212:213], s[34:35]
    v_pk_mul_f32 v[214:215], v[214:215], s[34:35]
    v_pk_mul_f32 v[216:217], v[216:217], s[34:35]
    v_pk_mul_f32 v[218:219], v[218:219], s[34:35]
    v_pk_mul_f32 v[220:221], v[220:221], s[34:35]
    v_pk_mul_f32 v[222:223], v[222:223], s[34:35]
    v_pk_mul_f32 v[224:225], v[224:225], s[34:35]
    v_pk_mul_f32 v[226:227], v[226:227], s[34:35]
    v_pk_mul_f32 v[228:229], v[228:229], s[34:35]
    v_pk_mul_f32 v[230:231], v[230:231], s[34:35]
    v_pk_mul_f32 v[232:233], v[232:233], s[34:35]
    v_pk_mul_f32 v[234:235], v[234:235], s[34:35]
    v_mfma_f32_32x32x16_bf16 v[112:127], v[184:187], v[184:187], 0
    v_cvt_pk_bf16_f32 v64, v204, v205
    v_cvt_pk_bf16_f32 v65, v206, v207
    v_cvt_pk_bf16_f32 v66, v208, v209
    v_cvt_pk_bf16_f32 v67, v210, v211
    v_cvt_pk_bf16_f32 v68, v212, v213
    v_cvt_pk_bf16_f32 v69, v214, v215
    v_cvt_pk_bf16_f32 v70, v216, v217
    v_cvt_pk_bf16_f32 v71, v218, v219
    v_cvt_pk_bf16_f32 v72, v220, v221
    v_cvt_pk_bf16_f32 v73, v222, v223
    v_cvt_pk_bf16_f32 v74, v224, v225
    v_cvt_pk_bf16_f32 v75, v226, v227
    v_cvt_pk_bf16_f32 v76, v228, v229
    v_cvt_pk_bf16_f32 v77, v230, v231
    v_cvt_pk_bf16_f32 v78, v232, v233
    v_cvt_pk_bf16_f32 v79, v234, v235
    v_permlane32_swap_b32 v80, v64
    v_permlane32_swap_b32 v81, v65
    v_permlane32_swap_b32 v82, v66
    v_permlane32_swap_b32 v83, v67
    v_permlane32_swap_b32 v84, v68
    v_permlane32_swap_b32 v85, v69
    v_permlane32_swap_b32 v86, v70
    v_permlane32_swap_b32 v87, v71
    v_permlane32_swap_b32 v88, v72
    v_permlane32_swap_b32 v89, v73
    v_permlane32_swap_b32 v90, v74
    v_permlane32_swap_b32 v91, v75
    v_permlane32_swap_b32 v92, v76
    v_permlane32_swap_b32 v93, v77
    v_permlane32_swap_b32 v94, v78
    v_permlane32_swap_b32 v95, v79
    s_lshl_b32 s72, s4, 7
    s_add_u32 s72, s72, 157824
    v_mov_b32 v190, s22
    s_mov_b32 exec_lo, 0xffff0000
    v_mov_b32 v190, s23
    s_mov_b32 exec_lo, -1
    s_mov_b32 exec_hi, 0
    v_sub_u32 v191, v247, v190
    v_and_b32 v191, 15, v191
    v_add_lshl_u32 v191, v191, v190, 5
    v_lshl_add_u32 v190, v247, 2, s72
    ds_write_b32 v190, v191
    s_mov_b32 exec_hi, -1
    s_mul_i32 s10, s5, 196
    s_add_u32 s11, s10, s7
    s_add_u32 s62, s10, s9
    s_min_u32 s11, s11, 50000
    s_min_u32 s62, s62, 50000
    s_sub_u32 s62, s62, s11
    s_lshl_b32 s11, s11, 7
    s_lshl_b32 s62, s62, 7
    s_add_u32 s60, s48, s11
    s_addc_u32 s61, s49, 0
    s_mul_i32 s74, s7, -128
    s_add_u32 s11, s10, s8
    s_add_u32 s50, s10, s24
    s_min_u32 s11, s11, 50000
    s_min_u32 s50, s50, 50000
    s_sub_u32 s50, s50, s11
    s_lshl_b32 s11, s11, 7
    s_lshl_b32 s50, s50, 7
    s_add_u32 s48, s48, s11
    s_addc_u32 s49, s49, 0
    s_mul_i32 s73, s8, -128
    s_and_b32 s10, s25, 12
    s_lshl_b32 s10, s10, 2
    s_bfm_b64 s[76:77], 16, s10
    s_branch L_SET
L_LATE0:
    s_lshl_b32 s34, s22, 5
    s_lshl_b32 s35, s23, 5
    s_mov_b32 vcc_lo, 0xff00ff00
    s_mov_b32 vcc_hi, 0xff00ff00
    v_mov_b32 v176, s35
    v_mov_b32 v177, s34
    v_cndmask_b32 v176, v176, v177, vcc
    v_and_b32 v177, 4, v247
    v_lshlrev_b32 v177, 6, v177
    v_lshl_add_u32 v177, v246, 2, v177
    v_sub_u32 v177, v177, v176
    v_and_b32 v178, 48, v247
    s_movk_i32 s34, 832
    v_mad_u32_u24 v178, v246, s34, v178
    s_mov_b32 s34, 116736
    v_add3_u32 v178, v178, v176, s34
    v_and_b32 v176, 0x1ff, v177
    v_add_u32 v176, v176, v178
    v_add_u32 v177, 0x80, v177
    v_and_b32 v177, 0x1ff, v177
    v_add_u32 v177, v177, v178
    v_mov_b64 v[184:185], 0
    v_mov_b64 v[186:187], 0
    v_lshrrev_b32 v188, 2, v247
    v_and_b32 v188, 12, v188
    v_subrev_u32 v188, s25, v188
    v_mov_b32 v189, 0x358637bd
    v_mfma_f32_32x32x16_bf16 v[144:159], v[184:187], v[184:187], 0
    v_cmp_ne_u32 s[80:81], 0, v188
    v_cmp_ne_u32 s[82:83], -1, v188
    v_cmp_ne_u32 s[84:85], -2, v188
    v_cmp_ne_u32 s[86:87], -3, v188
    v_cndmask_b32 v128, 0, v189, s[80:81]
    v_cndmask_b32 v129, 0, v189, s[82:83]
    v_cndmask_b32 v130, 0, v189, s[84:85]
    v_cndmask_b32 v131, 0, v189, s[86:87]
    v_mov_b64 v[132:133], v[128:129]
    v_mov_b64 v[134:135], v[130:131]
    v_mov_b64 v[136:137], v[128:129]
    v_mov_b64 v[138:139], v[130:131]
    v_mov_b64 v[140:141], v[128:129]
    v_mov_b64 v[142:143], v[130:131]
    ds_read_b128 v[160:163], v176 offset:0
    ds_read_b128 v[164:167], v176 offset:64
    ds_read_b128 v[168:171], v177 offset:0
    ds_read_b128 v[172:175], v177 offset:64
    s_mov_b32 s34, 0xbfb8aa3b
    s_mov_b32 s35, s34
    s_waitcnt lgkmcnt(3)
    v_mfma_f32_16x16x32_bf16 v[204:207], v[160:163], v[96:99], 0
    v_mfma_f32_16x16x32_bf16 v[212:215], v[160:163], v[104:107], 0
    v_mfma_f32_16x16x32_bf16 v[220:223], v[160:163], v[112:115], 0
    v_mfma_f32_16x16x32_bf16 v[228:231], v[160:163], v[120:123], 0
    s_waitcnt lgkmcnt(2)
    v_mfma_f32_16x16x32_bf16 v[204:207], v[164:167], v[100:103], v[204:207]
    v_mfma_f32_16x16x32_bf16 v[212:215], v[164:167], v[108:111], v[212:215]
    v_mfma_f32_16x16x32_bf16 v[220:223], v[164:167], v[116:119], v[220:223]
    v_mfma_f32_16x16x32_bf16 v[228:231], v[164:167], v[124:127], v[228:231]
    s_waitcnt lgkmcnt(1)
    v_mfma_f32_16x16x32_bf16 v[208:211], v[168:171], v[96:99], 0
    v_mfma_f32_16x16x32_bf16 v[216:219], v[168:171], v[104:107], 0
    v_mfma_f32_16x16x32_bf16 v[224:227], v[168:171], v[112:115], 0
    v_mfma_f32_16x16x32_bf16 v[232:235], v[168:171], v[120:123], 0
    s_waitcnt lgkmcnt(0)
    v_mfma_f32_16x16x32_bf16 v[208:211], v[172:175], v[100:103], v[208:211]
    v_mfma_f32_16x16x32_bf16 v[216:219], v[172:175], v[108:111], v[216:219]
    v_mfma_f32_16x16x32_bf16 v[224:227], v[172:175], v[116:119], v[224:227]
    v_mfma_f32_16x16x32_bf16 v[232:235], v[172:175], v[124:127], v[232:235]
    s_mov_b32 s10, 0x358637bd
    s_mov_b32 s11, s10
    v_mov_b64 v[96:97], s[10:11]
    v_mov_b64 v[98:99], s[10:11]
    v_mov_b64 v[100:101], s[10:11]
    v_mov_b64 v[102:103], s[10:11]
    v_mov_b64 v[104:105], s[10:11]
    v_mov_b64 v[106:107], s[10:11]
    v_mov_b64 v[108:109], s[10:11]
    v_mov_b64 v[110:111], s[10:11]
    v_pk_mul_f32 v[204:205], v[204:205], s[34:35]
    v_pk_mul_f32 v[206:207], v[206:207], s[34:35]
    v_pk_mul_f32 v[208:209], v[208:209], s[34:35]
    v_pk_mul_f32 v[210:211], v[210:211], s[34:35]
    v_pk_mul_f32 v[212:213], v[212:213], s[34:35]
    v_pk_mul_f32 v[214:215], v[214:215], s[34:35]
    v_pk_mul_f32 v[216:217], v[216:217], s[34:35]
    v_pk_mul_f32 v[218:219], v[218:219], s[34:35]
    v_pk_mul_f32 v[220:221], v[220:221], s[34:35]
    v_pk_mul_f32 v[222:223], v[222:223], s[34:35]
    v_pk_mul_f32 v[224:225], v[224:225], s[34:35]
    v_pk_mul_f32 v[226:227], v[226:227], s[34:35]
    v_pk_mul_f32 v[228:229], v[228:229], s[34:35]
    v_pk_mul_f32 v[230:231], v[230:231], s[34:35]
    v_pk_mul_f32 v[232:233], v[232:233], s[34:35]
    v_pk_mul_f32 v[234:235], v[234:235], s[34:35]
    v_mfma_f32_32x32x16_bf16 v[112:127], v[184:187], v[184:187], 0
    v_cvt_pk_bf16_f32 v64, v204, v205
    v_cvt_pk_bf16_f32 v65, v206, v207
    v_cvt_pk_bf16_f32 v66, v208, v209
    v_cvt_pk_bf16_f32 v67, v210, v211
    v_cvt_pk_bf16_f32 v68, v212, v213
    v_cvt_pk_bf16_f32 v69, v214, v215
    v_cvt_pk_bf16_f32 v70, v216, v217
    v_cvt_pk_bf16_f32 v71, v218, v219
    v_cvt_pk_bf16_f32 v72, v220, v221
    v_cvt_pk_bf16_f32 v73, v222, v223
    v_cvt_pk_bf16_f32 v74, v224, v225
    v_cvt_pk_bf16_f32 v75, v226, v227
    v_cvt_pk_bf16_f32 v76, v228, v229
    v_cvt_pk_bf16_f32 v77, v230, v231
    v_cvt_pk_bf16_f32 v78, v232, v233
    v_cvt_pk_bf16_f32 v79, v234, v235
    v_permlane32_swap_b32 v80, v64
    v_permlane32_swap_b32 v81, v65
    v_permlane32_swap_b32 v82, v66
    v_permlane32_swap_b32 v83, v67
    v_permlane32_swap_b32 v84, v68
    v_permlane32_swap_b32 v85, v69
    v_permlane32_swap_b32 v86, v70
    v_permlane32_swap_b32 v87, v71
    v_permlane32_swap_b32 v88, v72
    v_permlane32_swap_b32 v89, v73
    v_permlane32_swap_b32 v90, v74
    v_permlane32_swap_b32 v91, v75
    v_permlane32_swap_b32 v92, v76
    v_permlane32_swap_b32 v93, v77
    v_permlane32_swap_b32 v94, v78
    v_permlane32_swap_b32 v95, v79
L_SET:
    s_mov_b32 s26, -1
    s_mov_b64 s[32:33], 0
    s_mov_b32 s28, 0
    s_mov_b32 s29, 0
    s_cmp_lt_u32 s3, 4
    s_cbranch_scc1 L_HAD0
    s_lshl_b32 s72, s4, 7
    s_add_u32 s72, s72, 157824
    v_mov_b32 v190, s22
    s_mov_b32 exec_lo, 0xffff0000
    v_mov_b32 v190, s23
    s_mov_b32 exec_lo, -1
    s_mov_b32 exec_hi, 0
    v_sub_u32 v191, v247, v190
    v_and_b32 v191, 15, v191
    v_add_lshl_u32 v191, v191, v190, 5
    v_lshl_add_u32 v190, v247, 2, s72
    ds_write_b32 v190, v191
    s_mov_b32 exec_hi, -1
    s_mul_i32 s10, s5, 196
    s_add_u32 s11, s10, s7
    s_add_u32 s62, s10, s9
    s_min_u32 s11, s11, 50000
    s_min_u32 s62, s62, 50000
    s_sub_u32 s62, s62, s11
    s_lshl_b32 s11, s11, 7
    s_lshl_b32 s62, s62, 7
    s_add_u32 s60, s48, s11
    s_addc_u32 s61, s49, 0
    s_mul_i32 s74, s7, -128
    s_add_u32 s11, s10, s8
    s_add_u32 s50, s10, s24
    s_min_u32 s11, s11, 50000
    s_min_u32 s50, s50, 50000
    s_sub_u32 s50, s50, s11
    s_lshl_b32 s11, s11, 7
    s_lshl_b32 s50, s50, 7
    s_add_u32 s48, s48, s11
    s_addc_u32 s49, s49, 0
    s_mul_i32 s73, s8, -128
    s_and_b32 s10, s25, 12
    s_lshl_b32 s10, s10, 2
    s_bfm_b64 s[76:77], 16, s10
    s_add_u32 m0, s13, 0
    v_mad_u32_u16 v236, v236, s15, v243
    buffer_load_dwordx4 v236, s[40:43], 0 offen lds
    s_add_u32 m0, s13, 1056
    v_mad_u32_u16 v237, v237, s15, v243
    buffer_load_dwordx4 v237, s[40:43], 0 offen lds
    s_add_u32 m0, s13, 2112
    v_mad_u32_u16 v238, v238, s15, v243
    buffer_load_dwordx4 v238, s[40:43], 0 offen lds
    s_add_u32 m0, s13, 3168
    v_mad_u32_u16 v239, v239, s15, v243
    buffer_load_dwordx4 v239, s[40:43], 0 offen lds
    s_mov_b32 m0, s14
    s_nop 0
    buffer_load_dwordx4 v[240:241], s[44:47], 0 idxen offen lds
L_HAD0:
    s_cmp_eq_u32 s30, 0
    s_cbranch_scc1 L_GO
    s_lshl_b32 s10, s4, 3
    v_mov_b32 v188, s10
    ds_read_b64 v[188:189], v188 offset:576
    s_waitcnt lgkmcnt(0)
    v_readfirstlane_b32 s34, v188
    v_readfirstlane_b32 s35, v189
    s_sub_u32 s10, s12, 37888
    s_sub_u32 s34, s34, s10
    s_sub_u32 s35, s35, s10
    s_sub_u32 s35, s35, 1152
    s_add_u32 s10, s34, 127
    s_lshr_b32 s10, s10, 7
    s_lshl1_add_u32 s10, s10, -1
    s_add_u32 s11, s35, 127
    s_lshr_b32 s11, s11, 6
    s_and_b32 s11, s11, -2
    s_max_i32 s17, s10, s11
    s_cselect_b32 s10, s34, s35
    s_sub_u32 s10, s10, 1
    s_andn2_b32 s99, 64, s10
L_GO:
    ds_read_u16 v252, v250 offset:0
    ds_read_u16 v253, v250 offset:64
    ds_read_b128 v[236:239], v248 offset:1152
    ds_read_b32 v240, v249 offset:1152
    s_lshr_b32 s10, s4, 1
    s_lshl_b32 s10, s10, 9
    s_add_u32 s10, s10, 155776
    v_lshl_add_u32 v246, v247, 3, s10
    s_bitcmp1_b32 s4, 0
    s_cselect_b32 s101, -1, 1
    s_mul_i32 s10, s101, 0xff000000
    s_or_b32 s10, s10, 0xdddd
    v_mov_b32 v255, s10
    s_max_i32 s10, s17, 1
    s_sub_u32 s10, s10, 1
    s_mul_i32 s10, s101, s10
    s_lshl_b32 s10, s10, 24
    v_mov_b32 v188, s10
    ds_add_u32 v246, v188
    s_movk_i32 s94, 128
    s_movk_i32 s95, 128
    v_mov_b32 v247, 0
    s_mov_b32 exec_hi, 0
    v_add_u32 v247, 0x200, v245
    s_mov_b32 exec_hi, -1
    s_waitcnt lgkmcnt(0)
    v_bfi_b32 v252, 31, v245, v252
    v_bfi_b32 v253, 31, v245, v253
    v_max_u32 v252, v252, v245
    v_max_u32 v253, v253, v247
    s_waitcnt vmcnt(0)
    ds_read_b128 v[176:179], v252
    ds_read_b128 v[180:183], v253
    ds_read_b128 v[160:163], v244 offset:0
    ds_read_b128 v[168:171], v244 offset:512
    ds_read_b128 v[164:167], v244 offset:64
    ds_read_b128 v[172:175], v244 offset:576
    s_cmp_lt_i32 s17, 1
    s_cbranch_scc1 L_DONE
    s_waitcnt lgkmcnt(4)
    v_mfma_f32_16x16x32_bf16 v[188:191], v[176:179], v[64:67], 0
    v_mfma_f32_16x16x32_bf16 v[196:199], v[176:179], v[68:71], 0
    v_mfma_f32_16x16x32_bf16 v[192:195], v[180:183], v[64:67], 0
    v_mfma_f32_16x16x32_bf16 v[200:203], v[180:183], v[68:71], 0
    s_waitcnt lgkmcnt(0)
    v_mfma_f32_16x16x32_bf16 v[188:191], v[160:163], v[0:3], v[188:191]
    v_mfma_f32_16x16x32_bf16 v[196:199], v[160:163], v[8:11], v[196:199]
    v_mfma_f32_16x16x32_bf16 v[192:195], v[168:171], v[0:3], v[192:195]
    v_mfma_f32_16x16x32_bf16 v[200:203], v[168:171], v[8:11], v[200:203]
    v_mfma_f32_16x16x32_bf16 v[188:191], v[164:167], v[4:7], v[188:191]
    v_mfma_f32_16x16x32_bf16 v[196:199], v[164:167], v[12:15], v[196:199]
    v_mfma_f32_16x16x32_bf16 v[192:195], v[172:175], v[4:7], v[192:195]
    v_mfma_f32_16x16x32_bf16 v[200:203], v[172:175], v[12:15], v[200:203]
    s_mov_b32 s16, 1
    s_cmp_eq_u32 s17, 1
    s_cbranch_scc1 L_LT0
    s_add_u32 m0, s13, 0
    v_mad_u32_u16 v236, v236, s15, v243
    buffer_load_dwordx4 v236, s[40:43], 0 offen lds
    s_add_u32 m0, s13, 1056
    v_mad_u32_u16 v237, v237, s15, v243
    buffer_load_dwordx4 v237, s[40:43], 0 offen lds
    s_add_u32 m0, s13, 2112
    v_mad_u32_u16 v238, v238, s15, v243
    buffer_load_dwordx4 v238, s[40:43], 0 offen lds
    s_add_u32 m0, s13, 3168
    v_mad_u32_u16 v239, v239, s15, v243
    buffer_load_dwordx4 v239, s[40:43], 0 offen lds
    s_mov_b32 m0, s14
    s_nop 0
    buffer_load_dwordx4 v[240:241], s[44:47], 0 idxen offen lds
.p2align 6
L_LOOP1:
    s_setprio 1
    v_smfmac_f32_16x16x64_bf16 v[152:155], v[184:187], v[204:211], v255
    ds_read_u16 v236, v251 offset:0
    ds_read_u16 v237, v251 offset:16
    ds_add_rtn_u32 v238, v246, v255
    v_exp_f32 v188, v188
    v_smfmac_f32_16x16x64_bf16 v[156:159], v[184:187], v[212:219], v255
    v_exp_f32 v189, v189
    v_mfma_f32_16x16x32_bf16 v[204:207], v[160:163], v[32:35], 0
    v_exp_f32 v190, v190
    v_mfma_f32_16x16x32_bf16 v[212:215], v[160:163], v[40:43], 0
    v_exp_f32 v191, v191
    v_mfma_f32_16x16x32_bf16 v[208:211], v[168:171], v[32:35], 0
    v_exp_f32 v192, v192
    v_mfma_f32_16x16x32_bf16 v[216:219], v[168:171], v[40:43], 0
    v_exp_f32 v193, v193
    v_mfma_f32_16x16x32_bf16 v[204:207], v[164:167], v[36:39], v[204:207]
    v_exp_f32 v194, v194
    v_mfma_f32_16x16x32_bf16 v[212:215], v[164:167], v[44:47], v[212:215]
    v_exp_f32 v195, v195
    v_mfma_f32_16x16x32_bf16 v[208:211], v[172:175], v[36:39], v[208:211]
    s_waitcnt lgkmcnt(0)
    v_bfi_b32 v236, 31, v246, v236
    v_bfi_b32 v237, 31, v246, v237
    v_readfirstlane_b32 s96, v238
    v_exp_f32 v196, v196
    v_mfma_f32_16x16x32_bf16 v[216:219], v[172:175], v[44:47], v[216:219]
    v_exp_f32 v197, v197
    v_smfmac_f32_16x16x64_bf16 v[136:139], v[184:187], v[220:227], v255
    v_exp_f32 v198, v198
    v_smfmac_f32_16x16x64_bf16 v[140:143], v[184:187], v[228:235], v255
    v_exp_f32 v199, v199
    v_mfma_f32_4x4x4_16b_bf16 v[188:191], v[242:243], v[242:243], v[188:191]
    v_exp_f32 v200, v200
    v_mfma_f32_4x4x4_16b_bf16 v[192:195], v[242:243], v[242:243], v[192:195]
    v_exp_f32 v201, v201
    v_mfma_f32_4x4x4_16b_bf16 v[196:199], v[242:243], v[242:243], v[196:199]
    v_exp_f32 v202, v202
    v_mfma_f32_16x16x32_bf16 v[220:223], v[176:179], v[72:75], 0
    ds_read_b64_tr_b16 v[184:185], v236
    ds_read_b64_tr_b16 v[186:187], v237
    ds_read_u16 v252, v250 offset:1152
    ds_read_u16 v253, v250 offset:1216
    v_exp_f32 v203, v203
    v_mfma_f32_16x16x32_bf16 v[228:231], v[176:179], v[76:79], 0
    s_ashr_i32 s96, s96, 24
    s_mul_i32 s96, s96, s101
    v_rcp_f32 v188, v188
    v_mfma_f32_16x16x32_bf16 v[224:227], v[180:183], v[72:75], 0
    v_rcp_f32 v189, v189
    v_mfma_f32_4x4x4_16b_bf16 v[200:203], v[242:243], v[242:243], v[200:203]
    v_rcp_f32 v190, v190
    v_mfma_f32_16x16x32_bf16 v[232:235], v[180:183], v[76:79], 0
    v_rcp_f32 v191, v191
    v_mfma_f32_16x16x32_bf16 v[220:223], v[160:163], v[16:19], v[220:223]
    v_rcp_f32 v192, v192
    v_mfma_f32_16x16x32_bf16 v[228:231], v[160:163], v[24:27], v[228:231]
    v_rcp_f32 v193, v193
    v_mfma_f32_16x16x32_bf16 v[224:227], v[168:171], v[16:19], v[224:227]
    s_waitcnt lgkmcnt(0)
    v_bfi_b32 v252, 31, v245, v252
    v_bfi_b32 v253, 31, v245, v253
    v_max_u32 v252, v252, v245
    v_max_u32 v253, v253, v247
    ds_read_b128 v[236:239], v248 offset:128
    ds_read_b32 v240, v249 offset:128
    s_add_u32 s16, s16, 1
    v_rcp_f32 v194, v194
    v_mfma_f32_16x16x32_bf16 v[232:235], v[168:171], v[24:27], v[232:235]
    v_rcp_f32 v195, v195
    v_mfma_f32_16x16x32_bf16 v[220:223], v[164:167], v[20:23], v[220:223]
    v_rcp_f32 v196, v196
    v_mfma_f32_16x16x32_bf16 v[228:231], v[164:167], v[28:31], v[228:231]
    v_rcp_f32 v197, v197
    s_setprio 3
    v_mfma_f32_16x16x32_bf16 v[224:227], v[172:175], v[20:23], v[224:227]
    v_rcp_f32 v198, v198
    v_mfma_f32_16x16x32_bf16 v[232:235], v[172:175], v[28:31], v[232:235]
    v_rcp_f32 v199, v199
    v_rcp_f32 v200, v200
    v_rcp_f32 v201, v201
    v_rcp_f32 v202, v202
    v_rcp_f32 v203, v203
    v_pk_mul_f32 v[204:205], v[188:189], v[204:205]
    v_pk_mul_f32 v[206:207], v[190:191], v[206:207]
    v_pk_mul_f32 v[208:209], v[192:193], v[208:209]
    v_pk_mul_f32 v[210:211], v[194:195], v[210:211]
    v_pk_mul_f32 v[212:213], v[196:197], v[212:213]
    v_pk_mul_f32 v[214:215], v[198:199], v[214:215]
    v_pk_mul_f32 v[216:217], v[200:201], v[216:217]
    v_pk_mul_f32 v[218:219], v[202:203], v[218:219]
    s_cmp_ge_i32 s96, 1
    s_cbranch_scc0 L_PB00
L_PB01:
    s_setprio 1
    v_smfmac_f32_16x16x64_bf16 v[112:115], v[184:187], v[204:211], v255
    v_exp_f32 v220, v220
    v_smfmac_f32_16x16x64_bf16 v[116:119], v[184:187], v[212:219], v255
    v_exp_f32 v221, v221
    s_waitcnt vmcnt(1)
    v_mfma_f32_16x16x32_bf16 v[204:207], v[160:163], v[48:51], 0
    v_exp_f32 v222, v222
    v_mfma_f32_16x16x32_bf16 v[212:215], v[160:163], v[56:59], 0
    ds_read_b128 v[160:163], v244 offset:0
    v_exp_f32 v223, v223
    v_mfma_f32_16x16x32_bf16 v[208:211], v[168:171], v[48:51], 0
    v_exp_f32 v224, v224
    v_mfma_f32_16x16x32_bf16 v[216:219], v[168:171], v[56:59], 0
    ds_read_b128 v[168:171], v244 offset:512
    v_exp_f32 v225, v225
    v_mfma_f32_16x16x32_bf16 v[204:207], v[164:167], v[52:55], v[204:207]
    v_exp_f32 v226, v226
    v_mfma_f32_16x16x32_bf16 v[212:215], v[164:167], v[60:63], v[212:215]
    ds_read_b128 v[164:167], v244 offset:64
    v_exp_f32 v227, v227
    v_mfma_f32_16x16x32_bf16 v[208:211], v[172:175], v[52:55], v[208:211]
    v_exp_f32 v228, v228
    v_mfma_f32_16x16x32_bf16 v[216:219], v[172:175], v[60:63], v[216:219]
    ds_read_b128 v[172:175], v244 offset:576
    v_exp_f32 v229, v229
    v_smfmac_f32_16x16x64_bf16 v[96:99], v[184:187], v[188:195], v255
    v_exp_f32 v230, v230
    v_smfmac_f32_16x16x64_bf16 v[100:103], v[184:187], v[196:203], v255
    v_exp_f32 v231, v231
    v_mfma_f32_4x4x4_16b_bf16 v[220:223], v[242:243], v[242:243], v[220:223]
    v_exp_f32 v232, v232
    v_mfma_f32_4x4x4_16b_bf16 v[224:227], v[242:243], v[242:243], v[224:227]
    v_exp_f32 v233, v233
    v_mfma_f32_4x4x4_16b_bf16 v[228:231], v[242:243], v[242:243], v[228:231]
    v_exp_f32 v234, v234
    s_waitcnt lgkmcnt(2)
    v_mfma_f32_16x16x32_bf16 v[188:191], v[160:163], v[0:3], 0
    v_exp_f32 v235, v235
    v_mfma_f32_16x16x32_bf16 v[196:199], v[160:163], v[8:11], 0
    s_waitcnt vmcnt(0)
    ds_read_b128 v[176:179], v252
    ds_read_b128 v[180:183], v253
    v_rcp_f32 v220, v220
    v_mfma_f32_16x16x32_bf16 v[192:195], v[168:171], v[0:3], 0
    v_rcp_f32 v221, v221
    v_mfma_f32_4x4x4_16b_bf16 v[232:235], v[242:243], v[242:243], v[232:235]
    v_rcp_f32 v222, v222
    v_mfma_f32_16x16x32_bf16 v[200:203], v[168:171], v[8:11], 0
    v_rcp_f32 v223, v223
    s_waitcnt lgkmcnt(2)
    v_mfma_f32_16x16x32_bf16 v[188:191], v[164:167], v[4:7], v[188:191]
    v_rcp_f32 v224, v224
    v_mfma_f32_16x16x32_bf16 v[196:199], v[164:167], v[12:15], v[196:199]
    v_rcp_f32 v225, v225
    v_mfma_f32_16x16x32_bf16 v[192:195], v[172:175], v[4:7], v[192:195]
    v_rcp_f32 v226, v226
    v_mfma_f32_16x16x32_bf16 v[200:203], v[172:175], v[12:15], v[200:203]
    v_rcp_f32 v227, v227
    s_waitcnt lgkmcnt(0)
    v_mfma_f32_16x16x32_bf16 v[188:191], v[176:179], v[80:83], v[188:191]
    v_rcp_f32 v228, v228
    v_mfma_f32_16x16x32_bf16 v[196:199], v[176:179], v[84:87], v[196:199]
    s_cmp_lt_u32 s16, s17
    s_cbranch_scc0 L_ND01
    s_add_u32 m0, s13, 0
    v_mad_u32_u16 v236, v236, s15, v243
    buffer_load_dwordx4 v236, s[40:43], 0 offen lds
    s_add_u32 m0, s13, 1056
    v_mad_u32_u16 v237, v237, s15, v243
    buffer_load_dwordx4 v237, s[40:43], 0 offen lds
    s_add_u32 m0, s13, 2112
    v_mad_u32_u16 v238, v238, s15, v243
    buffer_load_dwordx4 v238, s[40:43], 0 offen lds
    s_add_u32 m0, s13, 3168
    v_mad_u32_u16 v239, v239, s15, v243
    buffer_load_dwordx4 v239, s[40:43], 0 offen lds
    s_mov_b32 m0, s14
    s_nop 0
    buffer_load_dwordx4 v[240:241], s[44:47], 0 idxen offen lds
L_ND01:
    v_rcp_f32 v229, v229
    s_setprio 3
    v_mfma_f32_16x16x32_bf16 v[192:195], v[180:183], v[80:83], v[192:195]
    v_rcp_f32 v230, v230
    v_mfma_f32_16x16x32_bf16 v[200:203], v[180:183], v[84:87], v[200:203]
    v_rcp_f32 v231, v231
    v_rcp_f32 v232, v232
    v_rcp_f32 v233, v233
    v_rcp_f32 v234, v234
    v_rcp_f32 v235, v235
    v_pk_mul_f32 v[204:205], v[220:221], v[204:205]
    v_pk_mul_f32 v[206:207], v[222:223], v[206:207]
    v_pk_mul_f32 v[208:209], v[224:225], v[208:209]
    v_pk_mul_f32 v[210:211], v[226:227], v[210:211]
    v_pk_mul_f32 v[212:213], v[228:229], v[212:213]
    v_pk_mul_f32 v[214:215], v[230:231], v[214:215]
    v_pk_mul_f32 v[216:217], v[232:233], v[216:217]
    v_pk_mul_f32 v[218:219], v[234:235], v[218:219]
    s_cmp_ge_u32 s16, s17
    s_cbranch_scc1 L_LT1
    s_setprio 1
    v_smfmac_f32_16x16x64_bf16 v[120:123], v[184:187], v[204:211], v255
    ds_read_u16 v236, v251 offset:1152
    ds_read_u16 v237, v251 offset:1168
    ds_add_rtn_u32 v238, v246, v255
    v_exp_f32 v188, v188
    v_smfmac_f32_16x16x64_bf16 v[124:127], v[184:187], v[212:219], v255
    v_exp_f32 v189, v189
    v_mfma_f32_16x16x32_bf16 v[204:207], v[160:163], v[32:35], 0
    v_exp_f32 v190, v190
    v_mfma_f32_16x16x32_bf16 v[212:215], v[160:163], v[40:43], 0
    v_exp_f32 v191, v191
    v_mfma_f32_16x16x32_bf16 v[208:211], v[168:171], v[32:35], 0
    v_exp_f32 v192, v192
    v_mfma_f32_16x16x32_bf16 v[216:219], v[168:171], v[40:43], 0
    v_exp_f32 v193, v193
    v_mfma_f32_16x16x32_bf16 v[204:207], v[164:167], v[36:39], v[204:207]
    v_exp_f32 v194, v194
    v_mfma_f32_16x16x32_bf16 v[212:215], v[164:167], v[44:47], v[212:215]
    v_exp_f32 v195, v195
    v_mfma_f32_16x16x32_bf16 v[208:211], v[172:175], v[36:39], v[208:211]
    s_waitcnt lgkmcnt(0)
    v_bfi_b32 v236, 31, v246, v236
    v_bfi_b32 v237, 31, v246, v237
    v_readfirstlane_b32 s96, v238
    v_exp_f32 v196, v196
    v_mfma_f32_16x16x32_bf16 v[216:219], v[172:175], v[44:47], v[216:219]
    v_exp_f32 v197, v197
    v_smfmac_f32_16x16x64_bf16 v[104:107], v[184:187], v[220:227], v255
    v_exp_f32 v198, v198
    v_smfmac_f32_16x16x64_bf16 v[108:111], v[184:187], v[228:235], v255
    v_exp_f32 v199, v199
    v_mfma_f32_4x4x4_16b_bf16 v[188:191], v[242:243], v[242:243], v[188:191]
    v_exp_f32 v200, v200
    v_mfma_f32_4x4x4_16b_bf16 v[192:195], v[242:243], v[242:243], v[192:195]
    v_exp_f32 v201, v201
    v_mfma_f32_4x4x4_16b_bf16 v[196:199], v[242:243], v[242:243], v[196:199]
    v_exp_f32 v202, v202
    v_mfma_f32_16x16x32_bf16 v[220:223], v[176:179], v[88:91], 0
    ds_read_b64_tr_b16 v[184:185], v236
    ds_read_b64_tr_b16 v[186:187], v237
    ds_read_u16 v252, v250 offset:128
    ds_read_u16 v253, v250 offset:192
    v_exp_f32 v203, v203
    v_mfma_f32_16x16x32_bf16 v[228:231], v[176:179], v[92:95], 0
    s_ashr_i32 s96, s96, 24
    s_mul_i32 s96, s96, s101
    v_rcp_f32 v188, v188
    v_mfma_f32_16x16x32_bf16 v[224:227], v[180:183], v[88:91], 0
    v_rcp_f32 v189, v189
    v_mfma_f32_4x4x4_16b_bf16 v[200:203], v[242:243], v[242:243], v[200:203]
    v_rcp_f32 v190, v190
    v_mfma_f32_16x16x32_bf16 v[232:235], v[180:183], v[92:95], 0
    v_rcp_f32 v191, v191
    v_mfma_f32_16x16x32_bf16 v[220:223], v[160:163], v[16:19], v[220:223]
    v_rcp_f32 v192, v192
    v_mfma_f32_16x16x32_bf16 v[228:231], v[160:163], v[24:27], v[228:231]
    v_rcp_f32 v193, v193
    v_mfma_f32_16x16x32_bf16 v[224:227], v[168:171], v[16:19], v[224:227]
    s_waitcnt lgkmcnt(0)
    v_bfi_b32 v252, 31, v245, v252
    v_bfi_b32 v253, 31, v245, v253
    v_max_u32 v252, v252, v245
    v_max_u32 v253, v253, v247
    ds_read_b128 v[236:239], v248 offset:1280
    ds_read_b32 v240, v249 offset:1280
    s_add_u32 s16, s16, 1
    v_rcp_f32 v194, v194
    v_mfma_f32_16x16x32_bf16 v[232:235], v[168:171], v[24:27], v[232:235]
    v_lshl_add_u64 v[248:249], v[248:249], 0, s[94:95]
    v_lshl_add_u64 v[250:251], v[250:251], 0, s[94:95]
    v_rcp_f32 v195, v195
    v_mfma_f32_16x16x32_bf16 v[220:223], v[164:167], v[20:23], v[220:223]
    v_rcp_f32 v196, v196
    v_mfma_f32_16x16x32_bf16 v[228:231], v[164:167], v[28:31], v[228:231]
    v_rcp_f32 v197, v197
    s_setprio 3
    v_mfma_f32_16x16x32_bf16 v[224:227], v[172:175], v[20:23], v[224:227]
    v_rcp_f32 v198, v198
    v_mfma_f32_16x16x32_bf16 v[232:235], v[172:175], v[28:31], v[232:235]
    v_rcp_f32 v199, v199
    v_rcp_f32 v200, v200
    v_rcp_f32 v201, v201
    v_rcp_f32 v202, v202
    v_rcp_f32 v203, v203
    v_pk_mul_f32 v[204:205], v[188:189], v[204:205]
    v_pk_mul_f32 v[206:207], v[190:191], v[206:207]
    v_pk_mul_f32 v[208:209], v[192:193], v[208:209]
    v_pk_mul_f32 v[210:211], v[194:195], v[210:211]
    v_pk_mul_f32 v[212:213], v[196:197], v[212:213]
    v_pk_mul_f32 v[214:215], v[198:199], v[214:215]
    v_pk_mul_f32 v[216:217], v[200:201], v[216:217]
    v_pk_mul_f32 v[218:219], v[202:203], v[218:219]
    s_cmp_ge_i32 s96, 1
    s_cbranch_scc0 L_PB10
L_PB11:
    s_setprio 1
    v_smfmac_f32_16x16x64_bf16 v[144:147], v[184:187], v[204:211], v255
    v_exp_f32 v220, v220
    v_smfmac_f32_16x16x64_bf16 v[148:151], v[184:187], v[212:219], v255
    v_exp_f32 v221, v221
    s_waitcnt vmcnt(1)
    v_mfma_f32_16x16x32_bf16 v[204:207], v[160:163], v[48:51], 0
    v_exp_f32 v222, v222
    v_mfma_f32_16x16x32_bf16 v[212:215], v[160:163], v[56:59], 0
    ds_read_b128 v[160:163], v244 offset:0
    v_exp_f32 v223, v223
    v_mfma_f32_16x16x32_bf16 v[208:211], v[168:171], v[48:51], 0
    v_exp_f32 v224, v224
    v_mfma_f32_16x16x32_bf16 v[216:219], v[168:171], v[56:59], 0
    ds_read_b128 v[168:171], v244 offset:512
    v_exp_f32 v225, v225
    v_mfma_f32_16x16x32_bf16 v[204:207], v[164:167], v[52:55], v[204:207]
    v_exp_f32 v226, v226
    v_mfma_f32_16x16x32_bf16 v[212:215], v[164:167], v[60:63], v[212:215]
    ds_read_b128 v[164:167], v244 offset:64
    v_exp_f32 v227, v227
    v_mfma_f32_16x16x32_bf16 v[208:211], v[172:175], v[52:55], v[208:211]
    v_exp_f32 v228, v228
    v_mfma_f32_16x16x32_bf16 v[216:219], v[172:175], v[60:63], v[216:219]
    ds_read_b128 v[172:175], v244 offset:576
    v_exp_f32 v229, v229
    v_smfmac_f32_16x16x64_bf16 v[128:131], v[184:187], v[188:195], v255
    v_exp_f32 v230, v230
    v_smfmac_f32_16x16x64_bf16 v[132:135], v[184:187], v[196:203], v255
    v_exp_f32 v231, v231
    v_mfma_f32_4x4x4_16b_bf16 v[220:223], v[242:243], v[242:243], v[220:223]
    v_exp_f32 v232, v232
    v_mfma_f32_4x4x4_16b_bf16 v[224:227], v[242:243], v[242:243], v[224:227]
    v_exp_f32 v233, v233
    v_mfma_f32_4x4x4_16b_bf16 v[228:231], v[242:243], v[242:243], v[228:231]
    v_exp_f32 v234, v234
    s_waitcnt lgkmcnt(2)
    v_mfma_f32_16x16x32_bf16 v[188:191], v[160:163], v[0:3], 0
    v_exp_f32 v235, v235
    v_mfma_f32_16x16x32_bf16 v[196:199], v[160:163], v[8:11], 0
    s_waitcnt vmcnt(0)
    ds_read_b128 v[176:179], v252
    ds_read_b128 v[180:183], v253
    v_rcp_f32 v220, v220
    v_mfma_f32_16x16x32_bf16 v[192:195], v[168:171], v[0:3], 0
    v_rcp_f32 v221, v221
    v_mfma_f32_4x4x4_16b_bf16 v[232:235], v[242:243], v[242:243], v[232:235]
    v_rcp_f32 v222, v222
    v_mfma_f32_16x16x32_bf16 v[200:203], v[168:171], v[8:11], 0
    v_rcp_f32 v223, v223
    s_waitcnt lgkmcnt(2)
    v_mfma_f32_16x16x32_bf16 v[188:191], v[164:167], v[4:7], v[188:191]
    v_rcp_f32 v224, v224
    v_mfma_f32_16x16x32_bf16 v[196:199], v[164:167], v[12:15], v[196:199]
    v_rcp_f32 v225, v225
    v_mfma_f32_16x16x32_bf16 v[192:195], v[172:175], v[4:7], v[192:195]
    v_rcp_f32 v226, v226
    v_mfma_f32_16x16x32_bf16 v[200:203], v[172:175], v[12:15], v[200:203]
    v_rcp_f32 v227, v227
    s_waitcnt lgkmcnt(0)
    v_mfma_f32_16x16x32_bf16 v[188:191], v[176:179], v[64:67], v[188:191]
    v_rcp_f32 v228, v228
    v_mfma_f32_16x16x32_bf16 v[196:199], v[176:179], v[68:71], v[196:199]
    s_cmp_lt_u32 s16, s17
    s_cbranch_scc0 L_ND11
    s_add_u32 m0, s13, 0
    v_mad_u32_u16 v236, v236, s15, v243
    buffer_load_dwordx4 v236, s[40:43], 0 offen lds
    s_add_u32 m0, s13, 1056
    v_mad_u32_u16 v237, v237, s15, v243
    buffer_load_dwordx4 v237, s[40:43], 0 offen lds
    s_add_u32 m0, s13, 2112
    v_mad_u32_u16 v238, v238, s15, v243
    buffer_load_dwordx4 v238, s[40:43], 0 offen lds
    s_add_u32 m0, s13, 3168
    v_mad_u32_u16 v239, v239, s15, v243
    buffer_load_dwordx4 v239, s[40:43], 0 offen lds
    s_mov_b32 m0, s14
    s_nop 0
    buffer_load_dwordx4 v[240:241], s[44:47], 0 idxen offen lds
L_ND11:
    v_rcp_f32 v229, v229
    s_setprio 3
    v_mfma_f32_16x16x32_bf16 v[192:195], v[180:183], v[64:67], v[192:195]
    v_rcp_f32 v230, v230
    v_mfma_f32_16x16x32_bf16 v[200:203], v[180:183], v[68:71], v[200:203]
    v_rcp_f32 v231, v231
    v_rcp_f32 v232, v232
    v_rcp_f32 v233, v233
    v_rcp_f32 v234, v234
    v_rcp_f32 v235, v235
    v_pk_mul_f32 v[204:205], v[220:221], v[204:205]
    v_pk_mul_f32 v[206:207], v[222:223], v[206:207]
    v_pk_mul_f32 v[208:209], v[224:225], v[208:209]
    v_pk_mul_f32 v[210:211], v[226:227], v[210:211]
    v_pk_mul_f32 v[212:213], v[228:229], v[212:213]
    v_pk_mul_f32 v[214:215], v[230:231], v[214:215]
    v_pk_mul_f32 v[216:217], v[232:233], v[216:217]
    v_pk_mul_f32 v[218:219], v[234:235], v[218:219]
    s_cmp_lt_u32 s16, s17
    s_cbranch_scc1 L_LOOP1
    s_branch L_LT0
.p2align 6
L_LOOP0:
    s_setprio 0
    v_smfmac_f32_16x16x64_bf16 v[152:155], v[184:187], v[204:211], v255
    ds_read_u16 v236, v251 offset:0
    ds_read_u16 v237, v251 offset:16
    ds_add_rtn_u32 v238, v246, v255
    v_exp_f32 v188, v188
    v_smfmac_f32_16x16x64_bf16 v[156:159], v[184:187], v[212:219], v255
    v_exp_f32 v189, v189
    v_mfma_f32_16x16x32_bf16 v[204:207], v[160:163], v[32:35], 0
    v_exp_f32 v190, v190
    v_mfma_f32_16x16x32_bf16 v[212:215], v[160:163], v[40:43], 0
    v_exp_f32 v191, v191
    v_mfma_f32_16x16x32_bf16 v[208:211], v[168:171], v[32:35], 0
    v_exp_f32 v192, v192
    v_mfma_f32_16x16x32_bf16 v[216:219], v[168:171], v[40:43], 0
    v_exp_f32 v193, v193
    v_mfma_f32_16x16x32_bf16 v[204:207], v[164:167], v[36:39], v[204:207]
    v_exp_f32 v194, v194
    v_mfma_f32_16x16x32_bf16 v[212:215], v[164:167], v[44:47], v[212:215]
    v_exp_f32 v195, v195
    v_mfma_f32_16x16x32_bf16 v[208:211], v[172:175], v[36:39], v[208:211]
    s_waitcnt lgkmcnt(0)
    v_bfi_b32 v236, 31, v246, v236
    v_bfi_b32 v237, 31, v246, v237
    v_readfirstlane_b32 s96, v238
    v_exp_f32 v196, v196
    v_mfma_f32_16x16x32_bf16 v[216:219], v[172:175], v[44:47], v[216:219]
    v_exp_f32 v197, v197
    v_smfmac_f32_16x16x64_bf16 v[136:139], v[184:187], v[220:227], v255
    v_exp_f32 v198, v198
    v_smfmac_f32_16x16x64_bf16 v[140:143], v[184:187], v[228:235], v255
    v_exp_f32 v199, v199
    v_mfma_f32_4x4x4_16b_bf16 v[188:191], v[242:243], v[242:243], v[188:191]
    v_exp_f32 v200, v200
    v_mfma_f32_4x4x4_16b_bf16 v[192:195], v[242:243], v[242:243], v[192:195]
    v_exp_f32 v201, v201
    v_mfma_f32_4x4x4_16b_bf16 v[196:199], v[242:243], v[242:243], v[196:199]
    v_exp_f32 v202, v202
    v_mfma_f32_16x16x32_bf16 v[220:223], v[176:179], v[72:75], 0
    ds_read_b64_tr_b16 v[184:185], v236
    ds_read_b64_tr_b16 v[186:187], v237
    ds_read_u16 v252, v250 offset:1152
    ds_read_u16 v253, v250 offset:1216
    v_exp_f32 v203, v203
    v_mfma_f32_16x16x32_bf16 v[228:231], v[176:179], v[76:79], 0
    s_ashr_i32 s96, s96, 24
    s_mul_i32 s96, s96, s101
    v_rcp_f32 v188, v188
    v_mfma_f32_16x16x32_bf16 v[224:227], v[180:183], v[72:75], 0
    v_rcp_f32 v189, v189
    v_mfma_f32_4x4x4_16b_bf16 v[200:203], v[242:243], v[242:243], v[200:203]
    v_rcp_f32 v190, v190
    v_mfma_f32_16x16x32_bf16 v[232:235], v[180:183], v[76:79], 0
    v_rcp_f32 v191, v191
    v_mfma_f32_16x16x32_bf16 v[220:223], v[160:163], v[16:19], v[220:223]
    v_rcp_f32 v192, v192
    v_mfma_f32_16x16x32_bf16 v[228:231], v[160:163], v[24:27], v[228:231]
    v_rcp_f32 v193, v193
    v_mfma_f32_16x16x32_bf16 v[224:227], v[168:171], v[16:19], v[224:227]
    s_waitcnt lgkmcnt(0)
    v_bfi_b32 v252, 31, v245, v252
    v_bfi_b32 v253, 31, v245, v253
    v_max_u32 v252, v252, v245
    v_max_u32 v253, v253, v247
    ds_read_b128 v[236:239], v248 offset:128
    ds_read_b32 v240, v249 offset:128
    s_add_u32 s16, s16, 1
    v_rcp_f32 v194, v194
    v_mfma_f32_16x16x32_bf16 v[232:235], v[168:171], v[24:27], v[232:235]
    v_rcp_f32 v195, v195
    v_mfma_f32_16x16x32_bf16 v[220:223], v[164:167], v[20:23], v[220:223]
    v_rcp_f32 v196, v196
    v_mfma_f32_16x16x32_bf16 v[228:231], v[164:167], v[28:31], v[228:231]
    v_rcp_f32 v197, v197
    s_setprio 3
    v_mfma_f32_16x16x32_bf16 v[224:227], v[172:175], v[20:23], v[224:227]
    v_rcp_f32 v198, v198
    v_mfma_f32_16x16x32_bf16 v[232:235], v[172:175], v[28:31], v[232:235]
    v_rcp_f32 v199, v199
    v_rcp_f32 v200, v200
    v_rcp_f32 v201, v201
    v_rcp_f32 v202, v202
    v_rcp_f32 v203, v203
    v_pk_mul_f32 v[204:205], v[188:189], v[204:205]
    v_pk_mul_f32 v[206:207], v[190:191], v[206:207]
    v_pk_mul_f32 v[208:209], v[192:193], v[208:209]
    v_pk_mul_f32 v[210:211], v[194:195], v[210:211]
    v_pk_mul_f32 v[212:213], v[196:197], v[212:213]
    v_pk_mul_f32 v[214:215], v[198:199], v[214:215]
    v_pk_mul_f32 v[216:217], v[200:201], v[216:217]
    v_pk_mul_f32 v[218:219], v[202:203], v[218:219]
    s_cmp_ge_i32 s96, 1
    s_cbranch_scc1 L_PB01
L_PB00:
    s_setprio 0
    v_smfmac_f32_16x16x64_bf16 v[112:115], v[184:187], v[204:211], v255
    v_exp_f32 v220, v220
    v_smfmac_f32_16x16x64_bf16 v[116:119], v[184:187], v[212:219], v255
    v_exp_f32 v221, v221
    s_waitcnt vmcnt(1)
    v_mfma_f32_16x16x32_bf16 v[204:207], v[160:163], v[48:51], 0
    v_exp_f32 v222, v222
    v_mfma_f32_16x16x32_bf16 v[212:215], v[160:163], v[56:59], 0
    ds_read_b128 v[160:163], v244 offset:0
    v_exp_f32 v223, v223
    v_mfma_f32_16x16x32_bf16 v[208:211], v[168:171], v[48:51], 0
    v_exp_f32 v224, v224
    v_mfma_f32_16x16x32_bf16 v[216:219], v[168:171], v[56:59], 0
    ds_read_b128 v[168:171], v244 offset:512
    v_exp_f32 v225, v225
    v_mfma_f32_16x16x32_bf16 v[204:207], v[164:167], v[52:55], v[204:207]
    v_exp_f32 v226, v226
    v_mfma_f32_16x16x32_bf16 v[212:215], v[164:167], v[60:63], v[212:215]
    ds_read_b128 v[164:167], v244 offset:64
    v_exp_f32 v227, v227
    v_mfma_f32_16x16x32_bf16 v[208:211], v[172:175], v[52:55], v[208:211]
    v_exp_f32 v228, v228
    v_mfma_f32_16x16x32_bf16 v[216:219], v[172:175], v[60:63], v[216:219]
    ds_read_b128 v[172:175], v244 offset:576
    v_exp_f32 v229, v229
    v_smfmac_f32_16x16x64_bf16 v[96:99], v[184:187], v[188:195], v255
    v_exp_f32 v230, v230
    v_smfmac_f32_16x16x64_bf16 v[100:103], v[184:187], v[196:203], v255
    v_exp_f32 v231, v231
    v_mfma_f32_4x4x4_16b_bf16 v[220:223], v[242:243], v[242:243], v[220:223]
    v_exp_f32 v232, v232
    v_mfma_f32_4x4x4_16b_bf16 v[224:227], v[242:243], v[242:243], v[224:227]
    v_exp_f32 v233, v233
    v_mfma_f32_4x4x4_16b_bf16 v[228:231], v[242:243], v[242:243], v[228:231]
    v_exp_f32 v234, v234
    s_waitcnt lgkmcnt(2)
    v_mfma_f32_16x16x32_bf16 v[188:191], v[160:163], v[0:3], 0
    v_exp_f32 v235, v235
    v_mfma_f32_16x16x32_bf16 v[196:199], v[160:163], v[8:11], 0
    s_waitcnt vmcnt(0)
    ds_read_b128 v[176:179], v252
    ds_read_b128 v[180:183], v253
    v_rcp_f32 v220, v220
    v_mfma_f32_16x16x32_bf16 v[192:195], v[168:171], v[0:3], 0
    v_rcp_f32 v221, v221
    v_mfma_f32_4x4x4_16b_bf16 v[232:235], v[242:243], v[242:243], v[232:235]
    v_rcp_f32 v222, v222
    v_mfma_f32_16x16x32_bf16 v[200:203], v[168:171], v[8:11], 0
    v_rcp_f32 v223, v223
    s_waitcnt lgkmcnt(2)
    v_mfma_f32_16x16x32_bf16 v[188:191], v[164:167], v[4:7], v[188:191]
    v_rcp_f32 v224, v224
    v_mfma_f32_16x16x32_bf16 v[196:199], v[164:167], v[12:15], v[196:199]
    v_rcp_f32 v225, v225
    v_mfma_f32_16x16x32_bf16 v[192:195], v[172:175], v[4:7], v[192:195]
    v_rcp_f32 v226, v226
    v_mfma_f32_16x16x32_bf16 v[200:203], v[172:175], v[12:15], v[200:203]
    v_rcp_f32 v227, v227
    s_waitcnt lgkmcnt(0)
    v_mfma_f32_16x16x32_bf16 v[188:191], v[176:179], v[80:83], v[188:191]
    v_rcp_f32 v228, v228
    v_mfma_f32_16x16x32_bf16 v[196:199], v[176:179], v[84:87], v[196:199]
    s_cmp_lt_u32 s16, s17
    s_cbranch_scc0 L_ND00
    s_add_u32 m0, s13, 0
    v_mad_u32_u16 v236, v236, s15, v243
    buffer_load_dwordx4 v236, s[40:43], 0 offen lds
    s_add_u32 m0, s13, 1056
    v_mad_u32_u16 v237, v237, s15, v243
    buffer_load_dwordx4 v237, s[40:43], 0 offen lds
    s_add_u32 m0, s13, 2112
    v_mad_u32_u16 v238, v238, s15, v243
    buffer_load_dwordx4 v238, s[40:43], 0 offen lds
    s_add_u32 m0, s13, 3168
    v_mad_u32_u16 v239, v239, s15, v243
    buffer_load_dwordx4 v239, s[40:43], 0 offen lds
    s_mov_b32 m0, s14
    s_nop 0
    buffer_load_dwordx4 v[240:241], s[44:47], 0 idxen offen lds
L_ND00:
    v_rcp_f32 v229, v229
    s_setprio 3
    v_mfma_f32_16x16x32_bf16 v[192:195], v[180:183], v[80:83], v[192:195]
    v_rcp_f32 v230, v230
    v_mfma_f32_16x16x32_bf16 v[200:203], v[180:183], v[84:87], v[200:203]
    v_rcp_f32 v231, v231
    v_rcp_f32 v232, v232
    v_rcp_f32 v233, v233
    v_rcp_f32 v234, v234
    v_rcp_f32 v235, v235
    v_pk_mul_f32 v[204:205], v[220:221], v[204:205]
    v_pk_mul_f32 v[206:207], v[222:223], v[206:207]
    v_pk_mul_f32 v[208:209], v[224:225], v[208:209]
    v_pk_mul_f32 v[210:211], v[226:227], v[210:211]
    v_pk_mul_f32 v[212:213], v[228:229], v[212:213]
    v_pk_mul_f32 v[214:215], v[230:231], v[214:215]
    v_pk_mul_f32 v[216:217], v[232:233], v[216:217]
    v_pk_mul_f32 v[218:219], v[234:235], v[218:219]
    s_cmp_ge_u32 s16, s17
    s_cbranch_scc1 L_LT1
    s_setprio 0
    v_smfmac_f32_16x16x64_bf16 v[120:123], v[184:187], v[204:211], v255
    ds_read_u16 v236, v251 offset:1152
    ds_read_u16 v237, v251 offset:1168
    ds_add_rtn_u32 v238, v246, v255
    v_exp_f32 v188, v188
    v_smfmac_f32_16x16x64_bf16 v[124:127], v[184:187], v[212:219], v255
    v_exp_f32 v189, v189
    v_mfma_f32_16x16x32_bf16 v[204:207], v[160:163], v[32:35], 0
    v_exp_f32 v190, v190
    v_mfma_f32_16x16x32_bf16 v[212:215], v[160:163], v[40:43], 0
    v_exp_f32 v191, v191
    v_mfma_f32_16x16x32_bf16 v[208:211], v[168:171], v[32:35], 0
    v_exp_f32 v192, v192
    v_mfma_f32_16x16x32_bf16 v[216:219], v[168:171], v[40:43], 0
    v_exp_f32 v193, v193
    v_mfma_f32_16x16x32_bf16 v[204:207], v[164:167], v[36:39], v[204:207]
    v_exp_f32 v194, v194
    v_mfma_f32_16x16x32_bf16 v[212:215], v[164:167], v[44:47], v[212:215]
    v_exp_f32 v195, v195
    v_mfma_f32_16x16x32_bf16 v[208:211], v[172:175], v[36:39], v[208:211]
    s_waitcnt lgkmcnt(0)
    v_bfi_b32 v236, 31, v246, v236
    v_bfi_b32 v237, 31, v246, v237
    v_readfirstlane_b32 s96, v238
    v_exp_f32 v196, v196
    v_mfma_f32_16x16x32_bf16 v[216:219], v[172:175], v[44:47], v[216:219]
    v_exp_f32 v197, v197
    v_smfmac_f32_16x16x64_bf16 v[104:107], v[184:187], v[220:227], v255
    v_exp_f32 v198, v198
    v_smfmac_f32_16x16x64_bf16 v[108:111], v[184:187], v[228:235], v255
    v_exp_f32 v199, v199
    v_mfma_f32_4x4x4_16b_bf16 v[188:191], v[242:243], v[242:243], v[188:191]
    v_exp_f32 v200, v200
    v_mfma_f32_4x4x4_16b_bf16 v[192:195], v[242:243], v[242:243], v[192:195]
    v_exp_f32 v201, v201
    v_mfma_f32_4x4x4_16b_bf16 v[196:199], v[242:243], v[242:243], v[196:199]
    v_exp_f32 v202, v202
    v_mfma_f32_16x16x32_bf16 v[220:223], v[176:179], v[88:91], 0
    ds_read_b64_tr_b16 v[184:185], v236
    ds_read_b64_tr_b16 v[186:187], v237
    ds_read_u16 v252, v250 offset:128
    ds_read_u16 v253, v250 offset:192
    v_exp_f32 v203, v203
    v_mfma_f32_16x16x32_bf16 v[228:231], v[176:179], v[92:95], 0
    s_ashr_i32 s96, s96, 24
    s_mul_i32 s96, s96, s101
    v_rcp_f32 v188, v188
    v_mfma_f32_16x16x32_bf16 v[224:227], v[180:183], v[88:91], 0
    v_rcp_f32 v189, v189
    v_mfma_f32_4x4x4_16b_bf16 v[200:203], v[242:243], v[242:243], v[200:203]
    v_rcp_f32 v190, v190
    v_mfma_f32_16x16x32_bf16 v[232:235], v[180:183], v[92:95], 0
    v_rcp_f32 v191, v191
    v_mfma_f32_16x16x32_bf16 v[220:223], v[160:163], v[16:19], v[220:223]
    v_rcp_f32 v192, v192
    v_mfma_f32_16x16x32_bf16 v[228:231], v[160:163], v[24:27], v[228:231]
    v_rcp_f32 v193, v193
    v_mfma_f32_16x16x32_bf16 v[224:227], v[168:171], v[16:19], v[224:227]
    s_waitcnt lgkmcnt(0)
    v_bfi_b32 v252, 31, v245, v252
    v_bfi_b32 v253, 31, v245, v253
    v_max_u32 v252, v252, v245
    v_max_u32 v253, v253, v247
    ds_read_b128 v[236:239], v248 offset:1280
    ds_read_b32 v240, v249 offset:1280
    s_add_u32 s16, s16, 1
    v_rcp_f32 v194, v194
    v_mfma_f32_16x16x32_bf16 v[232:235], v[168:171], v[24:27], v[232:235]
    v_lshl_add_u64 v[248:249], v[248:249], 0, s[94:95]
    v_lshl_add_u64 v[250:251], v[250:251], 0, s[94:95]
    v_rcp_f32 v195, v195
    v_mfma_f32_16x16x32_bf16 v[220:223], v[164:167], v[20:23], v[220:223]
    v_rcp_f32 v196, v196
    v_mfma_f32_16x16x32_bf16 v[228:231], v[164:167], v[28:31], v[228:231]
    v_rcp_f32 v197, v197
    s_setprio 3
    v_mfma_f32_16x16x32_bf16 v[224:227], v[172:175], v[20:23], v[224:227]
    v_rcp_f32 v198, v198
    v_mfma_f32_16x16x32_bf16 v[232:235], v[172:175], v[28:31], v[232:235]
    v_rcp_f32 v199, v199
    v_rcp_f32 v200, v200
    v_rcp_f32 v201, v201
    v_rcp_f32 v202, v202
    v_rcp_f32 v203, v203
    v_pk_mul_f32 v[204:205], v[188:189], v[204:205]
    v_pk_mul_f32 v[206:207], v[190:191], v[206:207]
    v_pk_mul_f32 v[208:209], v[192:193], v[208:209]
    v_pk_mul_f32 v[210:211], v[194:195], v[210:211]
    v_pk_mul_f32 v[212:213], v[196:197], v[212:213]
    v_pk_mul_f32 v[214:215], v[198:199], v[214:215]
    v_pk_mul_f32 v[216:217], v[200:201], v[216:217]
    v_pk_mul_f32 v[218:219], v[202:203], v[218:219]
    s_cmp_ge_i32 s96, 1
    s_cbranch_scc1 L_PB11
L_PB10:
    s_setprio 0
    v_smfmac_f32_16x16x64_bf16 v[144:147], v[184:187], v[204:211], v255
    v_exp_f32 v220, v220
    v_smfmac_f32_16x16x64_bf16 v[148:151], v[184:187], v[212:219], v255
    v_exp_f32 v221, v221
    s_waitcnt vmcnt(1)
    v_mfma_f32_16x16x32_bf16 v[204:207], v[160:163], v[48:51], 0
    v_exp_f32 v222, v222
    v_mfma_f32_16x16x32_bf16 v[212:215], v[160:163], v[56:59], 0
    ds_read_b128 v[160:163], v244 offset:0
    v_exp_f32 v223, v223
    v_mfma_f32_16x16x32_bf16 v[208:211], v[168:171], v[48:51], 0
    v_exp_f32 v224, v224
    v_mfma_f32_16x16x32_bf16 v[216:219], v[168:171], v[56:59], 0
    ds_read_b128 v[168:171], v244 offset:512
    v_exp_f32 v225, v225
    v_mfma_f32_16x16x32_bf16 v[204:207], v[164:167], v[52:55], v[204:207]
    v_exp_f32 v226, v226
    v_mfma_f32_16x16x32_bf16 v[212:215], v[164:167], v[60:63], v[212:215]
    ds_read_b128 v[164:167], v244 offset:64
    v_exp_f32 v227, v227
    v_mfma_f32_16x16x32_bf16 v[208:211], v[172:175], v[52:55], v[208:211]
    v_exp_f32 v228, v228
    v_mfma_f32_16x16x32_bf16 v[216:219], v[172:175], v[60:63], v[216:219]
    ds_read_b128 v[172:175], v244 offset:576
    v_exp_f32 v229, v229
    v_smfmac_f32_16x16x64_bf16 v[128:131], v[184:187], v[188:195], v255
    v_exp_f32 v230, v230
    v_smfmac_f32_16x16x64_bf16 v[132:135], v[184:187], v[196:203], v255
    v_exp_f32 v231, v231
    v_mfma_f32_4x4x4_16b_bf16 v[220:223], v[242:243], v[242:243], v[220:223]
    v_exp_f32 v232, v232
    v_mfma_f32_4x4x4_16b_bf16 v[224:227], v[242:243], v[242:243], v[224:227]
    v_exp_f32 v233, v233
    v_mfma_f32_4x4x4_16b_bf16 v[228:231], v[242:243], v[242:243], v[228:231]
    v_exp_f32 v234, v234
    s_waitcnt lgkmcnt(2)
    v_mfma_f32_16x16x32_bf16 v[188:191], v[160:163], v[0:3], 0
    v_exp_f32 v235, v235
    v_mfma_f32_16x16x32_bf16 v[196:199], v[160:163], v[8:11], 0
    s_waitcnt vmcnt(0)
    ds_read_b128 v[176:179], v252
    ds_read_b128 v[180:183], v253
    v_rcp_f32 v220, v220
    v_mfma_f32_16x16x32_bf16 v[192:195], v[168:171], v[0:3], 0
    v_rcp_f32 v221, v221
    v_mfma_f32_4x4x4_16b_bf16 v[232:235], v[242:243], v[242:243], v[232:235]
    v_rcp_f32 v222, v222
    v_mfma_f32_16x16x32_bf16 v[200:203], v[168:171], v[8:11], 0
    v_rcp_f32 v223, v223
    s_waitcnt lgkmcnt(2)
    v_mfma_f32_16x16x32_bf16 v[188:191], v[164:167], v[4:7], v[188:191]
    v_rcp_f32 v224, v224
    v_mfma_f32_16x16x32_bf16 v[196:199], v[164:167], v[12:15], v[196:199]
    v_rcp_f32 v225, v225
    v_mfma_f32_16x16x32_bf16 v[192:195], v[172:175], v[4:7], v[192:195]
    v_rcp_f32 v226, v226
    v_mfma_f32_16x16x32_bf16 v[200:203], v[172:175], v[12:15], v[200:203]
    v_rcp_f32 v227, v227
    s_waitcnt lgkmcnt(0)
    v_mfma_f32_16x16x32_bf16 v[188:191], v[176:179], v[64:67], v[188:191]
    v_rcp_f32 v228, v228
    v_mfma_f32_16x16x32_bf16 v[196:199], v[176:179], v[68:71], v[196:199]
    s_cmp_lt_u32 s16, s17
    s_cbranch_scc0 L_ND10
    s_add_u32 m0, s13, 0
    v_mad_u32_u16 v236, v236, s15, v243
    buffer_load_dwordx4 v236, s[40:43], 0 offen lds
    s_add_u32 m0, s13, 1056
    v_mad_u32_u16 v237, v237, s15, v243
    buffer_load_dwordx4 v237, s[40:43], 0 offen lds
    s_add_u32 m0, s13, 2112
    v_mad_u32_u16 v238, v238, s15, v243
    buffer_load_dwordx4 v238, s[40:43], 0 offen lds
    s_add_u32 m0, s13, 3168
    v_mad_u32_u16 v239, v239, s15, v243
    buffer_load_dwordx4 v239, s[40:43], 0 offen lds
    s_mov_b32 m0, s14
    s_nop 0
    buffer_load_dwordx4 v[240:241], s[44:47], 0 idxen offen lds
L_ND10:
    v_rcp_f32 v229, v229
    s_setprio 3
    v_mfma_f32_16x16x32_bf16 v[192:195], v[180:183], v[64:67], v[192:195]
    v_rcp_f32 v230, v230
    v_mfma_f32_16x16x32_bf16 v[200:203], v[180:183], v[68:71], v[200:203]
    v_rcp_f32 v231, v231
    v_rcp_f32 v232, v232
    v_rcp_f32 v233, v233
    v_rcp_f32 v234, v234
    v_rcp_f32 v235, v235
    v_pk_mul_f32 v[204:205], v[220:221], v[204:205]
    v_pk_mul_f32 v[206:207], v[222:223], v[206:207]
    v_pk_mul_f32 v[208:209], v[224:225], v[208:209]
    v_pk_mul_f32 v[210:211], v[226:227], v[210:211]
    v_pk_mul_f32 v[212:213], v[228:229], v[212:213]
    v_pk_mul_f32 v[214:215], v[230:231], v[214:215]
    v_pk_mul_f32 v[216:217], v[232:233], v[216:217]
    v_pk_mul_f32 v[218:219], v[234:235], v[218:219]
    s_cmp_lt_u32 s16, s17
    s_cbranch_scc1 L_LOOP0
    s_branch L_LT0
L_LT0:
    s_cmp_lg_u32 s99, 0
    s_cbranch_scc1 L_LH0
    s_setprio 0
    v_smfmac_f32_16x16x64_bf16 v[152:155], v[184:187], v[204:211], v255
    ds_read_u16 v236, v251 offset:0
    ds_read_u16 v237, v251 offset:16
    v_exp_f32 v188, v188
    v_smfmac_f32_16x16x64_bf16 v[156:159], v[184:187], v[212:219], v255
    v_exp_f32 v189, v189
    v_mfma_f32_16x16x32_bf16 v[204:207], v[160:163], v[32:35], 0
    v_exp_f32 v190, v190
    v_mfma_f32_16x16x32_bf16 v[212:215], v[160:163], v[40:43], 0
    v_exp_f32 v191, v191
    v_mfma_f32_16x16x32_bf16 v[208:211], v[168:171], v[32:35], 0
    v_exp_f32 v192, v192
    v_mfma_f32_16x16x32_bf16 v[216:219], v[168:171], v[40:43], 0
    v_exp_f32 v193, v193
    v_mfma_f32_16x16x32_bf16 v[204:207], v[164:167], v[36:39], v[204:207]
    v_exp_f32 v194, v194
    v_mfma_f32_16x16x32_bf16 v[212:215], v[164:167], v[44:47], v[212:215]
    v_exp_f32 v195, v195
    v_mfma_f32_16x16x32_bf16 v[208:211], v[172:175], v[36:39], v[208:211]
    v_exp_f32 v196, v196
    v_mfma_f32_16x16x32_bf16 v[216:219], v[172:175], v[44:47], v[216:219]
    v_exp_f32 v197, v197
    v_smfmac_f32_16x16x64_bf16 v[136:139], v[184:187], v[220:227], v255
    s_waitcnt lgkmcnt(0)
    v_bfi_b32 v236, 31, v246, v236
    v_bfi_b32 v237, 31, v246, v237
    v_exp_f32 v198, v198
    s_setprio 3
    v_smfmac_f32_16x16x64_bf16 v[140:143], v[184:187], v[228:235], v255
    v_exp_f32 v199, v199
    v_exp_f32 v200, v200
    v_exp_f32 v201, v201
    v_exp_f32 v202, v202
    v_exp_f32 v203, v203
    v_pk_add_f32 v[188:189], v[188:189], 1.0 op_sel_hi:[1,0]
    v_pk_add_f32 v[190:191], v[190:191], 1.0 op_sel_hi:[1,0]
    v_pk_add_f32 v[192:193], v[192:193], 1.0 op_sel_hi:[1,0]
    v_pk_add_f32 v[194:195], v[194:195], 1.0 op_sel_hi:[1,0]
    v_pk_add_f32 v[196:197], v[196:197], 1.0 op_sel_hi:[1,0]
    v_pk_add_f32 v[198:199], v[198:199], 1.0 op_sel_hi:[1,0]
    v_pk_add_f32 v[200:201], v[200:201], 1.0 op_sel_hi:[1,0]
    v_pk_add_f32 v[202:203], v[202:203], 1.0 op_sel_hi:[1,0]
    s_setprio 0
    v_mfma_f32_16x16x32_bf16 v[220:223], v[176:179], v[72:75], 0
    ds_read_b64_tr_b16 v[184:185], v236
    ds_read_b64_tr_b16 v[186:187], v237
    v_rcp_f32 v188, v188
    v_mfma_f32_16x16x32_bf16 v[228:231], v[176:179], v[76:79], 0
    v_rcp_f32 v189, v189
    v_mfma_f32_16x16x32_bf16 v[224:227], v[180:183], v[72:75], 0
    v_rcp_f32 v190, v190
    v_mfma_f32_16x16x32_bf16 v[232:235], v[180:183], v[76:79], 0
    v_rcp_f32 v191, v191
    v_mfma_f32_16x16x32_bf16 v[220:223], v[160:163], v[16:19], v[220:223]
    v_rcp_f32 v192, v192
    v_mfma_f32_16x16x32_bf16 v[228:231], v[160:163], v[24:27], v[228:231]
    v_rcp_f32 v193, v193
    v_mfma_f32_16x16x32_bf16 v[224:227], v[168:171], v[16:19], v[224:227]
    v_rcp_f32 v194, v194
    v_mfma_f32_16x16x32_bf16 v[232:235], v[168:171], v[24:27], v[232:235]
    v_rcp_f32 v195, v195
    v_mfma_f32_16x16x32_bf16 v[220:223], v[164:167], v[20:23], v[220:223]
    v_rcp_f32 v196, v196
    v_mfma_f32_16x16x32_bf16 v[228:231], v[164:167], v[28:31], v[228:231]
    v_rcp_f32 v197, v197
    v_mfma_f32_16x16x32_bf16 v[224:227], v[172:175], v[20:23], v[224:227]
    v_rcp_f32 v198, v198
    s_setprio 3
    v_mfma_f32_16x16x32_bf16 v[232:235], v[172:175], v[28:31], v[232:235]
    v_rcp_f32 v199, v199
    v_rcp_f32 v200, v200
    v_rcp_f32 v201, v201
    v_rcp_f32 v202, v202
    v_rcp_f32 v203, v203
    v_pk_mul_f32 v[204:205], v[188:189], v[204:205]
    v_pk_mul_f32 v[206:207], v[190:191], v[206:207]
    v_pk_mul_f32 v[208:209], v[192:193], v[208:209]
    v_pk_mul_f32 v[210:211], v[194:195], v[210:211]
    v_pk_mul_f32 v[212:213], v[196:197], v[212:213]
    v_pk_mul_f32 v[214:215], v[198:199], v[214:215]
    v_pk_mul_f32 v[216:217], v[200:201], v[216:217]
    v_pk_mul_f32 v[218:219], v[202:203], v[218:219]
    s_setprio 0
    s_waitcnt lgkmcnt(0)
    v_smfmac_f32_16x16x64_bf16 v[112:115], v[184:187], v[204:211], v255
    v_exp_f32 v220, v220
    v_smfmac_f32_16x16x64_bf16 v[116:119], v[184:187], v[212:219], v255
    v_exp_f32 v221, v221
    v_mfma_f32_16x16x32_bf16 v[204:207], v[160:163], v[48:51], 0
    v_exp_f32 v222, v222
    v_mfma_f32_16x16x32_bf16 v[212:215], v[160:163], v[56:59], 0
    v_exp_f32 v223, v223
    v_mfma_f32_16x16x32_bf16 v[208:211], v[168:171], v[48:51], 0
    v_exp_f32 v224, v224
    v_mfma_f32_16x16x32_bf16 v[216:219], v[168:171], v[56:59], 0
    v_exp_f32 v225, v225
    v_mfma_f32_16x16x32_bf16 v[204:207], v[164:167], v[52:55], v[204:207]
    v_exp_f32 v226, v226
    v_mfma_f32_16x16x32_bf16 v[212:215], v[164:167], v[60:63], v[212:215]
    v_exp_f32 v227, v227
    v_mfma_f32_16x16x32_bf16 v[208:211], v[172:175], v[52:55], v[208:211]
    v_exp_f32 v228, v228
    v_mfma_f32_16x16x32_bf16 v[216:219], v[172:175], v[60:63], v[216:219]
    v_exp_f32 v229, v229
    v_smfmac_f32_16x16x64_bf16 v[96:99], v[184:187], v[188:195], v255
    v_exp_f32 v230, v230
    s_setprio 3
    v_smfmac_f32_16x16x64_bf16 v[100:103], v[184:187], v[196:203], v255
    v_exp_f32 v231, v231
    v_exp_f32 v232, v232
    v_exp_f32 v233, v233
    v_exp_f32 v234, v234
    v_exp_f32 v235, v235
    v_pk_add_f32 v[220:221], v[220:221], 1.0 op_sel_hi:[1,0]
    v_pk_add_f32 v[222:223], v[222:223], 1.0 op_sel_hi:[1,0]
    v_pk_add_f32 v[224:225], v[224:225], 1.0 op_sel_hi:[1,0]
    v_pk_add_f32 v[226:227], v[226:227], 1.0 op_sel_hi:[1,0]
    v_pk_add_f32 v[228:229], v[228:229], 1.0 op_sel_hi:[1,0]
    v_pk_add_f32 v[230:231], v[230:231], 1.0 op_sel_hi:[1,0]
    v_pk_add_f32 v[232:233], v[232:233], 1.0 op_sel_hi:[1,0]
    v_pk_add_f32 v[234:235], v[234:235], 1.0 op_sel_hi:[1,0]
    s_setprio 0
    v_rcp_f32 v220, v220
    v_rcp_f32 v221, v221
    v_rcp_f32 v222, v222
    v_rcp_f32 v223, v223
    v_rcp_f32 v224, v224
    v_rcp_f32 v225, v225
    v_rcp_f32 v226, v226
    v_rcp_f32 v227, v227
    v_rcp_f32 v228, v228
    v_rcp_f32 v229, v229
    v_rcp_f32 v230, v230
    v_rcp_f32 v231, v231
    v_rcp_f32 v232, v232
    v_rcp_f32 v233, v233
    v_rcp_f32 v234, v234
    v_rcp_f32 v235, v235
    v_pk_mul_f32 v[204:205], v[220:221], v[204:205]
    v_pk_mul_f32 v[206:207], v[222:223], v[206:207]
    v_pk_mul_f32 v[208:209], v[224:225], v[208:209]
    v_pk_mul_f32 v[210:211], v[226:227], v[210:211]
    v_pk_mul_f32 v[212:213], v[228:229], v[212:213]
    v_pk_mul_f32 v[214:215], v[230:231], v[214:215]
    v_pk_mul_f32 v[216:217], v[232:233], v[216:217]
    v_pk_mul_f32 v[218:219], v[234:235], v[218:219]
    v_smfmac_f32_16x16x64_bf16 v[104:107], v[184:187], v[220:227], v255
    v_smfmac_f32_16x16x64_bf16 v[108:111], v[184:187], v[228:235], v255
    v_smfmac_f32_16x16x64_bf16 v[120:123], v[184:187], v[204:211], v255
    v_smfmac_f32_16x16x64_bf16 v[124:127], v[184:187], v[212:219], v255
    s_branch L_DONE
L_LH0:
    s_setprio 0
    v_smfmac_f32_16x16x64_bf16 v[152:155], v[184:187], v[204:211], v255
    ds_read_u16 v236, v251 offset:0
    ds_read_u16 v237, v251 offset:16
    v_smfmac_f32_16x16x64_bf16 v[156:159], v[184:187], v[212:219], v255
    v_exp_f32 v188, v188
    v_mfma_f32_16x16x32_bf16 v[204:207], v[160:163], v[32:35], 0
    v_mfma_f32_16x16x32_bf16 v[212:215], v[160:163], v[40:43], 0
    v_exp_f32 v189, v189
    v_mfma_f32_16x16x32_bf16 v[204:207], v[164:167], v[36:39], v[204:207]
    v_mfma_f32_16x16x32_bf16 v[212:215], v[164:167], v[44:47], v[212:215]
    v_exp_f32 v190, v190
    v_smfmac_f32_16x16x64_bf16 v[136:139], v[184:187], v[220:227], v255
    s_waitcnt lgkmcnt(0)
    v_bfi_b32 v236, 31, v246, v236
    v_bfi_b32 v237, 31, v246, v237
    v_exp_f32 v191, v191
    s_setprio 3
    v_smfmac_f32_16x16x64_bf16 v[140:143], v[184:187], v[228:235], v255
    v_exp_f32 v196, v196
    v_exp_f32 v197, v197
    v_exp_f32 v198, v198
    v_exp_f32 v199, v199
    v_pk_add_f32 v[188:189], v[188:189], 1.0 op_sel_hi:[1,0]
    v_pk_add_f32 v[190:191], v[190:191], 1.0 op_sel_hi:[1,0]
    v_pk_add_f32 v[196:197], v[196:197], 1.0 op_sel_hi:[1,0]
    v_pk_add_f32 v[198:199], v[198:199], 1.0 op_sel_hi:[1,0]
    s_setprio 0
    v_mfma_f32_16x16x32_bf16 v[220:223], v[176:179], v[72:75], 0
    ds_read_b64_tr_b16 v[184:185], v236
    ds_read_b64_tr_b16 v[186:187], v237
    v_mfma_f32_16x16x32_bf16 v[228:231], v[176:179], v[76:79], 0
    v_rcp_f32 v188, v188
    v_mfma_f32_16x16x32_bf16 v[220:223], v[160:163], v[16:19], v[220:223]
    v_rcp_f32 v189, v189
    v_mfma_f32_16x16x32_bf16 v[228:231], v[160:163], v[24:27], v[228:231]
    v_rcp_f32 v190, v190
    v_mfma_f32_16x16x32_bf16 v[220:223], v[164:167], v[20:23], v[220:223]
    v_rcp_f32 v191, v191
    s_setprio 3
    v_mfma_f32_16x16x32_bf16 v[228:231], v[164:167], v[28:31], v[228:231]
    v_rcp_f32 v196, v196
    v_rcp_f32 v197, v197
    v_rcp_f32 v198, v198
    v_rcp_f32 v199, v199
    v_pk_mul_f32 v[204:205], v[188:189], v[204:205]
    v_pk_mul_f32 v[206:207], v[190:191], v[206:207]
    v_pk_mul_f32 v[212:213], v[196:197], v[212:213]
    v_pk_mul_f32 v[214:215], v[198:199], v[214:215]
    s_setprio 0
    s_waitcnt lgkmcnt(0)
    v_smfmac_f32_16x16x64_bf16 v[112:115], v[184:187], v[204:211], v255
    v_smfmac_f32_16x16x64_bf16 v[116:119], v[184:187], v[212:219], v255
    v_exp_f32 v220, v220
    v_mfma_f32_16x16x32_bf16 v[204:207], v[160:163], v[48:51], 0
    v_mfma_f32_16x16x32_bf16 v[212:215], v[160:163], v[56:59], 0
    v_exp_f32 v221, v221
    v_mfma_f32_16x16x32_bf16 v[204:207], v[164:167], v[52:55], v[204:207]
    v_mfma_f32_16x16x32_bf16 v[212:215], v[164:167], v[60:63], v[212:215]
    v_exp_f32 v222, v222
    v_smfmac_f32_16x16x64_bf16 v[96:99], v[184:187], v[188:195], v255
    v_exp_f32 v223, v223
    s_setprio 3
    v_smfmac_f32_16x16x64_bf16 v[100:103], v[184:187], v[196:203], v255
    v_exp_f32 v228, v228
    v_exp_f32 v229, v229
    v_exp_f32 v230, v230
    v_exp_f32 v231, v231
    v_pk_add_f32 v[220:221], v[220:221], 1.0 op_sel_hi:[1,0]
    v_pk_add_f32 v[222:223], v[222:223], 1.0 op_sel_hi:[1,0]
    v_pk_add_f32 v[228:229], v[228:229], 1.0 op_sel_hi:[1,0]
    v_pk_add_f32 v[230:231], v[230:231], 1.0 op_sel_hi:[1,0]
    s_setprio 0
    v_rcp_f32 v220, v220
    v_rcp_f32 v221, v221
    v_rcp_f32 v222, v222
    v_rcp_f32 v223, v223
    v_rcp_f32 v228, v228
    v_rcp_f32 v229, v229
    v_rcp_f32 v230, v230
    v_rcp_f32 v231, v231
    v_pk_mul_f32 v[204:205], v[220:221], v[204:205]
    v_pk_mul_f32 v[206:207], v[222:223], v[206:207]
    v_pk_mul_f32 v[212:213], v[228:229], v[212:213]
    v_pk_mul_f32 v[214:215], v[230:231], v[214:215]
    v_smfmac_f32_16x16x64_bf16 v[104:107], v[184:187], v[220:227], v255
    v_smfmac_f32_16x16x64_bf16 v[108:111], v[184:187], v[228:235], v255
    v_smfmac_f32_16x16x64_bf16 v[120:123], v[184:187], v[204:211], v255
    v_smfmac_f32_16x16x64_bf16 v[124:127], v[184:187], v[212:219], v255
    s_branch L_DONE
L_LT1:
    s_cmp_lg_u32 s99, 0
    s_cbranch_scc1 L_LH1
    s_setprio 0
    v_smfmac_f32_16x16x64_bf16 v[120:123], v[184:187], v[204:211], v255
    ds_read_u16 v236, v251 offset:1152
    ds_read_u16 v237, v251 offset:1168
    v_exp_f32 v188, v188
    v_smfmac_f32_16x16x64_bf16 v[124:127], v[184:187], v[212:219], v255
    v_exp_f32 v189, v189
    v_mfma_f32_16x16x32_bf16 v[204:207], v[160:163], v[32:35], 0
    v_exp_f32 v190, v190
    v_mfma_f32_16x16x32_bf16 v[212:215], v[160:163], v[40:43], 0
    v_exp_f32 v191, v191
    v_mfma_f32_16x16x32_bf16 v[208:211], v[168:171], v[32:35], 0
    v_exp_f32 v192, v192
    v_mfma_f32_16x16x32_bf16 v[216:219], v[168:171], v[40:43], 0
    v_exp_f32 v193, v193
    v_mfma_f32_16x16x32_bf16 v[204:207], v[164:167], v[36:39], v[204:207]
    v_exp_f32 v194, v194
    v_mfma_f32_16x16x32_bf16 v[212:215], v[164:167], v[44:47], v[212:215]
    v_exp_f32 v195, v195
    v_mfma_f32_16x16x32_bf16 v[208:211], v[172:175], v[36:39], v[208:211]
    v_exp_f32 v196, v196
    v_mfma_f32_16x16x32_bf16 v[216:219], v[172:175], v[44:47], v[216:219]
    v_exp_f32 v197, v197
    v_smfmac_f32_16x16x64_bf16 v[104:107], v[184:187], v[220:227], v255
    s_waitcnt lgkmcnt(0)
    v_bfi_b32 v236, 31, v246, v236
    v_bfi_b32 v237, 31, v246, v237
    v_exp_f32 v198, v198
    s_setprio 3
    v_smfmac_f32_16x16x64_bf16 v[108:111], v[184:187], v[228:235], v255
    v_exp_f32 v199, v199
    v_exp_f32 v200, v200
    v_exp_f32 v201, v201
    v_exp_f32 v202, v202
    v_exp_f32 v203, v203
    v_pk_add_f32 v[188:189], v[188:189], 1.0 op_sel_hi:[1,0]
    v_pk_add_f32 v[190:191], v[190:191], 1.0 op_sel_hi:[1,0]
    v_pk_add_f32 v[192:193], v[192:193], 1.0 op_sel_hi:[1,0]
    v_pk_add_f32 v[194:195], v[194:195], 1.0 op_sel_hi:[1,0]
    v_pk_add_f32 v[196:197], v[196:197], 1.0 op_sel_hi:[1,0]
    v_pk_add_f32 v[198:199], v[198:199], 1.0 op_sel_hi:[1,0]
    v_pk_add_f32 v[200:201], v[200:201], 1.0 op_sel_hi:[1,0]
    v_pk_add_f32 v[202:203], v[202:203], 1.0 op_sel_hi:[1,0]
    s_setprio 0
    v_mfma_f32_16x16x32_bf16 v[220:223], v[176:179], v[88:91], 0
    ds_read_b64_tr_b16 v[184:185], v236
    ds_read_b64_tr_b16 v[186:187], v237
    v_rcp_f32 v188, v188
    v_mfma_f32_16x16x32_bf16 v[228:231], v[176:179], v[92:95], 0
    v_rcp_f32 v189, v189
    v_mfma_f32_16x16x32_bf16 v[224:227], v[180:183], v[88:91], 0
    v_rcp_f32 v190, v190
    v_mfma_f32_16x16x32_bf16 v[232:235], v[180:183], v[92:95], 0
    v_rcp_f32 v191, v191
    v_mfma_f32_16x16x32_bf16 v[220:223], v[160:163], v[16:19], v[220:223]
    v_rcp_f32 v192, v192
    v_mfma_f32_16x16x32_bf16 v[228:231], v[160:163], v[24:27], v[228:231]
    v_rcp_f32 v193, v193
    v_mfma_f32_16x16x32_bf16 v[224:227], v[168:171], v[16:19], v[224:227]
    v_rcp_f32 v194, v194
    v_mfma_f32_16x16x32_bf16 v[232:235], v[168:171], v[24:27], v[232:235]
    v_rcp_f32 v195, v195
    v_mfma_f32_16x16x32_bf16 v[220:223], v[164:167], v[20:23], v[220:223]
    v_rcp_f32 v196, v196
    v_mfma_f32_16x16x32_bf16 v[228:231], v[164:167], v[28:31], v[228:231]
    v_rcp_f32 v197, v197
    v_mfma_f32_16x16x32_bf16 v[224:227], v[172:175], v[20:23], v[224:227]
    v_rcp_f32 v198, v198
    s_setprio 3
    v_mfma_f32_16x16x32_bf16 v[232:235], v[172:175], v[28:31], v[232:235]
    v_rcp_f32 v199, v199
    v_rcp_f32 v200, v200
    v_rcp_f32 v201, v201
    v_rcp_f32 v202, v202
    v_rcp_f32 v203, v203
    v_pk_mul_f32 v[204:205], v[188:189], v[204:205]
    v_pk_mul_f32 v[206:207], v[190:191], v[206:207]
    v_pk_mul_f32 v[208:209], v[192:193], v[208:209]
    v_pk_mul_f32 v[210:211], v[194:195], v[210:211]
    v_pk_mul_f32 v[212:213], v[196:197], v[212:213]
    v_pk_mul_f32 v[214:215], v[198:199], v[214:215]
    v_pk_mul_f32 v[216:217], v[200:201], v[216:217]
    v_pk_mul_f32 v[218:219], v[202:203], v[218:219]
    s_setprio 0
    s_waitcnt lgkmcnt(0)
    v_smfmac_f32_16x16x64_bf16 v[144:147], v[184:187], v[204:211], v255
    v_exp_f32 v220, v220
    v_smfmac_f32_16x16x64_bf16 v[148:151], v[184:187], v[212:219], v255
    v_exp_f32 v221, v221
    v_mfma_f32_16x16x32_bf16 v[204:207], v[160:163], v[48:51], 0
    v_exp_f32 v222, v222
    v_mfma_f32_16x16x32_bf16 v[212:215], v[160:163], v[56:59], 0
    v_exp_f32 v223, v223
    v_mfma_f32_16x16x32_bf16 v[208:211], v[168:171], v[48:51], 0
    v_exp_f32 v224, v224
    v_mfma_f32_16x16x32_bf16 v[216:219], v[168:171], v[56:59], 0
    v_exp_f32 v225, v225
    v_mfma_f32_16x16x32_bf16 v[204:207], v[164:167], v[52:55], v[204:207]
    v_exp_f32 v226, v226
    v_mfma_f32_16x16x32_bf16 v[212:215], v[164:167], v[60:63], v[212:215]
    v_exp_f32 v227, v227
    v_mfma_f32_16x16x32_bf16 v[208:211], v[172:175], v[52:55], v[208:211]
    v_exp_f32 v228, v228
    v_mfma_f32_16x16x32_bf16 v[216:219], v[172:175], v[60:63], v[216:219]
    v_exp_f32 v229, v229
    v_smfmac_f32_16x16x64_bf16 v[128:131], v[184:187], v[188:195], v255
    v_exp_f32 v230, v230
    s_setprio 3
    v_smfmac_f32_16x16x64_bf16 v[132:135], v[184:187], v[196:203], v255
    v_exp_f32 v231, v231
    v_exp_f32 v232, v232
    v_exp_f32 v233, v233
    v_exp_f32 v234, v234
    v_exp_f32 v235, v235
    v_pk_add_f32 v[220:221], v[220:221], 1.0 op_sel_hi:[1,0]
    v_pk_add_f32 v[222:223], v[222:223], 1.0 op_sel_hi:[1,0]
    v_pk_add_f32 v[224:225], v[224:225], 1.0 op_sel_hi:[1,0]
    v_pk_add_f32 v[226:227], v[226:227], 1.0 op_sel_hi:[1,0]
    v_pk_add_f32 v[228:229], v[228:229], 1.0 op_sel_hi:[1,0]
    v_pk_add_f32 v[230:231], v[230:231], 1.0 op_sel_hi:[1,0]
    v_pk_add_f32 v[232:233], v[232:233], 1.0 op_sel_hi:[1,0]
    v_pk_add_f32 v[234:235], v[234:235], 1.0 op_sel_hi:[1,0]
    s_setprio 0
    v_rcp_f32 v220, v220
    v_rcp_f32 v221, v221
    v_rcp_f32 v222, v222
    v_rcp_f32 v223, v223
    v_rcp_f32 v224, v224
    v_rcp_f32 v225, v225
    v_rcp_f32 v226, v226
    v_rcp_f32 v227, v227
    v_rcp_f32 v228, v228
    v_rcp_f32 v229, v229
    v_rcp_f32 v230, v230
    v_rcp_f32 v231, v231
    v_rcp_f32 v232, v232
    v_rcp_f32 v233, v233
    v_rcp_f32 v234, v234
    v_rcp_f32 v235, v235
    v_pk_mul_f32 v[204:205], v[220:221], v[204:205]
    v_pk_mul_f32 v[206:207], v[222:223], v[206:207]
    v_pk_mul_f32 v[208:209], v[224:225], v[208:209]
    v_pk_mul_f32 v[210:211], v[226:227], v[210:211]
    v_pk_mul_f32 v[212:213], v[228:229], v[212:213]
    v_pk_mul_f32 v[214:215], v[230:231], v[214:215]
    v_pk_mul_f32 v[216:217], v[232:233], v[216:217]
    v_pk_mul_f32 v[218:219], v[234:235], v[218:219]
    v_smfmac_f32_16x16x64_bf16 v[136:139], v[184:187], v[220:227], v255
    v_smfmac_f32_16x16x64_bf16 v[140:143], v[184:187], v[228:235], v255
    v_smfmac_f32_16x16x64_bf16 v[152:155], v[184:187], v[204:211], v255
    v_smfmac_f32_16x16x64_bf16 v[156:159], v[184:187], v[212:219], v255
    s_branch L_DONE
L_LH1:
    s_setprio 0
    v_smfmac_f32_16x16x64_bf16 v[120:123], v[184:187], v[204:211], v255
    ds_read_u16 v236, v251 offset:1152
    ds_read_u16 v237, v251 offset:1168
    v_smfmac_f32_16x16x64_bf16 v[124:127], v[184:187], v[212:219], v255
    v_exp_f32 v188, v188
    v_mfma_f32_16x16x32_bf16 v[204:207], v[160:163], v[32:35], 0
    v_mfma_f32_16x16x32_bf16 v[212:215], v[160:163], v[40:43], 0
    v_exp_f32 v189, v189
    v_mfma_f32_16x16x32_bf16 v[204:207], v[164:167], v[36:39], v[204:207]
    v_mfma_f32_16x16x32_bf16 v[212:215], v[164:167], v[44:47], v[212:215]
    v_exp_f32 v190, v190
    v_smfmac_f32_16x16x64_bf16 v[104:107], v[184:187], v[220:227], v255
    s_waitcnt lgkmcnt(0)
    v_bfi_b32 v236, 31, v246, v236
    v_bfi_b32 v237, 31, v246, v237
    v_exp_f32 v191, v191
    s_setprio 3
    v_smfmac_f32_16x16x64_bf16 v[108:111], v[184:187], v[228:235], v255
    v_exp_f32 v196, v196
    v_exp_f32 v197, v197
    v_exp_f32 v198, v198
    v_exp_f32 v199, v199
    v_pk_add_f32 v[188:189], v[188:189], 1.0 op_sel_hi:[1,0]
    v_pk_add_f32 v[190:191], v[190:191], 1.0 op_sel_hi:[1,0]
    v_pk_add_f32 v[196:197], v[196:197], 1.0 op_sel_hi:[1,0]
    v_pk_add_f32 v[198:199], v[198:199], 1.0 op_sel_hi:[1,0]
    s_setprio 0
    v_mfma_f32_16x16x32_bf16 v[220:223], v[176:179], v[88:91], 0
    ds_read_b64_tr_b16 v[184:185], v236
    ds_read_b64_tr_b16 v[186:187], v237
    v_mfma_f32_16x16x32_bf16 v[228:231], v[176:179], v[92:95], 0
    v_rcp_f32 v188, v188
    v_mfma_f32_16x16x32_bf16 v[220:223], v[160:163], v[16:19], v[220:223]
    v_rcp_f32 v189, v189
    v_mfma_f32_16x16x32_bf16 v[228:231], v[160:163], v[24:27], v[228:231]
    v_rcp_f32 v190, v190
    v_mfma_f32_16x16x32_bf16 v[220:223], v[164:167], v[20:23], v[220:223]
    v_rcp_f32 v191, v191
    s_setprio 3
    v_mfma_f32_16x16x32_bf16 v[228:231], v[164:167], v[28:31], v[228:231]
    v_rcp_f32 v196, v196
    v_rcp_f32 v197, v197
    v_rcp_f32 v198, v198
    v_rcp_f32 v199, v199
    v_pk_mul_f32 v[204:205], v[188:189], v[204:205]
    v_pk_mul_f32 v[206:207], v[190:191], v[206:207]
    v_pk_mul_f32 v[212:213], v[196:197], v[212:213]
    v_pk_mul_f32 v[214:215], v[198:199], v[214:215]
    s_setprio 0
    s_waitcnt lgkmcnt(0)
    v_smfmac_f32_16x16x64_bf16 v[144:147], v[184:187], v[204:211], v255
    v_smfmac_f32_16x16x64_bf16 v[148:151], v[184:187], v[212:219], v255
    v_exp_f32 v220, v220
    v_mfma_f32_16x16x32_bf16 v[204:207], v[160:163], v[48:51], 0
    v_mfma_f32_16x16x32_bf16 v[212:215], v[160:163], v[56:59], 0
    v_exp_f32 v221, v221
    v_mfma_f32_16x16x32_bf16 v[204:207], v[164:167], v[52:55], v[204:207]
    v_mfma_f32_16x16x32_bf16 v[212:215], v[164:167], v[60:63], v[212:215]
    v_exp_f32 v222, v222
    v_smfmac_f32_16x16x64_bf16 v[128:131], v[184:187], v[188:195], v255
    v_exp_f32 v223, v223
    s_setprio 3
    v_smfmac_f32_16x16x64_bf16 v[132:135], v[184:187], v[196:203], v255
    v_exp_f32 v228, v228
    v_exp_f32 v229, v229
    v_exp_f32 v230, v230
    v_exp_f32 v231, v231
    v_pk_add_f32 v[220:221], v[220:221], 1.0 op_sel_hi:[1,0]
    v_pk_add_f32 v[222:223], v[222:223], 1.0 op_sel_hi:[1,0]
    v_pk_add_f32 v[228:229], v[228:229], 1.0 op_sel_hi:[1,0]
    v_pk_add_f32 v[230:231], v[230:231], 1.0 op_sel_hi:[1,0]
    s_setprio 0
    v_rcp_f32 v220, v220
    v_rcp_f32 v221, v221
    v_rcp_f32 v222, v222
    v_rcp_f32 v223, v223
    v_rcp_f32 v228, v228
    v_rcp_f32 v229, v229
    v_rcp_f32 v230, v230
    v_rcp_f32 v231, v231
    v_pk_mul_f32 v[204:205], v[220:221], v[204:205]
    v_pk_mul_f32 v[206:207], v[222:223], v[206:207]
    v_pk_mul_f32 v[212:213], v[228:229], v[212:213]
    v_pk_mul_f32 v[214:215], v[230:231], v[214:215]
    v_smfmac_f32_16x16x64_bf16 v[136:139], v[184:187], v[220:227], v255
    v_smfmac_f32_16x16x64_bf16 v[140:143], v[184:187], v[228:235], v255
    v_smfmac_f32_16x16x64_bf16 v[152:155], v[184:187], v[204:211], v255
    v_smfmac_f32_16x16x64_bf16 v[156:159], v[184:187], v[212:219], v255
    s_branch L_DONE
L_DONE:
    v_mbcnt_lo_u32_b32 v247, -1, 0
    v_mbcnt_hi_u32_b32 v247, -1, v247
    v_and_b32 v246, 24, v246
    s_cmp_lg_u32 s19, 0
    s_cbranch_scc1 L_SLOW
L_EPI:
    s_waitcnt lgkmcnt(0)
    v_and_b32 v64, 48, v247
    v_and_b32 v67, 15, v247
    v_add_u32 v69, s72, v64
    v_lshl_add_u32 v70, v67, 2, s72
    ds_read_b128 v[80:83], v69 offset:0
    ds_read_b128 v[84:87], v69 offset:64
    ds_read2_b32 v[72:73], v70 offset0:0 offset1:16
    v_bfe_u32 v65, v247, 2, 3
    v_lshrrev_b32 v66, 5, v247
    v_lshl_add_u32 v65, v66, 4, v65
    v_mul_u32_u24 v65, 160, v65
    s_mov_b32 s10, 143488
    v_add3_u32 v65, v65, v246, s10
    ds_read_b64_tr_b16 v[0:1], v65 offset:0
    ds_read_b64_tr_b16 v[2:3], v65 offset:1280
    ds_read_b64_tr_b16 v[8:9], v65 offset:32
    ds_read_b64_tr_b16 v[10:11], v65 offset:1312
    ds_read_b64_tr_b16 v[16:17], v65 offset:64
    ds_read_b64_tr_b16 v[18:19], v65 offset:1344
    ds_read_b64_tr_b16 v[24:25], v65 offset:96
    ds_read_b64_tr_b16 v[26:27], v65 offset:1376
    ds_read_b64_tr_b16 v[4:5], v65 offset:5120
    ds_read_b64_tr_b16 v[6:7], v65 offset:6400
    ds_read_b64_tr_b16 v[12:13], v65 offset:5152
    ds_read_b64_tr_b16 v[14:15], v65 offset:6432
    s_movk_i32 s10, 832
    v_mad_u32_u24 v64, v246, s10, v64
    s_mov_b32 s10, 116736
    v_lshl_add_u32 v69, v67, 3, s10
    v_lshl_add_u32 v74, v67, 3, s73
    v_lshl_add_u32 v75, v67, 3, s74
    s_waitcnt lgkmcnt(8)
    ds_read_b64_tr_b16 v[20:21], v65 offset:5184
    ds_read_b64_tr_b16 v[22:23], v65 offset:6464
    ds_read_b64_tr_b16 v[28:29], v65 offset:5216
    ds_read_b64_tr_b16 v[30:31], v65 offset:6496
    v_add_u32 v76, v80, v69
    ds_read_b64 v[32:33], v76 offset:0
    v_add_u32 v76, v81, v69
    ds_read_b64 v[34:35], v76 offset:6656
    v_add_u32 v76, v82, v69
    ds_read_b64 v[36:37], v76 offset:13312
    v_add_u32 v76, v83, v69
    ds_read_b64 v[38:39], v76 offset:19968
    v_add_u32 v76, v84, v69
    ds_read_b64 v[40:41], v76 offset:0
    v_add_u32 v76, v85, v69
    ds_read_b64 v[42:43], v76 offset:6656
    v_add_u32 v76, v86, v69
    ds_read_b64 v[44:45], v76 offset:13312
    v_add_u32 v76, v87, v69
    ds_read_b64 v[46:47], v76 offset:19968
    v_add3_u32 v72, v72, v64, s10
    ds_read_b128 v[160:163], v72 offset:0
    ds_read_b128 v[164:167], v72 offset:64
    v_add3_u32 v73, v73, v64, s10
    ds_read_b128 v[168:171], v73 offset:0
    ds_read_b128 v[172:175], v73 offset:64
    s_waitcnt lgkmcnt(0)
    v_lshlrev_b32 v188, 16, v32
    v_lshlrev_b32 v189, 16, v34
    v_lshlrev_b32 v190, 16, v36
    v_lshlrev_b32 v191, 16, v38
    v_and_b32 v192, 0xffff0000, v32
    v_and_b32 v193, 0xffff0000, v34
    v_and_b32 v194, 0xffff0000, v36
    v_and_b32 v195, 0xffff0000, v38
    v_mfma_f32_16x16x32_bf16 v[188:191], v[160:163], v[0:3], v[188:191]
    v_lshlrev_b32 v196, 16, v33
    v_lshlrev_b32 v197, 16, v35
    v_lshlrev_b32 v198, 16, v37
    v_lshlrev_b32 v199, 16, v39
    v_lshl_add_u32 v80, v80, 2, v74
    v_mfma_f32_16x16x32_bf16 v[188:191], v[164:167], v[4:7], v[188:191]
    v_mfma_f32_16x16x32_bf16 v[192:195], v[160:163], v[8:11], v[192:195]
    v_and_b32 v200, 0xffff0000, v33
    v_and_b32 v201, 0xffff0000, v35
    v_and_b32 v202, 0xffff0000, v37
    v_and_b32 v203, 0xffff0000, v39
    v_lshl_add_u32 v81, v81, 2, v74
    v_mfma_f32_16x16x32_bf16 v[192:195], v[164:167], v[12:15], v[192:195]
    v_mfma_f32_16x16x32_bf16 v[196:199], v[160:163], v[16:19], v[196:199]
    v_lshlrev_b32 v48, 16, v40
    v_lshlrev_b32 v49, 16, v42
    v_lshlrev_b32 v50, 16, v44
    v_lshlrev_b32 v51, 16, v46
    v_lshl_add_u32 v82, v82, 2, v74
    v_mfma_f32_16x16x32_bf16 v[196:199], v[164:167], v[20:23], v[196:199]
    v_mfma_f32_16x16x32_bf16 v[200:203], v[160:163], v[24:27], v[200:203]
    v_and_b32 v52, 0xffff0000, v40
    v_and_b32 v53, 0xffff0000, v42
    v_and_b32 v54, 0xffff0000, v44
    v_and_b32 v55, 0xffff0000, v46
    v_lshl_add_u32 v83, v83, 2, v74
    v_mfma_f32_16x16x32_bf16 v[200:203], v[164:167], v[28:31], v[200:203]
    v_mfma_f32_16x16x32_bf16 v[48:51], v[168:171], v[0:3], v[48:51]
    v_lshlrev_b32 v56, 16, v41
    v_lshlrev_b32 v57, 16, v43
    v_lshlrev_b32 v58, 16, v45
    v_lshlrev_b32 v59, 16, v47
    v_lshl_add_u32 v84, v84, 2, v75
    v_mfma_f32_16x16x32_bf16 v[48:51], v[172:175], v[4:7], v[48:51]
    v_mfma_f32_16x16x32_bf16 v[52:55], v[168:171], v[8:11], v[52:55]
    v_and_b32 v60, 0xffff0000, v41
    v_and_b32 v61, 0xffff0000, v43
    v_and_b32 v62, 0xffff0000, v45
    v_and_b32 v63, 0xffff0000, v47
    v_lshl_add_u32 v85, v85, 2, v75
    v_mfma_f32_16x16x32_bf16 v[52:55], v[172:175], v[12:15], v[52:55]
    v_mfma_f32_16x16x32_bf16 v[56:59], v[168:171], v[16:19], v[56:59]
    v_lshl_add_u32 v86, v86, 2, v75
    v_mfma_f32_16x16x32_bf16 v[56:59], v[172:175], v[20:23], v[56:59]
    v_mfma_f32_16x16x32_bf16 v[60:63], v[168:171], v[24:27], v[60:63]
    v_lshl_add_u32 v87, v87, 2, v75
    v_mfma_f32_16x16x32_bf16 v[60:63], v[172:175], v[28:31], v[60:63]
L_EPB:
    s_setprio 0
    s_mov_b64 exec, s[76:77]
    s_and_b32 s11, s25, 19
    s_nop 2
    s_cmp_eq_u32 s11, 0
    s_cbranch_scc1 L_NS0
    s_cmp_eq_u32 s11, 1
    s_cbranch_scc1 L_NS1
    s_cmp_eq_u32 s11, 2
    s_cbranch_scc1 L_NS2
    s_cmp_eq_u32 s11, 3
    s_cbranch_scc1 L_NS3
L_NSR:
    s_mov_b64 exec, -1
    v_rcp_f32 v96, v96
    v_rcp_f32 v97, v97
    v_rcp_f32 v98, v98
    v_rcp_f32 v99, v99
    v_rcp_f32 v100, v100
    v_rcp_f32 v101, v101
    v_rcp_f32 v102, v102
    v_rcp_f32 v103, v103
    v_rcp_f32 v104, v104
    v_rcp_f32 v105, v105
    v_rcp_f32 v106, v106
    v_rcp_f32 v107, v107
    v_rcp_f32 v108, v108
    v_rcp_f32 v109, v109
    v_rcp_f32 v110, v110
    v_rcp_f32 v111, v111
    v_pk_fma_f32 v[112:113], v[112:113], v[96:97], v[188:189]
    v_pk_fma_f32 v[114:115], v[114:115], v[98:99], v[190:191]
    v_pk_fma_f32 v[116:117], v[116:117], v[100:101], v[192:193]
    v_pk_fma_f32 v[118:119], v[118:119], v[102:103], v[194:195]
    v_pk_fma_f32 v[120:121], v[120:121], v[104:105], v[196:197]
    v_pk_fma_f32 v[122:123], v[122:123], v[106:107], v[198:199]
    v_pk_fma_f32 v[124:125], v[124:125], v[108:109], v[200:201]
    v_pk_fma_f32 v[126:127], v[126:127], v[110:111], v[202:203]
    v_cvt_pk_bf16_f32 v96, v112, v116
    v_cvt_pk_bf16_f32 v97, v120, v124
    v_pk_max_f16 v96, v96, v32
    v_pk_max_f16 v97, v97, v33
    buffer_store_dwordx2 v[96:97], v80, s[48:51], 0 offen sc1
    v_cvt_pk_bf16_f32 v98, v113, v117
    v_cvt_pk_bf16_f32 v99, v121, v125
    v_pk_max_f16 v98, v98, v34
    v_pk_max_f16 v99, v99, v35
    buffer_store_dwordx2 v[98:99], v81, s[48:51], 0 offen sc1
    v_cvt_pk_bf16_f32 v100, v114, v118
    v_cvt_pk_bf16_f32 v101, v122, v126
    v_pk_max_f16 v100, v100, v36
    v_pk_max_f16 v101, v101, v37
    buffer_store_dwordx2 v[100:101], v82, s[48:51], 0 offen sc1
    v_cvt_pk_bf16_f32 v102, v115, v119
    v_cvt_pk_bf16_f32 v103, v123, v127
    v_pk_max_f16 v102, v102, v38
    v_pk_max_f16 v103, v103, v39
    buffer_store_dwordx2 v[102:103], v83, s[48:51], 0 offen sc1
    v_rcp_f32 v128, v128
    v_rcp_f32 v129, v129
    v_rcp_f32 v130, v130
    v_rcp_f32 v131, v131
    v_rcp_f32 v132, v132
    v_rcp_f32 v133, v133
    v_rcp_f32 v134, v134
    v_rcp_f32 v135, v135
    v_rcp_f32 v136, v136
    v_rcp_f32 v137, v137
    v_rcp_f32 v138, v138
    v_rcp_f32 v139, v139
    v_rcp_f32 v140, v140
    v_rcp_f32 v141, v141
    v_rcp_f32 v142, v142
    v_rcp_f32 v143, v143
    v_pk_fma_f32 v[144:145], v[144:145], v[128:129], v[48:49]
    v_pk_fma_f32 v[146:147], v[146:147], v[130:131], v[50:51]
    v_pk_fma_f32 v[148:149], v[148:149], v[132:133], v[52:53]
    v_pk_fma_f32 v[150:151], v[150:151], v[134:135], v[54:55]
    v_pk_fma_f32 v[152:153], v[152:153], v[136:137], v[56:57]
    v_pk_fma_f32 v[154:155], v[154:155], v[138:139], v[58:59]
    v_pk_fma_f32 v[156:157], v[156:157], v[140:141], v[60:61]
    v_pk_fma_f32 v[158:159], v[158:159], v[142:143], v[62:63]
    v_cvt_pk_bf16_f32 v128, v144, v148
    v_cvt_pk_bf16_f32 v129, v152, v156
    v_pk_max_f16 v128, v128, v40
    v_pk_max_f16 v129, v129, v41
    buffer_store_dwordx2 v[128:129], v84, s[60:63], 0 offen sc1
    v_cvt_pk_bf16_f32 v130, v145, v149
    v_cvt_pk_bf16_f32 v131, v153, v157
    v_pk_max_f16 v130, v130, v42
    v_pk_max_f16 v131, v131, v43
    buffer_store_dwordx2 v[130:131], v85, s[60:63], 0 offen sc1
    v_cvt_pk_bf16_f32 v132, v146, v150
    v_cvt_pk_bf16_f32 v133, v154, v158
    v_pk_max_f16 v132, v132, v44
    v_pk_max_f16 v133, v133, v45
    buffer_store_dwordx2 v[132:133], v86, s[60:63], 0 offen sc1
    v_cvt_pk_bf16_f32 v134, v147, v151
    v_cvt_pk_bf16_f32 v135, v155, v159
    v_pk_max_f16 v134, v134, v46
    v_pk_max_f16 v135, v135, v47
    buffer_store_dwordx2 v[134:135], v87, s[60:63], 0 offen sc1
L_END:
    s_endpgm
L_NS0:
    v_add_f32 v96, v96, v128
    v_add_f32 v100, v100, v132
    v_add_f32 v104, v104, v136
    v_add_f32 v108, v108, v140
    v_add_f32 v112, v112, v144
    v_add_f32 v116, v116, v148
    v_add_f32 v120, v120, v152
    v_add_f32 v124, v124, v156
    s_branch L_NSR
L_NS1:
    v_add_f32 v97, v97, v129
    v_add_f32 v101, v101, v133
    v_add_f32 v105, v105, v137
    v_add_f32 v109, v109, v141
    v_add_f32 v113, v113, v145
    v_add_f32 v117, v117, v149
    v_add_f32 v121, v121, v153
    v_add_f32 v125, v125, v157
    s_branch L_NSR
L_NS2:
    v_add_f32 v98, v98, v130
    v_add_f32 v102, v102, v134
    v_add_f32 v106, v106, v138
    v_add_f32 v110, v110, v142
    v_add_f32 v114, v114, v146
    v_add_f32 v118, v118, v150
    v_add_f32 v122, v122, v154
    v_add_f32 v126, v126, v158
    s_branch L_NSR
L_NS3:
    v_add_f32 v99, v99, v131
    v_add_f32 v103, v103, v135
    v_add_f32 v107, v107, v139
    v_add_f32 v111, v111, v143
    v_add_f32 v115, v115, v147
    v_add_f32 v119, v119, v151
    v_add_f32 v123, v123, v155
    v_add_f32 v127, v127, v159
    s_branch L_NSR
L_RT0:
    s_waitcnt vmcnt(0)
    s_add_u32 s100, s100, 1
    s_cmp_gt_u32 s100, 200000
    s_cbranch_scc1 L_END
    s_sleep 1
    buffer_load_dwordx4 v[128:131], v232, s[56:59], s26 offen sc1
    buffer_load_dwordx4 v[132:135], v232, s[56:59], s27 offen sc1
    buffer_load_dwordx4 v[136:139], v232, s[56:59], s28 offen sc1
    buffer_load_dwordx4 v[140:143], v232, s[56:59], s29 offen sc1
    s_waitcnt vmcnt(0)
    s_branch L_PW0
L_RT1:
    s_waitcnt vmcnt(0)
    s_add_u32 s100, s100, 1
    s_cmp_gt_u32 s100, 200000
    s_cbranch_scc1 L_END
    s_sleep 1
    buffer_load_dwordx4 v[132:135], v232, s[56:59], s27 offen sc1
    buffer_load_dwordx4 v[136:139], v232, s[56:59], s28 offen sc1
    buffer_load_dwordx4 v[140:143], v232, s[56:59], s29 offen sc1
    s_waitcnt vmcnt(0)
    s_branch L_PW1
L_RT2:
    s_waitcnt vmcnt(0)
    s_add_u32 s100, s100, 1
    s_cmp_gt_u32 s100, 200000
    s_cbranch_scc1 L_END
    s_sleep 1
    buffer_load_dwordx4 v[136:139], v232, s[56:59], s28 offen sc1
    buffer_load_dwordx4 v[140:143], v232, s[56:59], s29 offen sc1
    s_waitcnt vmcnt(0)
    s_branch L_PW2
L_RT3:
    s_waitcnt vmcnt(0)
    s_add_u32 s100, s100, 1
    s_cmp_gt_u32 s100, 200000
    s_cbranch_scc1 L_END
    s_sleep 1
    buffer_load_dwordx4 v[140:143], v232, s[56:59], s29 offen sc1
    s_waitcnt vmcnt(0)
    s_branch L_PW3
L_XT2B:
    s_add_u32 s100, s100, 1
    s_cmp_gt_u32 s100, 200000
    s_cbranch_scc1 L_END
    s_sleep 1
    s_mov_b64 exec, s[70:71]
    s_cbranch_execz L_XLb0
    s_movk_i32 s10, 0
    buffer_load_dwordx4 v[64:67], v232, s[60:63], s10 offen sc1
L_XLb0:
    s_mov_b64 exec, s[78:79]
    s_cbranch_execz L_XLb1
    s_movk_i32 s10, 8192
    buffer_load_dwordx4 v[68:71], v232, s[60:63], s10 offen sc1
L_XLb1:
    s_mov_b64 exec, s[86:87]
    s_cbranch_execz L_XLb2
    s_movk_i32 s10, 16384
    buffer_load_dwordx4 v[72:75], v232, s[60:63], s10 offen sc1
L_XLb2:
    s_mov_b64 exec, s[94:95]
    s_cbranch_execz L_XLb3
    s_movk_i32 s10, 24576
    buffer_load_dwordx4 v[76:79], v232, s[60:63], s10 offen sc1
L_XLb3:
    s_mov_b64 exec, -1
    s_waitcnt vmcnt(0)
    s_branch L_XT2
L_OVF:
    s_mov_b32 s20, 0
    s_mov_b32 s17, 0
    s_mov_b32 s30, 0
    s_mov_b32 s19, 4
    s_waitcnt lgkmcnt(0)
    s_branch L_CA
L_POVF:
    s_movk_i32 s11, 1986
    v_mul_u32_u24 v64, s11, v192
    v_lshrrev_b32 v64, 16, v64
    v_mul_u32_u24 v65, s11, v193
    v_lshrrev_b32 v65, 16, v65
    v_mul_u32_u24 v66, s11, v194
    v_lshrrev_b32 v66, 16, v66
    v_mul_u32_u24 v67, s11, v195
    v_lshrrev_b32 v67, 16, v67
    v_add_u32 v69, v64, v65
    v_add_u32 v70, v69, v66
    v_add_u32 v71, v70, v67
    v_mov_b32 v72, v71
    s_nop 1
    v_add_u32_dpp v72, v72, v72 row_shr:1 row_mask:0xf bank_mask:0xf bound_ctrl:0
    s_nop 1
    v_add_u32_dpp v72, v72, v72 row_shr:2 row_mask:0xf bank_mask:0xf bound_ctrl:0
    s_nop 1
    v_add_u32_dpp v72, v72, v72 row_shr:4 row_mask:0xf bank_mask:0xf bound_ctrl:0
    s_nop 1
    v_add_u32_dpp v72, v72, v72 row_shr:8 row_mask:0xf bank_mask:0xf bound_ctrl:0
    s_nop 1
    v_add_u32_dpp v72, v72, v72 row_bcast:15 row_mask:0xa bank_mask:0xf
    s_nop 1
    v_add_u32_dpp v72, v72, v72 row_bcast:31 row_mask:0xc bank_mask:0xf
    s_nop 0
    v_sub_u32 v68, v72, v71
    v_add_u32 v71, v68, v70
    v_add_u32 v70, v68, v69
    v_add_u32 v69, v68, v64
    v_lshl_or_b32 v68, v64, 16, v68
    v_lshl_or_b32 v69, v65, 16, v69
    v_lshl_or_b32 v70, v66, 16, v70
    v_lshl_or_b32 v71, v67, 16, v71
    v_add_u32 v72, 154752, v185
    ds_write_b128 v72, v[68:71]
    s_lshl_b32 s10, s2, 10
    s_add_u32 s10, s10, 24772608
    buffer_store_dwordx4 v[68:71], v185, s[52:55], s10 offen sc1
    v_and_b32 v74, 0x3fc, v136
    v_add_u32 v74, 154752, v74
    ds_read_u16 v74, v74
    v_and_b32 v75, 0x3fc, v137
    v_add_u32 v75, 154752, v75
    ds_read_u16 v75, v75
    v_and_b32 v76, 0x3fc, v138
    v_add_u32 v76, 154752, v76
    ds_read_u16 v76, v76
    v_and_b32 v77, 0x3fc, v139
    v_add_u32 v77, 154752, v77
    ds_read_u16 v77, v77
    v_and_b32 v78, 0x3fc, v140
    v_add_u32 v78, 154752, v78
    ds_read_u16 v78, v78
    v_and_b32 v79, 0x3fc, v141
    v_add_u32 v79, 154752, v79
    ds_read_u16 v79, v79
    v_and_b32 v80, 0x3fc, v142
    v_add_u32 v80, 154752, v80
    ds_read_u16 v80, v80
    v_and_b32 v81, 0x3fc, v143
    v_add_u32 v81, 154752, v81
    ds_read_u16 v81, v81
    s_waitcnt lgkmcnt(0)
    v_cmpx_lt_u32 vcc, 1056, v228
    v_or_b32 v205, 0x10000, v205
    s_mov_b64 exec, -1
    v_cmpx_lt_u32 vcc, 1056, v229
    v_or_b32 v209, 0x10000, v209
    s_mov_b64 exec, -1
    v_cmpx_lt_u32 vcc, 1056, v230
    v_or_b32 v213, 0x10000, v213
    s_mov_b64 exec, -1
    v_cmpx_lt_u32 vcc, 1056, v231
    v_or_b32 v217, 0x10000, v217
    s_mov_b64 exec, -1
    s_mul_i32 s10, s2, 4152
    s_mov_b32 s34, 18874368
    s_mov_b32 s35, 23592960
    v_mul_u32_u24 v64, s11, v112
    v_lshrrev_b32 v64, 16, v64
    v_add3_u32 v64, v64, v74, s10
    v_lshlrev_b32 v65, 2, v64
    v_cmpx_le_u32 vcc, 1056, v112
    s_cbranch_execz L_PO0
    buffer_store_byte v120, v64, s[52:55], s35 offen sc1
    buffer_store_dword v96, v65, s[52:55], s34 offen sc1
L_PO0:
    s_mov_b64 exec, -1
    v_mul_u32_u24 v64, s11, v113
    v_lshrrev_b32 v64, 16, v64
    v_add3_u32 v64, v64, v75, s10
    v_lshlrev_b32 v65, 2, v64
    v_cmpx_le_u32 vcc, 1056, v113
    s_cbranch_execz L_PO1
    buffer_store_byte v121, v64, s[52:55], s35 offen sc1
    buffer_store_dword v97, v65, s[52:55], s34 offen sc1
L_PO1:
    s_mov_b64 exec, -1
    v_mul_u32_u24 v64, s11, v114
    v_lshrrev_b32 v64, 16, v64
    v_add3_u32 v64, v64, v76, s10
    v_lshlrev_b32 v65, 2, v64
    v_cmpx_le_u32 vcc, 1056, v114
    s_cbranch_execz L_PO2
    buffer_store_byte v122, v64, s[52:55], s35 offen sc1
    buffer_store_dword v98, v65, s[52:55], s34 offen sc1
L_PO2:
    s_mov_b64 exec, -1
    v_mul_u32_u24 v64, s11, v115
    v_lshrrev_b32 v64, 16, v64
    v_add3_u32 v64, v64, v77, s10
    v_lshlrev_b32 v65, 2, v64
    v_cmpx_le_u32 vcc, 1056, v115
    s_cbranch_execz L_PO3
    buffer_store_byte v123, v64, s[52:55], s35 offen sc1
    buffer_store_dword v99, v65, s[52:55], s34 offen sc1
L_PO3:
    s_mov_b64 exec, -1
    v_mul_u32_u24 v64, s11, v116
    v_lshrrev_b32 v64, 16, v64
    v_add3_u32 v64, v64, v78, s10
    v_lshlrev_b32 v65, 2, v64
    v_cmpx_le_u32 vcc, 1056, v116
    s_cbranch_execz L_PO4
    buffer_store_byte v120, v64, s[52:55], s35 offen sc1
    buffer_store_dword v100, v65, s[52:55], s34 offen sc1
L_PO4:
    s_mov_b64 exec, -1
    v_mul_u32_u24 v64, s11, v117
    v_lshrrev_b32 v64, 16, v64
    v_add3_u32 v64, v64, v79, s10
    v_lshlrev_b32 v65, 2, v64
    v_cmpx_le_u32 vcc, 1056, v117
    s_cbranch_execz L_PO5
    buffer_store_byte v121, v64, s[52:55], s35 offen sc1
    buffer_store_dword v101, v65, s[52:55], s34 offen sc1
L_PO5:
    s_mov_b64 exec, -1
    v_mul_u32_u24 v64, s11, v118
    v_lshrrev_b32 v64, 16, v64
    v_add3_u32 v64, v64, v80, s10
    v_lshlrev_b32 v65, 2, v64
    v_cmpx_le_u32 vcc, 1056, v118
    s_cbranch_execz L_PO6
    buffer_store_byte v122, v64, s[52:55], s35 offen sc1
    buffer_store_dword v102, v65, s[52:55], s34 offen sc1
L_PO6:
    s_mov_b64 exec, -1
    v_mul_u32_u24 v64, s11, v119
    v_lshrrev_b32 v64, 16, v64
    v_add3_u32 v64, v64, v81, s10
    v_lshlrev_b32 v65, 2, v64
    v_cmpx_le_u32 vcc, 1056, v119
    s_cbranch_execz L_PO7
    buffer_store_byte v123, v64, s[52:55], s35 offen sc1
    buffer_store_dword v103, v65, s[52:55], s34 offen sc1
L_PO7:
    s_mov_b64 exec, -1
    s_waitcnt vmcnt(0) lgkmcnt(0)
    s_barrier
    s_branch L_POUT
L_SLOW:
    s_setprio 0
    s_lshl_b32 s10, s3, 6
    v_add_u32 v255, s10, v247
    s_cmp_lg_u32 s19, 4
    s_cbranch_scc1 L_SL1
    s_mov_b32 s19, 1
    v_and_b32 v188, 0xff, v255
    v_lshlrev_b32 v189, 7, v188
    buffer_load_dword v190, v189, s[56:59], 0 offen offset:4 sc1
    v_lshlrev_b32 v189, 10, v188
    s_lshl_b32 s10, s5, 2
    s_add_u32 s10, s10, 24772608
    buffer_load_dword v191, v189, s[52:55], s10 offen sc1
    v_lshlrev_b32 v188, 2, v188
    v_add_u32 v188, 154752, v188
    s_waitcnt vmcnt(0)
    v_and_b32 v190, 0x10000, v190
    v_cmp_ne_u32 vcc, 0, v190
    v_mov_b32 v190, 2097152
    s_nop 0
    v_cndmask_b32 v190, v190, v191, vcc
    ds_write_b32 v188, v190
    s_waitcnt lgkmcnt(0)
    s_barrier
L_SL1:
    s_add_u32 s28, s28, 288
    s_cmp_lt_u32 s28, s29
    s_cbranch_scc1 L_BATCH
L_FIND:
    s_cmp_lg_u64 s[32:33], 0
    s_cbranch_scc1 L_GOT
    s_add_u32 s26, s26, 1
    s_cmp_ge_u32 s26, 4
    s_cbranch_scc1 L_EPI
    s_lshl_b32 s10, s26, 8
    s_add_u32 s10, s10, 154752
    v_lshl_add_u32 v188, v247, 2, s10
    ds_read_u16 v188, v188 offset:2
    s_waitcnt lgkmcnt(0)
    v_cmp_lt_u32 s[32:33], s20, v188
    s_nop 3
    s_branch L_FIND
L_GOT:
    s_ff1_i32_b64 s10, s[32:33]
    s_bitset0_b64 s[32:33], s10
    s_lshl_b32 s11, s26, 6
    s_add_u32 s27, s10, s11
    s_lshl_b32 s10, s27, 2
    s_add_u32 s10, s10, 154752
    v_mov_b32 v188, s10
    ds_read_b32 v188, v188
    s_waitcnt lgkmcnt(0)
    v_readfirstlane_b32 s10, v188
    s_nop 3
    s_lshr_b32 s29, s10, 16
    s_and_b32 s30, s10, 0xffff
    s_mov_b32 s28, s20
L_BATCH:
    s_waitcnt vmcnt(0)
    s_barrier
    v_mov_b32 v192, 0x2000000
    v_mov_b32 v193, 0x2000000
    v_mov_b32 v194, 0x2000000
    v_mov_b32 v195, 0x2000000
    v_mov_b32 v196, 0xfffff
    v_mov_b32 v197, 0xfffff
    v_mov_b32 v198, 0xfffff
    v_mov_b32 v199, 0xfffff
    v_lshl_add_u32 v200, v247, 4, s12
    ds_write_b128 v200, v[192:195] offset:0
    ds_write_b128 v200, v[196:199] offset:18432
    ds_write_b128 v200, v[192:195] offset:1024
    ds_write_b128 v200, v[196:199] offset:19456
    ds_write_b128 v200, v[192:195] offset:1280
    ds_write_b128 v200, v[196:199] offset:19712
    v_and_b32 v188, 15, v247
    v_mul_u32_u24 v189, 1152, v188
    v_add_u32 v189, 8192, v189
    v_lshlrev_b32 v188, 2, v188
    ds_write_b32 v188, v189 offset:576
    v_add_u32 v188, s28, v255
    s_mul_i32 s36, s27, 3128
    s_mul_i32 s11, s27, 4152
    s_add_u32 s11, s11, s30
    s_lshl_b32 s34, s11, 2
    s_add_u32 s34, s34, 18874368
    v_lshl_add_u32 v190, v188, 2, s34
    s_add_u32 s34, s11, 23592960
    v_add_u32 v191, s34, v188
    s_mul_i32 s10, s5, 32896
    s_lshl_b32 s34, s27, 7
    s_add_u32 s10, s10, s34
    s_add_u32 s10, s10, 65536
    v_and_b32 v206, 7, v188
    v_lshl_add_u32 v206, v206, 4, s10
    v_lshrrev_b32 v207, 3, v188
    v_cmpx_gt_u32 vcc, 32, v188
    v_add_u32 v190, 8421376, v206
    v_add_u32 v191, 8, v190
    v_cmpx_gt_u32 vcc, 24, v188
    v_lshl_add_u32 v190, v207, 2, v206
    v_add3_u32 v191, v206, v207, 12
    s_mov_b64 exec, -1
    s_add_u32 s10, s28, 288
    s_min_u32 s10, s10, s29
    v_cmp_gt_u32 vcc, s10, v188
    v_mov_b32 v206, 0x7ffffff0
    s_nop 0
    v_cndmask_b32 v190, v206, v190, vcc
    v_cndmask_b32 v191, v206, v191, vcc
    buffer_load_dwordx2 v[204:205], v190, s[52:55], 0 offen sc1
    buffer_load_ubyte v191, v191, s[52:55], 0 offen sc1
    s_waitcnt lgkmcnt(0)
    s_barrier
    s_waitcnt vmcnt(0)
    v_cmp_ne_u32 vcc, 3, v207
    v_cmp_eq_u32 s[10:11], s6, v205
    v_mov_b32 v206, s36
    s_or_b64 exec, vcc, s[10:11]
    v_cmpx_ne_u32 vcc, 0, v204
    v_bfe_u32 v190, v204, 18, 8
    v_lshlrev_b32 v190, 2, v190
    v_add_u32 v188, 153728, v190
    ds_read_b32 v188, v188
    v_add_u32_sdwa v191, v191, v206 dst_sel:DWORD dst_unused:UNUSED_PAD src0_sel:BYTE_0 src1_sel:DWORD
    v_lshrrev_b32 v189, 28, v204
    v_lshl_add_u32 v191, v189, 8, v191
    v_and_b32 v189, 60, v190
    v_and_b32 v204, 0xffff, v204
    v_lshl_or_b32 v204, v189, 19, v204
    v_mov_b32 v190, 4
    s_waitcnt lgkmcnt(0)
    ds_add_rtn_u32 v188, v188, v190 offset:576
    s_waitcnt lgkmcnt(0)
    ds_write2st64_b32 v188, v204, v191 offset0:148 offset1:220
    s_mov_b64 exec, -1
    s_waitcnt lgkmcnt(0)
    s_barrier
    v_lshrrev_b32 v190, 3, v247
    v_lshl_add_u32 v248, v190, 4, s12
    s_add_u32 s10, s12, 18432
    v_lshrrev_b32 v190, 1, v247
    v_lshl_add_u32 v249, v190, 2, s10
    s_add_u32 s10, s10, 2
    v_lshrrev_b32 v190, 5, v247
    v_mul_i32_i24 v250, 0xffffb800, v190
    v_and_b32 v190, 15, v247
    v_lshl_add_u32 v250, v190, 2, v250
    v_add_u32 v250, s10, v250
    s_add_u32 s10, s12, 2
    v_and_b32 v190, 48, v247
    v_lshl_add_u32 v251, v190, 1, s10
    v_and_b32 v190, 12, v247
    v_add_u32 v251, v251, v190
    ds_read_b128 v[236:239], v248
    ds_read_b32 v240, v249
    s_lshl_b32 s10, s4, 3
    v_mov_b32 v190, s10
    ds_read_b64 v[190:191], v190 offset:576
    s_waitcnt lgkmcnt(0)
    v_readfirstlane_b32 s34, v190
    v_readfirstlane_b32 s35, v191
    s_sub_u32 s10, s12, 37888
    s_sub_u32 s34, s34, s10
    s_sub_u32 s35, s35, s10
    s_sub_u32 s35, s35, 1152
    s_add_u32 s10, s34, 127
    s_lshr_b32 s10, s10, 7
    s_lshl1_add_u32 s10, s10, -1
    s_add_u32 s11, s35, 127
    s_lshr_b32 s11, s11, 6
    s_and_b32 s11, s11, -2
    s_max_i32 s17, s10, s11
    s_cselect_b32 s10, s34, s35
    s_sub_u32 s10, s10, 1
    s_andn2_b32 s99, 64, s10
    v_mov_b64 v[204:205], 0
    v_mov_b64 v[206:207], 0
    v_mov_b64 v[184:185], 0
    v_mov_b64 v[186:187], 0
    s_add_u32 m0, s13, 0
    v_mad_u32_u16 v236, v236, s15, v243
    buffer_load_dwordx4 v236, s[40:43], 0 offen lds
    s_add_u32 m0, s13, 1056
    v_mad_u32_u16 v237, v237, s15, v243
    buffer_load_dwordx4 v237, s[40:43], 0 offen lds
    s_add_u32 m0, s13, 2112
    v_mad_u32_u16 v238, v238, s15, v243
    buffer_load_dwordx4 v238, s[40:43], 0 offen lds
    s_add_u32 m0, s13, 3168
    v_mad_u32_u16 v239, v239, s15, v243
    buffer_load_dwordx4 v239, s[40:43], 0 offen lds
    s_mov_b32 m0, s14
    s_nop 0
    buffer_load_dwordx4 v[240:241], s[44:47], 0 idxen offen lds
L_LAST:
    s_branch L_GO
.section .rodata,"a"
.p2align 6
.amdhsa_kernel standalone__edge_featured_mpnn_gatedgcn__graph_kernel
  .amdhsa_next_free_vgpr 256
  .amdhsa_next_free_sgpr 102
  .amdhsa_accum_offset 256
  .amdhsa_group_segment_fixed_size 0
  .amdhsa_kernarg_size 96
  .amdhsa_user_sgpr_count 2
  .amdhsa_user_sgpr_kernarg_segment_ptr 1
  .amdhsa_system_sgpr_workgroup_id_x 1
.end_amdhsa_kernel
```
